```python
import torch

def _softmax(x, axis=-1):
    return torch.softmax(x, dim=axis)
def _gelu(x):
    return torch.nn.functional.gelu(x, approximate="tanh")
def _silu(x):
    return torch.nn.functional.silu(x)
def _sigmoid(x):
    return torch.sigmoid(x)
def _layernorm(x, axis=-1, eps=1e-5):
    m = x.mean(dim=axis, keepdim=True)
    v = x.var(dim=axis, keepdim=True, unbiased=False)
    return (x - m) / torch.sqrt(v + eps)
def _scatter_add(tgt, idx, src, axis=0):
    return tgt.clone().index_add_(axis, idx, src)
def _segment_sum(src, seg, n):
    out = torch.zeros((n,) + src.shape[1:], dtype=src.dtype)
    return out.index_add_(0, seg, src)
def _pad(x, pw):
    flat = tuple(v for pair in reversed(pw) for v in pair)
    return torch.nn.functional.pad(x, flat)

kernel_name = 'interleave_layers__sliding_local_dilated__glu_gated_bilinear__prompt'

def setup_inputs():

    _w = (lambda a: (lambda t: t.to(torch.bfloat16) if t.is_floating_point() else t)(torch.as_tensor(a)))
    def _A_setup():
        B, S, D = 1, 2048, 576
        return {
            "x": _w((lambda *s: torch.randn(*s, dtype=torch.bfloat16) * 0.05)(B, S, D)),
            "wqkv": _w((lambda *s: torch.randn(*s, dtype=torch.bfloat16) * 0.05)(D, 3 * D)),
            "wo": _w((lambda *s: torch.randn(*s, dtype=torch.bfloat16) * 0.05)(D, D)),
        }
    _A_in = _A_setup()

    def _B_setup():
        B, S, D, F = 1, 2048, 576, 4608
        return {
            "x": _w((lambda *s: torch.randn(*s, dtype=torch.bfloat16) * 0.05)(B, S, D)),
            "w_gate": _w((lambda *s: torch.randn(*s, dtype=torch.bfloat16) * 0.8)(D, F) * (D ** -0.5)),
            "w_up": _w((lambda *s: torch.randn(*s, dtype=torch.bfloat16) * 0.8)(D, F) * (D ** -0.5)),
            "w_down": _w((lambda *s: torch.randn(*s, dtype=torch.bfloat16) * 0.8)(F, D) * (F ** -0.5)),
        }
    _B_in = _B_setup()

    return {
        "A_x": _A_in["x"],
        "A_wqkv": _A_in["wqkv"],
        "A_wo": _A_in["wo"],
        "B_x": _B_in["x"],
        "B_w_gate": _B_in["w_gate"],
        "B_w_up": _B_in["w_up"],
        "B_w_down": _B_in["w_down"],
    }

def reference(A_x, A_wqkv, A_wo, B_x, B_w_gate, B_w_up, B_w_down):
    def _A_ref(x, wqkv, wo):
        B, S, D = x.shape
        H = 32; Dh = D // H
        W, dil = 8, 2
        qkv = (lambda x, *d: x.permute(*d))((x @ wqkv).reshape(B, S, 3, H, Dh), 2, 0, 3, 1, 4)
        q, k, v = qkv[0], qkv[1], qkv[2]
        scale = Dh ** -0.5
        pos = torch.arange(S)
        off = torch.arange(W) * dil
        idx = pos[:, None] - off[None, :]
        mask = idx >= 0
        idx_c = torch.where(mask, idx, 0).reshape(-1)
        kg = k[:, :, idx_c, :].reshape(B, H, S, W, Dh)
        vg = v[:, :, idx_c, :].reshape(B, H, S, W, Dh)
        logits = torch.einsum("bhsd,bhswd->bhsw", q, kg) * scale
        logits = torch.where(mask[None, None, :, :], logits, -1e9)
        attn = _softmax(logits, axis=-1)
        o = torch.einsum("bhsw,bhswd->bhsd", attn, vg)
        return (lambda x, *d: x.permute(*d))(o, 0, 2, 1, 3).reshape(B, S, D) @ wo

    def _B_ref(x, w_gate, w_up, w_down):
        g = torch.einsum("bsd,df->bsf", x, w_gate)
        u = torch.einsum("bsd,df->bsf", x, w_up)
        h = g * u
        return torch.einsum("bsf,fd->bsd", h, w_down)

    x = A_x
    x = x + _A_ref(_layernorm(x, axis=-1), A_wqkv, A_wo)
    x = x + _B_ref(_layernorm(x, axis=-1), B_w_gate, B_w_up, B_w_down)
    x = x + _A_ref(_layernorm(x, axis=-1), A_wqkv, A_wo)
    x = x + _B_ref(_layernorm(x, axis=-1), B_w_gate, B_w_up, B_w_down)
    return x
```

```asm
; @launch kernel=interleave_layers__sliding_local_dilated__glu_gated_bilinear__prompt_kernel grid=(256,1,1) block=(256,1,1) lds=9216
; @launch kernel=a1w_kernel grid=(256,1,1) block=(256,1,1) lds=163584
; @launch kernel=a2_kernel grid=(256,1,1) block=(256,1,1) lds=38144
; @launch kernel=b1_kernel grid=(256,1,1) block=(256,1,1) lds=163840
; @launch kernel=b2_kernel grid=(256,1,1) block=(256,1,1) lds=9216
; @launch kernel=a1_kernel grid=(256,1,1) block=(256,1,1) lds=163584
; @launch kernel=a2_kernel grid=(256,1,1) block=(256,1,1) lds=38144
; @launch kernel=b1_kernel grid=(256,1,1) block=(256,1,1) lds=163840
; @launch kernel=b2l_kernel grid=(256,1,1) block=(256,1,1) lds=9216
.amdgcn_target "amdgcn-amd-amdhsa--gfx950"
.text
.globl interleave_layers__sliding_local_dilated__glu_gated_bilinear__prompt_kernel
.p2align 8
.type interleave_layers__sliding_local_dilated__glu_gated_bilinear__prompt_kernel,@function
interleave_layers__sliding_local_dilated__glu_gated_bilinear__prompt_kernel:
  s_cmp_ge_u32 s2, 256
  s_cbranch_scc1 L_interleave_layers__sliding_local_dilated__glu_gated_bilinear__prompt_kernel_end
  s_load_dwordx4 s[44:47], s[0:1], 0
  s_load_dwordx2 s[48:49], s[0:1], 16
  s_load_dwordx2 s[50:51], s[0:1], 72
  v_lshrrev_b32 v12, 6, v0
  v_and_b32 v1, 63, v0
  v_readfirstlane_b32 s32, v12
  v_lshrrev_b32 v2, 3, v1
  v_and_b32 v3, 7, v1
  v_mov_b32 v11, 0x7ffffff0
  s_and_b32 s36, s2, 7
  s_lshl_b32 s36, s36, 5
  s_lshr_b32 s37, s2, 3
  s_add_u32 s33, s36, s37
  s_lshr_b32 s36, s33, 1
  s_mul_i32 s36, s36, 18432
  s_and_b32 s37, s33, 1
  s_lshl_b32 s37, s37, 7
  s_add_u32 s36, s36, s37
  v_lshlrev_b32 v12, 8, v2
  v_lshl_add_u32 v12, v3, 4, v12
  s_lshl_b32 s37, s32, 12
  s_add_u32 s37, s37, s36
  v_add_u32 v4, s37, v12
  s_lshl_b32 s37, s32, 2
  s_add_u32 s37, s37, s36
  s_add_u32 s37, s37, 16384
  v_add_u32 v5, s37, v12
  s_lshl_b32 s36, s33, 3
  v_add_u32 v13, s36, v3
  v_lshlrev_b32 v8, 2, v13
  v_mul_u32_u24 v13, 1152, v13
  v_lshrrev_b32 v12, 2, v2
  v_lshl_add_u32 v13, v12, 6, v13
  v_and_b32 v12, 3, v2
  v_lshl_add_u32 v13, v12, 3, v13
  s_lshl_b32 s37, s32, 8
  v_add_u32 v6, s37, v13
  s_lshr_b32 s37, s32, 1
  s_lshl_b32 s37, s37, 5
  s_and_b32 s38, s32, 1
  s_lshl_b32 s38, s38, 2
  s_add_u32 s37, s37, s38
  s_add_u32 s37, s37, 1024
  v_add_u32 v7, s37, v13
  v_lshlrev_b32 v10, 4, v3
  s_lshl_b32 s37, s32, 2
  v_add_u32 v9, s37, v10
  s_waitcnt lgkmcnt(0)
  s_mov_b32 s4, s44
  s_and_b32 s5, s45, 0xffff
  s_mov_b32 s6, 2359296
  s_mov_b32 s7, 0x20000
  s_mov_b32 s8, s46
  s_and_b32 s9, s47, 0xffff
  s_mov_b32 s10, 1990656
  s_mov_b32 s11, 0x20000
  s_mov_b32 s12, s48
  s_and_b32 s13, s49, 0xffff
  s_mov_b32 s14, 663552
  s_mov_b32 s15, 0x20000
  buffer_load_dwordx2 v[24:25], v6, s[4:7], 0 offen
  buffer_load_dwordx2 v[26:27], v6, s[4:7], 0 offen offset:32
  buffer_load_dwordx2 v[28:29], v6, s[4:7], 0 offen offset:128
  buffer_load_dwordx2 v[30:31], v6, s[4:7], 0 offen offset:160
  buffer_load_dword v32, v7, s[4:7], 0 offen
  s_add_u32 s16, s50, 2359296
  s_addc_u32 s17, s51, 0
  s_and_b32 s17, s17, 0xffff
  s_mov_b32 s18, 2359296
  s_mov_b32 s19, 0x20000
  s_add_u32 s20, s50, 9826304
  s_addc_u32 s21, s51, 0
  s_and_b32 s21, s21, 0xffff
  s_mov_b32 s22, 8192
  s_mov_b32 s23, 0x20000
  s_add_u32 s24, s50, 9834496
  s_addc_u32 s25, s51, 0
  s_and_b32 s25, s25, 0xffff
  s_mov_b32 s26, 8192
  s_mov_b32 s27, 0x20000
  s_add_u32 s28, s50, 7077888
  s_addc_u32 s29, s51, 0
  s_and_b32 s29, s29, 0xffff
  s_mov_b32 s30, 2064384
  s_mov_b32 s31, 0x20000
  s_add_u32 s40, s50, 9142272
  s_addc_u32 s41, s51, 0
  s_and_b32 s41, s41, 0xffff
  s_mov_b32 s42, 681984
  s_mov_b32 s43, 0x20000
  s_lshl_b32 s52, s2, 2
  s_add_u32 s52, s52, s32
  v_and_b32 v34, 15, v1
  v_lshrrev_b32 v35, 4, v1
  s_mov_b32 s57, 6912
  s_mov_b32 s58, 55296
  s_mov_b32 s59, 62208
  s_lshl_b32 s53, s52, 1
  s_add_u32 s53, s53, 0
  s_mul_hi_u32 s36, s53, 613566757
  s_mul_i32 s37, s36, 7
  s_sub_u32 s54, s53, s37
  s_mul_hi_u32 s56, s36, 238609295
  s_mul_i32 s37, s56, 18
  s_sub_u32 s55, s36, s37
  s_lshl_b32 s37, s54, 4
  v_add_u32 v36, s37, v34
  v_cmp_le_u32 vcc, 40, v36
  s_nop 1
  v_cndmask_b32 v37, 0, 1, vcc
  v_mul_u32_u24 v38, 40, v37
  v_sub_u32 v39, v36, v38
  v_mul_u32_u24 v37, 18, v37
  v_add_u32 v37, v37, v39
  v_cmp_le_u32 vcc, 18, v39
  s_nop 1
  v_cndmask_b32 v38, 0, 1, vcc
  v_mul_u32_u24 v38, 558, v38
  v_add_u32 v37, v37, v38
  v_add_u32 v37, 576, v37
  v_subrev_u32 v38, 76, v36
  v_cmp_le_u32 vcc, 76, v36
  s_nop 1
  v_cndmask_b32 v37, v37, v38, vcc
  s_mul_i32 s37, s56, 36
  v_add_u32 v37, s37, v37
  s_lshl_b32 s37, s55, 5
  v_lshl_add_u32 v38, v35, 2, s37
  v_mul_u32_u24 v38, 3456, v38
  v_lshl_add_u32 v52, v37, 1, v38
  v_subrev_u32 v38, 36, v36
  v_cmp_gt_u32 vcc, 4, v38
  s_nop 1
  v_cndmask_b32 v52, v52, v11, vcc
  s_lshl_b32 s37, s53, 10
  v_lshl_add_u32 v56, v1, 4, s37
  s_cmp_lt_u32 s53, 2016
  s_cselect_b32 s37, 0, 0x7ffffff0
  v_or_b32 v52, s37, v52
  buffer_load_ushort v40, v52, s[8:11], 0 offen
  buffer_load_ushort v84, v52, s[8:11], 0 offen offset:3456
  buffer_load_ushort v41, v52, s[8:11], s57 offen
  buffer_load_ushort v85, v52, s[8:11], s57 offen offset:3456
  buffer_load_ushort v42, v52, s[8:11], s58 offen
  buffer_load_ushort v86, v52, s[8:11], s58 offen offset:3456
  buffer_load_ushort v43, v52, s[8:11], s59 offen
  buffer_load_ushort v87, v52, s[8:11], s59 offen offset:3456
  s_lshl_b32 s53, s52, 1
  s_add_u32 s53, s53, 1
  s_mul_hi_u32 s36, s53, 613566757
  s_mul_i32 s37, s36, 7
  s_sub_u32 s54, s53, s37
  s_mul_hi_u32 s56, s36, 238609295
  s_mul_i32 s37, s56, 18
  s_sub_u32 s55, s36, s37
  s_lshl_b32 s37, s54, 4
  v_add_u32 v36, s37, v34
  v_cmp_le_u32 vcc, 40, v36
  s_nop 1
  v_cndmask_b32 v37, 0, 1, vcc
  v_mul_u32_u24 v38, 40, v37
  v_sub_u32 v39, v36, v38
  v_mul_u32_u24 v37, 18, v37
  v_add_u32 v37, v37, v39
  v_cmp_le_u32 vcc, 18, v39
  s_nop 1
  v_cndmask_b32 v38, 0, 1, vcc
  v_mul_u32_u24 v38, 558, v38
  v_add_u32 v37, v37, v38
  v_add_u32 v37, 576, v37
  v_subrev_u32 v38, 76, v36
  v_cmp_le_u32 vcc, 76, v36
  s_nop 1
  v_cndmask_b32 v37, v37, v38, vcc
  s_mul_i32 s37, s56, 36
  v_add_u32 v37, s37, v37
  s_lshl_b32 s37, s55, 5
  v_lshl_add_u32 v38, v35, 2, s37
  v_mul_u32_u24 v38, 3456, v38
  v_lshl_add_u32 v53, v37, 1, v38
  v_subrev_u32 v38, 36, v36
  v_cmp_gt_u32 vcc, 4, v38
  s_nop 1
  v_cndmask_b32 v53, v53, v11, vcc
  s_lshl_b32 s37, s53, 10
  v_lshl_add_u32 v57, v1, 4, s37
  s_cmp_lt_u32 s53, 2016
  s_cselect_b32 s37, 0, 0x7ffffff0
  v_or_b32 v53, s37, v53
  buffer_load_ushort v44, v53, s[8:11], 0 offen
  buffer_load_ushort v88, v53, s[8:11], 0 offen offset:3456
  buffer_load_ushort v45, v53, s[8:11], s57 offen
  buffer_load_ushort v89, v53, s[8:11], s57 offen offset:3456
  buffer_load_ushort v46, v53, s[8:11], s58 offen
  buffer_load_ushort v90, v53, s[8:11], s58 offen offset:3456
  buffer_load_ushort v47, v53, s[8:11], s59 offen
  buffer_load_ushort v91, v53, s[8:11], s59 offen offset:3456
  s_mul_hi_u32 s54, s52, 238609295
  s_mul_i32 s37, s54, 18
  s_sub_u32 s55, s52, s37
  v_lshrrev_b32 v36, 1, v35
  v_mul_u32_u24 v36, 18, v36
  v_and_b32 v37, 1, v35
  v_lshl_add_u32 v36, v37, 3, v36
  s_mul_i32 s37, s55, 36
  v_add_u32 v36, s37, v36
  v_mul_u32_u24 v37, 72, v35
  s_mul_i32 s37, s55, 288
  s_sub_u32 s37, s37, 4592
  v_add_u32 v37, s37, v37
  s_cmp_lt_u32 s55, 16
  s_cselect_b64 vcc, -1, 0
  v_cndmask_b32 v38, v37, v36, vcc
  s_cselect_b32 s60, 2, 18
  s_mul_i32 s60, s60, 1152
  s_mul_i32 s61, s60, 2
  s_mul_i32 s62, s60, 3
  v_mul_u32_u24 v38, 1152, v38
  s_lshl_b32 s37, s54, 5
  v_lshl_add_u32 v36, v34, 1, s37
  v_add_u32 v54, v38, v36
  s_lshl_b32 s37, s52, 10
  v_lshl_add_u32 v58, v1, 4, s37
  s_cmp_lt_u32 s52, 648
  s_cselect_b32 s37, 0, 0x7ffffff0
  v_or_b32 v54, s37, v54
  v_or_b32 v58, s37, v58
  buffer_load_ushort v48, v54, s[12:15], 0 offen
  buffer_load_ushort v92, v54, s[12:15], 0 offen offset:1152
  buffer_load_ushort v49, v54, s[12:15], s60 offen
  buffer_load_ushort v93, v54, s[12:15], s60 offen offset:1152
  buffer_load_ushort v50, v54, s[12:15], s61 offen
  buffer_load_ushort v94, v54, s[12:15], s61 offen offset:1152
  buffer_load_ushort v51, v54, s[12:15], s62 offen
  buffer_load_ushort v95, v54, s[12:15], s62 offen offset:1152
  s_waitcnt vmcnt(28)
  v_lshlrev_b32 v64, 16, v24
  v_and_b32 v65, 0xffff0000, v24
  v_lshlrev_b32 v66, 16, v25
  v_and_b32 v67, 0xffff0000, v25
  s_waitcnt vmcnt(27)
  v_lshlrev_b32 v68, 16, v26
  v_and_b32 v69, 0xffff0000, v26
  v_lshlrev_b32 v70, 16, v27
  v_and_b32 v71, 0xffff0000, v27
  s_waitcnt vmcnt(26)
  v_lshlrev_b32 v72, 16, v28
  v_and_b32 v73, 0xffff0000, v28
  v_lshlrev_b32 v74, 16, v29
  v_and_b32 v75, 0xffff0000, v29
  s_waitcnt vmcnt(25)
  v_lshlrev_b32 v76, 16, v30
  v_and_b32 v77, 0xffff0000, v30
  v_lshlrev_b32 v78, 16, v31
  v_and_b32 v79, 0xffff0000, v31
  s_waitcnt vmcnt(24)
  v_lshlrev_b32 v80, 16, v32
  v_and_b32 v81, 0xffff0000, v32
  v_add_f32 v14, v64, v65
  v_add_f32 v15, v66, v67
  v_add_f32 v14, v14, v68
  v_add_f32 v15, v15, v69
  v_add_f32 v14, v14, v70
  v_add_f32 v15, v15, v71
  v_add_f32 v14, v14, v72
  v_add_f32 v15, v15, v73
  v_add_f32 v14, v14, v74
  v_add_f32 v15, v15, v75
  v_add_f32 v14, v14, v76
  v_add_f32 v15, v15, v77
  v_add_f32 v14, v14, v78
  v_add_f32 v15, v15, v79
  v_add_f32 v14, v14, v80
  v_add_f32 v15, v15, v81
  v_add_f32 v14, v14, v15
  s_nop 1
  v_add_f32_dpp v14, v14, v14 row_ror:8 row_mask:0xf bank_mask:0xf
  v_mov_b32 v15, v14
  s_nop 1
  v_permlane16_swap_b32 v14, v15
  v_add_f32 v14, v14, v15
  v_mov_b32 v15, v14
  s_nop 1
  v_permlane32_swap_b32 v14, v15
  v_add_f32 v14, v14, v15
  ds_write_b32 v9, v14
  s_waitcnt lgkmcnt(0)
  s_barrier
  ds_read_b128 v[16:19], v10
  s_waitcnt lgkmcnt(0)
  v_add_f32 v16, v16, v17
  v_add_f32 v18, v18, v19
  v_add_f32 v14, v16, v18
  v_mul_f32 v14, 0x3ae38e39, v14
  v_sub_f32 v64, v64, v14
  v_sub_f32 v65, v65, v14
  v_sub_f32 v66, v66, v14
  v_sub_f32 v67, v67, v14
  v_sub_f32 v68, v68, v14
  v_sub_f32 v69, v69, v14
  v_sub_f32 v70, v70, v14
  v_sub_f32 v71, v71, v14
  v_sub_f32 v72, v72, v14
  v_sub_f32 v73, v73, v14
  v_sub_f32 v74, v74, v14
  v_sub_f32 v75, v75, v14
  v_sub_f32 v76, v76, v14
  v_sub_f32 v77, v77, v14
  v_sub_f32 v78, v78, v14
  v_sub_f32 v79, v79, v14
  v_sub_f32 v80, v80, v14
  v_sub_f32 v81, v81, v14
  v_mul_f32 v20, v64, v64
  v_mul_f32 v21, v65, v65
  v_fmac_f32 v20, v66, v66
  v_fmac_f32 v21, v67, v67
  v_fmac_f32 v20, v68, v68
  v_fmac_f32 v21, v69, v69
  v_fmac_f32 v20, v70, v70
  v_fmac_f32 v21, v71, v71
  v_fmac_f32 v20, v72, v72
  v_fmac_f32 v21, v73, v73
  v_fmac_f32 v20, v74, v74
  v_fmac_f32 v21, v75, v75
  v_fmac_f32 v20, v76, v76
  v_fmac_f32 v21, v77, v77
  v_fmac_f32 v20, v78, v78
  v_fmac_f32 v21, v79, v79
  v_fmac_f32 v20, v80, v80
  v_fmac_f32 v21, v81, v81
  v_add_f32 v20, v20, v21
  v_cvt_pk_bf16_f32 v24, v64, v65
  v_cvt_pk_bf16_f32 v25, v66, v67
  v_cvt_pk_bf16_f32 v26, v68, v69
  v_cvt_pk_bf16_f32 v27, v70, v71
  v_cvt_pk_bf16_f32 v28, v72, v73
  v_cvt_pk_bf16_f32 v29, v74, v75
  v_cvt_pk_bf16_f32 v30, v76, v77
  v_cvt_pk_bf16_f32 v31, v78, v79
  v_cvt_pk_bf16_f32 v32, v80, v81
  buffer_store_dwordx4 v[24:27], v4, s[16:19], 0 offen
  buffer_store_dwordx4 v[28:31], v4, s[16:19], 0 offen offset:2048
  buffer_store_dword v32, v5, s[16:19], 0 offen
  v_add_f32_dpp v20, v20, v20 row_ror:8 row_mask:0xf bank_mask:0xf
  v_mov_b32 v15, v20
  s_nop 1
  v_permlane16_swap_b32 v20, v15
  v_add_f32 v20, v20, v15
  v_mov_b32 v15, v20
  s_nop 1
  v_permlane32_swap_b32 v20, v15
  v_add_f32 v20, v20, v15
  ds_write_b32 v9, v20 offset:128
  s_waitcnt lgkmcnt(0)
  s_barrier
  ds_read_b128 v[16:19], v10 offset:128
  s_waitcnt lgkmcnt(0)
  v_add_f32 v16, v16, v17
  v_add_f32 v18, v18, v19
  v_add_f32 v20, v16, v18
  v_mov_b32 v15, 0x3727c5ac
  v_fmac_f32 v15, 0x3ae38e39, v20
  v_rsq_f32 v15, v15
  v_cmp_gt_u32 vcc, 8, v0
  s_nop 1
  v_cndmask_b32 v22, v11, v8, vcc
  buffer_store_dword v15, v22, s[20:23], 0 offen
  buffer_store_dword v14, v22, s[24:27], 0 offen
  s_waitcnt vmcnt(27)
  v_lshl_or_b32 v40, v84, 16, v40
  s_waitcnt vmcnt(25)
  v_lshl_or_b32 v41, v85, 16, v41
  s_waitcnt vmcnt(23)
  v_lshl_or_b32 v42, v86, 16, v42
  s_waitcnt vmcnt(21)
  v_lshl_or_b32 v43, v87, 16, v43
  s_waitcnt vmcnt(19)
  v_lshl_or_b32 v44, v88, 16, v44
  s_waitcnt vmcnt(17)
  v_lshl_or_b32 v45, v89, 16, v45
  s_waitcnt vmcnt(15)
  v_lshl_or_b32 v46, v90, 16, v46
  s_waitcnt vmcnt(13)
  v_lshl_or_b32 v47, v91, 16, v47
  s_waitcnt vmcnt(11)
  v_lshl_or_b32 v48, v92, 16, v48
  s_waitcnt vmcnt(9)
  v_lshl_or_b32 v49, v93, 16, v49
  s_waitcnt vmcnt(7)
  v_lshl_or_b32 v50, v94, 16, v50
  s_waitcnt vmcnt(5)
  v_lshl_or_b32 v51, v95, 16, v51
  buffer_store_dwordx4 v[40:43], v56, s[28:31], 0 offen
  buffer_store_dwordx4 v[44:47], v57, s[28:31], 0 offen
  buffer_store_dwordx4 v[48:51], v58, s[40:43], 0 offen
  s_waitcnt vmcnt(0)
  s_cmp_lt_u32 s2, 238
  s_cbranch_scc1 L_prep_done
  s_sub_u32 s55, s2, 238
  v_mov_b32 v35, s32
  v_lshrrev_b32 v36, 1, v35
  v_mul_u32_u24 v36, 18, v36
  v_and_b32 v37, 1, v35
  v_lshl_add_u32 v36, v37, 3, v36
  s_mul_i32 s37, s55, 36
  v_add_u32 v36, s37, v36
  v_mul_u32_u24 v37, 72, v35
  s_mul_i32 s37, s55, 288
  s_sub_u32 s37, s37, 4592
  v_add_u32 v37, s37, v37
  s_cmp_lt_u32 s55, 16
  s_cselect_b64 vcc, -1, 0
  v_cndmask_b32 v38, v37, v36, vcc
  v_lshrrev_b32 v36, 1, v2
  v_mul_u32_u24 v36, 18, v36
  v_and_b32 v37, 1, v2
  v_add_u32 v36, v36, v37
  v_cndmask_b32 v36, v36, v2, vcc
  v_add_u32 v38, v38, v36
  v_mul_u32_u24 v38, 1152, v38
  v_lshl_add_u32 v54, v3, 4, v38
  buffer_load_dwordx4 v[64:67], v54, s[12:15], 0 offen
  buffer_load_dwordx4 v[68:71], v54, s[12:15], 0 offen offset:128
  buffer_load_dwordx4 v[72:75], v54, s[12:15], 0 offen offset:256
  buffer_load_dwordx4 v[76:79], v54, s[12:15], 0 offen offset:384
  buffer_load_dwordx4 v[80:83], v54, s[12:15], 0 offen offset:512
  buffer_load_dwordx4 v[84:87], v54, s[12:15], 0 offen offset:640
  buffer_load_dwordx4 v[88:91], v54, s[12:15], 0 offen offset:768
  buffer_load_dwordx4 v[92:95], v54, s[12:15], 0 offen offset:896
  buffer_load_dwordx4 v[96:99], v54, s[12:15], 0 offen offset:1024
  v_mov_b32 v36, 0
  v_mov_b32 v37, 0
  s_mov_b32 s37, 0x3f803f80
  s_waitcnt vmcnt(8)
  v_dot2c_f32_bf16 v36, s37, v64
  v_dot2c_f32_bf16 v37, s37, v65
  v_dot2c_f32_bf16 v36, s37, v66
  v_dot2c_f32_bf16 v37, s37, v67
  s_waitcnt vmcnt(7)
  v_dot2c_f32_bf16 v36, s37, v68
  v_dot2c_f32_bf16 v37, s37, v69
  v_dot2c_f32_bf16 v36, s37, v70
  v_dot2c_f32_bf16 v37, s37, v71
  s_waitcnt vmcnt(6)
  v_dot2c_f32_bf16 v36, s37, v72
  v_dot2c_f32_bf16 v37, s37, v73
  v_dot2c_f32_bf16 v36, s37, v74
  v_dot2c_f32_bf16 v37, s37, v75
  s_waitcnt vmcnt(5)
  v_dot2c_f32_bf16 v36, s37, v76
  v_dot2c_f32_bf16 v37, s37, v77
  v_dot2c_f32_bf16 v36, s37, v78
  v_dot2c_f32_bf16 v37, s37, v79
  s_waitcnt vmcnt(4)
  v_dot2c_f32_bf16 v36, s37, v80
  v_dot2c_f32_bf16 v37, s37, v81
  v_dot2c_f32_bf16 v36, s37, v82
  v_dot2c_f32_bf16 v37, s37, v83
  s_waitcnt vmcnt(3)
  v_dot2c_f32_bf16 v36, s37, v84
  v_dot2c_f32_bf16 v37, s37, v85
  v_dot2c_f32_bf16 v36, s37, v86
  v_dot2c_f32_bf16 v37, s37, v87
  s_waitcnt vmcnt(2)
  v_dot2c_f32_bf16 v36, s37, v88
  v_dot2c_f32_bf16 v37, s37, v89
  v_dot2c_f32_bf16 v36, s37, v90
  v_dot2c_f32_bf16 v37, s37, v91
  s_waitcnt vmcnt(1)
  v_dot2c_f32_bf16 v36, s37, v92
  v_dot2c_f32_bf16 v37, s37, v93
  v_dot2c_f32_bf16 v36, s37, v94
  v_dot2c_f32_bf16 v37, s37, v95
  s_waitcnt vmcnt(0)
  v_dot2c_f32_bf16 v36, s37, v96
  v_dot2c_f32_bf16 v37, s37, v97
  v_dot2c_f32_bf16 v36, s37, v98
  v_dot2c_f32_bf16 v37, s37, v99
  s_nop 2
  v_add_f32 v36, v36, v37
  s_nop 1
  v_add_f32_dpp v36, v36, v36 quad_perm:[1,0,3,2] row_mask:0xf bank_mask:0xf
  s_nop 1
  v_add_f32_dpp v36, v36, v36 quad_perm:[2,3,0,1] row_mask:0xf bank_mask:0xf
  s_nop 1
  v_add_f32_dpp v36, v36, v36 row_half_mirror row_mask:0xf bank_mask:0xf
  v_mul_f32 v36, 0x3ae38e39, v36
  v_cvt_pk_bf16_f32 v37, v36, v36
  v_and_b32 v37, 0xffff0000, v37
  v_sub_f32 v36, v36, v37
  v_cvt_pk_bf16_f32 v36, v36, v36
  s_add_u32 s37, s55, 648
  s_lshl_b32 s37, s37, 10
  s_lshl_b32 s38, s32, 8
  s_add_u32 s37, s37, s38
  v_lshl_add_u32 v38, v2, 1, s37
  v_cmp_eq_u32 vcc, 0, v3
  s_nop 1
  v_cndmask_b32 v38, v11, v38, vcc
  buffer_store_short_d16_hi v37, v38, s[40:43], 0 offen
  buffer_store_short v36, v38, s[40:43], 0 offen offset:16
  v_lshl_add_u32 v38, v1, 4, s37
  v_cmp_gt_u32 vcc, 14, v1
  s_nop 1
  v_cndmask_b32 v38, v11, v38, vcc
  v_mov_b32 v40, 0
  v_mov_b32 v41, 0
  v_mov_b32 v42, 0
  v_mov_b32 v43, 0
  buffer_store_dwordx4 v[40:43], v38, s[40:43], 0 offen offset:32
L_prep_done:
L_interleave_layers__sliding_local_dilated__glu_gated_bilinear__prompt_kernel_end:
  s_endpgm
.globl a1w_kernel
.p2align 8
.type a1w_kernel,@function
a1w_kernel:
  s_cmp_ge_u32 s2, 256
  s_cbranch_scc1 L_a1w_kernel_end
  s_load_dwordx2 s[54:55], s[0:1], 72
  s_load_dwordx4 s[80:83], s[0:1], 32
  s_load_dwordx2 s[84:85], s[0:1], 48
  v_lshrrev_b32 v23, 6, v0
  v_and_b32 v20, 63, v0
  v_readfirstlane_b32 s32, v23
  v_and_b32 v21, 15, v20
  v_lshrrev_b32 v22, 4, v20
  v_lshlrev_b32 v1, 4, v20
  v_add_u32 v2, 65536, v1
  s_and_b32 s33, s2, 7
  s_lshl_b32 s33, s33, 1
  s_lshr_b32 s36, s2, 7
  s_add_u32 s33, s33, s36
  s_bfe_u32 s34, s2, 262147
  s_lshl_b32 s35, s32, 12
  s_lshl_b32 s36, s32, 10
  v_add_u32 v3, s36, v1
  v_add_u32 v4, 65536, v3
  s_mul_i32 s36, s34, 129024
  s_add_u32 s36, s36, s35
  v_add_u32 v7, s36, v1
  s_lshl_b32 s36, s33, 3
  s_max_u32 s37, s36, 1
  s_sub_u32 s37, s37, 1
  s_lshl_b32 s38, s32, 1
  s_add_u32 s36, s36, s38
  v_lshlrev_b32 v23, 2, v21
  s_lshl_b32 s38, s37, 6
  v_add_u32 v8, s38, v23
  s_lshl_b32 s38, s36, 6
  v_add_u32 v9, s38, v23
  s_mul_i32 s37, s37, 18432
  v_add_u32 v5, s37, v1
  s_mul_i32 s36, s36, 18432
  v_add_u32 v6, s36, v1
  s_mov_b32 s44, 0
  s_mov_b32 s49, 18432
  s_mov_b32 s45, 4096
  s_mov_b32 s50, 22528
  s_mov_b32 s46, 8192
  s_mov_b32 s51, 26624
  s_mov_b32 s47, 12288
  s_mov_b32 s52, 30720
  s_mov_b32 s48, 16384
  s_mov_b32 s53, 34816
  s_waitcnt lgkmcnt(0)
  s_add_u32 s8, s54, 7077888
  s_addc_u32 s9, s55, 0
  s_and_b32 s9, s9, 0xffff
  s_mov_b32 s10, 2064384
  s_mov_b32 s11, 0x20000
  s_add_u32 s4, s54, 2359296
  s_addc_u32 s5, s55, 0
  s_and_b32 s5, s5, 0xffff
  s_mov_b32 s6, 2359296
  s_mov_b32 s7, 0x20000
  s_add_u32 s12, s54, 9826304
  s_addc_u32 s13, s55, 0
  s_and_b32 s13, s13, 0xffff
  s_mov_b32 s14, 8192
  s_mov_b32 s15, 0x20000
  s_add_u32 m0, s35, 0
  s_mov_b32 s40, 0
  buffer_load_dwordx4 v7, s[8:11], s40 offen lds
  buffer_load_dwordx4 v7, s[8:11], s40 offen offset:1024 lds
  buffer_load_dwordx4 v7, s[8:11], s40 offen offset:2048 lds
  buffer_load_dwordx4 v7, s[8:11], s40 offen offset:3072 lds
  buffer_load_dwordx4 a[72:75], v6, s[4:7], s44 offen
  buffer_load_dwordx4 a[144:147], v6, s[4:7], s49 offen
  buffer_load_dwordx4 a[0:3], v5, s[4:7], s44 offen
  s_add_u32 m0, s35, 16384
  s_mov_b32 s40, 16384
  buffer_load_dwordx4 v7, s[8:11], s40 offen lds
  buffer_load_dwordx4 v7, s[8:11], s40 offen offset:1024 lds
  buffer_load_dwordx4 v7, s[8:11], s40 offen offset:2048 lds
  buffer_load_dwordx4 v7, s[8:11], s40 offen offset:3072 lds
  buffer_load_dwordx4 a[76:79], v6, s[4:7], s44 offen offset:1024
  buffer_load_dwordx4 a[148:151], v6, s[4:7], s49 offen offset:1024
  buffer_load_dwordx4 a[4:7], v5, s[4:7], s44 offen offset:1024
  buffer_load_dwordx4 a[80:83], v6, s[4:7], s44 offen offset:2048
  buffer_load_dwordx4 a[152:155], v6, s[4:7], s49 offen offset:2048
  buffer_load_dwordx4 a[8:11], v5, s[4:7], s44 offen offset:2048
  buffer_load_dword v10, v9, s[12:15], 0 offen offset:64
  buffer_load_dword v8, v8, s[12:15], 0 offen
  buffer_load_dword v9, v9, s[12:15], 0 offen
  s_add_u32 s16, s54, 4718592
  s_addc_u32 s17, s55, 0
  s_and_b32 s17, s17, 0xffff
  s_mov_b32 s18, 2359296
  s_mov_b32 s19, 0x20000
  v_mul_u32_u24 v23, 240, v21
  v_lshl_add_u32 v23, v22, 3, v23
  v_add_u32 v12, 129152, v23
  s_lshl_b32 s36, s32, 5
  s_add_u32 s37, s36, 129024
  v_add_u32 v11, s37, v23
  s_mul_i32 s36, s36, 240
  s_add_u32 s36, s36, 132864
  v_add_u32 v13, s36, v23
  s_and_b32 s39, s32, 1
  s_lshr_b32 s36, s32, 1
  s_lshl_b32 s36, s36, 6
  v_add_u32 v23, s36, v20
  v_mul_u32_u24 v24, 240, v23
  s_mul_i32 s37, s39, 80
  s_add_u32 s37, s37, 129504
  v_add_u32 v14, s37, v24
  s_mul_i32 s37, s39, 36
  s_add_u32 s37, s37, 133016
  v_add_u32 v15, s37, v24
  s_lshl_b32 s37, s33, 7
  v_add_u32 v23, s37, v23
  v_cmp_le_u32 s[60:61], 2, v23
  v_cmp_le_u32 s[62:63], 4, v23
  v_cmp_le_u32 s[64:65], 6, v23
  v_cmp_le_u32 s[66:67], 8, v23
  v_cmp_le_u32 s[68:69], 10, v23
  v_cmp_le_u32 s[70:71], 12, v23
  v_cmp_le_u32 s[72:73], 14, v23
  v_lshrrev_b32 v24, 4, v23
  v_mul_u32_u24 v24, 18432, v24
  v_lshl_add_u32 v24, v21, 4, v24
  s_lshl_b32 s37, s34, 1
  s_add_u32 s37, s37, s39
  s_lshl_b32 s37, s37, 9
  v_add_u32 v16, s37, v24
  s_lshr_b32 s37, s34, 1
  s_add_u32 s37, s37, 64
  s_lshl_b32 s37, s37, 8
  s_and_b32 s38, s34, 1
  s_lshl_b32 s38, s38, 3
  s_add_u32 s37, s37, s38
  s_lshl_b32 s38, s39, 2
  s_add_u32 s37, s37, s38
  v_add_u32 v17, s37, v24
  v_mov_b32 v18, 0xceabfb8f
  s_mov_b32 s74, 0x05040100
  s_mov_b32 s75, 0x07060302
  s_mov_b32 s76, 0x3f803f80
  s_mov_b32 s20, s80
  s_and_b32 s21, s81, 0xffff
  s_mov_b32 s22, 5308416
  s_mov_b32 s23, 0x20000
  s_mov_b32 s24, s82
  s_and_b32 s25, s83, 0xffff
  s_mov_b32 s26, 5308416
  s_mov_b32 s27, 0x20000
  s_mov_b32 s28, s84
  s_and_b32 s29, s85, 0xffff
  s_mov_b32 s30, 5308416
  s_mov_b32 s31, 0x20000
  s_and_b32 s36, s2, 7
  s_and_b32 s37, s36, 3
  s_lshl_b32 s37, s37, 1
  s_lshr_b32 s36, s36, 2
  s_add_u32 s36, s36, s37
  s_lshr_b32 s37, s2, 3
  v_mul_u32_u24 v23, 7282, v0
  v_lshrrev_b32 v23, 16, v23
  v_mul_u32_u24 v24, 9, v23
  v_sub_u32 v24, v0, v24
  s_mul_i32 s38, s37, 18
  v_add_u32 v23, s38, v23
  v_mul_u32_u24 v23, 9216, v23
  v_lshl_add_u32 v23, v24, 7, v23
  s_mul_i32 s38, s36, 1152
  v_add_u32 v25, s38, v23
  s_mul_i32 s38, s36, 663552
  s_mul_i32 s37, s37, 20736
  s_add_u32 s38, s38, s37
  v_lshl_add_u32 v26, v0, 7, s38
  v_mov_b32 v23, 0x7ffffff0
  v_cmp_gt_u32 vcc, 162, v0
  s_nop 1
  v_cndmask_b32 v25, v23, v25, vcc
  v_cndmask_b32 v26, v23, v26, vcc
  s_waitcnt vmcnt(16)
  s_barrier
  ds_read_b128 v[32:35], v1
  ds_read_b128 v[36:39], v1 offset:1024
  ds_read_b128 v[40:43], v1 offset:2048
  ds_read_b128 v[44:47], v1 offset:3072
  ds_read_b128 v[48:51], v1 offset:4096
  ds_read_b128 v[52:55], v1 offset:5120
  ds_read_b128 v[56:59], v1 offset:6144
  ds_read_b128 v[60:63], v3
  s_waitcnt vmcnt(15) lgkmcnt(7)
  v_mfma_f32_16x16x32_bf16 v[96:99], v[32:35], a[72:75], 0
  ds_read_b128 v[64:67], v1 offset:7168
  s_waitcnt vmcnt(14)
  v_mfma_f32_16x16x32_bf16 v[124:127], v[32:35], a[144:147], 0
  ds_read_b128 v[68:71], v1 offset:8192
  s_waitcnt lgkmcnt(8)
  v_mfma_f32_16x16x32_bf16 v[100:103], v[36:39], a[72:75], 0
  ds_read_b128 v[72:75], v1 offset:9216
  v_mfma_f32_16x16x32_bf16 v[128:131], v[36:39], a[144:147], 0
  ds_read_b128 v[76:79], v1 offset:10240
  s_waitcnt lgkmcnt(9)
  v_mfma_f32_16x16x32_bf16 v[104:107], v[40:43], a[72:75], 0
  ds_read_b128 v[80:83], v1 offset:11264
  v_mfma_f32_16x16x32_bf16 v[132:135], v[40:43], a[144:147], 0
  ds_read_b128 v[84:87], v1 offset:12288
  s_waitcnt lgkmcnt(10)
  v_mfma_f32_16x16x32_bf16 v[108:111], v[44:47], a[72:75], 0
  ds_read_b128 v[88:91], v1 offset:13312
  v_mfma_f32_16x16x32_bf16 v[136:139], v[44:47], a[144:147], 0
  ds_read_b128 v[92:95], v3 offset:7168
  s_waitcnt lgkmcnt(11)
  v_mfma_f32_16x16x32_bf16 v[112:115], v[48:51], a[72:75], 0
  s_add_u32 m0, s35, 32768
  s_mov_b32 s40, 32768
  v_mfma_f32_16x16x32_bf16 v[140:143], v[48:51], a[144:147], 0
  buffer_load_dwordx4 v7, s[8:11], s40 offen lds
  s_waitcnt lgkmcnt(10)
  v_mfma_f32_16x16x32_bf16 v[116:119], v[52:55], a[72:75], 0
  buffer_load_dwordx4 v7, s[8:11], s40 offen offset:1024 lds
  v_mfma_f32_16x16x32_bf16 v[144:147], v[52:55], a[144:147], 0
  buffer_load_dwordx4 v7, s[8:11], s40 offen offset:2048 lds
  s_waitcnt lgkmcnt(9)
  v_mfma_f32_16x16x32_bf16 v[120:123], v[56:59], a[72:75], 0
  buffer_load_dwordx4 v7, s[8:11], s40 offen offset:3072 lds
  v_mfma_f32_16x16x32_bf16 v[148:151], v[56:59], a[144:147], 0
  buffer_load_dwordx4 a[84:87], v6, s[4:7], s44 offen offset:3072
  s_waitcnt vmcnt(18) lgkmcnt(8)
  v_mfma_f32_16x16x32_bf16 v[152:155], v[60:63], a[0:3], 0
  buffer_load_dwordx4 a[156:159], v6, s[4:7], s49 offen offset:3072
  v_mfma_f32_16x16x32_bf16 v[156:159], v[48:51], a[0:3], 0
  buffer_load_dwordx4 a[12:15], v5, s[4:7], s44 offen offset:3072
  s_waitcnt vmcnt(15) lgkmcnt(7)
  v_mfma_f32_16x16x32_bf16 v[96:99], v[64:67], a[76:79], v[96:99]
  s_barrier
  s_waitcnt vmcnt(14)
  v_mfma_f32_16x16x32_bf16 v[124:127], v[64:67], a[148:151], v[124:127]
  ds_read_b128 v[32:35], v1 offset:14336
  s_waitcnt lgkmcnt(7)
  v_mfma_f32_16x16x32_bf16 v[100:103], v[68:71], a[76:79], v[100:103]
  ds_read_b128 v[36:39], v1 offset:15360
  v_mfma_f32_16x16x32_bf16 v[128:131], v[68:71], a[148:151], v[128:131]
  ds_read_b128 v[40:43], v1 offset:16384
  s_waitcnt lgkmcnt(8)
  v_mfma_f32_16x16x32_bf16 v[104:107], v[72:75], a[76:79], v[104:107]
  ds_read_b128 v[44:47], v1 offset:17408
  v_mfma_f32_16x16x32_bf16 v[132:135], v[72:75], a[148:151], v[132:135]
  ds_read_b128 v[48:51], v1 offset:18432
  s_waitcnt lgkmcnt(9)
  v_mfma_f32_16x16x32_bf16 v[108:111], v[76:79], a[76:79], v[108:111]
  ds_read_b128 v[52:55], v1 offset:19456
  v_mfma_f32_16x16x32_bf16 v[136:139], v[76:79], a[148:151], v[136:139]
  ds_read_b128 v[56:59], v1 offset:20480
  s_waitcnt lgkmcnt(10)
  v_mfma_f32_16x16x32_bf16 v[112:115], v[80:83], a[76:79], v[112:115]
  ds_read_b128 v[60:63], v3 offset:14336
  v_mfma_f32_16x16x32_bf16 v[140:143], v[80:83], a[148:151], v[140:143]
  buffer_load_dwordx4 a[88:91], v6, s[4:7], s45 offen
  s_waitcnt lgkmcnt(10)
  v_mfma_f32_16x16x32_bf16 v[116:119], v[84:87], a[76:79], v[116:119]
  buffer_load_dwordx4 a[160:163], v6, s[4:7], s50 offen
  v_mfma_f32_16x16x32_bf16 v[144:147], v[84:87], a[148:151], v[144:147]
  buffer_load_dwordx4 a[16:19], v5, s[4:7], s45 offen
  s_waitcnt lgkmcnt(9)
  v_mfma_f32_16x16x32_bf16 v[120:123], v[88:91], a[76:79], v[120:123]
  v_mfma_f32_16x16x32_bf16 v[148:151], v[88:91], a[148:151], v[148:151]
  s_waitcnt vmcnt(16) lgkmcnt(8)
  v_mfma_f32_16x16x32_bf16 v[152:155], v[92:95], a[4:7], v[152:155]
  v_mfma_f32_16x16x32_bf16 v[156:159], v[80:83], a[4:7], v[156:159]
  s_waitcnt vmcnt(15) lgkmcnt(7)
  v_mfma_f32_16x16x32_bf16 v[96:99], v[32:35], a[80:83], v[96:99]
  ds_read_b128 v[64:67], v1 offset:21504
  s_waitcnt vmcnt(14)
  v_mfma_f32_16x16x32_bf16 v[124:127], v[32:35], a[152:155], v[124:127]
  ds_read_b128 v[68:71], v1 offset:22528
  s_waitcnt lgkmcnt(8)
  v_mfma_f32_16x16x32_bf16 v[100:103], v[36:39], a[80:83], v[100:103]
  ds_read_b128 v[72:75], v1 offset:23552
  v_mfma_f32_16x16x32_bf16 v[128:131], v[36:39], a[152:155], v[128:131]
  ds_read_b128 v[76:79], v1 offset:24576
  s_waitcnt lgkmcnt(9)
  v_mfma_f32_16x16x32_bf16 v[104:107], v[40:43], a[80:83], v[104:107]
  ds_read_b128 v[80:83], v1 offset:25600
  v_mfma_f32_16x16x32_bf16 v[132:135], v[40:43], a[152:155], v[132:135]
  ds_read_b128 v[84:87], v1 offset:26624
  s_waitcnt lgkmcnt(10)
  v_mfma_f32_16x16x32_bf16 v[108:111], v[44:47], a[80:83], v[108:111]
  ds_read_b128 v[88:91], v1 offset:27648
  v_mfma_f32_16x16x32_bf16 v[136:139], v[44:47], a[152:155], v[136:139]
  ds_read_b128 v[92:95], v3 offset:21504
  s_waitcnt lgkmcnt(11)
  v_mfma_f32_16x16x32_bf16 v[112:115], v[48:51], a[80:83], v[112:115]
  s_add_u32 m0, s35, 49152
  s_mov_b32 s40, 49152
  v_mfma_f32_16x16x32_bf16 v[140:143], v[48:51], a[152:155], v[140:143]
  buffer_load_dwordx4 v7, s[8:11], s40 offen lds
  s_waitcnt lgkmcnt(10)
  v_mfma_f32_16x16x32_bf16 v[116:119], v[52:55], a[80:83], v[116:119]
  buffer_load_dwordx4 v7, s[8:11], s40 offen offset:1024 lds
  v_mfma_f32_16x16x32_bf16 v[144:147], v[52:55], a[152:155], v[144:147]
  buffer_load_dwordx4 v7, s[8:11], s40 offen offset:2048 lds
  s_waitcnt lgkmcnt(9)
  v_mfma_f32_16x16x32_bf16 v[120:123], v[56:59], a[80:83], v[120:123]
  buffer_load_dwordx4 v7, s[8:11], s40 offen offset:3072 lds
  v_mfma_f32_16x16x32_bf16 v[148:151], v[56:59], a[152:155], v[148:151]
  buffer_load_dwordx4 a[92:95], v6, s[4:7], s45 offen offset:1024
  s_waitcnt vmcnt(18) lgkmcnt(8)
  v_mfma_f32_16x16x32_bf16 v[152:155], v[60:63], a[8:11], v[152:155]
  buffer_load_dwordx4 a[164:167], v6, s[4:7], s50 offen offset:1024
  v_mfma_f32_16x16x32_bf16 v[156:159], v[48:51], a[8:11], v[156:159]
  buffer_load_dwordx4 a[20:23], v5, s[4:7], s45 offen offset:1024
  s_waitcnt vmcnt(12) lgkmcnt(7)
  v_mfma_f32_16x16x32_bf16 v[96:99], v[64:67], a[84:87], v[96:99]
  s_barrier
  s_waitcnt vmcnt(11)
  v_mfma_f32_16x16x32_bf16 v[124:127], v[64:67], a[156:159], v[124:127]
  ds_read_b128 v[32:35], v1 offset:28672
  s_waitcnt lgkmcnt(7)
  v_mfma_f32_16x16x32_bf16 v[100:103], v[68:71], a[84:87], v[100:103]
  ds_read_b128 v[36:39], v1 offset:29696
  v_mfma_f32_16x16x32_bf16 v[128:131], v[68:71], a[156:159], v[128:131]
  ds_read_b128 v[40:43], v1 offset:30720
  s_waitcnt lgkmcnt(8)
  v_mfma_f32_16x16x32_bf16 v[104:107], v[72:75], a[84:87], v[104:107]
  ds_read_b128 v[44:47], v1 offset:31744
  v_mfma_f32_16x16x32_bf16 v[132:135], v[72:75], a[156:159], v[132:135]
  ds_read_b128 v[48:51], v1 offset:32768
  s_waitcnt lgkmcnt(9)
  v_mfma_f32_16x16x32_bf16 v[108:111], v[76:79], a[84:87], v[108:111]
  ds_read_b128 v[52:55], v1 offset:33792
  v_mfma_f32_16x16x32_bf16 v[136:139], v[76:79], a[156:159], v[136:139]
  ds_read_b128 v[56:59], v1 offset:34816
  s_waitcnt lgkmcnt(10)
  v_mfma_f32_16x16x32_bf16 v[112:115], v[80:83], a[84:87], v[112:115]
  ds_read_b128 v[60:63], v3 offset:28672
  v_mfma_f32_16x16x32_bf16 v[140:143], v[80:83], a[156:159], v[140:143]
  buffer_load_dwordx4 a[96:99], v6, s[4:7], s45 offen offset:2048
  s_waitcnt lgkmcnt(10)
  v_mfma_f32_16x16x32_bf16 v[116:119], v[84:87], a[84:87], v[116:119]
  buffer_load_dwordx4 a[168:171], v6, s[4:7], s50 offen offset:2048
  v_mfma_f32_16x16x32_bf16 v[144:147], v[84:87], a[156:159], v[144:147]
  buffer_load_dwordx4 a[24:27], v5, s[4:7], s45 offen offset:2048
  s_waitcnt lgkmcnt(9)
  v_mfma_f32_16x16x32_bf16 v[120:123], v[88:91], a[84:87], v[120:123]
  v_mfma_f32_16x16x32_bf16 v[148:151], v[88:91], a[156:159], v[148:151]
  s_waitcnt vmcnt(13) lgkmcnt(8)
  v_mfma_f32_16x16x32_bf16 v[152:155], v[92:95], a[12:15], v[152:155]
  v_mfma_f32_16x16x32_bf16 v[156:159], v[80:83], a[12:15], v[156:159]
  s_waitcnt vmcnt(12) lgkmcnt(7)
  v_mfma_f32_16x16x32_bf16 v[96:99], v[32:35], a[88:91], v[96:99]
  ds_read_b128 v[64:67], v1 offset:35840
  s_waitcnt vmcnt(11)
  v_mfma_f32_16x16x32_bf16 v[124:127], v[32:35], a[160:163], v[124:127]
  ds_read_b128 v[68:71], v1 offset:36864
  s_waitcnt lgkmcnt(8)
  v_mfma_f32_16x16x32_bf16 v[100:103], v[36:39], a[88:91], v[100:103]
  ds_read_b128 v[72:75], v1 offset:37888
  v_mfma_f32_16x16x32_bf16 v[128:131], v[36:39], a[160:163], v[128:131]
  ds_read_b128 v[76:79], v1 offset:38912
  s_waitcnt lgkmcnt(9)
  v_mfma_f32_16x16x32_bf16 v[104:107], v[40:43], a[88:91], v[104:107]
  ds_read_b128 v[80:83], v1 offset:39936
  v_mfma_f32_16x16x32_bf16 v[132:135], v[40:43], a[160:163], v[132:135]
  ds_read_b128 v[84:87], v1 offset:40960
  s_waitcnt lgkmcnt(10)
  v_mfma_f32_16x16x32_bf16 v[108:111], v[44:47], a[88:91], v[108:111]
  ds_read_b128 v[88:91], v1 offset:41984
  v_mfma_f32_16x16x32_bf16 v[136:139], v[44:47], a[160:163], v[136:139]
  ds_read_b128 v[92:95], v3 offset:35840
  s_waitcnt lgkmcnt(11)
  v_mfma_f32_16x16x32_bf16 v[112:115], v[48:51], a[88:91], v[112:115]
  buffer_load_dwordx4 a[100:103], v6, s[4:7], s45 offen offset:3072
  v_mfma_f32_16x16x32_bf16 v[140:143], v[48:51], a[160:163], v[140:143]
  buffer_load_dwordx4 a[172:175], v6, s[4:7], s50 offen offset:3072
  s_waitcnt lgkmcnt(10)
  v_mfma_f32_16x16x32_bf16 v[116:119], v[52:55], a[88:91], v[116:119]
  buffer_load_dwordx4 a[28:31], v5, s[4:7], s45 offen offset:3072
  v_mfma_f32_16x16x32_bf16 v[144:147], v[52:55], a[160:163], v[144:147]
  s_waitcnt lgkmcnt(9)
  v_mfma_f32_16x16x32_bf16 v[120:123], v[56:59], a[88:91], v[120:123]
  v_mfma_f32_16x16x32_bf16 v[148:151], v[56:59], a[160:163], v[148:151]
  s_waitcnt vmcnt(13) lgkmcnt(8)
  v_mfma_f32_16x16x32_bf16 v[152:155], v[60:63], a[16:19], v[152:155]
  v_mfma_f32_16x16x32_bf16 v[156:159], v[48:51], a[16:19], v[156:159]
  s_waitcnt vmcnt(8) lgkmcnt(7)
  v_mfma_f32_16x16x32_bf16 v[96:99], v[64:67], a[92:95], v[96:99]
  s_barrier
  s_waitcnt vmcnt(7)
  v_mfma_f32_16x16x32_bf16 v[124:127], v[64:67], a[164:167], v[124:127]
  ds_read_b128 v[32:35], v1 offset:43008
  s_waitcnt lgkmcnt(7)
  v_mfma_f32_16x16x32_bf16 v[100:103], v[68:71], a[92:95], v[100:103]
  ds_read_b128 v[36:39], v1 offset:44032
  v_mfma_f32_16x16x32_bf16 v[128:131], v[68:71], a[164:167], v[128:131]
  ds_read_b128 v[40:43], v1 offset:45056
  s_waitcnt lgkmcnt(8)
  v_mfma_f32_16x16x32_bf16 v[104:107], v[72:75], a[92:95], v[104:107]
  ds_read_b128 v[44:47], v1 offset:46080
  v_mfma_f32_16x16x32_bf16 v[132:135], v[72:75], a[164:167], v[132:135]
  ds_read_b128 v[48:51], v1 offset:47104
  s_waitcnt lgkmcnt(9)
  v_mfma_f32_16x16x32_bf16 v[108:111], v[76:79], a[92:95], v[108:111]
  ds_read_b128 v[52:55], v1 offset:48128
  v_mfma_f32_16x16x32_bf16 v[136:139], v[76:79], a[164:167], v[136:139]
  ds_read_b128 v[56:59], v1 offset:49152
  s_waitcnt lgkmcnt(10)
  v_mfma_f32_16x16x32_bf16 v[112:115], v[80:83], a[92:95], v[112:115]
  ds_read_b128 v[60:63], v3 offset:43008
  v_mfma_f32_16x16x32_bf16 v[140:143], v[80:83], a[164:167], v[140:143]
  s_add_u32 m0, s35, 65536
  s_mov_b32 s40, 65536
  s_waitcnt lgkmcnt(10)
  v_mfma_f32_16x16x32_bf16 v[116:119], v[84:87], a[92:95], v[116:119]
  buffer_load_dwordx4 v7, s[8:11], s40 offen lds
  v_mfma_f32_16x16x32_bf16 v[144:147], v[84:87], a[164:167], v[144:147]
  buffer_load_dwordx4 v7, s[8:11], s40 offen offset:1024 lds
  s_waitcnt lgkmcnt(9)
  v_mfma_f32_16x16x32_bf16 v[120:123], v[88:91], a[92:95], v[120:123]
  buffer_load_dwordx4 v7, s[8:11], s40 offen offset:2048 lds
  v_mfma_f32_16x16x32_bf16 v[148:151], v[88:91], a[164:167], v[148:151]
  buffer_load_dwordx4 v7, s[8:11], s40 offen offset:3072 lds
  s_waitcnt vmcnt(10) lgkmcnt(8)
  v_mfma_f32_16x16x32_bf16 v[152:155], v[92:95], a[20:23], v[152:155]
  buffer_load_dwordx4 a[104:107], v6, s[4:7], s46 offen
  v_mfma_f32_16x16x32_bf16 v[156:159], v[80:83], a[20:23], v[156:159]
  buffer_load_dwordx4 a[176:179], v6, s[4:7], s51 offen
  buffer_load_dwordx4 a[32:35], v5, s[4:7], s46 offen
  s_waitcnt vmcnt(12) lgkmcnt(7)
  v_mfma_f32_16x16x32_bf16 v[96:99], v[32:35], a[96:99], v[96:99]
  ds_read_b128 v[64:67], v1 offset:50176
  s_waitcnt vmcnt(11)
  v_mfma_f32_16x16x32_bf16 v[124:127], v[32:35], a[168:171], v[124:127]
  ds_read_b128 v[68:71], v1 offset:51200
  s_waitcnt lgkmcnt(8)
  v_mfma_f32_16x16x32_bf16 v[100:103], v[36:39], a[96:99], v[100:103]
  ds_read_b128 v[72:75], v1 offset:52224
  v_mfma_f32_16x16x32_bf16 v[128:131], v[36:39], a[168:171], v[128:131]
  ds_read_b128 v[76:79], v1 offset:53248
  s_waitcnt lgkmcnt(9)
  v_mfma_f32_16x16x32_bf16 v[104:107], v[40:43], a[96:99], v[104:107]
  ds_read_b128 v[80:83], v1 offset:54272
  v_mfma_f32_16x16x32_bf16 v[132:135], v[40:43], a[168:171], v[132:135]
  ds_read_b128 v[84:87], v1 offset:55296
  s_waitcnt lgkmcnt(10)
  v_mfma_f32_16x16x32_bf16 v[108:111], v[44:47], a[96:99], v[108:111]
  ds_read_b128 v[88:91], v1 offset:56320
  v_mfma_f32_16x16x32_bf16 v[136:139], v[44:47], a[168:171], v[136:139]
  ds_read_b128 v[92:95], v3 offset:50176
  s_waitcnt lgkmcnt(11)
  v_mfma_f32_16x16x32_bf16 v[112:115], v[48:51], a[96:99], v[112:115]
  buffer_load_dwordx4 a[108:111], v6, s[4:7], s46 offen offset:1024
  v_mfma_f32_16x16x32_bf16 v[140:143], v[48:51], a[168:171], v[140:143]
  buffer_load_dwordx4 a[180:183], v6, s[4:7], s51 offen offset:1024
  s_waitcnt lgkmcnt(10)
  v_mfma_f32_16x16x32_bf16 v[116:119], v[52:55], a[96:99], v[116:119]
  buffer_load_dwordx4 a[36:39], v5, s[4:7], s46 offen offset:1024
  v_mfma_f32_16x16x32_bf16 v[144:147], v[52:55], a[168:171], v[144:147]
  s_waitcnt lgkmcnt(9)
  v_mfma_f32_16x16x32_bf16 v[120:123], v[56:59], a[96:99], v[120:123]
  v_mfma_f32_16x16x32_bf16 v[148:151], v[56:59], a[168:171], v[148:151]
  s_waitcnt vmcnt(13) lgkmcnt(8)
  v_mfma_f32_16x16x32_bf16 v[152:155], v[60:63], a[24:27], v[152:155]
  v_mfma_f32_16x16x32_bf16 v[156:159], v[48:51], a[24:27], v[156:159]
  s_waitcnt vmcnt(12) lgkmcnt(7)
  v_mfma_f32_16x16x32_bf16 v[96:99], v[64:67], a[100:103], v[96:99]
  ds_read_b128 v[32:35], v1 offset:57344
  s_waitcnt vmcnt(11)
  v_mfma_f32_16x16x32_bf16 v[124:127], v[64:67], a[172:175], v[124:127]
  ds_read_b128 v[36:39], v1 offset:58368
  s_waitcnt lgkmcnt(8)
  v_mfma_f32_16x16x32_bf16 v[100:103], v[68:71], a[100:103], v[100:103]
  ds_read_b128 v[40:43], v1 offset:59392
  v_mfma_f32_16x16x32_bf16 v[128:131], v[68:71], a[172:175], v[128:131]
  ds_read_b128 v[44:47], v1 offset:60416
  s_waitcnt lgkmcnt(9)
  v_mfma_f32_16x16x32_bf16 v[104:107], v[72:75], a[100:103], v[104:107]
  ds_read_b128 v[48:51], v1 offset:61440
  v_mfma_f32_16x16x32_bf16 v[132:135], v[72:75], a[172:175], v[132:135]
  ds_read_b128 v[52:55], v1 offset:62464
  s_waitcnt lgkmcnt(10)
  v_mfma_f32_16x16x32_bf16 v[108:111], v[76:79], a[100:103], v[108:111]
  ds_read_b128 v[56:59], v1 offset:63488
  v_mfma_f32_16x16x32_bf16 v[136:139], v[76:79], a[172:175], v[136:139]
  ds_read_b128 v[60:63], v3 offset:57344
  s_waitcnt lgkmcnt(11)
  v_mfma_f32_16x16x32_bf16 v[112:115], v[80:83], a[100:103], v[112:115]
  s_add_u32 m0, s35, 81920
  s_mov_b32 s40, 81920
  v_mfma_f32_16x16x32_bf16 v[140:143], v[80:83], a[172:175], v[140:143]
  buffer_load_dwordx4 v7, s[8:11], s40 offen lds
  s_waitcnt lgkmcnt(10)
  v_mfma_f32_16x16x32_bf16 v[116:119], v[84:87], a[100:103], v[116:119]
  buffer_load_dwordx4 v7, s[8:11], s40 offen offset:1024 lds
  v_mfma_f32_16x16x32_bf16 v[144:147], v[84:87], a[172:175], v[144:147]
  buffer_load_dwordx4 v7, s[8:11], s40 offen offset:2048 lds
  s_waitcnt lgkmcnt(9)
  v_mfma_f32_16x16x32_bf16 v[120:123], v[88:91], a[100:103], v[120:123]
  buffer_load_dwordx4 v7, s[8:11], s40 offen offset:3072 lds
  v_mfma_f32_16x16x32_bf16 v[148:151], v[88:91], a[172:175], v[148:151]
  buffer_load_dwordx4 a[112:115], v6, s[4:7], s46 offen offset:2048
  s_waitcnt vmcnt(15) lgkmcnt(8)
  v_mfma_f32_16x16x32_bf16 v[152:155], v[92:95], a[28:31], v[152:155]
  buffer_load_dwordx4 a[184:187], v6, s[4:7], s51 offen offset:2048
  v_mfma_f32_16x16x32_bf16 v[156:159], v[80:83], a[28:31], v[156:159]
  buffer_load_dwordx4 a[40:43], v5, s[4:7], s46 offen offset:2048
  s_waitcnt vmcnt(12) lgkmcnt(7)
  v_mfma_f32_16x16x32_bf16 v[96:99], v[32:35], a[104:107], v[96:99]
  s_barrier
  s_waitcnt vmcnt(11)
  v_mfma_f32_16x16x32_bf16 v[124:127], v[32:35], a[176:179], v[124:127]
  ds_read_b128 v[64:67], v1 offset:64512
  s_waitcnt lgkmcnt(7)
  v_mfma_f32_16x16x32_bf16 v[100:103], v[36:39], a[104:107], v[100:103]
  ds_read_b128 v[68:71], v2
  v_mfma_f32_16x16x32_bf16 v[128:131], v[36:39], a[176:179], v[128:131]
  ds_read_b128 v[72:75], v2 offset:1024
  s_waitcnt lgkmcnt(8)
  v_mfma_f32_16x16x32_bf16 v[104:107], v[40:43], a[104:107], v[104:107]
  ds_read_b128 v[76:79], v2 offset:2048
  v_mfma_f32_16x16x32_bf16 v[132:135], v[40:43], a[176:179], v[132:135]
  ds_read_b128 v[80:83], v2 offset:3072
  s_waitcnt lgkmcnt(9)
  v_mfma_f32_16x16x32_bf16 v[108:111], v[44:47], a[104:107], v[108:111]
  ds_read_b128 v[84:87], v2 offset:4096
  v_mfma_f32_16x16x32_bf16 v[136:139], v[44:47], a[176:179], v[136:139]
  ds_read_b128 v[88:91], v2 offset:5120
  s_waitcnt lgkmcnt(10)
  v_mfma_f32_16x16x32_bf16 v[112:115], v[48:51], a[104:107], v[112:115]
  ds_read_b128 v[92:95], v3 offset:64512
  v_mfma_f32_16x16x32_bf16 v[140:143], v[48:51], a[176:179], v[140:143]
  buffer_load_dwordx4 a[116:119], v6, s[4:7], s46 offen offset:3072
  s_waitcnt lgkmcnt(10)
  v_mfma_f32_16x16x32_bf16 v[116:119], v[52:55], a[104:107], v[116:119]
  buffer_load_dwordx4 a[188:191], v6, s[4:7], s51 offen offset:3072
  v_mfma_f32_16x16x32_bf16 v[144:147], v[52:55], a[176:179], v[144:147]
  buffer_load_dwordx4 a[44:47], v5, s[4:7], s46 offen offset:3072
  s_waitcnt lgkmcnt(9)
  v_mfma_f32_16x16x32_bf16 v[120:123], v[56:59], a[104:107], v[120:123]
  v_mfma_f32_16x16x32_bf16 v[148:151], v[56:59], a[176:179], v[148:151]
  s_waitcnt vmcnt(13) lgkmcnt(8)
  v_mfma_f32_16x16x32_bf16 v[152:155], v[60:63], a[32:35], v[152:155]
  v_mfma_f32_16x16x32_bf16 v[156:159], v[48:51], a[32:35], v[156:159]
  s_waitcnt vmcnt(12) lgkmcnt(7)
  v_mfma_f32_16x16x32_bf16 v[96:99], v[64:67], a[108:111], v[96:99]
  ds_read_b128 v[32:35], v2 offset:6144
  s_waitcnt vmcnt(11)
  v_mfma_f32_16x16x32_bf16 v[124:127], v[64:67], a[180:183], v[124:127]
  ds_read_b128 v[36:39], v2 offset:7168
  s_waitcnt lgkmcnt(8)
  v_mfma_f32_16x16x32_bf16 v[100:103], v[68:71], a[108:111], v[100:103]
  ds_read_b128 v[40:43], v2 offset:8192
  v_mfma_f32_16x16x32_bf16 v[128:131], v[68:71], a[180:183], v[128:131]
  ds_read_b128 v[44:47], v2 offset:9216
  s_waitcnt lgkmcnt(9)
  v_mfma_f32_16x16x32_bf16 v[104:107], v[72:75], a[108:111], v[104:107]
  ds_read_b128 v[48:51], v2 offset:10240
  v_mfma_f32_16x16x32_bf16 v[132:135], v[72:75], a[180:183], v[132:135]
  ds_read_b128 v[52:55], v2 offset:11264
  s_waitcnt lgkmcnt(10)
  v_mfma_f32_16x16x32_bf16 v[108:111], v[76:79], a[108:111], v[108:111]
  ds_read_b128 v[56:59], v2 offset:12288
  v_mfma_f32_16x16x32_bf16 v[136:139], v[76:79], a[180:183], v[136:139]
  ds_read_b128 v[60:63], v4 offset:6144
  s_waitcnt lgkmcnt(11)
  v_mfma_f32_16x16x32_bf16 v[112:115], v[80:83], a[108:111], v[112:115]
  s_add_u32 m0, s35, 98304
  s_mov_b32 s40, 98304
  v_mfma_f32_16x16x32_bf16 v[140:143], v[80:83], a[180:183], v[140:143]
  buffer_load_dwordx4 v7, s[8:11], s40 offen lds
  s_waitcnt lgkmcnt(10)
  v_mfma_f32_16x16x32_bf16 v[116:119], v[84:87], a[108:111], v[116:119]
  buffer_load_dwordx4 v7, s[8:11], s40 offen offset:1024 lds
  v_mfma_f32_16x16x32_bf16 v[144:147], v[84:87], a[180:183], v[144:147]
  buffer_load_dwordx4 v7, s[8:11], s40 offen offset:2048 lds
  s_waitcnt lgkmcnt(9)
  v_mfma_f32_16x16x32_bf16 v[120:123], v[88:91], a[108:111], v[120:123]
  buffer_load_dwordx4 v7, s[8:11], s40 offen offset:3072 lds
  v_mfma_f32_16x16x32_bf16 v[148:151], v[88:91], a[180:183], v[148:151]
  buffer_load_dwordx4 a[120:123], v6, s[4:7], s47 offen
  s_waitcnt vmcnt(15) lgkmcnt(8)
  v_mfma_f32_16x16x32_bf16 v[152:155], v[92:95], a[36:39], v[152:155]
  buffer_load_dwordx4 a[192:195], v6, s[4:7], s52 offen
  v_mfma_f32_16x16x32_bf16 v[156:159], v[80:83], a[36:39], v[156:159]
  buffer_load_dwordx4 a[48:51], v5, s[4:7], s47 offen
  s_waitcnt vmcnt(12) lgkmcnt(7)
  v_mfma_f32_16x16x32_bf16 v[96:99], v[32:35], a[112:115], v[96:99]
  s_barrier
  s_waitcnt vmcnt(11)
  v_mfma_f32_16x16x32_bf16 v[124:127], v[32:35], a[184:187], v[124:127]
  ds_read_b128 v[64:67], v2 offset:13312
  s_waitcnt lgkmcnt(7)
  v_mfma_f32_16x16x32_bf16 v[100:103], v[36:39], a[112:115], v[100:103]
  ds_read_b128 v[68:71], v2 offset:14336
  v_mfma_f32_16x16x32_bf16 v[128:131], v[36:39], a[184:187], v[128:131]
  ds_read_b128 v[72:75], v2 offset:15360
  s_waitcnt lgkmcnt(8)
  v_mfma_f32_16x16x32_bf16 v[104:107], v[40:43], a[112:115], v[104:107]
  ds_read_b128 v[76:79], v2 offset:16384
  v_mfma_f32_16x16x32_bf16 v[132:135], v[40:43], a[184:187], v[132:135]
  ds_read_b128 v[80:83], v2 offset:17408
  s_waitcnt lgkmcnt(9)
  v_mfma_f32_16x16x32_bf16 v[108:111], v[44:47], a[112:115], v[108:111]
  ds_read_b128 v[84:87], v2 offset:18432
  v_mfma_f32_16x16x32_bf16 v[136:139], v[44:47], a[184:187], v[136:139]
  ds_read_b128 v[88:91], v2 offset:19456
  s_waitcnt lgkmcnt(10)
  v_mfma_f32_16x16x32_bf16 v[112:115], v[48:51], a[112:115], v[112:115]
  ds_read_b128 v[92:95], v4 offset:13312
  v_mfma_f32_16x16x32_bf16 v[140:143], v[48:51], a[184:187], v[140:143]
  buffer_load_dwordx4 a[124:127], v6, s[4:7], s47 offen offset:1024
  s_waitcnt lgkmcnt(10)
  v_mfma_f32_16x16x32_bf16 v[116:119], v[52:55], a[112:115], v[116:119]
  buffer_load_dwordx4 a[196:199], v6, s[4:7], s52 offen offset:1024
  v_mfma_f32_16x16x32_bf16 v[144:147], v[52:55], a[184:187], v[144:147]
  buffer_load_dwordx4 a[52:55], v5, s[4:7], s47 offen offset:1024
  s_waitcnt lgkmcnt(9)
  v_mfma_f32_16x16x32_bf16 v[120:123], v[56:59], a[112:115], v[120:123]
  v_mfma_f32_16x16x32_bf16 v[148:151], v[56:59], a[184:187], v[148:151]
  s_waitcnt vmcnt(13) lgkmcnt(8)
  v_mfma_f32_16x16x32_bf16 v[152:155], v[60:63], a[40:43], v[152:155]
  v_mfma_f32_16x16x32_bf16 v[156:159], v[48:51], a[40:43], v[156:159]
  s_waitcnt vmcnt(12) lgkmcnt(7)
  v_mfma_f32_16x16x32_bf16 v[96:99], v[64:67], a[116:119], v[96:99]
  ds_read_b128 v[32:35], v2 offset:20480
  s_waitcnt vmcnt(11)
  v_mfma_f32_16x16x32_bf16 v[124:127], v[64:67], a[188:191], v[124:127]
  ds_read_b128 v[36:39], v2 offset:21504
  s_waitcnt lgkmcnt(8)
  v_mfma_f32_16x16x32_bf16 v[100:103], v[68:71], a[116:119], v[100:103]
  ds_read_b128 v[40:43], v2 offset:22528
  v_mfma_f32_16x16x32_bf16 v[128:131], v[68:71], a[188:191], v[128:131]
  ds_read_b128 v[44:47], v2 offset:23552
  s_waitcnt lgkmcnt(9)
  v_mfma_f32_16x16x32_bf16 v[104:107], v[72:75], a[116:119], v[104:107]
  ds_read_b128 v[48:51], v2 offset:24576
  v_mfma_f32_16x16x32_bf16 v[132:135], v[72:75], a[188:191], v[132:135]
  ds_read_b128 v[52:55], v2 offset:25600
  s_waitcnt lgkmcnt(10)
  v_mfma_f32_16x16x32_bf16 v[108:111], v[76:79], a[116:119], v[108:111]
  ds_read_b128 v[56:59], v2 offset:26624
  v_mfma_f32_16x16x32_bf16 v[136:139], v[76:79], a[188:191], v[136:139]
  ds_read_b128 v[60:63], v4 offset:20480
  s_waitcnt lgkmcnt(11)
  v_mfma_f32_16x16x32_bf16 v[112:115], v[80:83], a[116:119], v[112:115]
  buffer_load_dwordx4 a[128:131], v6, s[4:7], s47 offen offset:2048
  v_mfma_f32_16x16x32_bf16 v[140:143], v[80:83], a[188:191], v[140:143]
  buffer_load_dwordx4 a[200:203], v6, s[4:7], s52 offen offset:2048
  s_waitcnt lgkmcnt(10)
  v_mfma_f32_16x16x32_bf16 v[116:119], v[84:87], a[116:119], v[116:119]
  buffer_load_dwordx4 a[56:59], v5, s[4:7], s47 offen offset:2048
  v_mfma_f32_16x16x32_bf16 v[144:147], v[84:87], a[188:191], v[144:147]
  s_waitcnt lgkmcnt(9)
  v_mfma_f32_16x16x32_bf16 v[120:123], v[88:91], a[116:119], v[120:123]
  v_mfma_f32_16x16x32_bf16 v[148:151], v[88:91], a[188:191], v[148:151]
  s_waitcnt vmcnt(13) lgkmcnt(8)
  v_mfma_f32_16x16x32_bf16 v[152:155], v[92:95], a[44:47], v[152:155]
  v_mfma_f32_16x16x32_bf16 v[156:159], v[80:83], a[44:47], v[156:159]
  s_waitcnt vmcnt(8) lgkmcnt(7)
  v_mfma_f32_16x16x32_bf16 v[96:99], v[32:35], a[120:123], v[96:99]
  s_barrier
  s_waitcnt vmcnt(7)
  v_mfma_f32_16x16x32_bf16 v[124:127], v[32:35], a[192:195], v[124:127]
  ds_read_b128 v[64:67], v2 offset:27648
  s_waitcnt lgkmcnt(7)
  v_mfma_f32_16x16x32_bf16 v[100:103], v[36:39], a[120:123], v[100:103]
  ds_read_b128 v[68:71], v2 offset:28672
  v_mfma_f32_16x16x32_bf16 v[128:131], v[36:39], a[192:195], v[128:131]
  ds_read_b128 v[72:75], v2 offset:29696
  s_waitcnt lgkmcnt(8)
  v_mfma_f32_16x16x32_bf16 v[104:107], v[40:43], a[120:123], v[104:107]
  ds_read_b128 v[76:79], v2 offset:30720
  v_mfma_f32_16x16x32_bf16 v[132:135], v[40:43], a[192:195], v[132:135]
  ds_read_b128 v[80:83], v2 offset:31744
  s_waitcnt lgkmcnt(9)
  v_mfma_f32_16x16x32_bf16 v[108:111], v[44:47], a[120:123], v[108:111]
  ds_read_b128 v[84:87], v2 offset:32768
  v_mfma_f32_16x16x32_bf16 v[136:139], v[44:47], a[192:195], v[136:139]
  ds_read_b128 v[88:91], v2 offset:33792
  s_waitcnt lgkmcnt(10)
  v_mfma_f32_16x16x32_bf16 v[112:115], v[48:51], a[120:123], v[112:115]
  ds_read_b128 v[92:95], v4 offset:27648
  v_mfma_f32_16x16x32_bf16 v[140:143], v[48:51], a[192:195], v[140:143]
  s_add_u32 m0, s35, 114688
  s_mov_b32 s40, 114688
  s_waitcnt lgkmcnt(10)
  v_mfma_f32_16x16x32_bf16 v[116:119], v[52:55], a[120:123], v[116:119]
  buffer_load_dwordx4 v7, s[8:11], s40 offen lds
  v_mfma_f32_16x16x32_bf16 v[144:147], v[52:55], a[192:195], v[144:147]
  buffer_load_dwordx4 v7, s[8:11], s40 offen offset:1024 lds
  s_waitcnt lgkmcnt(9)
  v_mfma_f32_16x16x32_bf16 v[120:123], v[56:59], a[120:123], v[120:123]
  buffer_load_dwordx4 v7, s[8:11], s40 offen offset:2048 lds
  v_mfma_f32_16x16x32_bf16 v[148:151], v[56:59], a[192:195], v[148:151]
  buffer_load_dwordx4 v7, s[8:11], s40 offen offset:3072 lds
  s_waitcnt vmcnt(10) lgkmcnt(8)
  v_mfma_f32_16x16x32_bf16 v[152:155], v[60:63], a[48:51], v[152:155]
  buffer_load_dwordx4 a[132:135], v6, s[4:7], s47 offen offset:3072
  v_mfma_f32_16x16x32_bf16 v[156:159], v[48:51], a[48:51], v[156:159]
  buffer_load_dwordx4 a[204:207], v6, s[4:7], s52 offen offset:3072
  buffer_load_dwordx4 a[60:63], v5, s[4:7], s47 offen offset:3072
  s_waitcnt vmcnt(12) lgkmcnt(7)
  v_mfma_f32_16x16x32_bf16 v[96:99], v[64:67], a[124:127], v[96:99]
  ds_read_b128 v[32:35], v2 offset:34816
  s_waitcnt vmcnt(11)
  v_mfma_f32_16x16x32_bf16 v[124:127], v[64:67], a[196:199], v[124:127]
  ds_read_b128 v[36:39], v2 offset:35840
  s_waitcnt lgkmcnt(8)
  v_mfma_f32_16x16x32_bf16 v[100:103], v[68:71], a[124:127], v[100:103]
  ds_read_b128 v[40:43], v2 offset:36864
  v_mfma_f32_16x16x32_bf16 v[128:131], v[68:71], a[196:199], v[128:131]
  ds_read_b128 v[44:47], v2 offset:37888
  s_waitcnt lgkmcnt(9)
  v_mfma_f32_16x16x32_bf16 v[104:107], v[72:75], a[124:127], v[104:107]
  ds_read_b128 v[48:51], v2 offset:38912
  v_mfma_f32_16x16x32_bf16 v[132:135], v[72:75], a[196:199], v[132:135]
  ds_read_b128 v[52:55], v2 offset:39936
  s_waitcnt lgkmcnt(10)
  v_mfma_f32_16x16x32_bf16 v[108:111], v[76:79], a[124:127], v[108:111]
  ds_read_b128 v[56:59], v2 offset:40960
  v_mfma_f32_16x16x32_bf16 v[136:139], v[76:79], a[196:199], v[136:139]
  ds_read_b128 v[60:63], v4 offset:34816
  s_waitcnt lgkmcnt(11)
  v_mfma_f32_16x16x32_bf16 v[112:115], v[80:83], a[124:127], v[112:115]
  buffer_load_dwordx4 a[136:139], v6, s[4:7], s48 offen
  v_mfma_f32_16x16x32_bf16 v[140:143], v[80:83], a[196:199], v[140:143]
  buffer_load_dwordx4 a[208:211], v6, s[4:7], s53 offen
  s_waitcnt lgkmcnt(10)
  v_mfma_f32_16x16x32_bf16 v[116:119], v[84:87], a[124:127], v[116:119]
  buffer_load_dwordx4 a[64:67], v5, s[4:7], s48 offen
  v_mfma_f32_16x16x32_bf16 v[144:147], v[84:87], a[196:199], v[144:147]
  s_waitcnt lgkmcnt(9)
  v_mfma_f32_16x16x32_bf16 v[120:123], v[88:91], a[124:127], v[120:123]
  v_mfma_f32_16x16x32_bf16 v[148:151], v[88:91], a[196:199], v[148:151]
  s_waitcnt vmcnt(13) lgkmcnt(8)
  v_mfma_f32_16x16x32_bf16 v[152:155], v[92:95], a[52:55], v[152:155]
  v_mfma_f32_16x16x32_bf16 v[156:159], v[80:83], a[52:55], v[156:159]
  s_waitcnt vmcnt(12) lgkmcnt(7)
  v_mfma_f32_16x16x32_bf16 v[96:99], v[32:35], a[128:131], v[96:99]
  ds_read_b128 v[64:67], v2 offset:41984
  s_waitcnt vmcnt(11)
  v_mfma_f32_16x16x32_bf16 v[124:127], v[32:35], a[200:203], v[124:127]
  ds_read_b128 v[68:71], v2 offset:43008
  s_waitcnt lgkmcnt(8)
  v_mfma_f32_16x16x32_bf16 v[100:103], v[36:39], a[128:131], v[100:103]
  ds_read_b128 v[72:75], v2 offset:44032
  v_mfma_f32_16x16x32_bf16 v[128:131], v[36:39], a[200:203], v[128:131]
  ds_read_b128 v[76:79], v2 offset:45056
  s_waitcnt lgkmcnt(9)
  v_mfma_f32_16x16x32_bf16 v[104:107], v[40:43], a[128:131], v[104:107]
  ds_read_b128 v[80:83], v2 offset:46080
  v_mfma_f32_16x16x32_bf16 v[132:135], v[40:43], a[200:203], v[132:135]
  ds_read_b128 v[84:87], v2 offset:47104
  s_waitcnt lgkmcnt(10)
  v_mfma_f32_16x16x32_bf16 v[108:111], v[44:47], a[128:131], v[108:111]
  ds_read_b128 v[88:91], v2 offset:48128
  v_mfma_f32_16x16x32_bf16 v[136:139], v[44:47], a[200:203], v[136:139]
  ds_read_b128 v[92:95], v4 offset:41984
  s_waitcnt lgkmcnt(11)
  v_mfma_f32_16x16x32_bf16 v[112:115], v[48:51], a[128:131], v[112:115]
  buffer_load_dwordx4 a[140:143], v6, s[4:7], s48 offen offset:1024
  v_mfma_f32_16x16x32_bf16 v[140:143], v[48:51], a[200:203], v[140:143]
  buffer_load_dwordx4 a[212:215], v6, s[4:7], s53 offen offset:1024
  s_waitcnt lgkmcnt(10)
  v_mfma_f32_16x16x32_bf16 v[116:119], v[52:55], a[128:131], v[116:119]
  buffer_load_dwordx4 a[68:71], v5, s[4:7], s48 offen offset:1024
  v_mfma_f32_16x16x32_bf16 v[144:147], v[52:55], a[200:203], v[144:147]
  s_waitcnt lgkmcnt(9)
  v_mfma_f32_16x16x32_bf16 v[120:123], v[56:59], a[128:131], v[120:123]
  v_mfma_f32_16x16x32_bf16 v[148:151], v[56:59], a[200:203], v[148:151]
  s_waitcnt vmcnt(13) lgkmcnt(8)
  v_mfma_f32_16x16x32_bf16 v[152:155], v[60:63], a[56:59], v[152:155]
  v_mfma_f32_16x16x32_bf16 v[156:159], v[48:51], a[56:59], v[156:159]
  s_waitcnt vmcnt(8) lgkmcnt(7)
  v_mfma_f32_16x16x32_bf16 v[96:99], v[64:67], a[132:135], v[96:99]
  s_barrier
  s_waitcnt vmcnt(7)
  v_mfma_f32_16x16x32_bf16 v[124:127], v[64:67], a[204:207], v[124:127]
  ds_read_b128 v[32:35], v2 offset:49152
  s_waitcnt lgkmcnt(7)
  v_mfma_f32_16x16x32_bf16 v[100:103], v[68:71], a[132:135], v[100:103]
  ds_read_b128 v[36:39], v2 offset:50176
  v_mfma_f32_16x16x32_bf16 v[128:131], v[68:71], a[204:207], v[128:131]
  ds_read_b128 v[40:43], v2 offset:51200
  s_waitcnt lgkmcnt(8)
  v_mfma_f32_16x16x32_bf16 v[104:107], v[72:75], a[132:135], v[104:107]
  ds_read_b128 v[44:47], v2 offset:52224
  v_mfma_f32_16x16x32_bf16 v[132:135], v[72:75], a[204:207], v[132:135]
  ds_read_b128 v[48:51], v2 offset:53248
  s_waitcnt lgkmcnt(9)
  v_mfma_f32_16x16x32_bf16 v[108:111], v[76:79], a[132:135], v[108:111]
  ds_read_b128 v[52:55], v2 offset:54272
  v_mfma_f32_16x16x32_bf16 v[136:139], v[76:79], a[204:207], v[136:139]
  ds_read_b128 v[56:59], v2 offset:55296
  s_waitcnt lgkmcnt(10)
  v_mfma_f32_16x16x32_bf16 v[112:115], v[80:83], a[132:135], v[112:115]
  ds_read_b128 v[60:63], v4 offset:49152
  v_mfma_f32_16x16x32_bf16 v[140:143], v[80:83], a[204:207], v[140:143]
  s_waitcnt lgkmcnt(10)
  v_mfma_f32_16x16x32_bf16 v[116:119], v[84:87], a[132:135], v[116:119]
  v_mfma_f32_16x16x32_bf16 v[144:147], v[84:87], a[204:207], v[144:147]
  s_waitcnt lgkmcnt(9)
  v_mfma_f32_16x16x32_bf16 v[120:123], v[88:91], a[132:135], v[120:123]
  v_mfma_f32_16x16x32_bf16 v[148:151], v[88:91], a[204:207], v[148:151]
  s_waitcnt vmcnt(6) lgkmcnt(8)
  v_mfma_f32_16x16x32_bf16 v[152:155], v[92:95], a[60:63], v[152:155]
  v_mfma_f32_16x16x32_bf16 v[156:159], v[80:83], a[60:63], v[156:159]
  s_waitcnt vmcnt(5) lgkmcnt(7)
  v_mfma_f32_16x16x32_bf16 v[96:99], v[32:35], a[136:139], v[96:99]
  ds_read_b128 v[64:67], v2 offset:56320
  s_waitcnt vmcnt(4)
  v_mfma_f32_16x16x32_bf16 v[124:127], v[32:35], a[208:211], v[124:127]
  ds_read_b128 v[68:71], v2 offset:57344
  s_waitcnt lgkmcnt(8)
  v_mfma_f32_16x16x32_bf16 v[100:103], v[36:39], a[136:139], v[100:103]
  ds_read_b128 v[72:75], v2 offset:58368
  v_mfma_f32_16x16x32_bf16 v[128:131], v[36:39], a[208:211], v[128:131]
  ds_read_b128 v[76:79], v2 offset:59392
  s_waitcnt lgkmcnt(9)
  v_mfma_f32_16x16x32_bf16 v[104:107], v[40:43], a[136:139], v[104:107]
  ds_read_b128 v[80:83], v2 offset:60416
  v_mfma_f32_16x16x32_bf16 v[132:135], v[40:43], a[208:211], v[132:135]
  ds_read_b128 v[84:87], v2 offset:61440
  s_waitcnt lgkmcnt(10)
  v_mfma_f32_16x16x32_bf16 v[108:111], v[44:47], a[136:139], v[108:111]
  ds_read_b128 v[88:91], v2 offset:62464
  v_mfma_f32_16x16x32_bf16 v[136:139], v[44:47], a[208:211], v[136:139]
  ds_read_b128 v[92:95], v4 offset:56320
  s_waitcnt lgkmcnt(11)
  v_mfma_f32_16x16x32_bf16 v[112:115], v[48:51], a[136:139], v[112:115]
  buffer_load_dword v27, v25, s[20:23], 0 offen
  v_mfma_f32_16x16x32_bf16 v[140:143], v[48:51], a[208:211], v[140:143]
  buffer_load_dword v28, v25, s[24:27], 0 offen
  s_waitcnt lgkmcnt(10)
  v_mfma_f32_16x16x32_bf16 v[116:119], v[52:55], a[136:139], v[116:119]
  buffer_load_dword v29, v26, s[28:31], 0 offen
  v_mfma_f32_16x16x32_bf16 v[144:147], v[52:55], a[208:211], v[144:147]
  s_waitcnt lgkmcnt(9)
  v_mfma_f32_16x16x32_bf16 v[120:123], v[56:59], a[136:139], v[120:123]
  v_mfma_f32_16x16x32_bf16 v[148:151], v[56:59], a[208:211], v[148:151]
  s_waitcnt vmcnt(6) lgkmcnt(8)
  v_mfma_f32_16x16x32_bf16 v[152:155], v[60:63], a[64:67], v[152:155]
  v_mfma_f32_16x16x32_bf16 v[156:159], v[48:51], a[64:67], v[156:159]
  s_waitcnt vmcnt(5) lgkmcnt(7)
  v_mfma_f32_16x16x32_bf16 v[96:99], v[64:67], a[140:143], v[96:99]
  s_waitcnt vmcnt(4)
  v_mfma_f32_16x16x32_bf16 v[124:127], v[64:67], a[212:215], v[124:127]
  s_waitcnt lgkmcnt(6)
  v_mfma_f32_16x16x32_bf16 v[100:103], v[68:71], a[140:143], v[100:103]
  v_mfma_f32_16x16x32_bf16 v[128:131], v[68:71], a[212:215], v[128:131]
  s_waitcnt lgkmcnt(5)
  v_mfma_f32_16x16x32_bf16 v[104:107], v[72:75], a[140:143], v[104:107]
  v_mfma_f32_16x16x32_bf16 v[132:135], v[72:75], a[212:215], v[132:135]
  s_waitcnt lgkmcnt(4)
  v_mfma_f32_16x16x32_bf16 v[108:111], v[76:79], a[140:143], v[108:111]
  v_mfma_f32_16x16x32_bf16 v[136:139], v[76:79], a[212:215], v[136:139]
  s_waitcnt lgkmcnt(3)
  v_mfma_f32_16x16x32_bf16 v[112:115], v[80:83], a[140:143], v[112:115]
  v_mfma_f32_16x16x32_bf16 v[140:143], v[80:83], a[212:215], v[140:143]
  s_waitcnt lgkmcnt(2)
  v_mfma_f32_16x16x32_bf16 v[116:119], v[84:87], a[140:143], v[116:119]
  v_mfma_f32_16x16x32_bf16 v[144:147], v[84:87], a[212:215], v[144:147]
  s_waitcnt lgkmcnt(1)
  v_mfma_f32_16x16x32_bf16 v[120:123], v[88:91], a[140:143], v[120:123]
  v_mfma_f32_16x16x32_bf16 v[148:151], v[88:91], a[212:215], v[148:151]
  s_waitcnt vmcnt(3) lgkmcnt(0)
  v_mfma_f32_16x16x32_bf16 v[152:155], v[92:95], a[68:71], v[152:155]
  v_mfma_f32_16x16x32_bf16 v[156:159], v[80:83], a[68:71], v[156:159]
  v_mul_f32 v96, v96, v9
  v_mul_f32 v97, v97, v9
  v_mul_f32 v98, v98, v9
  v_mul_f32 v99, v99, v9
  v_cvt_pk_bf16_f32 v32, v96, v97
  v_cvt_pk_bf16_f32 v33, v98, v99
  ds_write_b64 v13, v[32:33]
  v_mul_f32 v124, v124, v10
  v_mul_f32 v125, v125, v10
  v_mul_f32 v126, v126, v10
  v_mul_f32 v127, v127, v10
  v_cvt_pk_bf16_f32 v34, v124, v125
  v_cvt_pk_bf16_f32 v35, v126, v127
  ds_write_b64 v13, v[34:35] offset:3840
  v_mul_f32 v100, v100, v9
  v_mul_f32 v101, v101, v9
  v_mul_f32 v102, v102, v9
  v_mul_f32 v103, v103, v9
  v_cvt_pk_bf16_f32 v36, v100, v101
  v_cvt_pk_bf16_f32 v37, v102, v103
  ds_write_b64 v13, v[36:37] offset:32
  v_mul_f32 v128, v128, v10
  v_mul_f32 v129, v129, v10
  v_mul_f32 v130, v130, v10
  v_mul_f32 v131, v131, v10
  v_cvt_pk_bf16_f32 v38, v128, v129
  v_cvt_pk_bf16_f32 v39, v130, v131
  ds_write_b64 v13, v[38:39] offset:3872
  v_mul_f32 v104, v104, v9
  v_mul_f32 v105, v105, v9
  v_mul_f32 v106, v106, v9
  v_mul_f32 v107, v107, v9
  v_cvt_pk_bf16_f32 v32, v104, v105
  v_cvt_pk_bf16_f32 v33, v106, v107
  ds_write_b64 v13, v[32:33] offset:64
  v_mul_f32 v132, v132, v10
  v_mul_f32 v133, v133, v10
  v_mul_f32 v134, v134, v10
  v_mul_f32 v135, v135, v10
  v_cvt_pk_bf16_f32 v34, v132, v133
  v_cvt_pk_bf16_f32 v35, v134, v135
  ds_write_b64 v13, v[34:35] offset:3904
  v_mul_f32 v108, v108, v9
  v_mul_f32 v109, v109, v9
  v_mul_f32 v110, v110, v9
  v_mul_f32 v111, v111, v9
  v_cvt_pk_bf16_f32 v36, v108, v109
  v_cvt_pk_bf16_f32 v37, v110, v111
  ds_write_b64 v13, v[36:37] offset:96
  v_mul_f32 v136, v136, v10
  v_mul_f32 v137, v137, v10
  v_mul_f32 v138, v138, v10
  v_mul_f32 v139, v139, v10
  v_cvt_pk_bf16_f32 v38, v136, v137
  v_cvt_pk_bf16_f32 v39, v138, v139
  ds_write_b64 v13, v[38:39] offset:3936
  v_mul_f32 v112, v112, v9
  v_mul_f32 v113, v113, v9
  v_mul_f32 v114, v114, v9
  v_mul_f32 v115, v115, v9
  v_cvt_pk_bf16_f32 v32, v112, v113
  v_cvt_pk_bf16_f32 v33, v114, v115
  ds_write_b64 v13, v[32:33] offset:128
  v_mul_f32 v140, v140, v10
  v_mul_f32 v141, v141, v10
  v_mul_f32 v142, v142, v10
  v_mul_f32 v143, v143, v10
  v_cvt_pk_bf16_f32 v34, v140, v141
  v_cvt_pk_bf16_f32 v35, v142, v143
  ds_write_b64 v13, v[34:35] offset:3968
  v_mul_f32 v116, v116, v9
  v_mul_f32 v117, v117, v9
  v_mul_f32 v118, v118, v9
  v_mul_f32 v119, v119, v9
  v_cvt_pk_bf16_f32 v36, v116, v117
  v_cvt_pk_bf16_f32 v37, v118, v119
  ds_write_b64 v13, v[36:37] offset:160
  v_mul_f32 v144, v144, v10
  v_mul_f32 v145, v145, v10
  v_mul_f32 v146, v146, v10
  v_mul_f32 v147, v147, v10
  v_cvt_pk_bf16_f32 v38, v144, v145
  v_cvt_pk_bf16_f32 v39, v146, v147
  ds_write_b64 v13, v[38:39] offset:4000
  v_mul_f32 v120, v120, v9
  v_mul_f32 v121, v121, v9
  v_mul_f32 v122, v122, v9
  v_mul_f32 v123, v123, v9
  v_cvt_pk_bf16_f32 v32, v120, v121
  v_cvt_pk_bf16_f32 v33, v122, v123
  ds_write_b64 v13, v[32:33] offset:192
  v_mul_f32 v148, v148, v10
  v_mul_f32 v149, v149, v10
  v_mul_f32 v150, v150, v10
  v_mul_f32 v151, v151, v10
  v_cvt_pk_bf16_f32 v34, v148, v149
  v_cvt_pk_bf16_f32 v35, v150, v151
  ds_write_b64 v13, v[34:35] offset:4032
  v_mul_f32 v152, v152, v8
  v_mul_f32 v153, v153, v8
  v_mul_f32 v154, v154, v8
  v_mul_f32 v155, v155, v8
  v_cvt_pk_bf16_f32 v36, v152, v153
  v_cvt_pk_bf16_f32 v37, v154, v155
  ds_write_b64 v11, v[36:37]
  v_mul_f32 v156, v156, v8
  v_mul_f32 v157, v157, v8
  v_mul_f32 v158, v158, v8
  v_mul_f32 v159, v159, v8
  v_cvt_pk_bf16_f32 v38, v156, v157
  v_cvt_pk_bf16_f32 v39, v158, v159
  ds_write_b64 v12, v[38:39]
  s_waitcnt lgkmcnt(0)
  s_barrier
  ds_read2_b32 v[192:193], v15 offset0:0 offset1:1
  ds_read2_b32 v[194:195], v15 offset0:2 offset1:3
  ds_read2_b32 v[196:197], v15 offset0:4 offset1:5
  ds_read2_b32 v[198:199], v15 offset0:6 offset1:7
  ds_read_b32 v200, v15 offset:32
  ds_read_b128 v[32:35], v14 offset:3360
  ds_read_b128 v[36:39], v14 offset:3376
  ds_read_b128 v[40:43], v14 offset:3392
  ds_read_b128 v[52:55], v14 offset:2880
  ds_read_b128 v[56:59], v14 offset:2896
  ds_read_b128 v[60:63], v14 offset:2912
  ds_read_b128 v[72:75], v14 offset:2400
  ds_read_b128 v[76:79], v14 offset:2416
  ds_read_b128 v[80:83], v14 offset:2432
  ds_read_b128 v[92:95], v14 offset:1920
  ds_read_b128 v[96:99], v14 offset:1936
  ds_read_b128 v[100:103], v14 offset:1952
  ds_read_b128 v[112:115], v14 offset:1440
  ds_read_b128 v[116:119], v14 offset:1456
  ds_read_b128 v[120:123], v14 offset:1472
  ds_read_b128 v[132:135], v14 offset:960
  ds_read_b128 v[136:139], v14 offset:976
  ds_read_b128 v[140:143], v14 offset:992
  ds_read_b128 v[152:155], v14 offset:480
  ds_read_b128 v[156:159], v14 offset:496
  ds_read_b128 v[160:163], v14 offset:512
  ds_read_b128 v[172:175], v14
  ds_read_b128 v[176:179], v14 offset:16
  ds_read_b128 v[180:183], v14 offset:32
  s_waitcnt lgkmcnt(15)
  v_dot2_f32_bf16 v204, v192, v32, 0
  v_dot2_f32_bf16 v205, v192, v52, 0
  v_dot2_f32_bf16 v206, v192, v72, 0
  s_waitcnt lgkmcnt(14)
  v_dot2_f32_bf16 v207, v192, v92, 0
  ds_read_b128 v[44:47], v14 offset:3408
  ds_read_b64 v[48:49], v14 offset:3424
  v_dot2_f32_bf16 v204, v193, v33, v204
  v_dot2_f32_bf16 v205, v193, v53, v205
  v_dot2_f32_bf16 v206, v193, v73, v206
  v_dot2_f32_bf16 v207, v193, v93, v207
  ds_read_b128 v[64:67], v14 offset:2928
  ds_read_b64 v[68:69], v14 offset:2944
  v_dot2_f32_bf16 v204, v194, v34, v204
  v_dot2_f32_bf16 v205, v194, v54, v205
  v_dot2_f32_bf16 v206, v194, v74, v206
  v_dot2_f32_bf16 v207, v194, v94, v207
  ds_read_b128 v[84:87], v14 offset:2448
  ds_read_b64 v[88:89], v14 offset:2464
  v_dot2_f32_bf16 v204, v195, v35, v204
  v_dot2_f32_bf16 v205, v195, v55, v205
  v_dot2_f32_bf16 v206, v195, v75, v206
  v_dot2_f32_bf16 v207, v195, v95, v207
  ds_read_b128 v[104:107], v14 offset:1968
  ds_read_b64 v[108:109], v14 offset:1984
  v_dot2_f32_bf16 v204, v196, v36, v204
  v_dot2_f32_bf16 v205, v196, v56, v205
  v_dot2_f32_bf16 v206, v196, v76, v206
  s_waitcnt lgkmcnt(15)
  v_dot2_f32_bf16 v207, v196, v96, v207
  ds_read_b128 v[124:127], v14 offset:1488
  ds_read_b64 v[128:129], v14 offset:1504
  v_dot2_f32_bf16 v204, v197, v37, v204
  v_dot2_f32_bf16 v205, v197, v57, v205
  v_dot2_f32_bf16 v206, v197, v77, v206
  v_dot2_f32_bf16 v207, v197, v97, v207
  ds_read_b128 v[144:147], v14 offset:1008
  ds_read_b64 v[148:149], v14 offset:1024
  v_dot2_f32_bf16 v204, v198, v38, v204
  v_dot2_f32_bf16 v205, v198, v58, v205
  v_dot2_f32_bf16 v206, v198, v78, v206
  v_dot2_f32_bf16 v207, v198, v98, v207
  ds_read_b128 v[164:167], v14 offset:528
  ds_read_b64 v[168:169], v14 offset:544
  v_dot2_f32_bf16 v204, v199, v39, v204
  v_dot2_f32_bf16 v205, v199, v59, v205
  v_dot2_f32_bf16 v206, v199, v79, v206
  v_dot2_f32_bf16 v207, v199, v99, v207
  ds_read_b128 v[184:187], v14 offset:48
  ds_read_b64 v[188:189], v14 offset:64
  v_dot2_f32_bf16 v204, v200, v40, v204
  v_dot2_f32_bf16 v205, v200, v60, v205
  v_dot2_f32_bf16 v206, v200, v80, v206
  v_dot2_f32_bf16 v207, v200, v100, v207
  v_dot2_f32_bf16 v208, v192, v112, 0
  v_dot2_f32_bf16 v209, v192, v132, 0
  s_waitcnt lgkmcnt(15)
  v_dot2_f32_bf16 v210, v192, v152, 0
  v_dot2_f32_bf16 v211, v192, v172, 0
  v_dot2_f32_bf16 v208, v193, v113, v208
  v_dot2_f32_bf16 v209, v193, v133, v209
  v_dot2_f32_bf16 v210, v193, v153, v210
  v_dot2_f32_bf16 v211, v193, v173, v211
  v_dot2_f32_bf16 v208, v194, v114, v208
  v_dot2_f32_bf16 v209, v194, v134, v209
  v_dot2_f32_bf16 v210, v194, v154, v210
  v_dot2_f32_bf16 v211, v194, v174, v211
  v_dot2_f32_bf16 v208, v195, v115, v208
  v_dot2_f32_bf16 v209, v195, v135, v209
  v_dot2_f32_bf16 v210, v195, v155, v210
  v_dot2_f32_bf16 v211, v195, v175, v211
  v_dot2_f32_bf16 v208, v196, v116, v208
  v_dot2_f32_bf16 v209, v196, v136, v209
  v_dot2_f32_bf16 v210, v196, v156, v210
  v_dot2_f32_bf16 v211, v196, v176, v211
  v_dot2_f32_bf16 v208, v197, v117, v208
  v_dot2_f32_bf16 v209, v197, v137, v209
  v_dot2_f32_bf16 v210, v197, v157, v210
  v_dot2_f32_bf16 v211, v197, v177, v211
  v_dot2_f32_bf16 v208, v198, v118, v208
  v_dot2_f32_bf16 v209, v198, v138, v209
  v_dot2_f32_bf16 v210, v198, v158, v210
  v_dot2_f32_bf16 v211, v198, v178, v211
  v_dot2_f32_bf16 v208, v199, v119, v208
  v_dot2_f32_bf16 v209, v199, v139, v209
  v_dot2_f32_bf16 v210, v199, v159, v210
  v_dot2_f32_bf16 v211, v199, v179, v211
  v_dot2_f32_bf16 v208, v200, v120, v208
  v_dot2_f32_bf16 v209, v200, v140, v209
  v_dot2_f32_bf16 v210, v200, v160, v210
  v_dot2_f32_bf16 v211, v200, v180, v211
  v_mul_f32 v204, 0x3eae1a93, v204
  v_mul_f32 v205, 0x3eae1a93, v205
  v_mul_f32 v206, 0x3eae1a93, v206
  v_mul_f32 v207, 0x3eae1a93, v207
  v_mul_f32 v208, 0x3eae1a93, v208
  v_mul_f32 v209, 0x3eae1a93, v209
  v_mul_f32 v210, 0x3eae1a93, v210
  v_mul_f32 v211, 0x3eae1a93, v211
  v_cndmask_b32 v205, v18, v205, s[60:61]
  v_cndmask_b32 v206, v18, v206, s[62:63]
  v_cndmask_b32 v207, v18, v207, s[64:65]
  v_cndmask_b32 v208, v18, v208, s[66:67]
  v_cndmask_b32 v209, v18, v209, s[68:69]
  v_cndmask_b32 v210, v18, v210, s[70:71]
  v_cndmask_b32 v211, v18, v211, s[72:73]
  v_max3_f32 v244, v204, v205, v206
  v_max3_f32 v245, v207, v208, v209
  v_max3_f32 v244, v244, v210, v211
  v_max_f32 v244, v244, v245
  v_sub_f32 v204, v204, v244
  v_sub_f32 v205, v205, v244
  v_sub_f32 v206, v206, v244
  v_sub_f32 v207, v207, v244
  v_sub_f32 v208, v208, v244
  v_sub_f32 v209, v209, v244
  v_sub_f32 v210, v210, v244
  v_sub_f32 v211, v211, v244
  v_exp_f32 v204, v204
  v_exp_f32 v205, v205
  v_exp_f32 v206, v206
  v_exp_f32 v207, v207
  v_exp_f32 v208, v208
  v_exp_f32 v209, v209
  v_exp_f32 v210, v210
  v_exp_f32 v211, v211
  v_cvt_pk_bf16_f32 v212, v204, v205
  v_cvt_pk_bf16_f32 v213, v206, v207
  v_cvt_pk_bf16_f32 v214, v208, v209
  v_cvt_pk_bf16_f32 v215, v210, v211
  v_dot2_f32_bf16 v246, v212, s76, 0
  v_dot2_f32_bf16 v246, v213, s76, v246
  v_dot2_f32_bf16 v246, v214, s76, v246
  v_dot2_f32_bf16 v246, v215, s76, v246
  v_perm_b32 v236, v61, v41, s74
  v_perm_b32 v237, v61, v41, s75
  v_perm_b32 v238, v62, v42, s74
  v_perm_b32 v239, v62, v42, s75
  v_dot2_f32_bf16 v216, v212, v236, 0
  v_dot2_f32_bf16 v217, v212, v237, 0
  v_perm_b32 v240, v63, v43, s74
  v_perm_b32 v241, v63, v43, s75
  v_dot2_f32_bf16 v218, v212, v238, 0
  v_dot2_f32_bf16 v219, v212, v239, 0
  s_waitcnt lgkmcnt(13)
  v_perm_b32 v242, v64, v44, s74
  v_perm_b32 v243, v64, v44, s75
  v_dot2_f32_bf16 v220, v212, v240, 0
  v_dot2_f32_bf16 v221, v212, v241, 0
  v_perm_b32 v236, v65, v45, s74
  v_perm_b32 v237, v65, v45, s75
  v_dot2_f32_bf16 v222, v212, v242, 0
  v_dot2_f32_bf16 v223, v212, v243, 0
  v_perm_b32 v238, v66, v46, s74
  v_perm_b32 v239, v66, v46, s75
  v_dot2_f32_bf16 v224, v212, v236, 0
  v_dot2_f32_bf16 v225, v212, v237, 0
  v_perm_b32 v240, v67, v47, s74
  v_perm_b32 v241, v67, v47, s75
  v_dot2_f32_bf16 v226, v212, v238, 0
  v_dot2_f32_bf16 v227, v212, v239, 0
  s_waitcnt lgkmcnt(12)
  v_perm_b32 v242, v68, v48, s74
  v_perm_b32 v243, v68, v48, s75
  v_dot2_f32_bf16 v228, v212, v240, 0
  v_dot2_f32_bf16 v229, v212, v241, 0
  v_perm_b32 v236, v69, v49, s74
  v_perm_b32 v237, v69, v49, s75
  v_dot2_f32_bf16 v230, v212, v242, 0
  v_dot2_f32_bf16 v231, v212, v243, 0
  v_perm_b32 v238, v101, v81, s74
  v_perm_b32 v239, v101, v81, s75
  v_dot2_f32_bf16 v232, v212, v236, 0
  v_dot2_f32_bf16 v233, v212, v237, 0
  v_rcp_f32 v246, v246
  v_perm_b32 v240, v102, v82, s74
  v_perm_b32 v241, v102, v82, s75
  v_dot2_f32_bf16 v216, v213, v238, v216
  v_dot2_f32_bf16 v217, v213, v239, v217
  v_perm_b32 v242, v103, v83, s74
  v_perm_b32 v243, v103, v83, s75
  v_dot2_f32_bf16 v218, v213, v240, v218
  v_dot2_f32_bf16 v219, v213, v241, v219
  s_waitcnt lgkmcnt(9)
  v_perm_b32 v236, v104, v84, s74
  v_perm_b32 v237, v104, v84, s75
  v_dot2_f32_bf16 v220, v213, v242, v220
  v_dot2_f32_bf16 v221, v213, v243, v221
  v_perm_b32 v238, v105, v85, s74
  v_perm_b32 v239, v105, v85, s75
  v_dot2_f32_bf16 v222, v213, v236, v222
  v_dot2_f32_bf16 v223, v213, v237, v223
  v_perm_b32 v240, v106, v86, s74
  v_perm_b32 v241, v106, v86, s75
  v_dot2_f32_bf16 v224, v213, v238, v224
  v_dot2_f32_bf16 v225, v213, v239, v225
  v_perm_b32 v242, v107, v87, s74
  v_perm_b32 v243, v107, v87, s75
  v_dot2_f32_bf16 v226, v213, v240, v226
  v_dot2_f32_bf16 v227, v213, v241, v227
  s_waitcnt lgkmcnt(8)
  v_perm_b32 v236, v108, v88, s74
  v_perm_b32 v237, v108, v88, s75
  v_dot2_f32_bf16 v228, v213, v242, v228
  v_dot2_f32_bf16 v229, v213, v243, v229
  v_perm_b32 v238, v109, v89, s74
  v_perm_b32 v239, v109, v89, s75
  v_dot2_f32_bf16 v230, v213, v236, v230
  v_dot2_f32_bf16 v231, v213, v237, v231
  v_perm_b32 v240, v141, v121, s74
  v_perm_b32 v241, v141, v121, s75
  v_dot2_f32_bf16 v232, v213, v238, v232
  v_dot2_f32_bf16 v233, v213, v239, v233
  v_perm_b32 v242, v142, v122, s74
  v_perm_b32 v243, v142, v122, s75
  v_dot2_f32_bf16 v216, v214, v240, v216
  v_dot2_f32_bf16 v217, v214, v241, v217
  v_perm_b32 v236, v143, v123, s74
  v_perm_b32 v237, v143, v123, s75
  v_dot2_f32_bf16 v218, v214, v242, v218
  v_dot2_f32_bf16 v219, v214, v243, v219
  s_waitcnt lgkmcnt(5)
  v_perm_b32 v238, v144, v124, s74
  v_perm_b32 v239, v144, v124, s75
  v_dot2_f32_bf16 v220, v214, v236, v220
  v_dot2_f32_bf16 v221, v214, v237, v221
  v_perm_b32 v240, v145, v125, s74
  v_perm_b32 v241, v145, v125, s75
  v_dot2_f32_bf16 v222, v214, v238, v222
  v_dot2_f32_bf16 v223, v214, v239, v223
  v_perm_b32 v242, v146, v126, s74
  v_perm_b32 v243, v146, v126, s75
  v_dot2_f32_bf16 v224, v214, v240, v224
  v_dot2_f32_bf16 v225, v214, v241, v225
  v_perm_b32 v236, v147, v127, s74
  v_perm_b32 v237, v147, v127, s75
  v_dot2_f32_bf16 v226, v214, v242, v226
  v_dot2_f32_bf16 v227, v214, v243, v227
  s_waitcnt lgkmcnt(4)
  v_perm_b32 v238, v148, v128, s74
  v_perm_b32 v239, v148, v128, s75
  v_dot2_f32_bf16 v228, v214, v236, v228
  v_dot2_f32_bf16 v229, v214, v237, v229
  v_perm_b32 v240, v149, v129, s74
  v_perm_b32 v241, v149, v129, s75
  v_dot2_f32_bf16 v230, v214, v238, v230
  v_dot2_f32_bf16 v231, v214, v239, v231
  v_perm_b32 v242, v181, v161, s74
  v_perm_b32 v243, v181, v161, s75
  v_dot2_f32_bf16 v232, v214, v240, v232
  v_dot2_f32_bf16 v233, v214, v241, v233
  v_perm_b32 v236, v182, v162, s74
  v_perm_b32 v237, v182, v162, s75
  v_dot2_f32_bf16 v216, v215, v242, v216
  v_dot2_f32_bf16 v217, v215, v243, v217
  v_perm_b32 v238, v183, v163, s74
  v_perm_b32 v239, v183, v163, s75
  v_dot2_f32_bf16 v218, v215, v236, v218
  v_dot2_f32_bf16 v219, v215, v237, v219
  s_waitcnt lgkmcnt(1)
  v_perm_b32 v240, v184, v164, s74
  v_perm_b32 v241, v184, v164, s75
  v_dot2_f32_bf16 v220, v215, v238, v220
  v_dot2_f32_bf16 v221, v215, v239, v221
  v_perm_b32 v242, v185, v165, s74
  v_perm_b32 v243, v185, v165, s75
  v_dot2_f32_bf16 v222, v215, v240, v222
  v_dot2_f32_bf16 v223, v215, v241, v223
  v_perm_b32 v236, v186, v166, s74
  v_perm_b32 v237, v186, v166, s75
  v_dot2_f32_bf16 v224, v215, v242, v224
  v_dot2_f32_bf16 v225, v215, v243, v225
  v_perm_b32 v238, v187, v167, s74
  v_perm_b32 v239, v187, v167, s75
  v_dot2_f32_bf16 v226, v215, v236, v226
  v_dot2_f32_bf16 v227, v215, v237, v227
  s_waitcnt lgkmcnt(0)
  v_perm_b32 v240, v188, v168, s74
  v_perm_b32 v241, v188, v168, s75
  v_dot2_f32_bf16 v228, v215, v238, v228
  v_dot2_f32_bf16 v229, v215, v239, v229
  v_perm_b32 v242, v189, v169, s74
  v_perm_b32 v243, v189, v169, s75
  v_dot2_f32_bf16 v230, v215, v240, v230
  v_dot2_f32_bf16 v231, v215, v241, v231
  v_dot2_f32_bf16 v232, v215, v242, v232
  v_dot2_f32_bf16 v233, v215, v243, v233
  v_mul_f32 v216, v216, v246
  v_mul_f32 v217, v217, v246
  v_mul_f32 v218, v218, v246
  v_mul_f32 v219, v219, v246
  v_mul_f32 v220, v220, v246
  v_mul_f32 v221, v221, v246
  v_mul_f32 v222, v222, v246
  v_mul_f32 v223, v223, v246
  v_mul_f32 v224, v224, v246
  v_mul_f32 v225, v225, v246
  v_mul_f32 v226, v226, v246
  v_mul_f32 v227, v227, v246
  v_mul_f32 v228, v228, v246
  v_mul_f32 v229, v229, v246
  v_mul_f32 v230, v230, v246
  v_mul_f32 v231, v231, v246
  v_mul_f32 v232, v232, v246
  v_mul_f32 v233, v233, v246
  v_cvt_pk_bf16_f32 v192, v216, v217
  v_cvt_pk_bf16_f32 v193, v218, v219
  v_cvt_pk_bf16_f32 v194, v220, v221
  v_cvt_pk_bf16_f32 v195, v222, v223
  v_cvt_pk_bf16_f32 v196, v224, v225
  v_cvt_pk_bf16_f32 v197, v226, v227
  v_cvt_pk_bf16_f32 v198, v228, v229
  v_cvt_pk_bf16_f32 v199, v230, v231
  v_cvt_pk_bf16_f32 v200, v232, v233
  buffer_store_dwordx4 v[192:195], v16, s[16:19], 0 offen
  buffer_store_dwordx4 v[196:199], v16, s[16:19], 0 offen offset:256
  buffer_store_dword v200, v17, s[16:19], 0 offen
L_a1w_kernel_end:
  s_endpgm
.globl a2_kernel
.p2align 8
.type a2_kernel,@function
a2_kernel:
  s_cmp_ge_u32 s2, 256
  s_cbranch_scc1 L_a2_kernel_end
  s_load_dwordx2 s[54:55], s[0:1], 72
  v_lshrrev_b32 v23, 6, v0
  v_and_b32 v20, 63, v0
  v_readfirstlane_b32 s32, v23
  v_and_b32 v21, 15, v20
  v_lshlrev_b32 v1, 4, v20
  v_mov_b32 v25, 0x7ffffff0
  s_and_b32 s33, s2, 7
  s_lshl_b32 s33, s33, 3
  s_lshr_b32 s36, s2, 5
  s_add_u32 s33, s33, s36
  s_bfe_u32 s34, s2, 131075
  s_mul_i32 s35, s32, 9216
  s_and_b32 s60, s32, 1
  s_mul_i32 s39, s33, 36864
  s_add_u32 s36, s39, s35
  v_add_u32 v5, s36, v1
  s_mul_i32 s36, s34, 9
  s_and_b32 s37, s34, 1
  s_add_u32 s58, s36, s37
  s_xor_b32 s37, s37, 1
  s_lshl_b32 s37, s37, 3
  s_add_u32 s59, s36, s37
  s_lshl_b32 s36, s32, 1
  s_add_u32 s58, s58, s36
  s_mul_i32 s36, s58, 18432
  v_add_u32 v3, s36, v1
  s_cmp_lt_u32 s32, 2
  s_cselect_b32 s36, s59, 36
  s_cselect_b32 s38, 0, 0x7ffffff0
  s_mul_i32 s36, s36, 18432
  v_add_u32 v4, s36, v1
  s_lshl_b32 s36, s58, 9
  s_add_u32 s36, s36, s39
  v_add_u32 v6, s36, v1
  s_lshr_b32 s36, s59, 1
  s_lshl_b32 s36, s36, 10
  s_and_b32 s37, s59, 1
  s_lshl_b32 s37, s37, 3
  s_add_u32 s36, s36, s37
  s_mul_i32 s37, s60, 18432
  v_add_u32 v2, s37, v1
  s_add_u32 s36, s36, s39
  v_add_u32 v7, s36, v2
  v_or_b32 v7, s38, v7
  s_mov_b32 s44, 0
  s_mov_b32 s49, 18432
  s_mov_b32 s45, 4096
  s_mov_b32 s50, 22528
  s_mov_b32 s46, 8192
  s_mov_b32 s51, 26624
  s_mov_b32 s47, 12288
  s_mov_b32 s52, 30720
  s_mov_b32 s48, 16384
  s_mov_b32 s53, 34816
  s_waitcnt lgkmcnt(0)
  s_add_u32 s8, s54, 4718592
  s_addc_u32 s9, s55, 0
  s_and_b32 s9, s9, 0xffff
  s_mov_b32 s10, 2359296
  s_mov_b32 s11, 0x20000
  s_add_u32 s4, s54, 9142272
  s_addc_u32 s5, s55, 0
  s_and_b32 s5, s5, 0xffff
  s_mov_b32 s6, 681984
  s_mov_b32 s7, 0x20000
  s_add_u32 s12, s54, 2359296
  s_addc_u32 s13, s55, 0
  s_and_b32 s13, s13, 0xffff
  s_mov_b32 s14, 2359296
  s_mov_b32 s15, 0x20000
  s_add_u32 m0, s35, 0
  s_nop 0
  buffer_load_dwordx4 v5, s[8:11], s44 offen lds
  buffer_load_dwordx4 v5, s[8:11], s44 offen offset:1024 lds
  buffer_load_dwordx4 v5, s[8:11], s44 offen offset:2048 lds
  buffer_load_dwordx4 v5, s[8:11], s44 offen offset:3072 lds
  s_add_u32 m0, s35, 4096
  s_nop 0
  buffer_load_dwordx4 v5, s[8:11], s45 offen lds
  buffer_load_dwordx4 v5, s[8:11], s45 offen offset:1024 lds
  buffer_load_dwordx4 v5, s[8:11], s45 offen offset:2048 lds
  buffer_load_dwordx4 v5, s[8:11], s45 offen offset:3072 lds
  s_add_u32 m0, s35, 8192
  s_nop 0
  buffer_load_dwordx4 v5, s[8:11], s46 offen lds
  buffer_load_dwordx4 a[0:3], v3, s[4:7], s44 offen
  buffer_load_dwordx4 a[72:75], v3, s[4:7], s49 offen
  buffer_load_dwordx4 a[144:147], v4, s[4:7], s44 offen
  buffer_load_dwordx4 a[4:7], v3, s[4:7], s44 offen offset:1024
  buffer_load_dwordx4 a[76:79], v3, s[4:7], s49 offen offset:1024
  buffer_load_dwordx4 a[148:151], v4, s[4:7], s44 offen offset:1024
  buffer_load_dwordx4 a[8:11], v3, s[4:7], s44 offen offset:2048
  buffer_load_dwordx4 a[80:83], v3, s[4:7], s49 offen offset:2048
  buffer_load_dwordx4 a[152:155], v4, s[4:7], s44 offen offset:2048
  buffer_load_dwordx4 a[12:15], v3, s[4:7], s44 offen offset:3072
  buffer_load_dwordx4 a[84:87], v3, s[4:7], s49 offen offset:3072
  buffer_load_dwordx4 a[156:159], v4, s[4:7], s44 offen offset:3072
  s_add_u32 s16, s54, 0
  s_addc_u32 s17, s55, 0
  s_and_b32 s17, s17, 0xffff
  s_mov_b32 s18, 2359296
  s_mov_b32 s19, 0x20000
  s_add_u32 s20, s54, 9850880
  s_addc_u32 s21, s55, 0
  s_and_b32 s21, s21, 0xffff
  s_mov_b32 s22, 131072
  s_mov_b32 s23, 0x20000
  s_add_u32 s24, s54, 9842688
  s_addc_u32 s25, s55, 0
  s_and_b32 s25, s25, 0xffff
  s_mov_b32 s26, 8192
  s_mov_b32 s27, 0x20000
  v_lshlrev_b32 v23, 2, v21
  v_add_u32 v9, 36864, v23
  s_lshl_b32 s36, s60, 6
  v_add_u32 v10, s36, v9
  v_lshlrev_b32 v24, 2, v0
  v_add_u32 v24, 36992, v24
  v_and_b32 v23, 176, v0
  v_cmp_eq_u32 vcc, 128, v23
  s_nop 1
  v_cndmask_b32 v8, v24, v10, vcc
  s_lshl_b32 s36, s33, 7
  s_sub_u32 s36, s36, 36864
  v_add_u32 v24, s36, v10
  v_cndmask_b32 v11, v25, v24, vcc
  s_cmp_eq_u32 s34, 0
  s_cselect_b32 s37, 0, 0x7ffffff0
  v_or_b32 v11, s37, v11
  v_lshrrev_b32 v23, 5, v20
  v_lshl_add_u32 v23, v23, 4, v21
  v_lshlrev_b32 v23, 6, v23
  s_lshl_b32 s36, s33, 11
  s_lshl_b32 s37, s34, 4
  s_add_u32 s36, s36, s37
  s_lshl_b32 s37, s32, 2
  s_add_u32 s36, s36, s37
  v_add_u32 v12, s36, v23
  s_cmp_eq_u32 s32, 0
  s_cselect_b32 s56, 1.0, 0
  s_cmp_eq_u32 s32, 1
  s_cselect_b32 s57, 1.0, 0
  s_waitcnt vmcnt(12)
  s_barrier
  ds_read_b128 v[32:35], v1
  ds_read_b128 v[36:39], v1 offset:18432
  ds_read_b128 v[40:43], v2
  s_waitcnt vmcnt(9) lgkmcnt(0)
  v_mfma_f32_16x16x32_bf16 v[80:83], a[144:147], v[40:43], 0
  ds_read_b128 v[44:47], v1 offset:1024
  v_mfma_f32_16x16x32_bf16 v[64:67], a[0:3], v[32:35], 0
  ds_read_b128 v[48:51], v1 offset:19456
  v_mfma_f32_16x16x32_bf16 v[68:71], a[0:3], v[36:39], 0
  ds_read_b128 v[52:55], v2 offset:1024
  buffer_load_dwordx4 a[16:19], v3, s[4:7], s45 offen
  v_mfma_f32_16x16x32_bf16 v[72:75], a[72:75], v[32:35], 0
  buffer_load_dwordx4 a[88:91], v3, s[4:7], s50 offen
  v_mfma_f32_16x16x32_bf16 v[76:79], a[72:75], v[36:39], 0
  buffer_load_dwordx4 a[160:163], v4, s[4:7], s45 offen
  s_waitcnt vmcnt(9) lgkmcnt(0)
  v_mfma_f32_16x16x32_bf16 v[80:83], a[148:151], v[52:55], v[80:83]
  ds_read_b128 v[32:35], v1 offset:2048
  v_mfma_f32_16x16x32_bf16 v[64:67], a[4:7], v[44:47], v[64:67]
  ds_read_b128 v[36:39], v1 offset:20480
  v_mfma_f32_16x16x32_bf16 v[68:71], a[4:7], v[48:51], v[68:71]
  ds_read_b128 v[40:43], v2 offset:2048
  buffer_load_dwordx4 a[20:23], v3, s[4:7], s45 offen offset:1024
  v_mfma_f32_16x16x32_bf16 v[72:75], a[76:79], v[44:47], v[72:75]
  buffer_load_dwordx4 a[92:95], v3, s[4:7], s50 offen offset:1024
  v_mfma_f32_16x16x32_bf16 v[76:79], a[76:79], v[48:51], v[76:79]
  buffer_load_dwordx4 a[164:167], v4, s[4:7], s45 offen offset:1024
  s_waitcnt vmcnt(9) lgkmcnt(0)
  v_mfma_f32_16x16x32_bf16 v[80:83], a[152:155], v[40:43], v[80:83]
  ds_read_b128 v[44:47], v1 offset:3072
  v_mfma_f32_16x16x32_bf16 v[64:67], a[8:11], v[32:35], v[64:67]
  ds_read_b128 v[48:51], v1 offset:21504
  v_mfma_f32_16x16x32_bf16 v[68:71], a[8:11], v[36:39], v[68:71]
  ds_read_b128 v[52:55], v2 offset:3072
  buffer_load_dwordx4 a[24:27], v3, s[4:7], s45 offen offset:2048
  v_mfma_f32_16x16x32_bf16 v[72:75], a[80:83], v[32:35], v[72:75]
  buffer_load_dwordx4 a[96:99], v3, s[4:7], s50 offen offset:2048
  v_mfma_f32_16x16x32_bf16 v[76:79], a[80:83], v[36:39], v[76:79]
  buffer_load_dwordx4 a[168:171], v4, s[4:7], s45 offen offset:2048
  s_waitcnt vmcnt(9) lgkmcnt(0)
  v_mfma_f32_16x16x32_bf16 v[80:83], a[156:159], v[52:55], v[80:83]
  ds_read_b128 v[32:35], v1 offset:4096
  v_mfma_f32_16x16x32_bf16 v[64:67], a[12:15], v[44:47], v[64:67]
  ds_read_b128 v[36:39], v1 offset:22528
  v_mfma_f32_16x16x32_bf16 v[68:71], a[12:15], v[48:51], v[68:71]
  ds_read_b128 v[40:43], v2 offset:4096
  buffer_load_dwordx4 a[28:31], v3, s[4:7], s45 offen offset:3072
  v_mfma_f32_16x16x32_bf16 v[72:75], a[84:87], v[44:47], v[72:75]
  buffer_load_dwordx4 a[100:103], v3, s[4:7], s50 offen offset:3072
  v_mfma_f32_16x16x32_bf16 v[76:79], a[84:87], v[48:51], v[76:79]
  buffer_load_dwordx4 a[172:175], v4, s[4:7], s45 offen offset:3072
  s_waitcnt vmcnt(9) lgkmcnt(0)
  v_mfma_f32_16x16x32_bf16 v[80:83], a[160:163], v[40:43], v[80:83]
  ds_read_b128 v[44:47], v1 offset:5120
  v_mfma_f32_16x16x32_bf16 v[64:67], a[16:19], v[32:35], v[64:67]
  ds_read_b128 v[48:51], v1 offset:23552
  v_mfma_f32_16x16x32_bf16 v[68:71], a[16:19], v[36:39], v[68:71]
  ds_read_b128 v[52:55], v2 offset:5120
  buffer_load_dwordx4 a[32:35], v3, s[4:7], s46 offen
  v_mfma_f32_16x16x32_bf16 v[72:75], a[88:91], v[32:35], v[72:75]
  buffer_load_dwordx4 a[104:107], v3, s[4:7], s51 offen
  v_mfma_f32_16x16x32_bf16 v[76:79], a[88:91], v[36:39], v[76:79]
  buffer_load_dwordx4 a[176:179], v4, s[4:7], s46 offen
  s_waitcnt vmcnt(9) lgkmcnt(0)
  v_mfma_f32_16x16x32_bf16 v[80:83], a[164:167], v[52:55], v[80:83]
  ds_read_b128 v[32:35], v1 offset:6144
  v_mfma_f32_16x16x32_bf16 v[64:67], a[20:23], v[44:47], v[64:67]
  ds_read_b128 v[36:39], v1 offset:24576
  v_mfma_f32_16x16x32_bf16 v[68:71], a[20:23], v[48:51], v[68:71]
  ds_read_b128 v[40:43], v2 offset:6144
  buffer_load_dwordx4 a[36:39], v3, s[4:7], s46 offen offset:1024
  v_mfma_f32_16x16x32_bf16 v[72:75], a[92:95], v[44:47], v[72:75]
  buffer_load_dwordx4 a[108:111], v3, s[4:7], s51 offen offset:1024
  v_mfma_f32_16x16x32_bf16 v[76:79], a[92:95], v[48:51], v[76:79]
  buffer_load_dwordx4 a[180:183], v4, s[4:7], s46 offen offset:1024
  s_waitcnt vmcnt(9) lgkmcnt(0)
  v_mfma_f32_16x16x32_bf16 v[80:83], a[168:171], v[40:43], v[80:83]
  ds_read_b128 v[44:47], v1 offset:7168
  v_mfma_f32_16x16x32_bf16 v[64:67], a[24:27], v[32:35], v[64:67]
  ds_read_b128 v[48:51], v1 offset:25600
  v_mfma_f32_16x16x32_bf16 v[68:71], a[24:27], v[36:39], v[68:71]
  ds_read_b128 v[52:55], v2 offset:7168
  buffer_load_dwordx4 a[40:43], v3, s[4:7], s46 offen offset:2048
  v_mfma_f32_16x16x32_bf16 v[72:75], a[96:99], v[32:35], v[72:75]
  buffer_load_dwordx4 a[112:115], v3, s[4:7], s51 offen offset:2048
  v_mfma_f32_16x16x32_bf16 v[76:79], a[96:99], v[36:39], v[76:79]
  buffer_load_dwordx4 a[184:187], v4, s[4:7], s46 offen offset:2048
  s_waitcnt vmcnt(9) lgkmcnt(0)
  v_mfma_f32_16x16x32_bf16 v[80:83], a[172:175], v[52:55], v[80:83]
  ds_read_b128 v[32:35], v1 offset:8192
  v_mfma_f32_16x16x32_bf16 v[64:67], a[28:31], v[44:47], v[64:67]
  ds_read_b128 v[36:39], v1 offset:26624
  v_mfma_f32_16x16x32_bf16 v[68:71], a[28:31], v[48:51], v[68:71]
  ds_read_b128 v[40:43], v2 offset:8192
  buffer_load_dwordx4 a[44:47], v3, s[4:7], s46 offen offset:3072
  v_mfma_f32_16x16x32_bf16 v[72:75], a[100:103], v[44:47], v[72:75]
  buffer_load_dwordx4 a[116:119], v3, s[4:7], s51 offen offset:3072
  v_mfma_f32_16x16x32_bf16 v[76:79], a[100:103], v[48:51], v[76:79]
  buffer_load_dwordx4 a[188:191], v4, s[4:7], s46 offen offset:3072
  s_waitcnt vmcnt(9) lgkmcnt(0)
  v_mfma_f32_16x16x32_bf16 v[80:83], a[176:179], v[40:43], v[80:83]
  ds_read_b128 v[44:47], v1 offset:9216
  v_mfma_f32_16x16x32_bf16 v[64:67], a[32:35], v[32:35], v[64:67]
  ds_read_b128 v[48:51], v1 offset:27648
  v_mfma_f32_16x16x32_bf16 v[68:71], a[32:35], v[36:39], v[68:71]
  ds_read_b128 v[52:55], v2 offset:9216
  buffer_load_dwordx4 a[48:51], v3, s[4:7], s47 offen
  v_mfma_f32_16x16x32_bf16 v[72:75], a[104:107], v[32:35], v[72:75]
  buffer_load_dwordx4 a[120:123], v3, s[4:7], s52 offen
  v_mfma_f32_16x16x32_bf16 v[76:79], a[104:107], v[36:39], v[76:79]
  buffer_load_dwordx4 a[192:195], v4, s[4:7], s47 offen
  s_waitcnt vmcnt(9) lgkmcnt(0)
  v_mfma_f32_16x16x32_bf16 v[80:83], a[180:183], v[52:55], v[80:83]
  ds_read_b128 v[32:35], v1 offset:10240
  v_mfma_f32_16x16x32_bf16 v[64:67], a[36:39], v[44:47], v[64:67]
  ds_read_b128 v[36:39], v1 offset:28672
  v_mfma_f32_16x16x32_bf16 v[68:71], a[36:39], v[48:51], v[68:71]
  ds_read_b128 v[40:43], v2 offset:10240
  buffer_load_dwordx4 a[52:55], v3, s[4:7], s47 offen offset:1024
  v_mfma_f32_16x16x32_bf16 v[72:75], a[108:111], v[44:47], v[72:75]
  buffer_load_dwordx4 a[124:127], v3, s[4:7], s52 offen offset:1024
  v_mfma_f32_16x16x32_bf16 v[76:79], a[108:111], v[48:51], v[76:79]
  buffer_load_dwordx4 a[196:199], v4, s[4:7], s47 offen offset:1024
  s_waitcnt vmcnt(9) lgkmcnt(0)
  v_mfma_f32_16x16x32_bf16 v[80:83], a[184:187], v[40:43], v[80:83]
  ds_read_b128 v[44:47], v1 offset:11264
  v_mfma_f32_16x16x32_bf16 v[64:67], a[40:43], v[32:35], v[64:67]
  ds_read_b128 v[48:51], v1 offset:29696
  v_mfma_f32_16x16x32_bf16 v[68:71], a[40:43], v[36:39], v[68:71]
  ds_read_b128 v[52:55], v2 offset:11264
  buffer_load_dwordx4 a[56:59], v3, s[4:7], s47 offen offset:2048
  v_mfma_f32_16x16x32_bf16 v[72:75], a[112:115], v[32:35], v[72:75]
  buffer_load_dwordx4 a[128:131], v3, s[4:7], s52 offen offset:2048
  v_mfma_f32_16x16x32_bf16 v[76:79], a[112:115], v[36:39], v[76:79]
  buffer_load_dwordx4 a[200:203], v4, s[4:7], s47 offen offset:2048
  s_waitcnt vmcnt(9) lgkmcnt(0)
  v_mfma_f32_16x16x32_bf16 v[80:83], a[188:191], v[52:55], v[80:83]
  ds_read_b128 v[32:35], v1 offset:12288
  v_mfma_f32_16x16x32_bf16 v[64:67], a[44:47], v[44:47], v[64:67]
  ds_read_b128 v[36:39], v1 offset:30720
  v_mfma_f32_16x16x32_bf16 v[68:71], a[44:47], v[48:51], v[68:71]
  ds_read_b128 v[40:43], v2 offset:12288
  buffer_load_dwordx4 a[60:63], v3, s[4:7], s47 offen offset:3072
  v_mfma_f32_16x16x32_bf16 v[72:75], a[116:119], v[44:47], v[72:75]
  buffer_load_dwordx4 a[132:135], v3, s[4:7], s52 offen offset:3072
  v_mfma_f32_16x16x32_bf16 v[76:79], a[116:119], v[48:51], v[76:79]
  buffer_load_dwordx4 a[204:207], v4, s[4:7], s47 offen offset:3072
  s_waitcnt vmcnt(9) lgkmcnt(0)
  v_mfma_f32_16x16x32_bf16 v[80:83], a[192:195], v[40:43], v[80:83]
  ds_read_b128 v[44:47], v1 offset:13312
  v_mfma_f32_16x16x32_bf16 v[64:67], a[48:51], v[32:35], v[64:67]
  ds_read_b128 v[48:51], v1 offset:31744
  v_mfma_f32_16x16x32_bf16 v[68:71], a[48:51], v[36:39], v[68:71]
  ds_read_b128 v[52:55], v2 offset:13312
  buffer_load_dwordx4 a[64:67], v3, s[4:7], s48 offen
  v_mfma_f32_16x16x32_bf16 v[72:75], a[120:123], v[32:35], v[72:75]
  buffer_load_dwordx4 a[136:139], v3, s[4:7], s53 offen
  v_mfma_f32_16x16x32_bf16 v[76:79], a[120:123], v[36:39], v[76:79]
  buffer_load_dwordx4 a[208:211], v4, s[4:7], s48 offen
  s_waitcnt vmcnt(9) lgkmcnt(0)
  v_mfma_f32_16x16x32_bf16 v[80:83], a[196:199], v[52:55], v[80:83]
  ds_read_b128 v[32:35], v1 offset:14336
  v_mfma_f32_16x16x32_bf16 v[64:67], a[52:55], v[44:47], v[64:67]
  ds_read_b128 v[36:39], v1 offset:32768
  v_mfma_f32_16x16x32_bf16 v[68:71], a[52:55], v[48:51], v[68:71]
  ds_read_b128 v[40:43], v2 offset:14336
  buffer_load_dwordx4 a[68:71], v3, s[4:7], s48 offen offset:1024
  v_mfma_f32_16x16x32_bf16 v[72:75], a[124:127], v[44:47], v[72:75]
  buffer_load_dwordx4 a[140:143], v3, s[4:7], s53 offen offset:1024
  v_mfma_f32_16x16x32_bf16 v[76:79], a[124:127], v[48:51], v[76:79]
  buffer_load_dwordx4 a[212:215], v4, s[4:7], s48 offen offset:1024
  s_waitcnt vmcnt(9) lgkmcnt(0)
  v_mfma_f32_16x16x32_bf16 v[80:83], a[200:203], v[40:43], v[80:83]
  ds_read_b128 v[44:47], v1 offset:15360
  v_mfma_f32_16x16x32_bf16 v[64:67], a[56:59], v[32:35], v[64:67]
  ds_read_b128 v[48:51], v1 offset:33792
  v_mfma_f32_16x16x32_bf16 v[68:71], a[56:59], v[36:39], v[68:71]
  ds_read_b128 v[52:55], v2 offset:15360
  buffer_load_dwordx4 v[84:87], v6, s[12:15], 0 offen
  v_mfma_f32_16x16x32_bf16 v[72:75], a[128:131], v[32:35], v[72:75]
  buffer_load_dwordx4 v[88:91], v6, s[12:15], s49 offen
  v_mfma_f32_16x16x32_bf16 v[76:79], a[128:131], v[36:39], v[76:79]
  buffer_load_dwordx2 v[92:93], v7, s[12:15], 0 offen
  s_waitcnt vmcnt(9) lgkmcnt(0)
  v_mfma_f32_16x16x32_bf16 v[80:83], a[204:207], v[52:55], v[80:83]
  ds_read_b128 v[32:35], v1 offset:16384
  v_mfma_f32_16x16x32_bf16 v[64:67], a[60:63], v[44:47], v[64:67]
  ds_read_b128 v[36:39], v1 offset:34816
  v_mfma_f32_16x16x32_bf16 v[68:71], a[60:63], v[48:51], v[68:71]
  ds_read_b128 v[40:43], v2 offset:16384
  v_mfma_f32_16x16x32_bf16 v[72:75], a[132:135], v[44:47], v[72:75]
  v_mfma_f32_16x16x32_bf16 v[76:79], a[132:135], v[48:51], v[76:79]
  s_waitcnt vmcnt(6) lgkmcnt(0)
  v_mfma_f32_16x16x32_bf16 v[80:83], a[208:211], v[40:43], v[80:83]
  ds_read_b128 v[44:47], v1 offset:17408
  v_mfma_f32_16x16x32_bf16 v[64:67], a[64:67], v[32:35], v[64:67]
  ds_read_b128 v[48:51], v1 offset:35840
  v_mfma_f32_16x16x32_bf16 v[68:71], a[64:67], v[36:39], v[68:71]
  ds_read_b128 v[52:55], v2 offset:17408
  v_mfma_f32_16x16x32_bf16 v[72:75], a[136:139], v[32:35], v[72:75]
  v_mfma_f32_16x16x32_bf16 v[76:79], a[136:139], v[36:39], v[76:79]
  s_waitcnt vmcnt(3) lgkmcnt(0)
  v_mfma_f32_16x16x32_bf16 v[80:83], a[212:215], v[52:55], v[80:83]
  v_mfma_f32_16x16x32_bf16 v[64:67], a[68:71], v[44:47], v[64:67]
  v_mfma_f32_16x16x32_bf16 v[68:71], a[68:71], v[48:51], v[68:71]
  v_mfma_f32_16x16x32_bf16 v[72:75], a[140:143], v[44:47], v[72:75]
  v_mfma_f32_16x16x32_bf16 v[76:79], a[140:143], v[48:51], v[76:79]
  s_nop 3
  v_add_f32 v26, v80, v81
  ds_write_b32 v8, v26
  buffer_store_dword v26, v11, s[24:27], 0 offen
  s_waitcnt lgkmcnt(0)
  s_barrier
  ds_read_b32 v27, v9
  ds_read_b32 v28, v9 offset:64
  ds_read_b32 v29, v10
  s_waitcnt vmcnt(3)
  v_lshlrev_b32 v32, 16, v84
  v_and_b32 v33, 0xffff0000, v84
  v_add_f32 v64, v64, v32
  v_add_f32 v65, v65, v33
  v_lshlrev_b32 v32, 16, v85
  v_and_b32 v33, 0xffff0000, v85
  v_add_f32 v66, v66, v32
  v_add_f32 v67, v67, v33
  s_waitcnt vmcnt(2)
  v_lshlrev_b32 v32, 16, v88
  v_and_b32 v33, 0xffff0000, v88
  v_add_f32 v68, v68, v32
  v_add_f32 v69, v69, v33
  v_lshlrev_b32 v32, 16, v89
  v_and_b32 v33, 0xffff0000, v89
  v_add_f32 v70, v70, v32
  v_add_f32 v71, v71, v33
  v_lshlrev_b32 v32, 16, v86
  v_and_b32 v33, 0xffff0000, v86
  v_add_f32 v72, v72, v32
  v_add_f32 v73, v73, v33
  v_lshlrev_b32 v32, 16, v87
  v_and_b32 v33, 0xffff0000, v87
  v_add_f32 v74, v74, v32
  v_add_f32 v75, v75, v33
  v_lshlrev_b32 v32, 16, v90
  v_and_b32 v33, 0xffff0000, v90
  v_add_f32 v76, v76, v32
  v_add_f32 v77, v77, v33
  v_lshlrev_b32 v32, 16, v91
  v_and_b32 v33, 0xffff0000, v91
  v_add_f32 v78, v78, v32
  v_add_f32 v79, v79, v33
  s_waitcnt vmcnt(1)
  v_lshlrev_b32 v32, 16, v92
  v_and_b32 v33, 0xffff0000, v92
  v_add_f32 v80, v80, v32
  v_add_f32 v81, v81, v33
  v_lshlrev_b32 v32, 16, v93
  v_and_b32 v33, 0xffff0000, v93
  v_add_f32 v82, v82, v32
  v_add_f32 v83, v83, v33
  s_waitcnt lgkmcnt(2)
  v_sub_f32 v64, v64, v27
  v_sub_f32 v65, v65, v27
  v_sub_f32 v66, v66, v27
  v_sub_f32 v67, v67, v27
  s_waitcnt lgkmcnt(1)
  v_sub_f32 v68, v68, v28
  v_sub_f32 v69, v69, v28
  v_sub_f32 v70, v70, v28
  v_sub_f32 v71, v71, v28
  v_sub_f32 v72, v72, v27
  v_sub_f32 v73, v73, v27
  v_sub_f32 v74, v74, v27
  v_sub_f32 v75, v75, v27
  v_sub_f32 v76, v76, v28
  v_sub_f32 v77, v77, v28
  v_sub_f32 v78, v78, v28
  v_sub_f32 v79, v79, v28
  s_waitcnt lgkmcnt(0)
  v_sub_f32 v80, v80, v29
  v_sub_f32 v81, v81, v29
  v_sub_f32 v82, v82, v29
  v_sub_f32 v83, v83, v29
  v_cvt_pk_bf16_f32 v36, v64, v65
  v_cvt_pk_bf16_f32 v37, v66, v67
  v_cvt_pk_bf16_f32 v38, v72, v73
  v_cvt_pk_bf16_f32 v39, v74, v75
  v_cvt_pk_bf16_f32 v40, v68, v69
  v_cvt_pk_bf16_f32 v41, v70, v71
  v_cvt_pk_bf16_f32 v42, v76, v77
  v_cvt_pk_bf16_f32 v43, v78, v79
  v_cvt_pk_bf16_f32 v44, v80, v81
  v_cvt_pk_bf16_f32 v45, v82, v83
  buffer_store_dwordx4 v[36:39], v6, s[16:19], 0 offen
  buffer_store_dwordx4 v[40:43], v6, s[16:19], s49 offen
  buffer_store_dwordx2 v[44:45], v7, s[16:19], 0 offen
  v_mul_f32 v48, v64, v64
  v_mul_f32 v49, v68, v68
  v_mul_f32 v50, v80, v80
  v_fmac_f32 v48, v72, v72
  v_fmac_f32 v49, v76, v76
  v_fmac_f32 v48, v65, v65
  v_fmac_f32 v49, v69, v69
  v_fmac_f32 v50, v81, v81
  v_fmac_f32 v48, v73, v73
  v_fmac_f32 v49, v77, v77
  v_fmac_f32 v48, v66, v66
  v_fmac_f32 v49, v70, v70
  v_fmac_f32 v50, v82, v82
  v_fmac_f32 v48, v74, v74
  v_fmac_f32 v49, v78, v78
  v_fmac_f32 v48, v67, v67
  v_fmac_f32 v49, v71, v71
  v_fmac_f32 v50, v83, v83
  v_fmac_f32 v48, v75, v75
  v_fmac_f32 v49, v79, v79
  v_fmac_f32 v48, s56, v50
  v_fmac_f32 v49, s57, v50
  s_nop 1
  v_permlane32_swap_b32 v48, v49
  v_add_f32 v48, v48, v49
  v_mov_b32 v49, v48
  s_nop 1
  v_permlane16_swap_b32 v48, v49
  v_add_f32 v48, v48, v49
  buffer_store_dword v48, v12, s[20:23], 0 offen
L_a2_kernel_end:
  s_endpgm
.globl b1_kernel
.p2align 8
.type b1_kernel,@function
b1_kernel:
  s_cmp_ge_u32 s2, 256
  s_cbranch_scc1 L_b1_kernel_end
  s_load_dwordx4 s[44:47], s[0:1], 32
  s_load_dwordx2 s[48:49], s[0:1], 48
  s_load_dwordx2 s[50:51], s[0:1], 72
  v_lshrrev_b32 v4, 6, v0
  v_and_b32 v1, 63, v0
  v_readfirstlane_b32 s32, v4
  v_and_b32 v2, 15, v1
  v_lshrrev_b32 v3, 4, v1
  v_lshlrev_b32 v24, 4, v1
  s_and_b32 s36, s2, 7
  s_lshr_b32 s37, s2, 3
  s_and_b32 s39, s36, 3
  s_lshl_b32 s39, s39, 2
  s_and_b32 s38, s37, 3
  s_add_u32 s39, s39, s38
  s_lshr_b32 s40, s36, 2
  s_lshl_b32 s40, s40, 3
  s_lshr_b32 s38, s37, 2
  s_add_u32 s40, s40, s38
  s_lshl_b32 s33, s32, 10
  s_and_b32 s41, s32, 1
  s_lshr_b32 s42, s32, 1
  s_and_b32 s43, s39, 1
  v_lshrrev_b32 v4, 2, v2
  v_lshl_add_u32 v4, v3, 2, v4
  v_and_b32 v5, 3, v2
  v_lshlrev_b32 v5, 3, v5
  v_lshrrev_b32 v6, 1, v4
  v_and_b32 v6, 3, v6
  s_lshl_b32 s36, s41, 1
  s_add_u32 s37, s36, 0
  v_xor_b32 v8, s37, v6
  v_lshlrev_b32 v8, 5, v8
  v_lshl_add_u32 v8, v4, 7, v8
  v_add_u32 v8, v8, v5
  v_add_u32 v9, 65536, v8
  v_add_u32 v10, 131072, v8
  s_add_u32 s37, s36, 1
  v_xor_b32 v11, s37, v6
  v_lshlrev_b32 v11, 5, v11
  v_lshl_add_u32 v11, v4, 7, v11
  v_add_u32 v11, v11, v5
  v_add_u32 v12, 65536, v11
  v_add_u32 v13, 131072, v11
  v_and_b32 v6, 1, v3
  v_xor_b32 v6, s41, v6
  v_lshlrev_b32 v6, 5, v6
  v_lshl_add_u32 v14, v4, 6, v6
  v_add_u32 v14, v14, v5
  v_add_u32 v15, 65536, v14
  v_add_u32 v25, 131072, v14
  s_lshl_b32 s36, s42, 11
  v_add_u32 v26, s36, v24
  v_add_u32 v27, 65536, v26
  v_add_u32 v28, 131072, v26
  s_mul_i32 s36, s42, 36864
  s_add_u32 s36, s36, 90112
  v_add_u32 v16, s36, v24
  s_lshl_b32 s37, s41, 12
  v_add_u32 v17, s37, v16
  s_lshl_b32 s37, s41, 3
  v_add_u32 v18, s37, v16
  v_bfe_u32 v4, v1, 1, 2
  v_xor_b32 v4, v4, v3
  v_lshlrev_b32 v4, 5, v4
  v_and_b32 v5, 1, v1
  v_lshl_add_u32 v4, v5, 4, v4
  v_lshrrev_b32 v5, 3, v1
  s_lshl_b32 s36, s32, 3
  v_add_u32 v5, s36, v5
  s_mul_i32 s36, s39, 576
  s_lshl_b32 s37, s43, 6
  s_add_u32 s37, s36, s37
  v_mul_u32_u24 v6, 9216, v5
  v_add3_u32 v19, v6, v4, s37
  v_mul_u32_u24 v6, 1152, v5
  v_add_u32 v6, v6, v4
  s_mul_i32 s37, s39, 331776
  s_mul_i32 s38, s43, 36864
  s_add_u32 s38, s38, s37
  v_add_u32 v21, s38, v6
  s_xor_b32 s38, s43, 1
  s_mul_i32 s38, s38, 294912
  s_add_u32 s38, s38, s37
  v_add_u32 v22, s38, v6
  v_bfe_u32 v4, v1, 1, 1
  v_and_b32 v5, 1, v3
  v_xor_b32 v4, v4, v5
  v_lshlrev_b32 v4, 5, v4
  v_and_b32 v5, 1, v1
  v_lshl_add_u32 v4, v5, 4, v4
  v_lshrrev_b32 v5, 2, v1
  s_lshl_b32 s37, s41, 4
  v_add_u32 v5, s37, v5
  v_mul_u32_u24 v5, 9216, v5
  s_xor_b32 s38, s43, 1
  s_lshl_b32 s38, s38, 9
  s_add_u32 s38, s38, s36
  v_add3_u32 v20, v5, v4, s38
  s_lshl_b32 s37, s40, 1
  s_add_u32 s37, s37, s42
  s_lshl_b32 s37, s37, 2
  s_add_u32 s37, s37, s41
  s_mul_i32 s37, s37, 18432
  v_add_u32 v23, s37, v24
  s_waitcnt lgkmcnt(0)
  s_mov_b32 s4, s44
  s_and_b32 s5, s45, 0xffff
  s_mov_b32 s6, 5308416
  s_mov_b32 s7, 0x20000
  s_mov_b32 s8, s46
  s_and_b32 s9, s47, 0xffff
  s_mov_b32 s10, 5308416
  s_mov_b32 s11, 0x20000
  s_mov_b32 s12, s48
  s_and_b32 s13, s49, 0xffff
  s_mov_b32 s14, 5308416
  s_mov_b32 s15, 0x20000
  s_cmp_eq_u32 s42, 0
  s_cselect_b32 s24, s44, s46
  s_cselect_b32 s25, s5, s9
  s_mov_b32 s26, 5308416
  s_mov_b32 s27, 0x20000
  s_add_u32 s16, s50, 0
  s_addc_u32 s17, s51, 0
  s_and_b32 s17, s17, 0xffff
  s_mov_b32 s18, 2359296
  s_mov_b32 s19, 0x20000
  s_mul_i32 s36, s39, 2359296
  s_lshl_b32 s37, s40, 1
  s_add_u32 s37, s37, s42
  s_mul_i32 s37, s37, 73728
  s_add_u32 s36, s36, s37
  s_lshl_b32 s37, s41, 10
  s_add_u32 s36, s36, s37
  s_add_u32 s36, s36, 11096064
  s_add_u32 s20, s50, s36
  s_addc_u32 s21, s51, 0
  s_and_b32 s21, s21, 0xffff
  s_mov_b32 s22, 72704
  s_mov_b32 s23, 0x20000
  s_add_u32 m0, s33, 0
  s_mov_b32 s34, 0
  buffer_load_dwordx4 v23, s[16:19], s34 offen lds
  s_add_u32 m0, s33, 4096
  s_mov_b32 s34, 36864
  buffer_load_dwordx4 v23, s[16:19], s34 offen lds
  s_add_u32 m0, s33, 8192
  s_mov_b32 s34, 1024
  buffer_load_dwordx4 v23, s[16:19], s34 offen lds
  s_add_u32 m0, s33, 12288
  s_mov_b32 s34, 37888
  buffer_load_dwordx4 v23, s[16:19], s34 offen lds
  s_add_u32 m0, s33, 16384
  s_mov_b32 s34, 2048
  buffer_load_dwordx4 v23, s[16:19], s34 offen lds
  s_add_u32 m0, s33, 20480
  s_mov_b32 s34, 38912
  buffer_load_dwordx4 v23, s[16:19], s34 offen lds
  s_add_u32 m0, s33, 24576
  s_mov_b32 s34, 0
  buffer_load_dwordx4 v19, s[4:7], s34 offen lds
  s_add_u32 m0, s33, 28672
  s_mov_b32 s34, 294912
  buffer_load_dwordx4 v19, s[4:7], s34 offen lds
  s_add_u32 m0, s33, 32768
  s_mov_b32 s34, 589824
  buffer_load_dwordx4 v19, s[4:7], s34 offen lds
  s_add_u32 m0, s33, 36864
  s_mov_b32 s34, 0
  buffer_load_dwordx4 v19, s[8:11], s34 offen lds
  s_add_u32 m0, s33, 40960
  s_mov_b32 s34, 294912
  buffer_load_dwordx4 v19, s[8:11], s34 offen lds
  s_add_u32 m0, s33, 45056
  s_mov_b32 s34, 589824
  buffer_load_dwordx4 v19, s[8:11], s34 offen lds
  s_add_u32 m0, s33, 49152
  s_mov_b32 s34, 3072
  buffer_load_dwordx4 v23, s[16:19], s34 offen lds
  s_add_u32 m0, s33, 53248
  s_mov_b32 s34, 39936
  buffer_load_dwordx4 v23, s[16:19], s34 offen lds
  s_add_u32 m0, s33, 57344
  s_mov_b32 s34, 4096
  buffer_load_dwordx4 v23, s[16:19], s34 offen lds
  s_add_u32 m0, s33, 61440
  s_mov_b32 s34, 40960
  buffer_load_dwordx4 v23, s[16:19], s34 offen lds
  s_add_u32 m0, s33, 65536
  s_mov_b32 s34, 5120
  buffer_load_dwordx4 v23, s[16:19], s34 offen lds
  s_add_u32 m0, s33, 69632
  s_mov_b32 s34, 41984
  buffer_load_dwordx4 v23, s[16:19], s34 offen lds
  s_add_u32 m0, s33, 73728
  s_mov_b32 s34, 884736
  buffer_load_dwordx4 v19, s[4:7], s34 offen lds
  s_add_u32 m0, s33, 77824
  s_mov_b32 s34, 1179648
  buffer_load_dwordx4 v19, s[4:7], s34 offen lds
  s_add_u32 m0, s33, 81920
  s_mov_b32 s34, 1474560
  buffer_load_dwordx4 v19, s[4:7], s34 offen lds
  s_add_u32 m0, s33, 86016
  s_mov_b32 s34, 884736
  buffer_load_dwordx4 v19, s[8:11], s34 offen lds
  s_waitcnt vmcnt(13)
  s_barrier
  ds_read_b64_tr_b16 v[56:57], v8 offset:24576
  ds_read_b64_tr_b16 v[58:59], v8 offset:26624
  ds_read_b64_tr_b16 v[60:61], v8 offset:28672
  ds_read_b64_tr_b16 v[62:63], v8 offset:30720
  ds_read_b64_tr_b16 v[64:65], v8 offset:32768
  ds_read_b64_tr_b16 v[66:67], v8 offset:34816
  ds_read_b128 a[0:3], v26
  ds_read_b128 a[4:7], v26 offset:1024
  ds_read_b128 a[8:11], v26 offset:4096
  ds_read_b128 a[12:15], v26 offset:5120
  ds_read_b128 a[16:19], v26 offset:8192
  ds_read_b128 a[20:23], v26 offset:9216
  ds_read_b128 a[24:27], v26 offset:12288
  ds_read_b128 a[28:31], v26 offset:13312
  ds_read_b128 a[32:35], v26 offset:16384
  ds_read_b128 a[36:39], v26 offset:17408
  ds_read_b128 a[40:43], v26 offset:20480
  ds_read_b128 a[44:47], v26 offset:21504
  ds_read_b64_tr_b16 v[68:69], v11 offset:24576
  ds_read_b64_tr_b16 v[70:71], v11 offset:26624
  ds_read_b64_tr_b16 v[72:73], v11 offset:28672
  ds_read_b64_tr_b16 v[74:75], v11 offset:30720
  ds_read_b64_tr_b16 v[76:77], v11 offset:32768
  ds_read_b64_tr_b16 v[78:79], v11 offset:34816
  s_waitcnt lgkmcnt(15)
  v_mfma_f32_16x16x32_bf16 v[128:131], v[56:59], a[0:3], 0
  s_waitcnt vmcnt(8)
  s_barrier
  s_waitcnt lgkmcnt(13)
  v_mfma_f32_16x16x32_bf16 v[128:131], v[60:63], a[16:19], v[128:131]
  ds_read_b64_tr_b16 v[80:81], v8 offset:36864
  s_add_u32 m0, s33, 90112
  s_waitcnt lgkmcnt(10)
  v_mfma_f32_16x16x32_bf16 v[128:131], v[64:67], a[32:35], v[128:131]
  ds_read_b64_tr_b16 v[82:83], v8 offset:38912
  s_mov_b32 s34, 1179648
  v_mfma_f32_16x16x32_bf16 v[132:135], v[56:59], a[4:7], 0
  ds_read_b64_tr_b16 v[84:85], v8 offset:40960
  buffer_load_dwordx4 v19, s[8:11], s34 offen lds
  v_mfma_f32_16x16x32_bf16 v[132:135], v[60:63], a[20:23], v[132:135]
  ds_read_b64_tr_b16 v[86:87], v8 offset:43008
  s_add_u32 m0, s33, 94208
  s_waitcnt lgkmcnt(12)
  v_mfma_f32_16x16x32_bf16 v[132:135], v[64:67], a[36:39], v[132:135]
  ds_read_b64_tr_b16 v[88:89], v8 offset:45056
  s_mov_b32 s34, 1474560
  v_mfma_f32_16x16x32_bf16 v[136:139], v[56:59], a[8:11], 0
  ds_read_b64_tr_b16 v[90:91], v8 offset:47104
  buffer_load_dwordx4 v19, s[8:11], s34 offen lds
  v_mfma_f32_16x16x32_bf16 v[136:139], v[60:63], a[24:27], v[136:139]
  s_add_u32 m0, s33, 98304
  s_waitcnt lgkmcnt(13)
  v_mfma_f32_16x16x32_bf16 v[136:139], v[64:67], a[40:43], v[136:139]
  s_mov_b32 s34, 6144
  v_mfma_f32_16x16x32_bf16 v[140:143], v[56:59], a[12:15], 0
  buffer_load_dwordx4 v23, s[16:19], s34 offen lds
  v_mfma_f32_16x16x32_bf16 v[140:143], v[60:63], a[28:31], v[140:143]
  s_add_u32 m0, s33, 102400
  s_waitcnt lgkmcnt(12)
  v_mfma_f32_16x16x32_bf16 v[140:143], v[64:67], a[44:47], v[140:143]
  s_mov_b32 s34, 43008
  buffer_load_dwordx4 v23, s[16:19], s34 offen lds
  s_waitcnt lgkmcnt(6)
  v_mfma_f32_16x16x32_bf16 v[144:147], v[68:71], a[0:3], 0
  ds_read_b64_tr_b16 v[56:57], v11 offset:36864
  s_add_u32 m0, s33, 106496
  v_mfma_f32_16x16x32_bf16 v[144:147], v[72:75], a[16:19], v[144:147]
  ds_read_b64_tr_b16 v[58:59], v11 offset:38912
  s_mov_b32 s34, 7168
  v_mfma_f32_16x16x32_bf16 v[144:147], v[76:79], a[32:35], v[144:147]
  ds_read_b64_tr_b16 v[60:61], v11 offset:40960
  buffer_load_dwordx4 v23, s[16:19], s34 offen lds
  v_mfma_f32_16x16x32_bf16 v[148:151], v[68:71], a[4:7], 0
  ds_read_b64_tr_b16 v[62:63], v11 offset:43008
  s_add_u32 m0, s33, 110592
  v_mfma_f32_16x16x32_bf16 v[148:151], v[72:75], a[20:23], v[148:151]
  ds_read_b64_tr_b16 v[64:65], v11 offset:45056
  s_mov_b32 s34, 44032
  v_mfma_f32_16x16x32_bf16 v[148:151], v[76:79], a[36:39], v[148:151]
  ds_read_b64_tr_b16 v[66:67], v11 offset:47104
  buffer_load_dwordx4 v23, s[16:19], s34 offen lds
  v_mfma_f32_16x16x32_bf16 v[152:155], v[68:71], a[8:11], 0
  ds_read_b128 a[48:51], v26 offset:49152
  s_add_u32 m0, s33, 114688
  v_mfma_f32_16x16x32_bf16 v[152:155], v[72:75], a[24:27], v[152:155]
  ds_read_b128 a[52:55], v26 offset:50176
  s_mov_b32 s34, 8192
  v_mfma_f32_16x16x32_bf16 v[152:155], v[76:79], a[40:43], v[152:155]
  ds_read_b128 a[56:59], v26 offset:53248
  buffer_load_dwordx4 v23, s[16:19], s34 offen lds
  v_mfma_f32_16x16x32_bf16 v[156:159], v[68:71], a[12:15], 0
  ds_read_b128 a[60:63], v26 offset:54272
  s_add_u32 m0, s33, 118784
  v_mfma_f32_16x16x32_bf16 v[156:159], v[72:75], a[28:31], v[156:159]
  s_mov_b32 s34, 45056
  v_mfma_f32_16x16x32_bf16 v[156:159], v[76:79], a[44:47], v[156:159]
  buffer_load_dwordx4 v23, s[16:19], s34 offen lds
  s_waitcnt lgkmcnt(10)
  v_mfma_f32_16x16x32_bf16 v[160:163], v[80:83], a[0:3], 0
  s_waitcnt vmcnt(9)
  s_barrier
  v_mfma_f32_16x16x32_bf16 v[160:163], v[84:87], a[16:19], v[160:163]
  ds_read_b64_tr_b16 v[68:69], v9 offset:8192
  s_add_u32 m0, s33, 122880
  v_mfma_f32_16x16x32_bf16 v[160:163], v[88:91], a[32:35], v[160:163]
  ds_read_b64_tr_b16 v[70:71], v9 offset:10240
  s_mov_b32 s34, 1769472
  v_mfma_f32_16x16x32_bf16 v[164:167], v[80:83], a[4:7], 0
  ds_read_b64_tr_b16 v[72:73], v9 offset:12288
  buffer_load_dwordx4 v19, s[4:7], s34 offen lds
  v_mfma_f32_16x16x32_bf16 v[164:167], v[84:87], a[20:23], v[164:167]
  ds_read_b64_tr_b16 v[74:75], v9 offset:14336
  s_add_u32 m0, s33, 126976
  v_mfma_f32_16x16x32_bf16 v[164:167], v[88:91], a[36:39], v[164:167]
  ds_read_b64_tr_b16 v[76:77], v9 offset:16384
  s_mov_b32 s34, 2064384
  v_mfma_f32_16x16x32_bf16 v[168:171], v[80:83], a[8:11], 0
  ds_read_b64_tr_b16 v[78:79], v9 offset:18432
  buffer_load_dwordx4 v19, s[4:7], s34 offen lds
  v_mfma_f32_16x16x32_bf16 v[168:171], v[84:87], a[24:27], v[168:171]
  ds_read_b128 a[64:67], v26 offset:57344
  s_add_u32 m0, s33, 131072
  v_mfma_f32_16x16x32_bf16 v[168:171], v[88:91], a[40:43], v[168:171]
  ds_read_b128 a[68:71], v26 offset:58368
  s_mov_b32 s34, 2359296
  v_mfma_f32_16x16x32_bf16 v[172:175], v[80:83], a[12:15], 0
  ds_read_b128 a[72:75], v26 offset:61440
  buffer_load_dwordx4 v19, s[4:7], s34 offen lds
  v_mfma_f32_16x16x32_bf16 v[172:175], v[84:87], a[28:31], v[172:175]
  ds_read_b128 a[76:79], v26 offset:62464
  s_add_u32 m0, s33, 135168
  v_mfma_f32_16x16x32_bf16 v[172:175], v[88:91], a[44:47], v[172:175]
  s_mov_b32 s34, 1769472
  buffer_load_dwordx4 v19, s[8:11], s34 offen lds
  s_waitcnt lgkmcnt(14)
  v_mfma_f32_16x16x32_bf16 v[176:179], v[56:59], a[0:3], 0
  ds_read_b64_tr_b16 v[80:81], v12 offset:8192
  s_add_u32 m0, s33, 139264
  v_mfma_f32_16x16x32_bf16 v[176:179], v[60:63], a[16:19], v[176:179]
  ds_read_b64_tr_b16 v[82:83], v12 offset:10240
  s_mov_b32 s34, 2064384
  v_mfma_f32_16x16x32_bf16 v[176:179], v[64:67], a[32:35], v[176:179]
  ds_read_b64_tr_b16 v[84:85], v12 offset:12288
  buffer_load_dwordx4 v19, s[8:11], s34 offen lds
  v_mfma_f32_16x16x32_bf16 v[180:183], v[56:59], a[4:7], 0
  ds_read_b64_tr_b16 v[86:87], v12 offset:14336
  s_add_u32 m0, s33, 143360
  v_mfma_f32_16x16x32_bf16 v[180:183], v[60:63], a[20:23], v[180:183]
  ds_read_b64_tr_b16 v[88:89], v12 offset:16384
  s_mov_b32 s34, 2359296
  v_mfma_f32_16x16x32_bf16 v[180:183], v[64:67], a[36:39], v[180:183]
  ds_read_b64_tr_b16 v[90:91], v12 offset:18432
  buffer_load_dwordx4 v19, s[8:11], s34 offen lds
  v_mfma_f32_16x16x32_bf16 v[184:187], v[56:59], a[8:11], 0
  ds_read_b128 a[80:83], v27
  s_add_u32 m0, s33, 147456
  v_mfma_f32_16x16x32_bf16 v[184:187], v[60:63], a[24:27], v[184:187]
  ds_read_b128 a[84:87], v27 offset:1024
  s_mov_b32 s34, 9216
  v_mfma_f32_16x16x32_bf16 v[184:187], v[64:67], a[40:43], v[184:187]
  ds_read_b128 a[88:91], v27 offset:4096
  buffer_load_dwordx4 v23, s[16:19], s34 offen lds
  v_mfma_f32_16x16x32_bf16 v[188:191], v[56:59], a[12:15], 0
  ds_read_b128 a[92:95], v27 offset:5120
  s_add_u32 m0, s33, 151552
  v_mfma_f32_16x16x32_bf16 v[188:191], v[60:63], a[28:31], v[188:191]
  s_mov_b32 s34, 46080
  v_mfma_f32_16x16x32_bf16 v[188:191], v[64:67], a[44:47], v[188:191]
  buffer_load_dwordx4 v23, s[16:19], s34 offen lds
  s_waitcnt lgkmcnt(14)
  v_mfma_f32_16x16x32_bf16 v[128:131], v[68:71], a[48:51], v[128:131]
  s_waitcnt vmcnt(12)
  s_barrier
  s_waitcnt lgkmcnt(13)
  v_mfma_f32_16x16x32_bf16 v[128:131], v[72:75], a[64:67], v[128:131]
  ds_read_b64_tr_b16 v[56:57], v9 offset:20480
  s_add_u32 m0, s33, 155648
  s_waitcnt lgkmcnt(4)
  v_mfma_f32_16x16x32_bf16 v[128:131], v[76:79], a[80:83], v[128:131]
  ds_read_b64_tr_b16 v[58:59], v9 offset:22528
  s_mov_b32 s34, 10240
  v_mfma_f32_16x16x32_bf16 v[132:135], v[68:71], a[52:55], v[132:135]
  ds_read_b64_tr_b16 v[60:61], v9 offset:24576
  buffer_load_dwordx4 v23, s[16:19], s34 offen lds
  v_mfma_f32_16x16x32_bf16 v[132:135], v[72:75], a[68:71], v[132:135]
  ds_read_b64_tr_b16 v[62:63], v9 offset:26624
  s_add_u32 m0, s33, 159744
  s_waitcnt lgkmcnt(6)
  v_mfma_f32_16x16x32_bf16 v[132:135], v[76:79], a[84:87], v[132:135]
  ds_read_b64_tr_b16 v[64:65], v9 offset:28672
  s_mov_b32 s34, 47104
  v_mfma_f32_16x16x32_bf16 v[136:139], v[68:71], a[56:59], v[136:139]
  ds_read_b64_tr_b16 v[66:67], v9 offset:30720
  buffer_load_dwordx4 v23, s[16:19], s34 offen lds
  v_mfma_f32_16x16x32_bf16 v[136:139], v[72:75], a[72:75], v[136:139]
  s_add_u32 m0, s33, 0
  s_waitcnt lgkmcnt(7)
  v_mfma_f32_16x16x32_bf16 v[136:139], v[76:79], a[88:91], v[136:139]
  s_mov_b32 s34, 11264
  v_mfma_f32_16x16x32_bf16 v[140:143], v[68:71], a[60:63], v[140:143]
  buffer_load_dwordx4 v23, s[16:19], s34 offen lds
  v_mfma_f32_16x16x32_bf16 v[140:143], v[72:75], a[76:79], v[140:143]
  s_add_u32 m0, s33, 4096
  s_waitcnt lgkmcnt(6)
  v_mfma_f32_16x16x32_bf16 v[140:143], v[76:79], a[92:95], v[140:143]
  s_mov_b32 s34, 48128
  buffer_load_dwordx4 v23, s[16:19], s34 offen lds
  v_mfma_f32_16x16x32_bf16 v[144:147], v[80:83], a[48:51], v[144:147]
  ds_read_b64_tr_b16 v[68:69], v12 offset:20480
  s_add_u32 m0, s33, 8192
  v_mfma_f32_16x16x32_bf16 v[144:147], v[84:87], a[64:67], v[144:147]
  ds_read_b64_tr_b16 v[70:71], v12 offset:22528
  s_mov_b32 s34, 2654208
  v_mfma_f32_16x16x32_bf16 v[144:147], v[88:91], a[80:83], v[144:147]
  ds_read_b64_tr_b16 v[72:73], v12 offset:24576
  buffer_load_dwordx4 v19, s[4:7], s34 offen lds
  v_mfma_f32_16x16x32_bf16 v[148:151], v[80:83], a[52:55], v[148:151]
  ds_read_b64_tr_b16 v[74:75], v12 offset:26624
  s_add_u32 m0, s33, 12288
  v_mfma_f32_16x16x32_bf16 v[148:151], v[84:87], a[68:71], v[148:151]
  ds_read_b64_tr_b16 v[76:77], v12 offset:28672
  s_mov_b32 s34, 2949120
  v_mfma_f32_16x16x32_bf16 v[148:151], v[88:91], a[84:87], v[148:151]
  ds_read_b64_tr_b16 v[78:79], v12 offset:30720
  buffer_load_dwordx4 v19, s[4:7], s34 offen lds
  v_mfma_f32_16x16x32_bf16 v[152:155], v[80:83], a[56:59], v[152:155]
  ds_read_b128 a[96:99], v27 offset:32768
  s_add_u32 m0, s33, 16384
  v_mfma_f32_16x16x32_bf16 v[152:155], v[84:87], a[72:75], v[152:155]
  ds_read_b128 a[100:103], v27 offset:33792
  s_mov_b32 s34, 3244032
  v_mfma_f32_16x16x32_bf16 v[152:155], v[88:91], a[88:91], v[152:155]
  ds_read_b128 a[104:107], v27 offset:36864
  buffer_load_dwordx4 v19, s[4:7], s34 offen lds
  v_mfma_f32_16x16x32_bf16 v[156:159], v[80:83], a[60:63], v[156:159]
  ds_read_b128 a[108:111], v27 offset:37888
  s_add_u32 m0, s33, 20480
  v_mfma_f32_16x16x32_bf16 v[156:159], v[84:87], a[76:79], v[156:159]
  s_mov_b32 s34, 2654208
  v_mfma_f32_16x16x32_bf16 v[156:159], v[88:91], a[92:95], v[156:159]
  buffer_load_dwordx4 v19, s[8:11], s34 offen lds
  s_waitcnt lgkmcnt(10)
  v_mfma_f32_16x16x32_bf16 v[160:163], v[56:59], a[48:51], v[160:163]
  s_waitcnt vmcnt(13)
  s_barrier
  v_mfma_f32_16x16x32_bf16 v[160:163], v[60:63], a[64:67], v[160:163]
  ds_read_b64_tr_b16 v[80:81], v9 offset:57344
  s_add_u32 m0, s33, 24576
  v_mfma_f32_16x16x32_bf16 v[160:163], v[64:67], a[80:83], v[160:163]
  ds_read_b64_tr_b16 v[82:83], v9 offset:59392
  s_mov_b32 s34, 2949120
  v_mfma_f32_16x16x32_bf16 v[164:167], v[56:59], a[52:55], v[164:167]
  ds_read_b64_tr_b16 v[84:85], v9 offset:61440
  buffer_load_dwordx4 v19, s[8:11], s34 offen lds
  v_mfma_f32_16x16x32_bf16 v[164:167], v[60:63], a[68:71], v[164:167]
  ds_read_b64_tr_b16 v[86:87], v9 offset:63488
  s_add_u32 m0, s33, 28672
  v_mfma_f32_16x16x32_bf16 v[164:167], v[64:67], a[84:87], v[164:167]
  ds_read_b64_tr_b16 v[88:89], v10
  s_mov_b32 s34, 3244032
  v_mfma_f32_16x16x32_bf16 v[168:171], v[56:59], a[56:59], v[168:171]
  ds_read_b64_tr_b16 v[90:91], v10 offset:2048
  buffer_load_dwordx4 v19, s[8:11], s34 offen lds
  v_mfma_f32_16x16x32_bf16 v[168:171], v[60:63], a[72:75], v[168:171]
  ds_read_b128 a[112:115], v27 offset:40960
  s_add_u32 m0, s33, 32768
  v_mfma_f32_16x16x32_bf16 v[168:171], v[64:67], a[88:91], v[168:171]
  ds_read_b128 a[116:119], v27 offset:41984
  s_mov_b32 s34, 12288
  v_mfma_f32_16x16x32_bf16 v[172:175], v[56:59], a[60:63], v[172:175]
  ds_read_b128 a[120:123], v27 offset:45056
  buffer_load_dwordx4 v23, s[16:19], s34 offen lds
  v_mfma_f32_16x16x32_bf16 v[172:175], v[60:63], a[76:79], v[172:175]
  ds_read_b128 a[124:127], v27 offset:46080
  s_add_u32 m0, s33, 36864
  v_mfma_f32_16x16x32_bf16 v[172:175], v[64:67], a[92:95], v[172:175]
  s_mov_b32 s34, 49152
  buffer_load_dwordx4 v23, s[16:19], s34 offen lds
  s_waitcnt lgkmcnt(14)
  v_mfma_f32_16x16x32_bf16 v[176:179], v[68:71], a[48:51], v[176:179]
  ds_read_b64_tr_b16 v[56:57], v12 offset:57344
  s_add_u32 m0, s33, 40960
  v_mfma_f32_16x16x32_bf16 v[176:179], v[72:75], a[64:67], v[176:179]
  ds_read_b64_tr_b16 v[58:59], v12 offset:59392
  s_mov_b32 s34, 13312
  v_mfma_f32_16x16x32_bf16 v[176:179], v[76:79], a[80:83], v[176:179]
  ds_read_b64_tr_b16 v[60:61], v12 offset:61440
  buffer_load_dwordx4 v23, s[16:19], s34 offen lds
  v_mfma_f32_16x16x32_bf16 v[180:183], v[68:71], a[52:55], v[180:183]
  ds_read_b64_tr_b16 v[62:63], v12 offset:63488
  s_add_u32 m0, s33, 45056
  v_mfma_f32_16x16x32_bf16 v[180:183], v[72:75], a[68:71], v[180:183]
  ds_read_b64_tr_b16 v[64:65], v13
  s_mov_b32 s34, 50176
  v_mfma_f32_16x16x32_bf16 v[180:183], v[76:79], a[84:87], v[180:183]
  ds_read_b64_tr_b16 v[66:67], v13 offset:2048
  buffer_load_dwordx4 v23, s[16:19], s34 offen lds
  v_mfma_f32_16x16x32_bf16 v[184:187], v[68:71], a[56:59], v[184:187]
  ds_read_b128 a[128:131], v27 offset:49152
  s_add_u32 m0, s33, 49152
  v_mfma_f32_16x16x32_bf16 v[184:187], v[72:75], a[72:75], v[184:187]
  ds_read_b128 a[132:135], v27 offset:50176
  s_mov_b32 s34, 14336
  v_mfma_f32_16x16x32_bf16 v[184:187], v[76:79], a[88:91], v[184:187]
  ds_read_b128 a[136:139], v27 offset:53248
  buffer_load_dwordx4 v23, s[16:19], s34 offen lds
  v_mfma_f32_16x16x32_bf16 v[188:191], v[68:71], a[60:63], v[188:191]
  ds_read_b128 a[140:143], v27 offset:54272
  s_add_u32 m0, s33, 53248
  v_mfma_f32_16x16x32_bf16 v[188:191], v[72:75], a[76:79], v[188:191]
  s_mov_b32 s34, 51200
  v_mfma_f32_16x16x32_bf16 v[188:191], v[76:79], a[92:95], v[188:191]
  buffer_load_dwordx4 v23, s[16:19], s34 offen lds
  s_waitcnt lgkmcnt(14)
  v_mfma_f32_16x16x32_bf16 v[128:131], v[80:83], a[96:99], v[128:131]
  s_waitcnt vmcnt(16)
  s_barrier
  s_waitcnt lgkmcnt(13)
  v_mfma_f32_16x16x32_bf16 v[128:131], v[84:87], a[112:115], v[128:131]
  ds_read_b64_tr_b16 v[68:69], v10 offset:4096
  s_add_u32 m0, s33, 57344
  s_waitcnt lgkmcnt(4)
  v_mfma_f32_16x16x32_bf16 v[128:131], v[88:91], a[128:131], v[128:131]
  ds_read_b64_tr_b16 v[70:71], v10 offset:6144
  s_mov_b32 s34, 3538944
  v_mfma_f32_16x16x32_bf16 v[132:135], v[80:83], a[100:103], v[132:135]
  ds_read_b64_tr_b16 v[72:73], v10 offset:8192
  buffer_load_dwordx4 v19, s[4:7], s34 offen lds
  v_mfma_f32_16x16x32_bf16 v[132:135], v[84:87], a[116:119], v[132:135]
  ds_read_b64_tr_b16 v[74:75], v10 offset:10240
  s_add_u32 m0, s33, 61440
  s_waitcnt lgkmcnt(6)
  v_mfma_f32_16x16x32_bf16 v[132:135], v[88:91], a[132:135], v[132:135]
  ds_read_b64_tr_b16 v[76:77], v10 offset:12288
  s_mov_b32 s34, 3833856
  v_mfma_f32_16x16x32_bf16 v[136:139], v[80:83], a[104:107], v[136:139]
  ds_read_b64_tr_b16 v[78:79], v10 offset:14336
  buffer_load_dwordx4 v19, s[4:7], s34 offen lds
  v_mfma_f32_16x16x32_bf16 v[136:139], v[84:87], a[120:123], v[136:139]
  s_add_u32 m0, s33, 65536
  s_waitcnt lgkmcnt(7)
  v_mfma_f32_16x16x32_bf16 v[136:139], v[88:91], a[136:139], v[136:139]
  s_mov_b32 s34, 4128768
  v_mfma_f32_16x16x32_bf16 v[140:143], v[80:83], a[108:111], v[140:143]
  buffer_load_dwordx4 v19, s[4:7], s34 offen lds
  v_mfma_f32_16x16x32_bf16 v[140:143], v[84:87], a[124:127], v[140:143]
  s_add_u32 m0, s33, 69632
  s_waitcnt lgkmcnt(6)
  v_mfma_f32_16x16x32_bf16 v[140:143], v[88:91], a[140:143], v[140:143]
  s_mov_b32 s34, 3538944
  buffer_load_dwordx4 v19, s[8:11], s34 offen lds
  v_mfma_f32_16x16x32_bf16 v[144:147], v[56:59], a[96:99], v[144:147]
  ds_read_b64_tr_b16 v[80:81], v13 offset:4096
  s_add_u32 m0, s33, 73728
  v_mfma_f32_16x16x32_bf16 v[144:147], v[60:63], a[112:115], v[144:147]
  ds_read_b64_tr_b16 v[82:83], v13 offset:6144
  s_mov_b32 s34, 3833856
  v_mfma_f32_16x16x32_bf16 v[144:147], v[64:67], a[128:131], v[144:147]
  ds_read_b64_tr_b16 v[84:85], v13 offset:8192
  buffer_load_dwordx4 v19, s[8:11], s34 offen lds
  v_mfma_f32_16x16x32_bf16 v[148:151], v[56:59], a[100:103], v[148:151]
  ds_read_b64_tr_b16 v[86:87], v13 offset:10240
  s_add_u32 m0, s33, 77824
  v_mfma_f32_16x16x32_bf16 v[148:151], v[60:63], a[116:119], v[148:151]
  ds_read_b64_tr_b16 v[88:89], v13 offset:12288
  s_mov_b32 s34, 4128768
  v_mfma_f32_16x16x32_bf16 v[148:151], v[64:67], a[132:135], v[148:151]
  ds_read_b64_tr_b16 v[90:91], v13 offset:14336
  buffer_load_dwordx4 v19, s[8:11], s34 offen lds
  v_mfma_f32_16x16x32_bf16 v[152:155], v[56:59], a[104:107], v[152:155]
  ds_read_b128 a[144:147], v28 offset:16384
  s_add_u32 m0, s33, 81920
  v_mfma_f32_16x16x32_bf16 v[152:155], v[60:63], a[120:123], v[152:155]
  ds_read_b128 a[148:151], v28 offset:17408
  s_mov_b32 s34, 15360
  v_mfma_f32_16x16x32_bf16 v[152:155], v[64:67], a[136:139], v[152:155]
  ds_read_b128 a[152:155], v28 offset:20480
  buffer_load_dwordx4 v23, s[16:19], s34 offen lds
  v_mfma_f32_16x16x32_bf16 v[156:159], v[56:59], a[108:111], v[156:159]
  ds_read_b128 a[156:159], v28 offset:21504
  s_add_u32 m0, s33, 86016
  v_mfma_f32_16x16x32_bf16 v[156:159], v[60:63], a[124:127], v[156:159]
  s_mov_b32 s34, 52224
  v_mfma_f32_16x16x32_bf16 v[156:159], v[64:67], a[140:143], v[156:159]
  buffer_load_dwordx4 v23, s[16:19], s34 offen lds
  s_waitcnt lgkmcnt(10)
  v_mfma_f32_16x16x32_bf16 v[160:163], v[68:71], a[96:99], v[160:163]
  s_waitcnt vmcnt(17)
  s_barrier
  v_mfma_f32_16x16x32_bf16 v[160:163], v[72:75], a[112:115], v[160:163]
  ds_read_b64_tr_b16 v[56:57], v8 offset:8192
  s_add_u32 m0, s33, 90112
  v_mfma_f32_16x16x32_bf16 v[160:163], v[76:79], a[128:131], v[160:163]
  ds_read_b64_tr_b16 v[58:59], v8 offset:10240
  s_mov_b32 s34, 16384
  v_mfma_f32_16x16x32_bf16 v[164:167], v[68:71], a[100:103], v[164:167]
  ds_read_b64_tr_b16 v[60:61], v8 offset:12288
  buffer_load_dwordx4 v23, s[16:19], s34 offen lds
  v_mfma_f32_16x16x32_bf16 v[164:167], v[72:75], a[116:119], v[164:167]
  ds_read_b64_tr_b16 v[62:63], v8 offset:14336
  s_add_u32 m0, s33, 94208
  v_mfma_f32_16x16x32_bf16 v[164:167], v[76:79], a[132:135], v[164:167]
  ds_read_b64_tr_b16 v[64:65], v8 offset:16384
  s_mov_b32 s34, 53248
  v_mfma_f32_16x16x32_bf16 v[168:171], v[68:71], a[104:107], v[168:171]
  ds_read_b64_tr_b16 v[66:67], v8 offset:18432
  buffer_load_dwordx4 v23, s[16:19], s34 offen lds
  v_mfma_f32_16x16x32_bf16 v[168:171], v[72:75], a[120:123], v[168:171]
  ds_read_b128 a[160:163], v28 offset:24576
  s_add_u32 m0, s33, 98304
  v_mfma_f32_16x16x32_bf16 v[168:171], v[76:79], a[136:139], v[168:171]
  ds_read_b128 a[164:167], v28 offset:25600
  s_mov_b32 s34, 17408
  v_mfma_f32_16x16x32_bf16 v[172:175], v[68:71], a[108:111], v[172:175]
  ds_read_b128 a[168:171], v28 offset:28672
  buffer_load_dwordx4 v23, s[16:19], s34 offen lds
  v_mfma_f32_16x16x32_bf16 v[172:175], v[72:75], a[124:127], v[172:175]
  ds_read_b128 a[172:175], v28 offset:29696
  s_add_u32 m0, s33, 102400
  v_mfma_f32_16x16x32_bf16 v[172:175], v[76:79], a[140:143], v[172:175]
  s_mov_b32 s34, 54272
  buffer_load_dwordx4 v23, s[16:19], s34 offen lds
  s_waitcnt lgkmcnt(14)
  v_mfma_f32_16x16x32_bf16 v[176:179], v[80:83], a[96:99], v[176:179]
  ds_read_b64_tr_b16 v[68:69], v11 offset:8192
  s_add_u32 m0, s33, 106496
  v_mfma_f32_16x16x32_bf16 v[176:179], v[84:87], a[112:115], v[176:179]
  ds_read_b64_tr_b16 v[70:71], v11 offset:10240
  s_mov_b32 s34, 4423680
  v_mfma_f32_16x16x32_bf16 v[176:179], v[88:91], a[128:131], v[176:179]
  ds_read_b64_tr_b16 v[72:73], v11 offset:12288
  buffer_load_dwordx4 v19, s[4:7], s34 offen lds
  v_mfma_f32_16x16x32_bf16 v[180:183], v[80:83], a[100:103], v[180:183]
  ds_read_b64_tr_b16 v[74:75], v11 offset:14336
  s_add_u32 m0, s33, 110592
  v_mfma_f32_16x16x32_bf16 v[180:183], v[84:87], a[116:119], v[180:183]
  ds_read_b64_tr_b16 v[76:77], v11 offset:16384
  s_mov_b32 s34, 4718592
  v_mfma_f32_16x16x32_bf16 v[180:183], v[88:91], a[132:135], v[180:183]
  ds_read_b64_tr_b16 v[78:79], v11 offset:18432
  buffer_load_dwordx4 v19, s[4:7], s34 offen lds
  v_mfma_f32_16x16x32_bf16 v[184:187], v[80:83], a[104:107], v[184:187]
  ds_read_b128 a[176:179], v26
  s_add_u32 m0, s33, 114688
  v_mfma_f32_16x16x32_bf16 v[184:187], v[84:87], a[120:123], v[184:187]
  ds_read_b128 a[180:183], v26 offset:1024
  s_mov_b32 s34, 5013504
  v_mfma_f32_16x16x32_bf16 v[184:187], v[88:91], a[136:139], v[184:187]
  ds_read_b128 a[184:187], v26 offset:4096
  buffer_load_dwordx4 v19, s[4:7], s34 offen lds
  v_mfma_f32_16x16x32_bf16 v[188:191], v[80:83], a[108:111], v[188:191]
  ds_read_b128 a[188:191], v26 offset:5120
  v_mfma_f32_16x16x32_bf16 v[188:191], v[84:87], a[124:127], v[188:191]
  v_mfma_f32_16x16x32_bf16 v[188:191], v[88:91], a[140:143], v[188:191]
  s_waitcnt lgkmcnt(14)
  v_mfma_f32_16x16x32_bf16 v[128:131], v[56:59], a[144:147], v[128:131]
  s_waitcnt vmcnt(19)
  s_barrier
  s_waitcnt lgkmcnt(13)
  v_mfma_f32_16x16x32_bf16 v[128:131], v[60:63], a[160:163], v[128:131]
  ds_read_b64_tr_b16 v[80:81], v8 offset:20480
  s_add_u32 m0, s33, 118784
  s_waitcnt lgkmcnt(4)
  v_mfma_f32_16x16x32_bf16 v[128:131], v[64:67], a[176:179], v[128:131]
  ds_read_b64_tr_b16 v[82:83], v8 offset:22528
  s_mov_b32 s34, 4423680
  v_mfma_f32_16x16x32_bf16 v[132:135], v[56:59], a[148:151], v[132:135]
  ds_read_b64_tr_b16 v[84:85], v8 offset:24576
  buffer_load_dwordx4 v19, s[8:11], s34 offen lds
  v_mfma_f32_16x16x32_bf16 v[132:135], v[60:63], a[164:167], v[132:135]
  ds_read_b64_tr_b16 v[86:87], v8 offset:26624
  s_add_u32 m0, s33, 122880
  s_waitcnt lgkmcnt(6)
  v_mfma_f32_16x16x32_bf16 v[132:135], v[64:67], a[180:183], v[132:135]
  ds_read_b64_tr_b16 v[88:89], v8 offset:28672
  s_mov_b32 s34, 4718592
  v_mfma_f32_16x16x32_bf16 v[136:139], v[56:59], a[152:155], v[136:139]
  ds_read_b64_tr_b16 v[90:91], v8 offset:30720
  buffer_load_dwordx4 v19, s[8:11], s34 offen lds
  v_mfma_f32_16x16x32_bf16 v[136:139], v[60:63], a[168:171], v[136:139]
  s_add_u32 m0, s33, 126976
  s_waitcnt lgkmcnt(7)
  v_mfma_f32_16x16x32_bf16 v[136:139], v[64:67], a[184:187], v[136:139]
  s_mov_b32 s34, 5013504
  v_mfma_f32_16x16x32_bf16 v[140:143], v[56:59], a[156:159], v[140:143]
  buffer_load_dwordx4 v19, s[8:11], s34 offen lds
  v_mfma_f32_16x16x32_bf16 v[140:143], v[60:63], a[172:175], v[140:143]
  s_waitcnt lgkmcnt(6)
  v_mfma_f32_16x16x32_bf16 v[140:143], v[64:67], a[188:191], v[140:143]
  v_mfma_f32_16x16x32_bf16 v[144:147], v[68:71], a[144:147], v[144:147]
  ds_read_b64_tr_b16 v[56:57], v11 offset:20480
  s_add_u32 m0, s33, 135168
  v_mfma_f32_16x16x32_bf16 v[144:147], v[72:75], a[160:163], v[144:147]
  ds_read_b64_tr_b16 v[58:59], v11 offset:22528
  s_mov_b32 s34, 128
  v_mfma_f32_16x16x32_bf16 v[144:147], v[76:79], a[176:179], v[144:147]
  ds_read_b64_tr_b16 v[60:61], v11 offset:24576
  buffer_load_dwordx4 v19, s[4:7], s34 offen lds
  v_mfma_f32_16x16x32_bf16 v[148:151], v[68:71], a[148:151], v[148:151]
  ds_read_b64_tr_b16 v[62:63], v11 offset:26624
  s_add_u32 m0, s33, 139264
  v_mfma_f32_16x16x32_bf16 v[148:151], v[72:75], a[164:167], v[148:151]
  ds_read_b64_tr_b16 v[64:65], v11 offset:28672
  s_mov_b32 s34, 295040
  v_mfma_f32_16x16x32_bf16 v[148:151], v[76:79], a[180:183], v[148:151]
  ds_read_b64_tr_b16 v[66:67], v11 offset:30720
  buffer_load_dwordx4 v19, s[4:7], s34 offen lds
  v_mfma_f32_16x16x32_bf16 v[152:155], v[68:71], a[152:155], v[152:155]
  ds_read_b128 a[192:195], v26 offset:32768
  v_mfma_f32_16x16x32_bf16 v[152:155], v[72:75], a[168:171], v[152:155]
  ds_read_b128 a[196:199], v26 offset:33792
  v_mfma_f32_16x16x32_bf16 v[152:155], v[76:79], a[184:187], v[152:155]
  ds_read_b128 a[200:203], v26 offset:36864
  v_mfma_f32_16x16x32_bf16 v[156:159], v[68:71], a[156:159], v[156:159]
  ds_read_b128 a[204:207], v26 offset:37888
  v_mfma_f32_16x16x32_bf16 v[156:159], v[72:75], a[172:175], v[156:159]
  v_mfma_f32_16x16x32_bf16 v[156:159], v[76:79], a[188:191], v[156:159]
  s_waitcnt lgkmcnt(10)
  v_mfma_f32_16x16x32_bf16 v[160:163], v[80:83], a[144:147], v[160:163]
  s_waitcnt vmcnt(17)
  s_barrier
  v_mfma_f32_16x16x32_bf16 v[160:163], v[84:87], a[160:163], v[160:163]
  ds_read_b64_tr_b16 v[68:69], v8 offset:57344
  s_add_u32 m0, s33, 143360
  v_mfma_f32_16x16x32_bf16 v[160:163], v[88:91], a[176:179], v[160:163]
  ds_read_b64_tr_b16 v[70:71], v8 offset:59392
  s_mov_b32 s34, 589952
  v_mfma_f32_16x16x32_bf16 v[164:167], v[80:83], a[148:151], v[164:167]
  ds_read_b64_tr_b16 v[72:73], v8 offset:61440
  buffer_load_dwordx4 v19, s[4:7], s34 offen lds
  v_mfma_f32_16x16x32_bf16 v[164:167], v[84:87], a[164:167], v[164:167]
  ds_read_b64_tr_b16 v[74:75], v8 offset:63488
  s_add_u32 m0, s33, 147456
  v_mfma_f32_16x16x32_bf16 v[164:167], v[88:91], a[180:183], v[164:167]
  ds_read_b64_tr_b16 v[76:77], v9
  s_mov_b32 s34, 128
  v_mfma_f32_16x16x32_bf16 v[168:171], v[80:83], a[152:155], v[168:171]
  ds_read_b64_tr_b16 v[78:79], v9 offset:2048
  buffer_load_dwordx4 v19, s[8:11], s34 offen lds
  v_mfma_f32_16x16x32_bf16 v[168:171], v[84:87], a[168:171], v[168:171]
  ds_read_b128 a[208:211], v26 offset:40960
  s_add_u32 m0, s33, 151552
  v_mfma_f32_16x16x32_bf16 v[168:171], v[88:91], a[184:187], v[168:171]
  ds_read_b128 a[212:215], v26 offset:41984
  s_mov_b32 s34, 295040
  v_mfma_f32_16x16x32_bf16 v[172:175], v[80:83], a[156:159], v[172:175]
  ds_read_b128 a[216:219], v26 offset:45056
  buffer_load_dwordx4 v19, s[8:11], s34 offen lds
  v_mfma_f32_16x16x32_bf16 v[172:175], v[84:87], a[172:175], v[172:175]
  ds_read_b128 a[220:223], v26 offset:46080
  s_add_u32 m0, s33, 155648
  v_mfma_f32_16x16x32_bf16 v[172:175], v[88:91], a[188:191], v[172:175]
  s_mov_b32 s34, 589952
  buffer_load_dwordx4 v19, s[8:11], s34 offen lds
  s_waitcnt lgkmcnt(14)
  v_mfma_f32_16x16x32_bf16 v[176:179], v[56:59], a[144:147], v[176:179]
  ds_read_b64_tr_b16 v[80:81], v11 offset:57344
  s_add_u32 m0, s33, 159744
  v_mfma_f32_16x16x32_bf16 v[176:179], v[60:63], a[160:163], v[176:179]
  ds_read_b64_tr_b16 v[82:83], v11 offset:59392
  s_mov_b32 s34, 884864
  v_mfma_f32_16x16x32_bf16 v[176:179], v[64:67], a[176:179], v[176:179]
  ds_read_b64_tr_b16 v[84:85], v11 offset:61440
  buffer_load_dwordx4 v19, s[4:7], s34 offen lds
  v_mfma_f32_16x16x32_bf16 v[180:183], v[56:59], a[148:151], v[180:183]
  ds_read_b64_tr_b16 v[86:87], v11 offset:63488
  s_add_u32 m0, s33, 0
  v_mfma_f32_16x16x32_bf16 v[180:183], v[60:63], a[164:167], v[180:183]
  ds_read_b64_tr_b16 v[88:89], v12
  s_mov_b32 s34, 1179776
  v_mfma_f32_16x16x32_bf16 v[180:183], v[64:67], a[180:183], v[180:183]
  ds_read_b64_tr_b16 v[90:91], v12 offset:2048
  buffer_load_dwordx4 v19, s[4:7], s34 offen lds
  v_mfma_f32_16x16x32_bf16 v[184:187], v[56:59], a[152:155], v[184:187]
  ds_read_b128 a[224:227], v26 offset:49152
  s_add_u32 m0, s33, 4096
  v_mfma_f32_16x16x32_bf16 v[184:187], v[60:63], a[168:171], v[184:187]
  ds_read_b128 a[228:231], v26 offset:50176
  s_mov_b32 s34, 1474688
  v_mfma_f32_16x16x32_bf16 v[184:187], v[64:67], a[184:187], v[184:187]
  ds_read_b128 a[232:235], v26 offset:53248
  buffer_load_dwordx4 v19, s[4:7], s34 offen lds
  v_mfma_f32_16x16x32_bf16 v[188:191], v[56:59], a[156:159], v[188:191]
  ds_read_b128 a[236:239], v26 offset:54272
  v_mfma_f32_16x16x32_bf16 v[188:191], v[60:63], a[172:175], v[188:191]
  v_mfma_f32_16x16x32_bf16 v[188:191], v[64:67], a[188:191], v[188:191]
  s_waitcnt lgkmcnt(14)
  v_mfma_f32_16x16x32_bf16 v[128:131], v[68:71], a[192:195], v[128:131]
  s_waitcnt vmcnt(19)
  s_barrier
  s_waitcnt lgkmcnt(13)
  v_mfma_f32_16x16x32_bf16 v[128:131], v[72:75], a[208:211], v[128:131]
  ds_read_b64_tr_b16 v[56:57], v9 offset:4096
  s_add_u32 m0, s33, 8192
  s_waitcnt lgkmcnt(4)
  v_mfma_f32_16x16x32_bf16 v[128:131], v[76:79], a[224:227], v[128:131]
  ds_read_b64_tr_b16 v[58:59], v9 offset:6144
  s_mov_b32 s34, 884864
  v_mfma_f32_16x16x32_bf16 v[132:135], v[68:71], a[196:199], v[132:135]
  ds_read_b64_tr_b16 v[60:61], v9 offset:8192
  buffer_load_dwordx4 v19, s[8:11], s34 offen lds
  v_mfma_f32_16x16x32_bf16 v[132:135], v[72:75], a[212:215], v[132:135]
  ds_read_b64_tr_b16 v[62:63], v9 offset:10240
  s_add_u32 m0, s33, 12288
  s_waitcnt lgkmcnt(6)
  v_mfma_f32_16x16x32_bf16 v[132:135], v[76:79], a[228:231], v[132:135]
  ds_read_b64_tr_b16 v[64:65], v9 offset:12288
  s_mov_b32 s34, 1179776
  v_mfma_f32_16x16x32_bf16 v[136:139], v[68:71], a[200:203], v[136:139]
  ds_read_b64_tr_b16 v[66:67], v9 offset:14336
  buffer_load_dwordx4 v19, s[8:11], s34 offen lds
  v_mfma_f32_16x16x32_bf16 v[136:139], v[72:75], a[216:219], v[136:139]
  s_add_u32 m0, s33, 16384
  s_waitcnt lgkmcnt(7)
  v_mfma_f32_16x16x32_bf16 v[136:139], v[76:79], a[232:235], v[136:139]
  s_mov_b32 s34, 1474688
  v_mfma_f32_16x16x32_bf16 v[140:143], v[68:71], a[204:207], v[140:143]
  buffer_load_dwordx4 v19, s[8:11], s34 offen lds
  v_mfma_f32_16x16x32_bf16 v[140:143], v[72:75], a[220:223], v[140:143]
  s_waitcnt lgkmcnt(6)
  v_mfma_f32_16x16x32_bf16 v[140:143], v[76:79], a[236:239], v[140:143]
  v_mfma_f32_16x16x32_bf16 v[144:147], v[80:83], a[192:195], v[144:147]
  ds_read_b64_tr_b16 v[68:69], v12 offset:4096
  s_add_u32 m0, s33, 20480
  v_mfma_f32_16x16x32_bf16 v[144:147], v[84:87], a[208:211], v[144:147]
  ds_read_b64_tr_b16 v[70:71], v12 offset:6144
  s_mov_b32 s34, 1769600
  v_mfma_f32_16x16x32_bf16 v[144:147], v[88:91], a[224:227], v[144:147]
  ds_read_b64_tr_b16 v[72:73], v12 offset:8192
  buffer_load_dwordx4 v19, s[4:7], s34 offen lds
  v_mfma_f32_16x16x32_bf16 v[148:151], v[80:83], a[196:199], v[148:151]
  ds_read_b64_tr_b16 v[74:75], v12 offset:10240
  s_add_u32 m0, s33, 24576
  v_mfma_f32_16x16x32_bf16 v[148:151], v[84:87], a[212:215], v[148:151]
  ds_read_b64_tr_b16 v[76:77], v12 offset:12288
  s_mov_b32 s34, 2064512
  v_mfma_f32_16x16x32_bf16 v[148:151], v[88:91], a[228:231], v[148:151]
  ds_read_b64_tr_b16 v[78:79], v12 offset:14336
  buffer_load_dwordx4 v19, s[4:7], s34 offen lds
  v_mfma_f32_16x16x32_bf16 v[152:155], v[80:83], a[200:203], v[152:155]
  ds_read_b128 a[240:243], v27 offset:16384
  v_mfma_f32_16x16x32_bf16 v[152:155], v[84:87], a[216:219], v[152:155]
  ds_read_b128 a[244:247], v27 offset:17408
  v_mfma_f32_16x16x32_bf16 v[152:155], v[88:91], a[232:235], v[152:155]
  ds_read_b128 a[248:251], v27 offset:20480
  v_mfma_f32_16x16x32_bf16 v[156:159], v[80:83], a[204:207], v[156:159]
  ds_read_b128 a[252:255], v27 offset:21504
  v_mfma_f32_16x16x32_bf16 v[156:159], v[84:87], a[220:223], v[156:159]
  v_mfma_f32_16x16x32_bf16 v[156:159], v[88:91], a[236:239], v[156:159]
  s_waitcnt lgkmcnt(10)
  v_mfma_f32_16x16x32_bf16 v[160:163], v[56:59], a[192:195], v[160:163]
  s_waitcnt vmcnt(17)
  s_barrier
  v_mfma_f32_16x16x32_bf16 v[160:163], v[60:63], a[208:211], v[160:163]
  ds_read_b64_tr_b16 v[80:81], v9 offset:40960
  s_add_u32 m0, s33, 28672
  v_mfma_f32_16x16x32_bf16 v[160:163], v[64:67], a[224:227], v[160:163]
  ds_read_b64_tr_b16 v[82:83], v9 offset:43008
  s_mov_b32 s34, 2359424
  v_mfma_f32_16x16x32_bf16 v[164:167], v[56:59], a[196:199], v[164:167]
  ds_read_b64_tr_b16 v[84:85], v9 offset:45056
  buffer_load_dwordx4 v19, s[4:7], s34 offen lds
  v_mfma_f32_16x16x32_bf16 v[164:167], v[60:63], a[212:215], v[164:167]
  ds_read_b64_tr_b16 v[86:87], v9 offset:47104
  s_add_u32 m0, s33, 32768
  v_mfma_f32_16x16x32_bf16 v[164:167], v[64:67], a[228:231], v[164:167]
  ds_read_b64_tr_b16 v[88:89], v9 offset:49152
  s_mov_b32 s34, 1769600
  v_mfma_f32_16x16x32_bf16 v[168:171], v[56:59], a[200:203], v[168:171]
  ds_read_b64_tr_b16 v[90:91], v9 offset:51200
  buffer_load_dwordx4 v19, s[8:11], s34 offen lds
  v_mfma_f32_16x16x32_bf16 v[168:171], v[60:63], a[216:219], v[168:171]
  ds_read_b128 v[96:99], v27 offset:24576
  s_add_u32 m0, s33, 36864
  v_mfma_f32_16x16x32_bf16 v[168:171], v[64:67], a[232:235], v[168:171]
  ds_read_b128 v[100:103], v27 offset:25600
  s_mov_b32 s34, 2064512
  v_mfma_f32_16x16x32_bf16 v[172:175], v[56:59], a[204:207], v[172:175]
  ds_read_b128 v[104:107], v27 offset:28672
  buffer_load_dwordx4 v19, s[8:11], s34 offen lds
  v_mfma_f32_16x16x32_bf16 v[172:175], v[60:63], a[220:223], v[172:175]
  ds_read_b128 v[108:111], v27 offset:29696
  s_add_u32 m0, s33, 40960
  v_mfma_f32_16x16x32_bf16 v[172:175], v[64:67], a[236:239], v[172:175]
  s_mov_b32 s34, 2359424
  buffer_load_dwordx4 v19, s[8:11], s34 offen lds
  s_waitcnt lgkmcnt(14)
  v_mfma_f32_16x16x32_bf16 v[176:179], v[68:71], a[192:195], v[176:179]
  ds_read_b64_tr_b16 v[56:57], v12 offset:40960
  s_add_u32 m0, s33, 45056
  v_mfma_f32_16x16x32_bf16 v[176:179], v[72:75], a[208:211], v[176:179]
  ds_read_b64_tr_b16 v[58:59], v12 offset:43008
  s_mov_b32 s34, 2654336
  v_mfma_f32_16x16x32_bf16 v[176:179], v[76:79], a[224:227], v[176:179]
  ds_read_b64_tr_b16 v[60:61], v12 offset:45056
  buffer_load_dwordx4 v19, s[4:7], s34 offen lds
  v_mfma_f32_16x16x32_bf16 v[180:183], v[68:71], a[196:199], v[180:183]
  ds_read_b64_tr_b16 v[62:63], v12 offset:47104
  s_add_u32 m0, s33, 49152
  v_mfma_f32_16x16x32_bf16 v[180:183], v[72:75], a[212:215], v[180:183]
  ds_read_b64_tr_b16 v[64:65], v12 offset:49152
  s_mov_b32 s34, 2949248
  v_mfma_f32_16x16x32_bf16 v[180:183], v[76:79], a[228:231], v[180:183]
  ds_read_b64_tr_b16 v[66:67], v12 offset:51200
  buffer_load_dwordx4 v19, s[4:7], s34 offen lds
  v_mfma_f32_16x16x32_bf16 v[184:187], v[68:71], a[200:203], v[184:187]
  ds_read_b128 v[112:115], v27 offset:32768
  s_add_u32 m0, s33, 53248
  v_mfma_f32_16x16x32_bf16 v[184:187], v[72:75], a[216:219], v[184:187]
  ds_read_b128 v[116:119], v27 offset:33792
  s_mov_b32 s34, 3244160
  v_mfma_f32_16x16x32_bf16 v[184:187], v[76:79], a[232:235], v[184:187]
  ds_read_b128 v[120:123], v27 offset:36864
  buffer_load_dwordx4 v19, s[4:7], s34 offen lds
  v_mfma_f32_16x16x32_bf16 v[188:191], v[68:71], a[204:207], v[188:191]
  ds_read_b128 v[124:127], v27 offset:37888
  v_mfma_f32_16x16x32_bf16 v[188:191], v[72:75], a[220:223], v[188:191]
  v_mfma_f32_16x16x32_bf16 v[188:191], v[76:79], a[236:239], v[188:191]
  s_waitcnt lgkmcnt(14)
  v_mfma_f32_16x16x32_bf16 v[128:131], v[80:83], a[240:243], v[128:131]
  s_waitcnt vmcnt(21)
  s_barrier
  s_waitcnt lgkmcnt(13)
  v_mfma_f32_16x16x32_bf16 v[128:131], v[84:87], v[96:99], v[128:131]
  ds_read_b64_tr_b16 v[68:69], v9 offset:53248
  s_add_u32 m0, s33, 57344
  s_waitcnt lgkmcnt(4)
  v_mfma_f32_16x16x32_bf16 v[128:131], v[88:91], v[112:115], v[128:131]
  ds_read_b64_tr_b16 v[70:71], v9 offset:55296
  s_mov_b32 s34, 2654336
  v_mfma_f32_16x16x32_bf16 v[132:135], v[80:83], a[244:247], v[132:135]
  ds_read_b64_tr_b16 v[72:73], v9 offset:57344
  buffer_load_dwordx4 v19, s[8:11], s34 offen lds
  v_mfma_f32_16x16x32_bf16 v[132:135], v[84:87], v[100:103], v[132:135]
  ds_read_b64_tr_b16 v[74:75], v9 offset:59392
  s_add_u32 m0, s33, 61440
  s_waitcnt lgkmcnt(6)
  v_mfma_f32_16x16x32_bf16 v[132:135], v[88:91], v[116:119], v[132:135]
  ds_read_b64_tr_b16 v[76:77], v9 offset:61440
  s_mov_b32 s34, 2949248
  v_mfma_f32_16x16x32_bf16 v[136:139], v[80:83], a[248:251], v[136:139]
  ds_read_b64_tr_b16 v[78:79], v9 offset:63488
  buffer_load_dwordx4 v19, s[8:11], s34 offen lds
  v_mfma_f32_16x16x32_bf16 v[136:139], v[84:87], v[104:107], v[136:139]
  s_add_u32 m0, s33, 65536
  s_waitcnt lgkmcnt(7)
  v_mfma_f32_16x16x32_bf16 v[136:139], v[88:91], v[120:123], v[136:139]
  s_mov_b32 s34, 3244160
  v_mfma_f32_16x16x32_bf16 v[140:143], v[80:83], a[252:255], v[140:143]
  buffer_load_dwordx4 v19, s[8:11], s34 offen lds
  v_mfma_f32_16x16x32_bf16 v[140:143], v[84:87], v[108:111], v[140:143]
  s_waitcnt lgkmcnt(6)
  v_mfma_f32_16x16x32_bf16 v[140:143], v[88:91], v[124:127], v[140:143]
  v_mfma_f32_16x16x32_bf16 v[144:147], v[56:59], a[240:243], v[144:147]
  ds_read_b64_tr_b16 v[80:81], v12 offset:53248
  v_mfma_f32_16x16x32_bf16 v[144:147], v[60:63], v[96:99], v[144:147]
  ds_read_b64_tr_b16 v[82:83], v12 offset:55296
  v_mfma_f32_16x16x32_bf16 v[144:147], v[64:67], v[112:115], v[144:147]
  ds_read_b64_tr_b16 v[84:85], v12 offset:57344
  v_mfma_f32_16x16x32_bf16 v[148:151], v[56:59], a[244:247], v[148:151]
  ds_read_b64_tr_b16 v[86:87], v12 offset:59392
  v_mfma_f32_16x16x32_bf16 v[148:151], v[60:63], v[100:103], v[148:151]
  ds_read_b64_tr_b16 v[88:89], v12 offset:61440
  v_mfma_f32_16x16x32_bf16 v[148:151], v[64:67], v[116:119], v[148:151]
  ds_read_b64_tr_b16 v[90:91], v12 offset:63488
  v_mfma_f32_16x16x32_bf16 v[152:155], v[56:59], a[248:251], v[152:155]
  v_mfma_f32_16x16x32_bf16 v[152:155], v[60:63], v[104:107], v[152:155]
  v_mfma_f32_16x16x32_bf16 v[152:155], v[64:67], v[120:123], v[152:155]
  v_mfma_f32_16x16x32_bf16 v[156:159], v[56:59], a[252:255], v[156:159]
  v_mfma_f32_16x16x32_bf16 v[156:159], v[60:63], v[108:111], v[156:159]
  v_mfma_f32_16x16x32_bf16 v[156:159], v[64:67], v[124:127], v[156:159]
  s_waitcnt lgkmcnt(6)
  v_mfma_f32_16x16x32_bf16 v[160:163], v[68:71], a[240:243], v[160:163]
  s_waitcnt vmcnt(21)
  s_barrier
  v_mfma_f32_16x16x32_bf16 v[160:163], v[72:75], v[96:99], v[160:163]
  ds_read_b64_tr_b16 v[56:57], v10 offset:4096
  s_add_u32 m0, s33, 69632
  v_mfma_f32_16x16x32_bf16 v[160:163], v[76:79], v[112:115], v[160:163]
  ds_read_b64_tr_b16 v[58:59], v10 offset:6144
  s_mov_b32 s34, 3539072
  v_mfma_f32_16x16x32_bf16 v[164:167], v[68:71], a[244:247], v[164:167]
  ds_read_b64_tr_b16 v[60:61], v10 offset:8192
  buffer_load_dwordx4 v19, s[4:7], s34 offen lds
  v_mfma_f32_16x16x32_bf16 v[164:167], v[72:75], v[100:103], v[164:167]
  ds_read_b64_tr_b16 v[62:63], v10 offset:10240
  s_add_u32 m0, s33, 73728
  v_mfma_f32_16x16x32_bf16 v[164:167], v[76:79], v[116:119], v[164:167]
  ds_read_b64_tr_b16 v[64:65], v10 offset:12288
  s_mov_b32 s34, 3833984
  v_mfma_f32_16x16x32_bf16 v[168:171], v[68:71], a[248:251], v[168:171]
  ds_read_b64_tr_b16 v[66:67], v10 offset:14336
  buffer_load_dwordx4 v19, s[4:7], s34 offen lds
  v_mfma_f32_16x16x32_bf16 v[168:171], v[72:75], v[104:107], v[168:171]
  s_add_u32 m0, s33, 77824
  v_mfma_f32_16x16x32_bf16 v[168:171], v[76:79], v[120:123], v[168:171]
  s_mov_b32 s34, 4128896
  v_mfma_f32_16x16x32_bf16 v[172:175], v[68:71], a[252:255], v[172:175]
  buffer_load_dwordx4 v19, s[4:7], s34 offen lds
  v_mfma_f32_16x16x32_bf16 v[172:175], v[72:75], v[108:111], v[172:175]
  v_mfma_f32_16x16x32_bf16 v[172:175], v[76:79], v[124:127], v[172:175]
  s_waitcnt lgkmcnt(6)
  v_mfma_f32_16x16x32_bf16 v[176:179], v[80:83], a[240:243], v[176:179]
  ds_read_b64_tr_b16 v[68:69], v13 offset:4096
  v_mfma_f32_16x16x32_bf16 v[176:179], v[84:87], v[96:99], v[176:179]
  ds_read_b64_tr_b16 v[70:71], v13 offset:6144
  v_mfma_f32_16x16x32_bf16 v[176:179], v[88:91], v[112:115], v[176:179]
  ds_read_b64_tr_b16 v[72:73], v13 offset:8192
  v_mfma_f32_16x16x32_bf16 v[180:183], v[80:83], a[244:247], v[180:183]
  ds_read_b64_tr_b16 v[74:75], v13 offset:10240
  v_mfma_f32_16x16x32_bf16 v[180:183], v[84:87], v[100:103], v[180:183]
  ds_read_b64_tr_b16 v[76:77], v13 offset:12288
  v_mfma_f32_16x16x32_bf16 v[180:183], v[88:91], v[116:119], v[180:183]
  ds_read_b64_tr_b16 v[78:79], v13 offset:14336
  v_mfma_f32_16x16x32_bf16 v[184:187], v[80:83], a[248:251], v[184:187]
  v_mfma_f32_16x16x32_bf16 v[184:187], v[84:87], v[104:107], v[184:187]
  v_mfma_f32_16x16x32_bf16 v[184:187], v[88:91], v[120:123], v[184:187]
  v_mfma_f32_16x16x32_bf16 v[188:191], v[80:83], a[252:255], v[188:191]
  v_mfma_f32_16x16x32_bf16 v[188:191], v[84:87], v[108:111], v[188:191]
  v_mfma_f32_16x16x32_bf16 v[188:191], v[88:91], v[124:127], v[188:191]
  s_waitcnt lgkmcnt(6)
  v_mfma_f32_16x16x32_bf16 v[192:195], v[56:59], a[0:3], 0
  s_waitcnt vmcnt(18)
  s_barrier
  v_mfma_f32_16x16x32_bf16 v[192:195], v[60:63], a[16:19], v[192:195]
  ds_read_b64_tr_b16 v[80:81], v10 offset:16384
  v_mul_f32 v128, v128, v160
  v_mfma_f32_16x16x32_bf16 v[192:195], v[64:67], a[32:35], v[192:195]
  ds_read_b64_tr_b16 v[82:83], v10 offset:18432
  v_mul_f32 v129, v129, v161
  v_mfma_f32_16x16x32_bf16 v[196:199], v[56:59], a[4:7], 0
  ds_read_b64_tr_b16 v[84:85], v10 offset:20480
  v_mul_f32 v130, v130, v162
  v_mfma_f32_16x16x32_bf16 v[196:199], v[60:63], a[20:23], v[196:199]
  ds_read_b64_tr_b16 v[86:87], v10 offset:22528
  v_mul_f32 v131, v131, v163
  v_mfma_f32_16x16x32_bf16 v[196:199], v[64:67], a[36:39], v[196:199]
  ds_read_b64_tr_b16 v[88:89], v10 offset:24576
  v_cvt_pk_bf16_f32 v32, v128, v129
  v_mfma_f32_16x16x32_bf16 v[200:203], v[56:59], a[8:11], 0
  ds_read_b64_tr_b16 v[90:91], v10 offset:26624
  v_cvt_pk_bf16_f32 v33, v130, v131
  v_mfma_f32_16x16x32_bf16 v[200:203], v[60:63], a[24:27], v[200:203]
  s_add_u32 m0, s33, 81920
  v_mul_f32 v144, v144, v176
  v_mfma_f32_16x16x32_bf16 v[200:203], v[64:67], a[40:43], v[200:203]
  s_mov_b32 s34, 3539072
  v_mul_f32 v145, v145, v177
  v_mfma_f32_16x16x32_bf16 v[204:207], v[56:59], a[12:15], 0
  buffer_load_dwordx4 v19, s[8:11], s34 offen lds
  v_mul_f32 v146, v146, v178
  v_mfma_f32_16x16x32_bf16 v[204:207], v[60:63], a[28:31], v[204:207]
  s_add_u32 m0, s33, 86016
  v_mul_f32 v147, v147, v179
  v_mfma_f32_16x16x32_bf16 v[204:207], v[64:67], a[44:47], v[204:207]
  s_mov_b32 s34, 3833984
  buffer_load_dwordx4 v19, s[8:11], s34 offen lds
  s_waitcnt lgkmcnt(6)
  v_mfma_f32_16x16x32_bf16 v[208:211], v[68:71], a[0:3], 0
  ds_read_b64_tr_b16 v[56:57], v13 offset:16384
  v_cvt_pk_bf16_f32 v34, v144, v145
  v_mfma_f32_16x16x32_bf16 v[208:211], v[72:75], a[16:19], v[208:211]
  ds_read_b64_tr_b16 v[58:59], v13 offset:18432
  v_cvt_pk_bf16_f32 v35, v146, v147
  v_mfma_f32_16x16x32_bf16 v[208:211], v[76:79], a[32:35], v[208:211]
  ds_read_b64_tr_b16 v[60:61], v13 offset:20480
  ds_write_b128 v17, v[32:35]
  v_mfma_f32_16x16x32_bf16 v[212:215], v[68:71], a[4:7], 0
  ds_read_b64_tr_b16 v[62:63], v13 offset:22528
  v_mul_f32 v132, v132, v164
  v_mfma_f32_16x16x32_bf16 v[212:215], v[72:75], a[20:23], v[212:215]
  ds_read_b64_tr_b16 v[64:65], v13 offset:24576
  v_mul_f32 v133, v133, v165
  v_mfma_f32_16x16x32_bf16 v[212:215], v[76:79], a[36:39], v[212:215]
  ds_read_b64_tr_b16 v[66:67], v13 offset:26624
  v_mul_f32 v134, v134, v166
  v_mfma_f32_16x16x32_bf16 v[216:219], v[68:71], a[8:11], 0
  s_add_u32 m0, s33, 98304
  v_mul_f32 v135, v135, v167
  v_mfma_f32_16x16x32_bf16 v[216:219], v[72:75], a[24:27], v[216:219]
  s_mov_b32 s34, 4128896
  v_cvt_pk_bf16_f32 v36, v132, v133
  v_mfma_f32_16x16x32_bf16 v[216:219], v[76:79], a[40:43], v[216:219]
  buffer_load_dwordx4 v19, s[8:11], s34 offen lds
  v_cvt_pk_bf16_f32 v37, v134, v135
  v_mfma_f32_16x16x32_bf16 v[220:223], v[68:71], a[12:15], 0
  v_mul_f32 v148, v148, v180
  v_mfma_f32_16x16x32_bf16 v[220:223], v[72:75], a[28:31], v[220:223]
  v_mul_f32 v149, v149, v181
  v_mfma_f32_16x16x32_bf16 v[220:223], v[76:79], a[44:47], v[220:223]
  v_mul_f32 v150, v150, v182
  s_waitcnt lgkmcnt(7)
  v_mfma_f32_16x16x32_bf16 v[224:227], v[80:83], a[0:3], 0
  ds_read_b64_tr_b16 v[68:69], v10 offset:28672
  v_mul_f32 v151, v151, v183
  v_mfma_f32_16x16x32_bf16 v[224:227], v[84:87], a[16:19], v[224:227]
  ds_read_b64_tr_b16 v[70:71], v10 offset:30720
  v_cvt_pk_bf16_f32 v38, v148, v149
  v_mfma_f32_16x16x32_bf16 v[224:227], v[88:91], a[32:35], v[224:227]
  ds_read_b64_tr_b16 v[72:73], v8
  v_cvt_pk_bf16_f32 v39, v150, v151
  v_mfma_f32_16x16x32_bf16 v[228:231], v[80:83], a[4:7], 0
  ds_read_b64_tr_b16 v[74:75], v8 offset:2048
  ds_write_b128 v17, v[36:39] offset:1024
  v_mfma_f32_16x16x32_bf16 v[228:231], v[84:87], a[20:23], v[228:231]
  ds_read_b64_tr_b16 v[76:77], v8 offset:4096
  v_mul_f32 v136, v136, v168
  v_mfma_f32_16x16x32_bf16 v[228:231], v[88:91], a[36:39], v[228:231]
  ds_read_b64_tr_b16 v[78:79], v8 offset:6144
  v_mul_f32 v137, v137, v169
  v_mfma_f32_16x16x32_bf16 v[232:235], v[80:83], a[8:11], 0
  s_add_u32 m0, s33, 102400
  v_mul_f32 v138, v138, v170
  v_mfma_f32_16x16x32_bf16 v[232:235], v[84:87], a[24:27], v[232:235]
  s_mov_b32 s34, 4423808
  v_mul_f32 v139, v139, v171
  v_mfma_f32_16x16x32_bf16 v[232:235], v[88:91], a[40:43], v[232:235]
  buffer_load_dwordx4 v19, s[4:7], s34 offen lds
  v_cvt_pk_bf16_f32 v32, v136, v137
  v_mfma_f32_16x16x32_bf16 v[236:239], v[80:83], a[12:15], 0
  s_add_u32 m0, s33, 106496
  v_cvt_pk_bf16_f32 v33, v138, v139
  v_mfma_f32_16x16x32_bf16 v[236:239], v[84:87], a[28:31], v[236:239]
  s_mov_b32 s34, 4718720
  v_mul_f32 v152, v152, v184
  v_mfma_f32_16x16x32_bf16 v[236:239], v[88:91], a[44:47], v[236:239]
  buffer_load_dwordx4 v19, s[4:7], s34 offen lds
  s_waitcnt lgkmcnt(7)
  v_mfma_f32_16x16x32_bf16 v[240:243], v[56:59], a[0:3], 0
  ds_read_b64_tr_b16 v[80:81], v13 offset:28672
  v_mul_f32 v153, v153, v185
  v_mfma_f32_16x16x32_bf16 v[240:243], v[60:63], a[16:19], v[240:243]
  ds_read_b64_tr_b16 v[82:83], v13 offset:30720
  v_mul_f32 v154, v154, v186
  v_mfma_f32_16x16x32_bf16 v[240:243], v[64:67], a[32:35], v[240:243]
  ds_read_b64_tr_b16 v[84:85], v11
  v_mul_f32 v155, v155, v187
  v_mfma_f32_16x16x32_bf16 v[244:247], v[56:59], a[4:7], 0
  ds_read_b64_tr_b16 v[86:87], v11 offset:2048
  v_cvt_pk_bf16_f32 v34, v152, v153
  v_mfma_f32_16x16x32_bf16 v[244:247], v[60:63], a[20:23], v[244:247]
  ds_read_b64_tr_b16 v[88:89], v11 offset:4096
  v_cvt_pk_bf16_f32 v35, v154, v155
  v_mfma_f32_16x16x32_bf16 v[244:247], v[64:67], a[36:39], v[244:247]
  ds_read_b64_tr_b16 v[90:91], v11 offset:6144
  ds_write_b128 v17, v[32:35] offset:2048
  v_mfma_f32_16x16x32_bf16 v[248:251], v[56:59], a[8:11], 0
  s_add_u32 m0, s33, 110592
  v_mul_f32 v140, v140, v172
  v_mfma_f32_16x16x32_bf16 v[248:251], v[60:63], a[24:27], v[248:251]
  s_mov_b32 s34, 5013632
  v_mul_f32 v141, v141, v173
  v_mfma_f32_16x16x32_bf16 v[248:251], v[64:67], a[40:43], v[248:251]
  buffer_load_dwordx4 v19, s[4:7], s34 offen lds
  v_mul_f32 v142, v142, v174
  v_mfma_f32_16x16x32_bf16 v[252:255], v[56:59], a[12:15], 0
  v_mul_f32 v143, v143, v175
  v_mfma_f32_16x16x32_bf16 v[252:255], v[60:63], a[28:31], v[252:255]
  v_cvt_pk_bf16_f32 v36, v140, v141
  v_mfma_f32_16x16x32_bf16 v[252:255], v[64:67], a[44:47], v[252:255]
  v_cvt_pk_bf16_f32 v37, v142, v143
  s_waitcnt lgkmcnt(7)
  v_mfma_f32_16x16x32_bf16 v[192:195], v[68:71], a[48:51], v[192:195]
  s_waitcnt vmcnt(18)
  s_barrier
  v_mfma_f32_16x16x32_bf16 v[192:195], v[72:75], a[64:67], v[192:195]
  ds_read_b64_tr_b16 v[56:57], v8 offset:8192
  v_mul_f32 v156, v156, v188
  v_mfma_f32_16x16x32_bf16 v[192:195], v[76:79], a[80:83], v[192:195]
  ds_read_b64_tr_b16 v[58:59], v8 offset:10240
  v_mul_f32 v157, v157, v189
  v_mfma_f32_16x16x32_bf16 v[196:199], v[68:71], a[52:55], v[196:199]
  ds_read_b64_tr_b16 v[60:61], v8 offset:12288
  v_mul_f32 v158, v158, v190
  v_mfma_f32_16x16x32_bf16 v[196:199], v[72:75], a[68:71], v[196:199]
  ds_read_b64_tr_b16 v[62:63], v8 offset:14336
  v_mul_f32 v159, v159, v191
  v_mfma_f32_16x16x32_bf16 v[196:199], v[76:79], a[84:87], v[196:199]
  ds_read_b64_tr_b16 v[64:65], v8 offset:16384
  v_cvt_pk_bf16_f32 v38, v156, v157
  v_mfma_f32_16x16x32_bf16 v[200:203], v[68:71], a[56:59], v[200:203]
  ds_read_b64_tr_b16 v[66:67], v8 offset:18432
  v_cvt_pk_bf16_f32 v39, v158, v159
  v_mfma_f32_16x16x32_bf16 v[200:203], v[72:75], a[72:75], v[200:203]
  s_add_u32 m0, s33, 114688
  ds_write_b128 v17, v[36:39] offset:3072
  v_mfma_f32_16x16x32_bf16 v[200:203], v[76:79], a[88:91], v[200:203]
  s_mov_b32 s34, 4423808
  v_mfma_f32_16x16x32_bf16 v[204:207], v[68:71], a[60:63], v[204:207]
  buffer_load_dwordx4 v19, s[8:11], s34 offen lds
  v_mfma_f32_16x16x32_bf16 v[204:207], v[72:75], a[76:79], v[204:207]
  s_add_u32 m0, s33, 118784
  v_mfma_f32_16x16x32_bf16 v[204:207], v[76:79], a[92:95], v[204:207]
  s_mov_b32 s34, 4718720
  buffer_load_dwordx4 v19, s[8:11], s34 offen lds
  s_waitcnt lgkmcnt(8)
  v_mfma_f32_16x16x32_bf16 v[208:211], v[80:83], a[48:51], v[208:211]
  ds_read_b64_tr_b16 v[68:69], v11 offset:8192
  v_mfma_f32_16x16x32_bf16 v[208:211], v[84:87], a[64:67], v[208:211]
  ds_read_b64_tr_b16 v[70:71], v11 offset:10240
  v_mfma_f32_16x16x32_bf16 v[208:211], v[88:91], a[80:83], v[208:211]
  ds_read_b64_tr_b16 v[72:73], v11 offset:12288
  v_mfma_f32_16x16x32_bf16 v[212:215], v[80:83], a[52:55], v[212:215]
  ds_read_b64_tr_b16 v[74:75], v11 offset:14336
  v_mfma_f32_16x16x32_bf16 v[212:215], v[84:87], a[68:71], v[212:215]
  ds_read_b64_tr_b16 v[76:77], v11 offset:16384
  v_mfma_f32_16x16x32_bf16 v[212:215], v[88:91], a[84:87], v[212:215]
  ds_read_b64_tr_b16 v[78:79], v11 offset:18432
  v_mfma_f32_16x16x32_bf16 v[216:219], v[80:83], a[56:59], v[216:219]
  s_add_u32 m0, s33, 122880
  v_mfma_f32_16x16x32_bf16 v[216:219], v[84:87], a[72:75], v[216:219]
  s_mov_b32 s34, 5013632
  v_mfma_f32_16x16x32_bf16 v[216:219], v[88:91], a[88:91], v[216:219]
  buffer_load_dwordx4 v19, s[8:11], s34 offen lds
  v_mfma_f32_16x16x32_bf16 v[220:223], v[80:83], a[60:63], v[220:223]
  v_mfma_f32_16x16x32_bf16 v[220:223], v[84:87], a[76:79], v[220:223]
  v_mfma_f32_16x16x32_bf16 v[220:223], v[88:91], a[92:95], v[220:223]
  s_waitcnt lgkmcnt(7)
  v_mfma_f32_16x16x32_bf16 v[224:227], v[56:59], a[48:51], v[224:227]
  ds_read_b64_tr_b16 v[80:81], v8 offset:20480
  v_mfma_f32_16x16x32_bf16 v[224:227], v[60:63], a[64:67], v[224:227]
  ds_read_b64_tr_b16 v[82:83], v8 offset:22528
  v_mfma_f32_16x16x32_bf16 v[224:227], v[64:67], a[80:83], v[224:227]
  ds_read_b64_tr_b16 v[84:85], v8 offset:24576
  v_mfma_f32_16x16x32_bf16 v[228:231], v[56:59], a[52:55], v[228:231]
  ds_read_b64_tr_b16 v[86:87], v8 offset:26624
  v_mfma_f32_16x16x32_bf16 v[228:231], v[60:63], a[68:71], v[228:231]
  ds_read_b64_tr_b16 v[88:89], v8 offset:28672
  v_mfma_f32_16x16x32_bf16 v[228:231], v[64:67], a[84:87], v[228:231]
  ds_read_b64_tr_b16 v[90:91], v8 offset:30720
  v_mfma_f32_16x16x32_bf16 v[232:235], v[56:59], a[56:59], v[232:235]
  s_add_u32 m0, s33, 143360
  v_mfma_f32_16x16x32_bf16 v[232:235], v[60:63], a[72:75], v[232:235]
  s_mov_b32 s34, 256
  v_mfma_f32_16x16x32_bf16 v[232:235], v[64:67], a[88:91], v[232:235]
  buffer_load_dwordx4 v19, s[4:7], s34 offen lds
  v_mfma_f32_16x16x32_bf16 v[236:239], v[56:59], a[60:63], v[236:239]
  s_add_u32 m0, s33, 147456
  v_mfma_f32_16x16x32_bf16 v[236:239], v[60:63], a[76:79], v[236:239]
  s_mov_b32 s34, 295168
  v_mfma_f32_16x16x32_bf16 v[236:239], v[64:67], a[92:95], v[236:239]
  buffer_load_dwordx4 v19, s[4:7], s34 offen lds
  s_waitcnt lgkmcnt(6)
  v_mfma_f32_16x16x32_bf16 v[240:243], v[68:71], a[48:51], v[240:243]
  ds_read_b64_tr_b16 v[56:57], v11 offset:20480
  v_mfma_f32_16x16x32_bf16 v[240:243], v[72:75], a[64:67], v[240:243]
  ds_read_b64_tr_b16 v[58:59], v11 offset:22528
  v_mfma_f32_16x16x32_bf16 v[240:243], v[76:79], a[80:83], v[240:243]
  ds_read_b64_tr_b16 v[60:61], v11 offset:24576
  v_mfma_f32_16x16x32_bf16 v[244:247], v[68:71], a[52:55], v[244:247]
  ds_read_b64_tr_b16 v[62:63], v11 offset:26624
  v_mfma_f32_16x16x32_bf16 v[244:247], v[72:75], a[68:71], v[244:247]
  ds_read_b64_tr_b16 v[64:65], v11 offset:28672
  v_mfma_f32_16x16x32_bf16 v[244:247], v[76:79], a[84:87], v[244:247]
  ds_read_b64_tr_b16 v[66:67], v11 offset:30720
  v_mfma_f32_16x16x32_bf16 v[248:251], v[68:71], a[56:59], v[248:251]
  s_add_u32 m0, s33, 151552
  v_mfma_f32_16x16x32_bf16 v[248:251], v[72:75], a[72:75], v[248:251]
  s_mov_b32 s34, 590080
  v_mfma_f32_16x16x32_bf16 v[248:251], v[76:79], a[88:91], v[248:251]
  buffer_load_dwordx4 v19, s[4:7], s34 offen lds
  v_mfma_f32_16x16x32_bf16 v[252:255], v[68:71], a[60:63], v[252:255]
  v_mfma_f32_16x16x32_bf16 v[252:255], v[72:75], a[76:79], v[252:255]
  v_mfma_f32_16x16x32_bf16 v[252:255], v[76:79], a[92:95], v[252:255]
  s_waitcnt lgkmcnt(6)
  v_mfma_f32_16x16x32_bf16 v[192:195], v[80:83], a[96:99], v[192:195]
  s_waitcnt vmcnt(18)
  s_barrier
  v_mfma_f32_16x16x32_bf16 v[192:195], v[84:87], a[112:115], v[192:195]
  ds_read_b64_tr_b16 v[68:69], v8 offset:32768
  v_mfma_f32_16x16x32_bf16 v[192:195], v[88:91], a[128:131], v[192:195]
  ds_read_b64_tr_b16 v[70:71], v8 offset:34816
  v_mfma_f32_16x16x32_bf16 v[196:199], v[80:83], a[100:103], v[196:199]
  ds_read_b64_tr_b16 v[72:73], v8 offset:36864
  v_mfma_f32_16x16x32_bf16 v[196:199], v[84:87], a[116:119], v[196:199]
  ds_read_b64_tr_b16 v[74:75], v8 offset:38912
  v_mfma_f32_16x16x32_bf16 v[196:199], v[88:91], a[132:135], v[196:199]
  ds_read_b64_tr_b16 v[76:77], v8 offset:40960
  v_mfma_f32_16x16x32_bf16 v[200:203], v[80:83], a[104:107], v[200:203]
  ds_read_b64_tr_b16 v[78:79], v8 offset:43008
  v_mfma_f32_16x16x32_bf16 v[200:203], v[84:87], a[120:123], v[200:203]
  s_add_u32 m0, s33, 155648
  v_mfma_f32_16x16x32_bf16 v[200:203], v[88:91], a[136:139], v[200:203]
  s_mov_b32 s34, 256
  v_mfma_f32_16x16x32_bf16 v[204:207], v[80:83], a[108:111], v[204:207]
  buffer_load_dwordx4 v19, s[8:11], s34 offen lds
  v_mfma_f32_16x16x32_bf16 v[204:207], v[84:87], a[124:127], v[204:207]
  s_add_u32 m0, s33, 159744
  v_mfma_f32_16x16x32_bf16 v[204:207], v[88:91], a[140:143], v[204:207]
  s_mov_b32 s34, 295168
  buffer_load_dwordx4 v19, s[8:11], s34 offen lds
  s_waitcnt lgkmcnt(6)
  v_mfma_f32_16x16x32_bf16 v[208:211], v[56:59], a[96:99], v[208:211]
  ds_read_b64_tr_b16 v[80:81], v11 offset:32768
  v_mfma_f32_16x16x32_bf16 v[208:211], v[60:63], a[112:115], v[208:211]
  ds_read_b64_tr_b16 v[82:83], v11 offset:34816
  v_mfma_f32_16x16x32_bf16 v[208:211], v[64:67], a[128:131], v[208:211]
  ds_read_b64_tr_b16 v[84:85], v11 offset:36864
  v_mfma_f32_16x16x32_bf16 v[212:215], v[56:59], a[100:103], v[212:215]
  ds_read_b64_tr_b16 v[86:87], v11 offset:38912
  v_mfma_f32_16x16x32_bf16 v[212:215], v[60:63], a[116:119], v[212:215]
  ds_read_b64_tr_b16 v[88:89], v11 offset:40960
  v_mfma_f32_16x16x32_bf16 v[212:215], v[64:67], a[132:135], v[212:215]
  ds_read_b64_tr_b16 v[90:91], v11 offset:43008
  v_mfma_f32_16x16x32_bf16 v[216:219], v[56:59], a[104:107], v[216:219]
  s_add_u32 m0, s33, 0
  v_mfma_f32_16x16x32_bf16 v[216:219], v[60:63], a[120:123], v[216:219]
  s_mov_b32 s34, 590080
  v_mfma_f32_16x16x32_bf16 v[216:219], v[64:67], a[136:139], v[216:219]
  buffer_load_dwordx4 v19, s[8:11], s34 offen lds
  v_mfma_f32_16x16x32_bf16 v[220:223], v[56:59], a[108:111], v[220:223]
  v_mfma_f32_16x16x32_bf16 v[220:223], v[60:63], a[124:127], v[220:223]
  v_mfma_f32_16x16x32_bf16 v[220:223], v[64:67], a[140:143], v[220:223]
  s_waitcnt lgkmcnt(6)
  v_mfma_f32_16x16x32_bf16 v[224:227], v[68:71], a[96:99], v[224:227]
  ds_read_b64_tr_b16 v[56:57], v8 offset:45056
  v_mfma_f32_16x16x32_bf16 v[224:227], v[72:75], a[112:115], v[224:227]
  ds_read_b64_tr_b16 v[58:59], v8 offset:47104
  v_mfma_f32_16x16x32_bf16 v[224:227], v[76:79], a[128:131], v[224:227]
  ds_read_b64_tr_b16 v[60:61], v8 offset:49152
  v_mfma_f32_16x16x32_bf16 v[228:231], v[68:71], a[100:103], v[228:231]
  ds_read_b64_tr_b16 v[62:63], v8 offset:51200
  v_mfma_f32_16x16x32_bf16 v[228:231], v[72:75], a[116:119], v[228:231]
  ds_read_b64_tr_b16 v[64:65], v8 offset:53248
  v_mfma_f32_16x16x32_bf16 v[228:231], v[76:79], a[132:135], v[228:231]
  ds_read_b64_tr_b16 v[66:67], v8 offset:55296
  v_mfma_f32_16x16x32_bf16 v[232:235], v[68:71], a[104:107], v[232:235]
  s_add_u32 m0, s33, 4096
  v_mfma_f32_16x16x32_bf16 v[232:235], v[72:75], a[120:123], v[232:235]
  s_mov_b32 s34, 884992
  v_mfma_f32_16x16x32_bf16 v[232:235], v[76:79], a[136:139], v[232:235]
  buffer_load_dwordx4 v19, s[4:7], s34 offen lds
  v_mfma_f32_16x16x32_bf16 v[236:239], v[68:71], a[108:111], v[236:239]
  s_add_u32 m0, s33, 8192
  v_mfma_f32_16x16x32_bf16 v[236:239], v[72:75], a[124:127], v[236:239]
  s_mov_b32 s34, 1179904
  v_mfma_f32_16x16x32_bf16 v[236:239], v[76:79], a[140:143], v[236:239]
  buffer_load_dwordx4 v19, s[4:7], s34 offen lds
  s_waitcnt lgkmcnt(6)
  v_mfma_f32_16x16x32_bf16 v[240:243], v[80:83], a[96:99], v[240:243]
  ds_read_b64_tr_b16 v[68:69], v11 offset:45056
  v_mfma_f32_16x16x32_bf16 v[240:243], v[84:87], a[112:115], v[240:243]
  ds_read_b64_tr_b16 v[70:71], v11 offset:47104
  v_mfma_f32_16x16x32_bf16 v[240:243], v[88:91], a[128:131], v[240:243]
  ds_read_b64_tr_b16 v[72:73], v11 offset:49152
  v_mfma_f32_16x16x32_bf16 v[244:247], v[80:83], a[100:103], v[244:247]
  ds_read_b64_tr_b16 v[74:75], v11 offset:51200
  v_mfma_f32_16x16x32_bf16 v[244:247], v[84:87], a[116:119], v[244:247]
  ds_read_b64_tr_b16 v[76:77], v11 offset:53248
  v_mfma_f32_16x16x32_bf16 v[244:247], v[88:91], a[132:135], v[244:247]
  ds_read_b64_tr_b16 v[78:79], v11 offset:55296
  v_mfma_f32_16x16x32_bf16 v[248:251], v[80:83], a[104:107], v[248:251]
  s_add_u32 m0, s33, 12288
  v_mfma_f32_16x16x32_bf16 v[248:251], v[84:87], a[120:123], v[248:251]
  s_mov_b32 s34, 1474816
  v_mfma_f32_16x16x32_bf16 v[248:251], v[88:91], a[136:139], v[248:251]
  buffer_load_dwordx4 v19, s[4:7], s34 offen lds
  v_mfma_f32_16x16x32_bf16 v[252:255], v[80:83], a[108:111], v[252:255]
  v_mfma_f32_16x16x32_bf16 v[252:255], v[84:87], a[124:127], v[252:255]
  v_mfma_f32_16x16x32_bf16 v[252:255], v[88:91], a[140:143], v[252:255]
  s_waitcnt lgkmcnt(6)
  v_mfma_f32_16x16x32_bf16 v[192:195], v[56:59], a[144:147], v[192:195]
  s_waitcnt vmcnt(18)
  s_barrier
  v_mfma_f32_16x16x32_bf16 v[192:195], v[60:63], a[160:163], v[192:195]
  ds_read_b64_tr_b16 v[80:81], v8 offset:57344
  v_mfma_f32_16x16x32_bf16 v[192:195], v[64:67], a[176:179], v[192:195]
  ds_read_b64_tr_b16 v[82:83], v8 offset:59392
  v_mfma_f32_16x16x32_bf16 v[196:199], v[56:59], a[148:151], v[196:199]
  ds_read_b64_tr_b16 v[84:85], v8 offset:61440
  v_mfma_f32_16x16x32_bf16 v[196:199], v[60:63], a[164:167], v[196:199]
  ds_read_b64_tr_b16 v[86:87], v8 offset:63488
  v_mfma_f32_16x16x32_bf16 v[196:199], v[64:67], a[180:183], v[196:199]
  ds_read_b64_tr_b16 v[88:89], v9
  v_mfma_f32_16x16x32_bf16 v[200:203], v[56:59], a[152:155], v[200:203]
  ds_read_b64_tr_b16 v[90:91], v9 offset:2048
  v_mfma_f32_16x16x32_bf16 v[200:203], v[60:63], a[168:171], v[200:203]
  s_add_u32 m0, s33, 16384
  v_mfma_f32_16x16x32_bf16 v[200:203], v[64:67], a[184:187], v[200:203]
  s_mov_b32 s34, 884992
  v_mfma_f32_16x16x32_bf16 v[204:207], v[56:59], a[156:159], v[204:207]
  buffer_load_dwordx4 v19, s[8:11], s34 offen lds
  v_mfma_f32_16x16x32_bf16 v[204:207], v[60:63], a[172:175], v[204:207]
  s_add_u32 m0, s33, 20480
  v_mfma_f32_16x16x32_bf16 v[204:207], v[64:67], a[188:191], v[204:207]
  s_mov_b32 s34, 1179904
  buffer_load_dwordx4 v19, s[8:11], s34 offen lds
  s_waitcnt lgkmcnt(6)
  v_mfma_f32_16x16x32_bf16 v[208:211], v[68:71], a[144:147], v[208:211]
  ds_read_b64_tr_b16 v[56:57], v11 offset:57344
  v_mfma_f32_16x16x32_bf16 v[208:211], v[72:75], a[160:163], v[208:211]
  ds_read_b64_tr_b16 v[58:59], v11 offset:59392
  v_mfma_f32_16x16x32_bf16 v[208:211], v[76:79], a[176:179], v[208:211]
  ds_read_b64_tr_b16 v[60:61], v11 offset:61440
  v_mfma_f32_16x16x32_bf16 v[212:215], v[68:71], a[148:151], v[212:215]
  ds_read_b64_tr_b16 v[62:63], v11 offset:63488
  v_mfma_f32_16x16x32_bf16 v[212:215], v[72:75], a[164:167], v[212:215]
  ds_read_b64_tr_b16 v[64:65], v12
  v_mfma_f32_16x16x32_bf16 v[212:215], v[76:79], a[180:183], v[212:215]
  ds_read_b64_tr_b16 v[66:67], v12 offset:2048
  v_mfma_f32_16x16x32_bf16 v[216:219], v[68:71], a[152:155], v[216:219]
  s_add_u32 m0, s33, 24576
  v_mfma_f32_16x16x32_bf16 v[216:219], v[72:75], a[168:171], v[216:219]
  s_mov_b32 s34, 1474816
  v_mfma_f32_16x16x32_bf16 v[216:219], v[76:79], a[184:187], v[216:219]
  buffer_load_dwordx4 v19, s[8:11], s34 offen lds
  v_mfma_f32_16x16x32_bf16 v[220:223], v[68:71], a[156:159], v[220:223]
  v_mfma_f32_16x16x32_bf16 v[220:223], v[72:75], a[172:175], v[220:223]
  v_mfma_f32_16x16x32_bf16 v[220:223], v[76:79], a[188:191], v[220:223]
  s_waitcnt lgkmcnt(6)
  v_mfma_f32_16x16x32_bf16 v[224:227], v[80:83], a[144:147], v[224:227]
  ds_read_b64_tr_b16 v[68:69], v9 offset:4096
  v_mfma_f32_16x16x32_bf16 v[224:227], v[84:87], a[160:163], v[224:227]
  ds_read_b64_tr_b16 v[70:71], v9 offset:6144
  v_mfma_f32_16x16x32_bf16 v[224:227], v[88:91], a[176:179], v[224:227]
  ds_read_b64_tr_b16 v[72:73], v9 offset:8192
  v_mfma_f32_16x16x32_bf16 v[228:231], v[80:83], a[148:151], v[228:231]
  ds_read_b64_tr_b16 v[74:75], v9 offset:10240
  v_mfma_f32_16x16x32_bf16 v[228:231], v[84:87], a[164:167], v[228:231]
  ds_read_b64_tr_b16 v[76:77], v9 offset:12288
  v_mfma_f32_16x16x32_bf16 v[228:231], v[88:91], a[180:183], v[228:231]
  ds_read_b64_tr_b16 v[78:79], v9 offset:14336
  v_mfma_f32_16x16x32_bf16 v[232:235], v[80:83], a[152:155], v[232:235]
  s_add_u32 m0, s33, 28672
  v_mfma_f32_16x16x32_bf16 v[232:235], v[84:87], a[168:171], v[232:235]
  s_mov_b32 s34, 1769728
  v_mfma_f32_16x16x32_bf16 v[232:235], v[88:91], a[184:187], v[232:235]
  buffer_load_dwordx4 v19, s[4:7], s34 offen lds
  v_mfma_f32_16x16x32_bf16 v[236:239], v[80:83], a[156:159], v[236:239]
  s_add_u32 m0, s33, 32768
  v_mfma_f32_16x16x32_bf16 v[236:239], v[84:87], a[172:175], v[236:239]
  s_mov_b32 s34, 2064640
  v_mfma_f32_16x16x32_bf16 v[236:239], v[88:91], a[188:191], v[236:239]
  buffer_load_dwordx4 v19, s[4:7], s34 offen lds
  s_waitcnt lgkmcnt(6)
  v_mfma_f32_16x16x32_bf16 v[240:243], v[56:59], a[144:147], v[240:243]
  ds_read_b64_tr_b16 v[80:81], v12 offset:4096
  v_mfma_f32_16x16x32_bf16 v[240:243], v[60:63], a[160:163], v[240:243]
  ds_read_b64_tr_b16 v[82:83], v12 offset:6144
  v_mfma_f32_16x16x32_bf16 v[240:243], v[64:67], a[176:179], v[240:243]
  ds_read_b64_tr_b16 v[84:85], v12 offset:8192
  v_mfma_f32_16x16x32_bf16 v[244:247], v[56:59], a[148:151], v[244:247]
  ds_read_b64_tr_b16 v[86:87], v12 offset:10240
  v_mfma_f32_16x16x32_bf16 v[244:247], v[60:63], a[164:167], v[244:247]
  ds_read_b64_tr_b16 v[88:89], v12 offset:12288
  v_mfma_f32_16x16x32_bf16 v[244:247], v[64:67], a[180:183], v[244:247]
  ds_read_b64_tr_b16 v[90:91], v12 offset:14336
  v_mfma_f32_16x16x32_bf16 v[248:251], v[56:59], a[152:155], v[248:251]
  s_add_u32 m0, s33, 36864
  v_mfma_f32_16x16x32_bf16 v[248:251], v[60:63], a[168:171], v[248:251]
  s_mov_b32 s34, 2359552
  v_mfma_f32_16x16x32_bf16 v[248:251], v[64:67], a[184:187], v[248:251]
  buffer_load_dwordx4 v19, s[4:7], s34 offen lds
  v_mfma_f32_16x16x32_bf16 v[252:255], v[56:59], a[156:159], v[252:255]
  v_mfma_f32_16x16x32_bf16 v[252:255], v[60:63], a[172:175], v[252:255]
  v_mfma_f32_16x16x32_bf16 v[252:255], v[64:67], a[188:191], v[252:255]
  s_waitcnt lgkmcnt(6)
  v_mfma_f32_16x16x32_bf16 v[192:195], v[68:71], a[192:195], v[192:195]
  s_waitcnt vmcnt(18)
  s_barrier
  v_mfma_f32_16x16x32_bf16 v[192:195], v[72:75], a[208:211], v[192:195]
  ds_read_b64_tr_b16 v[56:57], v9 offset:16384
  v_mfma_f32_16x16x32_bf16 v[192:195], v[76:79], a[224:227], v[192:195]
  ds_read_b64_tr_b16 v[58:59], v9 offset:18432
  v_mfma_f32_16x16x32_bf16 v[196:199], v[68:71], a[196:199], v[196:199]
  ds_read_b64_tr_b16 v[60:61], v9 offset:20480
  v_mfma_f32_16x16x32_bf16 v[196:199], v[72:75], a[212:215], v[196:199]
  ds_read_b64_tr_b16 v[62:63], v9 offset:22528
  v_mfma_f32_16x16x32_bf16 v[196:199], v[76:79], a[228:231], v[196:199]
  ds_read_b64_tr_b16 v[64:65], v9 offset:32768
  v_mfma_f32_16x16x32_bf16 v[200:203], v[68:71], a[200:203], v[200:203]
  ds_read_b64_tr_b16 v[66:67], v9 offset:34816
  v_mfma_f32_16x16x32_bf16 v[200:203], v[72:75], a[216:219], v[200:203]
  s_add_u32 m0, s33, 40960
  v_mfma_f32_16x16x32_bf16 v[200:203], v[76:79], a[232:235], v[200:203]
  s_mov_b32 s34, 1769728
  v_mfma_f32_16x16x32_bf16 v[204:207], v[68:71], a[204:207], v[204:207]
  buffer_load_dwordx4 v19, s[8:11], s34 offen lds
  v_mfma_f32_16x16x32_bf16 v[204:207], v[72:75], a[220:223], v[204:207]
  s_add_u32 m0, s33, 45056
  v_mfma_f32_16x16x32_bf16 v[204:207], v[76:79], a[236:239], v[204:207]
  s_mov_b32 s34, 2064640
  buffer_load_dwordx4 v19, s[8:11], s34 offen lds
  s_waitcnt lgkmcnt(6)
  v_mfma_f32_16x16x32_bf16 v[208:211], v[80:83], a[192:195], v[208:211]
  ds_read_b64_tr_b16 v[68:69], v12 offset:16384
  v_mfma_f32_16x16x32_bf16 v[208:211], v[84:87], a[208:211], v[208:211]
  ds_read_b64_tr_b16 v[70:71], v12 offset:18432
  v_mfma_f32_16x16x32_bf16 v[208:211], v[88:91], a[224:227], v[208:211]
  ds_read_b64_tr_b16 v[72:73], v12 offset:20480
  v_mfma_f32_16x16x32_bf16 v[212:215], v[80:83], a[196:199], v[212:215]
  ds_read_b64_tr_b16 v[74:75], v12 offset:22528
  v_mfma_f32_16x16x32_bf16 v[212:215], v[84:87], a[212:215], v[212:215]
  ds_read_b64_tr_b16 v[76:77], v12 offset:32768
  v_mfma_f32_16x16x32_bf16 v[212:215], v[88:91], a[228:231], v[212:215]
  ds_read_b64_tr_b16 v[78:79], v12 offset:34816
  v_mfma_f32_16x16x32_bf16 v[216:219], v[80:83], a[200:203], v[216:219]
  s_add_u32 m0, s33, 49152
  v_mfma_f32_16x16x32_bf16 v[216:219], v[84:87], a[216:219], v[216:219]
  s_mov_b32 s34, 2359552
  v_mfma_f32_16x16x32_bf16 v[216:219], v[88:91], a[232:235], v[216:219]
  buffer_load_dwordx4 v19, s[8:11], s34 offen lds
  v_mfma_f32_16x16x32_bf16 v[220:223], v[80:83], a[204:207], v[220:223]
  v_mfma_f32_16x16x32_bf16 v[220:223], v[84:87], a[220:223], v[220:223]
  v_mfma_f32_16x16x32_bf16 v[220:223], v[88:91], a[236:239], v[220:223]
  s_waitcnt lgkmcnt(6)
  v_mfma_f32_16x16x32_bf16 v[224:227], v[56:59], a[192:195], v[224:227]
  ds_read_b64_tr_b16 v[80:81], v9 offset:36864
  v_mfma_f32_16x16x32_bf16 v[224:227], v[60:63], a[208:211], v[224:227]
  ds_read_b64_tr_b16 v[82:83], v9 offset:38912
  v_mfma_f32_16x16x32_bf16 v[224:227], v[64:67], a[224:227], v[224:227]
  ds_read_b64_tr_b16 v[84:85], v9 offset:40960
  v_mfma_f32_16x16x32_bf16 v[228:231], v[56:59], a[196:199], v[228:231]
  ds_read_b64_tr_b16 v[86:87], v9 offset:43008
  v_mfma_f32_16x16x32_bf16 v[228:231], v[60:63], a[212:215], v[228:231]
  ds_read_b64_tr_b16 v[88:89], v9 offset:45056
  v_mfma_f32_16x16x32_bf16 v[228:231], v[64:67], a[228:231], v[228:231]
  ds_read_b64_tr_b16 v[90:91], v9 offset:47104
  v_mfma_f32_16x16x32_bf16 v[232:235], v[56:59], a[200:203], v[232:235]
  s_add_u32 m0, s33, 53248
  v_mfma_f32_16x16x32_bf16 v[232:235], v[60:63], a[216:219], v[232:235]
  s_mov_b32 s34, 2654464
  v_mfma_f32_16x16x32_bf16 v[232:235], v[64:67], a[232:235], v[232:235]
  buffer_load_dwordx4 v19, s[4:7], s34 offen lds
  v_mfma_f32_16x16x32_bf16 v[236:239], v[56:59], a[204:207], v[236:239]
  s_add_u32 m0, s33, 57344
  v_mfma_f32_16x16x32_bf16 v[236:239], v[60:63], a[220:223], v[236:239]
  s_mov_b32 s34, 2949376
  v_mfma_f32_16x16x32_bf16 v[236:239], v[64:67], a[236:239], v[236:239]
  buffer_load_dwordx4 v19, s[4:7], s34 offen lds
  s_waitcnt lgkmcnt(6)
  v_mfma_f32_16x16x32_bf16 v[240:243], v[68:71], a[192:195], v[240:243]
  ds_read_b64_tr_b16 v[56:57], v12 offset:36864
  v_mfma_f32_16x16x32_bf16 v[240:243], v[72:75], a[208:211], v[240:243]
  ds_read_b64_tr_b16 v[58:59], v12 offset:38912
  v_mfma_f32_16x16x32_bf16 v[240:243], v[76:79], a[224:227], v[240:243]
  ds_read_b64_tr_b16 v[60:61], v12 offset:40960
  v_mfma_f32_16x16x32_bf16 v[244:247], v[68:71], a[196:199], v[244:247]
  ds_read_b64_tr_b16 v[62:63], v12 offset:43008
  v_mfma_f32_16x16x32_bf16 v[244:247], v[72:75], a[212:215], v[244:247]
  ds_read_b64_tr_b16 v[64:65], v12 offset:45056
  v_mfma_f32_16x16x32_bf16 v[244:247], v[76:79], a[228:231], v[244:247]
  ds_read_b64_tr_b16 v[66:67], v12 offset:47104
  v_mfma_f32_16x16x32_bf16 v[248:251], v[68:71], a[200:203], v[248:251]
  s_add_u32 m0, s33, 61440
  v_mfma_f32_16x16x32_bf16 v[248:251], v[72:75], a[216:219], v[248:251]
  s_mov_b32 s34, 3244288
  v_mfma_f32_16x16x32_bf16 v[248:251], v[76:79], a[232:235], v[248:251]
  buffer_load_dwordx4 v19, s[4:7], s34 offen lds
  v_mfma_f32_16x16x32_bf16 v[252:255], v[68:71], a[204:207], v[252:255]
  v_mfma_f32_16x16x32_bf16 v[252:255], v[72:75], a[220:223], v[252:255]
  v_mfma_f32_16x16x32_bf16 v[252:255], v[76:79], a[236:239], v[252:255]
  s_waitcnt lgkmcnt(6)
  v_mfma_f32_16x16x32_bf16 v[192:195], v[80:83], a[240:243], v[192:195]
  s_waitcnt vmcnt(18)
  s_barrier
  v_mfma_f32_16x16x32_bf16 v[192:195], v[84:87], v[96:99], v[192:195]
  ds_read_b64_tr_b16 v[68:69], v9 offset:49152
  v_mfma_f32_16x16x32_bf16 v[192:195], v[88:91], v[112:115], v[192:195]
  ds_read_b64_tr_b16 v[70:71], v9 offset:51200
  v_mfma_f32_16x16x32_bf16 v[196:199], v[80:83], a[244:247], v[196:199]
  ds_read_b64_tr_b16 v[72:73], v9 offset:53248
  v_mfma_f32_16x16x32_bf16 v[196:199], v[84:87], v[100:103], v[196:199]
  ds_read_b64_tr_b16 v[74:75], v9 offset:55296
  v_mfma_f32_16x16x32_bf16 v[196:199], v[88:91], v[116:119], v[196:199]
  ds_read_b64_tr_b16 v[76:77], v9 offset:57344
  v_mfma_f32_16x16x32_bf16 v[200:203], v[80:83], a[248:251], v[200:203]
  ds_read_b64_tr_b16 v[78:79], v9 offset:59392
  v_mfma_f32_16x16x32_bf16 v[200:203], v[84:87], v[104:107], v[200:203]
  s_add_u32 m0, s33, 65536
  v_mfma_f32_16x16x32_bf16 v[200:203], v[88:91], v[120:123], v[200:203]
  s_mov_b32 s34, 2654464
  v_mfma_f32_16x16x32_bf16 v[204:207], v[80:83], a[252:255], v[204:207]
  buffer_load_dwordx4 v19, s[8:11], s34 offen lds
  v_mfma_f32_16x16x32_bf16 v[204:207], v[84:87], v[108:111], v[204:207]
  s_add_u32 m0, s33, 69632
  v_mfma_f32_16x16x32_bf16 v[204:207], v[88:91], v[124:127], v[204:207]
  s_mov_b32 s34, 2949376
  buffer_load_dwordx4 v19, s[8:11], s34 offen lds
  s_waitcnt lgkmcnt(6)
  v_mfma_f32_16x16x32_bf16 v[208:211], v[56:59], a[240:243], v[208:211]
  ds_read_b64_tr_b16 v[80:81], v12 offset:49152
  v_mfma_f32_16x16x32_bf16 v[208:211], v[60:63], v[96:99], v[208:211]
  ds_read_b64_tr_b16 v[82:83], v12 offset:51200
  v_mfma_f32_16x16x32_bf16 v[208:211], v[64:67], v[112:115], v[208:211]
  ds_read_b64_tr_b16 v[84:85], v12 offset:53248
  v_mfma_f32_16x16x32_bf16 v[212:215], v[56:59], a[244:247], v[212:215]
  ds_read_b64_tr_b16 v[86:87], v12 offset:55296
  v_mfma_f32_16x16x32_bf16 v[212:215], v[60:63], v[100:103], v[212:215]
  ds_read_b64_tr_b16 v[88:89], v12 offset:57344
  v_mfma_f32_16x16x32_bf16 v[212:215], v[64:67], v[116:119], v[212:215]
  ds_read_b64_tr_b16 v[90:91], v12 offset:59392
  v_mfma_f32_16x16x32_bf16 v[216:219], v[56:59], a[248:251], v[216:219]
  s_add_u32 m0, s33, 73728
  v_mfma_f32_16x16x32_bf16 v[216:219], v[60:63], v[104:107], v[216:219]
  s_mov_b32 s34, 3244288
  v_mfma_f32_16x16x32_bf16 v[216:219], v[64:67], v[120:123], v[216:219]
  buffer_load_dwordx4 v19, s[8:11], s34 offen lds
  v_mfma_f32_16x16x32_bf16 v[220:223], v[56:59], a[252:255], v[220:223]
  v_mfma_f32_16x16x32_bf16 v[220:223], v[60:63], v[108:111], v[220:223]
  v_mfma_f32_16x16x32_bf16 v[220:223], v[64:67], v[124:127], v[220:223]
  s_waitcnt lgkmcnt(6)
  v_mfma_f32_16x16x32_bf16 v[224:227], v[68:71], a[240:243], v[224:227]
  ds_read_b64_tr_b16 v[56:57], v10 offset:12288
  v_mfma_f32_16x16x32_bf16 v[224:227], v[72:75], v[96:99], v[224:227]
  ds_read_b64_tr_b16 v[58:59], v10 offset:14336
  v_mfma_f32_16x16x32_bf16 v[224:227], v[76:79], v[112:115], v[224:227]
  ds_read_b64_tr_b16 v[60:61], v10 offset:16384
  v_mfma_f32_16x16x32_bf16 v[228:231], v[68:71], a[244:247], v[228:231]
  ds_read_b64_tr_b16 v[62:63], v10 offset:18432
  v_mfma_f32_16x16x32_bf16 v[228:231], v[72:75], v[100:103], v[228:231]
  ds_read_b64_tr_b16 v[64:65], v10 offset:20480
  v_mfma_f32_16x16x32_bf16 v[228:231], v[76:79], v[116:119], v[228:231]
  ds_read_b64_tr_b16 v[66:67], v10 offset:22528
  v_mfma_f32_16x16x32_bf16 v[232:235], v[68:71], a[248:251], v[232:235]
  s_add_u32 m0, s33, 77824
  v_mfma_f32_16x16x32_bf16 v[232:235], v[72:75], v[104:107], v[232:235]
  s_mov_b32 s34, 3539200
  v_mfma_f32_16x16x32_bf16 v[232:235], v[76:79], v[120:123], v[232:235]
  buffer_load_dwordx4 v19, s[4:7], s34 offen lds
  v_mfma_f32_16x16x32_bf16 v[236:239], v[68:71], a[252:255], v[236:239]
  s_add_u32 m0, s33, 81920
  v_mfma_f32_16x16x32_bf16 v[236:239], v[72:75], v[108:111], v[236:239]
  s_mov_b32 s34, 3834112
  v_mfma_f32_16x16x32_bf16 v[236:239], v[76:79], v[124:127], v[236:239]
  buffer_load_dwordx4 v19, s[4:7], s34 offen lds
  s_waitcnt lgkmcnt(6)
  v_mfma_f32_16x16x32_bf16 v[240:243], v[80:83], a[240:243], v[240:243]
  ds_read_b64_tr_b16 v[68:69], v13 offset:12288
  v_mfma_f32_16x16x32_bf16 v[240:243], v[84:87], v[96:99], v[240:243]
  ds_read_b64_tr_b16 v[70:71], v13 offset:14336
  v_mfma_f32_16x16x32_bf16 v[240:243], v[88:91], v[112:115], v[240:243]
  ds_read_b64_tr_b16 v[72:73], v13 offset:16384
  v_mfma_f32_16x16x32_bf16 v[244:247], v[80:83], a[244:247], v[244:247]
  ds_read_b64_tr_b16 v[74:75], v13 offset:18432
  v_mfma_f32_16x16x32_bf16 v[244:247], v[84:87], v[100:103], v[244:247]
  ds_read_b64_tr_b16 v[76:77], v13 offset:20480
  v_mfma_f32_16x16x32_bf16 v[244:247], v[88:91], v[116:119], v[244:247]
  ds_read_b64_tr_b16 v[78:79], v13 offset:22528
  v_mfma_f32_16x16x32_bf16 v[248:251], v[80:83], a[248:251], v[248:251]
  s_add_u32 m0, s33, 86016
  v_mfma_f32_16x16x32_bf16 v[248:251], v[84:87], v[104:107], v[248:251]
  s_mov_b32 s34, 4129024
  v_mfma_f32_16x16x32_bf16 v[248:251], v[88:91], v[120:123], v[248:251]
  buffer_load_dwordx4 v19, s[4:7], s34 offen lds
  v_mfma_f32_16x16x32_bf16 v[252:255], v[80:83], a[252:255], v[252:255]
  v_mfma_f32_16x16x32_bf16 v[252:255], v[84:87], v[108:111], v[252:255]
  v_mfma_f32_16x16x32_bf16 v[252:255], v[88:91], v[124:127], v[252:255]
  s_waitcnt lgkmcnt(6)
  v_mfma_f32_16x16x32_bf16 v[128:131], v[56:59], a[0:3], 0
  s_waitcnt vmcnt(18)
  s_barrier
  v_mfma_f32_16x16x32_bf16 v[128:131], v[60:63], a[16:19], v[128:131]
  ds_read_b64_tr_b16 v[80:81], v10 offset:24576
  v_mul_f32 v192, v192, v224
  v_mfma_f32_16x16x32_bf16 v[128:131], v[64:67], a[32:35], v[128:131]
  ds_read_b64_tr_b16 v[82:83], v10 offset:26624
  v_mul_f32 v193, v193, v225
  v_mfma_f32_16x16x32_bf16 v[132:135], v[56:59], a[4:7], 0
  ds_read_b64_tr_b16 v[84:85], v10 offset:28672
  v_mul_f32 v194, v194, v226
  v_mfma_f32_16x16x32_bf16 v[132:135], v[60:63], a[20:23], v[132:135]
  ds_read_b64_tr_b16 v[86:87], v10 offset:30720
  v_mul_f32 v195, v195, v227
  v_mfma_f32_16x16x32_bf16 v[132:135], v[64:67], a[36:39], v[132:135]
  ds_read_b64_tr_b16 v[88:89], v8
  v_cvt_pk_bf16_f32 v32, v192, v193
  v_mfma_f32_16x16x32_bf16 v[136:139], v[56:59], a[8:11], 0
  ds_read_b64_tr_b16 v[90:91], v8 offset:2048
  v_cvt_pk_bf16_f32 v33, v194, v195
  v_mfma_f32_16x16x32_bf16 v[136:139], v[60:63], a[24:27], v[136:139]
  s_add_u32 m0, s33, 106496
  v_mul_f32 v208, v208, v240
  v_mfma_f32_16x16x32_bf16 v[136:139], v[64:67], a[40:43], v[136:139]
  s_mov_b32 s34, 3539200
  v_mul_f32 v209, v209, v241
  v_mfma_f32_16x16x32_bf16 v[140:143], v[56:59], a[12:15], 0
  buffer_load_dwordx4 v19, s[8:11], s34 offen lds
  v_mul_f32 v210, v210, v242
  v_mfma_f32_16x16x32_bf16 v[140:143], v[60:63], a[28:31], v[140:143]
  s_add_u32 m0, s33, 110592
  v_mul_f32 v211, v211, v243
  v_mfma_f32_16x16x32_bf16 v[140:143], v[64:67], a[44:47], v[140:143]
  s_mov_b32 s34, 3834112
  buffer_load_dwordx4 v19, s[8:11], s34 offen lds
  s_waitcnt lgkmcnt(6)
  v_mfma_f32_16x16x32_bf16 v[144:147], v[68:71], a[0:3], 0
  ds_read_b64_tr_b16 v[56:57], v13 offset:24576
  v_cvt_pk_bf16_f32 v34, v208, v209
  v_mfma_f32_16x16x32_bf16 v[144:147], v[72:75], a[16:19], v[144:147]
  ds_read_b64_tr_b16 v[58:59], v13 offset:26624
  v_cvt_pk_bf16_f32 v35, v210, v211
  v_mfma_f32_16x16x32_bf16 v[144:147], v[76:79], a[32:35], v[144:147]
  ds_read_b64_tr_b16 v[60:61], v13 offset:28672
  ds_write_b128 v17, v[32:35] offset:8192
  v_mfma_f32_16x16x32_bf16 v[148:151], v[68:71], a[4:7], 0
  ds_read_b64_tr_b16 v[62:63], v13 offset:30720
  v_mul_f32 v196, v196, v228
  v_mfma_f32_16x16x32_bf16 v[148:151], v[72:75], a[20:23], v[148:151]
  ds_read_b64_tr_b16 v[64:65], v11
  v_mul_f32 v197, v197, v229
  v_mfma_f32_16x16x32_bf16 v[148:151], v[76:79], a[36:39], v[148:151]
  ds_read_b64_tr_b16 v[66:67], v11 offset:2048
  v_mul_f32 v198, v198, v230
  v_mfma_f32_16x16x32_bf16 v[152:155], v[68:71], a[8:11], 0
  s_add_u32 m0, s33, 114688
  v_mul_f32 v199, v199, v231
  v_mfma_f32_16x16x32_bf16 v[152:155], v[72:75], a[24:27], v[152:155]
  s_mov_b32 s34, 4129024
  v_cvt_pk_bf16_f32 v36, v196, v197
  v_mfma_f32_16x16x32_bf16 v[152:155], v[76:79], a[40:43], v[152:155]
  buffer_load_dwordx4 v19, s[8:11], s34 offen lds
  v_cvt_pk_bf16_f32 v37, v198, v199
  v_mfma_f32_16x16x32_bf16 v[156:159], v[68:71], a[12:15], 0
  v_mul_f32 v212, v212, v244
  v_mfma_f32_16x16x32_bf16 v[156:159], v[72:75], a[28:31], v[156:159]
  v_mul_f32 v213, v213, v245
  v_mfma_f32_16x16x32_bf16 v[156:159], v[76:79], a[44:47], v[156:159]
  v_mul_f32 v214, v214, v246
  s_waitcnt lgkmcnt(7)
  v_mfma_f32_16x16x32_bf16 v[160:163], v[80:83], a[0:3], 0
  ds_read_b64_tr_b16 v[68:69], v8 offset:4096
  v_mul_f32 v215, v215, v247
  v_mfma_f32_16x16x32_bf16 v[160:163], v[84:87], a[16:19], v[160:163]
  ds_read_b64_tr_b16 v[70:71], v8 offset:6144
  v_cvt_pk_bf16_f32 v38, v212, v213
  v_mfma_f32_16x16x32_bf16 v[160:163], v[88:91], a[32:35], v[160:163]
  ds_read_b64_tr_b16 v[72:73], v8 offset:8192
  v_cvt_pk_bf16_f32 v39, v214, v215
  v_mfma_f32_16x16x32_bf16 v[164:167], v[80:83], a[4:7], 0
  ds_read_b64_tr_b16 v[74:75], v8 offset:10240
  ds_write_b128 v17, v[36:39] offset:9216
  v_mfma_f32_16x16x32_bf16 v[164:167], v[84:87], a[20:23], v[164:167]
  ds_read_b64_tr_b16 v[76:77], v8 offset:12288
  v_mul_f32 v200, v200, v232
  v_mfma_f32_16x16x32_bf16 v[164:167], v[88:91], a[36:39], v[164:167]
  ds_read_b64_tr_b16 v[78:79], v8 offset:14336
  v_mul_f32 v201, v201, v233
  v_mfma_f32_16x16x32_bf16 v[168:171], v[80:83], a[8:11], 0
  s_add_u32 m0, s33, 118784
  v_mul_f32 v202, v202, v234
  v_mfma_f32_16x16x32_bf16 v[168:171], v[84:87], a[24:27], v[168:171]
  s_mov_b32 s34, 4423936
  v_mul_f32 v203, v203, v235
  v_mfma_f32_16x16x32_bf16 v[168:171], v[88:91], a[40:43], v[168:171]
  buffer_load_dwordx4 v19, s[4:7], s34 offen lds
  v_cvt_pk_bf16_f32 v32, v200, v201
  v_mfma_f32_16x16x32_bf16 v[172:175], v[80:83], a[12:15], 0
  s_add_u32 m0, s33, 122880
  v_cvt_pk_bf16_f32 v33, v202, v203
  v_mfma_f32_16x16x32_bf16 v[172:175], v[84:87], a[28:31], v[172:175]
  s_mov_b32 s34, 4718848
  v_mul_f32 v216, v216, v248
  v_mfma_f32_16x16x32_bf16 v[172:175], v[88:91], a[44:47], v[172:175]
  buffer_load_dwordx4 v19, s[4:7], s34 offen lds
  s_waitcnt lgkmcnt(7)
  v_mfma_f32_16x16x32_bf16 v[176:179], v[56:59], a[0:3], 0
  ds_read_b64_tr_b16 v[80:81], v11 offset:4096
  v_mul_f32 v217, v217, v249
  v_mfma_f32_16x16x32_bf16 v[176:179], v[60:63], a[16:19], v[176:179]
  ds_read_b64_tr_b16 v[82:83], v11 offset:6144
  v_mul_f32 v218, v218, v250
  v_mfma_f32_16x16x32_bf16 v[176:179], v[64:67], a[32:35], v[176:179]
  ds_read_b64_tr_b16 v[84:85], v11 offset:8192
  v_mul_f32 v219, v219, v251
  v_mfma_f32_16x16x32_bf16 v[180:183], v[56:59], a[4:7], 0
  ds_read_b64_tr_b16 v[86:87], v11 offset:10240
  v_cvt_pk_bf16_f32 v34, v216, v217
  v_mfma_f32_16x16x32_bf16 v[180:183], v[60:63], a[20:23], v[180:183]
  ds_read_b64_tr_b16 v[88:89], v11 offset:12288
  v_cvt_pk_bf16_f32 v35, v218, v219
  v_mfma_f32_16x16x32_bf16 v[180:183], v[64:67], a[36:39], v[180:183]
  ds_read_b64_tr_b16 v[90:91], v11 offset:14336
  ds_write_b128 v17, v[32:35] offset:10240
  v_mfma_f32_16x16x32_bf16 v[184:187], v[56:59], a[8:11], 0
  v_mul_f32 v204, v204, v236
  v_mfma_f32_16x16x32_bf16 v[184:187], v[60:63], a[24:27], v[184:187]
  v_mul_f32 v205, v205, v237
  v_mfma_f32_16x16x32_bf16 v[184:187], v[64:67], a[40:43], v[184:187]
  v_mul_f32 v206, v206, v238
  v_mfma_f32_16x16x32_bf16 v[188:191], v[56:59], a[12:15], 0
  v_mul_f32 v207, v207, v239
  v_mfma_f32_16x16x32_bf16 v[188:191], v[60:63], a[28:31], v[188:191]
  v_cvt_pk_bf16_f32 v36, v204, v205
  v_mfma_f32_16x16x32_bf16 v[188:191], v[64:67], a[44:47], v[188:191]
  v_cvt_pk_bf16_f32 v37, v206, v207
  s_waitcnt lgkmcnt(7)
  v_mfma_f32_16x16x32_bf16 v[128:131], v[68:71], a[48:51], v[128:131]
  s_waitcnt vmcnt(17)
  s_barrier
  v_mfma_f32_16x16x32_bf16 v[128:131], v[72:75], a[64:67], v[128:131]
  ds_read_b64_tr_b16 v[56:57], v8 offset:16384
  v_mul_f32 v220, v220, v252
  v_mfma_f32_16x16x32_bf16 v[128:131], v[76:79], a[80:83], v[128:131]
  ds_read_b64_tr_b16 v[58:59], v8 offset:18432
  v_mul_f32 v221, v221, v253
  v_mfma_f32_16x16x32_bf16 v[132:135], v[68:71], a[52:55], v[132:135]
  ds_read_b64_tr_b16 v[60:61], v8 offset:20480
  v_mul_f32 v222, v222, v254
  v_mfma_f32_16x16x32_bf16 v[132:135], v[72:75], a[68:71], v[132:135]
  ds_read_b64_tr_b16 v[62:63], v8 offset:22528
  v_mul_f32 v223, v223, v255
  v_mfma_f32_16x16x32_bf16 v[132:135], v[76:79], a[84:87], v[132:135]
  ds_read_b64_tr_b16 v[64:65], v8 offset:24576
  v_cvt_pk_bf16_f32 v38, v220, v221
  v_mfma_f32_16x16x32_bf16 v[136:139], v[68:71], a[56:59], v[136:139]
  ds_read_b64_tr_b16 v[66:67], v8 offset:26624
  v_cvt_pk_bf16_f32 v39, v222, v223
  v_mfma_f32_16x16x32_bf16 v[136:139], v[72:75], a[72:75], v[136:139]
  s_add_u32 m0, s33, 143360
  ds_write_b128 v17, v[36:39] offset:11264
  v_mfma_f32_16x16x32_bf16 v[136:139], v[76:79], a[88:91], v[136:139]
  s_mov_b32 s34, 5013760
  v_mfma_f32_16x16x32_bf16 v[140:143], v[68:71], a[60:63], v[140:143]
  buffer_load_dwordx4 v19, s[4:7], s34 offen lds
  v_mfma_f32_16x16x32_bf16 v[140:143], v[72:75], a[76:79], v[140:143]
  s_add_u32 m0, s33, 147456
  v_mfma_f32_16x16x32_bf16 v[140:143], v[76:79], a[92:95], v[140:143]
  s_mov_b32 s34, 4423936
  buffer_load_dwordx4 v19, s[8:11], s34 offen lds
  s_waitcnt lgkmcnt(8)
  v_mfma_f32_16x16x32_bf16 v[144:147], v[80:83], a[48:51], v[144:147]
  ds_read_b64_tr_b16 v[68:69], v11 offset:16384
  v_mfma_f32_16x16x32_bf16 v[144:147], v[84:87], a[64:67], v[144:147]
  ds_read_b64_tr_b16 v[70:71], v11 offset:18432
  v_mfma_f32_16x16x32_bf16 v[144:147], v[88:91], a[80:83], v[144:147]
  ds_read_b64_tr_b16 v[72:73], v11 offset:20480
  v_mfma_f32_16x16x32_bf16 v[148:151], v[80:83], a[52:55], v[148:151]
  ds_read_b64_tr_b16 v[74:75], v11 offset:22528
  v_mfma_f32_16x16x32_bf16 v[148:151], v[84:87], a[68:71], v[148:151]
  ds_read_b64_tr_b16 v[76:77], v11 offset:24576
  v_mfma_f32_16x16x32_bf16 v[148:151], v[88:91], a[84:87], v[148:151]
  ds_read_b64_tr_b16 v[78:79], v11 offset:26624
  v_mfma_f32_16x16x32_bf16 v[152:155], v[80:83], a[56:59], v[152:155]
  s_add_u32 m0, s33, 151552
  v_mfma_f32_16x16x32_bf16 v[152:155], v[84:87], a[72:75], v[152:155]
  s_mov_b32 s34, 4718848
  v_mfma_f32_16x16x32_bf16 v[152:155], v[88:91], a[88:91], v[152:155]
  buffer_load_dwordx4 v19, s[8:11], s34 offen lds
  v_mfma_f32_16x16x32_bf16 v[156:159], v[80:83], a[60:63], v[156:159]
  s_add_u32 m0, s33, 155648
  v_mfma_f32_16x16x32_bf16 v[156:159], v[84:87], a[76:79], v[156:159]
  s_mov_b32 s34, 5013760
  v_mfma_f32_16x16x32_bf16 v[156:159], v[88:91], a[92:95], v[156:159]
  buffer_load_dwordx4 v19, s[8:11], s34 offen lds
  s_waitcnt lgkmcnt(7)
  v_mfma_f32_16x16x32_bf16 v[160:163], v[56:59], a[48:51], v[160:163]
  ds_read_b64_tr_b16 v[80:81], v8 offset:28672
  v_mfma_f32_16x16x32_bf16 v[160:163], v[60:63], a[64:67], v[160:163]
  ds_read_b64_tr_b16 v[82:83], v8 offset:30720
  v_mfma_f32_16x16x32_bf16 v[160:163], v[64:67], a[80:83], v[160:163]
  ds_read_b64_tr_b16 v[84:85], v8 offset:32768
  v_mfma_f32_16x16x32_bf16 v[164:167], v[56:59], a[52:55], v[164:167]
  ds_read_b64_tr_b16 v[86:87], v8 offset:34816
  v_mfma_f32_16x16x32_bf16 v[164:167], v[60:63], a[68:71], v[164:167]
  ds_read_b64_tr_b16 v[88:89], v8 offset:36864
  v_mfma_f32_16x16x32_bf16 v[164:167], v[64:67], a[84:87], v[164:167]
  ds_read_b64_tr_b16 v[90:91], v8 offset:38912
  v_mfma_f32_16x16x32_bf16 v[168:171], v[56:59], a[56:59], v[168:171]
  s_add_u32 m0, s33, 159744
  v_mfma_f32_16x16x32_bf16 v[168:171], v[60:63], a[72:75], v[168:171]
  s_mov_b32 s34, 384
  v_mfma_f32_16x16x32_bf16 v[168:171], v[64:67], a[88:91], v[168:171]
  buffer_load_dwordx4 v19, s[4:7], s34 offen lds
  v_mfma_f32_16x16x32_bf16 v[172:175], v[56:59], a[60:63], v[172:175]
  s_add_u32 m0, s33, 0
  v_mfma_f32_16x16x32_bf16 v[172:175], v[60:63], a[76:79], v[172:175]
  s_mov_b32 s34, 295296
  v_mfma_f32_16x16x32_bf16 v[172:175], v[64:67], a[92:95], v[172:175]
  buffer_load_dwordx4 v19, s[4:7], s34 offen lds
  s_waitcnt lgkmcnt(6)
  v_mfma_f32_16x16x32_bf16 v[176:179], v[68:71], a[48:51], v[176:179]
  ds_read_b64_tr_b16 v[56:57], v11 offset:28672
  v_mfma_f32_16x16x32_bf16 v[176:179], v[72:75], a[64:67], v[176:179]
  ds_read_b64_tr_b16 v[58:59], v11 offset:30720
  v_mfma_f32_16x16x32_bf16 v[176:179], v[76:79], a[80:83], v[176:179]
  ds_read_b64_tr_b16 v[60:61], v11 offset:32768
  v_mfma_f32_16x16x32_bf16 v[180:183], v[68:71], a[52:55], v[180:183]
  ds_read_b64_tr_b16 v[62:63], v11 offset:34816
  v_mfma_f32_16x16x32_bf16 v[180:183], v[72:75], a[68:71], v[180:183]
  ds_read_b64_tr_b16 v[64:65], v11 offset:36864
  v_mfma_f32_16x16x32_bf16 v[180:183], v[76:79], a[84:87], v[180:183]
  ds_read_b64_tr_b16 v[66:67], v11 offset:38912
  v_mfma_f32_16x16x32_bf16 v[184:187], v[68:71], a[56:59], v[184:187]
  v_mfma_f32_16x16x32_bf16 v[184:187], v[72:75], a[72:75], v[184:187]
  v_mfma_f32_16x16x32_bf16 v[184:187], v[76:79], a[88:91], v[184:187]
  v_mfma_f32_16x16x32_bf16 v[188:191], v[68:71], a[60:63], v[188:191]
  v_mfma_f32_16x16x32_bf16 v[188:191], v[72:75], a[76:79], v[188:191]
  v_mfma_f32_16x16x32_bf16 v[188:191], v[76:79], a[92:95], v[188:191]
  s_waitcnt lgkmcnt(6)
  v_mfma_f32_16x16x32_bf16 v[128:131], v[80:83], a[96:99], v[128:131]
  s_waitcnt vmcnt(17)
  s_barrier
  v_mfma_f32_16x16x32_bf16 v[128:131], v[84:87], a[112:115], v[128:131]
  ds_read_b64_tr_b16 v[68:69], v8 offset:40960
  v_mfma_f32_16x16x32_bf16 v[128:131], v[88:91], a[128:131], v[128:131]
  ds_read_b64_tr_b16 v[70:71], v8 offset:43008
  v_mfma_f32_16x16x32_bf16 v[132:135], v[80:83], a[100:103], v[132:135]
  ds_read_b64_tr_b16 v[72:73], v8 offset:45056
  v_mfma_f32_16x16x32_bf16 v[132:135], v[84:87], a[116:119], v[132:135]
  ds_read_b64_tr_b16 v[74:75], v8 offset:47104
  v_mfma_f32_16x16x32_bf16 v[132:135], v[88:91], a[132:135], v[132:135]
  ds_read_b64_tr_b16 v[76:77], v8 offset:49152
  v_mfma_f32_16x16x32_bf16 v[136:139], v[80:83], a[104:107], v[136:139]
  ds_read_b64_tr_b16 v[78:79], v8 offset:51200
  v_mfma_f32_16x16x32_bf16 v[136:139], v[84:87], a[120:123], v[136:139]
  s_add_u32 m0, s33, 4096
  v_mfma_f32_16x16x32_bf16 v[136:139], v[88:91], a[136:139], v[136:139]
  s_mov_b32 s34, 590208
  v_mfma_f32_16x16x32_bf16 v[140:143], v[80:83], a[108:111], v[140:143]
  buffer_load_dwordx4 v19, s[4:7], s34 offen lds
  v_mfma_f32_16x16x32_bf16 v[140:143], v[84:87], a[124:127], v[140:143]
  s_add_u32 m0, s33, 8192
  v_mfma_f32_16x16x32_bf16 v[140:143], v[88:91], a[140:143], v[140:143]
  s_mov_b32 s34, 384
  buffer_load_dwordx4 v19, s[8:11], s34 offen lds
  s_waitcnt lgkmcnt(6)
  v_mfma_f32_16x16x32_bf16 v[144:147], v[56:59], a[96:99], v[144:147]
  ds_read_b64_tr_b16 v[80:81], v11 offset:40960
  v_mfma_f32_16x16x32_bf16 v[144:147], v[60:63], a[112:115], v[144:147]
  ds_read_b64_tr_b16 v[82:83], v11 offset:43008
  v_mfma_f32_16x16x32_bf16 v[144:147], v[64:67], a[128:131], v[144:147]
  ds_read_b64_tr_b16 v[84:85], v11 offset:45056
  v_mfma_f32_16x16x32_bf16 v[148:151], v[56:59], a[100:103], v[148:151]
  ds_read_b64_tr_b16 v[86:87], v11 offset:47104
  v_mfma_f32_16x16x32_bf16 v[148:151], v[60:63], a[116:119], v[148:151]
  ds_read_b64_tr_b16 v[88:89], v11 offset:49152
  v_mfma_f32_16x16x32_bf16 v[148:151], v[64:67], a[132:135], v[148:151]
  ds_read_b64_tr_b16 v[90:91], v11 offset:51200
  v_mfma_f32_16x16x32_bf16 v[152:155], v[56:59], a[104:107], v[152:155]
  s_add_u32 m0, s33, 12288
  v_mfma_f32_16x16x32_bf16 v[152:155], v[60:63], a[120:123], v[152:155]
  s_mov_b32 s34, 295296
  v_mfma_f32_16x16x32_bf16 v[152:155], v[64:67], a[136:139], v[152:155]
  buffer_load_dwordx4 v19, s[8:11], s34 offen lds
  v_mfma_f32_16x16x32_bf16 v[156:159], v[56:59], a[108:111], v[156:159]
  s_add_u32 m0, s33, 16384
  v_mfma_f32_16x16x32_bf16 v[156:159], v[60:63], a[124:127], v[156:159]
  s_mov_b32 s34, 590208
  v_mfma_f32_16x16x32_bf16 v[156:159], v[64:67], a[140:143], v[156:159]
  buffer_load_dwordx4 v19, s[8:11], s34 offen lds
  s_waitcnt lgkmcnt(6)
  v_mfma_f32_16x16x32_bf16 v[160:163], v[68:71], a[96:99], v[160:163]
  ds_read_b64_tr_b16 v[56:57], v8 offset:53248
  v_mfma_f32_16x16x32_bf16 v[160:163], v[72:75], a[112:115], v[160:163]
  ds_read_b64_tr_b16 v[58:59], v8 offset:55296
  v_mfma_f32_16x16x32_bf16 v[160:163], v[76:79], a[128:131], v[160:163]
  ds_read_b64_tr_b16 v[60:61], v8 offset:57344
  v_mfma_f32_16x16x32_bf16 v[164:167], v[68:71], a[100:103], v[164:167]
  ds_read_b64_tr_b16 v[62:63], v8 offset:59392
  v_mfma_f32_16x16x32_bf16 v[164:167], v[72:75], a[116:119], v[164:167]
  ds_read_b64_tr_b16 v[64:65], v8 offset:61440
  v_mfma_f32_16x16x32_bf16 v[164:167], v[76:79], a[132:135], v[164:167]
  ds_read_b64_tr_b16 v[66:67], v8 offset:63488
  v_mfma_f32_16x16x32_bf16 v[168:171], v[68:71], a[104:107], v[168:171]
  s_add_u32 m0, s33, 20480
  v_mfma_f32_16x16x32_bf16 v[168:171], v[72:75], a[120:123], v[168:171]
  s_mov_b32 s34, 885120
  v_mfma_f32_16x16x32_bf16 v[168:171], v[76:79], a[136:139], v[168:171]
  buffer_load_dwordx4 v19, s[4:7], s34 offen lds
  v_mfma_f32_16x16x32_bf16 v[172:175], v[68:71], a[108:111], v[172:175]
  s_add_u32 m0, s33, 24576
  v_mfma_f32_16x16x32_bf16 v[172:175], v[72:75], a[124:127], v[172:175]
  s_mov_b32 s34, 1180032
  v_mfma_f32_16x16x32_bf16 v[172:175], v[76:79], a[140:143], v[172:175]
  buffer_load_dwordx4 v19, s[4:7], s34 offen lds
  s_waitcnt lgkmcnt(6)
  v_mfma_f32_16x16x32_bf16 v[176:179], v[80:83], a[96:99], v[176:179]
  ds_read_b64_tr_b16 v[68:69], v11 offset:53248
  v_mfma_f32_16x16x32_bf16 v[176:179], v[84:87], a[112:115], v[176:179]
  ds_read_b64_tr_b16 v[70:71], v11 offset:55296
  v_mfma_f32_16x16x32_bf16 v[176:179], v[88:91], a[128:131], v[176:179]
  ds_read_b64_tr_b16 v[72:73], v11 offset:57344
  v_mfma_f32_16x16x32_bf16 v[180:183], v[80:83], a[100:103], v[180:183]
  ds_read_b64_tr_b16 v[74:75], v11 offset:59392
  v_mfma_f32_16x16x32_bf16 v[180:183], v[84:87], a[116:119], v[180:183]
  ds_read_b64_tr_b16 v[76:77], v11 offset:61440
  v_mfma_f32_16x16x32_bf16 v[180:183], v[88:91], a[132:135], v[180:183]
  ds_read_b64_tr_b16 v[78:79], v11 offset:63488
  v_mfma_f32_16x16x32_bf16 v[184:187], v[80:83], a[104:107], v[184:187]
  v_mfma_f32_16x16x32_bf16 v[184:187], v[84:87], a[120:123], v[184:187]
  v_mfma_f32_16x16x32_bf16 v[184:187], v[88:91], a[136:139], v[184:187]
  v_mfma_f32_16x16x32_bf16 v[188:191], v[80:83], a[108:111], v[188:191]
  v_mfma_f32_16x16x32_bf16 v[188:191], v[84:87], a[124:127], v[188:191]
  v_mfma_f32_16x16x32_bf16 v[188:191], v[88:91], a[140:143], v[188:191]
  s_waitcnt lgkmcnt(6)
  v_mfma_f32_16x16x32_bf16 v[128:131], v[56:59], a[144:147], v[128:131]
  s_waitcnt vmcnt(17)
  s_barrier
  v_mfma_f32_16x16x32_bf16 v[128:131], v[60:63], a[160:163], v[128:131]
  ds_read_b64_tr_b16 v[80:81], v9
  v_mfma_f32_16x16x32_bf16 v[128:131], v[64:67], a[176:179], v[128:131]
  ds_read_b64_tr_b16 v[82:83], v9 offset:2048
  v_mfma_f32_16x16x32_bf16 v[132:135], v[56:59], a[148:151], v[132:135]
  ds_read_b64_tr_b16 v[84:85], v9 offset:4096
  v_mfma_f32_16x16x32_bf16 v[132:135], v[60:63], a[164:167], v[132:135]
  ds_read_b64_tr_b16 v[86:87], v9 offset:6144
  v_mfma_f32_16x16x32_bf16 v[132:135], v[64:67], a[180:183], v[132:135]
  ds_read_b64_tr_b16 v[88:89], v9 offset:8192
  v_mfma_f32_16x16x32_bf16 v[136:139], v[56:59], a[152:155], v[136:139]
  ds_read_b64_tr_b16 v[90:91], v9 offset:10240
  v_mfma_f32_16x16x32_bf16 v[136:139], v[60:63], a[168:171], v[136:139]
  s_add_u32 m0, s33, 28672
  v_mfma_f32_16x16x32_bf16 v[136:139], v[64:67], a[184:187], v[136:139]
  s_mov_b32 s34, 1474944
  v_mfma_f32_16x16x32_bf16 v[140:143], v[56:59], a[156:159], v[140:143]
  buffer_load_dwordx4 v19, s[4:7], s34 offen lds
  v_mfma_f32_16x16x32_bf16 v[140:143], v[60:63], a[172:175], v[140:143]
  s_add_u32 m0, s33, 32768
  v_mfma_f32_16x16x32_bf16 v[140:143], v[64:67], a[188:191], v[140:143]
  s_mov_b32 s34, 885120
  buffer_load_dwordx4 v19, s[8:11], s34 offen lds
  s_waitcnt lgkmcnt(6)
  v_mfma_f32_16x16x32_bf16 v[144:147], v[68:71], a[144:147], v[144:147]
  ds_read_b64_tr_b16 v[56:57], v12
  v_mfma_f32_16x16x32_bf16 v[144:147], v[72:75], a[160:163], v[144:147]
  ds_read_b64_tr_b16 v[58:59], v12 offset:2048
  v_mfma_f32_16x16x32_bf16 v[144:147], v[76:79], a[176:179], v[144:147]
  ds_read_b64_tr_b16 v[60:61], v12 offset:4096
  v_mfma_f32_16x16x32_bf16 v[148:151], v[68:71], a[148:151], v[148:151]
  ds_read_b64_tr_b16 v[62:63], v12 offset:6144
  v_mfma_f32_16x16x32_bf16 v[148:151], v[72:75], a[164:167], v[148:151]
  ds_read_b64_tr_b16 v[64:65], v12 offset:8192
  v_mfma_f32_16x16x32_bf16 v[148:151], v[76:79], a[180:183], v[148:151]
  ds_read_b64_tr_b16 v[66:67], v12 offset:10240
  v_mfma_f32_16x16x32_bf16 v[152:155], v[68:71], a[152:155], v[152:155]
  s_add_u32 m0, s33, 36864
  v_mfma_f32_16x16x32_bf16 v[152:155], v[72:75], a[168:171], v[152:155]
  s_mov_b32 s34, 1180032
  v_mfma_f32_16x16x32_bf16 v[152:155], v[76:79], a[184:187], v[152:155]
  buffer_load_dwordx4 v19, s[8:11], s34 offen lds
  v_mfma_f32_16x16x32_bf16 v[156:159], v[68:71], a[156:159], v[156:159]
  s_add_u32 m0, s33, 40960
  v_mfma_f32_16x16x32_bf16 v[156:159], v[72:75], a[172:175], v[156:159]
  s_mov_b32 s34, 1474944
  v_mfma_f32_16x16x32_bf16 v[156:159], v[76:79], a[188:191], v[156:159]
  buffer_load_dwordx4 v19, s[8:11], s34 offen lds
  s_waitcnt lgkmcnt(6)
  v_mfma_f32_16x16x32_bf16 v[160:163], v[80:83], a[144:147], v[160:163]
  ds_read_b64_tr_b16 v[68:69], v9 offset:12288
  v_mfma_f32_16x16x32_bf16 v[160:163], v[84:87], a[160:163], v[160:163]
  ds_read_b64_tr_b16 v[70:71], v9 offset:14336
  v_mfma_f32_16x16x32_bf16 v[160:163], v[88:91], a[176:179], v[160:163]
  ds_read_b64_tr_b16 v[72:73], v9 offset:16384
  v_mfma_f32_16x16x32_bf16 v[164:167], v[80:83], a[148:151], v[164:167]
  ds_read_b64_tr_b16 v[74:75], v9 offset:18432
  v_mfma_f32_16x16x32_bf16 v[164:167], v[84:87], a[164:167], v[164:167]
  ds_read_b64_tr_b16 v[76:77], v9 offset:20480
  v_mfma_f32_16x16x32_bf16 v[164:167], v[88:91], a[180:183], v[164:167]
  ds_read_b64_tr_b16 v[78:79], v9 offset:22528
  v_mfma_f32_16x16x32_bf16 v[168:171], v[80:83], a[152:155], v[168:171]
  s_add_u32 m0, s33, 45056
  v_mfma_f32_16x16x32_bf16 v[168:171], v[84:87], a[168:171], v[168:171]
  s_mov_b32 s34, 1769856
  v_mfma_f32_16x16x32_bf16 v[168:171], v[88:91], a[184:187], v[168:171]
  buffer_load_dwordx4 v19, s[4:7], s34 offen lds
  v_mfma_f32_16x16x32_bf16 v[172:175], v[80:83], a[156:159], v[172:175]
  s_add_u32 m0, s33, 49152
  v_mfma_f32_16x16x32_bf16 v[172:175], v[84:87], a[172:175], v[172:175]
  s_mov_b32 s34, 2064768
  v_mfma_f32_16x16x32_bf16 v[172:175], v[88:91], a[188:191], v[172:175]
  buffer_load_dwordx4 v19, s[4:7], s34 offen lds
  s_waitcnt lgkmcnt(6)
  v_mfma_f32_16x16x32_bf16 v[176:179], v[56:59], a[144:147], v[176:179]
  ds_read_b64_tr_b16 v[80:81], v12 offset:12288
  v_mfma_f32_16x16x32_bf16 v[176:179], v[60:63], a[160:163], v[176:179]
  ds_read_b64_tr_b16 v[82:83], v12 offset:14336
  v_mfma_f32_16x16x32_bf16 v[176:179], v[64:67], a[176:179], v[176:179]
  ds_read_b64_tr_b16 v[84:85], v12 offset:16384
  v_mfma_f32_16x16x32_bf16 v[180:183], v[56:59], a[148:151], v[180:183]
  ds_read_b64_tr_b16 v[86:87], v12 offset:18432
  v_mfma_f32_16x16x32_bf16 v[180:183], v[60:63], a[164:167], v[180:183]
  ds_read_b64_tr_b16 v[88:89], v12 offset:20480
  v_mfma_f32_16x16x32_bf16 v[180:183], v[64:67], a[180:183], v[180:183]
  ds_read_b64_tr_b16 v[90:91], v12 offset:22528
  v_mfma_f32_16x16x32_bf16 v[184:187], v[56:59], a[152:155], v[184:187]
  v_mfma_f32_16x16x32_bf16 v[184:187], v[60:63], a[168:171], v[184:187]
  v_mfma_f32_16x16x32_bf16 v[184:187], v[64:67], a[184:187], v[184:187]
  v_mfma_f32_16x16x32_bf16 v[188:191], v[56:59], a[156:159], v[188:191]
  v_mfma_f32_16x16x32_bf16 v[188:191], v[60:63], a[172:175], v[188:191]
  v_mfma_f32_16x16x32_bf16 v[188:191], v[64:67], a[188:191], v[188:191]
  s_waitcnt lgkmcnt(6)
  v_mfma_f32_16x16x32_bf16 v[128:131], v[68:71], a[192:195], v[128:131]
  s_waitcnt vmcnt(17)
  s_barrier
  v_mfma_f32_16x16x32_bf16 v[128:131], v[72:75], a[208:211], v[128:131]
  ds_read_b64_tr_b16 v[56:57], v9 offset:40960
  v_mfma_f32_16x16x32_bf16 v[128:131], v[76:79], a[224:227], v[128:131]
  ds_read_b64_tr_b16 v[58:59], v9 offset:43008
  v_mfma_f32_16x16x32_bf16 v[132:135], v[68:71], a[196:199], v[132:135]
  ds_read_b64_tr_b16 v[60:61], v9 offset:45056
  v_mfma_f32_16x16x32_bf16 v[132:135], v[72:75], a[212:215], v[132:135]
  ds_read_b64_tr_b16 v[62:63], v9 offset:47104
  v_mfma_f32_16x16x32_bf16 v[132:135], v[76:79], a[228:231], v[132:135]
  ds_read_b64_tr_b16 v[64:65], v9 offset:49152
  v_mfma_f32_16x16x32_bf16 v[136:139], v[68:71], a[200:203], v[136:139]
  ds_read_b64_tr_b16 v[66:67], v9 offset:51200
  v_mfma_f32_16x16x32_bf16 v[136:139], v[72:75], a[216:219], v[136:139]
  s_add_u32 m0, s33, 53248
  v_mfma_f32_16x16x32_bf16 v[136:139], v[76:79], a[232:235], v[136:139]
  s_mov_b32 s34, 2359680
  v_mfma_f32_16x16x32_bf16 v[140:143], v[68:71], a[204:207], v[140:143]
  buffer_load_dwordx4 v19, s[4:7], s34 offen lds
  v_mfma_f32_16x16x32_bf16 v[140:143], v[72:75], a[220:223], v[140:143]
  s_add_u32 m0, s33, 57344
  v_mfma_f32_16x16x32_bf16 v[140:143], v[76:79], a[236:239], v[140:143]
  s_mov_b32 s34, 1769856
  buffer_load_dwordx4 v19, s[8:11], s34 offen lds
  s_waitcnt lgkmcnt(6)
  v_mfma_f32_16x16x32_bf16 v[144:147], v[80:83], a[192:195], v[144:147]
  ds_read_b64_tr_b16 v[68:69], v12 offset:40960
  v_mfma_f32_16x16x32_bf16 v[144:147], v[84:87], a[208:211], v[144:147]
  ds_read_b64_tr_b16 v[70:71], v12 offset:43008
  v_mfma_f32_16x16x32_bf16 v[144:147], v[88:91], a[224:227], v[144:147]
  ds_read_b64_tr_b16 v[72:73], v12 offset:45056
  v_mfma_f32_16x16x32_bf16 v[148:151], v[80:83], a[196:199], v[148:151]
  ds_read_b64_tr_b16 v[74:75], v12 offset:47104
  v_mfma_f32_16x16x32_bf16 v[148:151], v[84:87], a[212:215], v[148:151]
  ds_read_b64_tr_b16 v[76:77], v12 offset:49152
  v_mfma_f32_16x16x32_bf16 v[148:151], v[88:91], a[228:231], v[148:151]
  ds_read_b64_tr_b16 v[78:79], v12 offset:51200
  v_mfma_f32_16x16x32_bf16 v[152:155], v[80:83], a[200:203], v[152:155]
  s_add_u32 m0, s33, 61440
  v_mfma_f32_16x16x32_bf16 v[152:155], v[84:87], a[216:219], v[152:155]
  s_mov_b32 s34, 2064768
  v_mfma_f32_16x16x32_bf16 v[152:155], v[88:91], a[232:235], v[152:155]
  buffer_load_dwordx4 v19, s[8:11], s34 offen lds
  v_mfma_f32_16x16x32_bf16 v[156:159], v[80:83], a[204:207], v[156:159]
  s_add_u32 m0, s33, 65536
  v_mfma_f32_16x16x32_bf16 v[156:159], v[84:87], a[220:223], v[156:159]
  s_mov_b32 s34, 2359680
  v_mfma_f32_16x16x32_bf16 v[156:159], v[88:91], a[236:239], v[156:159]
  buffer_load_dwordx4 v19, s[8:11], s34 offen lds
  s_waitcnt lgkmcnt(6)
  v_mfma_f32_16x16x32_bf16 v[160:163], v[56:59], a[192:195], v[160:163]
  ds_read_b64_tr_b16 v[80:81], v9 offset:53248
  v_mfma_f32_16x16x32_bf16 v[160:163], v[60:63], a[208:211], v[160:163]
  ds_read_b64_tr_b16 v[82:83], v9 offset:55296
  v_mfma_f32_16x16x32_bf16 v[160:163], v[64:67], a[224:227], v[160:163]
  ds_read_b64_tr_b16 v[84:85], v9 offset:57344
  v_mfma_f32_16x16x32_bf16 v[164:167], v[56:59], a[196:199], v[164:167]
  ds_read_b64_tr_b16 v[86:87], v9 offset:59392
  v_mfma_f32_16x16x32_bf16 v[164:167], v[60:63], a[212:215], v[164:167]
  ds_read_b64_tr_b16 v[88:89], v10 offset:12288
  v_mfma_f32_16x16x32_bf16 v[164:167], v[64:67], a[228:231], v[164:167]
  ds_read_b64_tr_b16 v[90:91], v10 offset:14336
  v_mfma_f32_16x16x32_bf16 v[168:171], v[56:59], a[200:203], v[168:171]
  s_add_u32 m0, s33, 69632
  v_mfma_f32_16x16x32_bf16 v[168:171], v[60:63], a[216:219], v[168:171]
  s_mov_b32 s34, 2654592
  v_mfma_f32_16x16x32_bf16 v[168:171], v[64:67], a[232:235], v[168:171]
  buffer_load_dwordx4 v19, s[4:7], s34 offen lds
  v_mfma_f32_16x16x32_bf16 v[172:175], v[56:59], a[204:207], v[172:175]
  s_add_u32 m0, s33, 73728
  v_mfma_f32_16x16x32_bf16 v[172:175], v[60:63], a[220:223], v[172:175]
  s_mov_b32 s34, 2949504
  v_mfma_f32_16x16x32_bf16 v[172:175], v[64:67], a[236:239], v[172:175]
  buffer_load_dwordx4 v19, s[4:7], s34 offen lds
  s_waitcnt lgkmcnt(6)
  v_mfma_f32_16x16x32_bf16 v[176:179], v[68:71], a[192:195], v[176:179]
  ds_read_b64_tr_b16 v[56:57], v12 offset:53248
  v_mfma_f32_16x16x32_bf16 v[176:179], v[72:75], a[208:211], v[176:179]
  ds_read_b64_tr_b16 v[58:59], v12 offset:55296
  v_mfma_f32_16x16x32_bf16 v[176:179], v[76:79], a[224:227], v[176:179]
  ds_read_b64_tr_b16 v[60:61], v12 offset:57344
  v_mfma_f32_16x16x32_bf16 v[180:183], v[68:71], a[196:199], v[180:183]
  ds_read_b64_tr_b16 v[62:63], v12 offset:59392
  v_mfma_f32_16x16x32_bf16 v[180:183], v[72:75], a[212:215], v[180:183]
  ds_read_b64_tr_b16 v[64:65], v13 offset:12288
  v_mfma_f32_16x16x32_bf16 v[180:183], v[76:79], a[228:231], v[180:183]
  ds_read_b64_tr_b16 v[66:67], v13 offset:14336
  v_mfma_f32_16x16x32_bf16 v[184:187], v[68:71], a[200:203], v[184:187]
  v_mfma_f32_16x16x32_bf16 v[184:187], v[72:75], a[216:219], v[184:187]
  v_mfma_f32_16x16x32_bf16 v[184:187], v[76:79], a[232:235], v[184:187]
  v_mfma_f32_16x16x32_bf16 v[188:191], v[68:71], a[204:207], v[188:191]
  v_mfma_f32_16x16x32_bf16 v[188:191], v[72:75], a[220:223], v[188:191]
  v_mfma_f32_16x16x32_bf16 v[188:191], v[76:79], a[236:239], v[188:191]
  s_waitcnt lgkmcnt(6)
  v_mfma_f32_16x16x32_bf16 v[128:131], v[80:83], a[240:243], v[128:131]
  s_waitcnt vmcnt(17)
  s_barrier
  v_mfma_f32_16x16x32_bf16 v[128:131], v[84:87], v[96:99], v[128:131]
  ds_read_b64_tr_b16 v[68:69], v10 offset:16384
  v_mfma_f32_16x16x32_bf16 v[128:131], v[88:91], v[112:115], v[128:131]
  ds_read_b64_tr_b16 v[70:71], v10 offset:18432
  v_mfma_f32_16x16x32_bf16 v[132:135], v[80:83], a[244:247], v[132:135]
  ds_read_b64_tr_b16 v[72:73], v10 offset:20480
  v_mfma_f32_16x16x32_bf16 v[132:135], v[84:87], v[100:103], v[132:135]
  ds_read_b64_tr_b16 v[74:75], v10 offset:22528
  v_mfma_f32_16x16x32_bf16 v[132:135], v[88:91], v[116:119], v[132:135]
  ds_read_b64_tr_b16 v[76:77], v10 offset:24576
  v_mfma_f32_16x16x32_bf16 v[136:139], v[80:83], a[248:251], v[136:139]
  ds_read_b64_tr_b16 v[78:79], v10 offset:26624
  v_mfma_f32_16x16x32_bf16 v[136:139], v[84:87], v[104:107], v[136:139]
  s_add_u32 m0, s33, 77824
  v_mfma_f32_16x16x32_bf16 v[136:139], v[88:91], v[120:123], v[136:139]
  s_mov_b32 s34, 3244416
  v_mfma_f32_16x16x32_bf16 v[140:143], v[80:83], a[252:255], v[140:143]
  buffer_load_dwordx4 v19, s[4:7], s34 offen lds
  v_mfma_f32_16x16x32_bf16 v[140:143], v[84:87], v[108:111], v[140:143]
  s_add_u32 m0, s33, 81920
  v_mfma_f32_16x16x32_bf16 v[140:143], v[88:91], v[124:127], v[140:143]
  s_mov_b32 s34, 2654592
  buffer_load_dwordx4 v19, s[8:11], s34 offen lds
  s_waitcnt lgkmcnt(6)
  v_mfma_f32_16x16x32_bf16 v[144:147], v[56:59], a[240:243], v[144:147]
  ds_read_b64_tr_b16 v[80:81], v13 offset:16384
  v_mfma_f32_16x16x32_bf16 v[144:147], v[60:63], v[96:99], v[144:147]
  ds_read_b64_tr_b16 v[82:83], v13 offset:18432
  v_mfma_f32_16x16x32_bf16 v[144:147], v[64:67], v[112:115], v[144:147]
  ds_read_b64_tr_b16 v[84:85], v13 offset:20480
  v_mfma_f32_16x16x32_bf16 v[148:151], v[56:59], a[244:247], v[148:151]
  ds_read_b64_tr_b16 v[86:87], v13 offset:22528
  v_mfma_f32_16x16x32_bf16 v[148:151], v[60:63], v[100:103], v[148:151]
  ds_read_b64_tr_b16 v[88:89], v13 offset:24576
  v_mfma_f32_16x16x32_bf16 v[148:151], v[64:67], v[116:119], v[148:151]
  ds_read_b64_tr_b16 v[90:91], v13 offset:26624
  v_mfma_f32_16x16x32_bf16 v[152:155], v[56:59], a[248:251], v[152:155]
  s_add_u32 m0, s33, 86016
  v_mfma_f32_16x16x32_bf16 v[152:155], v[60:63], v[104:107], v[152:155]
  s_mov_b32 s34, 2949504
  v_mfma_f32_16x16x32_bf16 v[152:155], v[64:67], v[120:123], v[152:155]
  buffer_load_dwordx4 v19, s[8:11], s34 offen lds
  v_mfma_f32_16x16x32_bf16 v[156:159], v[56:59], a[252:255], v[156:159]
  s_add_u32 m0, s33, 114688
  v_mfma_f32_16x16x32_bf16 v[156:159], v[60:63], v[108:111], v[156:159]
  s_mov_b32 s34, 3244416
  v_mfma_f32_16x16x32_bf16 v[156:159], v[64:67], v[124:127], v[156:159]
  buffer_load_dwordx4 v19, s[8:11], s34 offen lds
  s_waitcnt lgkmcnt(6)
  v_mfma_f32_16x16x32_bf16 v[160:163], v[68:71], a[240:243], v[160:163]
  ds_read_b64_tr_b16 v[56:57], v10 offset:28672
  v_mfma_f32_16x16x32_bf16 v[160:163], v[72:75], v[96:99], v[160:163]
  ds_read_b64_tr_b16 v[58:59], v10 offset:30720
  v_mfma_f32_16x16x32_bf16 v[160:163], v[76:79], v[112:115], v[160:163]
  ds_read_b64_tr_b16 v[60:61], v8
  v_mfma_f32_16x16x32_bf16 v[164:167], v[68:71], a[244:247], v[164:167]
  ds_read_b64_tr_b16 v[62:63], v8 offset:2048
  v_mfma_f32_16x16x32_bf16 v[164:167], v[72:75], v[100:103], v[164:167]
  ds_read_b64_tr_b16 v[64:65], v8 offset:4096
  v_mfma_f32_16x16x32_bf16 v[164:167], v[76:79], v[116:119], v[164:167]
  ds_read_b64_tr_b16 v[66:67], v8 offset:6144
  v_mfma_f32_16x16x32_bf16 v[168:171], v[68:71], a[248:251], v[168:171]
  v_mfma_f32_16x16x32_bf16 v[168:171], v[72:75], v[104:107], v[168:171]
  v_mfma_f32_16x16x32_bf16 v[168:171], v[76:79], v[120:123], v[168:171]
  v_mfma_f32_16x16x32_bf16 v[172:175], v[68:71], a[252:255], v[172:175]
  v_mfma_f32_16x16x32_bf16 v[172:175], v[72:75], v[108:111], v[172:175]
  v_mfma_f32_16x16x32_bf16 v[172:175], v[76:79], v[124:127], v[172:175]
  s_waitcnt lgkmcnt(6)
  v_mfma_f32_16x16x32_bf16 v[176:179], v[80:83], a[240:243], v[176:179]
  ds_read_b64_tr_b16 v[68:69], v13 offset:28672
  v_mfma_f32_16x16x32_bf16 v[176:179], v[84:87], v[96:99], v[176:179]
  ds_read_b64_tr_b16 v[70:71], v13 offset:30720
  v_mfma_f32_16x16x32_bf16 v[176:179], v[88:91], v[112:115], v[176:179]
  ds_read_b64_tr_b16 v[72:73], v11
  v_mfma_f32_16x16x32_bf16 v[180:183], v[80:83], a[244:247], v[180:183]
  ds_read_b64_tr_b16 v[74:75], v11 offset:2048
  v_mfma_f32_16x16x32_bf16 v[180:183], v[84:87], v[100:103], v[180:183]
  ds_read_b64_tr_b16 v[76:77], v11 offset:4096
  v_mfma_f32_16x16x32_bf16 v[180:183], v[88:91], v[116:119], v[180:183]
  ds_read_b64_tr_b16 v[78:79], v11 offset:6144
  v_mfma_f32_16x16x32_bf16 v[184:187], v[80:83], a[248:251], v[184:187]
  v_mfma_f32_16x16x32_bf16 v[184:187], v[84:87], v[104:107], v[184:187]
  v_mfma_f32_16x16x32_bf16 v[184:187], v[88:91], v[120:123], v[184:187]
  v_mfma_f32_16x16x32_bf16 v[188:191], v[80:83], a[252:255], v[188:191]
  v_mfma_f32_16x16x32_bf16 v[188:191], v[84:87], v[108:111], v[188:191]
  v_mfma_f32_16x16x32_bf16 v[188:191], v[88:91], v[124:127], v[188:191]
  s_waitcnt lgkmcnt(6)
  v_mfma_f32_16x16x32_bf16 v[192:195], v[56:59], a[0:3], 0
  s_waitcnt vmcnt(15)
  s_barrier
  v_mfma_f32_16x16x32_bf16 v[192:195], v[60:63], a[16:19], v[192:195]
  ds_read_b64_tr_b16 v[80:81], v8 offset:8192
  v_mul_f32 v128, v128, v160
  v_mfma_f32_16x16x32_bf16 v[192:195], v[64:67], a[32:35], v[192:195]
  ds_read_b64_tr_b16 v[82:83], v8 offset:10240
  v_mul_f32 v129, v129, v161
  v_mfma_f32_16x16x32_bf16 v[196:199], v[56:59], a[4:7], 0
  ds_read_b64_tr_b16 v[84:85], v8 offset:12288
  v_mul_f32 v130, v130, v162
  v_mfma_f32_16x16x32_bf16 v[196:199], v[60:63], a[20:23], v[196:199]
  ds_read_b64_tr_b16 v[86:87], v8 offset:14336
  v_mul_f32 v131, v131, v163
  v_mfma_f32_16x16x32_bf16 v[196:199], v[64:67], a[36:39], v[196:199]
  ds_read_b64_tr_b16 v[88:89], v8 offset:16384
  v_cvt_pk_bf16_f32 v32, v128, v129
  v_mfma_f32_16x16x32_bf16 v[200:203], v[56:59], a[8:11], 0
  ds_read_b64_tr_b16 v[90:91], v8 offset:18432
  v_cvt_pk_bf16_f32 v33, v130, v131
  v_mfma_f32_16x16x32_bf16 v[200:203], v[60:63], a[24:27], v[200:203]
  s_add_u32 m0, s33, 118784
  v_mul_f32 v144, v144, v176
  v_mfma_f32_16x16x32_bf16 v[200:203], v[64:67], a[40:43], v[200:203]
  s_mov_b32 s34, 3539328
  v_mul_f32 v145, v145, v177
  v_mfma_f32_16x16x32_bf16 v[204:207], v[56:59], a[12:15], 0
  buffer_load_dwordx4 v19, s[4:7], s34 offen lds
  v_mul_f32 v146, v146, v178
  v_mfma_f32_16x16x32_bf16 v[204:207], v[60:63], a[28:31], v[204:207]
  s_add_u32 m0, s33, 122880
  v_mul_f32 v147, v147, v179
  v_mfma_f32_16x16x32_bf16 v[204:207], v[64:67], a[44:47], v[204:207]
  s_mov_b32 s34, 3834240
  buffer_load_dwordx4 v19, s[4:7], s34 offen lds
  s_waitcnt lgkmcnt(6)
  v_mfma_f32_16x16x32_bf16 v[208:211], v[68:71], a[0:3], 0
  ds_read_b64_tr_b16 v[56:57], v11 offset:8192
  v_cvt_pk_bf16_f32 v34, v144, v145
  v_mfma_f32_16x16x32_bf16 v[208:211], v[72:75], a[16:19], v[208:211]
  ds_read_b64_tr_b16 v[58:59], v11 offset:10240
  v_cvt_pk_bf16_f32 v35, v146, v147
  v_mfma_f32_16x16x32_bf16 v[208:211], v[76:79], a[32:35], v[208:211]
  ds_read_b64_tr_b16 v[60:61], v11 offset:12288
  ds_write_b128 v17, v[32:35] offset:16384
  v_mfma_f32_16x16x32_bf16 v[212:215], v[68:71], a[4:7], 0
  ds_read_b64_tr_b16 v[62:63], v11 offset:14336
  v_mul_f32 v132, v132, v164
  v_mfma_f32_16x16x32_bf16 v[212:215], v[72:75], a[20:23], v[212:215]
  ds_read_b64_tr_b16 v[64:65], v11 offset:16384
  v_mul_f32 v133, v133, v165
  v_mfma_f32_16x16x32_bf16 v[212:215], v[76:79], a[36:39], v[212:215]
  ds_read_b64_tr_b16 v[66:67], v11 offset:18432
  v_mul_f32 v134, v134, v166
  v_mfma_f32_16x16x32_bf16 v[216:219], v[68:71], a[8:11], 0
  s_add_u32 m0, s33, 151552
  v_mul_f32 v135, v135, v167
  v_mfma_f32_16x16x32_bf16 v[216:219], v[72:75], a[24:27], v[216:219]
  s_mov_b32 s34, 4129152
  v_cvt_pk_bf16_f32 v36, v132, v133
  v_mfma_f32_16x16x32_bf16 v[216:219], v[76:79], a[40:43], v[216:219]
  buffer_load_dwordx4 v19, s[4:7], s34 offen lds
  v_cvt_pk_bf16_f32 v37, v134, v135
  v_mfma_f32_16x16x32_bf16 v[220:223], v[68:71], a[12:15], 0
  s_add_u32 m0, s33, 155648
  v_mul_f32 v148, v148, v180
  v_mfma_f32_16x16x32_bf16 v[220:223], v[72:75], a[28:31], v[220:223]
  s_mov_b32 s34, 3539328
  v_mul_f32 v149, v149, v181
  v_mfma_f32_16x16x32_bf16 v[220:223], v[76:79], a[44:47], v[220:223]
  buffer_load_dwordx4 v19, s[8:11], s34 offen lds
  s_waitcnt lgkmcnt(7)
  v_mfma_f32_16x16x32_bf16 v[224:227], v[80:83], a[0:3], 0
  ds_read_b64_tr_b16 v[68:69], v8 offset:20480
  v_mul_f32 v150, v150, v182
  v_mfma_f32_16x16x32_bf16 v[224:227], v[84:87], a[16:19], v[224:227]
  ds_read_b64_tr_b16 v[70:71], v8 offset:22528
  v_mul_f32 v151, v151, v183
  v_mfma_f32_16x16x32_bf16 v[224:227], v[88:91], a[32:35], v[224:227]
  ds_read_b64_tr_b16 v[72:73], v8 offset:24576
  v_cvt_pk_bf16_f32 v38, v148, v149
  v_mfma_f32_16x16x32_bf16 v[228:231], v[80:83], a[4:7], 0
  ds_read_b64_tr_b16 v[74:75], v8 offset:26624
  v_cvt_pk_bf16_f32 v39, v150, v151
  v_mfma_f32_16x16x32_bf16 v[228:231], v[84:87], a[20:23], v[228:231]
  ds_read_b64_tr_b16 v[76:77], v8 offset:28672
  ds_write_b128 v17, v[36:39] offset:17408
  v_mfma_f32_16x16x32_bf16 v[228:231], v[88:91], a[36:39], v[228:231]
  ds_read_b64_tr_b16 v[78:79], v8 offset:30720
  v_mul_f32 v136, v136, v168
  v_mfma_f32_16x16x32_bf16 v[232:235], v[80:83], a[8:11], 0
  v_mul_f32 v137, v137, v169
  v_mfma_f32_16x16x32_bf16 v[232:235], v[84:87], a[24:27], v[232:235]
  v_mul_f32 v138, v138, v170
  v_mfma_f32_16x16x32_bf16 v[232:235], v[88:91], a[40:43], v[232:235]
  v_mul_f32 v139, v139, v171
  v_mfma_f32_16x16x32_bf16 v[236:239], v[80:83], a[12:15], 0
  v_cvt_pk_bf16_f32 v32, v136, v137
  v_mfma_f32_16x16x32_bf16 v[236:239], v[84:87], a[28:31], v[236:239]
  v_cvt_pk_bf16_f32 v33, v138, v139
  v_mfma_f32_16x16x32_bf16 v[236:239], v[88:91], a[44:47], v[236:239]
  v_mul_f32 v152, v152, v184
  s_waitcnt lgkmcnt(7)
  v_mfma_f32_16x16x32_bf16 v[240:243], v[56:59], a[0:3], 0
  ds_read_b64_tr_b16 v[80:81], v11 offset:20480
  v_mul_f32 v153, v153, v185
  v_mfma_f32_16x16x32_bf16 v[240:243], v[60:63], a[16:19], v[240:243]
  ds_read_b64_tr_b16 v[82:83], v11 offset:22528
  v_mul_f32 v154, v154, v186
  v_mfma_f32_16x16x32_bf16 v[240:243], v[64:67], a[32:35], v[240:243]
  ds_read_b64_tr_b16 v[84:85], v11 offset:24576
  v_mul_f32 v155, v155, v187
  v_mfma_f32_16x16x32_bf16 v[244:247], v[56:59], a[4:7], 0
  ds_read_b64_tr_b16 v[86:87], v11 offset:26624
  v_cvt_pk_bf16_f32 v34, v152, v153
  v_mfma_f32_16x16x32_bf16 v[244:247], v[60:63], a[20:23], v[244:247]
  ds_read_b64_tr_b16 v[88:89], v11 offset:28672
  v_cvt_pk_bf16_f32 v35, v154, v155
  v_mfma_f32_16x16x32_bf16 v[244:247], v[64:67], a[36:39], v[244:247]
  ds_read_b64_tr_b16 v[90:91], v11 offset:30720
  ds_write_b128 v17, v[32:35] offset:18432
  v_mfma_f32_16x16x32_bf16 v[248:251], v[56:59], a[8:11], 0
  v_mul_f32 v140, v140, v172
  v_mfma_f32_16x16x32_bf16 v[248:251], v[60:63], a[24:27], v[248:251]
  v_mul_f32 v141, v141, v173
  v_mfma_f32_16x16x32_bf16 v[248:251], v[64:67], a[40:43], v[248:251]
  v_mul_f32 v142, v142, v174
  v_mfma_f32_16x16x32_bf16 v[252:255], v[56:59], a[12:15], 0
  v_mul_f32 v143, v143, v175
  v_mfma_f32_16x16x32_bf16 v[252:255], v[60:63], a[28:31], v[252:255]
  v_cvt_pk_bf16_f32 v36, v140, v141
  v_mfma_f32_16x16x32_bf16 v[252:255], v[64:67], a[44:47], v[252:255]
  v_cvt_pk_bf16_f32 v37, v142, v143
  s_waitcnt lgkmcnt(7)
  v_mfma_f32_16x16x32_bf16 v[192:195], v[68:71], a[48:51], v[192:195]
  s_waitcnt vmcnt(13)
  s_barrier
  v_mfma_f32_16x16x32_bf16 v[192:195], v[72:75], a[64:67], v[192:195]
  ds_read_b64_tr_b16 v[56:57], v8 offset:32768
  v_mul_f32 v156, v156, v188
  v_mfma_f32_16x16x32_bf16 v[192:195], v[76:79], a[80:83], v[192:195]
  ds_read_b64_tr_b16 v[58:59], v8 offset:34816
  v_mul_f32 v157, v157, v189
  v_mfma_f32_16x16x32_bf16 v[196:199], v[68:71], a[52:55], v[196:199]
  ds_read_b64_tr_b16 v[60:61], v8 offset:36864
  v_mul_f32 v158, v158, v190
  v_mfma_f32_16x16x32_bf16 v[196:199], v[72:75], a[68:71], v[196:199]
  ds_read_b64_tr_b16 v[62:63], v8 offset:38912
  v_mul_f32 v159, v159, v191
  v_mfma_f32_16x16x32_bf16 v[196:199], v[76:79], a[84:87], v[196:199]
  ds_read_b64_tr_b16 v[64:65], v8 offset:40960
  v_cvt_pk_bf16_f32 v38, v156, v157
  v_mfma_f32_16x16x32_bf16 v[200:203], v[68:71], a[56:59], v[200:203]
  ds_read_b64_tr_b16 v[66:67], v8 offset:43008
  v_cvt_pk_bf16_f32 v39, v158, v159
  v_mfma_f32_16x16x32_bf16 v[200:203], v[72:75], a[72:75], v[200:203]
  s_add_u32 m0, s33, 159744
  ds_write_b128 v17, v[36:39] offset:19456
  v_mfma_f32_16x16x32_bf16 v[200:203], v[76:79], a[88:91], v[200:203]
  s_mov_b32 s34, 3834240
  v_mfma_f32_16x16x32_bf16 v[204:207], v[68:71], a[60:63], v[204:207]
  buffer_load_dwordx4 v19, s[8:11], s34 offen lds
  v_mfma_f32_16x16x32_bf16 v[204:207], v[72:75], a[76:79], v[204:207]
  s_add_u32 m0, s33, 0
  v_mfma_f32_16x16x32_bf16 v[204:207], v[76:79], a[92:95], v[204:207]
  s_mov_b32 s34, 4129152
  buffer_load_dwordx4 v19, s[8:11], s34 offen lds
  s_waitcnt lgkmcnt(8)
  v_mfma_f32_16x16x32_bf16 v[208:211], v[80:83], a[48:51], v[208:211]
  ds_read_b64_tr_b16 v[68:69], v11 offset:32768
  v_mfma_f32_16x16x32_bf16 v[208:211], v[84:87], a[64:67], v[208:211]
  ds_read_b64_tr_b16 v[70:71], v11 offset:34816
  v_mfma_f32_16x16x32_bf16 v[208:211], v[88:91], a[80:83], v[208:211]
  ds_read_b64_tr_b16 v[72:73], v11 offset:36864
  v_mfma_f32_16x16x32_bf16 v[212:215], v[80:83], a[52:55], v[212:215]
  ds_read_b64_tr_b16 v[74:75], v11 offset:38912
  v_mfma_f32_16x16x32_bf16 v[212:215], v[84:87], a[68:71], v[212:215]
  ds_read_b64_tr_b16 v[76:77], v11 offset:40960
  v_mfma_f32_16x16x32_bf16 v[212:215], v[88:91], a[84:87], v[212:215]
  ds_read_b64_tr_b16 v[78:79], v11 offset:43008
  v_mfma_f32_16x16x32_bf16 v[216:219], v[80:83], a[56:59], v[216:219]
  s_add_u32 m0, s33, 4096
  v_mfma_f32_16x16x32_bf16 v[216:219], v[84:87], a[72:75], v[216:219]
  s_mov_b32 s34, 4424064
  v_mfma_f32_16x16x32_bf16 v[216:219], v[88:91], a[88:91], v[216:219]
  buffer_load_dwordx4 v19, s[4:7], s34 offen lds
  v_mfma_f32_16x16x32_bf16 v[220:223], v[80:83], a[60:63], v[220:223]
  s_add_u32 m0, s33, 8192
  v_mfma_f32_16x16x32_bf16 v[220:223], v[84:87], a[76:79], v[220:223]
  s_mov_b32 s34, 4718976
  v_mfma_f32_16x16x32_bf16 v[220:223], v[88:91], a[92:95], v[220:223]
  buffer_load_dwordx4 v19, s[4:7], s34 offen lds
  s_waitcnt lgkmcnt(7)
  v_mfma_f32_16x16x32_bf16 v[224:227], v[56:59], a[48:51], v[224:227]
  ds_read_b64_tr_b16 v[80:81], v8 offset:45056
  v_mfma_f32_16x16x32_bf16 v[224:227], v[60:63], a[64:67], v[224:227]
  ds_read_b64_tr_b16 v[82:83], v8 offset:47104
  v_mfma_f32_16x16x32_bf16 v[224:227], v[64:67], a[80:83], v[224:227]
  ds_read_b64_tr_b16 v[84:85], v8 offset:49152
  v_mfma_f32_16x16x32_bf16 v[228:231], v[56:59], a[52:55], v[228:231]
  ds_read_b64_tr_b16 v[86:87], v8 offset:51200
  v_mfma_f32_16x16x32_bf16 v[228:231], v[60:63], a[68:71], v[228:231]
  ds_read_b64_tr_b16 v[88:89], v8 offset:53248
  v_mfma_f32_16x16x32_bf16 v[228:231], v[64:67], a[84:87], v[228:231]
  ds_read_b64_tr_b16 v[90:91], v8 offset:55296
  v_mfma_f32_16x16x32_bf16 v[232:235], v[56:59], a[56:59], v[232:235]
  s_add_u32 m0, s33, 12288
  v_mfma_f32_16x16x32_bf16 v[232:235], v[60:63], a[72:75], v[232:235]
  s_mov_b32 s34, 5013888
  v_mfma_f32_16x16x32_bf16 v[232:235], v[64:67], a[88:91], v[232:235]
  buffer_load_dwordx4 v19, s[4:7], s34 offen lds
  v_mfma_f32_16x16x32_bf16 v[236:239], v[56:59], a[60:63], v[236:239]
  s_add_u32 m0, s33, 16384
  v_mfma_f32_16x16x32_bf16 v[236:239], v[60:63], a[76:79], v[236:239]
  s_mov_b32 s34, 4424064
  v_mfma_f32_16x16x32_bf16 v[236:239], v[64:67], a[92:95], v[236:239]
  buffer_load_dwordx4 v19, s[8:11], s34 offen lds
  s_waitcnt lgkmcnt(6)
  v_mfma_f32_16x16x32_bf16 v[240:243], v[68:71], a[48:51], v[240:243]
  ds_read_b64_tr_b16 v[56:57], v11 offset:45056
  v_mfma_f32_16x16x32_bf16 v[240:243], v[72:75], a[64:67], v[240:243]
  ds_read_b64_tr_b16 v[58:59], v11 offset:47104
  v_mfma_f32_16x16x32_bf16 v[240:243], v[76:79], a[80:83], v[240:243]
  ds_read_b64_tr_b16 v[60:61], v11 offset:49152
  v_mfma_f32_16x16x32_bf16 v[244:247], v[68:71], a[52:55], v[244:247]
  ds_read_b64_tr_b16 v[62:63], v11 offset:51200
  v_mfma_f32_16x16x32_bf16 v[244:247], v[72:75], a[68:71], v[244:247]
  ds_read_b64_tr_b16 v[64:65], v11 offset:53248
  v_mfma_f32_16x16x32_bf16 v[244:247], v[76:79], a[84:87], v[244:247]
  ds_read_b64_tr_b16 v[66:67], v11 offset:55296
  v_mfma_f32_16x16x32_bf16 v[248:251], v[68:71], a[56:59], v[248:251]
  v_mfma_f32_16x16x32_bf16 v[248:251], v[72:75], a[72:75], v[248:251]
  v_mfma_f32_16x16x32_bf16 v[248:251], v[76:79], a[88:91], v[248:251]
  v_mfma_f32_16x16x32_bf16 v[252:255], v[68:71], a[60:63], v[252:255]
  v_mfma_f32_16x16x32_bf16 v[252:255], v[72:75], a[76:79], v[252:255]
  v_mfma_f32_16x16x32_bf16 v[252:255], v[76:79], a[92:95], v[252:255]
  s_waitcnt lgkmcnt(6)
  v_mfma_f32_16x16x32_bf16 v[192:195], v[80:83], a[96:99], v[192:195]
  s_waitcnt vmcnt(13)
  s_barrier
  v_mfma_f32_16x16x32_bf16 v[192:195], v[84:87], a[112:115], v[192:195]
  ds_read_b64_tr_b16 v[68:69], v8 offset:57344
  v_mfma_f32_16x16x32_bf16 v[192:195], v[88:91], a[128:131], v[192:195]
  ds_read_b64_tr_b16 v[70:71], v8 offset:59392
  v_mfma_f32_16x16x32_bf16 v[196:199], v[80:83], a[100:103], v[196:199]
  ds_read_b64_tr_b16 v[72:73], v8 offset:61440
  v_mfma_f32_16x16x32_bf16 v[196:199], v[84:87], a[116:119], v[196:199]
  ds_read_b64_tr_b16 v[74:75], v8 offset:63488
  v_mfma_f32_16x16x32_bf16 v[196:199], v[88:91], a[132:135], v[196:199]
  ds_read_b64_tr_b16 v[76:77], v9
  v_mfma_f32_16x16x32_bf16 v[200:203], v[80:83], a[104:107], v[200:203]
  ds_read_b64_tr_b16 v[78:79], v9 offset:2048
  v_mfma_f32_16x16x32_bf16 v[200:203], v[84:87], a[120:123], v[200:203]
  s_add_u32 m0, s33, 20480
  v_mfma_f32_16x16x32_bf16 v[200:203], v[88:91], a[136:139], v[200:203]
  s_mov_b32 s34, 4718976
  v_mfma_f32_16x16x32_bf16 v[204:207], v[80:83], a[108:111], v[204:207]
  buffer_load_dwordx4 v19, s[8:11], s34 offen lds
  v_mfma_f32_16x16x32_bf16 v[204:207], v[84:87], a[124:127], v[204:207]
  s_add_u32 m0, s33, 24576
  v_mfma_f32_16x16x32_bf16 v[204:207], v[88:91], a[140:143], v[204:207]
  s_mov_b32 s34, 5013888
  buffer_load_dwordx4 v19, s[8:11], s34 offen lds
  s_waitcnt lgkmcnt(6)
  v_mfma_f32_16x16x32_bf16 v[208:211], v[56:59], a[96:99], v[208:211]
  ds_read_b64_tr_b16 v[80:81], v11 offset:57344
  v_mfma_f32_16x16x32_bf16 v[208:211], v[60:63], a[112:115], v[208:211]
  ds_read_b64_tr_b16 v[82:83], v11 offset:59392
  v_mfma_f32_16x16x32_bf16 v[208:211], v[64:67], a[128:131], v[208:211]
  ds_read_b64_tr_b16 v[84:85], v11 offset:61440
  v_mfma_f32_16x16x32_bf16 v[212:215], v[56:59], a[100:103], v[212:215]
  ds_read_b64_tr_b16 v[86:87], v11 offset:63488
  v_mfma_f32_16x16x32_bf16 v[212:215], v[60:63], a[116:119], v[212:215]
  ds_read_b64_tr_b16 v[88:89], v12
  v_mfma_f32_16x16x32_bf16 v[212:215], v[64:67], a[132:135], v[212:215]
  ds_read_b64_tr_b16 v[90:91], v12 offset:2048
  v_mfma_f32_16x16x32_bf16 v[216:219], v[56:59], a[104:107], v[216:219]
  s_add_u32 m0, s33, 28672
  v_mfma_f32_16x16x32_bf16 v[216:219], v[60:63], a[120:123], v[216:219]
  s_mov_b32 s34, 0
  v_mfma_f32_16x16x32_bf16 v[216:219], v[64:67], a[136:139], v[216:219]
  buffer_load_dwordx4 v20, s[24:27], s34 offen lds
  v_mfma_f32_16x16x32_bf16 v[220:223], v[56:59], a[108:111], v[220:223]
  s_add_u32 m0, s33, 32768
  v_mfma_f32_16x16x32_bf16 v[220:223], v[60:63], a[124:127], v[220:223]
  s_mov_b32 s34, 294912
  v_mfma_f32_16x16x32_bf16 v[220:223], v[64:67], a[140:143], v[220:223]
  buffer_load_dwordx4 v20, s[24:27], s34 offen lds
  s_waitcnt lgkmcnt(6)
  v_mfma_f32_16x16x32_bf16 v[224:227], v[68:71], a[96:99], v[224:227]
  ds_read_b64_tr_b16 v[56:57], v9 offset:4096
  v_mfma_f32_16x16x32_bf16 v[224:227], v[72:75], a[112:115], v[224:227]
  ds_read_b64_tr_b16 v[58:59], v9 offset:6144
  v_mfma_f32_16x16x32_bf16 v[224:227], v[76:79], a[128:131], v[224:227]
  ds_read_b64_tr_b16 v[60:61], v9 offset:8192
  v_mfma_f32_16x16x32_bf16 v[228:231], v[68:71], a[100:103], v[228:231]
  ds_read_b64_tr_b16 v[62:63], v9 offset:10240
  v_mfma_f32_16x16x32_bf16 v[228:231], v[72:75], a[116:119], v[228:231]
  ds_read_b64_tr_b16 v[64:65], v9 offset:12288
  v_mfma_f32_16x16x32_bf16 v[228:231], v[76:79], a[132:135], v[228:231]
  ds_read_b64_tr_b16 v[66:67], v9 offset:14336
  v_mfma_f32_16x16x32_bf16 v[232:235], v[68:71], a[104:107], v[232:235]
  s_add_u32 m0, s33, 36864
  v_mfma_f32_16x16x32_bf16 v[232:235], v[72:75], a[120:123], v[232:235]
  s_mov_b32 s34, 589824
  v_mfma_f32_16x16x32_bf16 v[232:235], v[76:79], a[136:139], v[232:235]
  buffer_load_dwordx4 v20, s[24:27], s34 offen lds
  v_mfma_f32_16x16x32_bf16 v[236:239], v[68:71], a[108:111], v[236:239]
  s_add_u32 m0, s33, 40960
  v_mfma_f32_16x16x32_bf16 v[236:239], v[72:75], a[124:127], v[236:239]
  s_mov_b32 s34, 884736
  v_mfma_f32_16x16x32_bf16 v[236:239], v[76:79], a[140:143], v[236:239]
  buffer_load_dwordx4 v20, s[24:27], s34 offen lds
  s_waitcnt lgkmcnt(6)
  v_mfma_f32_16x16x32_bf16 v[240:243], v[80:83], a[96:99], v[240:243]
  ds_read_b64_tr_b16 v[68:69], v12 offset:4096
  v_mfma_f32_16x16x32_bf16 v[240:243], v[84:87], a[112:115], v[240:243]
  ds_read_b64_tr_b16 v[70:71], v12 offset:6144
  v_mfma_f32_16x16x32_bf16 v[240:243], v[88:91], a[128:131], v[240:243]
  ds_read_b64_tr_b16 v[72:73], v12 offset:8192
  v_mfma_f32_16x16x32_bf16 v[244:247], v[80:83], a[100:103], v[244:247]
  ds_read_b64_tr_b16 v[74:75], v12 offset:10240
  v_mfma_f32_16x16x32_bf16 v[244:247], v[84:87], a[116:119], v[244:247]
  ds_read_b64_tr_b16 v[76:77], v12 offset:12288
  v_mfma_f32_16x16x32_bf16 v[244:247], v[88:91], a[132:135], v[244:247]
  ds_read_b64_tr_b16 v[78:79], v12 offset:14336
  v_mfma_f32_16x16x32_bf16 v[248:251], v[80:83], a[104:107], v[248:251]
  v_mfma_f32_16x16x32_bf16 v[248:251], v[84:87], a[120:123], v[248:251]
  v_mfma_f32_16x16x32_bf16 v[248:251], v[88:91], a[136:139], v[248:251]
  v_mfma_f32_16x16x32_bf16 v[252:255], v[80:83], a[108:111], v[252:255]
  v_mfma_f32_16x16x32_bf16 v[252:255], v[84:87], a[124:127], v[252:255]
  v_mfma_f32_16x16x32_bf16 v[252:255], v[88:91], a[140:143], v[252:255]
  s_waitcnt lgkmcnt(6)
  v_mfma_f32_16x16x32_bf16 v[192:195], v[56:59], a[144:147], v[192:195]
  s_waitcnt vmcnt(13)
  s_barrier
  v_mfma_f32_16x16x32_bf16 v[192:195], v[60:63], a[160:163], v[192:195]
  ds_read_b64_tr_b16 v[80:81], v9 offset:16384
  v_mfma_f32_16x16x32_bf16 v[192:195], v[64:67], a[176:179], v[192:195]
  ds_read_b64_tr_b16 v[82:83], v9 offset:18432
  v_mfma_f32_16x16x32_bf16 v[196:199], v[56:59], a[148:151], v[196:199]
  ds_read_b64_tr_b16 v[84:85], v9 offset:20480
  v_mfma_f32_16x16x32_bf16 v[196:199], v[60:63], a[164:167], v[196:199]
  ds_read_b64_tr_b16 v[86:87], v9 offset:22528
  v_mfma_f32_16x16x32_bf16 v[196:199], v[64:67], a[180:183], v[196:199]
  ds_read_b64_tr_b16 v[88:89], v9 offset:49152
  v_mfma_f32_16x16x32_bf16 v[200:203], v[56:59], a[152:155], v[200:203]
  ds_read_b64_tr_b16 v[90:91], v9 offset:51200
  v_mfma_f32_16x16x32_bf16 v[200:203], v[60:63], a[168:171], v[200:203]
  s_add_u32 m0, s33, 45056
  v_mfma_f32_16x16x32_bf16 v[200:203], v[64:67], a[184:187], v[200:203]
  s_mov_b32 s34, 1179648
  v_mfma_f32_16x16x32_bf16 v[204:207], v[56:59], a[156:159], v[204:207]
  buffer_load_dwordx4 v20, s[24:27], s34 offen lds
  v_mfma_f32_16x16x32_bf16 v[204:207], v[60:63], a[172:175], v[204:207]
  s_add_u32 m0, s33, 49152
  v_mfma_f32_16x16x32_bf16 v[204:207], v[64:67], a[188:191], v[204:207]
  s_mov_b32 s34, 1474560
  buffer_load_dwordx4 v20, s[24:27], s34 offen lds
  s_waitcnt lgkmcnt(6)
  v_mfma_f32_16x16x32_bf16 v[208:211], v[68:71], a[144:147], v[208:211]
  ds_read_b64_tr_b16 v[56:57], v12 offset:16384
  v_mfma_f32_16x16x32_bf16 v[208:211], v[72:75], a[160:163], v[208:211]
  ds_read_b64_tr_b16 v[58:59], v12 offset:18432
  v_mfma_f32_16x16x32_bf16 v[208:211], v[76:79], a[176:179], v[208:211]
  ds_read_b64_tr_b16 v[60:61], v12 offset:20480
  v_mfma_f32_16x16x32_bf16 v[212:215], v[68:71], a[148:151], v[212:215]
  ds_read_b64_tr_b16 v[62:63], v12 offset:22528
  v_mfma_f32_16x16x32_bf16 v[212:215], v[72:75], a[164:167], v[212:215]
  ds_read_b64_tr_b16 v[64:65], v12 offset:49152
  v_mfma_f32_16x16x32_bf16 v[212:215], v[76:79], a[180:183], v[212:215]
  ds_read_b64_tr_b16 v[66:67], v12 offset:51200
  v_mfma_f32_16x16x32_bf16 v[216:219], v[68:71], a[152:155], v[216:219]
  s_add_u32 m0, s33, 53248
  v_mfma_f32_16x16x32_bf16 v[216:219], v[72:75], a[168:171], v[216:219]
  s_mov_b32 s34, 1769472
  v_mfma_f32_16x16x32_bf16 v[216:219], v[76:79], a[184:187], v[216:219]
  buffer_load_dwordx4 v20, s[24:27], s34 offen lds
  v_mfma_f32_16x16x32_bf16 v[220:223], v[68:71], a[156:159], v[220:223]
  s_add_u32 m0, s33, 57344
  v_mfma_f32_16x16x32_bf16 v[220:223], v[72:75], a[172:175], v[220:223]
  s_mov_b32 s34, 2064384
  v_mfma_f32_16x16x32_bf16 v[220:223], v[76:79], a[188:191], v[220:223]
  buffer_load_dwordx4 v20, s[24:27], s34 offen lds
  s_waitcnt lgkmcnt(6)
  v_mfma_f32_16x16x32_bf16 v[224:227], v[80:83], a[144:147], v[224:227]
  ds_read_b64_tr_b16 v[68:69], v9 offset:53248
  v_mfma_f32_16x16x32_bf16 v[224:227], v[84:87], a[160:163], v[224:227]
  ds_read_b64_tr_b16 v[70:71], v9 offset:55296
  v_mfma_f32_16x16x32_bf16 v[224:227], v[88:91], a[176:179], v[224:227]
  ds_read_b64_tr_b16 v[72:73], v9 offset:57344
  v_mfma_f32_16x16x32_bf16 v[228:231], v[80:83], a[148:151], v[228:231]
  ds_read_b64_tr_b16 v[74:75], v9 offset:59392
  v_mfma_f32_16x16x32_bf16 v[228:231], v[84:87], a[164:167], v[228:231]
  ds_read_b64_tr_b16 v[76:77], v10 offset:20480
  v_mfma_f32_16x16x32_bf16 v[228:231], v[88:91], a[180:183], v[228:231]
  ds_read_b64_tr_b16 v[78:79], v10 offset:22528
  v_mfma_f32_16x16x32_bf16 v[232:235], v[80:83], a[152:155], v[232:235]
  s_add_u32 m0, s33, 61440
  v_mfma_f32_16x16x32_bf16 v[232:235], v[84:87], a[168:171], v[232:235]
  s_mov_b32 s34, 2359296
  v_mfma_f32_16x16x32_bf16 v[232:235], v[88:91], a[184:187], v[232:235]
  buffer_load_dwordx4 v20, s[24:27], s34 offen lds
  v_mfma_f32_16x16x32_bf16 v[236:239], v[80:83], a[156:159], v[236:239]
  s_add_u32 m0, s33, 65536
  v_mfma_f32_16x16x32_bf16 v[236:239], v[84:87], a[172:175], v[236:239]
  s_mov_b32 s34, 2654208
  v_mfma_f32_16x16x32_bf16 v[236:239], v[88:91], a[188:191], v[236:239]
  buffer_load_dwordx4 v20, s[24:27], s34 offen lds
  s_waitcnt lgkmcnt(6)
  v_mfma_f32_16x16x32_bf16 v[240:243], v[56:59], a[144:147], v[240:243]
  ds_read_b64_tr_b16 v[80:81], v12 offset:53248
  v_mfma_f32_16x16x32_bf16 v[240:243], v[60:63], a[160:163], v[240:243]
  ds_read_b64_tr_b16 v[82:83], v12 offset:55296
  v_mfma_f32_16x16x32_bf16 v[240:243], v[64:67], a[176:179], v[240:243]
  ds_read_b64_tr_b16 v[84:85], v12 offset:57344
  v_mfma_f32_16x16x32_bf16 v[244:247], v[56:59], a[148:151], v[244:247]
  ds_read_b64_tr_b16 v[86:87], v12 offset:59392
  v_mfma_f32_16x16x32_bf16 v[244:247], v[60:63], a[164:167], v[244:247]
  ds_read_b64_tr_b16 v[88:89], v13 offset:20480
  v_mfma_f32_16x16x32_bf16 v[244:247], v[64:67], a[180:183], v[244:247]
  ds_read_b64_tr_b16 v[90:91], v13 offset:22528
  v_mfma_f32_16x16x32_bf16 v[248:251], v[56:59], a[152:155], v[248:251]
  v_mfma_f32_16x16x32_bf16 v[248:251], v[60:63], a[168:171], v[248:251]
  v_mfma_f32_16x16x32_bf16 v[248:251], v[64:67], a[184:187], v[248:251]
  v_mfma_f32_16x16x32_bf16 v[252:255], v[56:59], a[156:159], v[252:255]
  v_mfma_f32_16x16x32_bf16 v[252:255], v[60:63], a[172:175], v[252:255]
  v_mfma_f32_16x16x32_bf16 v[252:255], v[64:67], a[188:191], v[252:255]
  s_waitcnt lgkmcnt(6)
  v_mfma_f32_16x16x32_bf16 v[192:195], v[68:71], a[192:195], v[192:195]
  s_waitcnt vmcnt(13)
  s_barrier
  v_mfma_f32_16x16x32_bf16 v[192:195], v[72:75], a[208:211], v[192:195]
  ds_read_b64_tr_b16 v[56:57], v10 offset:24576
  v_mfma_f32_16x16x32_bf16 v[192:195], v[76:79], a[224:227], v[192:195]
  ds_read_b64_tr_b16 v[58:59], v10 offset:26624
  v_mfma_f32_16x16x32_bf16 v[196:199], v[68:71], a[196:199], v[196:199]
  ds_read_b64_tr_b16 v[60:61], v10 offset:28672
  v_mfma_f32_16x16x32_bf16 v[196:199], v[72:75], a[212:215], v[196:199]
  ds_read_b64_tr_b16 v[62:63], v10 offset:30720
  v_mfma_f32_16x16x32_bf16 v[196:199], v[76:79], a[228:231], v[196:199]
  ds_read_b64_tr_b16 v[64:65], v8
  v_mfma_f32_16x16x32_bf16 v[200:203], v[68:71], a[200:203], v[200:203]
  ds_read_b64_tr_b16 v[66:67], v8 offset:2048
  v_mfma_f32_16x16x32_bf16 v[200:203], v[72:75], a[216:219], v[200:203]
  s_add_u32 m0, s33, 69632
  v_mfma_f32_16x16x32_bf16 v[200:203], v[76:79], a[232:235], v[200:203]
  s_mov_b32 s34, 2949120
  v_mfma_f32_16x16x32_bf16 v[204:207], v[68:71], a[204:207], v[204:207]
  buffer_load_dwordx4 v20, s[24:27], s34 offen lds
  v_mfma_f32_16x16x32_bf16 v[204:207], v[72:75], a[220:223], v[204:207]
  s_add_u32 m0, s33, 73728
  v_mfma_f32_16x16x32_bf16 v[204:207], v[76:79], a[236:239], v[204:207]
  s_mov_b32 s34, 3244032
  buffer_load_dwordx4 v20, s[24:27], s34 offen lds
  s_waitcnt lgkmcnt(6)
  v_mfma_f32_16x16x32_bf16 v[208:211], v[80:83], a[192:195], v[208:211]
  ds_read_b64_tr_b16 v[68:69], v13 offset:24576
  v_mfma_f32_16x16x32_bf16 v[208:211], v[84:87], a[208:211], v[208:211]
  ds_read_b64_tr_b16 v[70:71], v13 offset:26624
  v_mfma_f32_16x16x32_bf16 v[208:211], v[88:91], a[224:227], v[208:211]
  ds_read_b64_tr_b16 v[72:73], v13 offset:28672
  v_mfma_f32_16x16x32_bf16 v[212:215], v[80:83], a[196:199], v[212:215]
  ds_read_b64_tr_b16 v[74:75], v13 offset:30720
  v_mfma_f32_16x16x32_bf16 v[212:215], v[84:87], a[212:215], v[212:215]
  ds_read_b64_tr_b16 v[76:77], v11
  v_mfma_f32_16x16x32_bf16 v[212:215], v[88:91], a[228:231], v[212:215]
  ds_read_b64_tr_b16 v[78:79], v11 offset:2048
  v_mfma_f32_16x16x32_bf16 v[216:219], v[80:83], a[200:203], v[216:219]
  s_add_u32 m0, s33, 77824
  v_mfma_f32_16x16x32_bf16 v[216:219], v[84:87], a[216:219], v[216:219]
  s_mov_b32 s34, 3538944
  v_mfma_f32_16x16x32_bf16 v[216:219], v[88:91], a[232:235], v[216:219]
  buffer_load_dwordx4 v20, s[24:27], s34 offen lds
  v_mfma_f32_16x16x32_bf16 v[220:223], v[80:83], a[204:207], v[220:223]
  s_add_u32 m0, s33, 81920
  v_mfma_f32_16x16x32_bf16 v[220:223], v[84:87], a[220:223], v[220:223]
  s_mov_b32 s34, 3833856
  v_mfma_f32_16x16x32_bf16 v[220:223], v[88:91], a[236:239], v[220:223]
  buffer_load_dwordx4 v20, s[24:27], s34 offen lds
  s_waitcnt lgkmcnt(6)
  v_mfma_f32_16x16x32_bf16 v[224:227], v[56:59], a[192:195], v[224:227]
  ds_read_b64_tr_b16 v[80:81], v8 offset:4096
  v_mfma_f32_16x16x32_bf16 v[224:227], v[60:63], a[208:211], v[224:227]
  ds_read_b64_tr_b16 v[82:83], v8 offset:6144
  v_mfma_f32_16x16x32_bf16 v[224:227], v[64:67], a[224:227], v[224:227]
  ds_read_b64_tr_b16 v[84:85], v8 offset:8192
  v_mfma_f32_16x16x32_bf16 v[228:231], v[56:59], a[196:199], v[228:231]
  ds_read_b64_tr_b16 v[86:87], v8 offset:10240
  v_mfma_f32_16x16x32_bf16 v[228:231], v[60:63], a[212:215], v[228:231]
  ds_read_b64_tr_b16 v[88:89], v8 offset:12288
  v_mfma_f32_16x16x32_bf16 v[228:231], v[64:67], a[228:231], v[228:231]
  ds_read_b64_tr_b16 v[90:91], v8 offset:14336
  v_mfma_f32_16x16x32_bf16 v[232:235], v[56:59], a[200:203], v[232:235]
  s_add_u32 m0, s33, 86016
  v_mfma_f32_16x16x32_bf16 v[232:235], v[60:63], a[216:219], v[232:235]
  s_mov_b32 s34, 4128768
  v_mfma_f32_16x16x32_bf16 v[232:235], v[64:67], a[232:235], v[232:235]
  buffer_load_dwordx4 v20, s[24:27], s34 offen lds
  v_mfma_f32_16x16x32_bf16 v[236:239], v[56:59], a[204:207], v[236:239]
  v_mfma_f32_16x16x32_bf16 v[236:239], v[60:63], a[220:223], v[236:239]
  v_mfma_f32_16x16x32_bf16 v[236:239], v[64:67], a[236:239], v[236:239]
  s_waitcnt lgkmcnt(6)
  v_mfma_f32_16x16x32_bf16 v[240:243], v[68:71], a[192:195], v[240:243]
  ds_read_b64_tr_b16 v[56:57], v11 offset:4096
  v_mfma_f32_16x16x32_bf16 v[240:243], v[72:75], a[208:211], v[240:243]
  ds_read_b64_tr_b16 v[58:59], v11 offset:6144
  v_mfma_f32_16x16x32_bf16 v[240:243], v[76:79], a[224:227], v[240:243]
  ds_read_b64_tr_b16 v[60:61], v11 offset:8192
  v_mfma_f32_16x16x32_bf16 v[244:247], v[68:71], a[196:199], v[244:247]
  ds_read_b64_tr_b16 v[62:63], v11 offset:10240
  v_mfma_f32_16x16x32_bf16 v[244:247], v[72:75], a[212:215], v[244:247]
  ds_read_b64_tr_b16 v[64:65], v11 offset:12288
  v_mfma_f32_16x16x32_bf16 v[244:247], v[76:79], a[228:231], v[244:247]
  ds_read_b64_tr_b16 v[66:67], v11 offset:14336
  v_mfma_f32_16x16x32_bf16 v[248:251], v[68:71], a[200:203], v[248:251]
  v_mfma_f32_16x16x32_bf16 v[248:251], v[72:75], a[216:219], v[248:251]
  v_mfma_f32_16x16x32_bf16 v[248:251], v[76:79], a[232:235], v[248:251]
  v_mfma_f32_16x16x32_bf16 v[252:255], v[68:71], a[204:207], v[252:255]
  v_mfma_f32_16x16x32_bf16 v[252:255], v[72:75], a[220:223], v[252:255]
  v_mfma_f32_16x16x32_bf16 v[252:255], v[76:79], a[236:239], v[252:255]
  s_waitcnt lgkmcnt(6)
  v_mfma_f32_16x16x32_bf16 v[192:195], v[80:83], a[240:243], v[192:195]
  s_waitcnt vmcnt(12)
  s_barrier
  v_mfma_f32_16x16x32_bf16 v[192:195], v[84:87], v[96:99], v[192:195]
  ds_read_b64_tr_b16 v[68:69], v8 offset:16384
  v_mfma_f32_16x16x32_bf16 v[192:195], v[88:91], v[112:115], v[192:195]
  ds_read_b64_tr_b16 v[70:71], v8 offset:18432
  v_mfma_f32_16x16x32_bf16 v[196:199], v[80:83], a[244:247], v[196:199]
  ds_read_b64_tr_b16 v[72:73], v8 offset:20480
  v_mfma_f32_16x16x32_bf16 v[196:199], v[84:87], v[100:103], v[196:199]
  ds_read_b64_tr_b16 v[74:75], v8 offset:22528
  v_mfma_f32_16x16x32_bf16 v[196:199], v[88:91], v[116:119], v[196:199]
  ds_read_b64_tr_b16 v[76:77], v8 offset:24576
  v_mfma_f32_16x16x32_bf16 v[200:203], v[80:83], a[248:251], v[200:203]
  ds_read_b64_tr_b16 v[78:79], v8 offset:26624
  v_mfma_f32_16x16x32_bf16 v[200:203], v[84:87], v[104:107], v[200:203]
  s_add_u32 m0, s33, 122880
  v_mfma_f32_16x16x32_bf16 v[200:203], v[88:91], v[120:123], v[200:203]
  s_mov_b32 s34, 4423680
  v_mfma_f32_16x16x32_bf16 v[204:207], v[80:83], a[252:255], v[204:207]
  buffer_load_dwordx4 v20, s[24:27], s34 offen lds
  v_mfma_f32_16x16x32_bf16 v[204:207], v[84:87], v[108:111], v[204:207]
  s_add_u32 m0, s33, 159744
  v_mfma_f32_16x16x32_bf16 v[204:207], v[88:91], v[124:127], v[204:207]
  s_mov_b32 s34, 4718592
  buffer_load_dwordx4 v20, s[24:27], s34 offen lds
  s_waitcnt lgkmcnt(6)
  v_mfma_f32_16x16x32_bf16 v[208:211], v[56:59], a[240:243], v[208:211]
  ds_read_b64_tr_b16 v[80:81], v11 offset:16384
  v_mfma_f32_16x16x32_bf16 v[208:211], v[60:63], v[96:99], v[208:211]
  ds_read_b64_tr_b16 v[82:83], v11 offset:18432
  v_mfma_f32_16x16x32_bf16 v[208:211], v[64:67], v[112:115], v[208:211]
  ds_read_b64_tr_b16 v[84:85], v11 offset:20480
  v_mfma_f32_16x16x32_bf16 v[212:215], v[56:59], a[244:247], v[212:215]
  ds_read_b64_tr_b16 v[86:87], v11 offset:22528
  v_mfma_f32_16x16x32_bf16 v[212:215], v[60:63], v[100:103], v[212:215]
  ds_read_b64_tr_b16 v[88:89], v11 offset:24576
  v_mfma_f32_16x16x32_bf16 v[212:215], v[64:67], v[116:119], v[212:215]
  ds_read_b64_tr_b16 v[90:91], v11 offset:26624
  v_mfma_f32_16x16x32_bf16 v[216:219], v[56:59], a[248:251], v[216:219]
  s_add_u32 m0, s33, 0
  v_mfma_f32_16x16x32_bf16 v[216:219], v[60:63], v[104:107], v[216:219]
  s_mov_b32 s34, 5013504
  v_mfma_f32_16x16x32_bf16 v[216:219], v[64:67], v[120:123], v[216:219]
  buffer_load_dwordx4 v20, s[24:27], s34 offen lds
  v_mfma_f32_16x16x32_bf16 v[220:223], v[56:59], a[252:255], v[220:223]
  v_mfma_f32_16x16x32_bf16 v[220:223], v[60:63], v[108:111], v[220:223]
  v_mfma_f32_16x16x32_bf16 v[220:223], v[64:67], v[124:127], v[220:223]
  s_waitcnt lgkmcnt(6)
  v_mfma_f32_16x16x32_bf16 v[224:227], v[68:71], a[240:243], v[224:227]
  ds_read_b64_tr_b16 v[56:57], v14 offset:28672
  v_mfma_f32_16x16x32_bf16 v[224:227], v[72:75], v[96:99], v[224:227]
  ds_read_b64_tr_b16 v[58:59], v14 offset:29696
  v_mfma_f32_16x16x32_bf16 v[224:227], v[76:79], v[112:115], v[224:227]
  ds_read_b64_tr_b16 v[60:61], v14 offset:32768
  v_mfma_f32_16x16x32_bf16 v[228:231], v[68:71], a[244:247], v[228:231]
  ds_read_b64_tr_b16 v[62:63], v14 offset:33792
  v_mfma_f32_16x16x32_bf16 v[228:231], v[72:75], v[100:103], v[228:231]
  ds_read_b64_tr_b16 v[64:65], v14 offset:36864
  v_mfma_f32_16x16x32_bf16 v[228:231], v[76:79], v[116:119], v[228:231]
  ds_read_b64_tr_b16 v[66:67], v14 offset:37888
  v_mfma_f32_16x16x32_bf16 v[232:235], v[68:71], a[248:251], v[232:235]
  v_mfma_f32_16x16x32_bf16 v[232:235], v[72:75], v[104:107], v[232:235]
  v_mfma_f32_16x16x32_bf16 v[232:235], v[76:79], v[120:123], v[232:235]
  v_mfma_f32_16x16x32_bf16 v[236:239], v[68:71], a[252:255], v[236:239]
  v_mfma_f32_16x16x32_bf16 v[236:239], v[72:75], v[108:111], v[236:239]
  v_mfma_f32_16x16x32_bf16 v[236:239], v[76:79], v[124:127], v[236:239]
  s_waitcnt lgkmcnt(6)
  v_mfma_f32_16x16x32_bf16 v[240:243], v[80:83], a[240:243], v[240:243]
  ds_read_b64_tr_b16 v[68:69], v14 offset:30720
  v_mfma_f32_16x16x32_bf16 v[240:243], v[84:87], v[96:99], v[240:243]
  ds_read_b64_tr_b16 v[70:71], v14 offset:31744
  v_mfma_f32_16x16x32_bf16 v[240:243], v[88:91], v[112:115], v[240:243]
  ds_read_b64_tr_b16 v[72:73], v14 offset:34816
  v_mfma_f32_16x16x32_bf16 v[244:247], v[80:83], a[244:247], v[244:247]
  ds_read_b64_tr_b16 v[74:75], v14 offset:35840
  v_mfma_f32_16x16x32_bf16 v[244:247], v[84:87], v[100:103], v[244:247]
  ds_read_b64_tr_b16 v[76:77], v14 offset:38912
  v_mfma_f32_16x16x32_bf16 v[244:247], v[88:91], v[116:119], v[244:247]
  ds_read_b64_tr_b16 v[78:79], v14 offset:39936
  v_mfma_f32_16x16x32_bf16 v[248:251], v[80:83], a[248:251], v[248:251]
  v_mfma_f32_16x16x32_bf16 v[248:251], v[84:87], v[104:107], v[248:251]
  v_mfma_f32_16x16x32_bf16 v[248:251], v[88:91], v[120:123], v[248:251]
  v_mfma_f32_16x16x32_bf16 v[252:255], v[80:83], a[252:255], v[252:255]
  v_mfma_f32_16x16x32_bf16 v[252:255], v[84:87], v[108:111], v[252:255]
  v_mfma_f32_16x16x32_bf16 v[252:255], v[88:91], v[124:127], v[252:255]
  s_waitcnt lgkmcnt(6)
  v_mfma_f32_16x16x32_bf16 v[128:131], v[56:59], a[0:3], 0
  s_waitcnt vmcnt(9)
  s_barrier
  v_mfma_f32_16x16x32_bf16 v[128:131], v[60:63], a[16:19], v[128:131]
  ds_read_b64_tr_b16 v[80:81], v14 offset:40960
  v_mul_f32 v192, v192, v224
  v_mfma_f32_16x16x32_bf16 v[128:131], v[64:67], a[32:35], v[128:131]
  ds_read_b64_tr_b16 v[82:83], v14 offset:41984
  v_mul_f32 v193, v193, v225
  v_mfma_f32_16x16x32_bf16 v[132:135], v[56:59], a[4:7], 0
  ds_read_b64_tr_b16 v[84:85], v14 offset:45056
  v_mul_f32 v194, v194, v226
  v_mfma_f32_16x16x32_bf16 v[132:135], v[60:63], a[20:23], v[132:135]
  ds_read_b64_tr_b16 v[86:87], v14 offset:46080
  v_mul_f32 v195, v195, v227
  v_mfma_f32_16x16x32_bf16 v[132:135], v[64:67], a[36:39], v[132:135]
  ds_read_b64_tr_b16 v[88:89], v14 offset:49152
  v_cvt_pk_bf16_f32 v32, v192, v193
  v_mfma_f32_16x16x32_bf16 v[136:139], v[56:59], a[8:11], 0
  ds_read_b64_tr_b16 v[90:91], v14 offset:50176
  v_cvt_pk_bf16_f32 v33, v194, v195
  v_mfma_f32_16x16x32_bf16 v[136:139], v[60:63], a[24:27], v[136:139]
  s_add_u32 m0, s33, 4096
  v_mul_f32 v208, v208, v240
  v_mfma_f32_16x16x32_bf16 v[136:139], v[64:67], a[40:43], v[136:139]
  s_mov_b32 s34, 0
  v_mul_f32 v209, v209, v241
  v_mfma_f32_16x16x32_bf16 v[140:143], v[56:59], a[12:15], 0
  buffer_load_dwordx4 v21, s[12:15], s34 offen lds
  v_mul_f32 v210, v210, v242
  v_mfma_f32_16x16x32_bf16 v[140:143], v[60:63], a[28:31], v[140:143]
  s_add_u32 m0, s33, 8192
  v_mul_f32 v211, v211, v243
  v_mfma_f32_16x16x32_bf16 v[140:143], v[64:67], a[44:47], v[140:143]
  s_mov_b32 s34, 36864
  buffer_load_dwordx4 v21, s[12:15], s34 offen lds
  s_waitcnt lgkmcnt(6)
  v_mfma_f32_16x16x32_bf16 v[144:147], v[68:71], a[0:3], 0
  ds_read_b64_tr_b16 v[56:57], v14 offset:43008
  v_cvt_pk_bf16_f32 v34, v208, v209
  v_mfma_f32_16x16x32_bf16 v[144:147], v[72:75], a[16:19], v[144:147]
  ds_read_b64_tr_b16 v[58:59], v14 offset:44032
  v_cvt_pk_bf16_f32 v35, v210, v211
  v_mfma_f32_16x16x32_bf16 v[144:147], v[76:79], a[32:35], v[144:147]
  ds_read_b64_tr_b16 v[60:61], v14 offset:47104
  ds_write_b128 v17, v[32:35] offset:24576
  v_mfma_f32_16x16x32_bf16 v[148:151], v[68:71], a[4:7], 0
  ds_read_b64_tr_b16 v[62:63], v14 offset:48128
  v_mul_f32 v196, v196, v228
  v_mfma_f32_16x16x32_bf16 v[148:151], v[72:75], a[20:23], v[148:151]
  ds_read_b64_tr_b16 v[64:65], v14 offset:51200
  v_mul_f32 v197, v197, v229
  v_mfma_f32_16x16x32_bf16 v[148:151], v[76:79], a[36:39], v[148:151]
  ds_read_b64_tr_b16 v[66:67], v14 offset:52224
  v_mul_f32 v198, v198, v230
  v_mfma_f32_16x16x32_bf16 v[152:155], v[68:71], a[8:11], 0
  s_add_u32 m0, s33, 12288
  v_mul_f32 v199, v199, v231
  v_mfma_f32_16x16x32_bf16 v[152:155], v[72:75], a[24:27], v[152:155]
  s_mov_b32 s34, 73728
  v_cvt_pk_bf16_f32 v36, v196, v197
  v_mfma_f32_16x16x32_bf16 v[152:155], v[76:79], a[40:43], v[152:155]
  buffer_load_dwordx4 v21, s[12:15], s34 offen lds
  v_cvt_pk_bf16_f32 v37, v198, v199
  v_mfma_f32_16x16x32_bf16 v[156:159], v[68:71], a[12:15], 0
  s_add_u32 m0, s33, 16384
  v_mul_f32 v212, v212, v244
  v_mfma_f32_16x16x32_bf16 v[156:159], v[72:75], a[28:31], v[156:159]
  s_mov_b32 s34, 110592
  v_mul_f32 v213, v213, v245
  v_mfma_f32_16x16x32_bf16 v[156:159], v[76:79], a[44:47], v[156:159]
  buffer_load_dwordx4 v21, s[12:15], s34 offen lds
  s_waitcnt lgkmcnt(7)
  v_mfma_f32_16x16x32_bf16 v[128:131], v[80:83], a[48:51], v[128:131]
  ds_read_b64_tr_b16 v[68:69], v14 offset:53248
  v_mul_f32 v214, v214, v246
  v_mfma_f32_16x16x32_bf16 v[128:131], v[84:87], a[64:67], v[128:131]
  ds_read_b64_tr_b16 v[70:71], v14 offset:54272
  v_mul_f32 v215, v215, v247
  v_mfma_f32_16x16x32_bf16 v[128:131], v[88:91], a[80:83], v[128:131]
  ds_read_b64_tr_b16 v[72:73], v14 offset:57344
  v_cvt_pk_bf16_f32 v38, v212, v213
  v_mfma_f32_16x16x32_bf16 v[132:135], v[80:83], a[52:55], v[132:135]
  ds_read_b64_tr_b16 v[74:75], v14 offset:58368
  v_cvt_pk_bf16_f32 v39, v214, v215
  v_mfma_f32_16x16x32_bf16 v[132:135], v[84:87], a[68:71], v[132:135]
  ds_read_b64_tr_b16 v[76:77], v14 offset:61440
  ds_write_b128 v17, v[36:39] offset:25600
  v_mfma_f32_16x16x32_bf16 v[132:135], v[88:91], a[84:87], v[132:135]
  ds_read_b64_tr_b16 v[78:79], v14 offset:62464
  v_mul_f32 v200, v200, v232
  v_mfma_f32_16x16x32_bf16 v[136:139], v[80:83], a[56:59], v[136:139]
  s_add_u32 m0, s33, 20480
  v_mul_f32 v201, v201, v233
  v_mfma_f32_16x16x32_bf16 v[136:139], v[84:87], a[72:75], v[136:139]
  s_mov_b32 s34, 147456
  v_mul_f32 v202, v202, v234
  v_mfma_f32_16x16x32_bf16 v[136:139], v[88:91], a[88:91], v[136:139]
  buffer_load_dwordx4 v21, s[12:15], s34 offen lds
  v_mul_f32 v203, v203, v235
  v_mfma_f32_16x16x32_bf16 v[140:143], v[80:83], a[60:63], v[140:143]
  s_add_u32 m0, s33, 24576
  v_cvt_pk_bf16_f32 v32, v200, v201
  v_mfma_f32_16x16x32_bf16 v[140:143], v[84:87], a[76:79], v[140:143]
  s_mov_b32 s34, 184320
  v_cvt_pk_bf16_f32 v33, v202, v203
  v_mfma_f32_16x16x32_bf16 v[140:143], v[88:91], a[92:95], v[140:143]
  buffer_load_dwordx4 v21, s[12:15], s34 offen lds
  s_waitcnt lgkmcnt(7)
  v_mfma_f32_16x16x32_bf16 v[144:147], v[56:59], a[48:51], v[144:147]
  s_waitcnt vmcnt(12)
  s_barrier
  v_mfma_f32_16x16x32_bf16 v[144:147], v[60:63], a[64:67], v[144:147]
  ds_read_b64_tr_b16 v[80:81], v14 offset:55296
  v_mul_f32 v216, v216, v248
  v_mfma_f32_16x16x32_bf16 v[144:147], v[64:67], a[80:83], v[144:147]
  ds_read_b64_tr_b16 v[82:83], v14 offset:56320
  v_mul_f32 v217, v217, v249
  v_mfma_f32_16x16x32_bf16 v[148:151], v[56:59], a[52:55], v[148:151]
  ds_read_b64_tr_b16 v[84:85], v14 offset:59392
  v_mul_f32 v218, v218, v250
  v_mfma_f32_16x16x32_bf16 v[148:151], v[60:63], a[68:71], v[148:151]
  ds_read_b64_tr_b16 v[86:87], v14 offset:60416
  v_mul_f32 v219, v219, v251
  v_mfma_f32_16x16x32_bf16 v[148:151], v[64:67], a[84:87], v[148:151]
  ds_read_b64_tr_b16 v[88:89], v14 offset:63488
  v_cvt_pk_bf16_f32 v34, v216, v217
  v_mfma_f32_16x16x32_bf16 v[152:155], v[56:59], a[56:59], v[152:155]
  ds_read_b64_tr_b16 v[90:91], v14 offset:64512
  v_cvt_pk_bf16_f32 v35, v218, v219
  v_mfma_f32_16x16x32_bf16 v[152:155], v[60:63], a[72:75], v[152:155]
  s_add_u32 m0, s33, 28672
  ds_write_b128 v17, v[32:35] offset:26624
  v_mfma_f32_16x16x32_bf16 v[152:155], v[64:67], a[88:91], v[152:155]
  s_mov_b32 s34, 221184
  v_mul_f32 v204, v204, v236
  v_mfma_f32_16x16x32_bf16 v[156:159], v[56:59], a[60:63], v[156:159]
  buffer_load_dwordx4 v21, s[12:15], s34 offen lds
  v_mul_f32 v205, v205, v237
  v_mfma_f32_16x16x32_bf16 v[156:159], v[60:63], a[76:79], v[156:159]
  s_add_u32 m0, s33, 32768
  v_mul_f32 v206, v206, v238
  v_mfma_f32_16x16x32_bf16 v[156:159], v[64:67], a[92:95], v[156:159]
  s_mov_b32 s34, 258048
  buffer_load_dwordx4 v21, s[12:15], s34 offen lds
  s_waitcnt lgkmcnt(7)
  v_mfma_f32_16x16x32_bf16 v[128:131], v[68:71], a[96:99], v[128:131]
  ds_read_b64_tr_b16 v[56:57], v15
  v_mul_f32 v207, v207, v239
  v_mfma_f32_16x16x32_bf16 v[128:131], v[72:75], a[112:115], v[128:131]
  ds_read_b64_tr_b16 v[58:59], v15 offset:1024
  v_cvt_pk_bf16_f32 v36, v204, v205
  v_mfma_f32_16x16x32_bf16 v[128:131], v[76:79], a[128:131], v[128:131]
  ds_read_b64_tr_b16 v[60:61], v15 offset:4096
  v_cvt_pk_bf16_f32 v37, v206, v207
  v_mfma_f32_16x16x32_bf16 v[132:135], v[68:71], a[100:103], v[132:135]
  ds_read_b64_tr_b16 v[62:63], v15 offset:5120
  v_mul_f32 v220, v220, v252
  v_mfma_f32_16x16x32_bf16 v[132:135], v[72:75], a[116:119], v[132:135]
  ds_read_b64_tr_b16 v[64:65], v15 offset:8192
  v_mul_f32 v221, v221, v253
  v_mfma_f32_16x16x32_bf16 v[132:135], v[76:79], a[132:135], v[132:135]
  ds_read_b64_tr_b16 v[66:67], v15 offset:9216
  v_mul_f32 v222, v222, v254
  v_mfma_f32_16x16x32_bf16 v[136:139], v[68:71], a[104:107], v[136:139]
  s_add_u32 m0, s33, 36864
  v_mul_f32 v223, v223, v255
  v_mfma_f32_16x16x32_bf16 v[136:139], v[72:75], a[120:123], v[136:139]
  s_mov_b32 s34, 0
  v_cvt_pk_bf16_f32 v38, v220, v221
  v_mfma_f32_16x16x32_bf16 v[136:139], v[76:79], a[136:139], v[136:139]
  buffer_load_dwordx4 v22, s[12:15], s34 offen lds
  v_cvt_pk_bf16_f32 v39, v222, v223
  v_mfma_f32_16x16x32_bf16 v[140:143], v[68:71], a[108:111], v[140:143]
  s_add_u32 m0, s33, 40960
  ds_write_b128 v17, v[36:39] offset:27648
  v_mfma_f32_16x16x32_bf16 v[140:143], v[72:75], a[124:127], v[140:143]
  s_mov_b32 s34, 128
  ds_read_b128 a[0:3], v16
  v_mfma_f32_16x16x32_bf16 v[140:143], v[76:79], a[140:143], v[140:143]
  buffer_load_dwordx4 v21, s[12:15], s34 offen lds
  s_waitcnt lgkmcnt(9)
  v_mfma_f32_16x16x32_bf16 v[144:147], v[80:83], a[96:99], v[144:147]
  ds_read_b64_tr_b16 v[68:69], v15 offset:2048
  ds_read_b128 a[4:7], v16 offset:1024
  v_mfma_f32_16x16x32_bf16 v[144:147], v[84:87], a[112:115], v[144:147]
  ds_read_b64_tr_b16 v[70:71], v15 offset:3072
  ds_read_b128 a[8:11], v16 offset:2048
  v_mfma_f32_16x16x32_bf16 v[144:147], v[88:91], a[128:131], v[144:147]
  ds_read_b64_tr_b16 v[72:73], v15 offset:6144
  ds_read_b128 a[12:15], v16 offset:3072
  v_mfma_f32_16x16x32_bf16 v[148:151], v[80:83], a[100:103], v[148:151]
  ds_read_b64_tr_b16 v[74:75], v15 offset:7168
  ds_read_b128 a[16:19], v16 offset:4096
  v_mfma_f32_16x16x32_bf16 v[148:151], v[84:87], a[116:119], v[148:151]
  ds_read_b64_tr_b16 v[76:77], v15 offset:10240
  ds_read_b128 a[20:23], v16 offset:5120
  v_mfma_f32_16x16x32_bf16 v[148:151], v[88:91], a[132:135], v[148:151]
  ds_read_b64_tr_b16 v[78:79], v15 offset:11264
  ds_read_b128 a[24:27], v16 offset:6144
  v_mfma_f32_16x16x32_bf16 v[152:155], v[80:83], a[104:107], v[152:155]
  s_add_u32 m0, s33, 45056
  ds_read_b128 a[28:31], v16 offset:7168
  v_mfma_f32_16x16x32_bf16 v[152:155], v[84:87], a[120:123], v[152:155]
  s_mov_b32 s34, 36992
  ds_read_b128 a[32:35], v16 offset:8192
  v_mfma_f32_16x16x32_bf16 v[152:155], v[88:91], a[136:139], v[152:155]
  buffer_load_dwordx4 v21, s[12:15], s34 offen lds
  ds_read_b128 a[36:39], v16 offset:9216
  v_mfma_f32_16x16x32_bf16 v[156:159], v[80:83], a[108:111], v[156:159]
  s_add_u32 m0, s33, 49152
  ds_read_b128 a[40:43], v16 offset:10240
  v_mfma_f32_16x16x32_bf16 v[156:159], v[84:87], a[124:127], v[156:159]
  s_mov_b32 s34, 73856
  ds_read_b128 a[44:47], v16 offset:11264
  v_mfma_f32_16x16x32_bf16 v[156:159], v[88:91], a[140:143], v[156:159]
  buffer_load_dwordx4 v21, s[12:15], s34 offen lds
  s_waitcnt lgkmcnt(15)
  v_mfma_f32_16x16x32_bf16 v[128:131], v[56:59], a[144:147], v[128:131]
  s_waitcnt vmcnt(12)
  s_barrier
  v_mfma_f32_16x16x32_bf16 v[128:131], v[60:63], a[160:163], v[128:131]
  ds_read_b64_tr_b16 v[80:81], v15 offset:12288
  ds_read_b128 a[48:51], v16 offset:12288
  v_mfma_f32_16x16x32_bf16 v[128:131], v[64:67], a[176:179], v[128:131]
  ds_read_b64_tr_b16 v[82:83], v15 offset:13312
  ds_read_b128 a[52:55], v16 offset:13312
  v_mfma_f32_16x16x32_bf16 v[132:135], v[56:59], a[148:151], v[132:135]
  ds_read_b64_tr_b16 v[84:85], v15 offset:16384
  ds_read_b128 a[56:59], v16 offset:14336
  v_mfma_f32_16x16x32_bf16 v[132:135], v[60:63], a[164:167], v[132:135]
  ds_read_b64_tr_b16 v[86:87], v15 offset:17408
  ds_read_b128 a[60:63], v16 offset:15360
  v_mfma_f32_16x16x32_bf16 v[132:135], v[64:67], a[180:183], v[132:135]
  ds_read_b64_tr_b16 v[88:89], v15 offset:20480
  ds_read_b128 a[64:67], v16 offset:16384
  v_mfma_f32_16x16x32_bf16 v[136:139], v[56:59], a[152:155], v[136:139]
  ds_read_b64_tr_b16 v[90:91], v15 offset:21504
  ds_read_b128 a[68:71], v16 offset:17408
  v_mfma_f32_16x16x32_bf16 v[136:139], v[60:63], a[168:171], v[136:139]
  s_add_u32 m0, s33, 53248
  ds_read_b128 a[72:75], v16 offset:18432
  v_mfma_f32_16x16x32_bf16 v[136:139], v[64:67], a[184:187], v[136:139]
  s_mov_b32 s34, 110720
  ds_read_b128 a[76:79], v16 offset:19456
  v_mfma_f32_16x16x32_bf16 v[140:143], v[56:59], a[156:159], v[140:143]
  buffer_load_dwordx4 v21, s[12:15], s34 offen lds
  ds_read_b128 a[80:83], v16 offset:20480
  v_mfma_f32_16x16x32_bf16 v[140:143], v[60:63], a[172:175], v[140:143]
  s_add_u32 m0, s33, 57344
  ds_read_b128 a[84:87], v16 offset:21504
  v_mfma_f32_16x16x32_bf16 v[140:143], v[64:67], a[188:191], v[140:143]
  s_mov_b32 s34, 147584
  buffer_load_dwordx4 v21, s[12:15], s34 offen lds
  s_waitcnt lgkmcnt(15)
  v_mfma_f32_16x16x32_bf16 v[144:147], v[68:71], a[144:147], v[144:147]
  ds_read_b64_tr_b16 v[56:57], v15 offset:14336
  ds_read_b128 a[88:91], v16 offset:22528
  v_mfma_f32_16x16x32_bf16 v[144:147], v[72:75], a[160:163], v[144:147]
  ds_read_b64_tr_b16 v[58:59], v15 offset:15360
  ds_read_b128 a[92:95], v16 offset:23552
  v_mfma_f32_16x16x32_bf16 v[144:147], v[76:79], a[176:179], v[144:147]
  ds_read_b64_tr_b16 v[60:61], v15 offset:18432
  ds_read_b128 a[96:99], v16 offset:24576
  v_mfma_f32_16x16x32_bf16 v[148:151], v[68:71], a[148:151], v[148:151]
  ds_read_b64_tr_b16 v[62:63], v15 offset:19456
  ds_read_b128 a[100:103], v16 offset:25600
  v_mfma_f32_16x16x32_bf16 v[148:151], v[72:75], a[164:167], v[148:151]
  ds_read_b64_tr_b16 v[64:65], v15 offset:22528
  ds_read_b128 a[104:107], v16 offset:26624
  v_mfma_f32_16x16x32_bf16 v[148:151], v[76:79], a[180:183], v[148:151]
  ds_read_b64_tr_b16 v[66:67], v15 offset:23552
  ds_read_b128 a[108:111], v16 offset:27648
  v_mfma_f32_16x16x32_bf16 v[152:155], v[68:71], a[152:155], v[152:155]
  s_add_u32 m0, s33, 61440
  ds_read_b128 a[112:115], v16 offset:28672
  v_mfma_f32_16x16x32_bf16 v[152:155], v[72:75], a[168:171], v[152:155]
  s_mov_b32 s34, 184448
  ds_read_b128 a[116:119], v16 offset:29696
  v_mfma_f32_16x16x32_bf16 v[152:155], v[76:79], a[184:187], v[152:155]
  buffer_load_dwordx4 v21, s[12:15], s34 offen lds
  ds_read_b128 a[120:123], v16 offset:30720
  v_mfma_f32_16x16x32_bf16 v[156:159], v[68:71], a[156:159], v[156:159]
  ds_read_b128 a[124:127], v16 offset:31744
  v_mfma_f32_16x16x32_bf16 v[156:159], v[72:75], a[172:175], v[156:159]
  v_mfma_f32_16x16x32_bf16 v[156:159], v[76:79], a[188:191], v[156:159]
  s_waitcnt lgkmcnt(15)
  v_mfma_f32_16x16x32_bf16 v[128:131], v[80:83], a[192:195], v[128:131]
  ds_read_b64_tr_b16 v[68:69], v15 offset:57344
  v_mfma_f32_16x16x32_bf16 v[128:131], v[84:87], a[208:211], v[128:131]
  ds_read_b64_tr_b16 v[70:71], v15 offset:58368
  v_mfma_f32_16x16x32_bf16 v[128:131], v[88:91], a[224:227], v[128:131]
  ds_read_b64_tr_b16 v[72:73], v25 offset:28672
  v_mfma_f32_16x16x32_bf16 v[132:135], v[80:83], a[196:199], v[132:135]
  ds_read_b64_tr_b16 v[74:75], v25 offset:29696
  v_mfma_f32_16x16x32_bf16 v[132:135], v[84:87], a[212:215], v[132:135]
  ds_read_b64_tr_b16 v[76:77], v14
  v_mfma_f32_16x16x32_bf16 v[132:135], v[88:91], a[228:231], v[132:135]
  ds_read_b64_tr_b16 v[78:79], v14 offset:1024
  v_mfma_f32_16x16x32_bf16 v[136:139], v[80:83], a[200:203], v[136:139]
  v_mfma_f32_16x16x32_bf16 v[136:139], v[84:87], a[216:219], v[136:139]
  v_mfma_f32_16x16x32_bf16 v[136:139], v[88:91], a[232:235], v[136:139]
  v_mfma_f32_16x16x32_bf16 v[140:143], v[80:83], a[204:207], v[140:143]
  v_mfma_f32_16x16x32_bf16 v[140:143], v[84:87], a[220:223], v[140:143]
  v_mfma_f32_16x16x32_bf16 v[140:143], v[88:91], a[236:239], v[140:143]
  s_waitcnt lgkmcnt(11)
  v_mfma_f32_16x16x32_bf16 v[144:147], v[56:59], a[192:195], v[144:147]
  s_waitcnt vmcnt(12)
  s_barrier
  v_mfma_f32_16x16x32_bf16 v[144:147], v[60:63], a[208:211], v[144:147]
  ds_read_b64_tr_b16 v[80:81], v15 offset:59392
  v_mfma_f32_16x16x32_bf16 v[144:147], v[64:67], a[224:227], v[144:147]
  ds_read_b64_tr_b16 v[82:83], v15 offset:60416
  v_mfma_f32_16x16x32_bf16 v[148:151], v[56:59], a[196:199], v[148:151]
  ds_read_b64_tr_b16 v[84:85], v25 offset:30720
  v_mfma_f32_16x16x32_bf16 v[148:151], v[60:63], a[212:215], v[148:151]
  ds_read_b64_tr_b16 v[86:87], v25 offset:31744
  v_mfma_f32_16x16x32_bf16 v[148:151], v[64:67], a[228:231], v[148:151]
  ds_read_b64_tr_b16 v[88:89], v14 offset:2048
  v_mfma_f32_16x16x32_bf16 v[152:155], v[56:59], a[200:203], v[152:155]
  ds_read_b64_tr_b16 v[90:91], v14 offset:3072
  v_mfma_f32_16x16x32_bf16 v[152:155], v[60:63], a[216:219], v[152:155]
  s_add_u32 m0, s33, 65536
  v_mfma_f32_16x16x32_bf16 v[152:155], v[64:67], a[232:235], v[152:155]
  s_mov_b32 s34, 221312
  v_mfma_f32_16x16x32_bf16 v[156:159], v[56:59], a[204:207], v[156:159]
  buffer_load_dwordx4 v21, s[12:15], s34 offen lds
  v_mfma_f32_16x16x32_bf16 v[156:159], v[60:63], a[220:223], v[156:159]
  s_add_u32 m0, s33, 69632
  v_mfma_f32_16x16x32_bf16 v[156:159], v[64:67], a[236:239], v[156:159]
  s_mov_b32 s34, 258176
  buffer_load_dwordx4 v21, s[12:15], s34 offen lds
  s_waitcnt lgkmcnt(6)
  v_mfma_f32_16x16x32_bf16 v[128:131], v[68:71], a[240:243], v[128:131]
  ds_read_b64_tr_b16 v[56:57], v8 offset:4096
  v_mfma_f32_16x16x32_bf16 v[128:131], v[72:75], v[96:99], v[128:131]
  ds_read_b64_tr_b16 v[58:59], v8 offset:6144
  v_mfma_f32_16x16x32_bf16 v[128:131], v[76:79], v[112:115], v[128:131]
  ds_read_b64_tr_b16 v[60:61], v8 offset:8192
  v_mfma_f32_16x16x32_bf16 v[132:135], v[68:71], a[244:247], v[132:135]
  ds_read_b64_tr_b16 v[62:63], v8 offset:10240
  v_mfma_f32_16x16x32_bf16 v[132:135], v[72:75], v[100:103], v[132:135]
  ds_read_b64_tr_b16 v[64:65], v8 offset:12288
  v_mfma_f32_16x16x32_bf16 v[132:135], v[76:79], v[116:119], v[132:135]
  ds_read_b64_tr_b16 v[66:67], v8 offset:14336
  v_mfma_f32_16x16x32_bf16 v[136:139], v[68:71], a[248:251], v[136:139]
  s_add_u32 m0, s33, 73728
  v_mfma_f32_16x16x32_bf16 v[136:139], v[72:75], v[104:107], v[136:139]
  s_mov_b32 s34, 128
  v_mfma_f32_16x16x32_bf16 v[136:139], v[76:79], v[120:123], v[136:139]
  buffer_load_dwordx4 v22, s[12:15], s34 offen lds
  v_mfma_f32_16x16x32_bf16 v[140:143], v[68:71], a[252:255], v[140:143]
  s_add_u32 m0, s33, 77824
  v_mfma_f32_16x16x32_bf16 v[140:143], v[72:75], v[108:111], v[140:143]
  s_mov_b32 s34, 256
  v_mfma_f32_16x16x32_bf16 v[140:143], v[76:79], v[124:127], v[140:143]
  buffer_load_dwordx4 v21, s[12:15], s34 offen lds
  s_waitcnt lgkmcnt(6)
  v_mfma_f32_16x16x32_bf16 v[144:147], v[80:83], a[240:243], v[144:147]
  ds_read_b64_tr_b16 v[68:69], v11 offset:4096
  v_mfma_f32_16x16x32_bf16 v[144:147], v[84:87], v[96:99], v[144:147]
  ds_read_b64_tr_b16 v[70:71], v11 offset:6144
  v_mfma_f32_16x16x32_bf16 v[144:147], v[88:91], v[112:115], v[144:147]
  ds_read_b64_tr_b16 v[72:73], v11 offset:8192
  v_mfma_f32_16x16x32_bf16 v[148:151], v[80:83], a[244:247], v[148:151]
  ds_read_b64_tr_b16 v[74:75], v11 offset:10240
  v_mfma_f32_16x16x32_bf16 v[148:151], v[84:87], v[100:103], v[148:151]
  ds_read_b64_tr_b16 v[76:77], v11 offset:12288
  v_mfma_f32_16x16x32_bf16 v[148:151], v[88:91], v[116:119], v[148:151]
  ds_read_b64_tr_b16 v[78:79], v11 offset:14336
  v_mfma_f32_16x16x32_bf16 v[152:155], v[80:83], a[248:251], v[152:155]
  s_add_u32 m0, s33, 81920
  v_mfma_f32_16x16x32_bf16 v[152:155], v[84:87], v[104:107], v[152:155]
  s_mov_b32 s34, 37120
  v_mfma_f32_16x16x32_bf16 v[152:155], v[88:91], v[120:123], v[152:155]
  buffer_load_dwordx4 v21, s[12:15], s34 offen lds
  v_mfma_f32_16x16x32_bf16 v[156:159], v[80:83], a[252:255], v[156:159]
  s_add_u32 m0, s33, 86016
  v_mfma_f32_16x16x32_bf16 v[156:159], v[84:87], v[108:111], v[156:159]
  s_mov_b32 s34, 73984
  v_mfma_f32_16x16x32_bf16 v[156:159], v[88:91], v[124:127], v[156:159]
  buffer_load_dwordx4 v21, s[12:15], s34 offen lds
  s_waitcnt lgkmcnt(6)
  v_mfma_f32_16x16x32_bf16 v[192:195], v[56:59], a[0:3], 0
  s_waitcnt vmcnt(12)
  s_barrier
  v_mfma_f32_16x16x32_bf16 v[192:195], v[60:63], a[16:19], v[192:195]
  ds_read_b64_tr_b16 v[80:81], v8 offset:16384
  v_mul_f32 v128, v128, v144
  v_mfma_f32_16x16x32_bf16 v[192:195], v[64:67], a[32:35], v[192:195]
  ds_read_b64_tr_b16 v[82:83], v8 offset:18432
  v_mul_f32 v129, v129, v145
  v_mfma_f32_16x16x32_bf16 v[196:199], v[56:59], a[4:7], 0
  ds_read_b64_tr_b16 v[84:85], v8 offset:20480
  v_mul_f32 v130, v130, v146
  v_mfma_f32_16x16x32_bf16 v[196:199], v[60:63], a[20:23], v[196:199]
  ds_read_b64_tr_b16 v[86:87], v8 offset:22528
  v_mul_f32 v131, v131, v147
  v_mfma_f32_16x16x32_bf16 v[196:199], v[64:67], a[36:39], v[196:199]
  ds_read_b64_tr_b16 v[88:89], v8 offset:24576
  v_cvt_pk_bf16_f32 v32, v128, v129
  v_mfma_f32_16x16x32_bf16 v[200:203], v[56:59], a[8:11], 0
  ds_read_b64_tr_b16 v[90:91], v8 offset:26624
  v_cvt_pk_bf16_f32 v33, v130, v131
  v_mfma_f32_16x16x32_bf16 v[200:203], v[60:63], a[24:27], v[200:203]
  s_add_u32 m0, s33, 0
  ds_write_b64 v18, v[32:33] offset:32768
  v_mfma_f32_16x16x32_bf16 v[200:203], v[64:67], a[40:43], v[200:203]
  s_mov_b32 s34, 110848
  v_mul_f32 v132, v132, v148
  v_mfma_f32_16x16x32_bf16 v[204:207], v[56:59], a[12:15], 0
  buffer_load_dwordx4 v21, s[12:15], s34 offen lds
  v_mul_f32 v133, v133, v149
  v_mfma_f32_16x16x32_bf16 v[204:207], v[60:63], a[28:31], v[204:207]
  v_mul_f32 v134, v134, v150
  v_mul_f32 v135, v135, v151
  v_mfma_f32_16x16x32_bf16 v[204:207], v[64:67], a[44:47], v[204:207]
  v_cvt_pk_bf16_f32 v34, v132, v133
  s_waitcnt lgkmcnt(7)
  v_mfma_f32_16x16x32_bf16 v[208:211], v[68:71], a[0:3], 0
  ds_read_b64_tr_b16 v[56:57], v11 offset:16384
  v_cvt_pk_bf16_f32 v35, v134, v135
  v_mfma_f32_16x16x32_bf16 v[208:211], v[72:75], a[16:19], v[208:211]
  ds_read_b64_tr_b16 v[58:59], v11 offset:18432
  ds_write_b64 v18, v[34:35] offset:33792
  v_mfma_f32_16x16x32_bf16 v[208:211], v[76:79], a[32:35], v[208:211]
  ds_read_b64_tr_b16 v[60:61], v11 offset:20480
  v_mul_f32 v136, v136, v152
  v_mfma_f32_16x16x32_bf16 v[212:215], v[68:71], a[4:7], 0
  ds_read_b64_tr_b16 v[62:63], v11 offset:22528
  v_mul_f32 v137, v137, v153
  v_mfma_f32_16x16x32_bf16 v[212:215], v[72:75], a[20:23], v[212:215]
  ds_read_b64_tr_b16 v[64:65], v11 offset:24576
  v_mul_f32 v138, v138, v154
  v_mfma_f32_16x16x32_bf16 v[212:215], v[76:79], a[36:39], v[212:215]
  ds_read_b64_tr_b16 v[66:67], v11 offset:26624
  v_mul_f32 v139, v139, v155
  v_mfma_f32_16x16x32_bf16 v[216:219], v[68:71], a[8:11], 0
  v_cvt_pk_bf16_f32 v36, v136, v137
  v_cvt_pk_bf16_f32 v37, v138, v139
  v_mfma_f32_16x16x32_bf16 v[216:219], v[72:75], a[24:27], v[216:219]
  ds_write_b64 v18, v[36:37] offset:34816
  v_mul_f32 v140, v140, v156
  v_mfma_f32_16x16x32_bf16 v[216:219], v[76:79], a[40:43], v[216:219]
  v_mul_f32 v141, v141, v157
  v_mul_f32 v142, v142, v158
  v_mfma_f32_16x16x32_bf16 v[220:223], v[68:71], a[12:15], 0
  v_mul_f32 v143, v143, v159
  v_cvt_pk_bf16_f32 v38, v140, v141
  v_mfma_f32_16x16x32_bf16 v[220:223], v[72:75], a[28:31], v[220:223]
  v_cvt_pk_bf16_f32 v39, v142, v143
  ds_write_b64 v18, v[38:39] offset:35840
  v_mfma_f32_16x16x32_bf16 v[220:223], v[76:79], a[44:47], v[220:223]
  s_waitcnt lgkmcnt(10)
  v_mfma_f32_16x16x32_bf16 v[192:195], v[80:83], a[48:51], v[192:195]
  ds_read_b64_tr_b16 v[68:69], v8 offset:28672
  v_mfma_f32_16x16x32_bf16 v[192:195], v[84:87], a[64:67], v[192:195]
  ds_read_b64_tr_b16 v[70:71], v8 offset:30720
  v_mfma_f32_16x16x32_bf16 v[192:195], v[88:91], a[80:83], v[192:195]
  ds_read_b64_tr_b16 v[72:73], v8 offset:32768
  v_mfma_f32_16x16x32_bf16 v[196:199], v[80:83], a[52:55], v[196:199]
  ds_read_b64_tr_b16 v[74:75], v8 offset:34816
  v_mfma_f32_16x16x32_bf16 v[196:199], v[84:87], a[68:71], v[196:199]
  ds_read_b64_tr_b16 v[76:77], v8 offset:36864
  v_mfma_f32_16x16x32_bf16 v[196:199], v[88:91], a[84:87], v[196:199]
  ds_read_b64_tr_b16 v[78:79], v8 offset:38912
  v_mfma_f32_16x16x32_bf16 v[200:203], v[80:83], a[56:59], v[200:203]
  v_mfma_f32_16x16x32_bf16 v[200:203], v[84:87], a[72:75], v[200:203]
  v_mfma_f32_16x16x32_bf16 v[200:203], v[88:91], a[88:91], v[200:203]
  v_mfma_f32_16x16x32_bf16 v[204:207], v[80:83], a[60:63], v[204:207]
  v_mfma_f32_16x16x32_bf16 v[204:207], v[84:87], a[76:79], v[204:207]
  v_mfma_f32_16x16x32_bf16 v[204:207], v[88:91], a[92:95], v[204:207]
  s_waitcnt lgkmcnt(8)
  v_mfma_f32_16x16x32_bf16 v[208:211], v[56:59], a[48:51], v[208:211]
  s_waitcnt vmcnt(7) lgkmcnt(6)
  s_barrier
  v_mfma_f32_16x16x32_bf16 v[208:211], v[60:63], a[64:67], v[208:211]
  ds_read_b64_tr_b16 v[80:81], v11 offset:28672
  ds_read_b128 a[128:131], v16 offset:32768
  v_mfma_f32_16x16x32_bf16 v[208:211], v[64:67], a[80:83], v[208:211]
  ds_read_b64_tr_b16 v[82:83], v11 offset:30720
  ds_read_b128 a[132:135], v16 offset:33792
  v_mfma_f32_16x16x32_bf16 v[212:215], v[56:59], a[52:55], v[212:215]
  ds_read_b64_tr_b16 v[84:85], v11 offset:32768
  ds_read_b128 a[136:139], v16 offset:34816
  v_mfma_f32_16x16x32_bf16 v[212:215], v[60:63], a[68:71], v[212:215]
  ds_read_b64_tr_b16 v[86:87], v11 offset:34816
  ds_read_b128 a[140:143], v16 offset:35840
  v_mfma_f32_16x16x32_bf16 v[212:215], v[64:67], a[84:87], v[212:215]
  ds_read_b64_tr_b16 v[88:89], v11 offset:36864
  v_mfma_f32_16x16x32_bf16 v[216:219], v[56:59], a[56:59], v[216:219]
  ds_read_b64_tr_b16 v[90:91], v11 offset:38912
  v_mfma_f32_16x16x32_bf16 v[216:219], v[60:63], a[72:75], v[216:219]
  s_add_u32 m0, s33, 4096
  v_mfma_f32_16x16x32_bf16 v[216:219], v[64:67], a[88:91], v[216:219]
  s_mov_b32 s34, 147712
  v_mfma_f32_16x16x32_bf16 v[220:223], v[56:59], a[60:63], v[220:223]
  buffer_load_dwordx4 v21, s[12:15], s34 offen lds
  v_mfma_f32_16x16x32_bf16 v[220:223], v[60:63], a[76:79], v[220:223]
  s_add_u32 m0, s33, 8192
  v_mfma_f32_16x16x32_bf16 v[220:223], v[64:67], a[92:95], v[220:223]
  s_mov_b32 s34, 184576
  buffer_load_dwordx4 v21, s[12:15], s34 offen lds
  s_waitcnt lgkmcnt(10)
  v_mfma_f32_16x16x32_bf16 v[192:195], v[68:71], a[96:99], v[192:195]
  ds_read_b64_tr_b16 v[56:57], v8 offset:40960
  v_mfma_f32_16x16x32_bf16 v[192:195], v[72:75], a[112:115], v[192:195]
  ds_read_b64_tr_b16 v[58:59], v8 offset:43008
  s_waitcnt lgkmcnt(10)
  v_mfma_f32_16x16x32_bf16 v[192:195], v[76:79], a[128:131], v[192:195]
  ds_read_b64_tr_b16 v[60:61], v8 offset:45056
  v_mfma_f32_16x16x32_bf16 v[196:199], v[68:71], a[100:103], v[196:199]
  ds_read_b64_tr_b16 v[62:63], v8 offset:47104
  v_mfma_f32_16x16x32_bf16 v[196:199], v[72:75], a[116:119], v[196:199]
  ds_read_b64_tr_b16 v[64:65], v8 offset:49152
  s_waitcnt lgkmcnt(11)
  v_mfma_f32_16x16x32_bf16 v[196:199], v[76:79], a[132:135], v[196:199]
  ds_read_b64_tr_b16 v[66:67], v8 offset:51200
  v_mfma_f32_16x16x32_bf16 v[200:203], v[68:71], a[104:107], v[200:203]
  s_add_u32 m0, s33, 12288
  v_mfma_f32_16x16x32_bf16 v[200:203], v[72:75], a[120:123], v[200:203]
  s_mov_b32 s34, 221440
  s_waitcnt lgkmcnt(10)
  v_mfma_f32_16x16x32_bf16 v[200:203], v[76:79], a[136:139], v[200:203]
  buffer_load_dwordx4 v21, s[12:15], s34 offen lds
  v_mfma_f32_16x16x32_bf16 v[204:207], v[68:71], a[108:111], v[204:207]
  s_add_u32 m0, s33, 16384
  v_mfma_f32_16x16x32_bf16 v[204:207], v[72:75], a[124:127], v[204:207]
  s_mov_b32 s34, 258304
  s_waitcnt lgkmcnt(8)
  v_mfma_f32_16x16x32_bf16 v[204:207], v[76:79], a[140:143], v[204:207]
  buffer_load_dwordx4 v21, s[12:15], s34 offen lds
  s_waitcnt lgkmcnt(6)
  v_mfma_f32_16x16x32_bf16 v[208:211], v[80:83], a[96:99], v[208:211]
  ds_read_b64_tr_b16 v[68:69], v11 offset:40960
  v_mfma_f32_16x16x32_bf16 v[208:211], v[84:87], a[112:115], v[208:211]
  ds_read_b64_tr_b16 v[70:71], v11 offset:43008
  v_mfma_f32_16x16x32_bf16 v[208:211], v[88:91], a[128:131], v[208:211]
  ds_read_b64_tr_b16 v[72:73], v11 offset:45056
  v_mfma_f32_16x16x32_bf16 v[212:215], v[80:83], a[100:103], v[212:215]
  ds_read_b64_tr_b16 v[74:75], v11 offset:47104
  v_mfma_f32_16x16x32_bf16 v[212:215], v[84:87], a[116:119], v[212:215]
  ds_read_b64_tr_b16 v[76:77], v11 offset:49152
  v_mfma_f32_16x16x32_bf16 v[212:215], v[88:91], a[132:135], v[212:215]
  ds_read_b64_tr_b16 v[78:79], v11 offset:51200
  v_mfma_f32_16x16x32_bf16 v[216:219], v[80:83], a[104:107], v[216:219]
  s_add_u32 m0, s33, 20480
  v_mfma_f32_16x16x32_bf16 v[216:219], v[84:87], a[120:123], v[216:219]
  s_mov_b32 s34, 256
  v_mfma_f32_16x16x32_bf16 v[216:219], v[88:91], a[136:139], v[216:219]
  buffer_load_dwordx4 v22, s[12:15], s34 offen lds
  v_mfma_f32_16x16x32_bf16 v[220:223], v[80:83], a[108:111], v[220:223]
  s_add_u32 m0, s33, 24576
  v_mfma_f32_16x16x32_bf16 v[220:223], v[84:87], a[124:127], v[220:223]
  s_mov_b32 s34, 384
  v_mfma_f32_16x16x32_bf16 v[220:223], v[88:91], a[140:143], v[220:223]
  buffer_load_dwordx4 v21, s[12:15], s34 offen lds
  s_waitcnt lgkmcnt(6)
  v_mfma_f32_16x16x32_bf16 v[224:227], v[56:59], a[0:3], 0
  ds_read_b64_tr_b16 v[80:81], v8 offset:53248
  v_mfma_f32_16x16x32_bf16 v[224:227], v[60:63], a[16:19], v[224:227]
  ds_read_b64_tr_b16 v[82:83], v8 offset:55296
  v_cvt_pk_bf16_f32 v40, v192, v193
  v_mfma_f32_16x16x32_bf16 v[224:227], v[64:67], a[32:35], v[224:227]
  ds_read_b64_tr_b16 v[84:85], v8 offset:57344
  v_cvt_pk_bf16_f32 v41, v194, v195
  v_mfma_f32_16x16x32_bf16 v[228:231], v[56:59], a[4:7], 0
  ds_read_b64_tr_b16 v[86:87], v8 offset:59392
  v_cvt_pk_bf16_f32 v42, v208, v209
  v_mfma_f32_16x16x32_bf16 v[228:231], v[60:63], a[20:23], v[228:231]
  ds_read_b64_tr_b16 v[88:89], v8 offset:61440
  v_cvt_pk_bf16_f32 v43, v210, v211
  v_mfma_f32_16x16x32_bf16 v[228:231], v[64:67], a[36:39], v[228:231]
  ds_read_b64_tr_b16 v[90:91], v8 offset:63488
  s_mov_b32 s35, 0
  v_mfma_f32_16x16x32_bf16 v[232:235], v[56:59], a[8:11], 0
  buffer_store_dwordx4 v[40:43], v24, s[20:23], s35 offen
  v_mfma_f32_16x16x32_bf16 v[232:235], v[60:63], a[24:27], v[232:235]
  v_cvt_pk_bf16_f32 v44, v196, v197
  v_mfma_f32_16x16x32_bf16 v[232:235], v[64:67], a[40:43], v[232:235]
  v_cvt_pk_bf16_f32 v45, v198, v199
  v_mfma_f32_16x16x32_bf16 v[236:239], v[56:59], a[12:15], 0
  v_cvt_pk_bf16_f32 v46, v212, v213
  v_mfma_f32_16x16x32_bf16 v[236:239], v[60:63], a[28:31], v[236:239]
  v_cvt_pk_bf16_f32 v47, v214, v215
  v_mfma_f32_16x16x32_bf16 v[236:239], v[64:67], a[44:47], v[236:239]
  s_mov_b32 s35, 18432
  s_waitcnt lgkmcnt(6)
  v_mfma_f32_16x16x32_bf16 v[240:243], v[68:71], a[0:3], 0
  s_waitcnt vmcnt(8)
  s_barrier
  v_mfma_f32_16x16x32_bf16 v[240:243], v[72:75], a[16:19], v[240:243]
  ds_read_b64_tr_b16 v[56:57], v11 offset:53248
  buffer_store_dwordx4 v[44:47], v24, s[20:23], s35 offen
  v_mfma_f32_16x16x32_bf16 v[240:243], v[76:79], a[32:35], v[240:243]
  ds_read_b64_tr_b16 v[58:59], v11 offset:55296
  v_cvt_pk_bf16_f32 v48, v200, v201
  v_mfma_f32_16x16x32_bf16 v[244:247], v[68:71], a[4:7], 0
  ds_read_b64_tr_b16 v[60:61], v11 offset:57344
  v_cvt_pk_bf16_f32 v49, v202, v203
  v_mfma_f32_16x16x32_bf16 v[244:247], v[72:75], a[20:23], v[244:247]
  ds_read_b64_tr_b16 v[62:63], v11 offset:59392
  v_cvt_pk_bf16_f32 v50, v216, v217
  v_mfma_f32_16x16x32_bf16 v[244:247], v[76:79], a[36:39], v[244:247]
  ds_read_b64_tr_b16 v[64:65], v11 offset:61440
  v_cvt_pk_bf16_f32 v51, v218, v219
  v_mfma_f32_16x16x32_bf16 v[248:251], v[68:71], a[8:11], 0
  ds_read_b64_tr_b16 v[66:67], v11 offset:63488
  s_mov_b32 s35, 36864
  v_mfma_f32_16x16x32_bf16 v[248:251], v[72:75], a[24:27], v[248:251]
  s_add_u32 m0, s33, 131072
  buffer_store_dwordx4 v[48:51], v24, s[20:23], s35 offen
  v_mfma_f32_16x16x32_bf16 v[248:251], v[76:79], a[40:43], v[248:251]
  s_mov_b32 s34, 37248
  v_cvt_pk_bf16_f32 v52, v204, v205
  v_mfma_f32_16x16x32_bf16 v[252:255], v[68:71], a[12:15], 0
  buffer_load_dwordx4 v21, s[12:15], s34 offen lds
  v_cvt_pk_bf16_f32 v53, v206, v207
  v_mfma_f32_16x16x32_bf16 v[252:255], v[72:75], a[28:31], v[252:255]
  s_add_u32 m0, s33, 90112
  v_cvt_pk_bf16_f32 v54, v220, v221
  v_mfma_f32_16x16x32_bf16 v[252:255], v[76:79], a[44:47], v[252:255]
  s_mov_b32 s34, 74112
  buffer_load_dwordx4 v21, s[12:15], s34 offen lds
  s_waitcnt lgkmcnt(6)
  v_mfma_f32_16x16x32_bf16 v[224:227], v[80:83], a[48:51], v[224:227]
  ds_read_b64_tr_b16 v[68:69], v9
  v_cvt_pk_bf16_f32 v55, v222, v223
  v_mfma_f32_16x16x32_bf16 v[224:227], v[84:87], a[64:67], v[224:227]
  ds_read_b64_tr_b16 v[70:71], v9 offset:2048
  s_mov_b32 s35, 55296
  v_mfma_f32_16x16x32_bf16 v[224:227], v[88:91], a[80:83], v[224:227]
  ds_read_b64_tr_b16 v[72:73], v9 offset:4096
  buffer_store_dwordx4 v[52:55], v24, s[20:23], s35 offen
  v_mfma_f32_16x16x32_bf16 v[228:231], v[80:83], a[52:55], v[228:231]
  ds_read_b64_tr_b16 v[74:75], v9 offset:6144
  v_mfma_f32_16x16x32_bf16 v[228:231], v[84:87], a[68:71], v[228:231]
  ds_read_b64_tr_b16 v[76:77], v9 offset:8192
  v_mfma_f32_16x16x32_bf16 v[228:231], v[88:91], a[84:87], v[228:231]
  ds_read_b64_tr_b16 v[78:79], v9 offset:10240
  v_mfma_f32_16x16x32_bf16 v[232:235], v[80:83], a[56:59], v[232:235]
  s_add_u32 m0, s33, 94208
  v_mfma_f32_16x16x32_bf16 v[232:235], v[84:87], a[72:75], v[232:235]
  s_mov_b32 s34, 110976
  v_mfma_f32_16x16x32_bf16 v[232:235], v[88:91], a[88:91], v[232:235]
  buffer_load_dwordx4 v21, s[12:15], s34 offen lds
  v_mfma_f32_16x16x32_bf16 v[236:239], v[80:83], a[60:63], v[236:239]
  s_add_u32 m0, s33, 126976
  v_mfma_f32_16x16x32_bf16 v[236:239], v[84:87], a[76:79], v[236:239]
  s_mov_b32 s34, 147840
  v_mfma_f32_16x16x32_bf16 v[236:239], v[88:91], a[92:95], v[236:239]
  buffer_load_dwordx4 v21, s[12:15], s34 offen lds
  s_waitcnt lgkmcnt(6)
  v_mfma_f32_16x16x32_bf16 v[240:243], v[56:59], a[48:51], v[240:243]
  ds_read_b64_tr_b16 v[80:81], v12
  v_mfma_f32_16x16x32_bf16 v[240:243], v[60:63], a[64:67], v[240:243]
  ds_read_b64_tr_b16 v[82:83], v12 offset:2048
  v_mfma_f32_16x16x32_bf16 v[240:243], v[64:67], a[80:83], v[240:243]
  ds_read_b64_tr_b16 v[84:85], v12 offset:4096
  v_mfma_f32_16x16x32_bf16 v[244:247], v[56:59], a[52:55], v[244:247]
  ds_read_b64_tr_b16 v[86:87], v12 offset:6144
  v_mfma_f32_16x16x32_bf16 v[244:247], v[60:63], a[68:71], v[244:247]
  ds_read_b64_tr_b16 v[88:89], v12 offset:8192
  v_mfma_f32_16x16x32_bf16 v[244:247], v[64:67], a[84:87], v[244:247]
  ds_read_b64_tr_b16 v[90:91], v12 offset:10240
  v_mfma_f32_16x16x32_bf16 v[248:251], v[56:59], a[56:59], v[248:251]
  s_add_u32 m0, s33, 135168
  v_mfma_f32_16x16x32_bf16 v[248:251], v[60:63], a[72:75], v[248:251]
  s_mov_b32 s34, 184704
  v_mfma_f32_16x16x32_bf16 v[248:251], v[64:67], a[88:91], v[248:251]
  buffer_load_dwordx4 v21, s[12:15], s34 offen lds
  v_mfma_f32_16x16x32_bf16 v[252:255], v[56:59], a[60:63], v[252:255]
  s_add_u32 m0, s33, 139264
  v_mfma_f32_16x16x32_bf16 v[252:255], v[60:63], a[76:79], v[252:255]
  s_mov_b32 s34, 221568
  v_mfma_f32_16x16x32_bf16 v[252:255], v[64:67], a[92:95], v[252:255]
  buffer_load_dwordx4 v21, s[12:15], s34 offen lds
  s_waitcnt lgkmcnt(6)
  v_mfma_f32_16x16x32_bf16 v[224:227], v[68:71], a[96:99], v[224:227]
  ds_read_b64_tr_b16 v[56:57], v9 offset:12288
  v_mfma_f32_16x16x32_bf16 v[224:227], v[72:75], a[112:115], v[224:227]
  ds_read_b64_tr_b16 v[58:59], v9 offset:14336
  v_mfma_f32_16x16x32_bf16 v[224:227], v[76:79], a[128:131], v[224:227]
  ds_read_b64_tr_b16 v[60:61], v9 offset:16384
  v_mfma_f32_16x16x32_bf16 v[228:231], v[68:71], a[100:103], v[228:231]
  ds_read_b64_tr_b16 v[62:63], v9 offset:18432
  v_mfma_f32_16x16x32_bf16 v[228:231], v[72:75], a[116:119], v[228:231]
  ds_read_b64_tr_b16 v[64:65], v9 offset:20480
  v_mfma_f32_16x16x32_bf16 v[228:231], v[76:79], a[132:135], v[228:231]
  ds_read_b64_tr_b16 v[66:67], v9 offset:22528
  v_mfma_f32_16x16x32_bf16 v[232:235], v[68:71], a[104:107], v[232:235]
  s_add_u32 m0, s33, 98304
  v_mfma_f32_16x16x32_bf16 v[232:235], v[72:75], a[120:123], v[232:235]
  s_mov_b32 s34, 258432
  v_mfma_f32_16x16x32_bf16 v[232:235], v[76:79], a[136:139], v[232:235]
  buffer_load_dwordx4 v21, s[12:15], s34 offen lds
  v_mfma_f32_16x16x32_bf16 v[236:239], v[68:71], a[108:111], v[236:239]
  s_add_u32 m0, s33, 102400
  v_mfma_f32_16x16x32_bf16 v[236:239], v[72:75], a[124:127], v[236:239]
  s_mov_b32 s34, 384
  v_mfma_f32_16x16x32_bf16 v[236:239], v[76:79], a[140:143], v[236:239]
  buffer_load_dwordx4 v22, s[12:15], s34 offen lds
  s_waitcnt lgkmcnt(6)
  v_mfma_f32_16x16x32_bf16 v[240:243], v[80:83], a[96:99], v[240:243]
  s_waitcnt vmcnt(13)
  s_barrier
  v_mfma_f32_16x16x32_bf16 v[240:243], v[84:87], a[112:115], v[240:243]
  ds_read_b64_tr_b16 v[68:69], v12 offset:12288
  v_mfma_f32_16x16x32_bf16 v[240:243], v[88:91], a[128:131], v[240:243]
  ds_read_b64_tr_b16 v[70:71], v12 offset:14336
  v_mfma_f32_16x16x32_bf16 v[244:247], v[80:83], a[100:103], v[244:247]
  ds_read_b64_tr_b16 v[72:73], v12 offset:16384
  v_mfma_f32_16x16x32_bf16 v[244:247], v[84:87], a[116:119], v[244:247]
  ds_read_b64_tr_b16 v[74:75], v12 offset:18432
  v_mfma_f32_16x16x32_bf16 v[244:247], v[88:91], a[132:135], v[244:247]
  ds_read_b64_tr_b16 v[76:77], v12 offset:20480
  v_mfma_f32_16x16x32_bf16 v[248:251], v[80:83], a[104:107], v[248:251]
  ds_read_b64_tr_b16 v[78:79], v12 offset:22528
  v_mfma_f32_16x16x32_bf16 v[248:251], v[84:87], a[120:123], v[248:251]
  s_add_u32 m0, s33, 106496
  v_mfma_f32_16x16x32_bf16 v[248:251], v[88:91], a[136:139], v[248:251]
  s_mov_b32 s34, 512
  v_mfma_f32_16x16x32_bf16 v[252:255], v[80:83], a[108:111], v[252:255]
  buffer_load_dwordx4 v21, s[12:15], s34 offen lds
  v_mfma_f32_16x16x32_bf16 v[252:255], v[84:87], a[124:127], v[252:255]
  s_add_u32 m0, s33, 110592
  v_mfma_f32_16x16x32_bf16 v[252:255], v[88:91], a[140:143], v[252:255]
  s_mov_b32 s34, 37376
  buffer_load_dwordx4 v21, s[12:15], s34 offen lds
  s_waitcnt lgkmcnt(6)
  v_mfma_f32_16x16x32_bf16 v[160:163], v[56:59], a[0:3], 0
  ds_read_b64_tr_b16 v[80:81], v8
  v_mfma_f32_16x16x32_bf16 v[160:163], v[60:63], a[16:19], v[160:163]
  ds_read_b64_tr_b16 v[82:83], v8 offset:2048
  v_cvt_pk_bf16_f32 v40, v224, v225
  v_mfma_f32_16x16x32_bf16 v[160:163], v[64:67], a[32:35], v[160:163]
  ds_read_b64_tr_b16 v[84:85], v8 offset:4096
  v_cvt_pk_bf16_f32 v41, v226, v227
  v_mfma_f32_16x16x32_bf16 v[164:167], v[56:59], a[4:7], 0
  ds_read_b64_tr_b16 v[86:87], v8 offset:6144
  v_cvt_pk_bf16_f32 v42, v240, v241
  v_mfma_f32_16x16x32_bf16 v[164:167], v[60:63], a[20:23], v[164:167]
  ds_read_b64_tr_b16 v[88:89], v8 offset:8192
  v_cvt_pk_bf16_f32 v43, v242, v243
  v_mfma_f32_16x16x32_bf16 v[164:167], v[64:67], a[36:39], v[164:167]
  ds_read_b64_tr_b16 v[90:91], v8 offset:10240
  s_mov_b32 s35, 2048
  v_mfma_f32_16x16x32_bf16 v[168:171], v[56:59], a[8:11], 0
  s_add_u32 m0, s33, 143360
  buffer_store_dwordx4 v[40:43], v24, s[20:23], s35 offen
  v_mfma_f32_16x16x32_bf16 v[168:171], v[60:63], a[24:27], v[168:171]
  s_mov_b32 s34, 74240
  v_cvt_pk_bf16_f32 v44, v228, v229
  v_mfma_f32_16x16x32_bf16 v[168:171], v[64:67], a[40:43], v[168:171]
  buffer_load_dwordx4 v21, s[12:15], s34 offen lds
  v_cvt_pk_bf16_f32 v45, v230, v231
  v_mfma_f32_16x16x32_bf16 v[172:175], v[56:59], a[12:15], 0
  s_add_u32 m0, s33, 147456
  v_cvt_pk_bf16_f32 v46, v244, v245
  v_mfma_f32_16x16x32_bf16 v[172:175], v[60:63], a[28:31], v[172:175]
  s_mov_b32 s34, 111104
  v_cvt_pk_bf16_f32 v47, v246, v247
  v_mfma_f32_16x16x32_bf16 v[172:175], v[64:67], a[44:47], v[172:175]
  buffer_load_dwordx4 v21, s[12:15], s34 offen lds
  s_waitcnt lgkmcnt(6)
  v_mfma_f32_16x16x32_bf16 v[176:179], v[68:71], a[0:3], 0
  ds_read_b64_tr_b16 v[56:57], v11
  s_mov_b32 s35, 20480
  v_mfma_f32_16x16x32_bf16 v[176:179], v[72:75], a[16:19], v[176:179]
  ds_read_b64_tr_b16 v[58:59], v11 offset:2048
  buffer_store_dwordx4 v[44:47], v24, s[20:23], s35 offen
  v_mfma_f32_16x16x32_bf16 v[176:179], v[76:79], a[32:35], v[176:179]
  ds_read_b64_tr_b16 v[60:61], v11 offset:4096
  v_cvt_pk_bf16_f32 v48, v232, v233
  v_mfma_f32_16x16x32_bf16 v[180:183], v[68:71], a[4:7], 0
  ds_read_b64_tr_b16 v[62:63], v11 offset:6144
  v_cvt_pk_bf16_f32 v49, v234, v235
  v_mfma_f32_16x16x32_bf16 v[180:183], v[72:75], a[20:23], v[180:183]
  ds_read_b64_tr_b16 v[64:65], v11 offset:8192
  v_cvt_pk_bf16_f32 v50, v248, v249
  v_mfma_f32_16x16x32_bf16 v[180:183], v[76:79], a[36:39], v[180:183]
  ds_read_b64_tr_b16 v[66:67], v11 offset:10240
  v_cvt_pk_bf16_f32 v51, v250, v251
  v_mfma_f32_16x16x32_bf16 v[184:187], v[68:71], a[8:11], 0
  s_add_u32 m0, s33, 114688
  s_mov_b32 s35, 38912
  v_mfma_f32_16x16x32_bf16 v[184:187], v[72:75], a[24:27], v[184:187]
  s_mov_b32 s34, 147968
  buffer_store_dwordx4 v[48:51], v24, s[20:23], s35 offen
  v_mfma_f32_16x16x32_bf16 v[184:187], v[76:79], a[40:43], v[184:187]
  buffer_load_dwordx4 v21, s[12:15], s34 offen lds
  v_cvt_pk_bf16_f32 v52, v236, v237
  v_mfma_f32_16x16x32_bf16 v[188:191], v[68:71], a[12:15], 0
  s_add_u32 m0, s33, 118784
  v_cvt_pk_bf16_f32 v53, v238, v239
  v_mfma_f32_16x16x32_bf16 v[188:191], v[72:75], a[28:31], v[188:191]
  s_mov_b32 s34, 184832
  v_cvt_pk_bf16_f32 v54, v252, v253
  v_mfma_f32_16x16x32_bf16 v[188:191], v[76:79], a[44:47], v[188:191]
  buffer_load_dwordx4 v21, s[12:15], s34 offen lds
  s_waitcnt lgkmcnt(6)
  v_mfma_f32_16x16x32_bf16 v[160:163], v[80:83], a[48:51], v[160:163]
  ds_read_b64_tr_b16 v[68:69], v8 offset:12288
  v_cvt_pk_bf16_f32 v55, v254, v255
  v_mfma_f32_16x16x32_bf16 v[160:163], v[84:87], a[64:67], v[160:163]
  ds_read_b64_tr_b16 v[70:71], v8 offset:14336
  s_mov_b32 s35, 57344
  v_mfma_f32_16x16x32_bf16 v[160:163], v[88:91], a[80:83], v[160:163]
  ds_read_b64_tr_b16 v[72:73], v8 offset:16384
  buffer_store_dwordx4 v[52:55], v24, s[20:23], s35 offen
  v_mfma_f32_16x16x32_bf16 v[164:167], v[80:83], a[52:55], v[164:167]
  ds_read_b64_tr_b16 v[74:75], v8 offset:18432
  v_mfma_f32_16x16x32_bf16 v[164:167], v[84:87], a[68:71], v[164:167]
  ds_read_b64_tr_b16 v[76:77], v8 offset:20480
  v_mfma_f32_16x16x32_bf16 v[164:167], v[88:91], a[84:87], v[164:167]
  ds_read_b64_tr_b16 v[78:79], v8 offset:22528
  v_mfma_f32_16x16x32_bf16 v[168:171], v[80:83], a[56:59], v[168:171]
  s_add_u32 m0, s33, 151552
  v_mfma_f32_16x16x32_bf16 v[168:171], v[84:87], a[72:75], v[168:171]
  s_mov_b32 s34, 221696
  v_mfma_f32_16x16x32_bf16 v[168:171], v[88:91], a[88:91], v[168:171]
  buffer_load_dwordx4 v21, s[12:15], s34 offen lds
  v_mfma_f32_16x16x32_bf16 v[172:175], v[80:83], a[60:63], v[172:175]
  s_add_u32 m0, s33, 155648
  v_mfma_f32_16x16x32_bf16 v[172:175], v[84:87], a[76:79], v[172:175]
  s_mov_b32 s34, 258560
  v_mfma_f32_16x16x32_bf16 v[172:175], v[88:91], a[92:95], v[172:175]
  buffer_load_dwordx4 v21, s[12:15], s34 offen lds
  s_waitcnt lgkmcnt(6)
  v_mfma_f32_16x16x32_bf16 v[176:179], v[56:59], a[48:51], v[176:179]
  s_waitcnt vmcnt(15)
  s_barrier
  v_mfma_f32_16x16x32_bf16 v[176:179], v[60:63], a[64:67], v[176:179]
  ds_read_b64_tr_b16 v[80:81], v11 offset:12288
  v_mfma_f32_16x16x32_bf16 v[176:179], v[64:67], a[80:83], v[176:179]
  ds_read_b64_tr_b16 v[82:83], v11 offset:14336
  v_mfma_f32_16x16x32_bf16 v[180:183], v[56:59], a[52:55], v[180:183]
  ds_read_b64_tr_b16 v[84:85], v11 offset:16384
  v_mfma_f32_16x16x32_bf16 v[180:183], v[60:63], a[68:71], v[180:183]
  ds_read_b64_tr_b16 v[86:87], v11 offset:18432
  v_mfma_f32_16x16x32_bf16 v[180:183], v[64:67], a[84:87], v[180:183]
  ds_read_b64_tr_b16 v[88:89], v11 offset:20480
  v_mfma_f32_16x16x32_bf16 v[184:187], v[56:59], a[56:59], v[184:187]
  ds_read_b64_tr_b16 v[90:91], v11 offset:22528
  v_mfma_f32_16x16x32_bf16 v[184:187], v[60:63], a[72:75], v[184:187]
  s_add_u32 m0, s33, 122880
  v_mfma_f32_16x16x32_bf16 v[184:187], v[64:67], a[88:91], v[184:187]
  s_mov_b32 s34, 512
  v_mfma_f32_16x16x32_bf16 v[188:191], v[56:59], a[60:63], v[188:191]
  buffer_load_dwordx4 v22, s[12:15], s34 offen lds
  v_mfma_f32_16x16x32_bf16 v[188:191], v[60:63], a[76:79], v[188:191]
  s_add_u32 m0, s33, 159744
  v_mfma_f32_16x16x32_bf16 v[188:191], v[64:67], a[92:95], v[188:191]
  s_mov_b32 s34, 640
  buffer_load_dwordx4 v21, s[12:15], s34 offen lds
  s_waitcnt lgkmcnt(6)
  v_mfma_f32_16x16x32_bf16 v[160:163], v[68:71], a[96:99], v[160:163]
  ds_read_b64_tr_b16 v[56:57], v8 offset:24576
  v_mfma_f32_16x16x32_bf16 v[160:163], v[72:75], a[112:115], v[160:163]
  ds_read_b64_tr_b16 v[58:59], v8 offset:26624
  v_mfma_f32_16x16x32_bf16 v[160:163], v[76:79], a[128:131], v[160:163]
  ds_read_b64_tr_b16 v[60:61], v10
  v_mfma_f32_16x16x32_bf16 v[164:167], v[68:71], a[100:103], v[164:167]
  ds_read_b64_tr_b16 v[62:63], v10 offset:2048
  v_mfma_f32_16x16x32_bf16 v[164:167], v[72:75], a[116:119], v[164:167]
  ds_read_b64_tr_b16 v[64:65], v9 offset:24576
  v_mfma_f32_16x16x32_bf16 v[164:167], v[76:79], a[132:135], v[164:167]
  ds_read_b64_tr_b16 v[66:67], v9 offset:26624
  v_mfma_f32_16x16x32_bf16 v[168:171], v[68:71], a[104:107], v[168:171]
  s_add_u32 m0, s33, 28672
  v_mfma_f32_16x16x32_bf16 v[168:171], v[72:75], a[120:123], v[168:171]
  s_mov_b32 s34, 37504
  v_mfma_f32_16x16x32_bf16 v[168:171], v[76:79], a[136:139], v[168:171]
  buffer_load_dwordx4 v21, s[12:15], s34 offen lds
  v_mfma_f32_16x16x32_bf16 v[172:175], v[68:71], a[108:111], v[172:175]
  s_add_u32 m0, s33, 32768
  v_mfma_f32_16x16x32_bf16 v[172:175], v[72:75], a[124:127], v[172:175]
  s_mov_b32 s34, 74368
  v_mfma_f32_16x16x32_bf16 v[172:175], v[76:79], a[140:143], v[172:175]
  buffer_load_dwordx4 v21, s[12:15], s34 offen lds
  s_waitcnt lgkmcnt(6)
  v_mfma_f32_16x16x32_bf16 v[176:179], v[80:83], a[96:99], v[176:179]
  ds_read_b64_tr_b16 v[68:69], v11 offset:24576
  v_mfma_f32_16x16x32_bf16 v[176:179], v[84:87], a[112:115], v[176:179]
  ds_read_b64_tr_b16 v[70:71], v11 offset:26624
  v_mfma_f32_16x16x32_bf16 v[176:179], v[88:91], a[128:131], v[176:179]
  ds_read_b64_tr_b16 v[72:73], v13
  v_mfma_f32_16x16x32_bf16 v[180:183], v[80:83], a[100:103], v[180:183]
  ds_read_b64_tr_b16 v[74:75], v13 offset:2048
  v_mfma_f32_16x16x32_bf16 v[180:183], v[84:87], a[116:119], v[180:183]
  ds_read_b64_tr_b16 v[76:77], v12 offset:24576
  v_mfma_f32_16x16x32_bf16 v[180:183], v[88:91], a[132:135], v[180:183]
  ds_read_b64_tr_b16 v[78:79], v12 offset:26624
  v_mfma_f32_16x16x32_bf16 v[184:187], v[80:83], a[104:107], v[184:187]
  s_add_u32 m0, s33, 36864
  v_mfma_f32_16x16x32_bf16 v[184:187], v[84:87], a[120:123], v[184:187]
  s_mov_b32 s34, 111232
  v_mfma_f32_16x16x32_bf16 v[184:187], v[88:91], a[136:139], v[184:187]
  buffer_load_dwordx4 v21, s[12:15], s34 offen lds
  v_mfma_f32_16x16x32_bf16 v[188:191], v[80:83], a[108:111], v[188:191]
  s_add_u32 m0, s33, 40960
  v_mfma_f32_16x16x32_bf16 v[188:191], v[84:87], a[124:127], v[188:191]
  s_mov_b32 s34, 148096
  v_mfma_f32_16x16x32_bf16 v[188:191], v[88:91], a[140:143], v[188:191]
  buffer_load_dwordx4 v21, s[12:15], s34 offen lds
  s_waitcnt lgkmcnt(6)
  v_mfma_f32_16x16x32_bf16 v[128:131], v[56:59], a[0:3], 0
  ds_read_b64_tr_b16 v[80:81], v9 offset:28672
  v_mfma_f32_16x16x32_bf16 v[128:131], v[60:63], a[16:19], v[128:131]
  ds_read_b64_tr_b16 v[82:83], v9 offset:30720
  v_cvt_pk_bf16_f32 v40, v160, v161
  v_mfma_f32_16x16x32_bf16 v[128:131], v[64:67], a[32:35], v[128:131]
  ds_read_b64_tr_b16 v[84:85], v9 offset:61440
  v_cvt_pk_bf16_f32 v41, v162, v163
  v_mfma_f32_16x16x32_bf16 v[132:135], v[56:59], a[4:7], 0
  ds_read_b64_tr_b16 v[86:87], v9 offset:63488
  v_cvt_pk_bf16_f32 v42, v176, v177
  v_mfma_f32_16x16x32_bf16 v[132:135], v[60:63], a[20:23], v[132:135]
  ds_read_b64_tr_b16 v[88:89], v10 offset:4096
  v_cvt_pk_bf16_f32 v43, v178, v179
  v_mfma_f32_16x16x32_bf16 v[132:135], v[64:67], a[36:39], v[132:135]
  ds_read_b64_tr_b16 v[90:91], v10 offset:6144
  s_mov_b32 s35, 4096
  v_mfma_f32_16x16x32_bf16 v[136:139], v[56:59], a[8:11], 0
  s_add_u32 m0, s33, 45056
  buffer_store_dwordx4 v[40:43], v24, s[20:23], s35 offen
  v_mfma_f32_16x16x32_bf16 v[136:139], v[60:63], a[24:27], v[136:139]
  s_mov_b32 s34, 184960
  v_cvt_pk_bf16_f32 v44, v164, v165
  v_mfma_f32_16x16x32_bf16 v[136:139], v[64:67], a[40:43], v[136:139]
  buffer_load_dwordx4 v21, s[12:15], s34 offen lds
  v_cvt_pk_bf16_f32 v45, v166, v167
  v_mfma_f32_16x16x32_bf16 v[140:143], v[56:59], a[12:15], 0
  s_add_u32 m0, s33, 49152
  v_cvt_pk_bf16_f32 v46, v180, v181
  v_mfma_f32_16x16x32_bf16 v[140:143], v[60:63], a[28:31], v[140:143]
  s_mov_b32 s34, 221824
  v_cvt_pk_bf16_f32 v47, v182, v183
  v_mfma_f32_16x16x32_bf16 v[140:143], v[64:67], a[44:47], v[140:143]
  buffer_load_dwordx4 v21, s[12:15], s34 offen lds
  s_waitcnt lgkmcnt(6)
  v_mfma_f32_16x16x32_bf16 v[144:147], v[68:71], a[0:3], 0
  s_waitcnt vmcnt(17)
  s_barrier
  v_mfma_f32_16x16x32_bf16 v[144:147], v[72:75], a[16:19], v[144:147]
  ds_read_b64_tr_b16 v[56:57], v12 offset:28672
  s_mov_b32 s35, 22528
  v_mfma_f32_16x16x32_bf16 v[144:147], v[76:79], a[32:35], v[144:147]
  ds_read_b64_tr_b16 v[58:59], v12 offset:30720
  buffer_store_dwordx4 v[44:47], v24, s[20:23], s35 offen
  v_mfma_f32_16x16x32_bf16 v[148:151], v[68:71], a[4:7], 0
  ds_read_b64_tr_b16 v[60:61], v12 offset:61440
  v_cvt_pk_bf16_f32 v48, v168, v169
  v_mfma_f32_16x16x32_bf16 v[148:151], v[72:75], a[20:23], v[148:151]
  ds_read_b64_tr_b16 v[62:63], v12 offset:63488
  v_cvt_pk_bf16_f32 v49, v170, v171
  v_mfma_f32_16x16x32_bf16 v[148:151], v[76:79], a[36:39], v[148:151]
  ds_read_b64_tr_b16 v[64:65], v13 offset:4096
  v_cvt_pk_bf16_f32 v50, v184, v185
  v_mfma_f32_16x16x32_bf16 v[152:155], v[68:71], a[8:11], 0
  ds_read_b64_tr_b16 v[66:67], v13 offset:6144
  v_cvt_pk_bf16_f32 v51, v186, v187
  v_mfma_f32_16x16x32_bf16 v[152:155], v[72:75], a[24:27], v[152:155]
  s_add_u32 m0, s33, 53248
  s_mov_b32 s35, 40960
  v_mfma_f32_16x16x32_bf16 v[152:155], v[76:79], a[40:43], v[152:155]
  s_mov_b32 s34, 258688
  buffer_store_dwordx4 v[48:51], v24, s[20:23], s35 offen
  v_mfma_f32_16x16x32_bf16 v[156:159], v[68:71], a[12:15], 0
  buffer_load_dwordx4 v21, s[12:15], s34 offen lds
  v_cvt_pk_bf16_f32 v52, v172, v173
  v_mfma_f32_16x16x32_bf16 v[156:159], v[72:75], a[28:31], v[156:159]
  s_add_u32 m0, s33, 57344
  v_cvt_pk_bf16_f32 v53, v174, v175
  v_mfma_f32_16x16x32_bf16 v[156:159], v[76:79], a[44:47], v[156:159]
  s_mov_b32 s34, 640
  buffer_load_dwordx4 v22, s[12:15], s34 offen lds
  s_waitcnt lgkmcnt(6)
  v_mfma_f32_16x16x32_bf16 v[128:131], v[80:83], a[48:51], v[128:131]
  ds_read_b64_tr_b16 v[68:69], v10 offset:8192
  v_cvt_pk_bf16_f32 v54, v188, v189
  v_mfma_f32_16x16x32_bf16 v[128:131], v[84:87], a[64:67], v[128:131]
  ds_read_b64_tr_b16 v[70:71], v10 offset:10240
  v_cvt_pk_bf16_f32 v55, v190, v191
  v_mfma_f32_16x16x32_bf16 v[128:131], v[88:91], a[80:83], v[128:131]
  ds_read_b64_tr_b16 v[72:73], v9 offset:32768
  s_mov_b32 s35, 59392
  v_mfma_f32_16x16x32_bf16 v[132:135], v[80:83], a[52:55], v[132:135]
  ds_read_b64_tr_b16 v[74:75], v9 offset:34816
  buffer_store_dwordx4 v[52:55], v24, s[20:23], s35 offen
  v_mfma_f32_16x16x32_bf16 v[132:135], v[84:87], a[68:71], v[132:135]
  ds_read_b64_tr_b16 v[76:77], v9 offset:36864
  v_mfma_f32_16x16x32_bf16 v[132:135], v[88:91], a[84:87], v[132:135]
  ds_read_b64_tr_b16 v[78:79], v9 offset:38912
  v_mfma_f32_16x16x32_bf16 v[136:139], v[80:83], a[56:59], v[136:139]
  s_add_u32 m0, s33, 61440
  v_mfma_f32_16x16x32_bf16 v[136:139], v[84:87], a[72:75], v[136:139]
  s_mov_b32 s34, 768
  v_mfma_f32_16x16x32_bf16 v[136:139], v[88:91], a[88:91], v[136:139]
  buffer_load_dwordx4 v21, s[12:15], s34 offen lds
  v_mfma_f32_16x16x32_bf16 v[140:143], v[80:83], a[60:63], v[140:143]
  s_add_u32 m0, s33, 65536
  v_mfma_f32_16x16x32_bf16 v[140:143], v[84:87], a[76:79], v[140:143]
  s_mov_b32 s34, 37632
  v_mfma_f32_16x16x32_bf16 v[140:143], v[88:91], a[92:95], v[140:143]
  buffer_load_dwordx4 v21, s[12:15], s34 offen lds
  s_waitcnt lgkmcnt(6)
  v_mfma_f32_16x16x32_bf16 v[144:147], v[56:59], a[48:51], v[144:147]
  ds_read_b64_tr_b16 v[80:81], v13 offset:8192
  v_mfma_f32_16x16x32_bf16 v[144:147], v[60:63], a[64:67], v[144:147]
  ds_read_b64_tr_b16 v[82:83], v13 offset:10240
  v_mfma_f32_16x16x32_bf16 v[144:147], v[64:67], a[80:83], v[144:147]
  ds_read_b64_tr_b16 v[84:85], v12 offset:32768
  v_mfma_f32_16x16x32_bf16 v[148:151], v[56:59], a[52:55], v[148:151]
  ds_read_b64_tr_b16 v[86:87], v12 offset:34816
  v_mfma_f32_16x16x32_bf16 v[148:151], v[60:63], a[68:71], v[148:151]
  ds_read_b64_tr_b16 v[88:89], v12 offset:36864
  v_mfma_f32_16x16x32_bf16 v[148:151], v[64:67], a[84:87], v[148:151]
  ds_read_b64_tr_b16 v[90:91], v12 offset:38912
  v_mfma_f32_16x16x32_bf16 v[152:155], v[56:59], a[56:59], v[152:155]
  s_add_u32 m0, s33, 69632
  v_mfma_f32_16x16x32_bf16 v[152:155], v[60:63], a[72:75], v[152:155]
  s_mov_b32 s34, 74496
  v_mfma_f32_16x16x32_bf16 v[152:155], v[64:67], a[88:91], v[152:155]
  buffer_load_dwordx4 v21, s[12:15], s34 offen lds
  v_mfma_f32_16x16x32_bf16 v[156:159], v[56:59], a[60:63], v[156:159]
  s_add_u32 m0, s33, 73728
  v_mfma_f32_16x16x32_bf16 v[156:159], v[60:63], a[76:79], v[156:159]
  s_mov_b32 s34, 111360
  v_mfma_f32_16x16x32_bf16 v[156:159], v[64:67], a[92:95], v[156:159]
  buffer_load_dwordx4 v21, s[12:15], s34 offen lds
  s_waitcnt lgkmcnt(6)
  v_mfma_f32_16x16x32_bf16 v[128:131], v[68:71], a[96:99], v[128:131]
  ds_read_b64_tr_b16 v[56:57], v9 offset:40960
  v_mfma_f32_16x16x32_bf16 v[128:131], v[72:75], a[112:115], v[128:131]
  ds_read_b64_tr_b16 v[58:59], v9 offset:43008
  v_mfma_f32_16x16x32_bf16 v[128:131], v[76:79], a[128:131], v[128:131]
  ds_read_b64_tr_b16 v[60:61], v9 offset:45056
  v_mfma_f32_16x16x32_bf16 v[132:135], v[68:71], a[100:103], v[132:135]
  ds_read_b64_tr_b16 v[62:63], v9 offset:47104
  v_mfma_f32_16x16x32_bf16 v[132:135], v[72:75], a[116:119], v[132:135]
  ds_read_b64_tr_b16 v[64:65], v10 offset:12288
  v_mfma_f32_16x16x32_bf16 v[132:135], v[76:79], a[132:135], v[132:135]
  ds_read_b64_tr_b16 v[66:67], v10 offset:14336
  v_mfma_f32_16x16x32_bf16 v[136:139], v[68:71], a[104:107], v[136:139]
  s_add_u32 m0, s33, 77824
  v_mfma_f32_16x16x32_bf16 v[136:139], v[72:75], a[120:123], v[136:139]
  s_mov_b32 s34, 148224
  v_mfma_f32_16x16x32_bf16 v[136:139], v[76:79], a[136:139], v[136:139]
  buffer_load_dwordx4 v21, s[12:15], s34 offen lds
  v_mfma_f32_16x16x32_bf16 v[140:143], v[68:71], a[108:111], v[140:143]
  s_add_u32 m0, s33, 81920
  v_mfma_f32_16x16x32_bf16 v[140:143], v[72:75], a[124:127], v[140:143]
  s_mov_b32 s34, 185088
  v_mfma_f32_16x16x32_bf16 v[140:143], v[76:79], a[140:143], v[140:143]
  buffer_load_dwordx4 v21, s[12:15], s34 offen lds
  s_waitcnt lgkmcnt(6)
  v_mfma_f32_16x16x32_bf16 v[144:147], v[80:83], a[96:99], v[144:147]
  s_waitcnt vmcnt(19)
  s_barrier
  v_mfma_f32_16x16x32_bf16 v[144:147], v[84:87], a[112:115], v[144:147]
  ds_read_b64_tr_b16 v[68:69], v12 offset:40960
  v_mfma_f32_16x16x32_bf16 v[144:147], v[88:91], a[128:131], v[144:147]
  ds_read_b64_tr_b16 v[70:71], v12 offset:43008
  v_mfma_f32_16x16x32_bf16 v[148:151], v[80:83], a[100:103], v[148:151]
  ds_read_b64_tr_b16 v[72:73], v12 offset:45056
  v_mfma_f32_16x16x32_bf16 v[148:151], v[84:87], a[116:119], v[148:151]
  ds_read_b64_tr_b16 v[74:75], v12 offset:47104
  v_mfma_f32_16x16x32_bf16 v[148:151], v[88:91], a[132:135], v[148:151]
  ds_read_b64_tr_b16 v[76:77], v13 offset:12288
  v_mfma_f32_16x16x32_bf16 v[152:155], v[80:83], a[104:107], v[152:155]
  ds_read_b64_tr_b16 v[78:79], v13 offset:14336
  v_mfma_f32_16x16x32_bf16 v[152:155], v[84:87], a[120:123], v[152:155]
  s_add_u32 m0, s33, 86016
  v_mfma_f32_16x16x32_bf16 v[152:155], v[88:91], a[136:139], v[152:155]
  s_mov_b32 s34, 221952
  v_mfma_f32_16x16x32_bf16 v[156:159], v[80:83], a[108:111], v[156:159]
  buffer_load_dwordx4 v21, s[12:15], s34 offen lds
  v_mfma_f32_16x16x32_bf16 v[156:159], v[84:87], a[124:127], v[156:159]
  s_add_u32 m0, s33, 0
  v_mfma_f32_16x16x32_bf16 v[156:159], v[88:91], a[140:143], v[156:159]
  s_mov_b32 s34, 258816
  buffer_load_dwordx4 v21, s[12:15], s34 offen lds
  s_waitcnt lgkmcnt(6)
  v_mfma_f32_16x16x32_bf16 v[192:195], v[56:59], a[0:3], 0
  ds_read_b64_tr_b16 v[80:81], v10 offset:16384
  v_mfma_f32_16x16x32_bf16 v[192:195], v[60:63], a[16:19], v[192:195]
  ds_read_b64_tr_b16 v[82:83], v10 offset:18432
  v_cvt_pk_bf16_f32 v40, v128, v129
  v_mfma_f32_16x16x32_bf16 v[192:195], v[64:67], a[32:35], v[192:195]
  ds_read_b64_tr_b16 v[84:85], v9 offset:49152
  v_cvt_pk_bf16_f32 v41, v130, v131
  v_mfma_f32_16x16x32_bf16 v[196:199], v[56:59], a[4:7], 0
  ds_read_b64_tr_b16 v[86:87], v9 offset:51200
  v_cvt_pk_bf16_f32 v42, v144, v145
  v_mfma_f32_16x16x32_bf16 v[196:199], v[60:63], a[20:23], v[196:199]
  ds_read_b64_tr_b16 v[88:89], v9 offset:53248
  v_cvt_pk_bf16_f32 v43, v146, v147
  v_mfma_f32_16x16x32_bf16 v[196:199], v[64:67], a[36:39], v[196:199]
  ds_read_b64_tr_b16 v[90:91], v9 offset:55296
  s_mov_b32 s35, 6144
  v_mfma_f32_16x16x32_bf16 v[200:203], v[56:59], a[8:11], 0
  s_add_u32 m0, s33, 4096
  buffer_store_dwordx4 v[40:43], v24, s[20:23], s35 offen
  v_mfma_f32_16x16x32_bf16 v[200:203], v[60:63], a[24:27], v[200:203]
  s_mov_b32 s34, 768
  v_cvt_pk_bf16_f32 v44, v132, v133
  v_mfma_f32_16x16x32_bf16 v[200:203], v[64:67], a[40:43], v[200:203]
  buffer_load_dwordx4 v22, s[12:15], s34 offen lds
  v_cvt_pk_bf16_f32 v45, v134, v135
  v_mfma_f32_16x16x32_bf16 v[204:207], v[56:59], a[12:15], 0
  s_add_u32 m0, s33, 8192
  v_cvt_pk_bf16_f32 v46, v148, v149
  v_mfma_f32_16x16x32_bf16 v[204:207], v[60:63], a[28:31], v[204:207]
  s_mov_b32 s34, 896
  v_cvt_pk_bf16_f32 v47, v150, v151
  v_mfma_f32_16x16x32_bf16 v[204:207], v[64:67], a[44:47], v[204:207]
  buffer_load_dwordx4 v21, s[12:15], s34 offen lds
  s_waitcnt lgkmcnt(6)
  v_mfma_f32_16x16x32_bf16 v[208:211], v[68:71], a[0:3], 0
  ds_read_b64_tr_b16 v[56:57], v13 offset:16384
  s_mov_b32 s35, 24576
  v_mfma_f32_16x16x32_bf16 v[208:211], v[72:75], a[16:19], v[208:211]
  ds_read_b64_tr_b16 v[58:59], v13 offset:18432
  buffer_store_dwordx4 v[44:47], v24, s[20:23], s35 offen
  v_mfma_f32_16x16x32_bf16 v[208:211], v[76:79], a[32:35], v[208:211]
  ds_read_b64_tr_b16 v[60:61], v12 offset:49152
  v_cvt_pk_bf16_f32 v48, v136, v137
  v_mfma_f32_16x16x32_bf16 v[212:215], v[68:71], a[4:7], 0
  ds_read_b64_tr_b16 v[62:63], v12 offset:51200
  v_cvt_pk_bf16_f32 v49, v138, v139
  v_mfma_f32_16x16x32_bf16 v[212:215], v[72:75], a[20:23], v[212:215]
  ds_read_b64_tr_b16 v[64:65], v12 offset:53248
  v_cvt_pk_bf16_f32 v50, v152, v153
  v_mfma_f32_16x16x32_bf16 v[212:215], v[76:79], a[36:39], v[212:215]
  ds_read_b64_tr_b16 v[66:67], v12 offset:55296
  v_cvt_pk_bf16_f32 v51, v154, v155
  v_mfma_f32_16x16x32_bf16 v[216:219], v[68:71], a[8:11], 0
  s_add_u32 m0, s33, 12288
  s_mov_b32 s35, 43008
  v_mfma_f32_16x16x32_bf16 v[216:219], v[72:75], a[24:27], v[216:219]
  s_mov_b32 s34, 37760
  buffer_store_dwordx4 v[48:51], v24, s[20:23], s35 offen
  v_mfma_f32_16x16x32_bf16 v[216:219], v[76:79], a[40:43], v[216:219]
  buffer_load_dwordx4 v21, s[12:15], s34 offen lds
  v_cvt_pk_bf16_f32 v52, v140, v141
  v_mfma_f32_16x16x32_bf16 v[220:223], v[68:71], a[12:15], 0
  s_add_u32 m0, s33, 16384
  v_cvt_pk_bf16_f32 v53, v142, v143
  v_mfma_f32_16x16x32_bf16 v[220:223], v[72:75], a[28:31], v[220:223]
  s_mov_b32 s34, 74624
  v_cvt_pk_bf16_f32 v54, v156, v157
  v_mfma_f32_16x16x32_bf16 v[220:223], v[76:79], a[44:47], v[220:223]
  buffer_load_dwordx4 v21, s[12:15], s34 offen lds
  s_waitcnt lgkmcnt(6)
  v_mfma_f32_16x16x32_bf16 v[192:195], v[80:83], a[48:51], v[192:195]
  ds_read_b64_tr_b16 v[68:69], v10 offset:20480
  v_cvt_pk_bf16_f32 v55, v158, v159
  v_mfma_f32_16x16x32_bf16 v[192:195], v[84:87], a[64:67], v[192:195]
  ds_read_b64_tr_b16 v[70:71], v10 offset:22528
  s_mov_b32 s35, 61440
  v_mfma_f32_16x16x32_bf16 v[192:195], v[88:91], a[80:83], v[192:195]
  ds_read_b64_tr_b16 v[72:73], v10 offset:24576
  buffer_store_dwordx4 v[52:55], v24, s[20:23], s35 offen
  v_mfma_f32_16x16x32_bf16 v[196:199], v[80:83], a[52:55], v[196:199]
  ds_read_b64_tr_b16 v[74:75], v10 offset:26624
  v_mfma_f32_16x16x32_bf16 v[196:199], v[84:87], a[68:71], v[196:199]
  ds_read_b64_tr_b16 v[76:77], v9 offset:57344
  v_mfma_f32_16x16x32_bf16 v[196:199], v[88:91], a[84:87], v[196:199]
  ds_read_b64_tr_b16 v[78:79], v9 offset:59392
  v_mfma_f32_16x16x32_bf16 v[200:203], v[80:83], a[56:59], v[200:203]
  s_add_u32 m0, s33, 20480
  v_mfma_f32_16x16x32_bf16 v[200:203], v[84:87], a[72:75], v[200:203]
  s_mov_b32 s34, 111488
  v_mfma_f32_16x16x32_bf16 v[200:203], v[88:91], a[88:91], v[200:203]
  buffer_load_dwordx4 v21, s[12:15], s34 offen lds
  v_mfma_f32_16x16x32_bf16 v[204:207], v[80:83], a[60:63], v[204:207]
  s_add_u32 m0, s33, 24576
  v_mfma_f32_16x16x32_bf16 v[204:207], v[84:87], a[76:79], v[204:207]
  s_mov_b32 s34, 148352
  v_mfma_f32_16x16x32_bf16 v[204:207], v[88:91], a[92:95], v[204:207]
  buffer_load_dwordx4 v21, s[12:15], s34 offen lds
  s_waitcnt lgkmcnt(6)
  v_mfma_f32_16x16x32_bf16 v[208:211], v[56:59], a[48:51], v[208:211]
  s_waitcnt vmcnt(24)
  s_barrier
  v_mfma_f32_16x16x32_bf16 v[208:211], v[60:63], a[64:67], v[208:211]
  ds_read_b64_tr_b16 v[80:81], v13 offset:20480
  v_mfma_f32_16x16x32_bf16 v[208:211], v[64:67], a[80:83], v[208:211]
  ds_read_b64_tr_b16 v[82:83], v13 offset:22528
  v_mfma_f32_16x16x32_bf16 v[212:215], v[56:59], a[52:55], v[212:215]
  ds_read_b64_tr_b16 v[84:85], v13 offset:24576
  v_mfma_f32_16x16x32_bf16 v[212:215], v[60:63], a[68:71], v[212:215]
  ds_read_b64_tr_b16 v[86:87], v13 offset:26624
  v_mfma_f32_16x16x32_bf16 v[212:215], v[64:67], a[84:87], v[212:215]
  ds_read_b64_tr_b16 v[88:89], v12 offset:57344
  v_mfma_f32_16x16x32_bf16 v[216:219], v[56:59], a[56:59], v[216:219]
  ds_read_b64_tr_b16 v[90:91], v12 offset:59392
  v_mfma_f32_16x16x32_bf16 v[216:219], v[60:63], a[72:75], v[216:219]
  s_add_u32 m0, s33, 131072
  v_mfma_f32_16x16x32_bf16 v[216:219], v[64:67], a[88:91], v[216:219]
  s_mov_b32 s34, 185216
  v_mfma_f32_16x16x32_bf16 v[220:223], v[56:59], a[60:63], v[220:223]
  buffer_load_dwordx4 v21, s[12:15], s34 offen lds
  v_mfma_f32_16x16x32_bf16 v[220:223], v[60:63], a[76:79], v[220:223]
  v_mfma_f32_16x16x32_bf16 v[220:223], v[64:67], a[92:95], v[220:223]
  s_waitcnt lgkmcnt(6)
  v_mfma_f32_16x16x32_bf16 v[192:195], v[68:71], a[96:99], v[192:195]
  ds_read_b64_tr_b16 v[56:57], v10 offset:28672
  v_mfma_f32_16x16x32_bf16 v[192:195], v[72:75], a[112:115], v[192:195]
  ds_read_b64_tr_b16 v[58:59], v10 offset:30720
  v_mfma_f32_16x16x32_bf16 v[192:195], v[76:79], a[128:131], v[192:195]
  ds_read_b64_tr_b16 v[60:61], v8 offset:28672
  v_mfma_f32_16x16x32_bf16 v[196:199], v[68:71], a[100:103], v[196:199]
  ds_read_b64_tr_b16 v[62:63], v8 offset:30720
  v_mfma_f32_16x16x32_bf16 v[196:199], v[72:75], a[116:119], v[196:199]
  ds_read_b64_tr_b16 v[64:65], v8 offset:32768
  v_mfma_f32_16x16x32_bf16 v[196:199], v[76:79], a[132:135], v[196:199]
  ds_read_b64_tr_b16 v[66:67], v8 offset:34816
  v_mfma_f32_16x16x32_bf16 v[200:203], v[68:71], a[104:107], v[200:203]
  s_add_u32 m0, s33, 90112
  v_mfma_f32_16x16x32_bf16 v[200:203], v[72:75], a[120:123], v[200:203]
  s_mov_b32 s34, 222080
  v_mfma_f32_16x16x32_bf16 v[200:203], v[76:79], a[136:139], v[200:203]
  buffer_load_dwordx4 v21, s[12:15], s34 offen lds
  v_mfma_f32_16x16x32_bf16 v[204:207], v[68:71], a[108:111], v[204:207]
  s_add_u32 m0, s33, 94208
  v_mfma_f32_16x16x32_bf16 v[204:207], v[72:75], a[124:127], v[204:207]
  s_mov_b32 s34, 258944
  v_mfma_f32_16x16x32_bf16 v[204:207], v[76:79], a[140:143], v[204:207]
  buffer_load_dwordx4 v21, s[12:15], s34 offen lds
  s_waitcnt lgkmcnt(6)
  v_mfma_f32_16x16x32_bf16 v[208:211], v[80:83], a[96:99], v[208:211]
  ds_read_b64_tr_b16 v[68:69], v13 offset:28672
  v_mfma_f32_16x16x32_bf16 v[208:211], v[84:87], a[112:115], v[208:211]
  ds_read_b64_tr_b16 v[70:71], v13 offset:30720
  v_mfma_f32_16x16x32_bf16 v[208:211], v[88:91], a[128:131], v[208:211]
  ds_read_b64_tr_b16 v[72:73], v11 offset:28672
  v_mfma_f32_16x16x32_bf16 v[212:215], v[80:83], a[100:103], v[212:215]
  ds_read_b64_tr_b16 v[74:75], v11 offset:30720
  v_mfma_f32_16x16x32_bf16 v[212:215], v[84:87], a[116:119], v[212:215]
  ds_read_b64_tr_b16 v[76:77], v11 offset:32768
  v_mfma_f32_16x16x32_bf16 v[212:215], v[88:91], a[132:135], v[212:215]
  ds_read_b64_tr_b16 v[78:79], v11 offset:34816
  v_mfma_f32_16x16x32_bf16 v[216:219], v[80:83], a[104:107], v[216:219]
  s_add_u32 m0, s33, 126976
  v_mfma_f32_16x16x32_bf16 v[216:219], v[84:87], a[120:123], v[216:219]
  s_mov_b32 s34, 896
  v_mfma_f32_16x16x32_bf16 v[216:219], v[88:91], a[136:139], v[216:219]
  buffer_load_dwordx4 v22, s[12:15], s34 offen lds
  v_mfma_f32_16x16x32_bf16 v[220:223], v[80:83], a[108:111], v[220:223]
  v_mfma_f32_16x16x32_bf16 v[220:223], v[84:87], a[124:127], v[220:223]
  v_mfma_f32_16x16x32_bf16 v[220:223], v[88:91], a[140:143], v[220:223]
  s_waitcnt lgkmcnt(6)
  v_mfma_f32_16x16x32_bf16 v[224:227], v[56:59], a[0:3], 0
  ds_read_b64_tr_b16 v[80:81], v8 offset:36864
  v_mfma_f32_16x16x32_bf16 v[224:227], v[60:63], a[16:19], v[224:227]
  ds_read_b64_tr_b16 v[82:83], v8 offset:38912
  v_cvt_pk_bf16_f32 v40, v192, v193
  v_mfma_f32_16x16x32_bf16 v[224:227], v[64:67], a[32:35], v[224:227]
  ds_read_b64_tr_b16 v[84:85], v8 offset:40960
  v_cvt_pk_bf16_f32 v41, v194, v195
  v_mfma_f32_16x16x32_bf16 v[228:231], v[56:59], a[4:7], 0
  ds_read_b64_tr_b16 v[86:87], v8 offset:43008
  v_cvt_pk_bf16_f32 v42, v208, v209
  v_mfma_f32_16x16x32_bf16 v[228:231], v[60:63], a[20:23], v[228:231]
  ds_read_b64_tr_b16 v[88:89], v8 offset:45056
  v_cvt_pk_bf16_f32 v43, v210, v211
  v_mfma_f32_16x16x32_bf16 v[228:231], v[64:67], a[36:39], v[228:231]
  ds_read_b64_tr_b16 v[90:91], v8 offset:47104
  s_mov_b32 s35, 8192
  v_mfma_f32_16x16x32_bf16 v[232:235], v[56:59], a[8:11], 0
  s_add_u32 m0, s33, 135168
  buffer_store_dwordx4 v[40:43], v24, s[20:23], s35 offen
  v_mfma_f32_16x16x32_bf16 v[232:235], v[60:63], a[24:27], v[232:235]
  s_mov_b32 s34, 1024
  v_cvt_pk_bf16_f32 v44, v196, v197
  v_mfma_f32_16x16x32_bf16 v[232:235], v[64:67], a[40:43], v[232:235]
  buffer_load_dwordx4 v21, s[12:15], s34 offen lds
  v_cvt_pk_bf16_f32 v45, v198, v199
  v_mfma_f32_16x16x32_bf16 v[236:239], v[56:59], a[12:15], 0
  s_add_u32 m0, s33, 139264
  v_cvt_pk_bf16_f32 v46, v212, v213
  v_mfma_f32_16x16x32_bf16 v[236:239], v[60:63], a[28:31], v[236:239]
  s_mov_b32 s34, 37888
  v_cvt_pk_bf16_f32 v47, v214, v215
  v_mfma_f32_16x16x32_bf16 v[236:239], v[64:67], a[44:47], v[236:239]
  buffer_load_dwordx4 v21, s[12:15], s34 offen lds
  s_waitcnt lgkmcnt(6)
  v_mfma_f32_16x16x32_bf16 v[240:243], v[68:71], a[0:3], 0
  s_waitcnt vmcnt(22)
  s_barrier
  v_mfma_f32_16x16x32_bf16 v[240:243], v[72:75], a[16:19], v[240:243]
  ds_read_b64_tr_b16 v[56:57], v11 offset:36864
  s_mov_b32 s35, 26624
  v_mfma_f32_16x16x32_bf16 v[240:243], v[76:79], a[32:35], v[240:243]
  ds_read_b64_tr_b16 v[58:59], v11 offset:38912
  buffer_store_dwordx4 v[44:47], v24, s[20:23], s35 offen
  v_mfma_f32_16x16x32_bf16 v[244:247], v[68:71], a[4:7], 0
  ds_read_b64_tr_b16 v[60:61], v11 offset:40960
  v_cvt_pk_bf16_f32 v48, v200, v201
  v_mfma_f32_16x16x32_bf16 v[244:247], v[72:75], a[20:23], v[244:247]
  ds_read_b64_tr_b16 v[62:63], v11 offset:43008
  v_cvt_pk_bf16_f32 v49, v202, v203
  v_mfma_f32_16x16x32_bf16 v[244:247], v[76:79], a[36:39], v[244:247]
  ds_read_b64_tr_b16 v[64:65], v11 offset:45056
  v_cvt_pk_bf16_f32 v50, v216, v217
  v_mfma_f32_16x16x32_bf16 v[248:251], v[68:71], a[8:11], 0
  ds_read_b64_tr_b16 v[66:67], v11 offset:47104
  v_cvt_pk_bf16_f32 v51, v218, v219
  v_mfma_f32_16x16x32_bf16 v[248:251], v[72:75], a[24:27], v[248:251]
  s_add_u32 m0, s33, 98304
  s_mov_b32 s35, 45056
  v_mfma_f32_16x16x32_bf16 v[248:251], v[76:79], a[40:43], v[248:251]
  s_mov_b32 s34, 74752
  buffer_store_dwordx4 v[48:51], v24, s[20:23], s35 offen
  v_mfma_f32_16x16x32_bf16 v[252:255], v[68:71], a[12:15], 0
  buffer_load_dwordx4 v21, s[12:15], s34 offen lds
  v_cvt_pk_bf16_f32 v52, v204, v205
  v_mfma_f32_16x16x32_bf16 v[252:255], v[72:75], a[28:31], v[252:255]
  v_cvt_pk_bf16_f32 v53, v206, v207
  v_mfma_f32_16x16x32_bf16 v[252:255], v[76:79], a[44:47], v[252:255]
  v_cvt_pk_bf16_f32 v54, v220, v221
  s_waitcnt lgkmcnt(6)
  v_mfma_f32_16x16x32_bf16 v[224:227], v[80:83], a[48:51], v[224:227]
  ds_read_b64_tr_b16 v[68:69], v8 offset:49152
  v_cvt_pk_bf16_f32 v55, v222, v223
  v_mfma_f32_16x16x32_bf16 v[224:227], v[84:87], a[64:67], v[224:227]
  ds_read_b64_tr_b16 v[70:71], v8 offset:51200
  s_mov_b32 s35, 63488
  v_mfma_f32_16x16x32_bf16 v[224:227], v[88:91], a[80:83], v[224:227]
  ds_read_b64_tr_b16 v[72:73], v8 offset:53248
  buffer_store_dwordx4 v[52:55], v24, s[20:23], s35 offen
  v_mfma_f32_16x16x32_bf16 v[228:231], v[80:83], a[52:55], v[228:231]
  ds_read_b64_tr_b16 v[74:75], v8 offset:55296
  v_mfma_f32_16x16x32_bf16 v[228:231], v[84:87], a[68:71], v[228:231]
  ds_read_b64_tr_b16 v[76:77], v8 offset:57344
  v_mfma_f32_16x16x32_bf16 v[228:231], v[88:91], a[84:87], v[228:231]
  ds_read_b64_tr_b16 v[78:79], v8 offset:59392
  v_mfma_f32_16x16x32_bf16 v[232:235], v[80:83], a[56:59], v[232:235]
  s_add_u32 m0, s33, 102400
  v_mfma_f32_16x16x32_bf16 v[232:235], v[84:87], a[72:75], v[232:235]
  s_mov_b32 s34, 111616
  v_mfma_f32_16x16x32_bf16 v[232:235], v[88:91], a[88:91], v[232:235]
  buffer_load_dwordx4 v21, s[12:15], s34 offen lds
  v_mfma_f32_16x16x32_bf16 v[236:239], v[80:83], a[60:63], v[236:239]
  s_add_u32 m0, s33, 106496
  v_mfma_f32_16x16x32_bf16 v[236:239], v[84:87], a[76:79], v[236:239]
  s_mov_b32 s34, 148480
  v_mfma_f32_16x16x32_bf16 v[236:239], v[88:91], a[92:95], v[236:239]
  buffer_load_dwordx4 v21, s[12:15], s34 offen lds
  s_waitcnt lgkmcnt(6)
  v_mfma_f32_16x16x32_bf16 v[240:243], v[56:59], a[48:51], v[240:243]
  ds_read_b64_tr_b16 v[80:81], v11 offset:49152
  v_mfma_f32_16x16x32_bf16 v[240:243], v[60:63], a[64:67], v[240:243]
  ds_read_b64_tr_b16 v[82:83], v11 offset:51200
  v_mfma_f32_16x16x32_bf16 v[240:243], v[64:67], a[80:83], v[240:243]
  ds_read_b64_tr_b16 v[84:85], v11 offset:53248
  v_mfma_f32_16x16x32_bf16 v[244:247], v[56:59], a[52:55], v[244:247]
  ds_read_b64_tr_b16 v[86:87], v11 offset:55296
  v_mfma_f32_16x16x32_bf16 v[244:247], v[60:63], a[68:71], v[244:247]
  ds_read_b64_tr_b16 v[88:89], v11 offset:57344
  v_mfma_f32_16x16x32_bf16 v[244:247], v[64:67], a[84:87], v[244:247]
  ds_read_b64_tr_b16 v[90:91], v11 offset:59392
  v_mfma_f32_16x16x32_bf16 v[248:251], v[56:59], a[56:59], v[248:251]
  s_add_u32 m0, s33, 110592
  v_mfma_f32_16x16x32_bf16 v[248:251], v[60:63], a[72:75], v[248:251]
  s_mov_b32 s34, 185344
  v_mfma_f32_16x16x32_bf16 v[248:251], v[64:67], a[88:91], v[248:251]
  buffer_load_dwordx4 v21, s[12:15], s34 offen lds
  v_mfma_f32_16x16x32_bf16 v[252:255], v[56:59], a[60:63], v[252:255]
  v_mfma_f32_16x16x32_bf16 v[252:255], v[60:63], a[76:79], v[252:255]
  v_mfma_f32_16x16x32_bf16 v[252:255], v[64:67], a[92:95], v[252:255]
  s_waitcnt lgkmcnt(6)
  v_mfma_f32_16x16x32_bf16 v[224:227], v[68:71], a[96:99], v[224:227]
  ds_read_b64_tr_b16 v[56:57], v8 offset:61440
  v_mfma_f32_16x16x32_bf16 v[224:227], v[72:75], a[112:115], v[224:227]
  ds_read_b64_tr_b16 v[58:59], v8 offset:63488
  v_mfma_f32_16x16x32_bf16 v[224:227], v[76:79], a[128:131], v[224:227]
  ds_read_b64_tr_b16 v[60:61], v9
  v_mfma_f32_16x16x32_bf16 v[228:231], v[68:71], a[100:103], v[228:231]
  ds_read_b64_tr_b16 v[62:63], v9 offset:2048
  v_mfma_f32_16x16x32_bf16 v[228:231], v[72:75], a[116:119], v[228:231]
  ds_read_b64_tr_b16 v[64:65], v9 offset:4096
  v_mfma_f32_16x16x32_bf16 v[228:231], v[76:79], a[132:135], v[228:231]
  ds_read_b64_tr_b16 v[66:67], v9 offset:6144
  v_mfma_f32_16x16x32_bf16 v[232:235], v[68:71], a[104:107], v[232:235]
  s_add_u32 m0, s33, 143360
  v_mfma_f32_16x16x32_bf16 v[232:235], v[72:75], a[120:123], v[232:235]
  s_mov_b32 s34, 222208
  v_mfma_f32_16x16x32_bf16 v[232:235], v[76:79], a[136:139], v[232:235]
  buffer_load_dwordx4 v21, s[12:15], s34 offen lds
  v_mfma_f32_16x16x32_bf16 v[236:239], v[68:71], a[108:111], v[236:239]
  s_add_u32 m0, s33, 147456
  v_mfma_f32_16x16x32_bf16 v[236:239], v[72:75], a[124:127], v[236:239]
  s_mov_b32 s34, 259072
  v_mfma_f32_16x16x32_bf16 v[236:239], v[76:79], a[140:143], v[236:239]
  buffer_load_dwordx4 v21, s[12:15], s34 offen lds
  s_waitcnt lgkmcnt(6)
  v_mfma_f32_16x16x32_bf16 v[240:243], v[80:83], a[96:99], v[240:243]
  s_waitcnt vmcnt(24)
  s_barrier
  v_mfma_f32_16x16x32_bf16 v[240:243], v[84:87], a[112:115], v[240:243]
  ds_read_b64_tr_b16 v[68:69], v11 offset:61440
  v_mfma_f32_16x16x32_bf16 v[240:243], v[88:91], a[128:131], v[240:243]
  ds_read_b64_tr_b16 v[70:71], v11 offset:63488
  v_mfma_f32_16x16x32_bf16 v[244:247], v[80:83], a[100:103], v[244:247]
  ds_read_b64_tr_b16 v[72:73], v12
  v_mfma_f32_16x16x32_bf16 v[244:247], v[84:87], a[116:119], v[244:247]
  ds_read_b64_tr_b16 v[74:75], v12 offset:2048
  v_mfma_f32_16x16x32_bf16 v[244:247], v[88:91], a[132:135], v[244:247]
  ds_read_b64_tr_b16 v[76:77], v12 offset:4096
  v_mfma_f32_16x16x32_bf16 v[248:251], v[80:83], a[104:107], v[248:251]
  ds_read_b64_tr_b16 v[78:79], v12 offset:6144
  v_mfma_f32_16x16x32_bf16 v[248:251], v[84:87], a[120:123], v[248:251]
  s_add_u32 m0, s33, 114688
  v_mfma_f32_16x16x32_bf16 v[248:251], v[88:91], a[136:139], v[248:251]
  s_mov_b32 s34, 1024
  v_mfma_f32_16x16x32_bf16 v[252:255], v[80:83], a[108:111], v[252:255]
  buffer_load_dwordx4 v22, s[12:15], s34 offen lds
  v_mfma_f32_16x16x32_bf16 v[252:255], v[84:87], a[124:127], v[252:255]
  v_mfma_f32_16x16x32_bf16 v[252:255], v[88:91], a[140:143], v[252:255]
  s_waitcnt lgkmcnt(6)
  v_mfma_f32_16x16x32_bf16 v[160:163], v[56:59], a[0:3], 0
  ds_read_b64_tr_b16 v[80:81], v9 offset:8192
  v_mfma_f32_16x16x32_bf16 v[160:163], v[60:63], a[16:19], v[160:163]
  ds_read_b64_tr_b16 v[82:83], v9 offset:10240
  v_cvt_pk_bf16_f32 v40, v224, v225
  v_mfma_f32_16x16x32_bf16 v[160:163], v[64:67], a[32:35], v[160:163]
  ds_read_b64_tr_b16 v[84:85], v9 offset:12288
  v_cvt_pk_bf16_f32 v41, v226, v227
  v_mfma_f32_16x16x32_bf16 v[164:167], v[56:59], a[4:7], 0
  ds_read_b64_tr_b16 v[86:87], v9 offset:14336
  v_cvt_pk_bf16_f32 v42, v240, v241
  v_mfma_f32_16x16x32_bf16 v[164:167], v[60:63], a[20:23], v[164:167]
  ds_read_b64_tr_b16 v[88:89], v9 offset:16384
  v_cvt_pk_bf16_f32 v43, v242, v243
  v_mfma_f32_16x16x32_bf16 v[164:167], v[64:67], a[36:39], v[164:167]
  ds_read_b64_tr_b16 v[90:91], v9 offset:18432
  s_mov_b32 s35, 10240
  v_mfma_f32_16x16x32_bf16 v[168:171], v[56:59], a[8:11], 0
  buffer_store_dwordx4 v[40:43], v24, s[20:23], s35 offen
  v_mfma_f32_16x16x32_bf16 v[168:171], v[60:63], a[24:27], v[168:171]
  v_cvt_pk_bf16_f32 v44, v228, v229
  v_mfma_f32_16x16x32_bf16 v[168:171], v[64:67], a[40:43], v[168:171]
  v_cvt_pk_bf16_f32 v45, v230, v231
  v_mfma_f32_16x16x32_bf16 v[172:175], v[56:59], a[12:15], 0
  v_cvt_pk_bf16_f32 v46, v244, v245
  v_mfma_f32_16x16x32_bf16 v[172:175], v[60:63], a[28:31], v[172:175]
  v_cvt_pk_bf16_f32 v47, v246, v247
  v_mfma_f32_16x16x32_bf16 v[172:175], v[64:67], a[44:47], v[172:175]
  s_mov_b32 s35, 28672
  s_waitcnt lgkmcnt(6)
  v_mfma_f32_16x16x32_bf16 v[176:179], v[68:71], a[0:3], 0
  ds_read_b64_tr_b16 v[56:57], v12 offset:8192
  buffer_store_dwordx4 v[44:47], v24, s[20:23], s35 offen
  v_mfma_f32_16x16x32_bf16 v[176:179], v[72:75], a[16:19], v[176:179]
  ds_read_b64_tr_b16 v[58:59], v12 offset:10240
  v_cvt_pk_bf16_f32 v48, v232, v233
  v_mfma_f32_16x16x32_bf16 v[176:179], v[76:79], a[32:35], v[176:179]
  ds_read_b64_tr_b16 v[60:61], v12 offset:12288
  v_cvt_pk_bf16_f32 v49, v234, v235
  v_mfma_f32_16x16x32_bf16 v[180:183], v[68:71], a[4:7], 0
  ds_read_b64_tr_b16 v[62:63], v12 offset:14336
  v_cvt_pk_bf16_f32 v50, v248, v249
  v_mfma_f32_16x16x32_bf16 v[180:183], v[72:75], a[20:23], v[180:183]
  ds_read_b64_tr_b16 v[64:65], v12 offset:16384
  v_cvt_pk_bf16_f32 v51, v250, v251
  v_mfma_f32_16x16x32_bf16 v[180:183], v[76:79], a[36:39], v[180:183]
  ds_read_b64_tr_b16 v[66:67], v12 offset:18432
  s_mov_b32 s35, 47104
  v_mfma_f32_16x16x32_bf16 v[184:187], v[68:71], a[8:11], 0
  buffer_store_dwordx4 v[48:51], v24, s[20:23], s35 offen
  v_mfma_f32_16x16x32_bf16 v[184:187], v[72:75], a[24:27], v[184:187]
  v_cvt_pk_bf16_f32 v52, v236, v237
  v_mfma_f32_16x16x32_bf16 v[184:187], v[76:79], a[40:43], v[184:187]
  v_cvt_pk_bf16_f32 v53, v238, v239
  v_mfma_f32_16x16x32_bf16 v[188:191], v[68:71], a[12:15], 0
  v_cvt_pk_bf16_f32 v54, v252, v253
  v_mfma_f32_16x16x32_bf16 v[188:191], v[72:75], a[28:31], v[188:191]
  v_cvt_pk_bf16_f32 v55, v254, v255
  v_mfma_f32_16x16x32_bf16 v[188:191], v[76:79], a[44:47], v[188:191]
  s_mov_b32 s35, 65536
  s_waitcnt lgkmcnt(6)
  v_mfma_f32_16x16x32_bf16 v[160:163], v[80:83], a[48:51], v[160:163]
  ds_read_b64_tr_b16 v[68:69], v9 offset:20480
  buffer_store_dwordx4 v[52:55], v24, s[20:23], s35 offen
  v_mfma_f32_16x16x32_bf16 v[160:163], v[84:87], a[64:67], v[160:163]
  ds_read_b64_tr_b16 v[70:71], v9 offset:22528
  v_mfma_f32_16x16x32_bf16 v[160:163], v[88:91], a[80:83], v[160:163]
  ds_read_b64_tr_b16 v[72:73], v8
  v_mfma_f32_16x16x32_bf16 v[164:167], v[80:83], a[52:55], v[164:167]
  ds_read_b64_tr_b16 v[74:75], v8 offset:2048
  v_mfma_f32_16x16x32_bf16 v[164:167], v[84:87], a[68:71], v[164:167]
  ds_read_b64_tr_b16 v[76:77], v8 offset:4096
  v_mfma_f32_16x16x32_bf16 v[164:167], v[88:91], a[84:87], v[164:167]
  ds_read_b64_tr_b16 v[78:79], v8 offset:6144
  v_mfma_f32_16x16x32_bf16 v[168:171], v[80:83], a[56:59], v[168:171]
  v_mfma_f32_16x16x32_bf16 v[168:171], v[84:87], a[72:75], v[168:171]
  v_mfma_f32_16x16x32_bf16 v[168:171], v[88:91], a[88:91], v[168:171]
  v_mfma_f32_16x16x32_bf16 v[172:175], v[80:83], a[60:63], v[172:175]
  v_mfma_f32_16x16x32_bf16 v[172:175], v[84:87], a[76:79], v[172:175]
  v_mfma_f32_16x16x32_bf16 v[172:175], v[88:91], a[92:95], v[172:175]
  s_waitcnt lgkmcnt(6)
  v_mfma_f32_16x16x32_bf16 v[176:179], v[56:59], a[48:51], v[176:179]
  s_waitcnt vmcnt(20)
  s_barrier
  v_mfma_f32_16x16x32_bf16 v[176:179], v[60:63], a[64:67], v[176:179]
  ds_read_b64_tr_b16 v[80:81], v12 offset:20480
  v_mfma_f32_16x16x32_bf16 v[176:179], v[64:67], a[80:83], v[176:179]
  ds_read_b64_tr_b16 v[82:83], v12 offset:22528
  v_mfma_f32_16x16x32_bf16 v[180:183], v[56:59], a[52:55], v[180:183]
  ds_read_b64_tr_b16 v[84:85], v11
  v_mfma_f32_16x16x32_bf16 v[180:183], v[60:63], a[68:71], v[180:183]
  ds_read_b64_tr_b16 v[86:87], v11 offset:2048
  v_mfma_f32_16x16x32_bf16 v[180:183], v[64:67], a[84:87], v[180:183]
  ds_read_b64_tr_b16 v[88:89], v11 offset:4096
  v_mfma_f32_16x16x32_bf16 v[184:187], v[56:59], a[56:59], v[184:187]
  ds_read_b64_tr_b16 v[90:91], v11 offset:6144
  v_mfma_f32_16x16x32_bf16 v[184:187], v[60:63], a[72:75], v[184:187]
  v_mfma_f32_16x16x32_bf16 v[184:187], v[64:67], a[88:91], v[184:187]
  v_mfma_f32_16x16x32_bf16 v[188:191], v[56:59], a[60:63], v[188:191]
  v_mfma_f32_16x16x32_bf16 v[188:191], v[60:63], a[76:79], v[188:191]
  v_mfma_f32_16x16x32_bf16 v[188:191], v[64:67], a[92:95], v[188:191]
  s_waitcnt lgkmcnt(6)
  v_mfma_f32_16x16x32_bf16 v[160:163], v[68:71], a[96:99], v[160:163]
  ds_read_b64_tr_b16 v[56:57], v8 offset:8192
  v_mfma_f32_16x16x32_bf16 v[160:163], v[72:75], a[112:115], v[160:163]
  ds_read_b64_tr_b16 v[58:59], v8 offset:10240
  v_mfma_f32_16x16x32_bf16 v[160:163], v[76:79], a[128:131], v[160:163]
  ds_read_b64_tr_b16 v[60:61], v8 offset:12288
  v_mfma_f32_16x16x32_bf16 v[164:167], v[68:71], a[100:103], v[164:167]
  ds_read_b64_tr_b16 v[62:63], v8 offset:14336
  v_mfma_f32_16x16x32_bf16 v[164:167], v[72:75], a[116:119], v[164:167]
  ds_read_b64_tr_b16 v[64:65], v8 offset:16384
  v_mfma_f32_16x16x32_bf16 v[164:167], v[76:79], a[132:135], v[164:167]
  ds_read_b64_tr_b16 v[66:67], v8 offset:18432
  v_mfma_f32_16x16x32_bf16 v[168:171], v[68:71], a[104:107], v[168:171]
  v_mfma_f32_16x16x32_bf16 v[168:171], v[72:75], a[120:123], v[168:171]
  v_mfma_f32_16x16x32_bf16 v[168:171], v[76:79], a[136:139], v[168:171]
  v_mfma_f32_16x16x32_bf16 v[172:175], v[68:71], a[108:111], v[172:175]
  v_mfma_f32_16x16x32_bf16 v[172:175], v[72:75], a[124:127], v[172:175]
  v_mfma_f32_16x16x32_bf16 v[172:175], v[76:79], a[140:143], v[172:175]
  s_waitcnt lgkmcnt(6)
  v_mfma_f32_16x16x32_bf16 v[176:179], v[80:83], a[96:99], v[176:179]
  ds_read_b64_tr_b16 v[68:69], v11 offset:8192
  v_mfma_f32_16x16x32_bf16 v[176:179], v[84:87], a[112:115], v[176:179]
  ds_read_b64_tr_b16 v[70:71], v11 offset:10240
  v_mfma_f32_16x16x32_bf16 v[176:179], v[88:91], a[128:131], v[176:179]
  ds_read_b64_tr_b16 v[72:73], v11 offset:12288
  v_mfma_f32_16x16x32_bf16 v[180:183], v[80:83], a[100:103], v[180:183]
  ds_read_b64_tr_b16 v[74:75], v11 offset:14336
  v_mfma_f32_16x16x32_bf16 v[180:183], v[84:87], a[116:119], v[180:183]
  ds_read_b64_tr_b16 v[76:77], v11 offset:16384
  v_mfma_f32_16x16x32_bf16 v[180:183], v[88:91], a[132:135], v[180:183]
  ds_read_b64_tr_b16 v[78:79], v11 offset:18432
  v_mfma_f32_16x16x32_bf16 v[184:187], v[80:83], a[104:107], v[184:187]
  v_mfma_f32_16x16x32_bf16 v[184:187], v[84:87], a[120:123], v[184:187]
  v_mfma_f32_16x16x32_bf16 v[184:187], v[88:91], a[136:139], v[184:187]
  v_mfma_f32_16x16x32_bf16 v[188:191], v[80:83], a[108:111], v[188:191]
  v_mfma_f32_16x16x32_bf16 v[188:191], v[84:87], a[124:127], v[188:191]
  v_mfma_f32_16x16x32_bf16 v[188:191], v[88:91], a[140:143], v[188:191]
  s_waitcnt lgkmcnt(6)
  v_mfma_f32_16x16x32_bf16 v[128:131], v[56:59], a[0:3], 0
  ds_read_b64_tr_b16 v[80:81], v8 offset:20480
  v_mfma_f32_16x16x32_bf16 v[128:131], v[60:63], a[16:19], v[128:131]
  ds_read_b64_tr_b16 v[82:83], v8 offset:22528
  v_cvt_pk_bf16_f32 v40, v160, v161
  v_mfma_f32_16x16x32_bf16 v[128:131], v[64:67], a[32:35], v[128:131]
  ds_read_b64_tr_b16 v[84:85], v8 offset:24576
  v_cvt_pk_bf16_f32 v41, v162, v163
  v_mfma_f32_16x16x32_bf16 v[132:135], v[56:59], a[4:7], 0
  ds_read_b64_tr_b16 v[86:87], v8 offset:26624
  v_cvt_pk_bf16_f32 v42, v176, v177
  v_mfma_f32_16x16x32_bf16 v[132:135], v[60:63], a[20:23], v[132:135]
  ds_read_b64_tr_b16 v[88:89], v10
  v_cvt_pk_bf16_f32 v43, v178, v179
  v_mfma_f32_16x16x32_bf16 v[132:135], v[64:67], a[36:39], v[132:135]
  ds_read_b64_tr_b16 v[90:91], v10 offset:2048
  s_mov_b32 s35, 12288
  v_mfma_f32_16x16x32_bf16 v[136:139], v[56:59], a[8:11], 0
  buffer_store_dwordx4 v[40:43], v24, s[20:23], s35 offen
  v_mfma_f32_16x16x32_bf16 v[136:139], v[60:63], a[24:27], v[136:139]
  v_cvt_pk_bf16_f32 v44, v164, v165
  v_mfma_f32_16x16x32_bf16 v[136:139], v[64:67], a[40:43], v[136:139]
  v_cvt_pk_bf16_f32 v45, v166, v167
  v_mfma_f32_16x16x32_bf16 v[140:143], v[56:59], a[12:15], 0
  v_cvt_pk_bf16_f32 v46, v180, v181
  v_mfma_f32_16x16x32_bf16 v[140:143], v[60:63], a[28:31], v[140:143]
  v_cvt_pk_bf16_f32 v47, v182, v183
  v_mfma_f32_16x16x32_bf16 v[140:143], v[64:67], a[44:47], v[140:143]
  s_mov_b32 s35, 30720
  s_waitcnt lgkmcnt(6)
  v_mfma_f32_16x16x32_bf16 v[144:147], v[68:71], a[0:3], 0
  s_waitcnt vmcnt(12)
  s_barrier
  v_mfma_f32_16x16x32_bf16 v[144:147], v[72:75], a[16:19], v[144:147]
  ds_read_b64_tr_b16 v[56:57], v11 offset:20480
  buffer_store_dwordx4 v[44:47], v24, s[20:23], s35 offen
  v_mfma_f32_16x16x32_bf16 v[144:147], v[76:79], a[32:35], v[144:147]
  ds_read_b64_tr_b16 v[58:59], v11 offset:22528
  v_cvt_pk_bf16_f32 v48, v168, v169
  v_mfma_f32_16x16x32_bf16 v[148:151], v[68:71], a[4:7], 0
  ds_read_b64_tr_b16 v[60:61], v11 offset:24576
  v_cvt_pk_bf16_f32 v49, v170, v171
  v_mfma_f32_16x16x32_bf16 v[148:151], v[72:75], a[20:23], v[148:151]
  ds_read_b64_tr_b16 v[62:63], v11 offset:26624
  v_cvt_pk_bf16_f32 v50, v184, v185
  v_mfma_f32_16x16x32_bf16 v[148:151], v[76:79], a[36:39], v[148:151]
  ds_read_b64_tr_b16 v[64:65], v13
  v_cvt_pk_bf16_f32 v51, v186, v187
  v_mfma_f32_16x16x32_bf16 v[152:155], v[68:71], a[8:11], 0
  ds_read_b64_tr_b16 v[66:67], v13 offset:2048
  s_mov_b32 s35, 49152
  v_mfma_f32_16x16x32_bf16 v[152:155], v[72:75], a[24:27], v[152:155]
  buffer_store_dwordx4 v[48:51], v24, s[20:23], s35 offen
  v_mfma_f32_16x16x32_bf16 v[152:155], v[76:79], a[40:43], v[152:155]
  v_cvt_pk_bf16_f32 v52, v172, v173
  v_mfma_f32_16x16x32_bf16 v[156:159], v[68:71], a[12:15], 0
  v_cvt_pk_bf16_f32 v53, v174, v175
  v_mfma_f32_16x16x32_bf16 v[156:159], v[72:75], a[28:31], v[156:159]
  v_cvt_pk_bf16_f32 v54, v188, v189
  v_mfma_f32_16x16x32_bf16 v[156:159], v[76:79], a[44:47], v[156:159]
  v_cvt_pk_bf16_f32 v55, v190, v191
  s_waitcnt lgkmcnt(6)
  v_mfma_f32_16x16x32_bf16 v[128:131], v[80:83], a[48:51], v[128:131]
  ds_read_b64_tr_b16 v[68:69], v9 offset:24576
  s_mov_b32 s35, 67584
  v_mfma_f32_16x16x32_bf16 v[128:131], v[84:87], a[64:67], v[128:131]
  ds_read_b64_tr_b16 v[70:71], v9 offset:26624
  buffer_store_dwordx4 v[52:55], v24, s[20:23], s35 offen
  v_mfma_f32_16x16x32_bf16 v[128:131], v[88:91], a[80:83], v[128:131]
  ds_read_b64_tr_b16 v[72:73], v9 offset:28672
  v_mfma_f32_16x16x32_bf16 v[132:135], v[80:83], a[52:55], v[132:135]
  ds_read_b64_tr_b16 v[74:75], v9 offset:30720
  v_mfma_f32_16x16x32_bf16 v[132:135], v[84:87], a[68:71], v[132:135]
  ds_read_b64_tr_b16 v[76:77], v9 offset:61440
  v_mfma_f32_16x16x32_bf16 v[132:135], v[88:91], a[84:87], v[132:135]
  ds_read_b64_tr_b16 v[78:79], v9 offset:63488
  v_mfma_f32_16x16x32_bf16 v[136:139], v[80:83], a[56:59], v[136:139]
  v_mfma_f32_16x16x32_bf16 v[136:139], v[84:87], a[72:75], v[136:139]
  v_mfma_f32_16x16x32_bf16 v[136:139], v[88:91], a[88:91], v[136:139]
  v_mfma_f32_16x16x32_bf16 v[140:143], v[80:83], a[60:63], v[140:143]
  v_mfma_f32_16x16x32_bf16 v[140:143], v[84:87], a[76:79], v[140:143]
  v_mfma_f32_16x16x32_bf16 v[140:143], v[88:91], a[92:95], v[140:143]
  s_waitcnt lgkmcnt(6)
  v_mfma_f32_16x16x32_bf16 v[144:147], v[56:59], a[48:51], v[144:147]
  ds_read_b64_tr_b16 v[80:81], v12 offset:24576
  v_mfma_f32_16x16x32_bf16 v[144:147], v[60:63], a[64:67], v[144:147]
  ds_read_b64_tr_b16 v[82:83], v12 offset:26624
  v_mfma_f32_16x16x32_bf16 v[144:147], v[64:67], a[80:83], v[144:147]
  ds_read_b64_tr_b16 v[84:85], v12 offset:28672
  v_mfma_f32_16x16x32_bf16 v[148:151], v[56:59], a[52:55], v[148:151]
  ds_read_b64_tr_b16 v[86:87], v12 offset:30720
  v_mfma_f32_16x16x32_bf16 v[148:151], v[60:63], a[68:71], v[148:151]
  ds_read_b64_tr_b16 v[88:89], v12 offset:61440
  v_mfma_f32_16x16x32_bf16 v[148:151], v[64:67], a[84:87], v[148:151]
  ds_read_b64_tr_b16 v[90:91], v12 offset:63488
  v_mfma_f32_16x16x32_bf16 v[152:155], v[56:59], a[56:59], v[152:155]
  v_mfma_f32_16x16x32_bf16 v[152:155], v[60:63], a[72:75], v[152:155]
  v_mfma_f32_16x16x32_bf16 v[152:155], v[64:67], a[88:91], v[152:155]
  v_mfma_f32_16x16x32_bf16 v[156:159], v[56:59], a[60:63], v[156:159]
  v_mfma_f32_16x16x32_bf16 v[156:159], v[60:63], a[76:79], v[156:159]
  v_mfma_f32_16x16x32_bf16 v[156:159], v[64:67], a[92:95], v[156:159]
  s_waitcnt lgkmcnt(6)
  v_mfma_f32_16x16x32_bf16 v[128:131], v[68:71], a[96:99], v[128:131]
  ds_read_b64_tr_b16 v[56:57], v10 offset:4096
  v_mfma_f32_16x16x32_bf16 v[128:131], v[72:75], a[112:115], v[128:131]
  ds_read_b64_tr_b16 v[58:59], v10 offset:6144
  v_mfma_f32_16x16x32_bf16 v[128:131], v[76:79], a[128:131], v[128:131]
  ds_read_b64_tr_b16 v[60:61], v10 offset:8192
  v_mfma_f32_16x16x32_bf16 v[132:135], v[68:71], a[100:103], v[132:135]
  ds_read_b64_tr_b16 v[62:63], v10 offset:10240
  v_mfma_f32_16x16x32_bf16 v[132:135], v[72:75], a[116:119], v[132:135]
  ds_read_b64_tr_b16 v[64:65], v9 offset:32768
  v_mfma_f32_16x16x32_bf16 v[132:135], v[76:79], a[132:135], v[132:135]
  ds_read_b64_tr_b16 v[66:67], v9 offset:34816
  v_mfma_f32_16x16x32_bf16 v[136:139], v[68:71], a[104:107], v[136:139]
  v_mfma_f32_16x16x32_bf16 v[136:139], v[72:75], a[120:123], v[136:139]
  v_mfma_f32_16x16x32_bf16 v[136:139], v[76:79], a[136:139], v[136:139]
  v_mfma_f32_16x16x32_bf16 v[140:143], v[68:71], a[108:111], v[140:143]
  v_mfma_f32_16x16x32_bf16 v[140:143], v[72:75], a[124:127], v[140:143]
  v_mfma_f32_16x16x32_bf16 v[140:143], v[76:79], a[140:143], v[140:143]
  s_waitcnt lgkmcnt(6)
  v_mfma_f32_16x16x32_bf16 v[144:147], v[80:83], a[96:99], v[144:147]
  s_waitcnt vmcnt(8)
  s_barrier
  v_mfma_f32_16x16x32_bf16 v[144:147], v[84:87], a[112:115], v[144:147]
  ds_read_b64_tr_b16 v[68:69], v13 offset:4096
  v_mfma_f32_16x16x32_bf16 v[144:147], v[88:91], a[128:131], v[144:147]
  ds_read_b64_tr_b16 v[70:71], v13 offset:6144
  v_mfma_f32_16x16x32_bf16 v[148:151], v[80:83], a[100:103], v[148:151]
  ds_read_b64_tr_b16 v[72:73], v13 offset:8192
  v_mfma_f32_16x16x32_bf16 v[148:151], v[84:87], a[116:119], v[148:151]
  ds_read_b64_tr_b16 v[74:75], v13 offset:10240
  v_mfma_f32_16x16x32_bf16 v[148:151], v[88:91], a[132:135], v[148:151]
  ds_read_b64_tr_b16 v[76:77], v12 offset:32768
  v_mfma_f32_16x16x32_bf16 v[152:155], v[80:83], a[104:107], v[152:155]
  ds_read_b64_tr_b16 v[78:79], v12 offset:34816
  v_mfma_f32_16x16x32_bf16 v[152:155], v[84:87], a[120:123], v[152:155]
  v_mfma_f32_16x16x32_bf16 v[152:155], v[88:91], a[136:139], v[152:155]
  v_mfma_f32_16x16x32_bf16 v[156:159], v[80:83], a[108:111], v[156:159]
  v_mfma_f32_16x16x32_bf16 v[156:159], v[84:87], a[124:127], v[156:159]
  v_mfma_f32_16x16x32_bf16 v[156:159], v[88:91], a[140:143], v[156:159]
  s_waitcnt lgkmcnt(6)
  v_mfma_f32_16x16x32_bf16 v[192:195], v[56:59], a[0:3], 0
  ds_read_b64_tr_b16 v[80:81], v9 offset:36864
  v_mfma_f32_16x16x32_bf16 v[192:195], v[60:63], a[16:19], v[192:195]
  ds_read_b64_tr_b16 v[82:83], v9 offset:38912
  v_cvt_pk_bf16_f32 v40, v128, v129
  v_mfma_f32_16x16x32_bf16 v[192:195], v[64:67], a[32:35], v[192:195]
  ds_read_b64_tr_b16 v[84:85], v9 offset:40960
  v_cvt_pk_bf16_f32 v41, v130, v131
  v_mfma_f32_16x16x32_bf16 v[196:199], v[56:59], a[4:7], 0
  ds_read_b64_tr_b16 v[86:87], v9 offset:43008
  v_cvt_pk_bf16_f32 v42, v144, v145
  v_mfma_f32_16x16x32_bf16 v[196:199], v[60:63], a[20:23], v[196:199]
  ds_read_b64_tr_b16 v[88:89], v9 offset:45056
  v_cvt_pk_bf16_f32 v43, v146, v147
  v_mfma_f32_16x16x32_bf16 v[196:199], v[64:67], a[36:39], v[196:199]
  ds_read_b64_tr_b16 v[90:91], v9 offset:47104
  s_mov_b32 s35, 14336
  v_mfma_f32_16x16x32_bf16 v[200:203], v[56:59], a[8:11], 0
  buffer_store_dwordx4 v[40:43], v24, s[20:23], s35 offen
  v_mfma_f32_16x16x32_bf16 v[200:203], v[60:63], a[24:27], v[200:203]
  v_cvt_pk_bf16_f32 v44, v132, v133
  v_mfma_f32_16x16x32_bf16 v[200:203], v[64:67], a[40:43], v[200:203]
  v_cvt_pk_bf16_f32 v45, v134, v135
  v_mfma_f32_16x16x32_bf16 v[204:207], v[56:59], a[12:15], 0
  v_cvt_pk_bf16_f32 v46, v148, v149
  v_mfma_f32_16x16x32_bf16 v[204:207], v[60:63], a[28:31], v[204:207]
  v_cvt_pk_bf16_f32 v47, v150, v151
  v_mfma_f32_16x16x32_bf16 v[204:207], v[64:67], a[44:47], v[204:207]
  s_mov_b32 s35, 32768
  s_waitcnt lgkmcnt(6)
  v_mfma_f32_16x16x32_bf16 v[208:211], v[68:71], a[0:3], 0
  ds_read_b64_tr_b16 v[56:57], v12 offset:36864
  buffer_store_dwordx4 v[44:47], v24, s[20:23], s35 offen
  v_mfma_f32_16x16x32_bf16 v[208:211], v[72:75], a[16:19], v[208:211]
  ds_read_b64_tr_b16 v[58:59], v12 offset:38912
  v_cvt_pk_bf16_f32 v48, v136, v137
  v_mfma_f32_16x16x32_bf16 v[208:211], v[76:79], a[32:35], v[208:211]
  ds_read_b64_tr_b16 v[60:61], v12 offset:40960
  v_cvt_pk_bf16_f32 v49, v138, v139
  v_mfma_f32_16x16x32_bf16 v[212:215], v[68:71], a[4:7], 0
  ds_read_b64_tr_b16 v[62:63], v12 offset:43008
  v_cvt_pk_bf16_f32 v50, v152, v153
  v_mfma_f32_16x16x32_bf16 v[212:215], v[72:75], a[20:23], v[212:215]
  ds_read_b64_tr_b16 v[64:65], v12 offset:45056
  v_cvt_pk_bf16_f32 v51, v154, v155
  v_mfma_f32_16x16x32_bf16 v[212:215], v[76:79], a[36:39], v[212:215]
  ds_read_b64_tr_b16 v[66:67], v12 offset:47104
  s_mov_b32 s35, 51200
  v_mfma_f32_16x16x32_bf16 v[216:219], v[68:71], a[8:11], 0
  buffer_store_dwordx4 v[48:51], v24, s[20:23], s35 offen
  v_mfma_f32_16x16x32_bf16 v[216:219], v[72:75], a[24:27], v[216:219]
  v_cvt_pk_bf16_f32 v52, v140, v141
  v_mfma_f32_16x16x32_bf16 v[216:219], v[76:79], a[40:43], v[216:219]
  v_cvt_pk_bf16_f32 v53, v142, v143
  v_mfma_f32_16x16x32_bf16 v[220:223], v[68:71], a[12:15], 0
  v_cvt_pk_bf16_f32 v54, v156, v157
  v_mfma_f32_16x16x32_bf16 v[220:223], v[72:75], a[28:31], v[220:223]
  v_cvt_pk_bf16_f32 v55, v158, v159
  v_mfma_f32_16x16x32_bf16 v[220:223], v[76:79], a[44:47], v[220:223]
  s_mov_b32 s35, 69632
  s_waitcnt lgkmcnt(6)
  v_mfma_f32_16x16x32_bf16 v[192:195], v[80:83], a[48:51], v[192:195]
  ds_read_b64_tr_b16 v[68:69], v10 offset:12288
  buffer_store_dwordx4 v[52:55], v24, s[20:23], s35 offen
  v_mfma_f32_16x16x32_bf16 v[192:195], v[84:87], a[64:67], v[192:195]
  ds_read_b64_tr_b16 v[70:71], v10 offset:14336
  v_mfma_f32_16x16x32_bf16 v[192:195], v[88:91], a[80:83], v[192:195]
  ds_read_b64_tr_b16 v[72:73], v10 offset:16384
  v_mfma_f32_16x16x32_bf16 v[196:199], v[80:83], a[52:55], v[196:199]
  ds_read_b64_tr_b16 v[74:75], v10 offset:18432
  v_mfma_f32_16x16x32_bf16 v[196:199], v[84:87], a[68:71], v[196:199]
  ds_read_b64_tr_b16 v[76:77], v9 offset:49152
  v_mfma_f32_16x16x32_bf16 v[196:199], v[88:91], a[84:87], v[196:199]
  ds_read_b64_tr_b16 v[78:79], v9 offset:51200
  v_mfma_f32_16x16x32_bf16 v[200:203], v[80:83], a[56:59], v[200:203]
  v_mfma_f32_16x16x32_bf16 v[200:203], v[84:87], a[72:75], v[200:203]
  v_mfma_f32_16x16x32_bf16 v[200:203], v[88:91], a[88:91], v[200:203]
  v_mfma_f32_16x16x32_bf16 v[204:207], v[80:83], a[60:63], v[204:207]
  v_mfma_f32_16x16x32_bf16 v[204:207], v[84:87], a[76:79], v[204:207]
  v_mfma_f32_16x16x32_bf16 v[204:207], v[88:91], a[92:95], v[204:207]
  s_waitcnt lgkmcnt(6)
  v_mfma_f32_16x16x32_bf16 v[208:211], v[56:59], a[48:51], v[208:211]
  s_barrier
  v_mfma_f32_16x16x32_bf16 v[208:211], v[60:63], a[64:67], v[208:211]
  ds_read_b64_tr_b16 v[80:81], v13 offset:12288
  v_mfma_f32_16x16x32_bf16 v[208:211], v[64:67], a[80:83], v[208:211]
  ds_read_b64_tr_b16 v[82:83], v13 offset:14336
  v_mfma_f32_16x16x32_bf16 v[212:215], v[56:59], a[52:55], v[212:215]
  ds_read_b64_tr_b16 v[84:85], v13 offset:16384
  v_mfma_f32_16x16x32_bf16 v[212:215], v[60:63], a[68:71], v[212:215]
  ds_read_b64_tr_b16 v[86:87], v13 offset:18432
  v_mfma_f32_16x16x32_bf16 v[212:215], v[64:67], a[84:87], v[212:215]
  ds_read_b64_tr_b16 v[88:89], v12 offset:49152
  v_mfma_f32_16x16x32_bf16 v[216:219], v[56:59], a[56:59], v[216:219]
  ds_read_b64_tr_b16 v[90:91], v12 offset:51200
  v_mfma_f32_16x16x32_bf16 v[216:219], v[60:63], a[72:75], v[216:219]
  v_mfma_f32_16x16x32_bf16 v[216:219], v[64:67], a[88:91], v[216:219]
  v_mfma_f32_16x16x32_bf16 v[220:223], v[56:59], a[60:63], v[220:223]
  v_mfma_f32_16x16x32_bf16 v[220:223], v[60:63], a[76:79], v[220:223]
  v_mfma_f32_16x16x32_bf16 v[220:223], v[64:67], a[92:95], v[220:223]
  s_waitcnt lgkmcnt(6)
  v_mfma_f32_16x16x32_bf16 v[192:195], v[68:71], a[96:99], v[192:195]
  v_mfma_f32_16x16x32_bf16 v[192:195], v[72:75], a[112:115], v[192:195]
  v_mfma_f32_16x16x32_bf16 v[192:195], v[76:79], a[128:131], v[192:195]
  v_mfma_f32_16x16x32_bf16 v[196:199], v[68:71], a[100:103], v[196:199]
  v_mfma_f32_16x16x32_bf16 v[196:199], v[72:75], a[116:119], v[196:199]
  v_mfma_f32_16x16x32_bf16 v[196:199], v[76:79], a[132:135], v[196:199]
  v_mfma_f32_16x16x32_bf16 v[200:203], v[68:71], a[104:107], v[200:203]
  v_mfma_f32_16x16x32_bf16 v[200:203], v[72:75], a[120:123], v[200:203]
  v_mfma_f32_16x16x32_bf16 v[200:203], v[76:79], a[136:139], v[200:203]
  v_mfma_f32_16x16x32_bf16 v[204:207], v[68:71], a[108:111], v[204:207]
  v_mfma_f32_16x16x32_bf16 v[204:207], v[72:75], a[124:127], v[204:207]
  v_mfma_f32_16x16x32_bf16 v[204:207], v[76:79], a[140:143], v[204:207]
  s_waitcnt lgkmcnt(0)
  v_mfma_f32_16x16x32_bf16 v[208:211], v[80:83], a[96:99], v[208:211]
  v_mfma_f32_16x16x32_bf16 v[208:211], v[84:87], a[112:115], v[208:211]
  v_mfma_f32_16x16x32_bf16 v[208:211], v[88:91], a[128:131], v[208:211]
  v_mfma_f32_16x16x32_bf16 v[212:215], v[80:83], a[100:103], v[212:215]
  v_mfma_f32_16x16x32_bf16 v[212:215], v[84:87], a[116:119], v[212:215]
  v_mfma_f32_16x16x32_bf16 v[212:215], v[88:91], a[132:135], v[212:215]
  v_mfma_f32_16x16x32_bf16 v[216:219], v[80:83], a[104:107], v[216:219]
  v_mfma_f32_16x16x32_bf16 v[216:219], v[84:87], a[120:123], v[216:219]
  v_mfma_f32_16x16x32_bf16 v[216:219], v[88:91], a[136:139], v[216:219]
  v_mfma_f32_16x16x32_bf16 v[220:223], v[80:83], a[108:111], v[220:223]
  v_mfma_f32_16x16x32_bf16 v[220:223], v[84:87], a[124:127], v[220:223]
  v_mfma_f32_16x16x32_bf16 v[220:223], v[88:91], a[140:143], v[220:223]
  v_cvt_pk_bf16_f32 v40, v192, v193
  v_cvt_pk_bf16_f32 v41, v194, v195
  v_cvt_pk_bf16_f32 v42, v208, v209
  v_cvt_pk_bf16_f32 v43, v210, v211
  s_mov_b32 s35, 16384
  buffer_store_dwordx4 v[40:43], v24, s[20:23], s35 offen
  v_cvt_pk_bf16_f32 v44, v196, v197
  v_cvt_pk_bf16_f32 v45, v198, v199
  v_cvt_pk_bf16_f32 v46, v212, v213
  v_cvt_pk_bf16_f32 v47, v214, v215
  s_mov_b32 s35, 34816
  buffer_store_dwordx4 v[44:47], v24, s[20:23], s35 offen
  v_cvt_pk_bf16_f32 v48, v200, v201
  v_cvt_pk_bf16_f32 v49, v202, v203
  v_cvt_pk_bf16_f32 v50, v216, v217
  v_cvt_pk_bf16_f32 v51, v218, v219
  s_mov_b32 s35, 53248
  buffer_store_dwordx4 v[48:51], v24, s[20:23], s35 offen
  v_cvt_pk_bf16_f32 v52, v204, v205
  v_cvt_pk_bf16_f32 v53, v206, v207
  v_cvt_pk_bf16_f32 v54, v220, v221
  v_cvt_pk_bf16_f32 v55, v222, v223
  s_mov_b32 s35, 71680
  buffer_store_dwordx4 v[52:55], v24, s[20:23], s35 offen
L_b1_kernel_end:
  s_endpgm
.globl b2_kernel
.p2align 8
.type b2_kernel,@function
b2_kernel:
  s_cmp_ge_u32 s2, 256
  s_cbranch_scc1 L_b2_kernel_end
  s_load_dwordx2 s[44:45], s[0:1], 56
  s_load_dwordx2 s[50:51], s[0:1], 72
  v_lshrrev_b32 v12, 6, v0
  v_and_b32 v1, 63, v0
  v_readfirstlane_b32 s32, v12
  v_lshrrev_b32 v2, 3, v1
  v_and_b32 v3, 7, v1
  v_mov_b32 v11, 0x7ffffff0
  s_and_b32 s36, s2, 7
  s_lshl_b32 s36, s36, 5
  s_lshr_b32 s37, s2, 3
  s_add_u32 s33, s36, s37
  s_lshr_b32 s36, s33, 1
  s_mul_i32 s36, s36, 18432
  s_and_b32 s37, s33, 1
  s_lshl_b32 s37, s37, 7
  s_add_u32 s36, s36, s37
  v_lshlrev_b32 v12, 8, v2
  v_lshl_add_u32 v12, v3, 4, v12
  s_lshl_b32 s37, s32, 12
  s_add_u32 s37, s37, s36
  v_add_u32 v4, s37, v12
  s_lshl_b32 s37, s32, 2
  s_add_u32 s37, s37, s36
  s_add_u32 s37, s37, 16384
  v_add_u32 v5, s37, v12
  s_lshl_b32 s36, s33, 3
  v_add_u32 v13, s36, v3
  v_lshlrev_b32 v8, 2, v13
  v_mul_u32_u24 v13, 1152, v13
  v_lshrrev_b32 v12, 2, v2
  v_lshl_add_u32 v13, v12, 6, v13
  v_and_b32 v12, 3, v2
  v_lshl_add_u32 v13, v12, 3, v13
  s_lshl_b32 s37, s32, 8
  v_add_u32 v6, s37, v13
  s_lshr_b32 s37, s32, 1
  s_lshl_b32 s37, s37, 5
  s_and_b32 s38, s32, 1
  s_lshl_b32 s38, s38, 2
  s_add_u32 s37, s37, s38
  s_add_u32 s37, s37, 1024
  v_add_u32 v7, s37, v13
  v_lshlrev_b32 v10, 4, v3
  s_lshl_b32 s37, s32, 2
  v_add_u32 v9, s37, v10
  s_mul_i32 s36, s32, 9437180
  v_add_u32 v34, s36, v5
  v_lshlrev_b32 v12, 5, v1
  s_lshl_b32 s36, s32, 11
  s_add_u32 s36, s36, 1024
  v_add_u32 v35, s36, v12
  s_lshl_b32 s36, s32, 3
  s_add_u32 s36, s36, 1024
  v_add_u32 v36, s36, v12
  v_lshlrev_b32 v12, 4, v8
  v_lshl_add_u32 v37, v2, 3, v12
  s_mov_b32 s53, 2359296
  s_mov_b32 s54, 4718592
  s_mov_b32 s55, 7077888
  s_mov_b32 s56, 9437184
  s_mov_b32 s57, 11796480
  s_mov_b32 s58, 14155776
  s_mov_b32 s59, 16515072
  s_mov_b32 s60, 18874368
  s_mov_b32 s61, 21233664
  s_mov_b32 s62, 23592960
  s_mov_b32 s63, 25952256
  s_mov_b32 s64, 28311552
  s_mov_b32 s65, 30670848
  s_mov_b32 s66, 33030144
  s_mov_b32 s67, 35389440
  s_waitcnt lgkmcnt(0)
  s_add_u32 s4, s50, 11096064
  s_addc_u32 s5, s51, 0
  s_and_b32 s5, s5, 0xffff
  s_mov_b32 s6, 37748736
  s_mov_b32 s7, 0x20000
  buffer_load_dwordx4 v[96:99], v34, s[4:7], 0 offen
  buffer_load_dwordx4 v[100:103], v34, s[4:7], s53 offen
  buffer_load_dwordx4 v[104:107], v34, s[4:7], s54 offen
  buffer_load_dwordx4 v[108:111], v34, s[4:7], s55 offen
  s_add_u32 s8, s50, 0
  s_addc_u32 s9, s51, 0
  s_and_b32 s9, s9, 0xffff
  s_mov_b32 s10, 2359296
  s_mov_b32 s11, 0x20000
  s_add_u32 s12, s50, 9850880
  s_addc_u32 s13, s51, 0
  s_and_b32 s13, s13, 0xffff
  s_mov_b32 s14, 131072
  s_mov_b32 s15, 0x20000
  s_add_u32 s16, s50, 9834496
  s_addc_u32 s17, s51, 0
  s_and_b32 s17, s17, 0xffff
  s_mov_b32 s18, 8192
  s_mov_b32 s19, 0x20000
  s_add_u32 s20, s50, 9842688
  s_addc_u32 s21, s51, 0
  s_and_b32 s21, s21, 0xffff
  s_mov_b32 s22, 8192
  s_mov_b32 s23, 0x20000
  buffer_load_dwordx2 v[38:39], v37, s[12:15], 0 offen
  buffer_load_dword v40, v8, s[16:19], 0 offen
  buffer_load_dword v41, v8, s[20:23], 0 offen
  buffer_load_dwordx4 v[44:47], v4, s[8:11], 0 offen
  buffer_load_dwordx4 v[48:51], v4, s[8:11], 0 offen offset:2048
  buffer_load_dword v52, v5, s[8:11], 0 offen
  buffer_load_dwordx4 v[112:115], v4, s[4:7], 0 offen
  buffer_load_dwordx4 v[116:119], v4, s[4:7], 0 offen offset:2048
  buffer_load_dwordx4 v[120:123], v4, s[4:7], s53 offen
  buffer_load_dwordx4 v[124:127], v4, s[4:7], s53 offen offset:2048
  buffer_load_dwordx4 v[128:131], v4, s[4:7], s54 offen
  buffer_load_dwordx4 v[132:135], v4, s[4:7], s54 offen offset:2048
  buffer_load_dwordx4 v[136:139], v4, s[4:7], s55 offen
  buffer_load_dwordx4 v[140:143], v4, s[4:7], s55 offen offset:2048
  buffer_load_dwordx4 v[144:147], v4, s[4:7], s56 offen
  buffer_load_dwordx4 v[148:151], v4, s[4:7], s56 offen offset:2048
  buffer_load_dwordx4 v[152:155], v4, s[4:7], s57 offen
  buffer_load_dwordx4 v[156:159], v4, s[4:7], s57 offen offset:2048
  buffer_load_dwordx4 v[160:163], v4, s[4:7], s58 offen
  buffer_load_dwordx4 v[164:167], v4, s[4:7], s58 offen offset:2048
  buffer_load_dwordx4 v[168:171], v4, s[4:7], s59 offen
  buffer_load_dwordx4 v[172:175], v4, s[4:7], s59 offen offset:2048
  buffer_load_dwordx4 v[176:179], v4, s[4:7], s60 offen
  buffer_load_dwordx4 v[180:183], v4, s[4:7], s60 offen offset:2048
  buffer_load_dwordx4 v[184:187], v4, s[4:7], s61 offen
  buffer_load_dwordx4 v[188:191], v4, s[4:7], s61 offen offset:2048
  buffer_load_dwordx4 v[192:195], v4, s[4:7], s62 offen
  buffer_load_dwordx4 v[196:199], v4, s[4:7], s62 offen offset:2048
  buffer_load_dwordx4 v[200:203], v4, s[4:7], s63 offen
  buffer_load_dwordx4 v[204:207], v4, s[4:7], s63 offen offset:2048
  buffer_load_dwordx4 v[208:211], v4, s[4:7], s64 offen
  buffer_load_dwordx4 v[212:215], v4, s[4:7], s64 offen offset:2048
  buffer_load_dwordx4 v[216:219], v4, s[4:7], s65 offen
  buffer_load_dwordx4 v[220:223], v4, s[4:7], s65 offen offset:2048
  buffer_load_dwordx4 v[224:227], v4, s[4:7], s66 offen
  buffer_load_dwordx4 v[228:231], v4, s[4:7], s66 offen offset:2048
  buffer_load_dwordx4 v[232:235], v4, s[4:7], s67 offen
  buffer_load_dwordx4 v[236:239], v4, s[4:7], s67 offen offset:2048
  s_add_u32 s24, s50, 2359296
  s_addc_u32 s25, s51, 0
  s_and_b32 s25, s25, 0xffff
  s_mov_b32 s26, 2359296
  s_mov_b32 s27, 0x20000
  s_add_u32 s28, s50, 9826304
  s_addc_u32 s29, s51, 0
  s_and_b32 s29, s29, 0xffff
  s_mov_b32 s30, 8192
  s_mov_b32 s31, 0x20000
  s_mov_b32 s68, 0x3f80
  s_mov_b32 s69, 0x3f800000
  s_waitcnt vmcnt(41)
  v_lshlrev_b32 v84, 16, v96
  v_and_b32 v85, 0xffff0000, v96
  v_lshlrev_b32 v86, 16, v97
  v_and_b32 v87, 0xffff0000, v97
  v_lshlrev_b32 v88, 16, v98
  v_and_b32 v89, 0xffff0000, v98
  v_lshlrev_b32 v90, 16, v99
  v_and_b32 v91, 0xffff0000, v99
  s_waitcnt vmcnt(40)
  v_dot2c_f32_bf16 v84, s68, v100
  v_dot2c_f32_bf16 v85, s69, v100
  v_dot2c_f32_bf16 v86, s68, v101
  v_dot2c_f32_bf16 v87, s69, v101
  v_dot2c_f32_bf16 v88, s68, v102
  v_dot2c_f32_bf16 v89, s69, v102
  v_dot2c_f32_bf16 v90, s68, v103
  v_dot2c_f32_bf16 v91, s69, v103
  s_waitcnt vmcnt(39)
  v_dot2c_f32_bf16 v84, s68, v104
  v_dot2c_f32_bf16 v85, s69, v104
  v_dot2c_f32_bf16 v86, s68, v105
  v_dot2c_f32_bf16 v87, s69, v105
  v_dot2c_f32_bf16 v88, s68, v106
  v_dot2c_f32_bf16 v89, s69, v106
  v_dot2c_f32_bf16 v90, s68, v107
  v_dot2c_f32_bf16 v91, s69, v107
  s_waitcnt vmcnt(38)
  v_dot2c_f32_bf16 v84, s68, v108
  v_dot2c_f32_bf16 v85, s69, v108
  v_dot2c_f32_bf16 v86, s68, v109
  v_dot2c_f32_bf16 v87, s69, v109
  v_dot2c_f32_bf16 v88, s68, v110
  v_dot2c_f32_bf16 v89, s69, v110
  v_dot2c_f32_bf16 v90, s68, v111
  v_dot2c_f32_bf16 v91, s69, v111
  ds_write_b128 v35, v[84:87]
  s_nop 1
  ds_write_b128 v35, v[88:91] offset:16
  s_waitcnt vmcnt(37)
  v_add_f32 v38, v38, v39
  s_nop 1
  v_add_f32_dpp v38, v38, v38 row_ror:8 row_mask:0xf bank_mask:0xf
  v_mov_b32 v12, v38
  s_nop 1
  v_permlane16_swap_b32 v38, v12
  v_add_f32 v38, v38, v12
  v_mov_b32 v12, v38
  s_nop 1
  v_permlane32_swap_b32 v38, v12
  v_add_f32 v38, v38, v12
  v_mov_b32 v12, 0x3727c5ac
  v_fmac_f32 v12, 0x3ae38e39, v38
  v_rcp_f32 v38, v12
  s_waitcnt vmcnt(35)
  v_add_f32 v40, v40, v41
  s_waitcnt lgkmcnt(0)
  s_barrier
  ds_read_b64 v[96:97], v36
  ds_read_b64 v[98:99], v36 offset:2048
  ds_read_b64 v[100:101], v36 offset:4096
  ds_read_b64 v[102:103], v36 offset:6144
  s_waitcnt vmcnt(31)
  v_lshlrev_b32 v64, 16, v112
  v_and_b32 v65, 0xffff0000, v112
  v_lshlrev_b32 v66, 16, v113
  v_and_b32 v67, 0xffff0000, v113
  v_lshlrev_b32 v68, 16, v114
  v_and_b32 v69, 0xffff0000, v114
  v_lshlrev_b32 v70, 16, v115
  v_and_b32 v71, 0xffff0000, v115
  s_waitcnt vmcnt(30)
  v_lshlrev_b32 v72, 16, v116
  v_and_b32 v73, 0xffff0000, v116
  v_lshlrev_b32 v74, 16, v117
  v_and_b32 v75, 0xffff0000, v117
  v_lshlrev_b32 v76, 16, v118
  v_and_b32 v77, 0xffff0000, v118
  v_lshlrev_b32 v78, 16, v119
  v_and_b32 v79, 0xffff0000, v119
  s_waitcnt vmcnt(29)
  v_dot2c_f32_bf16 v64, s68, v120
  v_dot2c_f32_bf16 v65, s69, v120
  v_dot2c_f32_bf16 v66, s68, v121
  v_dot2c_f32_bf16 v67, s69, v121
  v_dot2c_f32_bf16 v68, s68, v122
  v_dot2c_f32_bf16 v69, s69, v122
  v_dot2c_f32_bf16 v70, s68, v123
  v_dot2c_f32_bf16 v71, s69, v123
  s_waitcnt vmcnt(28)
  v_dot2c_f32_bf16 v72, s68, v124
  v_dot2c_f32_bf16 v73, s69, v124
  v_dot2c_f32_bf16 v74, s68, v125
  v_dot2c_f32_bf16 v75, s69, v125
  v_dot2c_f32_bf16 v76, s68, v126
  v_dot2c_f32_bf16 v77, s69, v126
  v_dot2c_f32_bf16 v78, s68, v127
  v_dot2c_f32_bf16 v79, s69, v127
  s_waitcnt vmcnt(27)
  v_dot2c_f32_bf16 v64, s68, v128
  v_dot2c_f32_bf16 v65, s69, v128
  v_dot2c_f32_bf16 v66, s68, v129
  v_dot2c_f32_bf16 v67, s69, v129
  v_dot2c_f32_bf16 v68, s68, v130
  v_dot2c_f32_bf16 v69, s69, v130
  v_dot2c_f32_bf16 v70, s68, v131
  v_dot2c_f32_bf16 v71, s69, v131
  s_waitcnt vmcnt(26)
  v_dot2c_f32_bf16 v72, s68, v132
  v_dot2c_f32_bf16 v73, s69, v132
  v_dot2c_f32_bf16 v74, s68, v133
  v_dot2c_f32_bf16 v75, s69, v133
  v_dot2c_f32_bf16 v76, s68, v134
  v_dot2c_f32_bf16 v77, s69, v134
  v_dot2c_f32_bf16 v78, s68, v135
  v_dot2c_f32_bf16 v79, s69, v135
  s_waitcnt vmcnt(25)
  v_dot2c_f32_bf16 v64, s68, v136
  v_dot2c_f32_bf16 v65, s69, v136
  v_dot2c_f32_bf16 v66, s68, v137
  v_dot2c_f32_bf16 v67, s69, v137
  v_dot2c_f32_bf16 v68, s68, v138
  v_dot2c_f32_bf16 v69, s69, v138
  v_dot2c_f32_bf16 v70, s68, v139
  v_dot2c_f32_bf16 v71, s69, v139
  s_waitcnt vmcnt(24)
  v_dot2c_f32_bf16 v72, s68, v140
  v_dot2c_f32_bf16 v73, s69, v140
  v_dot2c_f32_bf16 v74, s68, v141
  v_dot2c_f32_bf16 v75, s69, v141
  v_dot2c_f32_bf16 v76, s68, v142
  v_dot2c_f32_bf16 v77, s69, v142
  v_dot2c_f32_bf16 v78, s68, v143
  v_dot2c_f32_bf16 v79, s69, v143
  s_waitcnt vmcnt(23)
  v_dot2c_f32_bf16 v64, s68, v144
  v_dot2c_f32_bf16 v65, s69, v144
  v_dot2c_f32_bf16 v66, s68, v145
  v_dot2c_f32_bf16 v67, s69, v145
  v_dot2c_f32_bf16 v68, s68, v146
  v_dot2c_f32_bf16 v69, s69, v146
  v_dot2c_f32_bf16 v70, s68, v147
  v_dot2c_f32_bf16 v71, s69, v147
  s_waitcnt vmcnt(22)
  v_dot2c_f32_bf16 v72, s68, v148
  v_dot2c_f32_bf16 v73, s69, v148
  v_dot2c_f32_bf16 v74, s68, v149
  v_dot2c_f32_bf16 v75, s69, v149
  v_dot2c_f32_bf16 v76, s68, v150
  v_dot2c_f32_bf16 v77, s69, v150
  v_dot2c_f32_bf16 v78, s68, v151
  v_dot2c_f32_bf16 v79, s69, v151
  s_waitcnt vmcnt(21)
  v_dot2c_f32_bf16 v64, s68, v152
  v_dot2c_f32_bf16 v65, s69, v152
  v_dot2c_f32_bf16 v66, s68, v153
  v_dot2c_f32_bf16 v67, s69, v153
  v_dot2c_f32_bf16 v68, s68, v154
  v_dot2c_f32_bf16 v69, s69, v154
  v_dot2c_f32_bf16 v70, s68, v155
  v_dot2c_f32_bf16 v71, s69, v155
  s_waitcnt vmcnt(20)
  v_dot2c_f32_bf16 v72, s68, v156
  v_dot2c_f32_bf16 v73, s69, v156
  v_dot2c_f32_bf16 v74, s68, v157
  v_dot2c_f32_bf16 v75, s69, v157
  v_dot2c_f32_bf16 v76, s68, v158
  v_dot2c_f32_bf16 v77, s69, v158
  v_dot2c_f32_bf16 v78, s68, v159
  v_dot2c_f32_bf16 v79, s69, v159
  s_waitcnt vmcnt(19)
  v_dot2c_f32_bf16 v64, s68, v160
  v_dot2c_f32_bf16 v65, s69, v160
  v_dot2c_f32_bf16 v66, s68, v161
  v_dot2c_f32_bf16 v67, s69, v161
  v_dot2c_f32_bf16 v68, s68, v162
  v_dot2c_f32_bf16 v69, s69, v162
  v_dot2c_f32_bf16 v70, s68, v163
  v_dot2c_f32_bf16 v71, s69, v163
  s_waitcnt vmcnt(18)
  v_dot2c_f32_bf16 v72, s68, v164
  v_dot2c_f32_bf16 v73, s69, v164
  v_dot2c_f32_bf16 v74, s68, v165
  v_dot2c_f32_bf16 v75, s69, v165
  v_dot2c_f32_bf16 v76, s68, v166
  v_dot2c_f32_bf16 v77, s69, v166
  v_dot2c_f32_bf16 v78, s68, v167
  v_dot2c_f32_bf16 v79, s69, v167
  s_waitcnt vmcnt(17)
  v_dot2c_f32_bf16 v64, s68, v168
  v_dot2c_f32_bf16 v65, s69, v168
  v_dot2c_f32_bf16 v66, s68, v169
  v_dot2c_f32_bf16 v67, s69, v169
  v_dot2c_f32_bf16 v68, s68, v170
  v_dot2c_f32_bf16 v69, s69, v170
  v_dot2c_f32_bf16 v70, s68, v171
  v_dot2c_f32_bf16 v71, s69, v171
  s_waitcnt vmcnt(16)
  v_dot2c_f32_bf16 v72, s68, v172
  v_dot2c_f32_bf16 v73, s69, v172
  v_dot2c_f32_bf16 v74, s68, v173
  v_dot2c_f32_bf16 v75, s69, v173
  v_dot2c_f32_bf16 v76, s68, v174
  v_dot2c_f32_bf16 v77, s69, v174
  v_dot2c_f32_bf16 v78, s68, v175
  v_dot2c_f32_bf16 v79, s69, v175
  s_waitcnt vmcnt(15)
  v_dot2c_f32_bf16 v64, s68, v176
  v_dot2c_f32_bf16 v65, s69, v176
  v_dot2c_f32_bf16 v66, s68, v177
  v_dot2c_f32_bf16 v67, s69, v177
  v_dot2c_f32_bf16 v68, s68, v178
  v_dot2c_f32_bf16 v69, s69, v178
  v_dot2c_f32_bf16 v70, s68, v179
  v_dot2c_f32_bf16 v71, s69, v179
  s_waitcnt vmcnt(14)
  v_dot2c_f32_bf16 v72, s68, v180
  v_dot2c_f32_bf16 v73, s69, v180
  v_dot2c_f32_bf16 v74, s68, v181
  v_dot2c_f32_bf16 v75, s69, v181
  v_dot2c_f32_bf16 v76, s68, v182
  v_dot2c_f32_bf16 v77, s69, v182
  v_dot2c_f32_bf16 v78, s68, v183
  v_dot2c_f32_bf16 v79, s69, v183
  s_waitcnt vmcnt(13)
  v_dot2c_f32_bf16 v64, s68, v184
  v_dot2c_f32_bf16 v65, s69, v184
  v_dot2c_f32_bf16 v66, s68, v185
  v_dot2c_f32_bf16 v67, s69, v185
  v_dot2c_f32_bf16 v68, s68, v186
  v_dot2c_f32_bf16 v69, s69, v186
  v_dot2c_f32_bf16 v70, s68, v187
  v_dot2c_f32_bf16 v71, s69, v187
  s_waitcnt vmcnt(12)
  v_dot2c_f32_bf16 v72, s68, v188
  v_dot2c_f32_bf16 v73, s69, v188
  v_dot2c_f32_bf16 v74, s68, v189
  v_dot2c_f32_bf16 v75, s69, v189
  v_dot2c_f32_bf16 v76, s68, v190
  v_dot2c_f32_bf16 v77, s69, v190
  v_dot2c_f32_bf16 v78, s68, v191
  v_dot2c_f32_bf16 v79, s69, v191
  s_waitcnt vmcnt(11)
  v_dot2c_f32_bf16 v64, s68, v192
  v_dot2c_f32_bf16 v65, s69, v192
  v_dot2c_f32_bf16 v66, s68, v193
  v_dot2c_f32_bf16 v67, s69, v193
  v_dot2c_f32_bf16 v68, s68, v194
  v_dot2c_f32_bf16 v69, s69, v194
  v_dot2c_f32_bf16 v70, s68, v195
  v_dot2c_f32_bf16 v71, s69, v195
  s_waitcnt vmcnt(10)
  v_dot2c_f32_bf16 v72, s68, v196
  v_dot2c_f32_bf16 v73, s69, v196
  v_dot2c_f32_bf16 v74, s68, v197
  v_dot2c_f32_bf16 v75, s69, v197
  v_dot2c_f32_bf16 v76, s68, v198
  v_dot2c_f32_bf16 v77, s69, v198
  v_dot2c_f32_bf16 v78, s68, v199
  v_dot2c_f32_bf16 v79, s69, v199
  s_waitcnt vmcnt(9)
  v_dot2c_f32_bf16 v64, s68, v200
  v_dot2c_f32_bf16 v65, s69, v200
  v_dot2c_f32_bf16 v66, s68, v201
  v_dot2c_f32_bf16 v67, s69, v201
  v_dot2c_f32_bf16 v68, s68, v202
  v_dot2c_f32_bf16 v69, s69, v202
  v_dot2c_f32_bf16 v70, s68, v203
  v_dot2c_f32_bf16 v71, s69, v203
  s_waitcnt vmcnt(8)
  v_dot2c_f32_bf16 v72, s68, v204
  v_dot2c_f32_bf16 v73, s69, v204
  v_dot2c_f32_bf16 v74, s68, v205
  v_dot2c_f32_bf16 v75, s69, v205
  v_dot2c_f32_bf16 v76, s68, v206
  v_dot2c_f32_bf16 v77, s69, v206
  v_dot2c_f32_bf16 v78, s68, v207
  v_dot2c_f32_bf16 v79, s69, v207
  s_waitcnt vmcnt(7)
  v_dot2c_f32_bf16 v64, s68, v208
  v_dot2c_f32_bf16 v65, s69, v208
  v_dot2c_f32_bf16 v66, s68, v209
  v_dot2c_f32_bf16 v67, s69, v209
  v_dot2c_f32_bf16 v68, s68, v210
  v_dot2c_f32_bf16 v69, s69, v210
  v_dot2c_f32_bf16 v70, s68, v211
  v_dot2c_f32_bf16 v71, s69, v211
  s_waitcnt vmcnt(6)
  v_dot2c_f32_bf16 v72, s68, v212
  v_dot2c_f32_bf16 v73, s69, v212
  v_dot2c_f32_bf16 v74, s68, v213
  v_dot2c_f32_bf16 v75, s69, v213
  v_dot2c_f32_bf16 v76, s68, v214
  v_dot2c_f32_bf16 v77, s69, v214
  v_dot2c_f32_bf16 v78, s68, v215
  v_dot2c_f32_bf16 v79, s69, v215
  s_waitcnt vmcnt(5)
  v_dot2c_f32_bf16 v64, s68, v216
  v_dot2c_f32_bf16 v65, s69, v216
  v_dot2c_f32_bf16 v66, s68, v217
  v_dot2c_f32_bf16 v67, s69, v217
  v_dot2c_f32_bf16 v68, s68, v218
  v_dot2c_f32_bf16 v69, s69, v218
  v_dot2c_f32_bf16 v70, s68, v219
  v_dot2c_f32_bf16 v71, s69, v219
  s_waitcnt vmcnt(4)
  v_dot2c_f32_bf16 v72, s68, v220
  v_dot2c_f32_bf16 v73, s69, v220
  v_dot2c_f32_bf16 v74, s68, v221
  v_dot2c_f32_bf16 v75, s69, v221
  v_dot2c_f32_bf16 v76, s68, v222
  v_dot2c_f32_bf16 v77, s69, v222
  v_dot2c_f32_bf16 v78, s68, v223
  v_dot2c_f32_bf16 v79, s69, v223
  s_waitcnt vmcnt(3)
  v_dot2c_f32_bf16 v64, s68, v224
  v_dot2c_f32_bf16 v65, s69, v224
  v_dot2c_f32_bf16 v66, s68, v225
  v_dot2c_f32_bf16 v67, s69, v225
  v_dot2c_f32_bf16 v68, s68, v226
  v_dot2c_f32_bf16 v69, s69, v226
  v_dot2c_f32_bf16 v70, s68, v227
  v_dot2c_f32_bf16 v71, s69, v227
  s_waitcnt vmcnt(2)
  v_dot2c_f32_bf16 v72, s68, v228
  v_dot2c_f32_bf16 v73, s69, v228
  v_dot2c_f32_bf16 v74, s68, v229
  v_dot2c_f32_bf16 v75, s69, v229
  v_dot2c_f32_bf16 v76, s68, v230
  v_dot2c_f32_bf16 v77, s69, v230
  v_dot2c_f32_bf16 v78, s68, v231
  v_dot2c_f32_bf16 v79, s69, v231
  s_waitcnt vmcnt(1)
  v_dot2c_f32_bf16 v64, s68, v232
  v_dot2c_f32_bf16 v65, s69, v232
  v_dot2c_f32_bf16 v66, s68, v233
  v_dot2c_f32_bf16 v67, s69, v233
  v_dot2c_f32_bf16 v68, s68, v234
  v_dot2c_f32_bf16 v69, s69, v234
  v_dot2c_f32_bf16 v70, s68, v235
  v_dot2c_f32_bf16 v71, s69, v235
  s_waitcnt vmcnt(0)
  v_dot2c_f32_bf16 v72, s68, v236
  v_dot2c_f32_bf16 v73, s69, v236
  v_dot2c_f32_bf16 v74, s68, v237
  v_dot2c_f32_bf16 v75, s69, v237
  v_dot2c_f32_bf16 v76, s68, v238
  v_dot2c_f32_bf16 v77, s69, v238
  v_dot2c_f32_bf16 v78, s68, v239
  v_dot2c_f32_bf16 v79, s69, v239
  s_waitcnt lgkmcnt(2)
  v_add_f32 v96, v96, v98
  s_waitcnt lgkmcnt(0)
  v_add_f32 v100, v100, v102
  v_add_f32 v80, v96, v100
  v_add_f32 v97, v97, v99
  v_add_f32 v101, v101, v103
  v_add_f32 v81, v97, v101
  v_lshlrev_b32 v54, 16, v44
  v_and_b32 v55, 0xffff0000, v44
  v_fma_f32 v64, v64, v38, v54
  v_fma_f32 v65, v65, v38, v55
  v_lshlrev_b32 v54, 16, v45
  v_and_b32 v55, 0xffff0000, v45
  v_fma_f32 v66, v66, v38, v54
  v_fma_f32 v67, v67, v38, v55
  v_lshlrev_b32 v54, 16, v46
  v_and_b32 v55, 0xffff0000, v46
  v_fma_f32 v68, v68, v38, v54
  v_fma_f32 v69, v69, v38, v55
  v_lshlrev_b32 v54, 16, v47
  v_and_b32 v55, 0xffff0000, v47
  v_fma_f32 v70, v70, v38, v54
  v_fma_f32 v71, v71, v38, v55
  v_lshlrev_b32 v54, 16, v48
  v_and_b32 v55, 0xffff0000, v48
  v_fma_f32 v72, v72, v38, v54
  v_fma_f32 v73, v73, v38, v55
  v_lshlrev_b32 v54, 16, v49
  v_and_b32 v55, 0xffff0000, v49
  v_fma_f32 v74, v74, v38, v54
  v_fma_f32 v75, v75, v38, v55
  v_lshlrev_b32 v54, 16, v50
  v_and_b32 v55, 0xffff0000, v50
  v_fma_f32 v76, v76, v38, v54
  v_fma_f32 v77, v77, v38, v55
  v_lshlrev_b32 v54, 16, v51
  v_and_b32 v55, 0xffff0000, v51
  v_fma_f32 v78, v78, v38, v54
  v_fma_f32 v79, v79, v38, v55
  v_lshlrev_b32 v54, 16, v52
  v_and_b32 v55, 0xffff0000, v52
  v_fma_f32 v80, v80, v38, v54
  v_fma_f32 v81, v81, v38, v55
  v_add_f32 v14, v64, v65
  v_add_f32 v15, v66, v67
  v_add_f32 v14, v14, v68
  v_add_f32 v15, v15, v69
  v_add_f32 v14, v14, v70
  v_add_f32 v15, v15, v71
  v_add_f32 v14, v14, v72
  v_add_f32 v15, v15, v73
  v_add_f32 v14, v14, v74
  v_add_f32 v15, v15, v75
  v_add_f32 v14, v14, v76
  v_add_f32 v15, v15, v77
  v_add_f32 v14, v14, v78
  v_add_f32 v15, v15, v79
  v_add_f32 v14, v14, v80
  v_add_f32 v15, v15, v81
  v_add_f32 v14, v14, v15
  s_nop 1
  v_add_f32_dpp v14, v14, v14 row_ror:8 row_mask:0xf bank_mask:0xf
  v_mov_b32 v15, v14
  s_nop 1
  v_permlane16_swap_b32 v14, v15
  v_add_f32 v14, v14, v15
  v_mov_b32 v15, v14
  s_nop 1
  v_permlane32_swap_b32 v14, v15
  v_add_f32 v14, v14, v15
  ds_write_b32 v9, v14
  s_waitcnt lgkmcnt(0)
  s_barrier
  ds_read_b128 v[16:19], v10
  s_waitcnt lgkmcnt(0)
  v_add_f32 v16, v16, v17
  v_add_f32 v18, v18, v19
  v_add_f32 v14, v16, v18
  v_mul_f32 v14, 0x3ae38e39, v14
  v_sub_f32 v64, v64, v14
  v_sub_f32 v65, v65, v14
  v_sub_f32 v66, v66, v14
  v_sub_f32 v67, v67, v14
  v_sub_f32 v68, v68, v14
  v_sub_f32 v69, v69, v14
  v_sub_f32 v70, v70, v14
  v_sub_f32 v71, v71, v14
  v_sub_f32 v72, v72, v14
  v_sub_f32 v73, v73, v14
  v_sub_f32 v74, v74, v14
  v_sub_f32 v75, v75, v14
  v_sub_f32 v76, v76, v14
  v_sub_f32 v77, v77, v14
  v_sub_f32 v78, v78, v14
  v_sub_f32 v79, v79, v14
  v_sub_f32 v80, v80, v14
  v_sub_f32 v81, v81, v14
  v_mul_f32 v20, v64, v64
  v_mul_f32 v21, v65, v65
  v_fmac_f32 v20, v66, v66
  v_fmac_f32 v21, v67, v67
  v_fmac_f32 v20, v68, v68
  v_fmac_f32 v21, v69, v69
  v_fmac_f32 v20, v70, v70
  v_fmac_f32 v21, v71, v71
  v_fmac_f32 v20, v72, v72
  v_fmac_f32 v21, v73, v73
  v_fmac_f32 v20, v74, v74
  v_fmac_f32 v21, v75, v75
  v_fmac_f32 v20, v76, v76
  v_fmac_f32 v21, v77, v77
  v_fmac_f32 v20, v78, v78
  v_fmac_f32 v21, v79, v79
  v_fmac_f32 v20, v80, v80
  v_fmac_f32 v21, v81, v81
  v_add_f32 v20, v20, v21
  v_cvt_pk_bf16_f32 v24, v64, v65
  v_cvt_pk_bf16_f32 v25, v66, v67
  v_cvt_pk_bf16_f32 v26, v68, v69
  v_cvt_pk_bf16_f32 v27, v70, v71
  v_cvt_pk_bf16_f32 v28, v72, v73
  v_cvt_pk_bf16_f32 v29, v74, v75
  v_cvt_pk_bf16_f32 v30, v76, v77
  v_cvt_pk_bf16_f32 v31, v78, v79
  v_cvt_pk_bf16_f32 v32, v80, v81
  buffer_store_dwordx4 v[24:27], v4, s[24:27], 0 offen
  buffer_store_dwordx4 v[28:31], v4, s[24:27], 0 offen offset:2048
  buffer_store_dword v32, v5, s[24:27], 0 offen
  v_add_f32_dpp v20, v20, v20 row_ror:8 row_mask:0xf bank_mask:0xf
  v_mov_b32 v15, v20
  s_nop 1
  v_permlane16_swap_b32 v20, v15
  v_add_f32 v20, v20, v15
  v_mov_b32 v15, v20
  s_nop 1
  v_permlane32_swap_b32 v20, v15
  v_add_f32 v20, v20, v15
  ds_write_b32 v9, v20 offset:128
  s_waitcnt lgkmcnt(0)
  s_barrier
  ds_read_b128 v[16:19], v10 offset:128
  s_waitcnt lgkmcnt(0)
  v_add_f32 v16, v16, v17
  v_add_f32 v18, v18, v19
  v_add_f32 v20, v16, v18
  v_mov_b32 v15, 0x3727c5ac
  v_fmac_f32 v15, 0x3ae38e39, v20
  v_rsq_f32 v15, v15
  v_add_f32 v14, v14, v40
  v_cmp_gt_u32 vcc, 8, v0
  s_nop 1
  v_cndmask_b32 v22, v11, v8, vcc
  buffer_store_dword v15, v22, s[28:31], 0 offen
  buffer_store_dword v14, v22, s[16:19], 0 offen
L_b2_kernel_end:
  s_endpgm
.globl a1_kernel
.p2align 8
.type a1_kernel,@function
a1_kernel:
  s_cmp_ge_u32 s2, 256
  s_cbranch_scc1 L_a1_kernel_end
  s_load_dwordx2 s[54:55], s[0:1], 72
  v_lshrrev_b32 v23, 6, v0
  v_and_b32 v20, 63, v0
  v_readfirstlane_b32 s32, v23
  v_and_b32 v21, 15, v20
  v_lshrrev_b32 v22, 4, v20
  v_lshlrev_b32 v1, 4, v20
  v_add_u32 v2, 65536, v1
  s_and_b32 s33, s2, 7
  s_lshl_b32 s33, s33, 1
  s_lshr_b32 s36, s2, 7
  s_add_u32 s33, s33, s36
  s_bfe_u32 s34, s2, 262147
  s_lshl_b32 s35, s32, 12
  s_lshl_b32 s36, s32, 10
  v_add_u32 v3, s36, v1
  v_add_u32 v4, 65536, v3
  s_mul_i32 s36, s34, 129024
  s_add_u32 s36, s36, s35
  v_add_u32 v7, s36, v1
  s_lshl_b32 s36, s33, 3
  s_max_u32 s37, s36, 1
  s_sub_u32 s37, s37, 1
  s_lshl_b32 s38, s32, 1
  s_add_u32 s36, s36, s38
  v_lshlrev_b32 v23, 2, v21
  s_lshl_b32 s38, s37, 6
  v_add_u32 v8, s38, v23
  s_lshl_b32 s38, s36, 6
  v_add_u32 v9, s38, v23
  s_mul_i32 s37, s37, 18432
  v_add_u32 v5, s37, v1
  s_mul_i32 s36, s36, 18432
  v_add_u32 v6, s36, v1
  s_mov_b32 s44, 0
  s_mov_b32 s49, 18432
  s_mov_b32 s45, 4096
  s_mov_b32 s50, 22528
  s_mov_b32 s46, 8192
  s_mov_b32 s51, 26624
  s_mov_b32 s47, 12288
  s_mov_b32 s52, 30720
  s_mov_b32 s48, 16384
  s_mov_b32 s53, 34816
  s_waitcnt lgkmcnt(0)
  s_add_u32 s8, s54, 7077888
  s_addc_u32 s9, s55, 0
  s_and_b32 s9, s9, 0xffff
  s_mov_b32 s10, 2064384
  s_mov_b32 s11, 0x20000
  s_add_u32 s4, s54, 2359296
  s_addc_u32 s5, s55, 0
  s_and_b32 s5, s5, 0xffff
  s_mov_b32 s6, 2359296
  s_mov_b32 s7, 0x20000
  s_add_u32 s12, s54, 9826304
  s_addc_u32 s13, s55, 0
  s_and_b32 s13, s13, 0xffff
  s_mov_b32 s14, 8192
  s_mov_b32 s15, 0x20000
  s_add_u32 m0, s35, 0
  s_mov_b32 s40, 0
  buffer_load_dwordx4 v7, s[8:11], s40 offen lds
  buffer_load_dwordx4 v7, s[8:11], s40 offen offset:1024 lds
  buffer_load_dwordx4 v7, s[8:11], s40 offen offset:2048 lds
  buffer_load_dwordx4 v7, s[8:11], s40 offen offset:3072 lds
  buffer_load_dwordx4 a[72:75], v6, s[4:7], s44 offen
  buffer_load_dwordx4 a[144:147], v6, s[4:7], s49 offen
  buffer_load_dwordx4 a[0:3], v5, s[4:7], s44 offen
  s_add_u32 m0, s35, 16384
  s_mov_b32 s40, 16384
  buffer_load_dwordx4 v7, s[8:11], s40 offen lds
  buffer_load_dwordx4 v7, s[8:11], s40 offen offset:1024 lds
  buffer_load_dwordx4 v7, s[8:11], s40 offen offset:2048 lds
  buffer_load_dwordx4 v7, s[8:11], s40 offen offset:3072 lds
  buffer_load_dwordx4 a[76:79], v6, s[4:7], s44 offen offset:1024
  buffer_load_dwordx4 a[148:151], v6, s[4:7], s49 offen offset:1024
  buffer_load_dwordx4 a[4:7], v5, s[4:7], s44 offen offset:1024
  buffer_load_dwordx4 a[80:83], v6, s[4:7], s44 offen offset:2048
  buffer_load_dwordx4 a[152:155], v6, s[4:7], s49 offen offset:2048
  buffer_load_dwordx4 a[8:11], v5, s[4:7], s44 offen offset:2048
  buffer_load_dword v10, v9, s[12:15], 0 offen offset:64
  buffer_load_dword v8, v8, s[12:15], 0 offen
  buffer_load_dword v9, v9, s[12:15], 0 offen
  s_add_u32 s16, s54, 4718592
  s_addc_u32 s17, s55, 0
  s_and_b32 s17, s17, 0xffff
  s_mov_b32 s18, 2359296
  s_mov_b32 s19, 0x20000
  v_mul_u32_u24 v23, 240, v21
  v_lshl_add_u32 v23, v22, 3, v23
  v_add_u32 v12, 129152, v23
  s_lshl_b32 s36, s32, 5
  s_add_u32 s37, s36, 129024
  v_add_u32 v11, s37, v23
  s_mul_i32 s36, s36, 240
  s_add_u32 s36, s36, 132864
  v_add_u32 v13, s36, v23
  s_and_b32 s39, s32, 1
  s_lshr_b32 s36, s32, 1
  s_lshl_b32 s36, s36, 6
  v_add_u32 v23, s36, v20
  v_mul_u32_u24 v24, 240, v23
  s_mul_i32 s37, s39, 80
  s_add_u32 s37, s37, 129504
  v_add_u32 v14, s37, v24
  s_mul_i32 s37, s39, 36
  s_add_u32 s37, s37, 133016
  v_add_u32 v15, s37, v24
  s_lshl_b32 s37, s33, 7
  v_add_u32 v23, s37, v23
  v_cmp_le_u32 s[60:61], 2, v23
  v_cmp_le_u32 s[62:63], 4, v23
  v_cmp_le_u32 s[64:65], 6, v23
  v_cmp_le_u32 s[66:67], 8, v23
  v_cmp_le_u32 s[68:69], 10, v23
  v_cmp_le_u32 s[70:71], 12, v23
  v_cmp_le_u32 s[72:73], 14, v23
  v_lshrrev_b32 v24, 4, v23
  v_mul_u32_u24 v24, 18432, v24
  v_lshl_add_u32 v24, v21, 4, v24
  s_lshl_b32 s37, s34, 1
  s_add_u32 s37, s37, s39
  s_lshl_b32 s37, s37, 9
  v_add_u32 v16, s37, v24
  s_lshr_b32 s37, s34, 1
  s_add_u32 s37, s37, 64
  s_lshl_b32 s37, s37, 8
  s_and_b32 s38, s34, 1
  s_lshl_b32 s38, s38, 3
  s_add_u32 s37, s37, s38
  s_lshl_b32 s38, s39, 2
  s_add_u32 s37, s37, s38
  v_add_u32 v17, s37, v24
  v_mov_b32 v18, 0xceabfb8f
  s_mov_b32 s74, 0x05040100
  s_mov_b32 s75, 0x07060302
  s_mov_b32 s76, 0x3f803f80
  s_waitcnt vmcnt(16)
  s_barrier
  ds_read_b128 v[32:35], v1
  ds_read_b128 v[36:39], v1 offset:1024
  ds_read_b128 v[40:43], v1 offset:2048
  ds_read_b128 v[44:47], v1 offset:3072
  ds_read_b128 v[48:51], v1 offset:4096
  ds_read_b128 v[52:55], v1 offset:5120
  ds_read_b128 v[56:59], v1 offset:6144
  ds_read_b128 v[60:63], v3
  s_waitcnt vmcnt(15) lgkmcnt(7)
  v_mfma_f32_16x16x32_bf16 v[96:99], v[32:35], a[72:75], 0
  ds_read_b128 v[64:67], v1 offset:7168
  s_waitcnt vmcnt(14)
  v_mfma_f32_16x16x32_bf16 v[124:127], v[32:35], a[144:147], 0
  ds_read_b128 v[68:71], v1 offset:8192
  s_waitcnt lgkmcnt(8)
  v_mfma_f32_16x16x32_bf16 v[100:103], v[36:39], a[72:75], 0
  ds_read_b128 v[72:75], v1 offset:9216
  v_mfma_f32_16x16x32_bf16 v[128:131], v[36:39], a[144:147], 0
  ds_read_b128 v[76:79], v1 offset:10240
  s_waitcnt lgkmcnt(9)
  v_mfma_f32_16x16x32_bf16 v[104:107], v[40:43], a[72:75], 0
  ds_read_b128 v[80:83], v1 offset:11264
  v_mfma_f32_16x16x32_bf16 v[132:135], v[40:43], a[144:147], 0
  ds_read_b128 v[84:87], v1 offset:12288
  s_waitcnt lgkmcnt(10)
  v_mfma_f32_16x16x32_bf16 v[108:111], v[44:47], a[72:75], 0
  ds_read_b128 v[88:91], v1 offset:13312
  v_mfma_f32_16x16x32_bf16 v[136:139], v[44:47], a[144:147], 0
  ds_read_b128 v[92:95], v3 offset:7168
  s_waitcnt lgkmcnt(11)
  v_mfma_f32_16x16x32_bf16 v[112:115], v[48:51], a[72:75], 0
  s_add_u32 m0, s35, 32768
  s_mov_b32 s40, 32768
  v_mfma_f32_16x16x32_bf16 v[140:143], v[48:51], a[144:147], 0
  buffer_load_dwordx4 v7, s[8:11], s40 offen lds
  s_waitcnt lgkmcnt(10)
  v_mfma_f32_16x16x32_bf16 v[116:119], v[52:55], a[72:75], 0
  buffer_load_dwordx4 v7, s[8:11], s40 offen offset:1024 lds
  v_mfma_f32_16x16x32_bf16 v[144:147], v[52:55], a[144:147], 0
  buffer_load_dwordx4 v7, s[8:11], s40 offen offset:2048 lds
  s_waitcnt lgkmcnt(9)
  v_mfma_f32_16x16x32_bf16 v[120:123], v[56:59], a[72:75], 0
  buffer_load_dwordx4 v7, s[8:11], s40 offen offset:3072 lds
  v_mfma_f32_16x16x32_bf16 v[148:151], v[56:59], a[144:147], 0
  buffer_load_dwordx4 a[84:87], v6, s[4:7], s44 offen offset:3072
  s_waitcnt vmcnt(18) lgkmcnt(8)
  v_mfma_f32_16x16x32_bf16 v[152:155], v[60:63], a[0:3], 0
  buffer_load_dwordx4 a[156:159], v6, s[4:7], s49 offen offset:3072
  v_mfma_f32_16x16x32_bf16 v[156:159], v[48:51], a[0:3], 0
  buffer_load_dwordx4 a[12:15], v5, s[4:7], s44 offen offset:3072
  s_waitcnt vmcnt(15) lgkmcnt(7)
  v_mfma_f32_16x16x32_bf16 v[96:99], v[64:67], a[76:79], v[96:99]
  s_barrier
  s_waitcnt vmcnt(14)
  v_mfma_f32_16x16x32_bf16 v[124:127], v[64:67], a[148:151], v[124:127]
  ds_read_b128 v[32:35], v1 offset:14336
  s_waitcnt lgkmcnt(7)
  v_mfma_f32_16x16x32_bf16 v[100:103], v[68:71], a[76:79], v[100:103]
  ds_read_b128 v[36:39], v1 offset:15360
  v_mfma_f32_16x16x32_bf16 v[128:131], v[68:71], a[148:151], v[128:131]
  ds_read_b128 v[40:43], v1 offset:16384
  s_waitcnt lgkmcnt(8)
  v_mfma_f32_16x16x32_bf16 v[104:107], v[72:75], a[76:79], v[104:107]
  ds_read_b128 v[44:47], v1 offset:17408
  v_mfma_f32_16x16x32_bf16 v[132:135], v[72:75], a[148:151], v[132:135]
  ds_read_b128 v[48:51], v1 offset:18432
  s_waitcnt lgkmcnt(9)
  v_mfma_f32_16x16x32_bf16 v[108:111], v[76:79], a[76:79], v[108:111]
  ds_read_b128 v[52:55], v1 offset:19456
  v_mfma_f32_16x16x32_bf16 v[136:139], v[76:79], a[148:151], v[136:139]
  ds_read_b128 v[56:59], v1 offset:20480
  s_waitcnt lgkmcnt(10)
  v_mfma_f32_16x16x32_bf16 v[112:115], v[80:83], a[76:79], v[112:115]
  ds_read_b128 v[60:63], v3 offset:14336
  v_mfma_f32_16x16x32_bf16 v[140:143], v[80:83], a[148:151], v[140:143]
  buffer_load_dwordx4 a[88:91], v6, s[4:7], s45 offen
  s_waitcnt lgkmcnt(10)
  v_mfma_f32_16x16x32_bf16 v[116:119], v[84:87], a[76:79], v[116:119]
  buffer_load_dwordx4 a[160:163], v6, s[4:7], s50 offen
  v_mfma_f32_16x16x32_bf16 v[144:147], v[84:87], a[148:151], v[144:147]
  buffer_load_dwordx4 a[16:19], v5, s[4:7], s45 offen
  s_waitcnt lgkmcnt(9)
  v_mfma_f32_16x16x32_bf16 v[120:123], v[88:91], a[76:79], v[120:123]
  v_mfma_f32_16x16x32_bf16 v[148:151], v[88:91], a[148:151], v[148:151]
  s_waitcnt vmcnt(16) lgkmcnt(8)
  v_mfma_f32_16x16x32_bf16 v[152:155], v[92:95], a[4:7], v[152:155]
  v_mfma_f32_16x16x32_bf16 v[156:159], v[80:83], a[4:7], v[156:159]
  s_waitcnt vmcnt(15) lgkmcnt(7)
  v_mfma_f32_16x16x32_bf16 v[96:99], v[32:35], a[80:83], v[96:99]
  ds_read_b128 v[64:67], v1 offset:21504
  s_waitcnt vmcnt(14)
  v_mfma_f32_16x16x32_bf16 v[124:127], v[32:35], a[152:155], v[124:127]
  ds_read_b128 v[68:71], v1 offset:22528
  s_waitcnt lgkmcnt(8)
  v_mfma_f32_16x16x32_bf16 v[100:103], v[36:39], a[80:83], v[100:103]
  ds_read_b128 v[72:75], v1 offset:23552
  v_mfma_f32_16x16x32_bf16 v[128:131], v[36:39], a[152:155], v[128:131]
  ds_read_b128 v[76:79], v1 offset:24576
  s_waitcnt lgkmcnt(9)
  v_mfma_f32_16x16x32_bf16 v[104:107], v[40:43], a[80:83], v[104:107]
  ds_read_b128 v[80:83], v1 offset:25600
  v_mfma_f32_16x16x32_bf16 v[132:135], v[40:43], a[152:155], v[132:135]
  ds_read_b128 v[84:87], v1 offset:26624
  s_waitcnt lgkmcnt(10)
  v_mfma_f32_16x16x32_bf16 v[108:111], v[44:47], a[80:83], v[108:111]
  ds_read_b128 v[88:91], v1 offset:27648
  v_mfma_f32_16x16x32_bf16 v[136:139], v[44:47], a[152:155], v[136:139]
  ds_read_b128 v[92:95], v3 offset:21504
  s_waitcnt lgkmcnt(11)
  v_mfma_f32_16x16x32_bf16 v[112:115], v[48:51], a[80:83], v[112:115]
  s_add_u32 m0, s35, 49152
  s_mov_b32 s40, 49152
  v_mfma_f32_16x16x32_bf16 v[140:143], v[48:51], a[152:155], v[140:143]
  buffer_load_dwordx4 v7, s[8:11], s40 offen lds
  s_waitcnt lgkmcnt(10)
  v_mfma_f32_16x16x32_bf16 v[116:119], v[52:55], a[80:83], v[116:119]
  buffer_load_dwordx4 v7, s[8:11], s40 offen offset:1024 lds
  v_mfma_f32_16x16x32_bf16 v[144:147], v[52:55], a[152:155], v[144:147]
  buffer_load_dwordx4 v7, s[8:11], s40 offen offset:2048 lds
  s_waitcnt lgkmcnt(9)
  v_mfma_f32_16x16x32_bf16 v[120:123], v[56:59], a[80:83], v[120:123]
  buffer_load_dwordx4 v7, s[8:11], s40 offen offset:3072 lds
  v_mfma_f32_16x16x32_bf16 v[148:151], v[56:59], a[152:155], v[148:151]
  buffer_load_dwordx4 a[92:95], v6, s[4:7], s45 offen offset:1024
  s_waitcnt vmcnt(18) lgkmcnt(8)
  v_mfma_f32_16x16x32_bf16 v[152:155], v[60:63], a[8:11], v[152:155]
  buffer_load_dwordx4 a[164:167], v6, s[4:7], s50 offen offset:1024
  v_mfma_f32_16x16x32_bf16 v[156:159], v[48:51], a[8:11], v[156:159]
  buffer_load_dwordx4 a[20:23], v5, s[4:7], s45 offen offset:1024
  s_waitcnt vmcnt(12) lgkmcnt(7)
  v_mfma_f32_16x16x32_bf16 v[96:99], v[64:67], a[84:87], v[96:99]
  s_barrier
  s_waitcnt vmcnt(11)
  v_mfma_f32_16x16x32_bf16 v[124:127], v[64:67], a[156:159], v[124:127]
  ds_read_b128 v[32:35], v1 offset:28672
  s_waitcnt lgkmcnt(7)
  v_mfma_f32_16x16x32_bf16 v[100:103], v[68:71], a[84:87], v[100:103]
  ds_read_b128 v[36:39], v1 offset:29696
  v_mfma_f32_16x16x32_bf16 v[128:131], v[68:71], a[156:159], v[128:131]
  ds_read_b128 v[40:43], v1 offset:30720
  s_waitcnt lgkmcnt(8)
  v_mfma_f32_16x16x32_bf16 v[104:107], v[72:75], a[84:87], v[104:107]
  ds_read_b128 v[44:47], v1 offset:31744
  v_mfma_f32_16x16x32_bf16 v[132:135], v[72:75], a[156:159], v[132:135]
  ds_read_b128 v[48:51], v1 offset:32768
  s_waitcnt lgkmcnt(9)
  v_mfma_f32_16x16x32_bf16 v[108:111], v[76:79], a[84:87], v[108:111]
  ds_read_b128 v[52:55], v1 offset:33792
  v_mfma_f32_16x16x32_bf16 v[136:139], v[76:79], a[156:159], v[136:139]
  ds_read_b128 v[56:59], v1 offset:34816
  s_waitcnt lgkmcnt(10)
  v_mfma_f32_16x16x32_bf16 v[112:115], v[80:83], a[84:87], v[112:115]
  ds_read_b128 v[60:63], v3 offset:28672
  v_mfma_f32_16x16x32_bf16 v[140:143], v[80:83], a[156:159], v[140:143]
  buffer_load_dwordx4 a[96:99], v6, s[4:7], s45 offen offset:2048
  s_waitcnt lgkmcnt(10)
  v_mfma_f32_16x16x32_bf16 v[116:119], v[84:87], a[84:87], v[116:119]
  buffer_load_dwordx4 a[168:171], v6, s[4:7], s50 offen offset:2048
  v_mfma_f32_16x16x32_bf16 v[144:147], v[84:87], a[156:159], v[144:147]
  buffer_load_dwordx4 a[24:27], v5, s[4:7], s45 offen offset:2048
  s_waitcnt lgkmcnt(9)
  v_mfma_f32_16x16x32_bf16 v[120:123], v[88:91], a[84:87], v[120:123]
  v_mfma_f32_16x16x32_bf16 v[148:151], v[88:91], a[156:159], v[148:151]
  s_waitcnt vmcnt(13) lgkmcnt(8)
  v_mfma_f32_16x16x32_bf16 v[152:155], v[92:95], a[12:15], v[152:155]
  v_mfma_f32_16x16x32_bf16 v[156:159], v[80:83], a[12:15], v[156:159]
  s_waitcnt vmcnt(12) lgkmcnt(7)
  v_mfma_f32_16x16x32_bf16 v[96:99], v[32:35], a[88:91], v[96:99]
  ds_read_b128 v[64:67], v1 offset:35840
  s_waitcnt vmcnt(11)
  v_mfma_f32_16x16x32_bf16 v[124:127], v[32:35], a[160:163], v[124:127]
  ds_read_b128 v[68:71], v1 offset:36864
  s_waitcnt lgkmcnt(8)
  v_mfma_f32_16x16x32_bf16 v[100:103], v[36:39], a[88:91], v[100:103]
  ds_read_b128 v[72:75], v1 offset:37888
  v_mfma_f32_16x16x32_bf16 v[128:131], v[36:39], a[160:163], v[128:131]
  ds_read_b128 v[76:79], v1 offset:38912
  s_waitcnt lgkmcnt(9)
  v_mfma_f32_16x16x32_bf16 v[104:107], v[40:43], a[88:91], v[104:107]
  ds_read_b128 v[80:83], v1 offset:39936
  v_mfma_f32_16x16x32_bf16 v[132:135], v[40:43], a[160:163], v[132:135]
  ds_read_b128 v[84:87], v1 offset:40960
  s_waitcnt lgkmcnt(10)
  v_mfma_f32_16x16x32_bf16 v[108:111], v[44:47], a[88:91], v[108:111]
  ds_read_b128 v[88:91], v1 offset:41984
  v_mfma_f32_16x16x32_bf16 v[136:139], v[44:47], a[160:163], v[136:139]
  ds_read_b128 v[92:95], v3 offset:35840
  s_waitcnt lgkmcnt(11)
  v_mfma_f32_16x16x32_bf16 v[112:115], v[48:51], a[88:91], v[112:115]
  buffer_load_dwordx4 a[100:103], v6, s[4:7], s45 offen offset:3072
  v_mfma_f32_16x16x32_bf16 v[140:143], v[48:51], a[160:163], v[140:143]
  buffer_load_dwordx4 a[172:175], v6, s[4:7], s50 offen offset:3072
  s_waitcnt lgkmcnt(10)
  v_mfma_f32_16x16x32_bf16 v[116:119], v[52:55], a[88:91], v[116:119]
  buffer_load_dwordx4 a[28:31], v5, s[4:7], s45 offen offset:3072
  v_mfma_f32_16x16x32_bf16 v[144:147], v[52:55], a[160:163], v[144:147]
  s_waitcnt lgkmcnt(9)
  v_mfma_f32_16x16x32_bf16 v[120:123], v[56:59], a[88:91], v[120:123]
  v_mfma_f32_16x16x32_bf16 v[148:151], v[56:59], a[160:163], v[148:151]
  s_waitcnt vmcnt(13) lgkmcnt(8)
  v_mfma_f32_16x16x32_bf16 v[152:155], v[60:63], a[16:19], v[152:155]
  v_mfma_f32_16x16x32_bf16 v[156:159], v[48:51], a[16:19], v[156:159]
  s_waitcnt vmcnt(8) lgkmcnt(7)
  v_mfma_f32_16x16x32_bf16 v[96:99], v[64:67], a[92:95], v[96:99]
  s_barrier
  s_waitcnt vmcnt(7)
  v_mfma_f32_16x16x32_bf16 v[124:127], v[64:67], a[164:167], v[124:127]
  ds_read_b128 v[32:35], v1 offset:43008
  s_waitcnt lgkmcnt(7)
  v_mfma_f32_16x16x32_bf16 v[100:103], v[68:71], a[92:95], v[100:103]
  ds_read_b128 v[36:39], v1 offset:44032
  v_mfma_f32_16x16x32_bf16 v[128:131], v[68:71], a[164:167], v[128:131]
  ds_read_b128 v[40:43], v1 offset:45056
  s_waitcnt lgkmcnt(8)
  v_mfma_f32_16x16x32_bf16 v[104:107], v[72:75], a[92:95], v[104:107]
  ds_read_b128 v[44:47], v1 offset:46080
  v_mfma_f32_16x16x32_bf16 v[132:135], v[72:75], a[164:167], v[132:135]
  ds_read_b128 v[48:51], v1 offset:47104
  s_waitcnt lgkmcnt(9)
  v_mfma_f32_16x16x32_bf16 v[108:111], v[76:79], a[92:95], v[108:111]
  ds_read_b128 v[52:55], v1 offset:48128
  v_mfma_f32_16x16x32_bf16 v[136:139], v[76:79], a[164:167], v[136:139]
  ds_read_b128 v[56:59], v1 offset:49152
  s_waitcnt lgkmcnt(10)
  v_mfma_f32_16x16x32_bf16 v[112:115], v[80:83], a[92:95], v[112:115]
  ds_read_b128 v[60:63], v3 offset:43008
  v_mfma_f32_16x16x32_bf16 v[140:143], v[80:83], a[164:167], v[140:143]
  s_add_u32 m0, s35, 65536
  s_mov_b32 s40, 65536
  s_waitcnt lgkmcnt(10)
  v_mfma_f32_16x16x32_bf16 v[116:119], v[84:87], a[92:95], v[116:119]
  buffer_load_dwordx4 v7, s[8:11], s40 offen lds
  v_mfma_f32_16x16x32_bf16 v[144:147], v[84:87], a[164:167], v[144:147]
  buffer_load_dwordx4 v7, s[8:11], s40 offen offset:1024 lds
  s_waitcnt lgkmcnt(9)
  v_mfma_f32_16x16x32_bf16 v[120:123], v[88:91], a[92:95], v[120:123]
  buffer_load_dwordx4 v7, s[8:11], s40 offen offset:2048 lds
  v_mfma_f32_16x16x32_bf16 v[148:151], v[88:91], a[164:167], v[148:151]
  buffer_load_dwordx4 v7, s[8:11], s40 offen offset:3072 lds
  s_waitcnt vmcnt(10) lgkmcnt(8)
  v_mfma_f32_16x16x32_bf16 v[152:155], v[92:95], a[20:23], v[152:155]
  buffer_load_dwordx4 a[104:107], v6, s[4:7], s46 offen
  v_mfma_f32_16x16x32_bf16 v[156:159], v[80:83], a[20:23], v[156:159]
  buffer_load_dwordx4 a[176:179], v6, s[4:7], s51 offen
  buffer_load_dwordx4 a[32:35], v5, s[4:7], s46 offen
  s_waitcnt vmcnt(12) lgkmcnt(7)
  v_mfma_f32_16x16x32_bf16 v[96:99], v[32:35], a[96:99], v[96:99]
  ds_read_b128 v[64:67], v1 offset:50176
  s_waitcnt vmcnt(11)
  v_mfma_f32_16x16x32_bf16 v[124:127], v[32:35], a[168:171], v[124:127]
  ds_read_b128 v[68:71], v1 offset:51200
  s_waitcnt lgkmcnt(8)
  v_mfma_f32_16x16x32_bf16 v[100:103], v[36:39], a[96:99], v[100:103]
  ds_read_b128 v[72:75], v1 offset:52224
  v_mfma_f32_16x16x32_bf16 v[128:131], v[36:39], a[168:171], v[128:131]
  ds_read_b128 v[76:79], v1 offset:53248
  s_waitcnt lgkmcnt(9)
  v_mfma_f32_16x16x32_bf16 v[104:107], v[40:43], a[96:99], v[104:107]
  ds_read_b128 v[80:83], v1 offset:54272
  v_mfma_f32_16x16x32_bf16 v[132:135], v[40:43], a[168:171], v[132:135]
  ds_read_b128 v[84:87], v1 offset:55296
  s_waitcnt lgkmcnt(10)
  v_mfma_f32_16x16x32_bf16 v[108:111], v[44:47], a[96:99], v[108:111]
  ds_read_b128 v[88:91], v1 offset:56320
  v_mfma_f32_16x16x32_bf16 v[136:139], v[44:47], a[168:171], v[136:139]
  ds_read_b128 v[92:95], v3 offset:50176
  s_waitcnt lgkmcnt(11)
  v_mfma_f32_16x16x32_bf16 v[112:115], v[48:51], a[96:99], v[112:115]
  buffer_load_dwordx4 a[108:111], v6, s[4:7], s46 offen offset:1024
  v_mfma_f32_16x16x32_bf16 v[140:143], v[48:51], a[168:171], v[140:143]
  buffer_load_dwordx4 a[180:183], v6, s[4:7], s51 offen offset:1024
  s_waitcnt lgkmcnt(10)
  v_mfma_f32_16x16x32_bf16 v[116:119], v[52:55], a[96:99], v[116:119]
  buffer_load_dwordx4 a[36:39], v5, s[4:7], s46 offen offset:1024
  v_mfma_f32_16x16x32_bf16 v[144:147], v[52:55], a[168:171], v[144:147]
  s_waitcnt lgkmcnt(9)
  v_mfma_f32_16x16x32_bf16 v[120:123], v[56:59], a[96:99], v[120:123]
  v_mfma_f32_16x16x32_bf16 v[148:151], v[56:59], a[168:171], v[148:151]
  s_waitcnt vmcnt(13) lgkmcnt(8)
  v_mfma_f32_16x16x32_bf16 v[152:155], v[60:63], a[24:27], v[152:155]
  v_mfma_f32_16x16x32_bf16 v[156:159], v[48:51], a[24:27], v[156:159]
  s_waitcnt vmcnt(12) lgkmcnt(7)
  v_mfma_f32_16x16x32_bf16 v[96:99], v[64:67], a[100:103], v[96:99]
  ds_read_b128 v[32:35], v1 offset:57344
  s_waitcnt vmcnt(11)
  v_mfma_f32_16x16x32_bf16 v[124:127], v[64:67], a[172:175], v[124:127]
  ds_read_b128 v[36:39], v1 offset:58368
  s_waitcnt lgkmcnt(8)
  v_mfma_f32_16x16x32_bf16 v[100:103], v[68:71], a[100:103], v[100:103]
  ds_read_b128 v[40:43], v1 offset:59392
  v_mfma_f32_16x16x32_bf16 v[128:131], v[68:71], a[172:175], v[128:131]
  ds_read_b128 v[44:47], v1 offset:60416
  s_waitcnt lgkmcnt(9)
  v_mfma_f32_16x16x32_bf16 v[104:107], v[72:75], a[100:103], v[104:107]
  ds_read_b128 v[48:51], v1 offset:61440
  v_mfma_f32_16x16x32_bf16 v[132:135], v[72:75], a[172:175], v[132:135]
  ds_read_b128 v[52:55], v1 offset:62464
  s_waitcnt lgkmcnt(10)
  v_mfma_f32_16x16x32_bf16 v[108:111], v[76:79], a[100:103], v[108:111]
  ds_read_b128 v[56:59], v1 offset:63488
  v_mfma_f32_16x16x32_bf16 v[136:139], v[76:79], a[172:175], v[136:139]
  ds_read_b128 v[60:63], v3 offset:57344
  s_waitcnt lgkmcnt(11)
  v_mfma_f32_16x16x32_bf16 v[112:115], v[80:83], a[100:103], v[112:115]
  s_add_u32 m0, s35, 81920
  s_mov_b32 s40, 81920
  v_mfma_f32_16x16x32_bf16 v[140:143], v[80:83], a[172:175], v[140:143]
  buffer_load_dwordx4 v7, s[8:11], s40 offen lds
  s_waitcnt lgkmcnt(10)
  v_mfma_f32_16x16x32_bf16 v[116:119], v[84:87], a[100:103], v[116:119]
  buffer_load_dwordx4 v7, s[8:11], s40 offen offset:1024 lds
  v_mfma_f32_16x16x32_bf16 v[144:147], v[84:87], a[172:175], v[144:147]
  buffer_load_dwordx4 v7, s[8:11], s40 offen offset:2048 lds
  s_waitcnt lgkmcnt(9)
  v_mfma_f32_16x16x32_bf16 v[120:123], v[88:91], a[100:103], v[120:123]
  buffer_load_dwordx4 v7, s[8:11], s40 offen offset:3072 lds
  v_mfma_f32_16x16x32_bf16 v[148:151], v[88:91], a[172:175], v[148:151]
  buffer_load_dwordx4 a[112:115], v6, s[4:7], s46 offen offset:2048
  s_waitcnt vmcnt(15) lgkmcnt(8)
  v_mfma_f32_16x16x32_bf16 v[152:155], v[92:95], a[28:31], v[152:155]
  buffer_load_dwordx4 a[184:187], v6, s[4:7], s51 offen offset:2048
  v_mfma_f32_16x16x32_bf16 v[156:159], v[80:83], a[28:31], v[156:159]
  buffer_load_dwordx4 a[40:43], v5, s[4:7], s46 offen offset:2048
  s_waitcnt vmcnt(12) lgkmcnt(7)
  v_mfma_f32_16x16x32_bf16 v[96:99], v[32:35], a[104:107], v[96:99]
  s_barrier
  s_waitcnt vmcnt(11)
  v_mfma_f32_16x16x32_bf16 v[124:127], v[32:35], a[176:179], v[124:127]
  ds_read_b128 v[64:67], v1 offset:64512
  s_waitcnt lgkmcnt(7)
  v_mfma_f32_16x16x32_bf16 v[100:103], v[36:39], a[104:107], v[100:103]
  ds_read_b128 v[68:71], v2
  v_mfma_f32_16x16x32_bf16 v[128:131], v[36:39], a[176:179], v[128:131]
  ds_read_b128 v[72:75], v2 offset:1024
  s_waitcnt lgkmcnt(8)
  v_mfma_f32_16x16x32_bf16 v[104:107], v[40:43], a[104:107], v[104:107]
  ds_read_b128 v[76:79], v2 offset:2048
  v_mfma_f32_16x16x32_bf16 v[132:135], v[40:43], a[176:179], v[132:135]
  ds_read_b128 v[80:83], v2 offset:3072
  s_waitcnt lgkmcnt(9)
  v_mfma_f32_16x16x32_bf16 v[108:111], v[44:47], a[104:107], v[108:111]
  ds_read_b128 v[84:87], v2 offset:4096
  v_mfma_f32_16x16x32_bf16 v[136:139], v[44:47], a[176:179], v[136:139]
  ds_read_b128 v[88:91], v2 offset:5120
  s_waitcnt lgkmcnt(10)
  v_mfma_f32_16x16x32_bf16 v[112:115], v[48:51], a[104:107], v[112:115]
  ds_read_b128 v[92:95], v3 offset:64512
  v_mfma_f32_16x16x32_bf16 v[140:143], v[48:51], a[176:179], v[140:143]
  buffer_load_dwordx4 a[116:119], v6, s[4:7], s46 offen offset:3072
  s_waitcnt lgkmcnt(10)
  v_mfma_f32_16x16x32_bf16 v[116:119], v[52:55], a[104:107], v[116:119]
  buffer_load_dwordx4 a[188:191], v6, s[4:7], s51 offen offset:3072
  v_mfma_f32_16x16x32_bf16 v[144:147], v[52:55], a[176:179], v[144:147]
  buffer_load_dwordx4 a[44:47], v5, s[4:7], s46 offen offset:3072
  s_waitcnt lgkmcnt(9)
  v_mfma_f32_16x16x32_bf16 v[120:123], v[56:59], a[104:107], v[120:123]
  v_mfma_f32_16x16x32_bf16 v[148:151], v[56:59], a[176:179], v[148:151]
  s_waitcnt vmcnt(13) lgkmcnt(8)
  v_mfma_f32_16x16x32_bf16 v[152:155], v[60:63], a[32:35], v[152:155]
  v_mfma_f32_16x16x32_bf16 v[156:159], v[48:51], a[32:35], v[156:159]
  s_waitcnt vmcnt(12) lgkmcnt(7)
  v_mfma_f32_16x16x32_bf16 v[96:99], v[64:67], a[108:111], v[96:99]
  ds_read_b128 v[32:35], v2 offset:6144
  s_waitcnt vmcnt(11)
  v_mfma_f32_16x16x32_bf16 v[124:127], v[64:67], a[180:183], v[124:127]
  ds_read_b128 v[36:39], v2 offset:7168
  s_waitcnt lgkmcnt(8)
  v_mfma_f32_16x16x32_bf16 v[100:103], v[68:71], a[108:111], v[100:103]
  ds_read_b128 v[40:43], v2 offset:8192
  v_mfma_f32_16x16x32_bf16 v[128:131], v[68:71], a[180:183], v[128:131]
  ds_read_b128 v[44:47], v2 offset:9216
  s_waitcnt lgkmcnt(9)
  v_mfma_f32_16x16x32_bf16 v[104:107], v[72:75], a[108:111], v[104:107]
  ds_read_b128 v[48:51], v2 offset:10240
  v_mfma_f32_16x16x32_bf16 v[132:135], v[72:75], a[180:183], v[132:135]
  ds_read_b128 v[52:55], v2 offset:11264
  s_waitcnt lgkmcnt(10)
  v_mfma_f32_16x16x32_bf16 v[108:111], v[76:79], a[108:111], v[108:111]
  ds_read_b128 v[56:59], v2 offset:12288
  v_mfma_f32_16x16x32_bf16 v[136:139], v[76:79], a[180:183], v[136:139]
  ds_read_b128 v[60:63], v4 offset:6144
  s_waitcnt lgkmcnt(11)
  v_mfma_f32_16x16x32_bf16 v[112:115], v[80:83], a[108:111], v[112:115]
  s_add_u32 m0, s35, 98304
  s_mov_b32 s40, 98304
  v_mfma_f32_16x16x32_bf16 v[140:143], v[80:83], a[180:183], v[140:143]
  buffer_load_dwordx4 v7, s[8:11], s40 offen lds
  s_waitcnt lgkmcnt(10)
  v_mfma_f32_16x16x32_bf16 v[116:119], v[84:87], a[108:111], v[116:119]
  buffer_load_dwordx4 v7, s[8:11], s40 offen offset:1024 lds
  v_mfma_f32_16x16x32_bf16 v[144:147], v[84:87], a[180:183], v[144:147]
  buffer_load_dwordx4 v7, s[8:11], s40 offen offset:2048 lds
  s_waitcnt lgkmcnt(9)
  v_mfma_f32_16x16x32_bf16 v[120:123], v[88:91], a[108:111], v[120:123]
  buffer_load_dwordx4 v7, s[8:11], s40 offen offset:3072 lds
  v_mfma_f32_16x16x32_bf16 v[148:151], v[88:91], a[180:183], v[148:151]
  buffer_load_dwordx4 a[120:123], v6, s[4:7], s47 offen
  s_waitcnt vmcnt(15) lgkmcnt(8)
  v_mfma_f32_16x16x32_bf16 v[152:155], v[92:95], a[36:39], v[152:155]
  buffer_load_dwordx4 a[192:195], v6, s[4:7], s52 offen
  v_mfma_f32_16x16x32_bf16 v[156:159], v[80:83], a[36:39], v[156:159]
  buffer_load_dwordx4 a[48:51], v5, s[4:7], s47 offen
  s_waitcnt vmcnt(12) lgkmcnt(7)
  v_mfma_f32_16x16x32_bf16 v[96:99], v[32:35], a[112:115], v[96:99]
  s_barrier
  s_waitcnt vmcnt(11)
  v_mfma_f32_16x16x32_bf16 v[124:127], v[32:35], a[184:187], v[124:127]
  ds_read_b128 v[64:67], v2 offset:13312
  s_waitcnt lgkmcnt(7)
  v_mfma_f32_16x16x32_bf16 v[100:103], v[36:39], a[112:115], v[100:103]
  ds_read_b128 v[68:71], v2 offset:14336
  v_mfma_f32_16x16x32_bf16 v[128:131], v[36:39], a[184:187], v[128:131]
  ds_read_b128 v[72:75], v2 offset:15360
  s_waitcnt lgkmcnt(8)
  v_mfma_f32_16x16x32_bf16 v[104:107], v[40:43], a[112:115], v[104:107]
  ds_read_b128 v[76:79], v2 offset:16384
  v_mfma_f32_16x16x32_bf16 v[132:135], v[40:43], a[184:187], v[132:135]
  ds_read_b128 v[80:83], v2 offset:17408
  s_waitcnt lgkmcnt(9)
  v_mfma_f32_16x16x32_bf16 v[108:111], v[44:47], a[112:115], v[108:111]
  ds_read_b128 v[84:87], v2 offset:18432
  v_mfma_f32_16x16x32_bf16 v[136:139], v[44:47], a[184:187], v[136:139]
  ds_read_b128 v[88:91], v2 offset:19456
  s_waitcnt lgkmcnt(10)
  v_mfma_f32_16x16x32_bf16 v[112:115], v[48:51], a[112:115], v[112:115]
  ds_read_b128 v[92:95], v4 offset:13312
  v_mfma_f32_16x16x32_bf16 v[140:143], v[48:51], a[184:187], v[140:143]
  buffer_load_dwordx4 a[124:127], v6, s[4:7], s47 offen offset:1024
  s_waitcnt lgkmcnt(10)
  v_mfma_f32_16x16x32_bf16 v[116:119], v[52:55], a[112:115], v[116:119]
  buffer_load_dwordx4 a[196:199], v6, s[4:7], s52 offen offset:1024
  v_mfma_f32_16x16x32_bf16 v[144:147], v[52:55], a[184:187], v[144:147]
  buffer_load_dwordx4 a[52:55], v5, s[4:7], s47 offen offset:1024
  s_waitcnt lgkmcnt(9)
  v_mfma_f32_16x16x32_bf16 v[120:123], v[56:59], a[112:115], v[120:123]
  v_mfma_f32_16x16x32_bf16 v[148:151], v[56:59], a[184:187], v[148:151]
  s_waitcnt vmcnt(13) lgkmcnt(8)
  v_mfma_f32_16x16x32_bf16 v[152:155], v[60:63], a[40:43], v[152:155]
  v_mfma_f32_16x16x32_bf16 v[156:159], v[48:51], a[40:43], v[156:159]
  s_waitcnt vmcnt(12) lgkmcnt(7)
  v_mfma_f32_16x16x32_bf16 v[96:99], v[64:67], a[116:119], v[96:99]
  ds_read_b128 v[32:35], v2 offset:20480
  s_waitcnt vmcnt(11)
  v_mfma_f32_16x16x32_bf16 v[124:127], v[64:67], a[188:191], v[124:127]
  ds_read_b128 v[36:39], v2 offset:21504
  s_waitcnt lgkmcnt(8)
  v_mfma_f32_16x16x32_bf16 v[100:103], v[68:71], a[116:119], v[100:103]
  ds_read_b128 v[40:43], v2 offset:22528
  v_mfma_f32_16x16x32_bf16 v[128:131], v[68:71], a[188:191], v[128:131]
  ds_read_b128 v[44:47], v2 offset:23552
  s_waitcnt lgkmcnt(9)
  v_mfma_f32_16x16x32_bf16 v[104:107], v[72:75], a[116:119], v[104:107]
  ds_read_b128 v[48:51], v2 offset:24576
  v_mfma_f32_16x16x32_bf16 v[132:135], v[72:75], a[188:191], v[132:135]
  ds_read_b128 v[52:55], v2 offset:25600
  s_waitcnt lgkmcnt(10)
  v_mfma_f32_16x16x32_bf16 v[108:111], v[76:79], a[116:119], v[108:111]
  ds_read_b128 v[56:59], v2 offset:26624
  v_mfma_f32_16x16x32_bf16 v[136:139], v[76:79], a[188:191], v[136:139]
  ds_read_b128 v[60:63], v4 offset:20480
  s_waitcnt lgkmcnt(11)
  v_mfma_f32_16x16x32_bf16 v[112:115], v[80:83], a[116:119], v[112:115]
  buffer_load_dwordx4 a[128:131], v6, s[4:7], s47 offen offset:2048
  v_mfma_f32_16x16x32_bf16 v[140:143], v[80:83], a[188:191], v[140:143]
  buffer_load_dwordx4 a[200:203], v6, s[4:7], s52 offen offset:2048
  s_waitcnt lgkmcnt(10)
  v_mfma_f32_16x16x32_bf16 v[116:119], v[84:87], a[116:119], v[116:119]
  buffer_load_dwordx4 a[56:59], v5, s[4:7], s47 offen offset:2048
  v_mfma_f32_16x16x32_bf16 v[144:147], v[84:87], a[188:191], v[144:147]
  s_waitcnt lgkmcnt(9)
  v_mfma_f32_16x16x32_bf16 v[120:123], v[88:91], a[116:119], v[120:123]
  v_mfma_f32_16x16x32_bf16 v[148:151], v[88:91], a[188:191], v[148:151]
  s_waitcnt vmcnt(13) lgkmcnt(8)
  v_mfma_f32_16x16x32_bf16 v[152:155], v[92:95], a[44:47], v[152:155]
  v_mfma_f32_16x16x32_bf16 v[156:159], v[80:83], a[44:47], v[156:159]
  s_waitcnt vmcnt(8) lgkmcnt(7)
  v_mfma_f32_16x16x32_bf16 v[96:99], v[32:35], a[120:123], v[96:99]
  s_barrier
  s_waitcnt vmcnt(7)
  v_mfma_f32_16x16x32_bf16 v[124:127], v[32:35], a[192:195], v[124:127]
  ds_read_b128 v[64:67], v2 offset:27648
  s_waitcnt lgkmcnt(7)
  v_mfma_f32_16x16x32_bf16 v[100:103], v[36:39], a[120:123], v[100:103]
  ds_read_b128 v[68:71], v2 offset:28672
  v_mfma_f32_16x16x32_bf16 v[128:131], v[36:39], a[192:195], v[128:131]
  ds_read_b128 v[72:75], v2 offset:29696
  s_waitcnt lgkmcnt(8)
  v_mfma_f32_16x16x32_bf16 v[104:107], v[40:43], a[120:123], v[104:107]
  ds_read_b128 v[76:79], v2 offset:30720
  v_mfma_f32_16x16x32_bf16 v[132:135], v[40:43], a[192:195], v[132:135]
  ds_read_b128 v[80:83], v2 offset:31744
  s_waitcnt lgkmcnt(9)
  v_mfma_f32_16x16x32_bf16 v[108:111], v[44:47], a[120:123], v[108:111]
  ds_read_b128 v[84:87], v2 offset:32768
  v_mfma_f32_16x16x32_bf16 v[136:139], v[44:47], a[192:195], v[136:139]
  ds_read_b128 v[88:91], v2 offset:33792
  s_waitcnt lgkmcnt(10)
  v_mfma_f32_16x16x32_bf16 v[112:115], v[48:51], a[120:123], v[112:115]
  ds_read_b128 v[92:95], v4 offset:27648
  v_mfma_f32_16x16x32_bf16 v[140:143], v[48:51], a[192:195], v[140:143]
  s_add_u32 m0, s35, 114688
  s_mov_b32 s40, 114688
  s_waitcnt lgkmcnt(10)
  v_mfma_f32_16x16x32_bf16 v[116:119], v[52:55], a[120:123], v[116:119]
  buffer_load_dwordx4 v7, s[8:11], s40 offen lds
  v_mfma_f32_16x16x32_bf16 v[144:147], v[52:55], a[192:195], v[144:147]
  buffer_load_dwordx4 v7, s[8:11], s40 offen offset:1024 lds
  s_waitcnt lgkmcnt(9)
  v_mfma_f32_16x16x32_bf16 v[120:123], v[56:59], a[120:123], v[120:123]
  buffer_load_dwordx4 v7, s[8:11], s40 offen offset:2048 lds
  v_mfma_f32_16x16x32_bf16 v[148:151], v[56:59], a[192:195], v[148:151]
  buffer_load_dwordx4 v7, s[8:11], s40 offen offset:3072 lds
  s_waitcnt vmcnt(10) lgkmcnt(8)
  v_mfma_f32_16x16x32_bf16 v[152:155], v[60:63], a[48:51], v[152:155]
  buffer_load_dwordx4 a[132:135], v6, s[4:7], s47 offen offset:3072
  v_mfma_f32_16x16x32_bf16 v[156:159], v[48:51], a[48:51], v[156:159]
  buffer_load_dwordx4 a[204:207], v6, s[4:7], s52 offen offset:3072
  buffer_load_dwordx4 a[60:63], v5, s[4:7], s47 offen offset:3072
  s_waitcnt vmcnt(12) lgkmcnt(7)
  v_mfma_f32_16x16x32_bf16 v[96:99], v[64:67], a[124:127], v[96:99]
  ds_read_b128 v[32:35], v2 offset:34816
  s_waitcnt vmcnt(11)
  v_mfma_f32_16x16x32_bf16 v[124:127], v[64:67], a[196:199], v[124:127]
  ds_read_b128 v[36:39], v2 offset:35840
  s_waitcnt lgkmcnt(8)
  v_mfma_f32_16x16x32_bf16 v[100:103], v[68:71], a[124:127], v[100:103]
  ds_read_b128 v[40:43], v2 offset:36864
  v_mfma_f32_16x16x32_bf16 v[128:131], v[68:71], a[196:199], v[128:131]
  ds_read_b128 v[44:47], v2 offset:37888
  s_waitcnt lgkmcnt(9)
  v_mfma_f32_16x16x32_bf16 v[104:107], v[72:75], a[124:127], v[104:107]
  ds_read_b128 v[48:51], v2 offset:38912
  v_mfma_f32_16x16x32_bf16 v[132:135], v[72:75], a[196:199], v[132:135]
  ds_read_b128 v[52:55], v2 offset:39936
  s_waitcnt lgkmcnt(10)
  v_mfma_f32_16x16x32_bf16 v[108:111], v[76:79], a[124:127], v[108:111]
  ds_read_b128 v[56:59], v2 offset:40960
  v_mfma_f32_16x16x32_bf16 v[136:139], v[76:79], a[196:199], v[136:139]
  ds_read_b128 v[60:63], v4 offset:34816
  s_waitcnt lgkmcnt(11)
  v_mfma_f32_16x16x32_bf16 v[112:115], v[80:83], a[124:127], v[112:115]
  buffer_load_dwordx4 a[136:139], v6, s[4:7], s48 offen
  v_mfma_f32_16x16x32_bf16 v[140:143], v[80:83], a[196:199], v[140:143]
  buffer_load_dwordx4 a[208:211], v6, s[4:7], s53 offen
  s_waitcnt lgkmcnt(10)
  v_mfma_f32_16x16x32_bf16 v[116:119], v[84:87], a[124:127], v[116:119]
  buffer_load_dwordx4 a[64:67], v5, s[4:7], s48 offen
  v_mfma_f32_16x16x32_bf16 v[144:147], v[84:87], a[196:199], v[144:147]
  s_waitcnt lgkmcnt(9)
  v_mfma_f32_16x16x32_bf16 v[120:123], v[88:91], a[124:127], v[120:123]
  v_mfma_f32_16x16x32_bf16 v[148:151], v[88:91], a[196:199], v[148:151]
  s_waitcnt vmcnt(13) lgkmcnt(8)
  v_mfma_f32_16x16x32_bf16 v[152:155], v[92:95], a[52:55], v[152:155]
  v_mfma_f32_16x16x32_bf16 v[156:159], v[80:83], a[52:55], v[156:159]
  s_waitcnt vmcnt(12) lgkmcnt(7)
  v_mfma_f32_16x16x32_bf16 v[96:99], v[32:35], a[128:131], v[96:99]
  ds_read_b128 v[64:67], v2 offset:41984
  s_waitcnt vmcnt(11)
  v_mfma_f32_16x16x32_bf16 v[124:127], v[32:35], a[200:203], v[124:127]
  ds_read_b128 v[68:71], v2 offset:43008
  s_waitcnt lgkmcnt(8)
  v_mfma_f32_16x16x32_bf16 v[100:103], v[36:39], a[128:131], v[100:103]
  ds_read_b128 v[72:75], v2 offset:44032
  v_mfma_f32_16x16x32_bf16 v[128:131], v[36:39], a[200:203], v[128:131]
  ds_read_b128 v[76:79], v2 offset:45056
  s_waitcnt lgkmcnt(9)
  v_mfma_f32_16x16x32_bf16 v[104:107], v[40:43], a[128:131], v[104:107]
  ds_read_b128 v[80:83], v2 offset:46080
  v_mfma_f32_16x16x32_bf16 v[132:135], v[40:43], a[200:203], v[132:135]
  ds_read_b128 v[84:87], v2 offset:47104
  s_waitcnt lgkmcnt(10)
  v_mfma_f32_16x16x32_bf16 v[108:111], v[44:47], a[128:131], v[108:111]
  ds_read_b128 v[88:91], v2 offset:48128
  v_mfma_f32_16x16x32_bf16 v[136:139], v[44:47], a[200:203], v[136:139]
  ds_read_b128 v[92:95], v4 offset:41984
  s_waitcnt lgkmcnt(11)
  v_mfma_f32_16x16x32_bf16 v[112:115], v[48:51], a[128:131], v[112:115]
  buffer_load_dwordx4 a[140:143], v6, s[4:7], s48 offen offset:1024
  v_mfma_f32_16x16x32_bf16 v[140:143], v[48:51], a[200:203], v[140:143]
  buffer_load_dwordx4 a[212:215], v6, s[4:7], s53 offen offset:1024
  s_waitcnt lgkmcnt(10)
  v_mfma_f32_16x16x32_bf16 v[116:119], v[52:55], a[128:131], v[116:119]
  buffer_load_dwordx4 a[68:71], v5, s[4:7], s48 offen offset:1024
  v_mfma_f32_16x16x32_bf16 v[144:147], v[52:55], a[200:203], v[144:147]
  s_waitcnt lgkmcnt(9)
  v_mfma_f32_16x16x32_bf16 v[120:123], v[56:59], a[128:131], v[120:123]
  v_mfma_f32_16x16x32_bf16 v[148:151], v[56:59], a[200:203], v[148:151]
  s_waitcnt vmcnt(13) lgkmcnt(8)
  v_mfma_f32_16x16x32_bf16 v[152:155], v[60:63], a[56:59], v[152:155]
  v_mfma_f32_16x16x32_bf16 v[156:159], v[48:51], a[56:59], v[156:159]
  s_waitcnt vmcnt(8) lgkmcnt(7)
  v_mfma_f32_16x16x32_bf16 v[96:99], v[64:67], a[132:135], v[96:99]
  s_barrier
  s_waitcnt vmcnt(7)
  v_mfma_f32_16x16x32_bf16 v[124:127], v[64:67], a[204:207], v[124:127]
  ds_read_b128 v[32:35], v2 offset:49152
  s_waitcnt lgkmcnt(7)
  v_mfma_f32_16x16x32_bf16 v[100:103], v[68:71], a[132:135], v[100:103]
  ds_read_b128 v[36:39], v2 offset:50176
  v_mfma_f32_16x16x32_bf16 v[128:131], v[68:71], a[204:207], v[128:131]
  ds_read_b128 v[40:43], v2 offset:51200
  s_waitcnt lgkmcnt(8)
  v_mfma_f32_16x16x32_bf16 v[104:107], v[72:75], a[132:135], v[104:107]
  ds_read_b128 v[44:47], v2 offset:52224
  v_mfma_f32_16x16x32_bf16 v[132:135], v[72:75], a[204:207], v[132:135]
  ds_read_b128 v[48:51], v2 offset:53248
  s_waitcnt lgkmcnt(9)
  v_mfma_f32_16x16x32_bf16 v[108:111], v[76:79], a[132:135], v[108:111]
  ds_read_b128 v[52:55], v2 offset:54272
  v_mfma_f32_16x16x32_bf16 v[136:139], v[76:79], a[204:207], v[136:139]
  ds_read_b128 v[56:59], v2 offset:55296
  s_waitcnt lgkmcnt(10)
  v_mfma_f32_16x16x32_bf16 v[112:115], v[80:83], a[132:135], v[112:115]
  ds_read_b128 v[60:63], v4 offset:49152
  v_mfma_f32_16x16x32_bf16 v[140:143], v[80:83], a[204:207], v[140:143]
  s_waitcnt lgkmcnt(10)
  v_mfma_f32_16x16x32_bf16 v[116:119], v[84:87], a[132:135], v[116:119]
  v_mfma_f32_16x16x32_bf16 v[144:147], v[84:87], a[204:207], v[144:147]
  s_waitcnt lgkmcnt(9)
  v_mfma_f32_16x16x32_bf16 v[120:123], v[88:91], a[132:135], v[120:123]
  v_mfma_f32_16x16x32_bf16 v[148:151], v[88:91], a[204:207], v[148:151]
  s_waitcnt vmcnt(6) lgkmcnt(8)
  v_mfma_f32_16x16x32_bf16 v[152:155], v[92:95], a[60:63], v[152:155]
  v_mfma_f32_16x16x32_bf16 v[156:159], v[80:83], a[60:63], v[156:159]
  s_waitcnt vmcnt(5) lgkmcnt(7)
  v_mfma_f32_16x16x32_bf16 v[96:99], v[32:35], a[136:139], v[96:99]
  ds_read_b128 v[64:67], v2 offset:56320
  s_waitcnt vmcnt(4)
  v_mfma_f32_16x16x32_bf16 v[124:127], v[32:35], a[208:211], v[124:127]
  ds_read_b128 v[68:71], v2 offset:57344
  s_waitcnt lgkmcnt(8)
  v_mfma_f32_16x16x32_bf16 v[100:103], v[36:39], a[136:139], v[100:103]
  ds_read_b128 v[72:75], v2 offset:58368
  v_mfma_f32_16x16x32_bf16 v[128:131], v[36:39], a[208:211], v[128:131]
  ds_read_b128 v[76:79], v2 offset:59392
  s_waitcnt lgkmcnt(9)
  v_mfma_f32_16x16x32_bf16 v[104:107], v[40:43], a[136:139], v[104:107]
  ds_read_b128 v[80:83], v2 offset:60416
  v_mfma_f32_16x16x32_bf16 v[132:135], v[40:43], a[208:211], v[132:135]
  ds_read_b128 v[84:87], v2 offset:61440
  s_waitcnt lgkmcnt(10)
  v_mfma_f32_16x16x32_bf16 v[108:111], v[44:47], a[136:139], v[108:111]
  ds_read_b128 v[88:91], v2 offset:62464
  v_mfma_f32_16x16x32_bf16 v[136:139], v[44:47], a[208:211], v[136:139]
  ds_read_b128 v[92:95], v4 offset:56320
  s_waitcnt lgkmcnt(11)
  v_mfma_f32_16x16x32_bf16 v[112:115], v[48:51], a[136:139], v[112:115]
  v_mfma_f32_16x16x32_bf16 v[140:143], v[48:51], a[208:211], v[140:143]
  s_waitcnt lgkmcnt(10)
  v_mfma_f32_16x16x32_bf16 v[116:119], v[52:55], a[136:139], v[116:119]
  v_mfma_f32_16x16x32_bf16 v[144:147], v[52:55], a[208:211], v[144:147]
  s_waitcnt lgkmcnt(9)
  v_mfma_f32_16x16x32_bf16 v[120:123], v[56:59], a[136:139], v[120:123]
  v_mfma_f32_16x16x32_bf16 v[148:151], v[56:59], a[208:211], v[148:151]
  s_waitcnt vmcnt(3) lgkmcnt(8)
  v_mfma_f32_16x16x32_bf16 v[152:155], v[60:63], a[64:67], v[152:155]
  v_mfma_f32_16x16x32_bf16 v[156:159], v[48:51], a[64:67], v[156:159]
  s_waitcnt vmcnt(2) lgkmcnt(7)
  v_mfma_f32_16x16x32_bf16 v[96:99], v[64:67], a[140:143], v[96:99]
  s_waitcnt vmcnt(1)
  v_mfma_f32_16x16x32_bf16 v[124:127], v[64:67], a[212:215], v[124:127]
  s_waitcnt lgkmcnt(6)
  v_mfma_f32_16x16x32_bf16 v[100:103], v[68:71], a[140:143], v[100:103]
  v_mfma_f32_16x16x32_bf16 v[128:131], v[68:71], a[212:215], v[128:131]
  s_waitcnt lgkmcnt(5)
  v_mfma_f32_16x16x32_bf16 v[104:107], v[72:75], a[140:143], v[104:107]
  v_mfma_f32_16x16x32_bf16 v[132:135], v[72:75], a[212:215], v[132:135]
  s_waitcnt lgkmcnt(4)
  v_mfma_f32_16x16x32_bf16 v[108:111], v[76:79], a[140:143], v[108:111]
  v_mfma_f32_16x16x32_bf16 v[136:139], v[76:79], a[212:215], v[136:139]
  s_waitcnt lgkmcnt(3)
  v_mfma_f32_16x16x32_bf16 v[112:115], v[80:83], a[140:143], v[112:115]
  v_mfma_f32_16x16x32_bf16 v[140:143], v[80:83], a[212:215], v[140:143]
  s_waitcnt lgkmcnt(2)
  v_mfma_f32_16x16x32_bf16 v[116:119], v[84:87], a[140:143], v[116:119]
  v_mfma_f32_16x16x32_bf16 v[144:147], v[84:87], a[212:215], v[144:147]
  s_waitcnt lgkmcnt(1)
  v_mfma_f32_16x16x32_bf16 v[120:123], v[88:91], a[140:143], v[120:123]
  v_mfma_f32_16x16x32_bf16 v[148:151], v[88:91], a[212:215], v[148:151]
  s_waitcnt vmcnt(0) lgkmcnt(0)
  v_mfma_f32_16x16x32_bf16 v[152:155], v[92:95], a[68:71], v[152:155]
  v_mfma_f32_16x16x32_bf16 v[156:159], v[80:83], a[68:71], v[156:159]
  v_mul_f32 v96, v96, v9
  v_mul_f32 v97, v97, v9
  v_mul_f32 v98, v98, v9
  v_mul_f32 v99, v99, v9
  v_cvt_pk_bf16_f32 v32, v96, v97
  v_cvt_pk_bf16_f32 v33, v98, v99
  ds_write_b64 v13, v[32:33]
  v_mul_f32 v124, v124, v10
  v_mul_f32 v125, v125, v10
  v_mul_f32 v126, v126, v10
  v_mul_f32 v127, v127, v10
  v_cvt_pk_bf16_f32 v34, v124, v125
  v_cvt_pk_bf16_f32 v35, v126, v127
  ds_write_b64 v13, v[34:35] offset:3840
  v_mul_f32 v100, v100, v9
  v_mul_f32 v101, v101, v9
  v_mul_f32 v102, v102, v9
  v_mul_f32 v103, v103, v9
  v_cvt_pk_bf16_f32 v36, v100, v101
  v_cvt_pk_bf16_f32 v37, v102, v103
  ds_write_b64 v13, v[36:37] offset:32
  v_mul_f32 v128, v128, v10
  v_mul_f32 v129, v129, v10
  v_mul_f32 v130, v130, v10
  v_mul_f32 v131, v131, v10
  v_cvt_pk_bf16_f32 v38, v128, v129
  v_cvt_pk_bf16_f32 v39, v130, v131
  ds_write_b64 v13, v[38:39] offset:3872
  v_mul_f32 v104, v104, v9
  v_mul_f32 v105, v105, v9
  v_mul_f32 v106, v106, v9
  v_mul_f32 v107, v107, v9
  v_cvt_pk_bf16_f32 v32, v104, v105
  v_cvt_pk_bf16_f32 v33, v106, v107
  ds_write_b64 v13, v[32:33] offset:64
  v_mul_f32 v132, v132, v10
  v_mul_f32 v133, v133, v10
  v_mul_f32 v134, v134, v10
  v_mul_f32 v135, v135, v10
  v_cvt_pk_bf16_f32 v34, v132, v133
  v_cvt_pk_bf16_f32 v35, v134, v135
  ds_write_b64 v13, v[34:35] offset:3904
  v_mul_f32 v108, v108, v9
  v_mul_f32 v109, v109, v9
  v_mul_f32 v110, v110, v9
  v_mul_f32 v111, v111, v9
  v_cvt_pk_bf16_f32 v36, v108, v109
  v_cvt_pk_bf16_f32 v37, v110, v111
  ds_write_b64 v13, v[36:37] offset:96
  v_mul_f32 v136, v136, v10
  v_mul_f32 v137, v137, v10
  v_mul_f32 v138, v138, v10
  v_mul_f32 v139, v139, v10
  v_cvt_pk_bf16_f32 v38, v136, v137
  v_cvt_pk_bf16_f32 v39, v138, v139
  ds_write_b64 v13, v[38:39] offset:3936
  v_mul_f32 v112, v112, v9
  v_mul_f32 v113, v113, v9
  v_mul_f32 v114, v114, v9
  v_mul_f32 v115, v115, v9
  v_cvt_pk_bf16_f32 v32, v112, v113
  v_cvt_pk_bf16_f32 v33, v114, v115
  ds_write_b64 v13, v[32:33] offset:128
  v_mul_f32 v140, v140, v10
  v_mul_f32 v141, v141, v10
  v_mul_f32 v142, v142, v10
  v_mul_f32 v143, v143, v10
  v_cvt_pk_bf16_f32 v34, v140, v141
  v_cvt_pk_bf16_f32 v35, v142, v143
  ds_write_b64 v13, v[34:35] offset:3968
  v_mul_f32 v116, v116, v9
  v_mul_f32 v117, v117, v9
  v_mul_f32 v118, v118, v9
  v_mul_f32 v119, v119, v9
  v_cvt_pk_bf16_f32 v36, v116, v117
  v_cvt_pk_bf16_f32 v37, v118, v119
  ds_write_b64 v13, v[36:37] offset:160
  v_mul_f32 v144, v144, v10
  v_mul_f32 v145, v145, v10
  v_mul_f32 v146, v146, v10
  v_mul_f32 v147, v147, v10
  v_cvt_pk_bf16_f32 v38, v144, v145
  v_cvt_pk_bf16_f32 v39, v146, v147
  ds_write_b64 v13, v[38:39] offset:4000
  v_mul_f32 v120, v120, v9
  v_mul_f32 v121, v121, v9
  v_mul_f32 v122, v122, v9
  v_mul_f32 v123, v123, v9
  v_cvt_pk_bf16_f32 v32, v120, v121
  v_cvt_pk_bf16_f32 v33, v122, v123
  ds_write_b64 v13, v[32:33] offset:192
  v_mul_f32 v148, v148, v10
  v_mul_f32 v149, v149, v10
  v_mul_f32 v150, v150, v10
  v_mul_f32 v151, v151, v10
  v_cvt_pk_bf16_f32 v34, v148, v149
  v_cvt_pk_bf16_f32 v35, v150, v151
  ds_write_b64 v13, v[34:35] offset:4032
  v_mul_f32 v152, v152, v8
  v_mul_f32 v153, v153, v8
  v_mul_f32 v154, v154, v8
  v_mul_f32 v155, v155, v8
  v_cvt_pk_bf16_f32 v36, v152, v153
  v_cvt_pk_bf16_f32 v37, v154, v155
  ds_write_b64 v11, v[36:37]
  v_mul_f32 v156, v156, v8
  v_mul_f32 v157, v157, v8
  v_mul_f32 v158, v158, v8
  v_mul_f32 v159, v159, v8
  v_cvt_pk_bf16_f32 v38, v156, v157
  v_cvt_pk_bf16_f32 v39, v158, v159
  ds_write_b64 v12, v[38:39]
  s_waitcnt lgkmcnt(0)
  s_barrier
  ds_read2_b32 v[192:193], v15 offset0:0 offset1:1
  ds_read2_b32 v[194:195], v15 offset0:2 offset1:3
  ds_read2_b32 v[196:197], v15 offset0:4 offset1:5
  ds_read2_b32 v[198:199], v15 offset0:6 offset1:7
  ds_read_b32 v200, v15 offset:32
  ds_read_b128 v[32:35], v14 offset:3360
  ds_read_b128 v[36:39], v14 offset:3376
  ds_read_b128 v[40:43], v14 offset:3392
  ds_read_b128 v[52:55], v14 offset:2880
  ds_read_b128 v[56:59], v14 offset:2896
  ds_read_b128 v[60:63], v14 offset:2912
  ds_read_b128 v[72:75], v14 offset:2400
  ds_read_b128 v[76:79], v14 offset:2416
  ds_read_b128 v[80:83], v14 offset:2432
  ds_read_b128 v[92:95], v14 offset:1920
  ds_read_b128 v[96:99], v14 offset:1936
  ds_read_b128 v[100:103], v14 offset:1952
  ds_read_b128 v[112:115], v14 offset:1440
  ds_read_b128 v[116:119], v14 offset:1456
  ds_read_b128 v[120:123], v14 offset:1472
  ds_read_b128 v[132:135], v14 offset:960
  ds_read_b128 v[136:139], v14 offset:976
  ds_read_b128 v[140:143], v14 offset:992
  ds_read_b128 v[152:155], v14 offset:480
  ds_read_b128 v[156:159], v14 offset:496
  ds_read_b128 v[160:163], v14 offset:512
  ds_read_b128 v[172:175], v14
  ds_read_b128 v[176:179], v14 offset:16
  ds_read_b128 v[180:183], v14 offset:32
  s_waitcnt lgkmcnt(15)
  v_dot2_f32_bf16 v204, v192, v32, 0
  v_dot2_f32_bf16 v205, v192, v52, 0
  v_dot2_f32_bf16 v206, v192, v72, 0
  s_waitcnt lgkmcnt(14)
  v_dot2_f32_bf16 v207, v192, v92, 0
  ds_read_b128 v[44:47], v14 offset:3408
  ds_read_b64 v[48:49], v14 offset:3424
  v_dot2_f32_bf16 v204, v193, v33, v204
  v_dot2_f32_bf16 v205, v193, v53, v205
  v_dot2_f32_bf16 v206, v193, v73, v206
  v_dot2_f32_bf16 v207, v193, v93, v207
  ds_read_b128 v[64:67], v14 offset:2928
  ds_read_b64 v[68:69], v14 offset:2944
  v_dot2_f32_bf16 v204, v194, v34, v204
  v_dot2_f32_bf16 v205, v194, v54, v205
  v_dot2_f32_bf16 v206, v194, v74, v206
  v_dot2_f32_bf16 v207, v194, v94, v207
  ds_read_b128 v[84:87], v14 offset:2448
  ds_read_b64 v[88:89], v14 offset:2464
  v_dot2_f32_bf16 v204, v195, v35, v204
  v_dot2_f32_bf16 v205, v195, v55, v205
  v_dot2_f32_bf16 v206, v195, v75, v206
  v_dot2_f32_bf16 v207, v195, v95, v207
  ds_read_b128 v[104:107], v14 offset:1968
  ds_read_b64 v[108:109], v14 offset:1984
  v_dot2_f32_bf16 v204, v196, v36, v204
  v_dot2_f32_bf16 v205, v196, v56, v205
  v_dot2_f32_bf16 v206, v196, v76, v206
  s_waitcnt lgkmcnt(15)
  v_dot2_f32_bf16 v207, v196, v96, v207
  ds_read_b128 v[124:127], v14 offset:1488
  ds_read_b64 v[128:129], v14 offset:1504
  v_dot2_f32_bf16 v204, v197, v37, v204
  v_dot2_f32_bf16 v205, v197, v57, v205
  v_dot2_f32_bf16 v206, v197, v77, v206
  v_dot2_f32_bf16 v207, v197, v97, v207
  ds_read_b128 v[144:147], v14 offset:1008
  ds_read_b64 v[148:149], v14 offset:1024
  v_dot2_f32_bf16 v204, v198, v38, v204
  v_dot2_f32_bf16 v205, v198, v58, v205
  v_dot2_f32_bf16 v206, v198, v78, v206
  v_dot2_f32_bf16 v207, v198, v98, v207
  ds_read_b128 v[164:167], v14 offset:528
  ds_read_b64 v[168:169], v14 offset:544
  v_dot2_f32_bf16 v204, v199, v39, v204
  v_dot2_f32_bf16 v205, v199, v59, v205
  v_dot2_f32_bf16 v206, v199, v79, v206
  v_dot2_f32_bf16 v207, v199, v99, v207
  ds_read_b128 v[184:187], v14 offset:48
  ds_read_b64 v[188:189], v14 offset:64
  v_dot2_f32_bf16 v204, v200, v40, v204
  v_dot2_f32_bf16 v205, v200, v60, v205
  v_dot2_f32_bf16 v206, v200, v80, v206
  v_dot2_f32_bf16 v207, v200, v100, v207
  v_dot2_f32_bf16 v208, v192, v112, 0
  v_dot2_f32_bf16 v209, v192, v132, 0
  s_waitcnt lgkmcnt(15)
  v_dot2_f32_bf16 v210, v192, v152, 0
  v_dot2_f32_bf16 v211, v192, v172, 0
  v_dot2_f32_bf16 v208, v193, v113, v208
  v_dot2_f32_bf16 v209, v193, v133, v209
  v_dot2_f32_bf16 v210, v193, v153, v210
  v_dot2_f32_bf16 v211, v193, v173, v211
  v_dot2_f32_bf16 v208, v194, v114, v208
  v_dot2_f32_bf16 v209, v194, v134, v209
  v_dot2_f32_bf16 v210, v194, v154, v210
  v_dot2_f32_bf16 v211, v194, v174, v211
  v_dot2_f32_bf16 v208, v195, v115, v208
  v_dot2_f32_bf16 v209, v195, v135, v209
  v_dot2_f32_bf16 v210, v195, v155, v210
  v_dot2_f32_bf16 v211, v195, v175, v211
  v_dot2_f32_bf16 v208, v196, v116, v208
  v_dot2_f32_bf16 v209, v196, v136, v209
  v_dot2_f32_bf16 v210, v196, v156, v210
  v_dot2_f32_bf16 v211, v196, v176, v211
  v_dot2_f32_bf16 v208, v197, v117, v208
  v_dot2_f32_bf16 v209, v197, v137, v209
  v_dot2_f32_bf16 v210, v197, v157, v210
  v_dot2_f32_bf16 v211, v197, v177, v211
  v_dot2_f32_bf16 v208, v198, v118, v208
  v_dot2_f32_bf16 v209, v198, v138, v209
  v_dot2_f32_bf16 v210, v198, v158, v210
  v_dot2_f32_bf16 v211, v198, v178, v211
  v_dot2_f32_bf16 v208, v199, v119, v208
  v_dot2_f32_bf16 v209, v199, v139, v209
  v_dot2_f32_bf16 v210, v199, v159, v210
  v_dot2_f32_bf16 v211, v199, v179, v211
  v_dot2_f32_bf16 v208, v200, v120, v208
  v_dot2_f32_bf16 v209, v200, v140, v209
  v_dot2_f32_bf16 v210, v200, v160, v210
  v_dot2_f32_bf16 v211, v200, v180, v211
  v_mul_f32 v204, 0x3eae1a93, v204
  v_mul_f32 v205, 0x3eae1a93, v205
  v_mul_f32 v206, 0x3eae1a93, v206
  v_mul_f32 v207, 0x3eae1a93, v207
  v_mul_f32 v208, 0x3eae1a93, v208
  v_mul_f32 v209, 0x3eae1a93, v209
  v_mul_f32 v210, 0x3eae1a93, v210
  v_mul_f32 v211, 0x3eae1a93, v211
  v_cndmask_b32 v205, v18, v205, s[60:61]
  v_cndmask_b32 v206, v18, v206, s[62:63]
  v_cndmask_b32 v207, v18, v207, s[64:65]
  v_cndmask_b32 v208, v18, v208, s[66:67]
  v_cndmask_b32 v209, v18, v209, s[68:69]
  v_cndmask_b32 v210, v18, v210, s[70:71]
  v_cndmask_b32 v211, v18, v211, s[72:73]
  v_max3_f32 v244, v204, v205, v206
  v_max3_f32 v245, v207, v208, v209
  v_max3_f32 v244, v244, v210, v211
  v_max_f32 v244, v244, v245
  v_sub_f32 v204, v204, v244
  v_sub_f32 v205, v205, v244
  v_sub_f32 v206, v206, v244
  v_sub_f32 v207, v207, v244
  v_sub_f32 v208, v208, v244
  v_sub_f32 v209, v209, v244
  v_sub_f32 v210, v210, v244
  v_sub_f32 v211, v211, v244
  v_exp_f32 v204, v204
  v_exp_f32 v205, v205
  v_exp_f32 v206, v206
  v_exp_f32 v207, v207
  v_exp_f32 v208, v208
  v_exp_f32 v209, v209
  v_exp_f32 v210, v210
  v_exp_f32 v211, v211
  v_cvt_pk_bf16_f32 v212, v204, v205
  v_cvt_pk_bf16_f32 v213, v206, v207
  v_cvt_pk_bf16_f32 v214, v208, v209
  v_cvt_pk_bf16_f32 v215, v210, v211
  v_dot2_f32_bf16 v246, v212, s76, 0
  v_dot2_f32_bf16 v246, v213, s76, v246
  v_dot2_f32_bf16 v246, v214, s76, v246
  v_dot2_f32_bf16 v246, v215, s76, v246
  v_perm_b32 v236, v61, v41, s74
  v_perm_b32 v237, v61, v41, s75
  v_perm_b32 v238, v62, v42, s74
  v_perm_b32 v239, v62, v42, s75
  v_dot2_f32_bf16 v216, v212, v236, 0
  v_dot2_f32_bf16 v217, v212, v237, 0
  v_perm_b32 v240, v63, v43, s74
  v_perm_b32 v241, v63, v43, s75
  v_dot2_f32_bf16 v218, v212, v238, 0
  v_dot2_f32_bf16 v219, v212, v239, 0
  s_waitcnt lgkmcnt(13)
  v_perm_b32 v242, v64, v44, s74
  v_perm_b32 v243, v64, v44, s75
  v_dot2_f32_bf16 v220, v212, v240, 0
  v_dot2_f32_bf16 v221, v212, v241, 0
  v_perm_b32 v236, v65, v45, s74
  v_perm_b32 v237, v65, v45, s75
  v_dot2_f32_bf16 v222, v212, v242, 0
  v_dot2_f32_bf16 v223, v212, v243, 0
  v_perm_b32 v238, v66, v46, s74
  v_perm_b32 v239, v66, v46, s75
  v_dot2_f32_bf16 v224, v212, v236, 0
  v_dot2_f32_bf16 v225, v212, v237, 0
  v_perm_b32 v240, v67, v47, s74
  v_perm_b32 v241, v67, v47, s75
  v_dot2_f32_bf16 v226, v212, v238, 0
  v_dot2_f32_bf16 v227, v212, v239, 0
  s_waitcnt lgkmcnt(12)
  v_perm_b32 v242, v68, v48, s74
  v_perm_b32 v243, v68, v48, s75
  v_dot2_f32_bf16 v228, v212, v240, 0
  v_dot2_f32_bf16 v229, v212, v241, 0
  v_perm_b32 v236, v69, v49, s74
  v_perm_b32 v237, v69, v49, s75
  v_dot2_f32_bf16 v230, v212, v242, 0
  v_dot2_f32_bf16 v231, v212, v243, 0
  v_perm_b32 v238, v101, v81, s74
  v_perm_b32 v239, v101, v81, s75
  v_dot2_f32_bf16 v232, v212, v236, 0
  v_dot2_f32_bf16 v233, v212, v237, 0
  v_rcp_f32 v246, v246
  v_perm_b32 v240, v102, v82, s74
  v_perm_b32 v241, v102, v82, s75
  v_dot2_f32_bf16 v216, v213, v238, v216
  v_dot2_f32_bf16 v217, v213, v239, v217
  v_perm_b32 v242, v103, v83, s74
  v_perm_b32 v243, v103, v83, s75
  v_dot2_f32_bf16 v218, v213, v240, v218
  v_dot2_f32_bf16 v219, v213, v241, v219
  s_waitcnt lgkmcnt(9)
  v_perm_b32 v236, v104, v84, s74
  v_perm_b32 v237, v104, v84, s75
  v_dot2_f32_bf16 v220, v213, v242, v220
  v_dot2_f32_bf16 v221, v213, v243, v221
  v_perm_b32 v238, v105, v85, s74
  v_perm_b32 v239, v105, v85, s75
  v_dot2_f32_bf16 v222, v213, v236, v222
  v_dot2_f32_bf16 v223, v213, v237, v223
  v_perm_b32 v240, v106, v86, s74
  v_perm_b32 v241, v106, v86, s75
  v_dot2_f32_bf16 v224, v213, v238, v224
  v_dot2_f32_bf16 v225, v213, v239, v225
  v_perm_b32 v242, v107, v87, s74
  v_perm_b32 v243, v107, v87, s75
  v_dot2_f32_bf16 v226, v213, v240, v226
  v_dot2_f32_bf16 v227, v213, v241, v227
  s_waitcnt lgkmcnt(8)
  v_perm_b32 v236, v108, v88, s74
  v_perm_b32 v237, v108, v88, s75
  v_dot2_f32_bf16 v228, v213, v242, v228
  v_dot2_f32_bf16 v229, v213, v243, v229
  v_perm_b32 v238, v109, v89, s74
  v_perm_b32 v239, v109, v89, s75
  v_dot2_f32_bf16 v230, v213, v236, v230
  v_dot2_f32_bf16 v231, v213, v237, v231
  v_perm_b32 v240, v141, v121, s74
  v_perm_b32 v241, v141, v121, s75
  v_dot2_f32_bf16 v232, v213, v238, v232
  v_dot2_f32_bf16 v233, v213, v239, v233
  v_perm_b32 v242, v142, v122, s74
  v_perm_b32 v243, v142, v122, s75
  v_dot2_f32_bf16 v216, v214, v240, v216
  v_dot2_f32_bf16 v217, v214, v241, v217
  v_perm_b32 v236, v143, v123, s74
  v_perm_b32 v237, v143, v123, s75
  v_dot2_f32_bf16 v218, v214, v242, v218
  v_dot2_f32_bf16 v219, v214, v243, v219
  s_waitcnt lgkmcnt(5)
  v_perm_b32 v238, v144, v124, s74
  v_perm_b32 v239, v144, v124, s75
  v_dot2_f32_bf16 v220, v214, v236, v220
  v_dot2_f32_bf16 v221, v214, v237, v221
  v_perm_b32 v240, v145, v125, s74
  v_perm_b32 v241, v145, v125, s75
  v_dot2_f32_bf16 v222, v214, v238, v222
  v_dot2_f32_bf16 v223, v214, v239, v223
  v_perm_b32 v242, v146, v126, s74
  v_perm_b32 v243, v146, v126, s75
  v_dot2_f32_bf16 v224, v214, v240, v224
  v_dot2_f32_bf16 v225, v214, v241, v225
  v_perm_b32 v236, v147, v127, s74
  v_perm_b32 v237, v147, v127, s75
  v_dot2_f32_bf16 v226, v214, v242, v226
  v_dot2_f32_bf16 v227, v214, v243, v227
  s_waitcnt lgkmcnt(4)
  v_perm_b32 v238, v148, v128, s74
  v_perm_b32 v239, v148, v128, s75
  v_dot2_f32_bf16 v228, v214, v236, v228
  v_dot2_f32_bf16 v229, v214, v237, v229
  v_perm_b32 v240, v149, v129, s74
  v_perm_b32 v241, v149, v129, s75
  v_dot2_f32_bf16 v230, v214, v238, v230
  v_dot2_f32_bf16 v231, v214, v239, v231
  v_perm_b32 v242, v181, v161, s74
  v_perm_b32 v243, v181, v161, s75
  v_dot2_f32_bf16 v232, v214, v240, v232
  v_dot2_f32_bf16 v233, v214, v241, v233
  v_perm_b32 v236, v182, v162, s74
  v_perm_b32 v237, v182, v162, s75
  v_dot2_f32_bf16 v216, v215, v242, v216
  v_dot2_f32_bf16 v217, v215, v243, v217
  v_perm_b32 v238, v183, v163, s74
  v_perm_b32 v239, v183, v163, s75
  v_dot2_f32_bf16 v218, v215, v236, v218
  v_dot2_f32_bf16 v219, v215, v237, v219
  s_waitcnt lgkmcnt(1)
  v_perm_b32 v240, v184, v164, s74
  v_perm_b32 v241, v184, v164, s75
  v_dot2_f32_bf16 v220, v215, v238, v220
  v_dot2_f32_bf16 v221, v215, v239, v221
  v_perm_b32 v242, v185, v165, s74
  v_perm_b32 v243, v185, v165, s75
  v_dot2_f32_bf16 v222, v215, v240, v222
  v_dot2_f32_bf16 v223, v215, v241, v223
  v_perm_b32 v236, v186, v166, s74
  v_perm_b32 v237, v186, v166, s75
  v_dot2_f32_bf16 v224, v215, v242, v224
  v_dot2_f32_bf16 v225, v215, v243, v225
  v_perm_b32 v238, v187, v167, s74
  v_perm_b32 v239, v187, v167, s75
  v_dot2_f32_bf16 v226, v215, v236, v226
  v_dot2_f32_bf16 v227, v215, v237, v227
  s_waitcnt lgkmcnt(0)
  v_perm_b32 v240, v188, v168, s74
  v_perm_b32 v241, v188, v168, s75
  v_dot2_f32_bf16 v228, v215, v238, v228
  v_dot2_f32_bf16 v229, v215, v239, v229
  v_perm_b32 v242, v189, v169, s74
  v_perm_b32 v243, v189, v169, s75
  v_dot2_f32_bf16 v230, v215, v240, v230
  v_dot2_f32_bf16 v231, v215, v241, v231
  v_dot2_f32_bf16 v232, v215, v242, v232
  v_dot2_f32_bf16 v233, v215, v243, v233
  v_mul_f32 v216, v216, v246
  v_mul_f32 v217, v217, v246
  v_mul_f32 v218, v218, v246
  v_mul_f32 v219, v219, v246
  v_mul_f32 v220, v220, v246
  v_mul_f32 v221, v221, v246
  v_mul_f32 v222, v222, v246
  v_mul_f32 v223, v223, v246
  v_mul_f32 v224, v224, v246
  v_mul_f32 v225, v225, v246
  v_mul_f32 v226, v226, v246
  v_mul_f32 v227, v227, v246
  v_mul_f32 v228, v228, v246
  v_mul_f32 v229, v229, v246
  v_mul_f32 v230, v230, v246
  v_mul_f32 v231, v231, v246
  v_mul_f32 v232, v232, v246
  v_mul_f32 v233, v233, v246
  v_cvt_pk_bf16_f32 v192, v216, v217
  v_cvt_pk_bf16_f32 v193, v218, v219
  v_cvt_pk_bf16_f32 v194, v220, v221
  v_cvt_pk_bf16_f32 v195, v222, v223
  v_cvt_pk_bf16_f32 v196, v224, v225
  v_cvt_pk_bf16_f32 v197, v226, v227
  v_cvt_pk_bf16_f32 v198, v228, v229
  v_cvt_pk_bf16_f32 v199, v230, v231
  v_cvt_pk_bf16_f32 v200, v232, v233
  buffer_store_dwordx4 v[192:195], v16, s[16:19], 0 offen
  buffer_store_dwordx4 v[196:199], v16, s[16:19], 0 offen offset:256
  buffer_store_dword v200, v17, s[16:19], 0 offen
L_a1_kernel_end:
  s_endpgm
.globl b2l_kernel
.p2align 8
.type b2l_kernel,@function
b2l_kernel:
  s_cmp_ge_u32 s2, 256
  s_cbranch_scc1 L_b2l_kernel_end
  s_load_dwordx2 s[44:45], s[0:1], 56
  s_load_dwordx2 s[50:51], s[0:1], 72
  v_lshrrev_b32 v12, 6, v0
  v_and_b32 v1, 63, v0
  v_readfirstlane_b32 s32, v12
  v_lshrrev_b32 v2, 3, v1
  v_and_b32 v3, 7, v1
  v_mov_b32 v11, 0x7ffffff0
  s_and_b32 s36, s2, 7
  s_lshl_b32 s36, s36, 5
  s_lshr_b32 s37, s2, 3
  s_add_u32 s33, s36, s37
  s_lshr_b32 s36, s33, 1
  s_mul_i32 s36, s36, 18432
  s_and_b32 s37, s33, 1
  s_lshl_b32 s37, s37, 7
  s_add_u32 s36, s36, s37
  v_lshlrev_b32 v12, 8, v2
  v_lshl_add_u32 v12, v3, 4, v12
  s_lshl_b32 s37, s32, 12
  s_add_u32 s37, s37, s36
  v_add_u32 v4, s37, v12
  s_lshl_b32 s37, s32, 2
  s_add_u32 s37, s37, s36
  s_add_u32 s37, s37, 16384
  v_add_u32 v5, s37, v12
  s_lshl_b32 s36, s33, 3
  v_add_u32 v13, s36, v3
  v_lshlrev_b32 v8, 2, v13
  v_mul_u32_u24 v13, 1152, v13
  v_lshrrev_b32 v12, 2, v2
  v_lshl_add_u32 v13, v12, 6, v13
  v_and_b32 v12, 3, v2
  v_lshl_add_u32 v13, v12, 3, v13
  s_lshl_b32 s37, s32, 8
  v_add_u32 v6, s37, v13
  s_lshr_b32 s37, s32, 1
  s_lshl_b32 s37, s37, 5
  s_and_b32 s38, s32, 1
  s_lshl_b32 s38, s38, 2
  s_add_u32 s37, s37, s38
  s_add_u32 s37, s37, 1024
  v_add_u32 v7, s37, v13
  v_lshlrev_b32 v10, 4, v3
  s_lshl_b32 s37, s32, 2
  v_add_u32 v9, s37, v10
  s_mul_i32 s36, s32, 9437180
  v_add_u32 v34, s36, v5
  v_lshlrev_b32 v12, 5, v1
  s_lshl_b32 s36, s32, 11
  s_add_u32 s36, s36, 1024
  v_add_u32 v35, s36, v12
  s_lshl_b32 s36, s32, 3
  s_add_u32 s36, s36, 1024
  v_add_u32 v36, s36, v12
  v_lshlrev_b32 v12, 4, v8
  v_lshl_add_u32 v37, v2, 3, v12
  s_mov_b32 s53, 2359296
  s_mov_b32 s54, 4718592
  s_mov_b32 s55, 7077888
  s_mov_b32 s56, 9437184
  s_mov_b32 s57, 11796480
  s_mov_b32 s58, 14155776
  s_mov_b32 s59, 16515072
  s_mov_b32 s60, 18874368
  s_mov_b32 s61, 21233664
  s_mov_b32 s62, 23592960
  s_mov_b32 s63, 25952256
  s_mov_b32 s64, 28311552
  s_mov_b32 s65, 30670848
  s_mov_b32 s66, 33030144
  s_mov_b32 s67, 35389440
  s_waitcnt lgkmcnt(0)
  s_add_u32 s4, s50, 11096064
  s_addc_u32 s5, s51, 0
  s_and_b32 s5, s5, 0xffff
  s_mov_b32 s6, 37748736
  s_mov_b32 s7, 0x20000
  buffer_load_dwordx4 v[96:99], v34, s[4:7], 0 offen
  buffer_load_dwordx4 v[100:103], v34, s[4:7], s53 offen
  buffer_load_dwordx4 v[104:107], v34, s[4:7], s54 offen
  buffer_load_dwordx4 v[108:111], v34, s[4:7], s55 offen
  s_add_u32 s8, s50, 0
  s_addc_u32 s9, s51, 0
  s_and_b32 s9, s9, 0xffff
  s_mov_b32 s10, 2359296
  s_mov_b32 s11, 0x20000
  s_add_u32 s12, s50, 9850880
  s_addc_u32 s13, s51, 0
  s_and_b32 s13, s13, 0xffff
  s_mov_b32 s14, 131072
  s_mov_b32 s15, 0x20000
  s_add_u32 s16, s50, 9834496
  s_addc_u32 s17, s51, 0
  s_and_b32 s17, s17, 0xffff
  s_mov_b32 s18, 8192
  s_mov_b32 s19, 0x20000
  s_add_u32 s20, s50, 9842688
  s_addc_u32 s21, s51, 0
  s_and_b32 s21, s21, 0xffff
  s_mov_b32 s22, 8192
  s_mov_b32 s23, 0x20000
  buffer_load_dwordx2 v[38:39], v37, s[12:15], 0 offen
  buffer_load_dword v40, v8, s[16:19], 0 offen
  buffer_load_dword v41, v8, s[20:23], 0 offen
  buffer_load_dwordx4 v[44:47], v4, s[8:11], 0 offen
  buffer_load_dwordx4 v[48:51], v4, s[8:11], 0 offen offset:2048
  buffer_load_dword v52, v5, s[8:11], 0 offen
  buffer_load_dwordx4 v[112:115], v4, s[4:7], 0 offen
  buffer_load_dwordx4 v[116:119], v4, s[4:7], 0 offen offset:2048
  buffer_load_dwordx4 v[120:123], v4, s[4:7], s53 offen
  buffer_load_dwordx4 v[124:127], v4, s[4:7], s53 offen offset:2048
  buffer_load_dwordx4 v[128:131], v4, s[4:7], s54 offen
  buffer_load_dwordx4 v[132:135], v4, s[4:7], s54 offen offset:2048
  buffer_load_dwordx4 v[136:139], v4, s[4:7], s55 offen
  buffer_load_dwordx4 v[140:143], v4, s[4:7], s55 offen offset:2048
  buffer_load_dwordx4 v[144:147], v4, s[4:7], s56 offen
  buffer_load_dwordx4 v[148:151], v4, s[4:7], s56 offen offset:2048
  buffer_load_dwordx4 v[152:155], v4, s[4:7], s57 offen
  buffer_load_dwordx4 v[156:159], v4, s[4:7], s57 offen offset:2048
  buffer_load_dwordx4 v[160:163], v4, s[4:7], s58 offen
  buffer_load_dwordx4 v[164:167], v4, s[4:7], s58 offen offset:2048
  buffer_load_dwordx4 v[168:171], v4, s[4:7], s59 offen
  buffer_load_dwordx4 v[172:175], v4, s[4:7], s59 offen offset:2048
  buffer_load_dwordx4 v[176:179], v4, s[4:7], s60 offen
  buffer_load_dwordx4 v[180:183], v4, s[4:7], s60 offen offset:2048
  buffer_load_dwordx4 v[184:187], v4, s[4:7], s61 offen
  buffer_load_dwordx4 v[188:191], v4, s[4:7], s61 offen offset:2048
  buffer_load_dwordx4 v[192:195], v4, s[4:7], s62 offen
  buffer_load_dwordx4 v[196:199], v4, s[4:7], s62 offen offset:2048
  buffer_load_dwordx4 v[200:203], v4, s[4:7], s63 offen
  buffer_load_dwordx4 v[204:207], v4, s[4:7], s63 offen offset:2048
  buffer_load_dwordx4 v[208:211], v4, s[4:7], s64 offen
  buffer_load_dwordx4 v[212:215], v4, s[4:7], s64 offen offset:2048
  buffer_load_dwordx4 v[216:219], v4, s[4:7], s65 offen
  buffer_load_dwordx4 v[220:223], v4, s[4:7], s65 offen offset:2048
  buffer_load_dwordx4 v[224:227], v4, s[4:7], s66 offen
  buffer_load_dwordx4 v[228:231], v4, s[4:7], s66 offen offset:2048
  buffer_load_dwordx4 v[232:235], v4, s[4:7], s67 offen
  buffer_load_dwordx4 v[236:239], v4, s[4:7], s67 offen offset:2048
  s_mov_b32 s40, s44
  s_and_b32 s41, s45, 0xffff
  s_mov_b32 s42, 2359296
  s_mov_b32 s43, 0x20000
  s_mov_b32 s68, 0x3f80
  s_mov_b32 s69, 0x3f800000
  s_waitcnt vmcnt(41)
  v_lshlrev_b32 v84, 16, v96
  v_and_b32 v85, 0xffff0000, v96
  v_lshlrev_b32 v86, 16, v97
  v_and_b32 v87, 0xffff0000, v97
  v_lshlrev_b32 v88, 16, v98
  v_and_b32 v89, 0xffff0000, v98
  v_lshlrev_b32 v90, 16, v99
  v_and_b32 v91, 0xffff0000, v99
  s_waitcnt vmcnt(40)
  v_dot2c_f32_bf16 v84, s68, v100
  v_dot2c_f32_bf16 v85, s69, v100
  v_dot2c_f32_bf16 v86, s68, v101
  v_dot2c_f32_bf16 v87, s69, v101
  v_dot2c_f32_bf16 v88, s68, v102
  v_dot2c_f32_bf16 v89, s69, v102
  v_dot2c_f32_bf16 v90, s68, v103
  v_dot2c_f32_bf16 v91, s69, v103
  s_waitcnt vmcnt(39)
  v_dot2c_f32_bf16 v84, s68, v104
  v_dot2c_f32_bf16 v85, s69, v104
  v_dot2c_f32_bf16 v86, s68, v105
  v_dot2c_f32_bf16 v87, s69, v105
  v_dot2c_f32_bf16 v88, s68, v106
  v_dot2c_f32_bf16 v89, s69, v106
  v_dot2c_f32_bf16 v90, s68, v107
  v_dot2c_f32_bf16 v91, s69, v107
  s_waitcnt vmcnt(38)
  v_dot2c_f32_bf16 v84, s68, v108
  v_dot2c_f32_bf16 v85, s69, v108
  v_dot2c_f32_bf16 v86, s68, v109
  v_dot2c_f32_bf16 v87, s69, v109
  v_dot2c_f32_bf16 v88, s68, v110
  v_dot2c_f32_bf16 v89, s69, v110
  v_dot2c_f32_bf16 v90, s68, v111
  v_dot2c_f32_bf16 v91, s69, v111
  ds_write_b128 v35, v[84:87]
  s_nop 1
  ds_write_b128 v35, v[88:91] offset:16
  s_waitcnt vmcnt(37)
  v_add_f32 v38, v38, v39
  s_nop 1
  v_add_f32_dpp v38, v38, v38 row_ror:8 row_mask:0xf bank_mask:0xf
  v_mov_b32 v12, v38
  s_nop 1
  v_permlane16_swap_b32 v38, v12
  v_add_f32 v38, v38, v12
  v_mov_b32 v12, v38
  s_nop 1
  v_permlane32_swap_b32 v38, v12
  v_add_f32 v38, v38, v12
  v_mov_b32 v12, 0x3727c5ac
  v_fmac_f32 v12, 0x3ae38e39, v38
  v_rcp_f32 v38, v12
  s_waitcnt vmcnt(35)
  v_add_f32 v40, v40, v41
  s_waitcnt lgkmcnt(0)
  s_barrier
  ds_read_b64 v[96:97], v36
  ds_read_b64 v[98:99], v36 offset:2048
  ds_read_b64 v[100:101], v36 offset:4096
  ds_read_b64 v[102:103], v36 offset:6144
  s_waitcnt vmcnt(31)
  v_lshlrev_b32 v64, 16, v112
  v_and_b32 v65, 0xffff0000, v112
  v_lshlrev_b32 v66, 16, v113
  v_and_b32 v67, 0xffff0000, v113
  v_lshlrev_b32 v68, 16, v114
  v_and_b32 v69, 0xffff0000, v114
  v_lshlrev_b32 v70, 16, v115
  v_and_b32 v71, 0xffff0000, v115
  s_waitcnt vmcnt(30)
  v_lshlrev_b32 v72, 16, v116
  v_and_b32 v73, 0xffff0000, v116
  v_lshlrev_b32 v74, 16, v117
  v_and_b32 v75, 0xffff0000, v117
  v_lshlrev_b32 v76, 16, v118
  v_and_b32 v77, 0xffff0000, v118
  v_lshlrev_b32 v78, 16, v119
  v_and_b32 v79, 0xffff0000, v119
  s_waitcnt vmcnt(29)
  v_dot2c_f32_bf16 v64, s68, v120
  v_dot2c_f32_bf16 v65, s69, v120
  v_dot2c_f32_bf16 v66, s68, v121
  v_dot2c_f32_bf16 v67, s69, v121
  v_dot2c_f32_bf16 v68, s68, v122
  v_dot2c_f32_bf16 v69, s69, v122
  v_dot2c_f32_bf16 v70, s68, v123
  v_dot2c_f32_bf16 v71, s69, v123
  s_waitcnt vmcnt(28)
  v_dot2c_f32_bf16 v72, s68, v124
  v_dot2c_f32_bf16 v73, s69, v124
  v_dot2c_f32_bf16 v74, s68, v125
  v_dot2c_f32_bf16 v75, s69, v125
  v_dot2c_f32_bf16 v76, s68, v126
  v_dot2c_f32_bf16 v77, s69, v126
  v_dot2c_f32_bf16 v78, s68, v127
  v_dot2c_f32_bf16 v79, s69, v127
  s_waitcnt vmcnt(27)
  v_dot2c_f32_bf16 v64, s68, v128
  v_dot2c_f32_bf16 v65, s69, v128
  v_dot2c_f32_bf16 v66, s68, v129
  v_dot2c_f32_bf16 v67, s69, v129
  v_dot2c_f32_bf16 v68, s68, v130
  v_dot2c_f32_bf16 v69, s69, v130
  v_dot2c_f32_bf16 v70, s68, v131
  v_dot2c_f32_bf16 v71, s69, v131
  s_waitcnt vmcnt(26)
  v_dot2c_f32_bf16 v72, s68, v132
  v_dot2c_f32_bf16 v73, s69, v132
  v_dot2c_f32_bf16 v74, s68, v133
  v_dot2c_f32_bf16 v75, s69, v133
  v_dot2c_f32_bf16 v76, s68, v134
  v_dot2c_f32_bf16 v77, s69, v134
  v_dot2c_f32_bf16 v78, s68, v135
  v_dot2c_f32_bf16 v79, s69, v135
  s_waitcnt vmcnt(25)
  v_dot2c_f32_bf16 v64, s68, v136
  v_dot2c_f32_bf16 v65, s69, v136
  v_dot2c_f32_bf16 v66, s68, v137
  v_dot2c_f32_bf16 v67, s69, v137
  v_dot2c_f32_bf16 v68, s68, v138
  v_dot2c_f32_bf16 v69, s69, v138
  v_dot2c_f32_bf16 v70, s68, v139
  v_dot2c_f32_bf16 v71, s69, v139
  s_waitcnt vmcnt(24)
  v_dot2c_f32_bf16 v72, s68, v140
  v_dot2c_f32_bf16 v73, s69, v140
  v_dot2c_f32_bf16 v74, s68, v141
  v_dot2c_f32_bf16 v75, s69, v141
  v_dot2c_f32_bf16 v76, s68, v142
  v_dot2c_f32_bf16 v77, s69, v142
  v_dot2c_f32_bf16 v78, s68, v143
  v_dot2c_f32_bf16 v79, s69, v143
  s_waitcnt vmcnt(23)
  v_dot2c_f32_bf16 v64, s68, v144
  v_dot2c_f32_bf16 v65, s69, v144
  v_dot2c_f32_bf16 v66, s68, v145
  v_dot2c_f32_bf16 v67, s69, v145
  v_dot2c_f32_bf16 v68, s68, v146
  v_dot2c_f32_bf16 v69, s69, v146
  v_dot2c_f32_bf16 v70, s68, v147
  v_dot2c_f32_bf16 v71, s69, v147
  s_waitcnt vmcnt(22)
  v_dot2c_f32_bf16 v72, s68, v148
  v_dot2c_f32_bf16 v73, s69, v148
  v_dot2c_f32_bf16 v74, s68, v149
  v_dot2c_f32_bf16 v75, s69, v149
  v_dot2c_f32_bf16 v76, s68, v150
  v_dot2c_f32_bf16 v77, s69, v150
  v_dot2c_f32_bf16 v78, s68, v151
  v_dot2c_f32_bf16 v79, s69, v151
  s_waitcnt vmcnt(21)
  v_dot2c_f32_bf16 v64, s68, v152
  v_dot2c_f32_bf16 v65, s69, v152
  v_dot2c_f32_bf16 v66, s68, v153
  v_dot2c_f32_bf16 v67, s69, v153
  v_dot2c_f32_bf16 v68, s68, v154
  v_dot2c_f32_bf16 v69, s69, v154
  v_dot2c_f32_bf16 v70, s68, v155
  v_dot2c_f32_bf16 v71, s69, v155
  s_waitcnt vmcnt(20)
  v_dot2c_f32_bf16 v72, s68, v156
  v_dot2c_f32_bf16 v73, s69, v156
  v_dot2c_f32_bf16 v74, s68, v157
  v_dot2c_f32_bf16 v75, s69, v157
  v_dot2c_f32_bf16 v76, s68, v158
  v_dot2c_f32_bf16 v77, s69, v158
  v_dot2c_f32_bf16 v78, s68, v159
  v_dot2c_f32_bf16 v79, s69, v159
  s_waitcnt vmcnt(19)
  v_dot2c_f32_bf16 v64, s68, v160
  v_dot2c_f32_bf16 v65, s69, v160
  v_dot2c_f32_bf16 v66, s68, v161
  v_dot2c_f32_bf16 v67, s69, v161
  v_dot2c_f32_bf16 v68, s68, v162
  v_dot2c_f32_bf16 v69, s69, v162
  v_dot2c_f32_bf16 v70, s68, v163
  v_dot2c_f32_bf16 v71, s69, v163
  s_waitcnt vmcnt(18)
  v_dot2c_f32_bf16 v72, s68, v164
  v_dot2c_f32_bf16 v73, s69, v164
  v_dot2c_f32_bf16 v74, s68, v165
  v_dot2c_f32_bf16 v75, s69, v165
  v_dot2c_f32_bf16 v76, s68, v166
  v_dot2c_f32_bf16 v77, s69, v166
  v_dot2c_f32_bf16 v78, s68, v167
  v_dot2c_f32_bf16 v79, s69, v167
  s_waitcnt vmcnt(17)
  v_dot2c_f32_bf16 v64, s68, v168
  v_dot2c_f32_bf16 v65, s69, v168
  v_dot2c_f32_bf16 v66, s68, v169
  v_dot2c_f32_bf16 v67, s69, v169
  v_dot2c_f32_bf16 v68, s68, v170
  v_dot2c_f32_bf16 v69, s69, v170
  v_dot2c_f32_bf16 v70, s68, v171
  v_dot2c_f32_bf16 v71, s69, v171
  s_waitcnt vmcnt(16)
  v_dot2c_f32_bf16 v72, s68, v172
  v_dot2c_f32_bf16 v73, s69, v172
  v_dot2c_f32_bf16 v74, s68, v173
  v_dot2c_f32_bf16 v75, s69, v173
  v_dot2c_f32_bf16 v76, s68, v174
  v_dot2c_f32_bf16 v77, s69, v174
  v_dot2c_f32_bf16 v78, s68, v175
  v_dot2c_f32_bf16 v79, s69, v175
  s_waitcnt vmcnt(15)
  v_dot2c_f32_bf16 v64, s68, v176
  v_dot2c_f32_bf16 v65, s69, v176
  v_dot2c_f32_bf16 v66, s68, v177
  v_dot2c_f32_bf16 v67, s69, v177
  v_dot2c_f32_bf16 v68, s68, v178
  v_dot2c_f32_bf16 v69, s69, v178
  v_dot2c_f32_bf16 v70, s68, v179
  v_dot2c_f32_bf16 v71, s69, v179
  s_waitcnt vmcnt(14)
  v_dot2c_f32_bf16 v72, s68, v180
  v_dot2c_f32_bf16 v73, s69, v180
  v_dot2c_f32_bf16 v74, s68, v181
  v_dot2c_f32_bf16 v75, s69, v181
  v_dot2c_f32_bf16 v76, s68, v182
  v_dot2c_f32_bf16 v77, s69, v182
  v_dot2c_f32_bf16 v78, s68, v183
  v_dot2c_f32_bf16 v79, s69, v183
  s_waitcnt vmcnt(13)
  v_dot2c_f32_bf16 v64, s68, v184
  v_dot2c_f32_bf16 v65, s69, v184
  v_dot2c_f32_bf16 v66, s68, v185
  v_dot2c_f32_bf16 v67, s69, v185
  v_dot2c_f32_bf16 v68, s68, v186
  v_dot2c_f32_bf16 v69, s69, v186
  v_dot2c_f32_bf16 v70, s68, v187
  v_dot2c_f32_bf16 v71, s69, v187
  s_waitcnt vmcnt(12)
  v_dot2c_f32_bf16 v72, s68, v188
  v_dot2c_f32_bf16 v73, s69, v188
  v_dot2c_f32_bf16 v74, s68, v189
  v_dot2c_f32_bf16 v75, s69, v189
  v_dot2c_f32_bf16 v76, s68, v190
  v_dot2c_f32_bf16 v77, s69, v190
  v_dot2c_f32_bf16 v78, s68, v191
  v_dot2c_f32_bf16 v79, s69, v191
  s_waitcnt vmcnt(11)
  v_dot2c_f32_bf16 v64, s68, v192
  v_dot2c_f32_bf16 v65, s69, v192
  v_dot2c_f32_bf16 v66, s68, v193
  v_dot2c_f32_bf16 v67, s69, v193
  v_dot2c_f32_bf16 v68, s68, v194
  v_dot2c_f32_bf16 v69, s69, v194
  v_dot2c_f32_bf16 v70, s68, v195
  v_dot2c_f32_bf16 v71, s69, v195
  s_waitcnt vmcnt(10)
  v_dot2c_f32_bf16 v72, s68, v196
  v_dot2c_f32_bf16 v73, s69, v196
  v_dot2c_f32_bf16 v74, s68, v197
  v_dot2c_f32_bf16 v75, s69, v197
  v_dot2c_f32_bf16 v76, s68, v198
  v_dot2c_f32_bf16 v77, s69, v198
  v_dot2c_f32_bf16 v78, s68, v199
  v_dot2c_f32_bf16 v79, s69, v199
  s_waitcnt vmcnt(9)
  v_dot2c_f32_bf16 v64, s68, v200
  v_dot2c_f32_bf16 v65, s69, v200
  v_dot2c_f32_bf16 v66, s68, v201
  v_dot2c_f32_bf16 v67, s69, v201
  v_dot2c_f32_bf16 v68, s68, v202
  v_dot2c_f32_bf16 v69, s69, v202
  v_dot2c_f32_bf16 v70, s68, v203
  v_dot2c_f32_bf16 v71, s69, v203
  s_waitcnt vmcnt(8)
  v_dot2c_f32_bf16 v72, s68, v204
  v_dot2c_f32_bf16 v73, s69, v204
  v_dot2c_f32_bf16 v74, s68, v205
  v_dot2c_f32_bf16 v75, s69, v205
  v_dot2c_f32_bf16 v76, s68, v206
  v_dot2c_f32_bf16 v77, s69, v206
  v_dot2c_f32_bf16 v78, s68, v207
  v_dot2c_f32_bf16 v79, s69, v207
  s_waitcnt vmcnt(7)
  v_dot2c_f32_bf16 v64, s68, v208
  v_dot2c_f32_bf16 v65, s69, v208
  v_dot2c_f32_bf16 v66, s68, v209
  v_dot2c_f32_bf16 v67, s69, v209
  v_dot2c_f32_bf16 v68, s68, v210
  v_dot2c_f32_bf16 v69, s69, v210
  v_dot2c_f32_bf16 v70, s68, v211
  v_dot2c_f32_bf16 v71, s69, v211
  s_waitcnt vmcnt(6)
  v_dot2c_f32_bf16 v72, s68, v212
  v_dot2c_f32_bf16 v73, s69, v212
  v_dot2c_f32_bf16 v74, s68, v213
  v_dot2c_f32_bf16 v75, s69, v213
  v_dot2c_f32_bf16 v76, s68, v214
  v_dot2c_f32_bf16 v77, s69, v214
  v_dot2c_f32_bf16 v78, s68, v215
  v_dot2c_f32_bf16 v79, s69, v215
  s_waitcnt vmcnt(5)
  v_dot2c_f32_bf16 v64, s68, v216
  v_dot2c_f32_bf16 v65, s69, v216
  v_dot2c_f32_bf16 v66, s68, v217
  v_dot2c_f32_bf16 v67, s69, v217
  v_dot2c_f32_bf16 v68, s68, v218
  v_dot2c_f32_bf16 v69, s69, v218
  v_dot2c_f32_bf16 v70, s68, v219
  v_dot2c_f32_bf16 v71, s69, v219
  s_waitcnt vmcnt(4)
  v_dot2c_f32_bf16 v72, s68, v220
  v_dot2c_f32_bf16 v73, s69, v220
  v_dot2c_f32_bf16 v74, s68, v221
  v_dot2c_f32_bf16 v75, s69, v221
  v_dot2c_f32_bf16 v76, s68, v222
  v_dot2c_f32_bf16 v77, s69, v222
  v_dot2c_f32_bf16 v78, s68, v223
  v_dot2c_f32_bf16 v79, s69, v223
  s_waitcnt vmcnt(3)
  v_dot2c_f32_bf16 v64, s68, v224
  v_dot2c_f32_bf16 v65, s69, v224
  v_dot2c_f32_bf16 v66, s68, v225
  v_dot2c_f32_bf16 v67, s69, v225
  v_dot2c_f32_bf16 v68, s68, v226
  v_dot2c_f32_bf16 v69, s69, v226
  v_dot2c_f32_bf16 v70, s68, v227
  v_dot2c_f32_bf16 v71, s69, v227
  s_waitcnt vmcnt(2)
  v_dot2c_f32_bf16 v72, s68, v228
  v_dot2c_f32_bf16 v73, s69, v228
  v_dot2c_f32_bf16 v74, s68, v229
  v_dot2c_f32_bf16 v75, s69, v229
  v_dot2c_f32_bf16 v76, s68, v230
  v_dot2c_f32_bf16 v77, s69, v230
  v_dot2c_f32_bf16 v78, s68, v231
  v_dot2c_f32_bf16 v79, s69, v231
  s_waitcnt vmcnt(1)
  v_dot2c_f32_bf16 v64, s68, v232
  v_dot2c_f32_bf16 v65, s69, v232
  v_dot2c_f32_bf16 v66, s68, v233
  v_dot2c_f32_bf16 v67, s69, v233
  v_dot2c_f32_bf16 v68, s68, v234
  v_dot2c_f32_bf16 v69, s69, v234
  v_dot2c_f32_bf16 v70, s68, v235
  v_dot2c_f32_bf16 v71, s69, v235
  s_waitcnt vmcnt(0)
  v_dot2c_f32_bf16 v72, s68, v236
  v_dot2c_f32_bf16 v73, s69, v236
  v_dot2c_f32_bf16 v74, s68, v237
  v_dot2c_f32_bf16 v75, s69, v237
  v_dot2c_f32_bf16 v76, s68, v238
  v_dot2c_f32_bf16 v77, s69, v238
  v_dot2c_f32_bf16 v78, s68, v239
  v_dot2c_f32_bf16 v79, s69, v239
  s_waitcnt lgkmcnt(2)
  v_add_f32 v96, v96, v98
  s_waitcnt lgkmcnt(0)
  v_add_f32 v100, v100, v102
  v_add_f32 v80, v96, v100
  v_add_f32 v97, v97, v99
  v_add_f32 v101, v101, v103
  v_add_f32 v81, v97, v101
  v_lshlrev_b32 v54, 16, v44
  v_and_b32 v55, 0xffff0000, v44
  v_fma_f32 v64, v64, v38, v54
  v_fma_f32 v65, v65, v38, v55
  v_lshlrev_b32 v54, 16, v45
  v_and_b32 v55, 0xffff0000, v45
  v_fma_f32 v66, v66, v38, v54
  v_fma_f32 v67, v67, v38, v55
  v_lshlrev_b32 v54, 16, v46
  v_and_b32 v55, 0xffff0000, v46
  v_fma_f32 v68, v68, v38, v54
  v_fma_f32 v69, v69, v38, v55
  v_lshlrev_b32 v54, 16, v47
  v_and_b32 v55, 0xffff0000, v47
  v_fma_f32 v70, v70, v38, v54
  v_fma_f32 v71, v71, v38, v55
  v_lshlrev_b32 v54, 16, v48
  v_and_b32 v55, 0xffff0000, v48
  v_fma_f32 v72, v72, v38, v54
  v_fma_f32 v73, v73, v38, v55
  v_lshlrev_b32 v54, 16, v49
  v_and_b32 v55, 0xffff0000, v49
  v_fma_f32 v74, v74, v38, v54
  v_fma_f32 v75, v75, v38, v55
  v_lshlrev_b32 v54, 16, v50
  v_and_b32 v55, 0xffff0000, v50
  v_fma_f32 v76, v76, v38, v54
  v_fma_f32 v77, v77, v38, v55
  v_lshlrev_b32 v54, 16, v51
  v_and_b32 v55, 0xffff0000, v51
  v_fma_f32 v78, v78, v38, v54
  v_fma_f32 v79, v79, v38, v55
  v_lshlrev_b32 v54, 16, v52
  v_and_b32 v55, 0xffff0000, v52
  v_fma_f32 v80, v80, v38, v54
  v_fma_f32 v81, v81, v38, v55
  v_add_f32 v64, v64, v40
  v_add_f32 v65, v65, v40
  v_add_f32 v66, v66, v40
  v_add_f32 v67, v67, v40
  v_add_f32 v68, v68, v40
  v_add_f32 v69, v69, v40
  v_add_f32 v70, v70, v40
  v_add_f32 v71, v71, v40
  v_add_f32 v72, v72, v40
  v_add_f32 v73, v73, v40
  v_add_f32 v74, v74, v40
  v_add_f32 v75, v75, v40
  v_add_f32 v76, v76, v40
  v_add_f32 v77, v77, v40
  v_add_f32 v78, v78, v40
  v_add_f32 v79, v79, v40
  v_add_f32 v80, v80, v40
  v_add_f32 v81, v81, v40
  v_cvt_pk_bf16_f32 v24, v64, v65
  v_cvt_pk_bf16_f32 v25, v66, v67
  v_cvt_pk_bf16_f32 v26, v68, v69
  v_cvt_pk_bf16_f32 v27, v70, v71
  v_cvt_pk_bf16_f32 v28, v72, v73
  v_cvt_pk_bf16_f32 v29, v74, v75
  v_cvt_pk_bf16_f32 v30, v76, v77
  v_cvt_pk_bf16_f32 v31, v78, v79
  v_cvt_pk_bf16_f32 v32, v80, v81
  buffer_store_dwordx2 v[24:25], v6, s[40:43], 0 offen
  buffer_store_dwordx2 v[26:27], v6, s[40:43], 0 offen offset:32
  buffer_store_dwordx2 v[28:29], v6, s[40:43], 0 offen offset:128
  buffer_store_dwordx2 v[30:31], v6, s[40:43], 0 offen offset:160
  buffer_store_dword v32, v7, s[40:43], 0 offen
L_b2l_kernel_end:
  s_endpgm
.section .rodata,"a"
.p2align 6
.amdhsa_kernel interleave_layers__sliding_local_dilated__glu_gated_bilinear__prompt_kernel
  .amdhsa_next_free_vgpr 128
  .amdhsa_next_free_sgpr 102
  .amdhsa_accum_offset 128
  .amdhsa_group_segment_fixed_size 0
  .amdhsa_kernarg_size 80
  .amdhsa_user_sgpr_count 2
  .amdhsa_user_sgpr_kernarg_segment_ptr 1
  .amdhsa_system_sgpr_workgroup_id_x 1
  .amdhsa_float_denorm_mode_32 3
.end_amdhsa_kernel
.p2align 6
.amdhsa_kernel a1w_kernel
  .amdhsa_next_free_vgpr 512
  .amdhsa_next_free_sgpr 102
  .amdhsa_accum_offset 256
  .amdhsa_group_segment_fixed_size 0
  .amdhsa_kernarg_size 80
  .amdhsa_user_sgpr_count 2
  .amdhsa_user_sgpr_kernarg_segment_ptr 1
  .amdhsa_system_sgpr_workgroup_id_x 1
  .amdhsa_float_denorm_mode_32 3
.end_amdhsa_kernel
.p2align 6
.amdhsa_kernel a2_kernel
  .amdhsa_next_free_vgpr 512
  .amdhsa_next_free_sgpr 102
  .amdhsa_accum_offset 256
  .amdhsa_group_segment_fixed_size 0
  .amdhsa_kernarg_size 80
  .amdhsa_user_sgpr_count 2
  .amdhsa_user_sgpr_kernarg_segment_ptr 1
  .amdhsa_system_sgpr_workgroup_id_x 1
  .amdhsa_float_denorm_mode_32 3
.end_amdhsa_kernel
.p2align 6
.amdhsa_kernel b1_kernel
  .amdhsa_next_free_vgpr 512
  .amdhsa_next_free_sgpr 102
  .amdhsa_accum_offset 256
  .amdhsa_group_segment_fixed_size 0
  .amdhsa_kernarg_size 80
  .amdhsa_user_sgpr_count 2
  .amdhsa_user_sgpr_kernarg_segment_ptr 1
  .amdhsa_system_sgpr_workgroup_id_x 1
  .amdhsa_float_denorm_mode_32 3
.end_amdhsa_kernel
.p2align 6
.amdhsa_kernel b2_kernel
  .amdhsa_next_free_vgpr 256
  .amdhsa_next_free_sgpr 102
  .amdhsa_accum_offset 256
  .amdhsa_group_segment_fixed_size 0
  .amdhsa_kernarg_size 80
  .amdhsa_user_sgpr_count 2
  .amdhsa_user_sgpr_kernarg_segment_ptr 1
  .amdhsa_system_sgpr_workgroup_id_x 1
  .amdhsa_float_denorm_mode_32 3
.end_amdhsa_kernel
.p2align 6
.amdhsa_kernel a1_kernel
  .amdhsa_next_free_vgpr 512
  .amdhsa_next_free_sgpr 102
  .amdhsa_accum_offset 256
  .amdhsa_group_segment_fixed_size 0
  .amdhsa_kernarg_size 80
  .amdhsa_user_sgpr_count 2
  .amdhsa_user_sgpr_kernarg_segment_ptr 1
  .amdhsa_system_sgpr_workgroup_id_x 1
  .amdhsa_float_denorm_mode_32 3
.end_amdhsa_kernel
.p2align 6
.amdhsa_kernel b2l_kernel
  .amdhsa_next_free_vgpr 256
  .amdhsa_next_free_sgpr 102
  .amdhsa_accum_offset 256
  .amdhsa_group_segment_fixed_size 0
  .amdhsa_kernarg_size 80
  .amdhsa_user_sgpr_count 2
  .amdhsa_user_sgpr_kernarg_segment_ptr 1
  .amdhsa_system_sgpr_workgroup_id_x 1
  .amdhsa_float_denorm_mode_32 3
.end_amdhsa_kernel
```

```asm
; @launch kernel=interleave_layers__sliding_local_dilated__glu_gated_bilinear__prompt_kernel grid=(256,1,1) block=(256,1,1) lds=9216
; @launch kernel=main_kernel grid=(256,1,1) block=(256,1,1) lds=163840
.amdgcn_target "amdgcn-amd-amdhsa--gfx950"
.text
.globl interleave_layers__sliding_local_dilated__glu_gated_bilinear__prompt_kernel
.p2align 8
.type interleave_layers__sliding_local_dilated__glu_gated_bilinear__prompt_kernel,@function
interleave_layers__sliding_local_dilated__glu_gated_bilinear__prompt_kernel:
  s_cmp_ge_u32 s2, 256
  s_cbranch_scc1 L_prep_end
  s_load_dwordx4 s[44:47], s[0:1], 0
  s_load_dwordx2 s[48:49], s[0:1], 16
  s_load_dwordx2 s[50:51], s[0:1], 72
  s_load_dwordx4 s[76:79], s[0:1], 32
  v_lshrrev_b32 v12, 6, v0
  v_and_b32 v1, 63, v0
  v_readfirstlane_b32 s32, v12
  v_lshrrev_b32 v2, 3, v1
  v_and_b32 v3, 7, v1
  v_mov_b32 v11, 0x7ffffff0
  s_and_b32 s36, s2, 7
  s_lshl_b32 s36, s36, 5
  s_lshr_b32 s37, s2, 3
  s_add_u32 s33, s36, s37
  s_lshr_b32 s36, s33, 1
  s_mul_i32 s36, s36, 18432
  s_and_b32 s37, s33, 1
  s_lshl_b32 s37, s37, 7
  s_add_u32 s36, s36, s37
  v_lshlrev_b32 v12, 8, v2
  v_lshl_add_u32 v12, v3, 4, v12
  s_lshl_b32 s37, s32, 12
  s_add_u32 s37, s37, s36
  v_add_u32 v4, s37, v12
  s_lshl_b32 s37, s32, 2
  s_add_u32 s37, s37, s36
  s_add_u32 s37, s37, 16384
  v_add_u32 v5, s37, v12
  s_lshl_b32 s36, s33, 3
  v_add_u32 v13, s36, v3
  v_lshlrev_b32 v8, 2, v13
  v_mul_u32_u24 v13, 1152, v13
  v_lshrrev_b32 v12, 2, v2
  v_lshl_add_u32 v13, v12, 6, v13
  v_and_b32 v12, 3, v2
  v_lshl_add_u32 v13, v12, 3, v13
  s_lshl_b32 s37, s32, 8
  v_add_u32 v6, s37, v13
  s_lshr_b32 s37, s32, 1
  s_lshl_b32 s37, s37, 5
  s_and_b32 s38, s32, 1
  s_lshl_b32 s38, s38, 2
  s_add_u32 s37, s37, s38
  s_add_u32 s37, s37, 1024
  v_add_u32 v7, s37, v13
  v_lshlrev_b32 v10, 4, v3
  s_lshl_b32 s37, s32, 2
  v_add_u32 v9, s37, v10
  s_waitcnt lgkmcnt(0)
  s_mov_b32 s4, s44
  s_and_b32 s5, s45, 0xffff
  s_mov_b32 s6, 2359296
  s_mov_b32 s7, 0x20000
  s_mov_b32 s8, s46
  s_and_b32 s9, s47, 0xffff
  s_mov_b32 s10, 1990656
  s_mov_b32 s11, 0x20000
  s_mov_b32 s12, s48
  s_and_b32 s13, s49, 0xffff
  s_mov_b32 s14, 663552
  s_mov_b32 s15, 0x20000
  buffer_load_dwordx2 v[24:25], v6, s[4:7], 0 offen
  buffer_load_dwordx2 v[26:27], v6, s[4:7], 0 offen offset:32
  buffer_load_dwordx2 v[28:29], v6, s[4:7], 0 offen offset:128
  buffer_load_dwordx2 v[30:31], v6, s[4:7], 0 offen offset:160
  buffer_load_dword v32, v7, s[4:7], 0 offen
  s_add_u32 s16, s50, 3796992
  s_addc_u32 s17, s51, 0
  s_and_b32 s17, s17, 0xffff
  s_mov_b32 s18, 2359296
  s_mov_b32 s19, 0x20000
  s_add_u32 s20, s50, 10874880
  s_addc_u32 s21, s51, 0
  s_and_b32 s21, s21, 0xffff
  s_mov_b32 s22, 8192
  s_mov_b32 s23, 0x20000
  s_add_u32 s24, s50, 10883072
  s_addc_u32 s25, s51, 0
  s_and_b32 s25, s25, 0xffff
  s_mov_b32 s26, 8192
  s_mov_b32 s27, 0x20000
  s_add_u32 s28, s50, 0
  s_addc_u32 s29, s51, 0
  s_and_b32 s29, s29, 0xffff
  s_mov_b32 s30, 2064384
  s_mov_b32 s31, 0x20000
  s_add_u32 s40, s50, 2064384
  s_addc_u32 s41, s51, 0
  s_and_b32 s41, s41, 0xffff
  s_mov_b32 s42, 681984
  s_mov_b32 s43, 0x20000
  s_lshl_b32 s52, s2, 2
  s_add_u32 s52, s52, s32
  v_and_b32 v34, 15, v1
  v_lshrrev_b32 v35, 4, v1
  s_mov_b32 s57, 6912
  s_mov_b32 s58, 55296
  s_mov_b32 s59, 62208
  s_lshl_b32 s53, s52, 1
  s_add_u32 s53, s53, 0
  s_mul_hi_u32 s36, s53, 613566757
  s_mul_i32 s37, s36, 7
  s_sub_u32 s54, s53, s37
  s_mul_hi_u32 s56, s36, 238609295
  s_mul_i32 s37, s56, 18
  s_sub_u32 s55, s36, s37
  s_lshl_b32 s37, s54, 4
  v_add_u32 v36, s37, v34
  v_cmp_le_u32 vcc, 40, v36
  s_nop 1
  v_cndmask_b32 v37, 0, 1, vcc
  v_mul_u32_u24 v38, 40, v37
  v_sub_u32 v39, v36, v38
  v_mul_u32_u24 v37, 18, v37
  v_add_u32 v37, v37, v39
  v_cmp_le_u32 vcc, 18, v39
  s_nop 1
  v_cndmask_b32 v38, 0, 1, vcc
  v_mul_u32_u24 v38, 558, v38
  v_add_u32 v37, v37, v38
  v_add_u32 v37, 576, v37
  v_subrev_u32 v38, 76, v36
  v_cmp_le_u32 vcc, 76, v36
  s_nop 1
  v_cndmask_b32 v37, v37, v38, vcc
  s_mul_i32 s37, s56, 36
  v_add_u32 v37, s37, v37
  s_lshl_b32 s37, s55, 5
  v_lshl_add_u32 v38, v35, 2, s37
  v_mul_u32_u24 v38, 3456, v38
  v_lshl_add_u32 v52, v37, 1, v38
  v_subrev_u32 v38, 36, v36
  v_cmp_gt_u32 vcc, 4, v38
  s_nop 1
  v_cndmask_b32 v52, v52, v11, vcc
  s_lshl_b32 s37, s53, 10
  v_lshl_add_u32 v56, v1, 4, s37
  s_cmp_lt_u32 s53, 2016
  s_cselect_b32 s37, 0, 0x7ffffff0
  v_or_b32 v52, s37, v52
  buffer_load_ushort v40, v52, s[8:11], 0 offen
  buffer_load_ushort v84, v52, s[8:11], 0 offen offset:3456
  buffer_load_ushort v41, v52, s[8:11], s57 offen
  buffer_load_ushort v85, v52, s[8:11], s57 offen offset:3456
  buffer_load_ushort v42, v52, s[8:11], s58 offen
  buffer_load_ushort v86, v52, s[8:11], s58 offen offset:3456
  buffer_load_ushort v43, v52, s[8:11], s59 offen
  buffer_load_ushort v87, v52, s[8:11], s59 offen offset:3456
  s_lshl_b32 s53, s52, 1
  s_add_u32 s53, s53, 1
  s_mul_hi_u32 s36, s53, 613566757
  s_mul_i32 s37, s36, 7
  s_sub_u32 s54, s53, s37
  s_mul_hi_u32 s56, s36, 238609295
  s_mul_i32 s37, s56, 18
  s_sub_u32 s55, s36, s37
  s_lshl_b32 s37, s54, 4
  v_add_u32 v36, s37, v34
  v_cmp_le_u32 vcc, 40, v36
  s_nop 1
  v_cndmask_b32 v37, 0, 1, vcc
  v_mul_u32_u24 v38, 40, v37
  v_sub_u32 v39, v36, v38
  v_mul_u32_u24 v37, 18, v37
  v_add_u32 v37, v37, v39
  v_cmp_le_u32 vcc, 18, v39
  s_nop 1
  v_cndmask_b32 v38, 0, 1, vcc
  v_mul_u32_u24 v38, 558, v38
  v_add_u32 v37, v37, v38
  v_add_u32 v37, 576, v37
  v_subrev_u32 v38, 76, v36
  v_cmp_le_u32 vcc, 76, v36
  s_nop 1
  v_cndmask_b32 v37, v37, v38, vcc
  s_mul_i32 s37, s56, 36
  v_add_u32 v37, s37, v37
  s_lshl_b32 s37, s55, 5
  v_lshl_add_u32 v38, v35, 2, s37
  v_mul_u32_u24 v38, 3456, v38
  v_lshl_add_u32 v53, v37, 1, v38
  v_subrev_u32 v38, 36, v36
  v_cmp_gt_u32 vcc, 4, v38
  s_nop 1
  v_cndmask_b32 v53, v53, v11, vcc
  s_lshl_b32 s37, s53, 10
  v_lshl_add_u32 v57, v1, 4, s37
  s_cmp_lt_u32 s53, 2016
  s_cselect_b32 s37, 0, 0x7ffffff0
  v_or_b32 v53, s37, v53
  buffer_load_ushort v44, v53, s[8:11], 0 offen
  buffer_load_ushort v88, v53, s[8:11], 0 offen offset:3456
  buffer_load_ushort v45, v53, s[8:11], s57 offen
  buffer_load_ushort v89, v53, s[8:11], s57 offen offset:3456
  buffer_load_ushort v46, v53, s[8:11], s58 offen
  buffer_load_ushort v90, v53, s[8:11], s58 offen offset:3456
  buffer_load_ushort v47, v53, s[8:11], s59 offen
  buffer_load_ushort v91, v53, s[8:11], s59 offen offset:3456
  s_mul_hi_u32 s54, s52, 238609295
  s_mul_i32 s37, s54, 18
  s_sub_u32 s55, s52, s37
  v_lshrrev_b32 v36, 1, v35
  v_mul_u32_u24 v36, 18, v36
  v_and_b32 v37, 1, v35
  v_lshl_add_u32 v36, v37, 3, v36
  s_mul_i32 s37, s55, 36
  v_add_u32 v36, s37, v36
  v_mul_u32_u24 v37, 72, v35
  s_mul_i32 s37, s55, 288
  s_sub_u32 s37, s37, 4592
  v_add_u32 v37, s37, v37
  s_cmp_lt_u32 s55, 16
  s_cselect_b64 vcc, -1, 0
  v_cndmask_b32 v38, v37, v36, vcc
  s_cselect_b32 s60, 2, 18
  s_mul_i32 s60, s60, 1152
  s_mul_i32 s61, s60, 2
  s_mul_i32 s62, s60, 3
  v_mul_u32_u24 v38, 1152, v38
  s_lshl_b32 s37, s54, 5
  v_lshl_add_u32 v36, v34, 1, s37
  v_add_u32 v54, v38, v36
  s_lshl_b32 s37, s52, 10
  v_lshl_add_u32 v58, v1, 4, s37
  s_cmp_lt_u32 s52, 648
  s_cselect_b32 s37, 0, 0x7ffffff0
  v_or_b32 v54, s37, v54
  v_or_b32 v58, s37, v58
  buffer_load_ushort v48, v54, s[12:15], 0 offen
  buffer_load_ushort v92, v54, s[12:15], 0 offen offset:1152
  buffer_load_ushort v49, v54, s[12:15], s60 offen
  buffer_load_ushort v93, v54, s[12:15], s60 offen offset:1152
  buffer_load_ushort v50, v54, s[12:15], s61 offen
  buffer_load_ushort v94, v54, s[12:15], s61 offen offset:1152
  buffer_load_ushort v51, v54, s[12:15], s62 offen
  buffer_load_ushort v95, v54, s[12:15], s62 offen offset:1152
  s_mov_b32 s64, s76
  s_and_b32 s65, s77, 0xffff
  s_mov_b32 s66, 5308416
  s_mov_b32 s67, 0x20000
  s_mov_b32 s68, s78
  s_and_b32 s69, s79, 0xffff
  s_mov_b32 s70, 5308416
  s_mov_b32 s71, 0x20000
  v_mul_u32_u24 v36, 21846, v0
  v_lshrrev_b32 v36, 16, v36
  v_mul_u32_u24 v37, 3, v36
  v_sub_u32 v37, v0, v37
  s_lshr_b32 s36, s2, 4
  s_mul_i32 s36, s36, 36
  v_add_u32 v36, s36, v36
  v_mul_u32_u24 v36, 9216, v36
  v_lshl_add_u32 v36, v37, 7, v36
  s_and_b32 s36, s2, 15
  s_mul_i32 s36, s36, 576
  s_add_u32 s36, s36, 64
  s_and_b32 s36, s36, 0xffffff80
  v_add_u32 v36, s36, v36
  v_cmp_gt_u32 vcc, 108, v0
  s_nop 1
  v_cndmask_b32 v36, v11, v36, vcc
  buffer_load_dword v60, v36, s[64:67], 0 offen
  buffer_load_dword v61, v36, s[68:71], 0 offen
  s_add_u32 s72, s50, 11030528
  s_addc_u32 s73, s51, 0
  s_and_b32 s73, s73, 0xffff
  s_mov_b32 s74, 45047808
  s_mov_b32 s75, 0x20000
  s_and_b32 s36, s2, 127
  s_lshl_b32 s36, s36, 8
  s_lshr_b32 s37, s2, 7
  s_mul_i32 s37, s37, 45015040
  s_add_u32 s36, s36, s37
  v_lshl_add_u32 v36, v0, 4, s36
  v_cmp_gt_u32 vcc, 16, v0
  s_nop 1
  v_cndmask_b32 v36, v11, v36, vcc
  v_mov_b32 v100, 0
  v_mov_b32 v101, 0
  v_mov_b32 v102, 0
  v_mov_b32 v103, 0
  buffer_store_dwordx4 v[100:103], v36, s[72:75], 0 offen
  s_waitcnt vmcnt(31)
  v_lshlrev_b32 v64, 16, v24
  v_and_b32 v65, 0xffff0000, v24
  v_lshlrev_b32 v66, 16, v25
  v_and_b32 v67, 0xffff0000, v25
  s_waitcnt vmcnt(30)
  v_lshlrev_b32 v68, 16, v26
  v_and_b32 v69, 0xffff0000, v26
  v_lshlrev_b32 v70, 16, v27
  v_and_b32 v71, 0xffff0000, v27
  s_waitcnt vmcnt(29)
  v_lshlrev_b32 v72, 16, v28
  v_and_b32 v73, 0xffff0000, v28
  v_lshlrev_b32 v74, 16, v29
  v_and_b32 v75, 0xffff0000, v29
  s_waitcnt vmcnt(28)
  v_lshlrev_b32 v76, 16, v30
  v_and_b32 v77, 0xffff0000, v30
  v_lshlrev_b32 v78, 16, v31
  v_and_b32 v79, 0xffff0000, v31
  s_waitcnt vmcnt(27)
  v_lshlrev_b32 v80, 16, v32
  v_and_b32 v81, 0xffff0000, v32
  v_add_f32 v14, v64, v65
  v_add_f32 v15, v66, v67
  v_add_f32 v14, v14, v68
  v_add_f32 v15, v15, v69
  v_add_f32 v14, v14, v70
  v_add_f32 v15, v15, v71
  v_add_f32 v14, v14, v72
  v_add_f32 v15, v15, v73
  v_add_f32 v14, v14, v74
  v_add_f32 v15, v15, v75
  v_add_f32 v14, v14, v76
  v_add_f32 v15, v15, v77
  v_add_f32 v14, v14, v78
  v_add_f32 v15, v15, v79
  v_add_f32 v14, v14, v80
  v_add_f32 v15, v15, v81
  v_add_f32 v14, v14, v15
  s_nop 1
  v_add_f32_dpp v14, v14, v14 row_ror:8 row_mask:0xf bank_mask:0xf
  v_mov_b32 v15, v14
  s_nop 1
  v_permlane16_swap_b32 v14, v15
  v_add_f32 v14, v14, v15
  v_mov_b32 v15, v14
  s_nop 1
  v_permlane32_swap_b32 v14, v15
  v_add_f32 v14, v14, v15
  ds_write_b32 v9, v14
  s_waitcnt lgkmcnt(0)
  s_barrier
  ds_read_b128 v[16:19], v10
  s_waitcnt lgkmcnt(0)
  v_add_f32 v16, v16, v17
  v_add_f32 v18, v18, v19
  v_add_f32 v14, v16, v18
  v_mul_f32 v14, 0x3ae38e39, v14
  v_sub_f32 v64, v64, v14
  v_sub_f32 v65, v65, v14
  v_sub_f32 v66, v66, v14
  v_sub_f32 v67, v67, v14
  v_sub_f32 v68, v68, v14
  v_sub_f32 v69, v69, v14
  v_sub_f32 v70, v70, v14
  v_sub_f32 v71, v71, v14
  v_sub_f32 v72, v72, v14
  v_sub_f32 v73, v73, v14
  v_sub_f32 v74, v74, v14
  v_sub_f32 v75, v75, v14
  v_sub_f32 v76, v76, v14
  v_sub_f32 v77, v77, v14
  v_sub_f32 v78, v78, v14
  v_sub_f32 v79, v79, v14
  v_sub_f32 v80, v80, v14
  v_sub_f32 v81, v81, v14
  v_mul_f32 v20, v64, v64
  v_mul_f32 v21, v65, v65
  v_fmac_f32 v20, v66, v66
  v_fmac_f32 v21, v67, v67
  v_fmac_f32 v20, v68, v68
  v_fmac_f32 v21, v69, v69
  v_fmac_f32 v20, v70, v70
  v_fmac_f32 v21, v71, v71
  v_fmac_f32 v20, v72, v72
  v_fmac_f32 v21, v73, v73
  v_fmac_f32 v20, v74, v74
  v_fmac_f32 v21, v75, v75
  v_fmac_f32 v20, v76, v76
  v_fmac_f32 v21, v77, v77
  v_fmac_f32 v20, v78, v78
  v_fmac_f32 v21, v79, v79
  v_fmac_f32 v20, v80, v80
  v_fmac_f32 v21, v81, v81
  v_add_f32 v20, v20, v21
  v_cvt_pk_bf16_f32 v24, v64, v65
  v_cvt_pk_bf16_f32 v25, v66, v67
  v_cvt_pk_bf16_f32 v26, v68, v69
  v_cvt_pk_bf16_f32 v27, v70, v71
  v_cvt_pk_bf16_f32 v28, v72, v73
  v_cvt_pk_bf16_f32 v29, v74, v75
  v_cvt_pk_bf16_f32 v30, v76, v77
  v_cvt_pk_bf16_f32 v31, v78, v79
  v_cvt_pk_bf16_f32 v32, v80, v81
  buffer_store_dwordx4 v[24:27], v4, s[16:19], 0 offen
  buffer_store_dwordx4 v[28:31], v4, s[16:19], 0 offen offset:2048
  buffer_store_dword v32, v5, s[16:19], 0 offen
  v_add_f32_dpp v20, v20, v20 row_ror:8 row_mask:0xf bank_mask:0xf
  v_mov_b32 v15, v20
  s_nop 1
  v_permlane16_swap_b32 v20, v15
  v_add_f32 v20, v20, v15
  v_mov_b32 v15, v20
  s_nop 1
  v_permlane32_swap_b32 v20, v15
  v_add_f32 v20, v20, v15
  ds_write_b32 v9, v20 offset:128
  s_waitcnt lgkmcnt(0)
  s_barrier
  ds_read_b128 v[16:19], v10 offset:128
  s_waitcnt lgkmcnt(0)
  v_add_f32 v16, v16, v17
  v_add_f32 v18, v18, v19
  v_add_f32 v20, v16, v18
  v_mov_b32 v15, 0x3727c5ac
  v_fmac_f32 v15, 0x3ae38e39, v20
  v_rsq_f32 v15, v15
  v_cmp_gt_u32 vcc, 8, v0
  s_nop 1
  v_cndmask_b32 v22, v11, v8, vcc
  buffer_store_dword v15, v22, s[20:23], 0 offen
  buffer_store_dword v14, v22, s[24:27], 0 offen
  s_waitcnt vmcnt(30)
  v_lshl_or_b32 v40, v84, 16, v40
  s_waitcnt vmcnt(28)
  v_lshl_or_b32 v41, v85, 16, v41
  s_waitcnt vmcnt(26)
  v_lshl_or_b32 v42, v86, 16, v42
  s_waitcnt vmcnt(24)
  v_lshl_or_b32 v43, v87, 16, v43
  s_waitcnt vmcnt(22)
  v_lshl_or_b32 v44, v88, 16, v44
  s_waitcnt vmcnt(20)
  v_lshl_or_b32 v45, v89, 16, v45
  s_waitcnt vmcnt(18)
  v_lshl_or_b32 v46, v90, 16, v46
  s_waitcnt vmcnt(16)
  v_lshl_or_b32 v47, v91, 16, v47
  s_waitcnt vmcnt(14)
  v_lshl_or_b32 v48, v92, 16, v48
  s_waitcnt vmcnt(12)
  v_lshl_or_b32 v49, v93, 16, v49
  s_waitcnt vmcnt(10)
  v_lshl_or_b32 v50, v94, 16, v50
  s_waitcnt vmcnt(8)
  v_lshl_or_b32 v51, v95, 16, v51
  buffer_store_dwordx4 v[40:43], v56, s[28:31], 0 offen
  buffer_store_dwordx4 v[44:47], v57, s[28:31], 0 offen
  buffer_store_dwordx4 v[48:51], v58, s[40:43], 0 offen
  s_waitcnt vmcnt(0)
  s_cmp_lt_u32 s2, 238
  s_cbranch_scc1 L_prep_done
  s_sub_u32 s55, s2, 238
  v_mov_b32 v35, s32
  v_lshrrev_b32 v36, 1, v35
  v_mul_u32_u24 v36, 18, v36
  v_and_b32 v37, 1, v35
  v_lshl_add_u32 v36, v37, 3, v36
  s_mul_i32 s37, s55, 36
  v_add_u32 v36, s37, v36
  v_mul_u32_u24 v37, 72, v35
  s_mul_i32 s37, s55, 288
  s_sub_u32 s37, s37, 4592
  v_add_u32 v37, s37, v37
  s_cmp_lt_u32 s55, 16
  s_cselect_b64 vcc, -1, 0
  v_cndmask_b32 v38, v37, v36, vcc
  v_lshrrev_b32 v36, 1, v2
  v_mul_u32_u24 v36, 18, v36
  v_and_b32 v37, 1, v2
  v_add_u32 v36, v36, v37
  v_cndmask_b32 v36, v36, v2, vcc
  v_add_u32 v38, v38, v36
  v_mul_u32_u24 v38, 1152, v38
  v_lshl_add_u32 v54, v3, 4, v38
  buffer_load_dwordx4 v[64:67], v54, s[12:15], 0 offen
  buffer_load_dwordx4 v[68:71], v54, s[12:15], 0 offen offset:128
  buffer_load_dwordx4 v[72:75], v54, s[12:15], 0 offen offset:256
  buffer_load_dwordx4 v[76:79], v54, s[12:15], 0 offen offset:384
  buffer_load_dwordx4 v[80:83], v54, s[12:15], 0 offen offset:512
  buffer_load_dwordx4 v[84:87], v54, s[12:15], 0 offen offset:640
  buffer_load_dwordx4 v[88:91], v54, s[12:15], 0 offen offset:768
  buffer_load_dwordx4 v[92:95], v54, s[12:15], 0 offen offset:896
  buffer_load_dwordx4 v[96:99], v54, s[12:15], 0 offen offset:1024
  v_mov_b32 v36, 0
  v_mov_b32 v37, 0
  s_mov_b32 s37, 0x3f803f80
  s_waitcnt vmcnt(8)
  v_dot2c_f32_bf16 v36, s37, v64
  v_dot2c_f32_bf16 v37, s37, v65
  v_dot2c_f32_bf16 v36, s37, v66
  v_dot2c_f32_bf16 v37, s37, v67
  s_waitcnt vmcnt(7)
  v_dot2c_f32_bf16 v36, s37, v68
  v_dot2c_f32_bf16 v37, s37, v69
  v_dot2c_f32_bf16 v36, s37, v70
  v_dot2c_f32_bf16 v37, s37, v71
  s_waitcnt vmcnt(6)
  v_dot2c_f32_bf16 v36, s37, v72
  v_dot2c_f32_bf16 v37, s37, v73
  v_dot2c_f32_bf16 v36, s37, v74
  v_dot2c_f32_bf16 v37, s37, v75
  s_waitcnt vmcnt(5)
  v_dot2c_f32_bf16 v36, s37, v76
  v_dot2c_f32_bf16 v37, s37, v77
  v_dot2c_f32_bf16 v36, s37, v78
  v_dot2c_f32_bf16 v37, s37, v79
  s_waitcnt vmcnt(4)
  v_dot2c_f32_bf16 v36, s37, v80
  v_dot2c_f32_bf16 v37, s37, v81
  v_dot2c_f32_bf16 v36, s37, v82
  v_dot2c_f32_bf16 v37, s37, v83
  s_waitcnt vmcnt(3)
  v_dot2c_f32_bf16 v36, s37, v84
  v_dot2c_f32_bf16 v37, s37, v85
  v_dot2c_f32_bf16 v36, s37, v86
  v_dot2c_f32_bf16 v37, s37, v87
  s_waitcnt vmcnt(2)
  v_dot2c_f32_bf16 v36, s37, v88
  v_dot2c_f32_bf16 v37, s37, v89
  v_dot2c_f32_bf16 v36, s37, v90
  v_dot2c_f32_bf16 v37, s37, v91
  s_waitcnt vmcnt(1)
  v_dot2c_f32_bf16 v36, s37, v92
  v_dot2c_f32_bf16 v37, s37, v93
  v_dot2c_f32_bf16 v36, s37, v94
  v_dot2c_f32_bf16 v37, s37, v95
  s_waitcnt vmcnt(0)
  v_dot2c_f32_bf16 v36, s37, v96
  v_dot2c_f32_bf16 v37, s37, v97
  v_dot2c_f32_bf16 v36, s37, v98
  v_dot2c_f32_bf16 v37, s37, v99
  s_nop 2
  v_add_f32 v36, v36, v37
  s_nop 1
  v_add_f32_dpp v36, v36, v36 quad_perm:[1,0,3,2] row_mask:0xf bank_mask:0xf
  s_nop 1
  v_add_f32_dpp v36, v36, v36 quad_perm:[2,3,0,1] row_mask:0xf bank_mask:0xf
  s_nop 1
  v_add_f32_dpp v36, v36, v36 row_half_mirror row_mask:0xf bank_mask:0xf
  v_mul_f32 v36, 0x3ae38e39, v36
  v_cvt_pk_bf16_f32 v37, v36, v36
  v_and_b32 v37, 0xffff0000, v37
  v_sub_f32 v36, v36, v37
  v_cvt_pk_bf16_f32 v36, v36, v36
  s_add_u32 s37, s55, 648
  s_lshl_b32 s37, s37, 10
  s_lshl_b32 s38, s32, 8
  s_add_u32 s37, s37, s38
  v_lshl_add_u32 v38, v2, 1, s37
  v_cmp_eq_u32 vcc, 0, v3
  s_nop 1
  v_cndmask_b32 v38, v11, v38, vcc
  buffer_store_short_d16_hi v37, v38, s[40:43], 0 offen
  buffer_store_short v36, v38, s[40:43], 0 offen offset:16
  v_lshl_add_u32 v38, v1, 4, s37
  v_cmp_gt_u32 vcc, 14, v1
  s_nop 1
  v_cndmask_b32 v38, v11, v38, vcc
  v_mov_b32 v40, 0
  v_mov_b32 v41, 0
  v_mov_b32 v42, 0
  v_mov_b32 v43, 0
  buffer_store_dwordx4 v[40:43], v38, s[40:43], 0 offen offset:32
L_prep_done:
L_prep_end:
  s_endpgm
.globl main_kernel
.p2align 8
.type main_kernel,@function
main_kernel:
  s_cmp_ge_u32 s2, 256
  s_cbranch_scc1 L_main_end
  s_load_dwordx4 s[80:83], s[0:1], 32
  s_load_dwordx2 s[84:85], s[0:1], 48
  s_load_dwordx2 s[86:87], s[0:1], 72
  s_load_dwordx2 s[88:89], s[0:1], 56
  v_lshrrev_b32 v1, 6, v0
  s_mov_b32 s95, 0
  s_mov_b32 s101, 0
  v_readfirstlane_b32 s92, v1
  s_and_b32 s36, s2, 7
  s_lshr_b32 s37, s2, 3
  s_and_b32 s94, s36, 3
  s_lshl_b32 s94, s94, 2
  s_and_b32 s38, s37, 3
  s_add_u32 s94, s94, s38
  s_lshr_b32 s93, s36, 2
  s_lshl_b32 s93, s93, 3
  s_lshr_b32 s38, s37, 2
  s_add_u32 s93, s93, s38
  s_waitcnt lgkmcnt(0)
  s_add_u32 s44, s86, 0
  s_addc_u32 s45, s87, 0
  s_and_b32 s45, s45, 0xffff
  s_mov_b32 s46, 2064384
  s_mov_b32 s47, 0x20000
  s_mul_i32 s36, s94, 129024
  s_lshl_b32 s66, s92, 12
  s_add_u32 s36, s36, s66
  v_and_b32 v7, 63, v0
  v_lshlrev_b32 v7, 4, v7
  v_add_u32 v7, s36, v7
  s_add_u32 m0, s66, 0
  s_mov_b32 s38, 0
  buffer_load_dwordx4 v7, s[44:47], s38 offen lds
  buffer_load_dwordx4 v7, s[44:47], s38 offen offset:1024 lds
  buffer_load_dwordx4 v7, s[44:47], s38 offen offset:2048 lds
  buffer_load_dwordx4 v7, s[44:47], s38 offen offset:3072 lds
  s_add_u32 m0, s66, 16384
  s_mov_b32 s38, 16384
  buffer_load_dwordx4 v7, s[44:47], s38 offen lds
  buffer_load_dwordx4 v7, s[44:47], s38 offen offset:1024 lds
  buffer_load_dwordx4 v7, s[44:47], s38 offen offset:2048 lds
  buffer_load_dwordx4 v7, s[44:47], s38 offen offset:3072 lds
  s_add_u32 m0, s66, 32768
  s_mov_b32 s38, 32768
  buffer_load_dwordx4 v7, s[44:47], s38 offen lds
  buffer_load_dwordx4 v7, s[44:47], s38 offen offset:1024 lds
  buffer_load_dwordx4 v7, s[44:47], s38 offen offset:2048 lds
  buffer_load_dwordx4 v7, s[44:47], s38 offen offset:3072 lds
  s_add_u32 m0, s66, 49152
  s_mov_b32 s38, 49152
  buffer_load_dwordx4 v7, s[44:47], s38 offen lds
  buffer_load_dwordx4 v7, s[44:47], s38 offen offset:1024 lds
  buffer_load_dwordx4 v7, s[44:47], s38 offen offset:2048 lds
  buffer_load_dwordx4 v7, s[44:47], s38 offen offset:3072 lds
  s_add_u32 m0, s66, 65536
  s_mov_b32 s38, 65536
  buffer_load_dwordx4 v7, s[44:47], s38 offen lds
  buffer_load_dwordx4 v7, s[44:47], s38 offen offset:1024 lds
  buffer_load_dwordx4 v7, s[44:47], s38 offen offset:2048 lds
  buffer_load_dwordx4 v7, s[44:47], s38 offen offset:3072 lds
  s_add_u32 m0, s66, 81920
  s_mov_b32 s38, 81920
  buffer_load_dwordx4 v7, s[44:47], s38 offen lds
  buffer_load_dwordx4 v7, s[44:47], s38 offen offset:1024 lds
  buffer_load_dwordx4 v7, s[44:47], s38 offen offset:2048 lds
  buffer_load_dwordx4 v7, s[44:47], s38 offen offset:3072 lds
  s_add_u32 m0, s66, 98304
  s_mov_b32 s38, 98304
  buffer_load_dwordx4 v7, s[44:47], s38 offen lds
  buffer_load_dwordx4 v7, s[44:47], s38 offen offset:1024 lds
  buffer_load_dwordx4 v7, s[44:47], s38 offen offset:2048 lds
  buffer_load_dwordx4 v7, s[44:47], s38 offen offset:3072 lds
  s_add_u32 m0, s66, 114688
  s_mov_b32 s38, 114688
  buffer_load_dwordx4 v7, s[44:47], s38 offen lds
  buffer_load_dwordx4 v7, s[44:47], s38 offen offset:1024 lds
  buffer_load_dwordx4 v7, s[44:47], s38 offen offset:2048 lds
  buffer_load_dwordx4 v7, s[44:47], s38 offen offset:3072 lds
  s_add_u32 s90, s86, 3796992
  s_addc_u32 s91, s87, 0
  s_lshl_b32 s36, s93, 7
  s_lshl_b32 s37, s94, 2
  s_add_u32 s37, s37, s36
  v_mov_b32 v31, 0x7ffffff0
  v_mov_b32 v29, s37
  v_cmp_eq_u32 vcc, 0, v0
  s_nop 1
  v_cndmask_b32 v29, v31, v29, vcc
  v_and_b32 v30, 15, v0
  v_lshlrev_b32 v30, 2, v30
  v_add_u32 v30, s36, v30
  s_add_u32 s96, s90, 7233536
  s_addc_u32 s97, s91, 0
  s_and_b32 s97, s97, 0xffff
  s_mov_b32 s98, 45047808
  s_mov_b32 s99, 0x20000
L_layer:
  v_and_b32 v20, 63, v0
  v_and_b32 v21, 15, v20
  v_lshrrev_b32 v22, 4, v20
  v_lshlrev_b32 v1, 4, v20
  v_add_u32 v2, 65536, v1
  v_add_u32 v19, 129024, v1
  s_lshl_b32 s36, s92, 10
  v_add_u32 v3, s36, v1
  v_add_u32 v4, 65536, v3
  s_lshl_b32 s36, s93, 3
  s_max_u32 s37, s36, 1
  s_sub_u32 s37, s37, 1
  s_lshl_b32 s38, s92, 1
  s_add_u32 s36, s36, s38
  v_lshlrev_b32 v23, 2, v21
  s_lshl_b32 s38, s37, 6
  v_add_u32 v8, s38, v23
  s_lshl_b32 s38, s36, 6
  v_add_u32 v9, s38, v23
  s_mul_i32 s37, s37, 18432
  s_mul_i32 s35, s92, 5120
  s_add_u32 s37, s37, s35
  v_add_u32 v5, s37, v1
  s_add_u32 s35, s35, 129024
  s_mul_i32 s36, s36, 18432
  v_add_u32 v6, s36, v1
  s_max_u32 s36, s93, 1
  s_sub_u32 s36, s36, 1
  s_lshl_b32 s36, s36, 7
  s_add_u32 s36, s36, 56
  v_and_b32 v23, 1, v20
  v_lshl_add_u32 v23, v23, 2, s36
  v_cmp_gt_u32 vcc, 16, v20
  s_nop 1
  v_cndmask_b32 v25, v23, v30, vcc
  s_mov_b32 s48, 0
  s_mov_b32 s53, 18432
  s_mov_b32 s49, 4096
  s_mov_b32 s54, 22528
  s_mov_b32 s50, 8192
  s_mov_b32 s55, 26624
  s_mov_b32 s51, 12288
  s_mov_b32 s56, 30720
  s_mov_b32 s52, 16384
  s_mov_b32 s57, 34816
  s_add_u32 s4, s90, 0
  s_addc_u32 s5, s91, 0
  s_and_b32 s5, s5, 0xffff
  s_mov_b32 s6, 2359296
  s_mov_b32 s7, 0x20000
  s_add_u32 s8, s90, 7077888
  s_addc_u32 s9, s91, 0
  s_and_b32 s9, s9, 0xffff
  s_mov_b32 s10, 8192
  s_mov_b32 s11, 0x20000
  s_cmp_eq_u32 s95, 0
  s_cbranch_scc1 L_a1np_1
  s_mov_b32 s36, 0
  buffer_load_dword v31, v25, s[96:99], s36 offen sc1
  s_waitcnt vmcnt(0)
  v_cmp_eq_u32 vcc, 0, v31
  s_cbranch_vccnz L_sp_2
L_bk_3:
L_a1np_1:
  buffer_load_dwordx4 a[0:3], v6, s[4:7], s48 offen sc1
  buffer_load_dwordx4 a[72:75], v6, s[4:7], s53 offen sc1
  s_mov_b32 m0, s35
  s_nop 0
  buffer_load_dwordx4 v5, s[4:7], 0 offen sc1 lds
  buffer_load_dwordx4 v5, s[4:7], 0 offen offset:1024 sc1 lds
  buffer_load_dwordx4 v5, s[4:7], 0 offen offset:2048 sc1 lds
  buffer_load_dwordx4 v5, s[4:7], 0 offen offset:3072 sc1 lds
  s_add_u32 m0, s35, 4096
  s_nop 0
  buffer_load_dwordx4 v5, s[4:7], s49 offen sc1 lds
  buffer_load_dwordx4 a[4:7], v6, s[4:7], s48 offen offset:1024 sc1
  buffer_load_dwordx4 a[76:79], v6, s[4:7], s53 offen offset:1024 sc1
  buffer_load_dwordx4 a[8:11], v6, s[4:7], s48 offen offset:2048 sc1
  buffer_load_dwordx4 a[80:83], v6, s[4:7], s53 offen offset:2048 sc1
  buffer_load_dwordx4 a[12:15], v6, s[4:7], s48 offen offset:3072 sc1
  buffer_load_dwordx4 a[84:87], v6, s[4:7], s53 offen offset:3072 sc1
  buffer_load_dwordx4 a[16:19], v6, s[4:7], s49 offen sc1
  buffer_load_dwordx4 a[88:91], v6, s[4:7], s54 offen sc1
  buffer_load_dword v10, v9, s[8:11], 0 offen offset:64 sc1
  buffer_load_dword v8, v8, s[8:11], 0 offen sc1
  buffer_load_dword v9, v9, s[8:11], 0 offen sc1
  s_add_u32 s12, s90, 4718592
  s_addc_u32 s13, s91, 0
  s_and_b32 s13, s13, 0xffff
  s_mov_b32 s14, 2359296
  s_mov_b32 s15, 0x20000
  v_mul_u32_u24 v23, 240, v21
  v_lshl_add_u32 v23, v22, 3, v23
  v_add_u32 v12, 129152, v23
  s_lshl_b32 s36, s92, 5
  s_add_u32 s37, s36, 129024
  v_add_u32 v11, s37, v23
  s_mul_i32 s36, s36, 240
  s_add_u32 s36, s36, 132864
  v_add_u32 v13, s36, v23
  s_and_b32 s39, s92, 1
  s_lshr_b32 s36, s92, 1
  s_lshl_b32 s36, s36, 6
  v_add_u32 v23, s36, v20
  v_mul_u32_u24 v24, 240, v23
  s_mul_i32 s37, s39, 80
  s_add_u32 s37, s37, 129504
  v_add_u32 v14, s37, v24
  s_mul_i32 s37, s39, 36
  s_add_u32 s37, s37, 133016
  v_add_u32 v15, s37, v24
  s_lshl_b32 s37, s93, 7
  v_add_u32 v23, s37, v23
  v_cmp_le_u32 s[64:65], 2, v23
  v_cmp_le_u32 s[66:67], 4, v23
  v_cmp_le_u32 s[68:69], 6, v23
  v_cmp_le_u32 s[70:71], 8, v23
  v_cmp_le_u32 s[72:73], 10, v23
  v_cmp_le_u32 s[74:75], 12, v23
  v_cmp_le_u32 s[76:77], 14, v23
  v_lshrrev_b32 v24, 4, v23
  v_mul_u32_u24 v24, 18432, v24
  v_lshl_add_u32 v24, v21, 4, v24
  s_lshl_b32 s37, s94, 1
  s_add_u32 s37, s37, s39
  s_lshl_b32 s37, s37, 9
  v_add_u32 v16, s37, v24
  s_lshr_b32 s37, s94, 1
  s_add_u32 s37, s37, 64
  s_lshl_b32 s37, s37, 8
  s_and_b32 s38, s94, 1
  s_lshl_b32 s38, s38, 3
  s_add_u32 s37, s37, s38
  s_lshl_b32 s38, s39, 2
  s_add_u32 s37, s37, s38
  v_add_u32 v17, s37, v24
  v_mov_b32 v18, 0xceabfb8f
  s_mov_b32 s32, 0x05040100
  s_mov_b32 s33, 0x07060302
  s_mov_b32 s34, 0x3f803f80
  s_add_u32 s60, s86, 2064384
  s_addc_u32 s61, s87, 0
  s_and_b32 s61, s61, 0xffff
  s_mov_b32 s62, 681984
  s_mov_b32 s63, 0x20000
  s_and_b32 s36, s94, 3
  s_and_b32 s37, s36, 1
  s_mul_i32 s36, s36, 9
  s_add_u32 s38, s36, s37
  s_xor_b32 s37, s37, 1
  s_lshl_b32 s37, s37, 3
  s_add_u32 s36, s36, s37
  s_lshl_b32 s37, s92, 1
  s_add_u32 s38, s38, s37
  s_mul_i32 s38, s38, 18432
  v_add_u32 v248, s38, v1
  s_cmp_lt_u32 s92, 2
  s_cselect_b32 s36, s36, 36
  s_mul_i32 s36, s36, 18432
  v_add_u32 v249, s36, v1
  s_waitcnt vmcnt(11)
  s_barrier
  ds_read_b128 v[32:35], v1
  ds_read_b128 v[36:39], v1 offset:1024
  ds_read_b128 v[40:43], v1 offset:2048
  ds_read_b128 v[44:47], v1 offset:3072
  ds_read_b128 v[48:51], v1 offset:4096
  ds_read_b128 v[52:55], v1 offset:5120
  ds_read_b128 v[56:59], v1 offset:6144
  ds_read_b128 v[60:63], v3
  ds_read_b128 v[64:67], v19
  s_waitcnt lgkmcnt(8)
  v_mfma_f32_16x16x32_bf16 v[112:115], v[32:35], a[0:3], 0
  ds_read_b128 v[68:71], v1 offset:7168
  v_mfma_f32_16x16x32_bf16 v[140:143], v[32:35], a[72:75], 0
  ds_read_b128 v[72:75], v1 offset:8192
  s_waitcnt lgkmcnt(9)
  v_mfma_f32_16x16x32_bf16 v[116:119], v[36:39], a[0:3], 0
  ds_read_b128 v[76:79], v1 offset:9216
  v_mfma_f32_16x16x32_bf16 v[144:147], v[36:39], a[72:75], 0
  ds_read_b128 v[80:83], v1 offset:10240
  s_waitcnt lgkmcnt(10)
  v_mfma_f32_16x16x32_bf16 v[120:123], v[40:43], a[0:3], 0
  ds_read_b128 v[84:87], v1 offset:11264
  v_mfma_f32_16x16x32_bf16 v[148:151], v[40:43], a[72:75], 0
  ds_read_b128 v[88:91], v1 offset:12288
  s_waitcnt lgkmcnt(11)
  v_mfma_f32_16x16x32_bf16 v[124:127], v[44:47], a[0:3], 0
  ds_read_b128 v[92:95], v1 offset:13312
  v_mfma_f32_16x16x32_bf16 v[152:155], v[44:47], a[72:75], 0
  ds_read_b128 v[96:99], v3 offset:7168
  s_waitcnt lgkmcnt(12)
  v_mfma_f32_16x16x32_bf16 v[128:131], v[48:51], a[0:3], 0
  ds_read_b128 v[100:103], v19 offset:1024
  v_mfma_f32_16x16x32_bf16 v[156:159], v[48:51], a[72:75], 0
  buffer_load_dwordx4 a[20:23], v6, s[4:7], s49 offen offset:1024 sc1
  s_waitcnt lgkmcnt(12)
  v_mfma_f32_16x16x32_bf16 v[132:135], v[52:55], a[0:3], 0
  buffer_load_dwordx4 a[92:95], v6, s[4:7], s54 offen offset:1024 sc1
  v_mfma_f32_16x16x32_bf16 v[160:163], v[52:55], a[72:75], 0
  s_waitcnt lgkmcnt(11)
  v_mfma_f32_16x16x32_bf16 v[136:139], v[56:59], a[0:3], 0
  v_mfma_f32_16x16x32_bf16 v[164:167], v[56:59], a[72:75], 0
  s_waitcnt lgkmcnt(9)
  v_mfma_f32_16x16x32_bf16 v[168:171], v[60:63], v[64:67], 0
  v_mfma_f32_16x16x32_bf16 v[172:175], v[48:51], v[64:67], 0
  s_waitcnt vmcnt(12) lgkmcnt(8)
  v_mfma_f32_16x16x32_bf16 v[112:115], v[68:71], a[4:7], v[112:115]
  ds_read_b128 v[32:35], v1 offset:14336
  s_waitcnt vmcnt(11)
  v_mfma_f32_16x16x32_bf16 v[140:143], v[68:71], a[76:79], v[140:143]
  ds_read_b128 v[36:39], v1 offset:15360
  s_waitcnt lgkmcnt(9)
  v_mfma_f32_16x16x32_bf16 v[116:119], v[72:75], a[4:7], v[116:119]
  ds_read_b128 v[40:43], v1 offset:16384
  v_mfma_f32_16x16x32_bf16 v[144:147], v[72:75], a[76:79], v[144:147]
  ds_read_b128 v[44:47], v1 offset:17408
  s_waitcnt lgkmcnt(10)
  v_mfma_f32_16x16x32_bf16 v[120:123], v[76:79], a[4:7], v[120:123]
  ds_read_b128 v[48:51], v1 offset:18432
  v_mfma_f32_16x16x32_bf16 v[148:151], v[76:79], a[76:79], v[148:151]
  ds_read_b128 v[52:55], v1 offset:19456
  s_waitcnt lgkmcnt(11)
  v_mfma_f32_16x16x32_bf16 v[124:127], v[80:83], a[4:7], v[124:127]
  ds_read_b128 v[56:59], v1 offset:20480
  v_mfma_f32_16x16x32_bf16 v[152:155], v[80:83], a[76:79], v[152:155]
  ds_read_b128 v[60:63], v3 offset:14336
  s_waitcnt lgkmcnt(12)
  v_mfma_f32_16x16x32_bf16 v[128:131], v[84:87], a[4:7], v[128:131]
  ds_read_b128 v[64:67], v19 offset:2048
  v_mfma_f32_16x16x32_bf16 v[156:159], v[84:87], a[76:79], v[156:159]
  buffer_load_dwordx4 a[24:27], v6, s[4:7], s49 offen offset:2048 sc1
  s_waitcnt lgkmcnt(12)
  v_mfma_f32_16x16x32_bf16 v[132:135], v[88:91], a[4:7], v[132:135]
  buffer_load_dwordx4 a[96:99], v6, s[4:7], s54 offen offset:2048 sc1
  v_mfma_f32_16x16x32_bf16 v[160:163], v[88:91], a[76:79], v[160:163]
  s_waitcnt lgkmcnt(11)
  v_mfma_f32_16x16x32_bf16 v[136:139], v[92:95], a[4:7], v[136:139]
  v_mfma_f32_16x16x32_bf16 v[164:167], v[92:95], a[76:79], v[164:167]
  s_waitcnt lgkmcnt(9)
  v_mfma_f32_16x16x32_bf16 v[168:171], v[96:99], v[100:103], v[168:171]
  v_mfma_f32_16x16x32_bf16 v[172:175], v[84:87], v[100:103], v[172:175]
  s_waitcnt vmcnt(12) lgkmcnt(8)
  v_mfma_f32_16x16x32_bf16 v[112:115], v[32:35], a[8:11], v[112:115]
  ds_read_b128 v[68:71], v1 offset:21504
  s_waitcnt vmcnt(11)
  v_mfma_f32_16x16x32_bf16 v[140:143], v[32:35], a[80:83], v[140:143]
  ds_read_b128 v[72:75], v1 offset:22528
  s_waitcnt lgkmcnt(9)
  v_mfma_f32_16x16x32_bf16 v[116:119], v[36:39], a[8:11], v[116:119]
  ds_read_b128 v[76:79], v1 offset:23552
  v_mfma_f32_16x16x32_bf16 v[144:147], v[36:39], a[80:83], v[144:147]
  ds_read_b128 v[80:83], v1 offset:24576
  s_waitcnt lgkmcnt(10)
  v_mfma_f32_16x16x32_bf16 v[120:123], v[40:43], a[8:11], v[120:123]
  ds_read_b128 v[84:87], v1 offset:25600
  v_mfma_f32_16x16x32_bf16 v[148:151], v[40:43], a[80:83], v[148:151]
  ds_read_b128 v[88:91], v1 offset:26624
  s_waitcnt lgkmcnt(11)
  v_mfma_f32_16x16x32_bf16 v[124:127], v[44:47], a[8:11], v[124:127]
  ds_read_b128 v[92:95], v1 offset:27648
  v_mfma_f32_16x16x32_bf16 v[152:155], v[44:47], a[80:83], v[152:155]
  ds_read_b128 v[96:99], v3 offset:21504
  s_waitcnt lgkmcnt(12)
  v_mfma_f32_16x16x32_bf16 v[128:131], v[48:51], a[8:11], v[128:131]
  ds_read_b128 v[100:103], v19 offset:3072
  v_mfma_f32_16x16x32_bf16 v[156:159], v[48:51], a[80:83], v[156:159]
  buffer_load_dwordx4 a[28:31], v6, s[4:7], s49 offen offset:3072 sc1
  s_waitcnt lgkmcnt(12)
  v_mfma_f32_16x16x32_bf16 v[132:135], v[52:55], a[8:11], v[132:135]
  buffer_load_dwordx4 a[100:103], v6, s[4:7], s54 offen offset:3072 sc1
  v_mfma_f32_16x16x32_bf16 v[160:163], v[52:55], a[80:83], v[160:163]
  s_waitcnt lgkmcnt(11)
  v_mfma_f32_16x16x32_bf16 v[136:139], v[56:59], a[8:11], v[136:139]
  v_mfma_f32_16x16x32_bf16 v[164:167], v[56:59], a[80:83], v[164:167]
  s_waitcnt lgkmcnt(9)
  v_mfma_f32_16x16x32_bf16 v[168:171], v[60:63], v[64:67], v[168:171]
  v_mfma_f32_16x16x32_bf16 v[172:175], v[48:51], v[64:67], v[172:175]
  s_waitcnt vmcnt(12) lgkmcnt(8)
  v_mfma_f32_16x16x32_bf16 v[112:115], v[68:71], a[12:15], v[112:115]
  ds_read_b128 v[32:35], v1 offset:28672
  s_waitcnt vmcnt(11)
  v_mfma_f32_16x16x32_bf16 v[140:143], v[68:71], a[84:87], v[140:143]
  ds_read_b128 v[36:39], v1 offset:29696
  s_waitcnt lgkmcnt(9)
  v_mfma_f32_16x16x32_bf16 v[116:119], v[72:75], a[12:15], v[116:119]
  ds_read_b128 v[40:43], v1 offset:30720
  v_mfma_f32_16x16x32_bf16 v[144:147], v[72:75], a[84:87], v[144:147]
  ds_read_b128 v[44:47], v1 offset:31744
  s_waitcnt lgkmcnt(10)
  v_mfma_f32_16x16x32_bf16 v[120:123], v[76:79], a[12:15], v[120:123]
  ds_read_b128 v[48:51], v1 offset:32768
  v_mfma_f32_16x16x32_bf16 v[148:151], v[76:79], a[84:87], v[148:151]
  ds_read_b128 v[52:55], v1 offset:33792
  s_waitcnt lgkmcnt(11)
  v_mfma_f32_16x16x32_bf16 v[124:127], v[80:83], a[12:15], v[124:127]
  ds_read_b128 v[56:59], v1 offset:34816
  v_mfma_f32_16x16x32_bf16 v[152:155], v[80:83], a[84:87], v[152:155]
  ds_read_b128 v[60:63], v3 offset:28672
  s_waitcnt lgkmcnt(12)
  v_mfma_f32_16x16x32_bf16 v[128:131], v[84:87], a[12:15], v[128:131]
  ds_read_b128 v[64:67], v19 offset:4096
  v_mfma_f32_16x16x32_bf16 v[156:159], v[84:87], a[84:87], v[156:159]
  buffer_load_dwordx4 a[32:35], v6, s[4:7], s50 offen sc1
  s_waitcnt lgkmcnt(12)
  v_mfma_f32_16x16x32_bf16 v[132:135], v[88:91], a[12:15], v[132:135]
  buffer_load_dwordx4 a[104:107], v6, s[4:7], s55 offen sc1
  v_mfma_f32_16x16x32_bf16 v[160:163], v[88:91], a[84:87], v[160:163]
  s_waitcnt lgkmcnt(11)
  v_mfma_f32_16x16x32_bf16 v[136:139], v[92:95], a[12:15], v[136:139]
  v_mfma_f32_16x16x32_bf16 v[164:167], v[92:95], a[84:87], v[164:167]
  s_waitcnt lgkmcnt(9)
  v_mfma_f32_16x16x32_bf16 v[168:171], v[96:99], v[100:103], v[168:171]
  v_mfma_f32_16x16x32_bf16 v[172:175], v[84:87], v[100:103], v[172:175]
  s_waitcnt vmcnt(12) lgkmcnt(8)
  v_mfma_f32_16x16x32_bf16 v[112:115], v[32:35], a[16:19], v[112:115]
  ds_read_b128 v[68:71], v1 offset:35840
  s_waitcnt vmcnt(11)
  v_mfma_f32_16x16x32_bf16 v[140:143], v[32:35], a[88:91], v[140:143]
  ds_read_b128 v[72:75], v1 offset:36864
  s_waitcnt lgkmcnt(9)
  v_mfma_f32_16x16x32_bf16 v[116:119], v[36:39], a[16:19], v[116:119]
  ds_read_b128 v[76:79], v1 offset:37888
  v_mfma_f32_16x16x32_bf16 v[144:147], v[36:39], a[88:91], v[144:147]
  ds_read_b128 v[80:83], v1 offset:38912
  s_waitcnt lgkmcnt(10)
  v_mfma_f32_16x16x32_bf16 v[120:123], v[40:43], a[16:19], v[120:123]
  ds_read_b128 v[84:87], v1 offset:39936
  v_mfma_f32_16x16x32_bf16 v[148:151], v[40:43], a[88:91], v[148:151]
  ds_read_b128 v[88:91], v1 offset:40960
  s_waitcnt lgkmcnt(11)
  v_mfma_f32_16x16x32_bf16 v[124:127], v[44:47], a[16:19], v[124:127]
  ds_read_b128 v[92:95], v1 offset:41984
  v_mfma_f32_16x16x32_bf16 v[152:155], v[44:47], a[88:91], v[152:155]
  ds_read_b128 v[96:99], v3 offset:35840
  s_waitcnt lgkmcnt(12)
  v_mfma_f32_16x16x32_bf16 v[128:131], v[48:51], a[16:19], v[128:131]
  ds_read_b128 v[100:103], v19 offset:5120
  v_mfma_f32_16x16x32_bf16 v[156:159], v[48:51], a[88:91], v[156:159]
  buffer_load_dwordx4 a[36:39], v6, s[4:7], s50 offen offset:1024 sc1
  s_waitcnt lgkmcnt(12)
  v_mfma_f32_16x16x32_bf16 v[132:135], v[52:55], a[16:19], v[132:135]
  buffer_load_dwordx4 a[108:111], v6, s[4:7], s55 offen offset:1024 sc1
  v_mfma_f32_16x16x32_bf16 v[160:163], v[52:55], a[88:91], v[160:163]
  s_waitcnt lgkmcnt(11)
  v_mfma_f32_16x16x32_bf16 v[136:139], v[56:59], a[16:19], v[136:139]
  v_mfma_f32_16x16x32_bf16 v[164:167], v[56:59], a[88:91], v[164:167]
  s_waitcnt lgkmcnt(9)
  v_mfma_f32_16x16x32_bf16 v[168:171], v[60:63], v[64:67], v[168:171]
  v_mfma_f32_16x16x32_bf16 v[172:175], v[48:51], v[64:67], v[172:175]
  s_waitcnt vmcnt(9) lgkmcnt(8)
  v_mfma_f32_16x16x32_bf16 v[112:115], v[68:71], a[20:23], v[112:115]
  ds_read_b128 v[32:35], v1 offset:43008
  s_waitcnt vmcnt(8)
  v_mfma_f32_16x16x32_bf16 v[140:143], v[68:71], a[92:95], v[140:143]
  ds_read_b128 v[36:39], v1 offset:44032
  s_waitcnt lgkmcnt(9)
  v_mfma_f32_16x16x32_bf16 v[116:119], v[72:75], a[20:23], v[116:119]
  ds_read_b128 v[40:43], v1 offset:45056
  v_mfma_f32_16x16x32_bf16 v[144:147], v[72:75], a[92:95], v[144:147]
  ds_read_b128 v[44:47], v1 offset:46080
  s_waitcnt lgkmcnt(10)
  v_mfma_f32_16x16x32_bf16 v[120:123], v[76:79], a[20:23], v[120:123]
  ds_read_b128 v[48:51], v1 offset:47104
  v_mfma_f32_16x16x32_bf16 v[148:151], v[76:79], a[92:95], v[148:151]
  ds_read_b128 v[52:55], v1 offset:48128
  s_waitcnt lgkmcnt(11)
  v_mfma_f32_16x16x32_bf16 v[124:127], v[80:83], a[20:23], v[124:127]
  ds_read_b128 v[56:59], v1 offset:49152
  v_mfma_f32_16x16x32_bf16 v[152:155], v[80:83], a[92:95], v[152:155]
  ds_read_b128 v[60:63], v3 offset:43008
  s_waitcnt lgkmcnt(12)
  v_mfma_f32_16x16x32_bf16 v[128:131], v[84:87], a[20:23], v[128:131]
  ds_read_b128 v[64:67], v19 offset:6144
  v_mfma_f32_16x16x32_bf16 v[156:159], v[84:87], a[92:95], v[156:159]
  buffer_load_dwordx4 a[40:43], v6, s[4:7], s50 offen offset:2048 sc1
  s_waitcnt lgkmcnt(12)
  v_mfma_f32_16x16x32_bf16 v[132:135], v[88:91], a[20:23], v[132:135]
  buffer_load_dwordx4 a[112:115], v6, s[4:7], s55 offen offset:2048 sc1
  v_mfma_f32_16x16x32_bf16 v[160:163], v[88:91], a[92:95], v[160:163]
  s_waitcnt lgkmcnt(11)
  v_mfma_f32_16x16x32_bf16 v[136:139], v[92:95], a[20:23], v[136:139]
  v_mfma_f32_16x16x32_bf16 v[164:167], v[92:95], a[92:95], v[164:167]
  s_waitcnt lgkmcnt(9)
  v_mfma_f32_16x16x32_bf16 v[168:171], v[96:99], v[100:103], v[168:171]
  v_mfma_f32_16x16x32_bf16 v[172:175], v[84:87], v[100:103], v[172:175]
  s_waitcnt vmcnt(9) lgkmcnt(8)
  v_mfma_f32_16x16x32_bf16 v[112:115], v[32:35], a[24:27], v[112:115]
  ds_read_b128 v[68:71], v1 offset:50176
  s_waitcnt vmcnt(8)
  v_mfma_f32_16x16x32_bf16 v[140:143], v[32:35], a[96:99], v[140:143]
  ds_read_b128 v[72:75], v1 offset:51200
  s_waitcnt lgkmcnt(9)
  v_mfma_f32_16x16x32_bf16 v[116:119], v[36:39], a[24:27], v[116:119]
  ds_read_b128 v[76:79], v1 offset:52224
  v_mfma_f32_16x16x32_bf16 v[144:147], v[36:39], a[96:99], v[144:147]
  ds_read_b128 v[80:83], v1 offset:53248
  s_waitcnt lgkmcnt(10)
  v_mfma_f32_16x16x32_bf16 v[120:123], v[40:43], a[24:27], v[120:123]
  ds_read_b128 v[84:87], v1 offset:54272
  v_mfma_f32_16x16x32_bf16 v[148:151], v[40:43], a[96:99], v[148:151]
  ds_read_b128 v[88:91], v1 offset:55296
  s_waitcnt lgkmcnt(11)
  v_mfma_f32_16x16x32_bf16 v[124:127], v[44:47], a[24:27], v[124:127]
  ds_read_b128 v[92:95], v1 offset:56320
  v_mfma_f32_16x16x32_bf16 v[152:155], v[44:47], a[96:99], v[152:155]
  ds_read_b128 v[96:99], v3 offset:50176
  s_waitcnt lgkmcnt(12)
  v_mfma_f32_16x16x32_bf16 v[128:131], v[48:51], a[24:27], v[128:131]
  ds_read_b128 v[100:103], v19 offset:7168
  v_mfma_f32_16x16x32_bf16 v[156:159], v[48:51], a[96:99], v[156:159]
  buffer_load_dwordx4 a[44:47], v6, s[4:7], s50 offen offset:3072 sc1
  s_waitcnt lgkmcnt(12)
  v_mfma_f32_16x16x32_bf16 v[132:135], v[52:55], a[24:27], v[132:135]
  buffer_load_dwordx4 a[116:119], v6, s[4:7], s55 offen offset:3072 sc1
  v_mfma_f32_16x16x32_bf16 v[160:163], v[52:55], a[96:99], v[160:163]
  s_waitcnt lgkmcnt(11)
  v_mfma_f32_16x16x32_bf16 v[136:139], v[56:59], a[24:27], v[136:139]
  v_mfma_f32_16x16x32_bf16 v[164:167], v[56:59], a[96:99], v[164:167]
  s_waitcnt lgkmcnt(9)
  v_mfma_f32_16x16x32_bf16 v[168:171], v[60:63], v[64:67], v[168:171]
  v_mfma_f32_16x16x32_bf16 v[172:175], v[48:51], v[64:67], v[172:175]
  s_waitcnt vmcnt(9) lgkmcnt(8)
  v_mfma_f32_16x16x32_bf16 v[112:115], v[68:71], a[28:31], v[112:115]
  ds_read_b128 v[32:35], v1 offset:57344
  s_waitcnt vmcnt(8)
  v_mfma_f32_16x16x32_bf16 v[140:143], v[68:71], a[100:103], v[140:143]
  ds_read_b128 v[36:39], v1 offset:58368
  s_waitcnt lgkmcnt(9)
  v_mfma_f32_16x16x32_bf16 v[116:119], v[72:75], a[28:31], v[116:119]
  ds_read_b128 v[40:43], v1 offset:59392
  v_mfma_f32_16x16x32_bf16 v[144:147], v[72:75], a[100:103], v[144:147]
  ds_read_b128 v[44:47], v1 offset:60416
  s_waitcnt lgkmcnt(10)
  v_mfma_f32_16x16x32_bf16 v[120:123], v[76:79], a[28:31], v[120:123]
  ds_read_b128 v[48:51], v1 offset:61440
  v_mfma_f32_16x16x32_bf16 v[148:151], v[76:79], a[100:103], v[148:151]
  ds_read_b128 v[52:55], v1 offset:62464
  s_waitcnt lgkmcnt(11)
  v_mfma_f32_16x16x32_bf16 v[124:127], v[80:83], a[28:31], v[124:127]
  ds_read_b128 v[56:59], v1 offset:63488
  v_mfma_f32_16x16x32_bf16 v[152:155], v[80:83], a[100:103], v[152:155]
  ds_read_b128 v[60:63], v3 offset:57344
  s_waitcnt lgkmcnt(12)
  v_mfma_f32_16x16x32_bf16 v[128:131], v[84:87], a[28:31], v[128:131]
  ds_read_b128 v[64:67], v19 offset:8192
  v_mfma_f32_16x16x32_bf16 v[156:159], v[84:87], a[100:103], v[156:159]
  buffer_load_dwordx4 a[48:51], v6, s[4:7], s51 offen sc1
  s_waitcnt lgkmcnt(12)
  v_mfma_f32_16x16x32_bf16 v[132:135], v[88:91], a[28:31], v[132:135]
  buffer_load_dwordx4 a[120:123], v6, s[4:7], s56 offen sc1
  v_mfma_f32_16x16x32_bf16 v[160:163], v[88:91], a[100:103], v[160:163]
  s_waitcnt lgkmcnt(11)
  v_mfma_f32_16x16x32_bf16 v[136:139], v[92:95], a[28:31], v[136:139]
  v_mfma_f32_16x16x32_bf16 v[164:167], v[92:95], a[100:103], v[164:167]
  s_waitcnt lgkmcnt(9)
  v_mfma_f32_16x16x32_bf16 v[168:171], v[96:99], v[100:103], v[168:171]
  v_mfma_f32_16x16x32_bf16 v[172:175], v[84:87], v[100:103], v[172:175]
  s_waitcnt vmcnt(9) lgkmcnt(8)
  v_mfma_f32_16x16x32_bf16 v[112:115], v[32:35], a[32:35], v[112:115]
  ds_read_b128 v[68:71], v1 offset:64512
  s_waitcnt vmcnt(8)
  v_mfma_f32_16x16x32_bf16 v[140:143], v[32:35], a[104:107], v[140:143]
  ds_read_b128 v[72:75], v2
  s_waitcnt lgkmcnt(9)
  v_mfma_f32_16x16x32_bf16 v[116:119], v[36:39], a[32:35], v[116:119]
  ds_read_b128 v[76:79], v2 offset:1024
  v_mfma_f32_16x16x32_bf16 v[144:147], v[36:39], a[104:107], v[144:147]
  ds_read_b128 v[80:83], v2 offset:2048
  s_waitcnt lgkmcnt(10)
  v_mfma_f32_16x16x32_bf16 v[120:123], v[40:43], a[32:35], v[120:123]
  ds_read_b128 v[84:87], v2 offset:3072
  v_mfma_f32_16x16x32_bf16 v[148:151], v[40:43], a[104:107], v[148:151]
  ds_read_b128 v[88:91], v2 offset:4096
  s_waitcnt lgkmcnt(11)
  v_mfma_f32_16x16x32_bf16 v[124:127], v[44:47], a[32:35], v[124:127]
  ds_read_b128 v[92:95], v2 offset:5120
  v_mfma_f32_16x16x32_bf16 v[152:155], v[44:47], a[104:107], v[152:155]
  ds_read_b128 v[96:99], v3 offset:64512
  s_waitcnt lgkmcnt(12)
  v_mfma_f32_16x16x32_bf16 v[128:131], v[48:51], a[32:35], v[128:131]
  ds_read_b128 v[100:103], v19 offset:9216
  v_mfma_f32_16x16x32_bf16 v[156:159], v[48:51], a[104:107], v[156:159]
  buffer_load_dwordx4 a[52:55], v6, s[4:7], s51 offen offset:1024 sc1
  s_waitcnt lgkmcnt(12)
  v_mfma_f32_16x16x32_bf16 v[132:135], v[52:55], a[32:35], v[132:135]
  buffer_load_dwordx4 a[124:127], v6, s[4:7], s56 offen offset:1024 sc1
  v_mfma_f32_16x16x32_bf16 v[160:163], v[52:55], a[104:107], v[160:163]
  s_waitcnt lgkmcnt(11)
  v_mfma_f32_16x16x32_bf16 v[136:139], v[56:59], a[32:35], v[136:139]
  v_mfma_f32_16x16x32_bf16 v[164:167], v[56:59], a[104:107], v[164:167]
  s_waitcnt lgkmcnt(9)
  v_mfma_f32_16x16x32_bf16 v[168:171], v[60:63], v[64:67], v[168:171]
  v_mfma_f32_16x16x32_bf16 v[172:175], v[48:51], v[64:67], v[172:175]
  s_waitcnt vmcnt(9) lgkmcnt(8)
  v_mfma_f32_16x16x32_bf16 v[112:115], v[68:71], a[36:39], v[112:115]
  ds_read_b128 v[32:35], v2 offset:6144
  s_waitcnt vmcnt(8)
  v_mfma_f32_16x16x32_bf16 v[140:143], v[68:71], a[108:111], v[140:143]
  ds_read_b128 v[36:39], v2 offset:7168
  s_waitcnt lgkmcnt(9)
  v_mfma_f32_16x16x32_bf16 v[116:119], v[72:75], a[36:39], v[116:119]
  ds_read_b128 v[40:43], v2 offset:8192
  v_mfma_f32_16x16x32_bf16 v[144:147], v[72:75], a[108:111], v[144:147]
  ds_read_b128 v[44:47], v2 offset:9216
  s_waitcnt lgkmcnt(10)
  v_mfma_f32_16x16x32_bf16 v[120:123], v[76:79], a[36:39], v[120:123]
  ds_read_b128 v[48:51], v2 offset:10240
  v_mfma_f32_16x16x32_bf16 v[148:151], v[76:79], a[108:111], v[148:151]
  ds_read_b128 v[52:55], v2 offset:11264
  s_waitcnt lgkmcnt(11)
  v_mfma_f32_16x16x32_bf16 v[124:127], v[80:83], a[36:39], v[124:127]
  ds_read_b128 v[56:59], v2 offset:12288
  v_mfma_f32_16x16x32_bf16 v[152:155], v[80:83], a[108:111], v[152:155]
  ds_read_b128 v[60:63], v4 offset:6144
  s_waitcnt lgkmcnt(12)
  v_mfma_f32_16x16x32_bf16 v[128:131], v[84:87], a[36:39], v[128:131]
  ds_read_b128 v[64:67], v19 offset:10240
  v_mfma_f32_16x16x32_bf16 v[156:159], v[84:87], a[108:111], v[156:159]
  buffer_load_dwordx4 a[56:59], v6, s[4:7], s51 offen offset:2048 sc1
  s_waitcnt lgkmcnt(12)
  v_mfma_f32_16x16x32_bf16 v[132:135], v[88:91], a[36:39], v[132:135]
  buffer_load_dwordx4 a[128:131], v6, s[4:7], s56 offen offset:2048 sc1
  v_mfma_f32_16x16x32_bf16 v[160:163], v[88:91], a[108:111], v[160:163]
  s_waitcnt lgkmcnt(11)
  v_mfma_f32_16x16x32_bf16 v[136:139], v[92:95], a[36:39], v[136:139]
  v_mfma_f32_16x16x32_bf16 v[164:167], v[92:95], a[108:111], v[164:167]
  s_waitcnt lgkmcnt(9)
  v_mfma_f32_16x16x32_bf16 v[168:171], v[96:99], v[100:103], v[168:171]
  v_mfma_f32_16x16x32_bf16 v[172:175], v[84:87], v[100:103], v[172:175]
  s_waitcnt vmcnt(9) lgkmcnt(8)
  v_mfma_f32_16x16x32_bf16 v[112:115], v[32:35], a[40:43], v[112:115]
  ds_read_b128 v[68:71], v2 offset:13312
  s_waitcnt vmcnt(8)
  v_mfma_f32_16x16x32_bf16 v[140:143], v[32:35], a[112:115], v[140:143]
  ds_read_b128 v[72:75], v2 offset:14336
  s_waitcnt lgkmcnt(9)
  v_mfma_f32_16x16x32_bf16 v[116:119], v[36:39], a[40:43], v[116:119]
  ds_read_b128 v[76:79], v2 offset:15360
  v_mfma_f32_16x16x32_bf16 v[144:147], v[36:39], a[112:115], v[144:147]
  ds_read_b128 v[80:83], v2 offset:16384
  s_waitcnt lgkmcnt(10)
  v_mfma_f32_16x16x32_bf16 v[120:123], v[40:43], a[40:43], v[120:123]
  ds_read_b128 v[84:87], v2 offset:17408
  v_mfma_f32_16x16x32_bf16 v[148:151], v[40:43], a[112:115], v[148:151]
  ds_read_b128 v[88:91], v2 offset:18432
  s_waitcnt lgkmcnt(11)
  v_mfma_f32_16x16x32_bf16 v[124:127], v[44:47], a[40:43], v[124:127]
  ds_read_b128 v[92:95], v2 offset:19456
  v_mfma_f32_16x16x32_bf16 v[152:155], v[44:47], a[112:115], v[152:155]
  ds_read_b128 v[96:99], v4 offset:13312
  s_waitcnt lgkmcnt(12)
  v_mfma_f32_16x16x32_bf16 v[128:131], v[48:51], a[40:43], v[128:131]
  ds_read_b128 v[100:103], v19 offset:11264
  v_mfma_f32_16x16x32_bf16 v[156:159], v[48:51], a[112:115], v[156:159]
  buffer_load_dwordx4 a[60:63], v6, s[4:7], s51 offen offset:3072 sc1
  s_waitcnt lgkmcnt(12)
  v_mfma_f32_16x16x32_bf16 v[132:135], v[52:55], a[40:43], v[132:135]
  buffer_load_dwordx4 a[132:135], v6, s[4:7], s56 offen offset:3072 sc1
  v_mfma_f32_16x16x32_bf16 v[160:163], v[52:55], a[112:115], v[160:163]
  s_waitcnt lgkmcnt(11)
  v_mfma_f32_16x16x32_bf16 v[136:139], v[56:59], a[40:43], v[136:139]
  v_mfma_f32_16x16x32_bf16 v[164:167], v[56:59], a[112:115], v[164:167]
  s_waitcnt lgkmcnt(9)
  v_mfma_f32_16x16x32_bf16 v[168:171], v[60:63], v[64:67], v[168:171]
  v_mfma_f32_16x16x32_bf16 v[172:175], v[48:51], v[64:67], v[172:175]
  s_waitcnt vmcnt(9) lgkmcnt(8)
  v_mfma_f32_16x16x32_bf16 v[112:115], v[68:71], a[44:47], v[112:115]
  ds_read_b128 v[32:35], v2 offset:20480
  s_waitcnt vmcnt(8)
  v_mfma_f32_16x16x32_bf16 v[140:143], v[68:71], a[116:119], v[140:143]
  ds_read_b128 v[36:39], v2 offset:21504
  s_waitcnt lgkmcnt(9)
  v_mfma_f32_16x16x32_bf16 v[116:119], v[72:75], a[44:47], v[116:119]
  ds_read_b128 v[40:43], v2 offset:22528
  v_mfma_f32_16x16x32_bf16 v[144:147], v[72:75], a[116:119], v[144:147]
  ds_read_b128 v[44:47], v2 offset:23552
  s_waitcnt lgkmcnt(10)
  v_mfma_f32_16x16x32_bf16 v[120:123], v[76:79], a[44:47], v[120:123]
  ds_read_b128 v[48:51], v2 offset:24576
  v_mfma_f32_16x16x32_bf16 v[148:151], v[76:79], a[116:119], v[148:151]
  ds_read_b128 v[52:55], v2 offset:25600
  s_waitcnt lgkmcnt(11)
  v_mfma_f32_16x16x32_bf16 v[124:127], v[80:83], a[44:47], v[124:127]
  ds_read_b128 v[56:59], v2 offset:26624
  v_mfma_f32_16x16x32_bf16 v[152:155], v[80:83], a[116:119], v[152:155]
  ds_read_b128 v[60:63], v4 offset:20480
  s_waitcnt lgkmcnt(12)
  v_mfma_f32_16x16x32_bf16 v[128:131], v[84:87], a[44:47], v[128:131]
  ds_read_b128 v[64:67], v19 offset:12288
  v_mfma_f32_16x16x32_bf16 v[156:159], v[84:87], a[116:119], v[156:159]
  buffer_load_dwordx4 a[64:67], v6, s[4:7], s52 offen sc1
  s_waitcnt lgkmcnt(12)
  v_mfma_f32_16x16x32_bf16 v[132:135], v[88:91], a[44:47], v[132:135]
  buffer_load_dwordx4 a[136:139], v6, s[4:7], s57 offen sc1
  v_mfma_f32_16x16x32_bf16 v[160:163], v[88:91], a[116:119], v[160:163]
  s_waitcnt lgkmcnt(11)
  v_mfma_f32_16x16x32_bf16 v[136:139], v[92:95], a[44:47], v[136:139]
  v_mfma_f32_16x16x32_bf16 v[164:167], v[92:95], a[116:119], v[164:167]
  s_waitcnt lgkmcnt(9)
  v_mfma_f32_16x16x32_bf16 v[168:171], v[96:99], v[100:103], v[168:171]
  v_mfma_f32_16x16x32_bf16 v[172:175], v[84:87], v[100:103], v[172:175]
  s_waitcnt vmcnt(9) lgkmcnt(8)
  v_mfma_f32_16x16x32_bf16 v[112:115], v[32:35], a[48:51], v[112:115]
  ds_read_b128 v[68:71], v2 offset:27648
  s_waitcnt vmcnt(8)
  v_mfma_f32_16x16x32_bf16 v[140:143], v[32:35], a[120:123], v[140:143]
  ds_read_b128 v[72:75], v2 offset:28672
  s_waitcnt lgkmcnt(9)
  v_mfma_f32_16x16x32_bf16 v[116:119], v[36:39], a[48:51], v[116:119]
  ds_read_b128 v[76:79], v2 offset:29696
  v_mfma_f32_16x16x32_bf16 v[144:147], v[36:39], a[120:123], v[144:147]
  ds_read_b128 v[80:83], v2 offset:30720
  s_waitcnt lgkmcnt(10)
  v_mfma_f32_16x16x32_bf16 v[120:123], v[40:43], a[48:51], v[120:123]
  ds_read_b128 v[84:87], v2 offset:31744
  v_mfma_f32_16x16x32_bf16 v[148:151], v[40:43], a[120:123], v[148:151]
  ds_read_b128 v[88:91], v2 offset:32768
  s_waitcnt lgkmcnt(11)
  v_mfma_f32_16x16x32_bf16 v[124:127], v[44:47], a[48:51], v[124:127]
  ds_read_b128 v[92:95], v2 offset:33792
  v_mfma_f32_16x16x32_bf16 v[152:155], v[44:47], a[120:123], v[152:155]
  ds_read_b128 v[96:99], v4 offset:27648
  s_waitcnt lgkmcnt(12)
  v_mfma_f32_16x16x32_bf16 v[128:131], v[48:51], a[48:51], v[128:131]
  ds_read_b128 v[100:103], v19 offset:13312
  v_mfma_f32_16x16x32_bf16 v[156:159], v[48:51], a[120:123], v[156:159]
  buffer_load_dwordx4 a[68:71], v6, s[4:7], s52 offen offset:1024 sc1
  s_waitcnt lgkmcnt(12)
  v_mfma_f32_16x16x32_bf16 v[132:135], v[52:55], a[48:51], v[132:135]
  buffer_load_dwordx4 a[140:143], v6, s[4:7], s57 offen offset:1024 sc1
  v_mfma_f32_16x16x32_bf16 v[160:163], v[52:55], a[120:123], v[160:163]
  s_waitcnt lgkmcnt(11)
  v_mfma_f32_16x16x32_bf16 v[136:139], v[56:59], a[48:51], v[136:139]
  v_mfma_f32_16x16x32_bf16 v[164:167], v[56:59], a[120:123], v[164:167]
  s_waitcnt lgkmcnt(9)
  v_mfma_f32_16x16x32_bf16 v[168:171], v[60:63], v[64:67], v[168:171]
  v_mfma_f32_16x16x32_bf16 v[172:175], v[48:51], v[64:67], v[172:175]
  s_waitcnt vmcnt(9) lgkmcnt(8)
  v_mfma_f32_16x16x32_bf16 v[112:115], v[68:71], a[52:55], v[112:115]
  ds_read_b128 v[32:35], v2 offset:34816
  s_waitcnt vmcnt(8)
  v_mfma_f32_16x16x32_bf16 v[140:143], v[68:71], a[124:127], v[140:143]
  ds_read_b128 v[36:39], v2 offset:35840
  s_waitcnt lgkmcnt(9)
  v_mfma_f32_16x16x32_bf16 v[116:119], v[72:75], a[52:55], v[116:119]
  ds_read_b128 v[40:43], v2 offset:36864
  v_mfma_f32_16x16x32_bf16 v[144:147], v[72:75], a[124:127], v[144:147]
  ds_read_b128 v[44:47], v2 offset:37888
  s_waitcnt lgkmcnt(10)
  v_mfma_f32_16x16x32_bf16 v[120:123], v[76:79], a[52:55], v[120:123]
  ds_read_b128 v[48:51], v2 offset:38912
  v_mfma_f32_16x16x32_bf16 v[148:151], v[76:79], a[124:127], v[148:151]
  ds_read_b128 v[52:55], v2 offset:39936
  s_waitcnt lgkmcnt(11)
  v_mfma_f32_16x16x32_bf16 v[124:127], v[80:83], a[52:55], v[124:127]
  ds_read_b128 v[56:59], v2 offset:40960
  v_mfma_f32_16x16x32_bf16 v[152:155], v[80:83], a[124:127], v[152:155]
  ds_read_b128 v[60:63], v4 offset:34816
  s_waitcnt lgkmcnt(12)
  v_mfma_f32_16x16x32_bf16 v[128:131], v[84:87], a[52:55], v[128:131]
  ds_read_b128 v[64:67], v19 offset:14336
  v_mfma_f32_16x16x32_bf16 v[156:159], v[84:87], a[124:127], v[156:159]
  buffer_load_dwordx4 a[144:147], v249, s[60:63], s48 offen
  s_waitcnt lgkmcnt(12)
  v_mfma_f32_16x16x32_bf16 v[132:135], v[88:91], a[52:55], v[132:135]
  buffer_load_dwordx4 a[148:151], v249, s[60:63], s48 offen offset:1024
  v_mfma_f32_16x16x32_bf16 v[160:163], v[88:91], a[124:127], v[160:163]
  buffer_load_dwordx4 a[152:155], v249, s[60:63], s48 offen offset:2048
  s_waitcnt lgkmcnt(11)
  v_mfma_f32_16x16x32_bf16 v[136:139], v[92:95], a[52:55], v[136:139]
  buffer_load_dwordx4 a[156:159], v249, s[60:63], s48 offen offset:3072
  v_mfma_f32_16x16x32_bf16 v[164:167], v[92:95], a[124:127], v[164:167]
  s_waitcnt lgkmcnt(9)
  v_mfma_f32_16x16x32_bf16 v[168:171], v[96:99], v[100:103], v[168:171]
  v_mfma_f32_16x16x32_bf16 v[172:175], v[84:87], v[100:103], v[172:175]
  s_waitcnt vmcnt(11) lgkmcnt(8)
  v_mfma_f32_16x16x32_bf16 v[112:115], v[32:35], a[56:59], v[112:115]
  ds_read_b128 v[68:71], v2 offset:41984
  s_waitcnt vmcnt(10)
  v_mfma_f32_16x16x32_bf16 v[140:143], v[32:35], a[128:131], v[140:143]
  ds_read_b128 v[72:75], v2 offset:43008
  s_waitcnt lgkmcnt(9)
  v_mfma_f32_16x16x32_bf16 v[116:119], v[36:39], a[56:59], v[116:119]
  ds_read_b128 v[76:79], v2 offset:44032
  v_mfma_f32_16x16x32_bf16 v[144:147], v[36:39], a[128:131], v[144:147]
  ds_read_b128 v[80:83], v2 offset:45056
  s_waitcnt lgkmcnt(10)
  v_mfma_f32_16x16x32_bf16 v[120:123], v[40:43], a[56:59], v[120:123]
  ds_read_b128 v[84:87], v2 offset:46080
  v_mfma_f32_16x16x32_bf16 v[148:151], v[40:43], a[128:131], v[148:151]
  ds_read_b128 v[88:91], v2 offset:47104
  s_waitcnt lgkmcnt(11)
  v_mfma_f32_16x16x32_bf16 v[124:127], v[44:47], a[56:59], v[124:127]
  ds_read_b128 v[92:95], v2 offset:48128
  v_mfma_f32_16x16x32_bf16 v[152:155], v[44:47], a[128:131], v[152:155]
  ds_read_b128 v[96:99], v4 offset:41984
  s_waitcnt lgkmcnt(12)
  v_mfma_f32_16x16x32_bf16 v[128:131], v[48:51], a[56:59], v[128:131]
  ds_read_b128 v[100:103], v19 offset:15360
  v_mfma_f32_16x16x32_bf16 v[156:159], v[48:51], a[128:131], v[156:159]
  buffer_load_dwordx4 a[160:163], v249, s[60:63], s49 offen
  s_waitcnt lgkmcnt(12)
  v_mfma_f32_16x16x32_bf16 v[132:135], v[52:55], a[56:59], v[132:135]
  buffer_load_dwordx4 a[164:167], v249, s[60:63], s49 offen offset:1024
  v_mfma_f32_16x16x32_bf16 v[160:163], v[52:55], a[128:131], v[160:163]
  buffer_load_dwordx4 a[168:171], v249, s[60:63], s49 offen offset:2048
  s_waitcnt lgkmcnt(11)
  v_mfma_f32_16x16x32_bf16 v[136:139], v[56:59], a[56:59], v[136:139]
  buffer_load_dwordx4 a[172:175], v249, s[60:63], s49 offen offset:3072
  v_mfma_f32_16x16x32_bf16 v[164:167], v[56:59], a[128:131], v[164:167]
  s_waitcnt lgkmcnt(9)
  v_mfma_f32_16x16x32_bf16 v[168:171], v[60:63], v[64:67], v[168:171]
  v_mfma_f32_16x16x32_bf16 v[172:175], v[48:51], v[64:67], v[172:175]
  s_waitcnt vmcnt(13) lgkmcnt(8)
  v_mfma_f32_16x16x32_bf16 v[112:115], v[68:71], a[60:63], v[112:115]
  ds_read_b128 v[32:35], v2 offset:49152
  s_waitcnt vmcnt(12)
  v_mfma_f32_16x16x32_bf16 v[140:143], v[68:71], a[132:135], v[140:143]
  ds_read_b128 v[36:39], v2 offset:50176
  s_waitcnt lgkmcnt(9)
  v_mfma_f32_16x16x32_bf16 v[116:119], v[72:75], a[60:63], v[116:119]
  ds_read_b128 v[40:43], v2 offset:51200
  v_mfma_f32_16x16x32_bf16 v[144:147], v[72:75], a[132:135], v[144:147]
  ds_read_b128 v[44:47], v2 offset:52224
  s_waitcnt lgkmcnt(10)
  v_mfma_f32_16x16x32_bf16 v[120:123], v[76:79], a[60:63], v[120:123]
  ds_read_b128 v[48:51], v2 offset:53248
  v_mfma_f32_16x16x32_bf16 v[148:151], v[76:79], a[132:135], v[148:151]
  ds_read_b128 v[52:55], v2 offset:54272
  s_waitcnt lgkmcnt(11)
  v_mfma_f32_16x16x32_bf16 v[124:127], v[80:83], a[60:63], v[124:127]
  ds_read_b128 v[56:59], v2 offset:55296
  v_mfma_f32_16x16x32_bf16 v[152:155], v[80:83], a[132:135], v[152:155]
  ds_read_b128 v[60:63], v4 offset:49152
  s_waitcnt lgkmcnt(12)
  v_mfma_f32_16x16x32_bf16 v[128:131], v[84:87], a[60:63], v[128:131]
  ds_read_b128 v[64:67], v19 offset:16384
  v_mfma_f32_16x16x32_bf16 v[156:159], v[84:87], a[132:135], v[156:159]
  buffer_load_dwordx4 a[176:179], v249, s[60:63], s50 offen
  s_waitcnt lgkmcnt(12)
  v_mfma_f32_16x16x32_bf16 v[132:135], v[88:91], a[60:63], v[132:135]
  buffer_load_dwordx4 a[180:183], v249, s[60:63], s50 offen offset:1024
  v_mfma_f32_16x16x32_bf16 v[160:163], v[88:91], a[132:135], v[160:163]
  buffer_load_dwordx4 a[184:187], v249, s[60:63], s50 offen offset:2048
  s_waitcnt lgkmcnt(11)
  v_mfma_f32_16x16x32_bf16 v[136:139], v[92:95], a[60:63], v[136:139]
  buffer_load_dwordx4 a[188:191], v249, s[60:63], s50 offen offset:3072
  v_mfma_f32_16x16x32_bf16 v[164:167], v[92:95], a[132:135], v[164:167]
  s_waitcnt lgkmcnt(9)
  v_mfma_f32_16x16x32_bf16 v[168:171], v[96:99], v[100:103], v[168:171]
  v_mfma_f32_16x16x32_bf16 v[172:175], v[84:87], v[100:103], v[172:175]
  s_waitcnt vmcnt(15) lgkmcnt(8)
  v_mfma_f32_16x16x32_bf16 v[112:115], v[32:35], a[64:67], v[112:115]
  ds_read_b128 v[68:71], v2 offset:56320
  s_waitcnt vmcnt(14)
  v_mfma_f32_16x16x32_bf16 v[140:143], v[32:35], a[136:139], v[140:143]
  ds_read_b128 v[72:75], v2 offset:57344
  s_waitcnt lgkmcnt(9)
  v_mfma_f32_16x16x32_bf16 v[116:119], v[36:39], a[64:67], v[116:119]
  ds_read_b128 v[76:79], v2 offset:58368
  v_mfma_f32_16x16x32_bf16 v[144:147], v[36:39], a[136:139], v[144:147]
  ds_read_b128 v[80:83], v2 offset:59392
  s_waitcnt lgkmcnt(10)
  v_mfma_f32_16x16x32_bf16 v[120:123], v[40:43], a[64:67], v[120:123]
  ds_read_b128 v[84:87], v2 offset:60416
  v_mfma_f32_16x16x32_bf16 v[148:151], v[40:43], a[136:139], v[148:151]
  ds_read_b128 v[88:91], v2 offset:61440
  s_waitcnt lgkmcnt(11)
  v_mfma_f32_16x16x32_bf16 v[124:127], v[44:47], a[64:67], v[124:127]
  ds_read_b128 v[92:95], v2 offset:62464
  v_mfma_f32_16x16x32_bf16 v[152:155], v[44:47], a[136:139], v[152:155]
  ds_read_b128 v[96:99], v4 offset:56320
  s_waitcnt lgkmcnt(12)
  v_mfma_f32_16x16x32_bf16 v[128:131], v[48:51], a[64:67], v[128:131]
  ds_read_b128 v[100:103], v19 offset:17408
  v_mfma_f32_16x16x32_bf16 v[156:159], v[48:51], a[136:139], v[156:159]
  buffer_load_dwordx4 a[192:195], v249, s[60:63], s51 offen
  s_waitcnt lgkmcnt(12)
  v_mfma_f32_16x16x32_bf16 v[132:135], v[52:55], a[64:67], v[132:135]
  buffer_load_dwordx4 a[196:199], v249, s[60:63], s51 offen offset:1024
  v_mfma_f32_16x16x32_bf16 v[160:163], v[52:55], a[136:139], v[160:163]
  buffer_load_dwordx4 a[200:203], v249, s[60:63], s51 offen offset:2048
  s_waitcnt lgkmcnt(11)
  v_mfma_f32_16x16x32_bf16 v[136:139], v[56:59], a[64:67], v[136:139]
  buffer_load_dwordx4 a[204:207], v249, s[60:63], s51 offen offset:3072
  v_mfma_f32_16x16x32_bf16 v[164:167], v[56:59], a[136:139], v[164:167]
  s_waitcnt lgkmcnt(9)
  v_mfma_f32_16x16x32_bf16 v[168:171], v[60:63], v[64:67], v[168:171]
  v_mfma_f32_16x16x32_bf16 v[172:175], v[48:51], v[64:67], v[172:175]
  s_waitcnt vmcnt(17) lgkmcnt(8)
  v_mfma_f32_16x16x32_bf16 v[112:115], v[68:71], a[68:71], v[112:115]
  buffer_load_dwordx4 a[208:211], v249, s[60:63], s52 offen
  s_waitcnt vmcnt(17)
  v_mfma_f32_16x16x32_bf16 v[140:143], v[68:71], a[140:143], v[140:143]
  buffer_load_dwordx4 a[212:215], v249, s[60:63], s52 offen offset:1024
  s_waitcnt lgkmcnt(7)
  v_mfma_f32_16x16x32_bf16 v[116:119], v[72:75], a[68:71], v[116:119]
  v_mfma_f32_16x16x32_bf16 v[144:147], v[72:75], a[140:143], v[144:147]
  s_waitcnt lgkmcnt(6)
  v_mfma_f32_16x16x32_bf16 v[120:123], v[76:79], a[68:71], v[120:123]
  v_mfma_f32_16x16x32_bf16 v[148:151], v[76:79], a[140:143], v[148:151]
  s_waitcnt lgkmcnt(5)
  v_mfma_f32_16x16x32_bf16 v[124:127], v[80:83], a[68:71], v[124:127]
  v_mfma_f32_16x16x32_bf16 v[152:155], v[80:83], a[140:143], v[152:155]
  s_waitcnt lgkmcnt(4)
  v_mfma_f32_16x16x32_bf16 v[128:131], v[84:87], a[68:71], v[128:131]
  v_mfma_f32_16x16x32_bf16 v[156:159], v[84:87], a[140:143], v[156:159]
  s_waitcnt lgkmcnt(3)
  v_mfma_f32_16x16x32_bf16 v[132:135], v[88:91], a[68:71], v[132:135]
  v_mfma_f32_16x16x32_bf16 v[160:163], v[88:91], a[140:143], v[160:163]
  s_waitcnt lgkmcnt(2)
  v_mfma_f32_16x16x32_bf16 v[136:139], v[92:95], a[68:71], v[136:139]
  v_mfma_f32_16x16x32_bf16 v[164:167], v[92:95], a[140:143], v[164:167]
  s_waitcnt lgkmcnt(0)
  v_mfma_f32_16x16x32_bf16 v[168:171], v[96:99], v[100:103], v[168:171]
  v_mfma_f32_16x16x32_bf16 v[172:175], v[84:87], v[100:103], v[172:175]
  s_barrier
  v_mul_f32 v112, v112, v9
  v_mul_f32 v113, v113, v9
  v_mul_f32 v114, v114, v9
  v_mul_f32 v115, v115, v9
  v_cvt_pk_bf16_f32 v32, v112, v113
  v_cvt_pk_bf16_f32 v33, v114, v115
  ds_write_b64 v13, v[32:33]
  buffer_load_dwordx4 a[0:3], v248, s[60:63], s48 offen
  v_mul_f32 v140, v140, v10
  v_mul_f32 v141, v141, v10
  v_mul_f32 v142, v142, v10
  v_mul_f32 v143, v143, v10
  v_cvt_pk_bf16_f32 v34, v140, v141
  v_cvt_pk_bf16_f32 v35, v142, v143
  ds_write_b64 v13, v[34:35] offset:3840
  buffer_load_dwordx4 a[72:75], v248, s[60:63], s53 offen
  v_mul_f32 v116, v116, v9
  v_mul_f32 v117, v117, v9
  v_mul_f32 v118, v118, v9
  v_mul_f32 v119, v119, v9
  v_cvt_pk_bf16_f32 v36, v116, v117
  v_cvt_pk_bf16_f32 v37, v118, v119
  ds_write_b64 v13, v[36:37] offset:32
  buffer_load_dwordx4 a[4:7], v248, s[60:63], s48 offen offset:1024
  v_mul_f32 v144, v144, v10
  v_mul_f32 v145, v145, v10
  v_mul_f32 v146, v146, v10
  v_mul_f32 v147, v147, v10
  v_cvt_pk_bf16_f32 v38, v144, v145
  v_cvt_pk_bf16_f32 v39, v146, v147
  ds_write_b64 v13, v[38:39] offset:3872
  buffer_load_dwordx4 a[76:79], v248, s[60:63], s53 offen offset:1024
  v_mul_f32 v120, v120, v9
  v_mul_f32 v121, v121, v9
  v_mul_f32 v122, v122, v9
  v_mul_f32 v123, v123, v9
  v_cvt_pk_bf16_f32 v32, v120, v121
  v_cvt_pk_bf16_f32 v33, v122, v123
  ds_write_b64 v13, v[32:33] offset:64
  buffer_load_dwordx4 a[8:11], v248, s[60:63], s48 offen offset:2048
  v_mul_f32 v148, v148, v10
  v_mul_f32 v149, v149, v10
  v_mul_f32 v150, v150, v10
  v_mul_f32 v151, v151, v10
  v_cvt_pk_bf16_f32 v34, v148, v149
  v_cvt_pk_bf16_f32 v35, v150, v151
  ds_write_b64 v13, v[34:35] offset:3904
  buffer_load_dwordx4 a[80:83], v248, s[60:63], s53 offen offset:2048
  v_mul_f32 v124, v124, v9
  v_mul_f32 v125, v125, v9
  v_mul_f32 v126, v126, v9
  v_mul_f32 v127, v127, v9
  v_cvt_pk_bf16_f32 v36, v124, v125
  v_cvt_pk_bf16_f32 v37, v126, v127
  ds_write_b64 v13, v[36:37] offset:96
  buffer_load_dwordx4 a[12:15], v248, s[60:63], s48 offen offset:3072
  v_mul_f32 v152, v152, v10
  v_mul_f32 v153, v153, v10
  v_mul_f32 v154, v154, v10
  v_mul_f32 v155, v155, v10
  v_cvt_pk_bf16_f32 v38, v152, v153
  v_cvt_pk_bf16_f32 v39, v154, v155
  ds_write_b64 v13, v[38:39] offset:3936
  buffer_load_dwordx4 a[84:87], v248, s[60:63], s53 offen offset:3072
  v_mul_f32 v128, v128, v9
  v_mul_f32 v129, v129, v9
  v_mul_f32 v130, v130, v9
  v_mul_f32 v131, v131, v9
  v_cvt_pk_bf16_f32 v32, v128, v129
  v_cvt_pk_bf16_f32 v33, v130, v131
  ds_write_b64 v13, v[32:33] offset:128
  buffer_load_dwordx4 a[16:19], v248, s[60:63], s49 offen
  v_mul_f32 v156, v156, v10
  v_mul_f32 v157, v157, v10
  v_mul_f32 v158, v158, v10
  v_mul_f32 v159, v159, v10
  v_cvt_pk_bf16_f32 v34, v156, v157
  v_cvt_pk_bf16_f32 v35, v158, v159
  ds_write_b64 v13, v[34:35] offset:3968
  buffer_load_dwordx4 a[88:91], v248, s[60:63], s54 offen
  v_mul_f32 v132, v132, v9
  v_mul_f32 v133, v133, v9
  v_mul_f32 v134, v134, v9
  v_mul_f32 v135, v135, v9
  v_cvt_pk_bf16_f32 v36, v132, v133
  v_cvt_pk_bf16_f32 v37, v134, v135
  ds_write_b64 v13, v[36:37] offset:160
  buffer_load_dwordx4 a[20:23], v248, s[60:63], s49 offen offset:1024
  v_mul_f32 v160, v160, v10
  v_mul_f32 v161, v161, v10
  v_mul_f32 v162, v162, v10
  v_mul_f32 v163, v163, v10
  v_cvt_pk_bf16_f32 v38, v160, v161
  v_cvt_pk_bf16_f32 v39, v162, v163
  ds_write_b64 v13, v[38:39] offset:4000
  buffer_load_dwordx4 a[92:95], v248, s[60:63], s54 offen offset:1024
  v_mul_f32 v136, v136, v9
  v_mul_f32 v137, v137, v9
  v_mul_f32 v138, v138, v9
  v_mul_f32 v139, v139, v9
  v_cvt_pk_bf16_f32 v32, v136, v137
  v_cvt_pk_bf16_f32 v33, v138, v139
  ds_write_b64 v13, v[32:33] offset:192
  buffer_load_dwordx4 a[24:27], v248, s[60:63], s49 offen offset:2048
  v_mul_f32 v164, v164, v10
  v_mul_f32 v165, v165, v10
  v_mul_f32 v166, v166, v10
  v_mul_f32 v167, v167, v10
  v_cvt_pk_bf16_f32 v34, v164, v165
  v_cvt_pk_bf16_f32 v35, v166, v167
  ds_write_b64 v13, v[34:35] offset:4032
  buffer_load_dwordx4 a[96:99], v248, s[60:63], s54 offen offset:2048
  v_mul_f32 v168, v168, v8
  v_mul_f32 v169, v169, v8
  v_mul_f32 v170, v170, v8
  v_mul_f32 v171, v171, v8
  v_cvt_pk_bf16_f32 v36, v168, v169
  v_cvt_pk_bf16_f32 v37, v170, v171
  ds_write_b64 v11, v[36:37]
  buffer_load_dwordx4 a[28:31], v248, s[60:63], s49 offen offset:3072
  v_mul_f32 v172, v172, v8
  v_mul_f32 v173, v173, v8
  v_mul_f32 v174, v174, v8
  v_mul_f32 v175, v175, v8
  v_cvt_pk_bf16_f32 v38, v172, v173
  v_cvt_pk_bf16_f32 v39, v174, v175
  ds_write_b64 v12, v[38:39]
  buffer_load_dwordx4 a[100:103], v248, s[60:63], s54 offen offset:3072
  s_waitcnt lgkmcnt(0)
  s_barrier
  ds_read2_b32 v[192:193], v15 offset0:0 offset1:1
  ds_read2_b32 v[194:195], v15 offset0:2 offset1:3
  ds_read2_b32 v[196:197], v15 offset0:4 offset1:5
  ds_read2_b32 v[198:199], v15 offset0:6 offset1:7
  ds_read_b32 v200, v15 offset:32
  ds_read_b128 v[32:35], v14 offset:3360
  ds_read_b128 v[36:39], v14 offset:3376
  ds_read_b128 v[40:43], v14 offset:3392
  ds_read_b128 v[52:55], v14 offset:2880
  ds_read_b128 v[56:59], v14 offset:2896
  ds_read_b128 v[60:63], v14 offset:2912
  ds_read_b128 v[72:75], v14 offset:2400
  ds_read_b128 v[76:79], v14 offset:2416
  ds_read_b128 v[80:83], v14 offset:2432
  ds_read_b128 v[92:95], v14 offset:1920
  ds_read_b128 v[96:99], v14 offset:1936
  ds_read_b128 v[100:103], v14 offset:1952
  ds_read_b128 v[112:115], v14 offset:1440
  ds_read_b128 v[116:119], v14 offset:1456
  ds_read_b128 v[120:123], v14 offset:1472
  ds_read_b128 v[132:135], v14 offset:960
  ds_read_b128 v[136:139], v14 offset:976
  ds_read_b128 v[140:143], v14 offset:992
  ds_read_b128 v[152:155], v14 offset:480
  ds_read_b128 v[156:159], v14 offset:496
  ds_read_b128 v[160:163], v14 offset:512
  ds_read_b128 v[172:175], v14
  ds_read_b128 v[176:179], v14 offset:16
  ds_read_b128 v[180:183], v14 offset:32
  s_waitcnt lgkmcnt(15)
  v_dot2_f32_bf16 v204, v192, v32, 0
  v_dot2_f32_bf16 v205, v192, v52, 0
  v_dot2_f32_bf16 v206, v192, v72, 0
  s_waitcnt lgkmcnt(14)
  v_dot2_f32_bf16 v207, v192, v92, 0
  ds_read_b128 v[44:47], v14 offset:3408
  ds_read_b64 v[48:49], v14 offset:3424
  v_dot2_f32_bf16 v204, v193, v33, v204
  v_dot2_f32_bf16 v205, v193, v53, v205
  v_dot2_f32_bf16 v206, v193, v73, v206
  v_dot2_f32_bf16 v207, v193, v93, v207
  ds_read_b128 v[64:67], v14 offset:2928
  ds_read_b64 v[68:69], v14 offset:2944
  v_dot2_f32_bf16 v204, v194, v34, v204
  v_dot2_f32_bf16 v205, v194, v54, v205
  v_dot2_f32_bf16 v206, v194, v74, v206
  v_dot2_f32_bf16 v207, v194, v94, v207
  ds_read_b128 v[84:87], v14 offset:2448
  ds_read_b64 v[88:89], v14 offset:2464
  v_dot2_f32_bf16 v204, v195, v35, v204
  v_dot2_f32_bf16 v205, v195, v55, v205
  v_dot2_f32_bf16 v206, v195, v75, v206
  v_dot2_f32_bf16 v207, v195, v95, v207
  ds_read_b128 v[104:107], v14 offset:1968
  ds_read_b64 v[108:109], v14 offset:1984
  v_dot2_f32_bf16 v204, v196, v36, v204
  v_dot2_f32_bf16 v205, v196, v56, v205
  v_dot2_f32_bf16 v206, v196, v76, v206
  s_waitcnt lgkmcnt(15)
  v_dot2_f32_bf16 v207, v196, v96, v207
  ds_read_b128 v[124:127], v14 offset:1488
  ds_read_b64 v[128:129], v14 offset:1504
  v_dot2_f32_bf16 v204, v197, v37, v204
  v_dot2_f32_bf16 v205, v197, v57, v205
  v_dot2_f32_bf16 v206, v197, v77, v206
  v_dot2_f32_bf16 v207, v197, v97, v207
  ds_read_b128 v[144:147], v14 offset:1008
  ds_read_b64 v[148:149], v14 offset:1024
  v_dot2_f32_bf16 v204, v198, v38, v204
  v_dot2_f32_bf16 v205, v198, v58, v205
  v_dot2_f32_bf16 v206, v198, v78, v206
  v_dot2_f32_bf16 v207, v198, v98, v207
  ds_read_b128 v[164:167], v14 offset:528
  ds_read_b64 v[168:169], v14 offset:544
  v_dot2_f32_bf16 v204, v199, v39, v204
  v_dot2_f32_bf16 v205, v199, v59, v205
  v_dot2_f32_bf16 v206, v199, v79, v206
  v_dot2_f32_bf16 v207, v199, v99, v207
  ds_read_b128 v[184:187], v14 offset:48
  ds_read_b64 v[188:189], v14 offset:64
  v_dot2_f32_bf16 v204, v200, v40, v204
  v_dot2_f32_bf16 v205, v200, v60, v205
  v_dot2_f32_bf16 v206, v200, v80, v206
  v_dot2_f32_bf16 v207, v200, v100, v207
  v_dot2_f32_bf16 v208, v192, v112, 0
  v_dot2_f32_bf16 v209, v192, v132, 0
  s_waitcnt lgkmcnt(15)
  v_dot2_f32_bf16 v210, v192, v152, 0
  v_dot2_f32_bf16 v211, v192, v172, 0
  v_dot2_f32_bf16 v208, v193, v113, v208
  v_dot2_f32_bf16 v209, v193, v133, v209
  v_dot2_f32_bf16 v210, v193, v153, v210
  v_dot2_f32_bf16 v211, v193, v173, v211
  v_dot2_f32_bf16 v208, v194, v114, v208
  v_dot2_f32_bf16 v209, v194, v134, v209
  v_dot2_f32_bf16 v210, v194, v154, v210
  v_dot2_f32_bf16 v211, v194, v174, v211
  v_dot2_f32_bf16 v208, v195, v115, v208
  v_dot2_f32_bf16 v209, v195, v135, v209
  v_dot2_f32_bf16 v210, v195, v155, v210
  v_dot2_f32_bf16 v211, v195, v175, v211
  v_dot2_f32_bf16 v208, v196, v116, v208
  v_dot2_f32_bf16 v209, v196, v136, v209
  v_dot2_f32_bf16 v210, v196, v156, v210
  v_dot2_f32_bf16 v211, v196, v176, v211
  v_dot2_f32_bf16 v208, v197, v117, v208
  v_dot2_f32_bf16 v209, v197, v137, v209
  v_dot2_f32_bf16 v210, v197, v157, v210
  v_dot2_f32_bf16 v211, v197, v177, v211
  v_dot2_f32_bf16 v208, v198, v118, v208
  v_dot2_f32_bf16 v209, v198, v138, v209
  v_dot2_f32_bf16 v210, v198, v158, v210
  v_dot2_f32_bf16 v211, v198, v178, v211
  v_dot2_f32_bf16 v208, v199, v119, v208
  v_dot2_f32_bf16 v209, v199, v139, v209
  v_dot2_f32_bf16 v210, v199, v159, v210
  v_dot2_f32_bf16 v211, v199, v179, v211
  v_dot2_f32_bf16 v208, v200, v120, v208
  v_dot2_f32_bf16 v209, v200, v140, v209
  v_dot2_f32_bf16 v210, v200, v160, v210
  v_dot2_f32_bf16 v211, v200, v180, v211
  v_mul_f32 v204, 0x3eae1a93, v204
  v_mul_f32 v205, 0x3eae1a93, v205
  v_mul_f32 v206, 0x3eae1a93, v206
  v_mul_f32 v207, 0x3eae1a93, v207
  v_mul_f32 v208, 0x3eae1a93, v208
  v_mul_f32 v209, 0x3eae1a93, v209
  v_mul_f32 v210, 0x3eae1a93, v210
  v_mul_f32 v211, 0x3eae1a93, v211
  v_cndmask_b32 v205, v18, v205, s[64:65]
  v_cndmask_b32 v206, v18, v206, s[66:67]
  v_cndmask_b32 v207, v18, v207, s[68:69]
  v_cndmask_b32 v208, v18, v208, s[70:71]
  v_cndmask_b32 v209, v18, v209, s[72:73]
  v_cndmask_b32 v210, v18, v210, s[74:75]
  v_cndmask_b32 v211, v18, v211, s[76:77]
  v_max3_f32 v244, v204, v205, v206
  v_max3_f32 v245, v207, v208, v209
  v_max3_f32 v244, v244, v210, v211
  v_max_f32 v244, v244, v245
  v_sub_f32 v204, v204, v244
  v_sub_f32 v205, v205, v244
  v_sub_f32 v206, v206, v244
  v_sub_f32 v207, v207, v244
  v_sub_f32 v208, v208, v244
  v_sub_f32 v209, v209, v244
  v_sub_f32 v210, v210, v244
  v_sub_f32 v211, v211, v244
  v_exp_f32 v204, v204
  v_exp_f32 v205, v205
  v_exp_f32 v206, v206
  v_exp_f32 v207, v207
  v_exp_f32 v208, v208
  v_exp_f32 v209, v209
  v_exp_f32 v210, v210
  v_exp_f32 v211, v211
  v_cvt_pk_bf16_f32 v212, v204, v205
  v_cvt_pk_bf16_f32 v213, v206, v207
  v_cvt_pk_bf16_f32 v214, v208, v209
  v_cvt_pk_bf16_f32 v215, v210, v211
  v_dot2_f32_bf16 v246, v212, s34, 0
  v_dot2_f32_bf16 v246, v213, s34, v246
  v_dot2_f32_bf16 v246, v214, s34, v246
  v_dot2_f32_bf16 v246, v215, s34, v246
  v_perm_b32 v236, v61, v41, s32
  v_perm_b32 v237, v61, v41, s33
  v_perm_b32 v238, v62, v42, s32
  v_perm_b32 v239, v62, v42, s33
  v_dot2_f32_bf16 v216, v212, v236, 0
  v_dot2_f32_bf16 v217, v212, v237, 0
  v_perm_b32 v240, v63, v43, s32
  v_perm_b32 v241, v63, v43, s33
  v_dot2_f32_bf16 v218, v212, v238, 0
  v_dot2_f32_bf16 v219, v212, v239, 0
  s_waitcnt lgkmcnt(13)
  v_perm_b32 v242, v64, v44, s32
  v_perm_b32 v243, v64, v44, s33
  v_dot2_f32_bf16 v220, v212, v240, 0
  v_dot2_f32_bf16 v221, v212, v241, 0
  v_perm_b32 v236, v65, v45, s32
  v_perm_b32 v237, v65, v45, s33
  v_dot2_f32_bf16 v222, v212, v242, 0
  v_dot2_f32_bf16 v223, v212, v243, 0
  v_perm_b32 v238, v66, v46, s32
  v_perm_b32 v239, v66, v46, s33
  v_dot2_f32_bf16 v224, v212, v236, 0
  v_dot2_f32_bf16 v225, v212, v237, 0
  v_perm_b32 v240, v67, v47, s32
  v_perm_b32 v241, v67, v47, s33
  v_dot2_f32_bf16 v226, v212, v238, 0
  v_dot2_f32_bf16 v227, v212, v239, 0
  s_waitcnt lgkmcnt(12)
  v_perm_b32 v242, v68, v48, s32
  v_perm_b32 v243, v68, v48, s33
  v_dot2_f32_bf16 v228, v212, v240, 0
  v_dot2_f32_bf16 v229, v212, v241, 0
  v_perm_b32 v236, v69, v49, s32
  v_perm_b32 v237, v69, v49, s33
  v_dot2_f32_bf16 v230, v212, v242, 0
  v_dot2_f32_bf16 v231, v212, v243, 0
  v_perm_b32 v238, v101, v81, s32
  v_perm_b32 v239, v101, v81, s33
  v_dot2_f32_bf16 v232, v212, v236, 0
  v_dot2_f32_bf16 v233, v212, v237, 0
  v_rcp_f32 v246, v246
  v_perm_b32 v240, v102, v82, s32
  v_perm_b32 v241, v102, v82, s33
  v_dot2_f32_bf16 v216, v213, v238, v216
  v_dot2_f32_bf16 v217, v213, v239, v217
  v_perm_b32 v242, v103, v83, s32
  v_perm_b32 v243, v103, v83, s33
  v_dot2_f32_bf16 v218, v213, v240, v218
  v_dot2_f32_bf16 v219, v213, v241, v219
  s_waitcnt lgkmcnt(9)
  v_perm_b32 v236, v104, v84, s32
  v_perm_b32 v237, v104, v84, s33
  v_dot2_f32_bf16 v220, v213, v242, v220
  v_dot2_f32_bf16 v221, v213, v243, v221
  v_perm_b32 v238, v105, v85, s32
  v_perm_b32 v239, v105, v85, s33
  v_dot2_f32_bf16 v222, v213, v236, v222
  v_dot2_f32_bf16 v223, v213, v237, v223
  v_perm_b32 v240, v106, v86, s32
  v_perm_b32 v241, v106, v86, s33
  v_dot2_f32_bf16 v224, v213, v238, v224
  v_dot2_f32_bf16 v225, v213, v239, v225
  v_perm_b32 v242, v107, v87, s32
  v_perm_b32 v243, v107, v87, s33
  v_dot2_f32_bf16 v226, v213, v240, v226
  v_dot2_f32_bf16 v227, v213, v241, v227
  s_waitcnt lgkmcnt(8)
  v_perm_b32 v236, v108, v88, s32
  v_perm_b32 v237, v108, v88, s33
  v_dot2_f32_bf16 v228, v213, v242, v228
  v_dot2_f32_bf16 v229, v213, v243, v229
  v_perm_b32 v238, v109, v89, s32
  v_perm_b32 v239, v109, v89, s33
  v_dot2_f32_bf16 v230, v213, v236, v230
  v_dot2_f32_bf16 v231, v213, v237, v231
  v_perm_b32 v240, v141, v121, s32
  v_perm_b32 v241, v141, v121, s33
  v_dot2_f32_bf16 v232, v213, v238, v232
  v_dot2_f32_bf16 v233, v213, v239, v233
  v_perm_b32 v242, v142, v122, s32
  v_perm_b32 v243, v142, v122, s33
  v_dot2_f32_bf16 v216, v214, v240, v216
  v_dot2_f32_bf16 v217, v214, v241, v217
  v_perm_b32 v236, v143, v123, s32
  v_perm_b32 v237, v143, v123, s33
  v_dot2_f32_bf16 v218, v214, v242, v218
  v_dot2_f32_bf16 v219, v214, v243, v219
  s_waitcnt lgkmcnt(5)
  v_perm_b32 v238, v144, v124, s32
  v_perm_b32 v239, v144, v124, s33
  v_dot2_f32_bf16 v220, v214, v236, v220
  v_dot2_f32_bf16 v221, v214, v237, v221
  v_perm_b32 v240, v145, v125, s32
  v_perm_b32 v241, v145, v125, s33
  v_dot2_f32_bf16 v222, v214, v238, v222
  v_dot2_f32_bf16 v223, v214, v239, v223
  v_perm_b32 v242, v146, v126, s32
  v_perm_b32 v243, v146, v126, s33
  v_dot2_f32_bf16 v224, v214, v240, v224
  v_dot2_f32_bf16 v225, v214, v241, v225
  v_perm_b32 v236, v147, v127, s32
  v_perm_b32 v237, v147, v127, s33
  v_dot2_f32_bf16 v226, v214, v242, v226
  v_dot2_f32_bf16 v227, v214, v243, v227
  s_waitcnt lgkmcnt(4)
  v_perm_b32 v238, v148, v128, s32
  v_perm_b32 v239, v148, v128, s33
  v_dot2_f32_bf16 v228, v214, v236, v228
  v_dot2_f32_bf16 v229, v214, v237, v229
  v_perm_b32 v240, v149, v129, s32
  v_perm_b32 v241, v149, v129, s33
  v_dot2_f32_bf16 v230, v214, v238, v230
  v_dot2_f32_bf16 v231, v214, v239, v231
  v_perm_b32 v242, v181, v161, s32
  v_perm_b32 v243, v181, v161, s33
  v_dot2_f32_bf16 v232, v214, v240, v232
  v_dot2_f32_bf16 v233, v214, v241, v233
  v_perm_b32 v236, v182, v162, s32
  v_perm_b32 v237, v182, v162, s33
  v_dot2_f32_bf16 v216, v215, v242, v216
  v_dot2_f32_bf16 v217, v215, v243, v217
  v_perm_b32 v238, v183, v163, s32
  v_perm_b32 v239, v183, v163, s33
  v_dot2_f32_bf16 v218, v215, v236, v218
  v_dot2_f32_bf16 v219, v215, v237, v219
  s_waitcnt lgkmcnt(1)
  v_perm_b32 v240, v184, v164, s32
  v_perm_b32 v241, v184, v164, s33
  v_dot2_f32_bf16 v220, v215, v238, v220
  v_dot2_f32_bf16 v221, v215, v239, v221
  v_perm_b32 v242, v185, v165, s32
  v_perm_b32 v243, v185, v165, s33
  v_dot2_f32_bf16 v222, v215, v240, v222
  v_dot2_f32_bf16 v223, v215, v241, v223
  v_perm_b32 v236, v186, v166, s32
  v_perm_b32 v237, v186, v166, s33
  v_dot2_f32_bf16 v224, v215, v242, v224
  v_dot2_f32_bf16 v225, v215, v243, v225
  v_perm_b32 v238, v187, v167, s32
  v_perm_b32 v239, v187, v167, s33
  v_dot2_f32_bf16 v226, v215, v236, v226
  v_dot2_f32_bf16 v227, v215, v237, v227
  s_waitcnt lgkmcnt(0)
  v_perm_b32 v240, v188, v168, s32
  v_perm_b32 v241, v188, v168, s33
  v_dot2_f32_bf16 v228, v215, v238, v228
  v_dot2_f32_bf16 v229, v215, v239, v229
  v_perm_b32 v242, v189, v169, s32
  v_perm_b32 v243, v189, v169, s33
  v_dot2_f32_bf16 v230, v215, v240, v230
  v_dot2_f32_bf16 v231, v215, v241, v231
  v_dot2_f32_bf16 v232, v215, v242, v232
  v_dot2_f32_bf16 v233, v215, v243, v233
  v_mul_f32 v216, v216, v246
  v_mul_f32 v217, v217, v246
  v_mul_f32 v218, v218, v246
  v_mul_f32 v219, v219, v246
  v_mul_f32 v220, v220, v246
  v_mul_f32 v221, v221, v246
  v_mul_f32 v222, v222, v246
  v_mul_f32 v223, v223, v246
  v_mul_f32 v224, v224, v246
  v_mul_f32 v225, v225, v246
  v_mul_f32 v226, v226, v246
  v_mul_f32 v227, v227, v246
  v_mul_f32 v228, v228, v246
  v_mul_f32 v229, v229, v246
  v_mul_f32 v230, v230, v246
  v_mul_f32 v231, v231, v246
  v_mul_f32 v232, v232, v246
  v_mul_f32 v233, v233, v246
  v_cvt_pk_bf16_f32 v192, v216, v217
  v_cvt_pk_bf16_f32 v193, v218, v219
  v_cvt_pk_bf16_f32 v194, v220, v221
  v_cvt_pk_bf16_f32 v195, v222, v223
  v_cvt_pk_bf16_f32 v196, v224, v225
  v_cvt_pk_bf16_f32 v197, v226, v227
  v_cvt_pk_bf16_f32 v198, v228, v229
  v_cvt_pk_bf16_f32 v199, v230, v231
  v_cvt_pk_bf16_f32 v200, v232, v233
  buffer_store_dwordx4 v[192:195], v16, s[12:15], 0 offen sc1
  buffer_store_dwordx4 v[196:199], v16, s[12:15], 0 offen offset:256 sc1
  buffer_store_dword v200, v17, s[12:15], 0 offen sc1
  s_waitcnt vmcnt(0)
  s_barrier
  s_mov_b32 s36, 2048
  v_mov_b32 v26, 1
  buffer_store_dword v26, v29, s[96:99], s36 offen sc1
  buffer_load_dwordx4 a[32:35], v248, s[60:63], s50 offen
  buffer_load_dwordx4 a[104:107], v248, s[60:63], s55 offen
  buffer_load_dwordx4 a[36:39], v248, s[60:63], s50 offen offset:1024
  buffer_load_dwordx4 a[108:111], v248, s[60:63], s55 offen offset:1024
  buffer_load_dwordx4 a[40:43], v248, s[60:63], s50 offen offset:2048
  buffer_load_dwordx4 a[112:115], v248, s[60:63], s55 offen offset:2048
  buffer_load_dwordx4 a[44:47], v248, s[60:63], s50 offen offset:3072
  buffer_load_dwordx4 a[116:119], v248, s[60:63], s55 offen offset:3072
  buffer_load_dwordx4 a[48:51], v248, s[60:63], s51 offen
  buffer_load_dwordx4 a[120:123], v248, s[60:63], s56 offen
  buffer_load_dwordx4 a[52:55], v248, s[60:63], s51 offen offset:1024
  buffer_load_dwordx4 a[124:127], v248, s[60:63], s56 offen offset:1024
  buffer_load_dwordx4 a[56:59], v248, s[60:63], s51 offen offset:2048
  buffer_load_dwordx4 a[128:131], v248, s[60:63], s56 offen offset:2048
  buffer_load_dwordx4 a[60:63], v248, s[60:63], s51 offen offset:3072
  buffer_load_dwordx4 a[132:135], v248, s[60:63], s56 offen offset:3072
  buffer_load_dwordx4 a[64:67], v248, s[60:63], s52 offen
  buffer_load_dwordx4 a[136:139], v248, s[60:63], s57 offen
  buffer_load_dwordx4 a[68:71], v248, s[60:63], s52 offen offset:1024
  buffer_load_dwordx4 a[140:143], v248, s[60:63], s57 offen offset:1024
  v_and_b32 v170, 63, v0
  v_and_b32 v171, 15, v170
  v_lshlrev_b32 v160, 4, v170
  v_mov_b32 v175, 0x7ffffff0
  s_lshl_b32 s35, s93, 2
  s_lshr_b32 s36, s94, 2
  s_add_u32 s35, s35, s36
  s_and_b32 s40, s94, 3
  s_mul_i32 s3, s92, 9216
  s_and_b32 s34, s92, 1
  s_mul_i32 s39, s35, 36864
  s_add_u32 s36, s39, s3
  v_add_u32 v162, s36, v160
  s_mul_i32 s36, s40, 9
  s_and_b32 s37, s40, 1
  s_add_u32 s32, s36, s37
  s_xor_b32 s37, s37, 1
  s_lshl_b32 s37, s37, 3
  s_add_u32 s33, s36, s37
  s_lshl_b32 s36, s92, 1
  s_add_u32 s32, s32, s36
  s_cmp_lt_u32 s92, 2
  s_cselect_b32 s38, 0, 0x7ffffff0
  s_lshl_b32 s36, s32, 9
  s_add_u32 s36, s36, s39
  v_add_u32 v163, s36, v160
  s_lshr_b32 s36, s33, 1
  s_lshl_b32 s36, s36, 10
  s_and_b32 s37, s33, 1
  s_lshl_b32 s37, s37, 3
  s_add_u32 s36, s36, s37
  s_mul_i32 s37, s34, 18432
  v_add_u32 v161, s37, v160
  s_add_u32 s36, s36, s39
  v_add_u32 v164, s36, v161
  v_or_b32 v164, s38, v164
  s_add_u32 s64, s90, 4718592
  s_addc_u32 s65, s91, 0
  s_and_b32 s65, s65, 0xffff
  s_mov_b32 s66, 2359296
  s_mov_b32 s67, 0x20000
  s_add_u32 s68, s90, 0
  s_addc_u32 s69, s91, 0
  s_and_b32 s69, s69, 0xffff
  s_mov_b32 s70, 2359296
  s_mov_b32 s71, 0x20000
  s_add_u32 s72, s90, 2359296
  s_addc_u32 s73, s91, 0
  s_and_b32 s73, s73, 0xffff
  s_mov_b32 s74, 2359296
  s_mov_b32 s75, 0x20000
  s_add_u32 s76, s90, 7102464
  s_addc_u32 s77, s91, 0
  s_and_b32 s77, s77, 0xffff
  s_mov_b32 s78, 131072
  s_mov_b32 s79, 0x20000
  s_add_u32 s44, s90, 7094272
  s_addc_u32 s45, s91, 0
  s_and_b32 s45, s45, 0xffff
  s_mov_b32 s46, 8192
  s_mov_b32 s47, 0x20000
  v_lshlrev_b32 v173, 2, v171
  v_add_u32 v166, 36864, v173
  s_lshl_b32 s36, s34, 6
  v_add_u32 v167, s36, v166
  v_lshlrev_b32 v174, 2, v0
  v_add_u32 v174, 36992, v174
  v_and_b32 v173, 176, v0
  v_cmp_eq_u32 vcc, 128, v173
  s_nop 1
  v_cndmask_b32 v165, v174, v167, vcc
  s_lshl_b32 s36, s35, 7
  s_sub_u32 s36, s36, 36864
  v_add_u32 v174, s36, v167
  v_cndmask_b32 v168, v175, v174, vcc
  s_cmp_eq_u32 s40, 0
  s_cselect_b32 s37, 0, 0x7ffffff0
  v_or_b32 v168, s37, v168
  v_lshrrev_b32 v173, 5, v170
  v_lshl_add_u32 v173, v173, 4, v171
  v_lshlrev_b32 v173, 6, v173
  s_lshl_b32 s36, s35, 11
  s_lshl_b32 s37, s40, 4
  s_add_u32 s36, s36, s37
  s_lshl_b32 s37, s92, 2
  s_add_u32 s36, s36, s37
  v_add_u32 v169, s36, v173
  s_cmp_eq_u32 s92, 0
  s_cselect_b32 s58, 1.0, 0
  s_cmp_eq_u32 s92, 1
  s_cselect_b32 s59, 1.0, 0
  buffer_load_dwordx4 v[84:87], v163, s[68:71], 0 offen sc1
  buffer_load_dwordx4 v[88:91], v163, s[68:71], s53 offen sc1
  buffer_load_dwordx2 v[92:93], v164, s[68:71], 0 offen sc1
  v_and_b32 v1, 63, v0
  v_and_b32 v2, 15, v1
  v_lshrrev_b32 v3, 4, v1
  v_lshlrev_b32 v24, 4, v1
  s_lshl_b32 s33, s92, 10
  s_and_b32 s41, s92, 1
  s_lshr_b32 s42, s92, 1
  s_and_b32 s43, s94, 1
  v_lshrrev_b32 v4, 2, v2
  v_lshl_add_u32 v4, v3, 2, v4
  v_and_b32 v5, 3, v2
  v_lshlrev_b32 v5, 3, v5
  v_lshrrev_b32 v6, 1, v4
  v_and_b32 v6, 3, v6
  s_lshl_b32 s36, s41, 1
  s_add_u32 s37, s36, 0
  v_xor_b32 v8, s37, v6
  v_lshlrev_b32 v8, 5, v8
  v_lshl_add_u32 v8, v4, 7, v8
  v_add_u32 v8, v8, v5
  v_add_u32 v9, 65536, v8
  v_add_u32 v10, 131072, v8
  s_add_u32 s37, s36, 1
  v_xor_b32 v11, s37, v6
  v_lshlrev_b32 v11, 5, v11
  v_lshl_add_u32 v11, v4, 7, v11
  v_add_u32 v11, v11, v5
  v_add_u32 v12, 65536, v11
  v_add_u32 v13, 131072, v11
  v_and_b32 v6, 1, v3
  v_xor_b32 v6, s41, v6
  v_lshlrev_b32 v6, 5, v6
  v_lshl_add_u32 v14, v4, 6, v6
  v_add_u32 v14, v14, v5
  v_add_u32 v15, 65536, v14
  v_add_u32 v25, 131072, v14
  s_lshl_b32 s36, s42, 11
  v_add_u32 v26, s36, v24
  v_add_u32 v27, 65536, v26
  v_add_u32 v28, 131072, v26
  s_mul_i32 s36, s42, 36864
  s_add_u32 s36, s36, 90112
  v_add_u32 v16, s36, v24
  s_lshl_b32 s37, s41, 12
  v_add_u32 v17, s37, v16
  s_lshl_b32 s37, s41, 3
  v_add_u32 v18, s37, v16
  v_bfe_u32 v4, v1, 1, 2
  v_xor_b32 v4, v4, v3
  v_lshlrev_b32 v4, 5, v4
  v_and_b32 v5, 1, v1
  v_lshl_add_u32 v4, v5, 4, v4
  v_lshrrev_b32 v5, 3, v1
  s_lshl_b32 s36, s92, 3
  v_add_u32 v5, s36, v5
  s_mul_i32 s36, s94, 576
  s_lshl_b32 s37, s43, 6
  s_add_u32 s37, s36, s37
  v_mul_u32_u24 v6, 9216, v5
  v_add3_u32 v19, v6, v4, s37
  v_mul_u32_u24 v6, 1152, v5
  v_add_u32 v6, v6, v4
  s_mul_i32 s37, s94, 331776
  s_mul_i32 s38, s43, 36864
  s_add_u32 s38, s38, s37
  v_add_u32 v21, s38, v6
  s_xor_b32 s38, s43, 1
  s_mul_i32 s38, s38, 294912
  s_add_u32 s38, s38, s37
  v_add_u32 v22, s38, v6
  v_bfe_u32 v4, v1, 1, 1
  v_and_b32 v5, 1, v3
  v_xor_b32 v4, v4, v5
  v_lshlrev_b32 v4, 5, v4
  v_and_b32 v5, 1, v1
  v_lshl_add_u32 v4, v5, 4, v4
  v_lshrrev_b32 v5, 2, v1
  s_lshl_b32 s37, s41, 4
  v_add_u32 v5, s37, v5
  v_mul_u32_u24 v5, 9216, v5
  s_xor_b32 s38, s43, 1
  s_lshl_b32 s38, s38, 9
  s_add_u32 s38, s38, s36
  v_add3_u32 v20, v5, v4, s38
  s_lshl_b32 s37, s93, 1
  s_add_u32 s37, s37, s42
  s_lshl_b32 s37, s37, 2
  s_add_u32 s37, s37, s41
  s_mul_i32 s37, s37, 18432
  v_add_u32 v23, s37, v24
  s_mov_b32 s4, s80
  s_and_b32 s5, s81, 0xffff
  s_mov_b32 s6, 5308416
  s_mov_b32 s7, 0x20000
  s_mov_b32 s8, s82
  s_and_b32 s9, s83, 0xffff
  s_mov_b32 s10, 5308416
  s_mov_b32 s11, 0x20000
  s_mov_b32 s12, s84
  s_and_b32 s13, s85, 0xffff
  s_mov_b32 s14, 5308416
  s_mov_b32 s15, 0x20000
  s_cmp_eq_u32 s42, 0
  s_cselect_b32 s24, s80, s82
  s_cselect_b32 s25, s5, s9
  s_mov_b32 s26, 5308416
  s_mov_b32 s27, 0x20000
  s_add_u32 s16, s90, 2359296
  s_addc_u32 s17, s91, 0
  s_and_b32 s17, s17, 0xffff
  s_mov_b32 s18, 2359296
  s_mov_b32 s19, 0x20000
  s_mul_i32 s36, s94, 2359296
  s_lshl_b32 s37, s93, 1
  s_add_u32 s37, s37, s42
  s_mul_i32 s37, s37, 73728
  s_add_u32 s36, s36, s37
  s_lshl_b32 s37, s41, 10
  s_add_u32 s36, s36, s37
  s_add_u32 s36, s36, 7266304
  s_add_u32 s20, s90, s36
  s_addc_u32 s21, s91, 0
  s_and_b32 s21, s21, 0xffff
  s_mov_b32 s22, 72704
  s_mov_b32 s23, 0x20000
  s_mov_b32 s36, 2048
  buffer_load_dword v31, v30, s[96:99], s36 offen sc1
  s_waitcnt vmcnt(0)
  v_cmp_eq_u32 vcc, 0, v31
  s_cbranch_vccnz L_sp_5
L_bk_6:
  s_add_u32 m0, s3, 0
  s_nop 0
  buffer_load_dwordx4 v162, s[64:67], s48 offen sc1 lds
  buffer_load_dwordx4 v162, s[64:67], s48 offen offset:1024 sc1 lds
  buffer_load_dwordx4 v162, s[64:67], s48 offen offset:2048 sc1 lds
  buffer_load_dwordx4 v162, s[64:67], s48 offen offset:3072 sc1 lds
  s_add_u32 m0, s3, 4096
  s_nop 0
  buffer_load_dwordx4 v162, s[64:67], s49 offen sc1 lds
  buffer_load_dwordx4 v162, s[64:67], s49 offen offset:1024 sc1 lds
  buffer_load_dwordx4 v162, s[64:67], s49 offen offset:2048 sc1 lds
  buffer_load_dwordx4 v162, s[64:67], s49 offen offset:3072 sc1 lds
  s_add_u32 m0, s3, 8192
  s_nop 0
  buffer_load_dwordx4 v162, s[64:67], s50 offen sc1 lds
  s_waitcnt vmcnt(0)
  s_barrier
  ds_read_b128 v[32:35], v160
  ds_read_b128 v[36:39], v160 offset:18432
  ds_read_b128 v[40:43], v161
  s_waitcnt lgkmcnt(0)
  v_mfma_f32_16x16x32_bf16 v[80:83], a[144:147], v[40:43], 0
  ds_read_b128 v[44:47], v160 offset:1024
  v_mfma_f32_16x16x32_bf16 v[64:67], a[0:3], v[32:35], 0
  ds_read_b128 v[48:51], v160 offset:19456
  v_mfma_f32_16x16x32_bf16 v[68:71], a[0:3], v[36:39], 0
  ds_read_b128 v[52:55], v161 offset:1024
  s_add_u32 m0, s33, 40960
  v_mfma_f32_16x16x32_bf16 v[72:75], a[72:75], v[32:35], 0
  s_mov_b32 s34, 0
  v_mfma_f32_16x16x32_bf16 v[76:79], a[72:75], v[36:39], 0
  buffer_load_dwordx4 v19, s[4:7], s34 offen lds
  s_waitcnt lgkmcnt(0)
  v_mfma_f32_16x16x32_bf16 v[80:83], a[148:151], v[52:55], v[80:83]
  ds_read_b128 v[32:35], v160 offset:2048
  v_mfma_f32_16x16x32_bf16 v[64:67], a[4:7], v[44:47], v[64:67]
  ds_read_b128 v[36:39], v160 offset:20480
  v_mfma_f32_16x16x32_bf16 v[68:71], a[4:7], v[48:51], v[68:71]
  ds_read_b128 v[40:43], v161 offset:2048
  s_add_u32 m0, s33, 45056
  v_mfma_f32_16x16x32_bf16 v[72:75], a[76:79], v[44:47], v[72:75]
  s_mov_b32 s34, 294912
  v_mfma_f32_16x16x32_bf16 v[76:79], a[76:79], v[48:51], v[76:79]
  buffer_load_dwordx4 v19, s[4:7], s34 offen lds
  s_waitcnt lgkmcnt(0)
  v_mfma_f32_16x16x32_bf16 v[80:83], a[152:155], v[40:43], v[80:83]
  ds_read_b128 v[44:47], v160 offset:3072
  v_mfma_f32_16x16x32_bf16 v[64:67], a[8:11], v[32:35], v[64:67]
  ds_read_b128 v[48:51], v160 offset:21504
  v_mfma_f32_16x16x32_bf16 v[68:71], a[8:11], v[36:39], v[68:71]
  ds_read_b128 v[52:55], v161 offset:3072
  s_add_u32 m0, s33, 49152
  v_mfma_f32_16x16x32_bf16 v[72:75], a[80:83], v[32:35], v[72:75]
  s_mov_b32 s34, 589824
  v_mfma_f32_16x16x32_bf16 v[76:79], a[80:83], v[36:39], v[76:79]
  buffer_load_dwordx4 v19, s[4:7], s34 offen lds
  s_waitcnt lgkmcnt(0)
  v_mfma_f32_16x16x32_bf16 v[80:83], a[156:159], v[52:55], v[80:83]
  ds_read_b128 v[32:35], v160 offset:4096
  v_mfma_f32_16x16x32_bf16 v[64:67], a[12:15], v[44:47], v[64:67]
  ds_read_b128 v[36:39], v160 offset:22528
  v_mfma_f32_16x16x32_bf16 v[68:71], a[12:15], v[48:51], v[68:71]
  ds_read_b128 v[40:43], v161 offset:4096
  s_add_u32 m0, s33, 53248
  v_mfma_f32_16x16x32_bf16 v[72:75], a[84:87], v[44:47], v[72:75]
  s_mov_b32 s34, 0
  v_mfma_f32_16x16x32_bf16 v[76:79], a[84:87], v[48:51], v[76:79]
  buffer_load_dwordx4 v19, s[8:11], s34 offen lds
  s_waitcnt lgkmcnt(0)
  v_mfma_f32_16x16x32_bf16 v[80:83], a[160:163], v[40:43], v[80:83]
  ds_read_b128 v[44:47], v160 offset:5120
  v_mfma_f32_16x16x32_bf16 v[64:67], a[16:19], v[32:35], v[64:67]
  ds_read_b128 v[48:51], v160 offset:23552
  v_mfma_f32_16x16x32_bf16 v[68:71], a[16:19], v[36:39], v[68:71]
  ds_read_b128 v[52:55], v161 offset:5120
  s_add_u32 m0, s33, 57344
  v_mfma_f32_16x16x32_bf16 v[72:75], a[88:91], v[32:35], v[72:75]
  s_mov_b32 s34, 294912
  v_mfma_f32_16x16x32_bf16 v[76:79], a[88:91], v[36:39], v[76:79]
  buffer_load_dwordx4 v19, s[8:11], s34 offen lds
  s_waitcnt lgkmcnt(0)
  v_mfma_f32_16x16x32_bf16 v[80:83], a[164:167], v[52:55], v[80:83]
  ds_read_b128 v[32:35], v160 offset:6144
  v_mfma_f32_16x16x32_bf16 v[64:67], a[20:23], v[44:47], v[64:67]
  ds_read_b128 v[36:39], v160 offset:24576
  v_mfma_f32_16x16x32_bf16 v[68:71], a[20:23], v[48:51], v[68:71]
  ds_read_b128 v[40:43], v161 offset:6144
  s_add_u32 m0, s33, 61440
  v_mfma_f32_16x16x32_bf16 v[72:75], a[92:95], v[44:47], v[72:75]
  s_mov_b32 s34, 589824
  v_mfma_f32_16x16x32_bf16 v[76:79], a[92:95], v[48:51], v[76:79]
  buffer_load_dwordx4 v19, s[8:11], s34 offen lds
  s_waitcnt lgkmcnt(0)
  v_mfma_f32_16x16x32_bf16 v[80:83], a[168:171], v[40:43], v[80:83]
  ds_read_b128 v[44:47], v160 offset:7168
  v_mfma_f32_16x16x32_bf16 v[64:67], a[24:27], v[32:35], v[64:67]
  ds_read_b128 v[48:51], v160 offset:25600
  v_mfma_f32_16x16x32_bf16 v[68:71], a[24:27], v[36:39], v[68:71]
  ds_read_b128 v[52:55], v161 offset:7168
  s_add_u32 m0, s33, 65536
  v_mfma_f32_16x16x32_bf16 v[72:75], a[96:99], v[32:35], v[72:75]
  s_mov_b32 s34, 884736
  v_mfma_f32_16x16x32_bf16 v[76:79], a[96:99], v[36:39], v[76:79]
  buffer_load_dwordx4 v19, s[4:7], s34 offen lds
  s_waitcnt lgkmcnt(0)
  v_mfma_f32_16x16x32_bf16 v[80:83], a[172:175], v[52:55], v[80:83]
  ds_read_b128 v[32:35], v160 offset:8192
  v_mfma_f32_16x16x32_bf16 v[64:67], a[28:31], v[44:47], v[64:67]
  ds_read_b128 v[36:39], v160 offset:26624
  v_mfma_f32_16x16x32_bf16 v[68:71], a[28:31], v[48:51], v[68:71]
  ds_read_b128 v[40:43], v161 offset:8192
  s_add_u32 m0, s33, 69632
  v_mfma_f32_16x16x32_bf16 v[72:75], a[100:103], v[44:47], v[72:75]
  s_mov_b32 s34, 1179648
  v_mfma_f32_16x16x32_bf16 v[76:79], a[100:103], v[48:51], v[76:79]
  buffer_load_dwordx4 v19, s[4:7], s34 offen lds
  s_waitcnt lgkmcnt(0)
  v_mfma_f32_16x16x32_bf16 v[80:83], a[176:179], v[40:43], v[80:83]
  ds_read_b128 v[44:47], v160 offset:9216
  v_mfma_f32_16x16x32_bf16 v[64:67], a[32:35], v[32:35], v[64:67]
  ds_read_b128 v[48:51], v160 offset:27648
  v_mfma_f32_16x16x32_bf16 v[68:71], a[32:35], v[36:39], v[68:71]
  ds_read_b128 v[52:55], v161 offset:9216
  s_add_u32 m0, s33, 73728
  v_mfma_f32_16x16x32_bf16 v[72:75], a[104:107], v[32:35], v[72:75]
  s_mov_b32 s34, 1474560
  v_mfma_f32_16x16x32_bf16 v[76:79], a[104:107], v[36:39], v[76:79]
  buffer_load_dwordx4 v19, s[4:7], s34 offen lds
  s_waitcnt lgkmcnt(0)
  v_mfma_f32_16x16x32_bf16 v[80:83], a[180:183], v[52:55], v[80:83]
  ds_read_b128 v[32:35], v160 offset:10240
  v_mfma_f32_16x16x32_bf16 v[64:67], a[36:39], v[44:47], v[64:67]
  ds_read_b128 v[36:39], v160 offset:28672
  v_mfma_f32_16x16x32_bf16 v[68:71], a[36:39], v[48:51], v[68:71]
  ds_read_b128 v[40:43], v161 offset:10240
  s_add_u32 m0, s33, 77824
  v_mfma_f32_16x16x32_bf16 v[72:75], a[108:111], v[44:47], v[72:75]
  s_mov_b32 s34, 884736
  v_mfma_f32_16x16x32_bf16 v[76:79], a[108:111], v[48:51], v[76:79]
  buffer_load_dwordx4 v19, s[8:11], s34 offen lds
  s_waitcnt lgkmcnt(0)
  v_mfma_f32_16x16x32_bf16 v[80:83], a[184:187], v[40:43], v[80:83]
  ds_read_b128 v[44:47], v160 offset:11264
  v_mfma_f32_16x16x32_bf16 v[64:67], a[40:43], v[32:35], v[64:67]
  ds_read_b128 v[48:51], v160 offset:29696
  v_mfma_f32_16x16x32_bf16 v[68:71], a[40:43], v[36:39], v[68:71]
  ds_read_b128 v[52:55], v161 offset:11264
  s_add_u32 m0, s33, 81920
  v_mfma_f32_16x16x32_bf16 v[72:75], a[112:115], v[32:35], v[72:75]
  s_mov_b32 s34, 1179648
  v_mfma_f32_16x16x32_bf16 v[76:79], a[112:115], v[36:39], v[76:79]
  buffer_load_dwordx4 v19, s[8:11], s34 offen lds
  s_waitcnt lgkmcnt(0)
  v_mfma_f32_16x16x32_bf16 v[80:83], a[188:191], v[52:55], v[80:83]
  ds_read_b128 v[32:35], v160 offset:12288
  v_mfma_f32_16x16x32_bf16 v[64:67], a[44:47], v[44:47], v[64:67]
  ds_read_b128 v[36:39], v160 offset:30720
  v_mfma_f32_16x16x32_bf16 v[68:71], a[44:47], v[48:51], v[68:71]
  ds_read_b128 v[40:43], v161 offset:12288
  s_add_u32 m0, s33, 86016
  v_mfma_f32_16x16x32_bf16 v[72:75], a[116:119], v[44:47], v[72:75]
  s_mov_b32 s34, 1474560
  v_mfma_f32_16x16x32_bf16 v[76:79], a[116:119], v[48:51], v[76:79]
  buffer_load_dwordx4 v19, s[8:11], s34 offen lds
  s_waitcnt lgkmcnt(0)
  v_mfma_f32_16x16x32_bf16 v[80:83], a[192:195], v[40:43], v[80:83]
  ds_read_b128 v[44:47], v160 offset:13312
  v_mfma_f32_16x16x32_bf16 v[64:67], a[48:51], v[32:35], v[64:67]
  ds_read_b128 v[48:51], v160 offset:31744
  v_mfma_f32_16x16x32_bf16 v[68:71], a[48:51], v[36:39], v[68:71]
  ds_read_b128 v[52:55], v161 offset:13312
  v_mfma_f32_16x16x32_bf16 v[72:75], a[120:123], v[32:35], v[72:75]
  v_mfma_f32_16x16x32_bf16 v[76:79], a[120:123], v[36:39], v[76:79]
  s_waitcnt lgkmcnt(0)
  v_mfma_f32_16x16x32_bf16 v[80:83], a[196:199], v[52:55], v[80:83]
  ds_read_b128 v[32:35], v160 offset:14336
  v_mfma_f32_16x16x32_bf16 v[64:67], a[52:55], v[44:47], v[64:67]
  ds_read_b128 v[36:39], v160 offset:32768
  v_mfma_f32_16x16x32_bf16 v[68:71], a[52:55], v[48:51], v[68:71]
  ds_read_b128 v[40:43], v161 offset:14336
  v_mfma_f32_16x16x32_bf16 v[72:75], a[124:127], v[44:47], v[72:75]
  v_mfma_f32_16x16x32_bf16 v[76:79], a[124:127], v[48:51], v[76:79]
  s_waitcnt lgkmcnt(0)
  v_mfma_f32_16x16x32_bf16 v[80:83], a[200:203], v[40:43], v[80:83]
  ds_read_b128 v[44:47], v160 offset:15360
  v_mfma_f32_16x16x32_bf16 v[64:67], a[56:59], v[32:35], v[64:67]
  ds_read_b128 v[48:51], v160 offset:33792
  v_mfma_f32_16x16x32_bf16 v[68:71], a[56:59], v[36:39], v[68:71]
  ds_read_b128 v[52:55], v161 offset:15360
  v_mfma_f32_16x16x32_bf16 v[72:75], a[128:131], v[32:35], v[72:75]
  v_mfma_f32_16x16x32_bf16 v[76:79], a[128:131], v[36:39], v[76:79]
  s_waitcnt lgkmcnt(0)
  v_mfma_f32_16x16x32_bf16 v[80:83], a[204:207], v[52:55], v[80:83]
  ds_read_b128 v[32:35], v160 offset:16384
  v_mfma_f32_16x16x32_bf16 v[64:67], a[60:63], v[44:47], v[64:67]
  ds_read_b128 v[36:39], v160 offset:34816
  v_mfma_f32_16x16x32_bf16 v[68:71], a[60:63], v[48:51], v[68:71]
  ds_read_b128 v[40:43], v161 offset:16384
  v_mfma_f32_16x16x32_bf16 v[72:75], a[132:135], v[44:47], v[72:75]
  v_mfma_f32_16x16x32_bf16 v[76:79], a[132:135], v[48:51], v[76:79]
  s_waitcnt lgkmcnt(0)
  v_mfma_f32_16x16x32_bf16 v[80:83], a[208:211], v[40:43], v[80:83]
  ds_read_b128 v[44:47], v160 offset:17408
  v_mfma_f32_16x16x32_bf16 v[64:67], a[64:67], v[32:35], v[64:67]
  ds_read_b128 v[48:51], v160 offset:35840
  v_mfma_f32_16x16x32_bf16 v[68:71], a[64:67], v[36:39], v[68:71]
  ds_read_b128 v[52:55], v161 offset:17408
  v_mfma_f32_16x16x32_bf16 v[72:75], a[136:139], v[32:35], v[72:75]
  v_mfma_f32_16x16x32_bf16 v[76:79], a[136:139], v[36:39], v[76:79]
  s_waitcnt lgkmcnt(0)
  v_mfma_f32_16x16x32_bf16 v[80:83], a[212:215], v[52:55], v[80:83]
  v_mfma_f32_16x16x32_bf16 v[64:67], a[68:71], v[44:47], v[64:67]
  v_mfma_f32_16x16x32_bf16 v[68:71], a[68:71], v[48:51], v[68:71]
  v_mfma_f32_16x16x32_bf16 v[72:75], a[140:143], v[44:47], v[72:75]
  v_mfma_f32_16x16x32_bf16 v[76:79], a[140:143], v[48:51], v[76:79]
  s_nop 3
  v_add_f32 v176, v80, v81
  ds_write_b32 v165, v176
  buffer_store_dword v176, v168, s[44:47], 0 offen sc1
  s_waitcnt lgkmcnt(0)
  s_barrier
  ds_read_b32 v177, v166
  ds_read_b32 v178, v166 offset:64
  ds_read_b32 v179, v167
  v_lshlrev_b32 v32, 16, v84
  v_and_b32 v33, 0xffff0000, v84
  v_add_f32 v64, v64, v32
  v_add_f32 v65, v65, v33
  v_lshlrev_b32 v32, 16, v85
  v_and_b32 v33, 0xffff0000, v85
  v_add_f32 v66, v66, v32
  v_add_f32 v67, v67, v33
  v_lshlrev_b32 v32, 16, v88
  v_and_b32 v33, 0xffff0000, v88
  v_add_f32 v68, v68, v32
  v_add_f32 v69, v69, v33
  v_lshlrev_b32 v32, 16, v89
  v_and_b32 v33, 0xffff0000, v89
  v_add_f32 v70, v70, v32
  v_add_f32 v71, v71, v33
  v_lshlrev_b32 v32, 16, v86
  v_and_b32 v33, 0xffff0000, v86
  v_add_f32 v72, v72, v32
  v_add_f32 v73, v73, v33
  v_lshlrev_b32 v32, 16, v87
  v_and_b32 v33, 0xffff0000, v87
  v_add_f32 v74, v74, v32
  v_add_f32 v75, v75, v33
  v_lshlrev_b32 v32, 16, v90
  v_and_b32 v33, 0xffff0000, v90
  v_add_f32 v76, v76, v32
  v_add_f32 v77, v77, v33
  v_lshlrev_b32 v32, 16, v91
  v_and_b32 v33, 0xffff0000, v91
  v_add_f32 v78, v78, v32
  v_add_f32 v79, v79, v33
  v_lshlrev_b32 v32, 16, v92
  v_and_b32 v33, 0xffff0000, v92
  v_add_f32 v80, v80, v32
  v_add_f32 v81, v81, v33
  v_lshlrev_b32 v32, 16, v93
  v_and_b32 v33, 0xffff0000, v93
  v_add_f32 v82, v82, v32
  v_add_f32 v83, v83, v33
  s_waitcnt lgkmcnt(2)
  v_sub_f32 v64, v64, v177
  v_sub_f32 v65, v65, v177
  v_sub_f32 v66, v66, v177
  v_sub_f32 v67, v67, v177
  s_waitcnt lgkmcnt(1)
  v_sub_f32 v68, v68, v178
  v_sub_f32 v69, v69, v178
  v_sub_f32 v70, v70, v178
  v_sub_f32 v71, v71, v178
  v_sub_f32 v72, v72, v177
  v_sub_f32 v73, v73, v177
  v_sub_f32 v74, v74, v177
  v_sub_f32 v75, v75, v177
  v_sub_f32 v76, v76, v178
  v_sub_f32 v77, v77, v178
  v_sub_f32 v78, v78, v178
  v_sub_f32 v79, v79, v178
  s_waitcnt lgkmcnt(0)
  v_sub_f32 v80, v80, v179
  v_sub_f32 v81, v81, v179
  v_sub_f32 v82, v82, v179
  v_sub_f32 v83, v83, v179
  v_cvt_pk_bf16_f32 v36, v64, v65
  v_cvt_pk_bf16_f32 v37, v66, v67
  v_cvt_pk_bf16_f32 v38, v72, v73
  v_cvt_pk_bf16_f32 v39, v74, v75
  v_cvt_pk_bf16_f32 v40, v68, v69
  v_cvt_pk_bf16_f32 v41, v70, v71
  v_cvt_pk_bf16_f32 v42, v76, v77
  v_cvt_pk_bf16_f32 v43, v78, v79
  v_cvt_pk_bf16_f32 v44, v80, v81
  v_cvt_pk_bf16_f32 v45, v82, v83
  buffer_store_dwordx4 v[36:39], v163, s[72:75], 0 offen sc1
  buffer_store_dwordx4 v[40:43], v163, s[72:75], s53 offen sc1
  buffer_store_dwordx2 v[44:45], v164, s[72:75], 0 offen sc1
  v_mul_f32 v48, v64, v64
  v_mul_f32 v49, v68, v68
  v_mul_f32 v50, v80, v80
  v_fmac_f32 v48, v72, v72
  v_fmac_f32 v49, v76, v76
  v_fmac_f32 v48, v65, v65
  v_fmac_f32 v49, v69, v69
  v_fmac_f32 v50, v81, v81
  v_fmac_f32 v48, v73, v73
  v_fmac_f32 v49, v77, v77
  v_fmac_f32 v48, v66, v66
  v_fmac_f32 v49, v70, v70
  v_fmac_f32 v50, v82, v82
  v_fmac_f32 v48, v74, v74
  v_fmac_f32 v49, v78, v78
  v_fmac_f32 v48, v67, v67
  v_fmac_f32 v49, v71, v71
  v_fmac_f32 v50, v83, v83
  v_fmac_f32 v48, v75, v75
  v_fmac_f32 v49, v79, v79
  v_fmac_f32 v48, s58, v50
  v_fmac_f32 v49, s59, v50
  s_nop 1
  v_permlane32_swap_b32 v48, v49
  v_add_f32 v48, v48, v49
  v_mov_b32 v49, v48
  s_nop 1
  v_permlane16_swap_b32 v48, v49
  v_add_f32 v48, v48, v49
  buffer_store_dword v48, v169, s[76:79], 0 offen sc1
  s_waitcnt vmcnt(0)
  s_barrier
  s_mov_b32 s36, 4096
  v_mov_b32 v1, 1
  buffer_store_dword v1, v29, s[96:99], s36 offen sc1
  s_add_u32 m0, s33, 90112
  s_mov_b32 s34, 1769472
  buffer_load_dwordx4 v19, s[4:7], s34 offen lds
  s_add_u32 m0, s33, 94208
  s_mov_b32 s34, 2064384
  buffer_load_dwordx4 v19, s[4:7], s34 offen lds
  s_add_u32 m0, s33, 98304
  s_mov_b32 s34, 2359296
  buffer_load_dwordx4 v19, s[4:7], s34 offen lds
  s_add_u32 m0, s33, 102400
  s_mov_b32 s34, 1769472
  buffer_load_dwordx4 v19, s[8:11], s34 offen lds
  s_add_u32 m0, s33, 106496
  s_mov_b32 s34, 2064384
  buffer_load_dwordx4 v19, s[8:11], s34 offen lds
  s_add_u32 m0, s33, 110592
  s_mov_b32 s34, 2359296
  buffer_load_dwordx4 v19, s[8:11], s34 offen lds
  s_mov_b32 s36, 4096
  buffer_load_dword v31, v30, s[96:99], s36 offen sc1
  s_waitcnt vmcnt(0)
  v_cmp_eq_u32 vcc, 0, v31
  s_cbranch_vccnz L_sp_8
L_bk_9:
  s_add_u32 m0, s33, 114688
  s_mov_b32 s34, 0
  buffer_load_dwordx4 v23, s[16:19], s34 offen sc1 lds
  s_add_u32 m0, s33, 118784
  s_mov_b32 s34, 36864
  buffer_load_dwordx4 v23, s[16:19], s34 offen sc1 lds
  s_add_u32 m0, s33, 122880
  s_mov_b32 s34, 1024
  buffer_load_dwordx4 v23, s[16:19], s34 offen sc1 lds
  s_add_u32 m0, s33, 126976
  s_mov_b32 s34, 37888
  buffer_load_dwordx4 v23, s[16:19], s34 offen sc1 lds
  s_add_u32 m0, s33, 131072
  s_mov_b32 s34, 2048
  buffer_load_dwordx4 v23, s[16:19], s34 offen sc1 lds
  s_add_u32 m0, s33, 135168
  s_mov_b32 s34, 38912
  buffer_load_dwordx4 v23, s[16:19], s34 offen sc1 lds
  s_add_u32 m0, s33, 139264
  s_mov_b32 s34, 3072
  buffer_load_dwordx4 v23, s[16:19], s34 offen sc1 lds
  s_add_u32 m0, s33, 143360
  s_mov_b32 s34, 39936
  buffer_load_dwordx4 v23, s[16:19], s34 offen sc1 lds
  s_add_u32 m0, s33, 147456
  s_mov_b32 s34, 4096
  buffer_load_dwordx4 v23, s[16:19], s34 offen sc1 lds
  s_add_u32 m0, s33, 151552
  s_mov_b32 s34, 40960
  buffer_load_dwordx4 v23, s[16:19], s34 offen sc1 lds
  s_add_u32 m0, s33, 155648
  s_mov_b32 s34, 5120
  buffer_load_dwordx4 v23, s[16:19], s34 offen sc1 lds
  s_add_u32 m0, s33, 159744
  s_mov_b32 s34, 41984
  buffer_load_dwordx4 v23, s[16:19], s34 offen sc1 lds
  s_waitcnt vmcnt(6)
  s_barrier
  ds_read_b64_tr_b16 v[56:57], v8 offset:40960
  ds_read_b64_tr_b16 v[58:59], v8 offset:43008
  ds_read_b64_tr_b16 v[60:61], v8 offset:45056
  ds_read_b64_tr_b16 v[62:63], v8 offset:47104
  ds_read_b64_tr_b16 v[64:65], v8 offset:49152
  ds_read_b64_tr_b16 v[66:67], v8 offset:51200
  ds_read_b128 a[0:3], v27 offset:49152
  ds_read_b128 a[4:7], v27 offset:50176
  ds_read_b128 a[8:11], v27 offset:53248
  ds_read_b128 a[12:15], v27 offset:54272
  ds_read_b128 a[16:19], v27 offset:57344
  ds_read_b128 a[20:23], v27 offset:58368
  ds_read_b128 a[24:27], v27 offset:61440
  ds_read_b128 a[28:31], v27 offset:62464
  ds_read_b128 a[32:35], v28
  ds_read_b128 a[36:39], v28 offset:1024
  ds_read_b128 a[40:43], v28 offset:4096
  ds_read_b128 a[44:47], v28 offset:5120
  ds_read_b64_tr_b16 v[68:69], v11 offset:40960
  ds_read_b64_tr_b16 v[70:71], v11 offset:43008
  ds_read_b64_tr_b16 v[72:73], v11 offset:45056
  ds_read_b64_tr_b16 v[74:75], v11 offset:47104
  ds_read_b64_tr_b16 v[76:77], v11 offset:49152
  ds_read_b64_tr_b16 v[78:79], v11 offset:51200
  s_waitcnt lgkmcnt(15)
  v_mfma_f32_16x16x32_bf16 v[128:131], v[56:59], a[0:3], 0
  s_waitcnt vmcnt(4)
  s_barrier
  s_waitcnt lgkmcnt(13)
  v_mfma_f32_16x16x32_bf16 v[128:131], v[60:63], a[16:19], v[128:131]
  ds_read_b64_tr_b16 v[80:81], v8 offset:53248
  s_add_u32 m0, s33, 0
  s_waitcnt lgkmcnt(10)
  v_mfma_f32_16x16x32_bf16 v[128:131], v[64:67], a[32:35], v[128:131]
  ds_read_b64_tr_b16 v[82:83], v8 offset:55296
  s_mov_b32 s34, 6144
  v_mfma_f32_16x16x32_bf16 v[132:135], v[56:59], a[4:7], 0
  ds_read_b64_tr_b16 v[84:85], v8 offset:57344
  buffer_load_dwordx4 v23, s[16:19], s34 offen sc1 lds
  v_mfma_f32_16x16x32_bf16 v[132:135], v[60:63], a[20:23], v[132:135]
  ds_read_b64_tr_b16 v[86:87], v8 offset:59392
  s_add_u32 m0, s33, 4096
  s_waitcnt lgkmcnt(12)
  v_mfma_f32_16x16x32_bf16 v[132:135], v[64:67], a[36:39], v[132:135]
  ds_read_b64_tr_b16 v[88:89], v8 offset:61440
  s_mov_b32 s34, 43008
  v_mfma_f32_16x16x32_bf16 v[136:139], v[56:59], a[8:11], 0
  ds_read_b64_tr_b16 v[90:91], v8 offset:63488
  buffer_load_dwordx4 v23, s[16:19], s34 offen sc1 lds
  v_mfma_f32_16x16x32_bf16 v[136:139], v[60:63], a[24:27], v[136:139]
  s_add_u32 m0, s33, 8192
  s_waitcnt lgkmcnt(13)
  v_mfma_f32_16x16x32_bf16 v[136:139], v[64:67], a[40:43], v[136:139]
  s_mov_b32 s34, 7168
  v_mfma_f32_16x16x32_bf16 v[140:143], v[56:59], a[12:15], 0
  buffer_load_dwordx4 v23, s[16:19], s34 offen sc1 lds
  v_mfma_f32_16x16x32_bf16 v[140:143], v[60:63], a[28:31], v[140:143]
  s_waitcnt lgkmcnt(12)
  v_mfma_f32_16x16x32_bf16 v[140:143], v[64:67], a[44:47], v[140:143]
  s_waitcnt lgkmcnt(6)
  v_mfma_f32_16x16x32_bf16 v[144:147], v[68:71], a[0:3], 0
  ds_read_b64_tr_b16 v[56:57], v11 offset:53248
  s_add_u32 m0, s33, 12288
  v_mfma_f32_16x16x32_bf16 v[144:147], v[72:75], a[16:19], v[144:147]
  ds_read_b64_tr_b16 v[58:59], v11 offset:55296
  s_mov_b32 s34, 44032
  v_mfma_f32_16x16x32_bf16 v[144:147], v[76:79], a[32:35], v[144:147]
  ds_read_b64_tr_b16 v[60:61], v11 offset:57344
  buffer_load_dwordx4 v23, s[16:19], s34 offen sc1 lds
  v_mfma_f32_16x16x32_bf16 v[148:151], v[68:71], a[4:7], 0
  ds_read_b64_tr_b16 v[62:63], v11 offset:59392
  s_add_u32 m0, s33, 16384
  v_mfma_f32_16x16x32_bf16 v[148:151], v[72:75], a[20:23], v[148:151]
  ds_read_b64_tr_b16 v[64:65], v11 offset:61440
  s_mov_b32 s34, 8192
  v_mfma_f32_16x16x32_bf16 v[148:151], v[76:79], a[36:39], v[148:151]
  ds_read_b64_tr_b16 v[66:67], v11 offset:63488
  buffer_load_dwordx4 v23, s[16:19], s34 offen sc1 lds
  v_mfma_f32_16x16x32_bf16 v[152:155], v[68:71], a[8:11], 0
  ds_read_b128 a[48:51], v28 offset:8192
  s_add_u32 m0, s33, 20480
  v_mfma_f32_16x16x32_bf16 v[152:155], v[72:75], a[24:27], v[152:155]
  ds_read_b128 a[52:55], v28 offset:9216
  s_mov_b32 s34, 45056
  v_mfma_f32_16x16x32_bf16 v[152:155], v[76:79], a[40:43], v[152:155]
  ds_read_b128 a[56:59], v28 offset:12288
  buffer_load_dwordx4 v23, s[16:19], s34 offen sc1 lds
  v_mfma_f32_16x16x32_bf16 v[156:159], v[68:71], a[12:15], 0
  ds_read_b128 a[60:63], v28 offset:13312
  v_mfma_f32_16x16x32_bf16 v[156:159], v[72:75], a[28:31], v[156:159]
  v_mfma_f32_16x16x32_bf16 v[156:159], v[76:79], a[44:47], v[156:159]
  s_waitcnt lgkmcnt(10)
  v_mfma_f32_16x16x32_bf16 v[160:163], v[80:83], a[0:3], 0
  s_waitcnt vmcnt(6)
  s_barrier
  v_mfma_f32_16x16x32_bf16 v[160:163], v[84:87], a[16:19], v[160:163]
  ds_read_b64_tr_b16 v[68:69], v9
  s_add_u32 m0, s33, 24576
  v_mfma_f32_16x16x32_bf16 v[160:163], v[88:91], a[32:35], v[160:163]
  ds_read_b64_tr_b16 v[70:71], v9 offset:2048
  s_mov_b32 s34, 9216
  v_mfma_f32_16x16x32_bf16 v[164:167], v[80:83], a[4:7], 0
  ds_read_b64_tr_b16 v[72:73], v9 offset:4096
  buffer_load_dwordx4 v23, s[16:19], s34 offen sc1 lds
  v_mfma_f32_16x16x32_bf16 v[164:167], v[84:87], a[20:23], v[164:167]
  ds_read_b64_tr_b16 v[74:75], v9 offset:6144
  s_add_u32 m0, s33, 28672
  v_mfma_f32_16x16x32_bf16 v[164:167], v[88:91], a[36:39], v[164:167]
  ds_read_b64_tr_b16 v[76:77], v9 offset:8192
  s_mov_b32 s34, 46080
  v_mfma_f32_16x16x32_bf16 v[168:171], v[80:83], a[8:11], 0
  ds_read_b64_tr_b16 v[78:79], v9 offset:10240
  buffer_load_dwordx4 v23, s[16:19], s34 offen sc1 lds
  v_mfma_f32_16x16x32_bf16 v[168:171], v[84:87], a[24:27], v[168:171]
  ds_read_b128 a[64:67], v28 offset:16384
  s_add_u32 m0, s33, 32768
  v_mfma_f32_16x16x32_bf16 v[168:171], v[88:91], a[40:43], v[168:171]
  ds_read_b128 a[68:71], v28 offset:17408
  s_mov_b32 s34, 10240
  v_mfma_f32_16x16x32_bf16 v[172:175], v[80:83], a[12:15], 0
  ds_read_b128 a[72:75], v28 offset:20480
  buffer_load_dwordx4 v23, s[16:19], s34 offen sc1 lds
  v_mfma_f32_16x16x32_bf16 v[172:175], v[84:87], a[28:31], v[172:175]
  ds_read_b128 a[76:79], v28 offset:21504
  v_mfma_f32_16x16x32_bf16 v[172:175], v[88:91], a[44:47], v[172:175]
  s_waitcnt lgkmcnt(14)
  v_mfma_f32_16x16x32_bf16 v[176:179], v[56:59], a[0:3], 0
  ds_read_b64_tr_b16 v[80:81], v12
  s_add_u32 m0, s33, 36864
  v_mfma_f32_16x16x32_bf16 v[176:179], v[60:63], a[16:19], v[176:179]
  ds_read_b64_tr_b16 v[82:83], v12 offset:2048
  s_mov_b32 s34, 47104
  v_mfma_f32_16x16x32_bf16 v[176:179], v[64:67], a[32:35], v[176:179]
  ds_read_b64_tr_b16 v[84:85], v12 offset:4096
  buffer_load_dwordx4 v23, s[16:19], s34 offen sc1 lds
  v_mfma_f32_16x16x32_bf16 v[180:183], v[56:59], a[4:7], 0
  ds_read_b64_tr_b16 v[86:87], v12 offset:6144
  s_add_u32 m0, s33, 114688
  v_mfma_f32_16x16x32_bf16 v[180:183], v[60:63], a[20:23], v[180:183]
  ds_read_b64_tr_b16 v[88:89], v12 offset:8192
  s_mov_b32 s34, 11264
  v_mfma_f32_16x16x32_bf16 v[180:183], v[64:67], a[36:39], v[180:183]
  ds_read_b64_tr_b16 v[90:91], v12 offset:10240
  buffer_load_dwordx4 v23, s[16:19], s34 offen sc1 lds
  v_mfma_f32_16x16x32_bf16 v[184:187], v[56:59], a[8:11], 0
  ds_read_b128 a[80:83], v28 offset:24576
  s_add_u32 m0, s33, 118784
  v_mfma_f32_16x16x32_bf16 v[184:187], v[60:63], a[24:27], v[184:187]
  ds_read_b128 a[84:87], v28 offset:25600
  s_mov_b32 s34, 48128
  v_mfma_f32_16x16x32_bf16 v[184:187], v[64:67], a[40:43], v[184:187]
  ds_read_b128 a[88:91], v28 offset:28672
  buffer_load_dwordx4 v23, s[16:19], s34 offen sc1 lds
  v_mfma_f32_16x16x32_bf16 v[188:191], v[56:59], a[12:15], 0
  ds_read_b128 a[92:95], v28 offset:29696
  v_mfma_f32_16x16x32_bf16 v[188:191], v[60:63], a[28:31], v[188:191]
  v_mfma_f32_16x16x32_bf16 v[188:191], v[64:67], a[44:47], v[188:191]
  s_waitcnt lgkmcnt(14)
  v_mfma_f32_16x16x32_bf16 v[128:131], v[68:71], a[48:51], v[128:131]
  s_waitcnt vmcnt(10)
  s_barrier
  s_waitcnt lgkmcnt(13)
  v_mfma_f32_16x16x32_bf16 v[128:131], v[72:75], a[64:67], v[128:131]
  ds_read_b64_tr_b16 v[56:57], v9 offset:12288
  s_add_u32 m0, s33, 122880
  s_waitcnt lgkmcnt(4)
  v_mfma_f32_16x16x32_bf16 v[128:131], v[76:79], a[80:83], v[128:131]
  ds_read_b64_tr_b16 v[58:59], v9 offset:14336
  s_mov_b32 s34, 2654208
  v_mfma_f32_16x16x32_bf16 v[132:135], v[68:71], a[52:55], v[132:135]
  ds_read_b64_tr_b16 v[60:61], v9 offset:16384
  buffer_load_dwordx4 v19, s[4:7], s34 offen lds
  v_mfma_f32_16x16x32_bf16 v[132:135], v[72:75], a[68:71], v[132:135]
  ds_read_b64_tr_b16 v[62:63], v9 offset:18432
  s_add_u32 m0, s33, 126976
  s_waitcnt lgkmcnt(6)
  v_mfma_f32_16x16x32_bf16 v[132:135], v[76:79], a[84:87], v[132:135]
  ds_read_b64_tr_b16 v[64:65], v9 offset:20480
  s_mov_b32 s34, 2949120
  v_mfma_f32_16x16x32_bf16 v[136:139], v[68:71], a[56:59], v[136:139]
  ds_read_b64_tr_b16 v[66:67], v9 offset:22528
  buffer_load_dwordx4 v19, s[4:7], s34 offen lds
  v_mfma_f32_16x16x32_bf16 v[136:139], v[72:75], a[72:75], v[136:139]
  s_add_u32 m0, s33, 131072
  s_waitcnt lgkmcnt(7)
  v_mfma_f32_16x16x32_bf16 v[136:139], v[76:79], a[88:91], v[136:139]
  s_mov_b32 s34, 3244032
  v_mfma_f32_16x16x32_bf16 v[140:143], v[68:71], a[60:63], v[140:143]
  buffer_load_dwordx4 v19, s[4:7], s34 offen lds
  v_mfma_f32_16x16x32_bf16 v[140:143], v[72:75], a[76:79], v[140:143]
  s_waitcnt lgkmcnt(6)
  v_mfma_f32_16x16x32_bf16 v[140:143], v[76:79], a[92:95], v[140:143]
  v_mfma_f32_16x16x32_bf16 v[144:147], v[80:83], a[48:51], v[144:147]
  ds_read_b64_tr_b16 v[68:69], v12 offset:12288
  s_add_u32 m0, s33, 135168
  v_mfma_f32_16x16x32_bf16 v[144:147], v[84:87], a[64:67], v[144:147]
  ds_read_b64_tr_b16 v[70:71], v12 offset:14336
  s_mov_b32 s34, 2654208
  v_mfma_f32_16x16x32_bf16 v[144:147], v[88:91], a[80:83], v[144:147]
  ds_read_b64_tr_b16 v[72:73], v12 offset:16384
  buffer_load_dwordx4 v19, s[8:11], s34 offen lds
  v_mfma_f32_16x16x32_bf16 v[148:151], v[80:83], a[52:55], v[148:151]
  ds_read_b64_tr_b16 v[74:75], v12 offset:18432
  s_add_u32 m0, s33, 40960
  v_mfma_f32_16x16x32_bf16 v[148:151], v[84:87], a[68:71], v[148:151]
  ds_read_b64_tr_b16 v[76:77], v12 offset:20480
  s_mov_b32 s34, 2949120
  v_mfma_f32_16x16x32_bf16 v[148:151], v[88:91], a[84:87], v[148:151]
  ds_read_b64_tr_b16 v[78:79], v12 offset:22528
  buffer_load_dwordx4 v19, s[8:11], s34 offen lds
  v_mfma_f32_16x16x32_bf16 v[152:155], v[80:83], a[56:59], v[152:155]
  ds_read_b128 a[96:99], v26
  s_add_u32 m0, s33, 45056
  v_mfma_f32_16x16x32_bf16 v[152:155], v[84:87], a[72:75], v[152:155]
  ds_read_b128 a[100:103], v26 offset:1024
  s_mov_b32 s34, 3244032
  v_mfma_f32_16x16x32_bf16 v[152:155], v[88:91], a[88:91], v[152:155]
  ds_read_b128 a[104:107], v26 offset:4096
  buffer_load_dwordx4 v19, s[8:11], s34 offen lds
  v_mfma_f32_16x16x32_bf16 v[156:159], v[80:83], a[60:63], v[156:159]
  ds_read_b128 a[108:111], v26 offset:5120
  v_mfma_f32_16x16x32_bf16 v[156:159], v[84:87], a[76:79], v[156:159]
  v_mfma_f32_16x16x32_bf16 v[156:159], v[88:91], a[92:95], v[156:159]
  s_waitcnt lgkmcnt(10)
  v_mfma_f32_16x16x32_bf16 v[160:163], v[56:59], a[48:51], v[160:163]
  s_waitcnt vmcnt(12)
  s_barrier
  v_mfma_f32_16x16x32_bf16 v[160:163], v[60:63], a[64:67], v[160:163]
  ds_read_b64_tr_b16 v[80:81], v9 offset:24576
  s_add_u32 m0, s33, 49152
  v_mfma_f32_16x16x32_bf16 v[160:163], v[64:67], a[80:83], v[160:163]
  ds_read_b64_tr_b16 v[82:83], v9 offset:26624
  s_mov_b32 s34, 12288
  v_mfma_f32_16x16x32_bf16 v[164:167], v[56:59], a[52:55], v[164:167]
  ds_read_b64_tr_b16 v[84:85], v9 offset:28672
  buffer_load_dwordx4 v23, s[16:19], s34 offen sc1 lds
  v_mfma_f32_16x16x32_bf16 v[164:167], v[60:63], a[68:71], v[164:167]
  ds_read_b64_tr_b16 v[86:87], v9 offset:30720
  s_add_u32 m0, s33, 53248
  v_mfma_f32_16x16x32_bf16 v[164:167], v[64:67], a[84:87], v[164:167]
  ds_read_b64_tr_b16 v[88:89], v9 offset:32768
  s_mov_b32 s34, 49152
  v_mfma_f32_16x16x32_bf16 v[168:171], v[56:59], a[56:59], v[168:171]
  ds_read_b64_tr_b16 v[90:91], v9 offset:34816
  buffer_load_dwordx4 v23, s[16:19], s34 offen sc1 lds
  v_mfma_f32_16x16x32_bf16 v[168:171], v[60:63], a[72:75], v[168:171]
  ds_read_b128 a[112:115], v26 offset:8192
  s_add_u32 m0, s33, 57344
  v_mfma_f32_16x16x32_bf16 v[168:171], v[64:67], a[88:91], v[168:171]
  ds_read_b128 a[116:119], v26 offset:9216
  s_mov_b32 s34, 13312
  v_mfma_f32_16x16x32_bf16 v[172:175], v[56:59], a[60:63], v[172:175]
  ds_read_b128 a[120:123], v26 offset:12288
  buffer_load_dwordx4 v23, s[16:19], s34 offen sc1 lds
  v_mfma_f32_16x16x32_bf16 v[172:175], v[60:63], a[76:79], v[172:175]
  ds_read_b128 a[124:127], v26 offset:13312
  v_mfma_f32_16x16x32_bf16 v[172:175], v[64:67], a[92:95], v[172:175]
  s_waitcnt lgkmcnt(14)
  v_mfma_f32_16x16x32_bf16 v[176:179], v[68:71], a[48:51], v[176:179]
  ds_read_b64_tr_b16 v[56:57], v12 offset:24576
  s_add_u32 m0, s33, 61440
  v_mfma_f32_16x16x32_bf16 v[176:179], v[72:75], a[64:67], v[176:179]
  ds_read_b64_tr_b16 v[58:59], v12 offset:26624
  s_mov_b32 s34, 50176
  v_mfma_f32_16x16x32_bf16 v[176:179], v[76:79], a[80:83], v[176:179]
  ds_read_b64_tr_b16 v[60:61], v12 offset:28672
  buffer_load_dwordx4 v23, s[16:19], s34 offen sc1 lds
  v_mfma_f32_16x16x32_bf16 v[180:183], v[68:71], a[52:55], v[180:183]
  ds_read_b64_tr_b16 v[62:63], v12 offset:30720
  s_add_u32 m0, s33, 139264
  v_mfma_f32_16x16x32_bf16 v[180:183], v[72:75], a[68:71], v[180:183]
  ds_read_b64_tr_b16 v[64:65], v12 offset:32768
  s_mov_b32 s34, 14336
  v_mfma_f32_16x16x32_bf16 v[180:183], v[76:79], a[84:87], v[180:183]
  ds_read_b64_tr_b16 v[66:67], v12 offset:34816
  buffer_load_dwordx4 v23, s[16:19], s34 offen sc1 lds
  v_mfma_f32_16x16x32_bf16 v[184:187], v[68:71], a[56:59], v[184:187]
  ds_read_b128 a[128:131], v26 offset:16384
  s_add_u32 m0, s33, 143360
  v_mfma_f32_16x16x32_bf16 v[184:187], v[72:75], a[72:75], v[184:187]
  ds_read_b128 a[132:135], v26 offset:17408
  s_mov_b32 s34, 51200
  v_mfma_f32_16x16x32_bf16 v[184:187], v[76:79], a[88:91], v[184:187]
  ds_read_b128 a[136:139], v26 offset:20480
  buffer_load_dwordx4 v23, s[16:19], s34 offen sc1 lds
  v_mfma_f32_16x16x32_bf16 v[188:191], v[68:71], a[60:63], v[188:191]
  ds_read_b128 a[140:143], v26 offset:21504
  v_mfma_f32_16x16x32_bf16 v[188:191], v[72:75], a[76:79], v[188:191]
  v_mfma_f32_16x16x32_bf16 v[188:191], v[76:79], a[92:95], v[188:191]
  s_waitcnt lgkmcnt(14)
  v_mfma_f32_16x16x32_bf16 v[128:131], v[80:83], a[96:99], v[128:131]
  s_waitcnt vmcnt(16)
  s_barrier
  s_waitcnt lgkmcnt(13)
  v_mfma_f32_16x16x32_bf16 v[128:131], v[84:87], a[112:115], v[128:131]
  ds_read_b64_tr_b16 v[68:69], v9 offset:36864
  s_add_u32 m0, s33, 147456
  s_waitcnt lgkmcnt(4)
  v_mfma_f32_16x16x32_bf16 v[128:131], v[88:91], a[128:131], v[128:131]
  ds_read_b64_tr_b16 v[70:71], v9 offset:38912
  s_mov_b32 s34, 3538944
  v_mfma_f32_16x16x32_bf16 v[132:135], v[80:83], a[100:103], v[132:135]
  ds_read_b64_tr_b16 v[72:73], v9 offset:40960
  buffer_load_dwordx4 v19, s[4:7], s34 offen lds
  v_mfma_f32_16x16x32_bf16 v[132:135], v[84:87], a[116:119], v[132:135]
  ds_read_b64_tr_b16 v[74:75], v9 offset:43008
  s_add_u32 m0, s33, 151552
  s_waitcnt lgkmcnt(6)
  v_mfma_f32_16x16x32_bf16 v[132:135], v[88:91], a[132:135], v[132:135]
  ds_read_b64_tr_b16 v[76:77], v9 offset:45056
  s_mov_b32 s34, 3833856
  v_mfma_f32_16x16x32_bf16 v[136:139], v[80:83], a[104:107], v[136:139]
  ds_read_b64_tr_b16 v[78:79], v9 offset:47104
  buffer_load_dwordx4 v19, s[4:7], s34 offen lds
  v_mfma_f32_16x16x32_bf16 v[136:139], v[84:87], a[120:123], v[136:139]
  s_add_u32 m0, s33, 65536
  s_waitcnt lgkmcnt(7)
  v_mfma_f32_16x16x32_bf16 v[136:139], v[88:91], a[136:139], v[136:139]
  s_mov_b32 s34, 4128768
  v_mfma_f32_16x16x32_bf16 v[140:143], v[80:83], a[108:111], v[140:143]
  buffer_load_dwordx4 v19, s[4:7], s34 offen lds
  v_mfma_f32_16x16x32_bf16 v[140:143], v[84:87], a[124:127], v[140:143]
  s_waitcnt lgkmcnt(6)
  v_mfma_f32_16x16x32_bf16 v[140:143], v[88:91], a[140:143], v[140:143]
  v_mfma_f32_16x16x32_bf16 v[144:147], v[56:59], a[96:99], v[144:147]
  ds_read_b64_tr_b16 v[80:81], v12 offset:36864
  s_add_u32 m0, s33, 69632
  v_mfma_f32_16x16x32_bf16 v[144:147], v[60:63], a[112:115], v[144:147]
  ds_read_b64_tr_b16 v[82:83], v12 offset:38912
  s_mov_b32 s34, 3538944
  v_mfma_f32_16x16x32_bf16 v[144:147], v[64:67], a[128:131], v[144:147]
  ds_read_b64_tr_b16 v[84:85], v12 offset:40960
  buffer_load_dwordx4 v19, s[8:11], s34 offen lds
  v_mfma_f32_16x16x32_bf16 v[148:151], v[56:59], a[100:103], v[148:151]
  ds_read_b64_tr_b16 v[86:87], v12 offset:43008
  s_add_u32 m0, s33, 73728
  v_mfma_f32_16x16x32_bf16 v[148:151], v[60:63], a[116:119], v[148:151]
  ds_read_b64_tr_b16 v[88:89], v12 offset:45056
  s_mov_b32 s34, 3833856
  v_mfma_f32_16x16x32_bf16 v[148:151], v[64:67], a[132:135], v[148:151]
  ds_read_b64_tr_b16 v[90:91], v12 offset:47104
  buffer_load_dwordx4 v19, s[8:11], s34 offen lds
  v_mfma_f32_16x16x32_bf16 v[152:155], v[56:59], a[104:107], v[152:155]
  ds_read_b128 a[144:147], v26 offset:24576
  s_add_u32 m0, s33, 155648
  v_mfma_f32_16x16x32_bf16 v[152:155], v[60:63], a[120:123], v[152:155]
  ds_read_b128 a[148:151], v26 offset:25600
  s_mov_b32 s34, 4128768
  v_mfma_f32_16x16x32_bf16 v[152:155], v[64:67], a[136:139], v[152:155]
  ds_read_b128 a[152:155], v26 offset:28672
  buffer_load_dwordx4 v19, s[8:11], s34 offen lds
  v_mfma_f32_16x16x32_bf16 v[156:159], v[56:59], a[108:111], v[156:159]
  ds_read_b128 a[156:159], v26 offset:29696
  v_mfma_f32_16x16x32_bf16 v[156:159], v[60:63], a[124:127], v[156:159]
  v_mfma_f32_16x16x32_bf16 v[156:159], v[64:67], a[140:143], v[156:159]
  s_waitcnt lgkmcnt(10)
  v_mfma_f32_16x16x32_bf16 v[160:163], v[68:71], a[96:99], v[160:163]
  s_waitcnt vmcnt(15)
  s_barrier
  v_mfma_f32_16x16x32_bf16 v[160:163], v[72:75], a[112:115], v[160:163]
  ds_read_b64_tr_b16 v[56:57], v9 offset:57344
  s_add_u32 m0, s33, 159744
  v_mfma_f32_16x16x32_bf16 v[160:163], v[76:79], a[128:131], v[160:163]
  ds_read_b64_tr_b16 v[58:59], v9 offset:59392
  s_mov_b32 s34, 15360
  v_mfma_f32_16x16x32_bf16 v[164:167], v[68:71], a[100:103], v[164:167]
  ds_read_b64_tr_b16 v[60:61], v9 offset:61440
  buffer_load_dwordx4 v23, s[16:19], s34 offen sc1 lds
  v_mfma_f32_16x16x32_bf16 v[164:167], v[72:75], a[116:119], v[164:167]
  ds_read_b64_tr_b16 v[62:63], v9 offset:63488
  s_add_u32 m0, s33, 77824
  v_mfma_f32_16x16x32_bf16 v[164:167], v[76:79], a[132:135], v[164:167]
  ds_read_b64_tr_b16 v[64:65], v10
  s_mov_b32 s34, 52224
  v_mfma_f32_16x16x32_bf16 v[168:171], v[68:71], a[104:107], v[168:171]
  ds_read_b64_tr_b16 v[66:67], v10 offset:2048
  buffer_load_dwordx4 v23, s[16:19], s34 offen sc1 lds
  v_mfma_f32_16x16x32_bf16 v[168:171], v[72:75], a[120:123], v[168:171]
  ds_read_b128 a[160:163], v26 offset:32768
  s_add_u32 m0, s33, 81920
  v_mfma_f32_16x16x32_bf16 v[168:171], v[76:79], a[136:139], v[168:171]
  ds_read_b128 a[164:167], v26 offset:33792
  s_mov_b32 s34, 16384
  v_mfma_f32_16x16x32_bf16 v[172:175], v[68:71], a[108:111], v[172:175]
  ds_read_b128 a[168:171], v26 offset:36864
  buffer_load_dwordx4 v23, s[16:19], s34 offen sc1 lds
  v_mfma_f32_16x16x32_bf16 v[172:175], v[72:75], a[124:127], v[172:175]
  ds_read_b128 a[172:175], v26 offset:37888
  v_mfma_f32_16x16x32_bf16 v[172:175], v[76:79], a[140:143], v[172:175]
  s_waitcnt lgkmcnt(14)
  v_mfma_f32_16x16x32_bf16 v[176:179], v[80:83], a[96:99], v[176:179]
  ds_read_b64_tr_b16 v[68:69], v12 offset:57344
  s_add_u32 m0, s33, 86016
  v_mfma_f32_16x16x32_bf16 v[176:179], v[84:87], a[112:115], v[176:179]
  ds_read_b64_tr_b16 v[70:71], v12 offset:59392
  s_mov_b32 s34, 53248
  v_mfma_f32_16x16x32_bf16 v[176:179], v[88:91], a[128:131], v[176:179]
  ds_read_b64_tr_b16 v[72:73], v12 offset:61440
  buffer_load_dwordx4 v23, s[16:19], s34 offen sc1 lds
  v_mfma_f32_16x16x32_bf16 v[180:183], v[80:83], a[100:103], v[180:183]
  ds_read_b64_tr_b16 v[74:75], v12 offset:63488
  s_add_u32 m0, s33, 0
  v_mfma_f32_16x16x32_bf16 v[180:183], v[84:87], a[116:119], v[180:183]
  ds_read_b64_tr_b16 v[76:77], v13
  s_mov_b32 s34, 17408
  v_mfma_f32_16x16x32_bf16 v[180:183], v[88:91], a[132:135], v[180:183]
  ds_read_b64_tr_b16 v[78:79], v13 offset:2048
  buffer_load_dwordx4 v23, s[16:19], s34 offen sc1 lds
  v_mfma_f32_16x16x32_bf16 v[184:187], v[80:83], a[104:107], v[184:187]
  ds_read_b128 a[176:179], v27 offset:49152
  s_add_u32 m0, s33, 4096
  v_mfma_f32_16x16x32_bf16 v[184:187], v[84:87], a[120:123], v[184:187]
  ds_read_b128 a[180:183], v27 offset:50176
  s_mov_b32 s34, 54272
  v_mfma_f32_16x16x32_bf16 v[184:187], v[88:91], a[136:139], v[184:187]
  ds_read_b128 a[184:187], v27 offset:53248
  buffer_load_dwordx4 v23, s[16:19], s34 offen sc1 lds
  v_mfma_f32_16x16x32_bf16 v[188:191], v[80:83], a[108:111], v[188:191]
  ds_read_b128 a[188:191], v27 offset:54272
  v_mfma_f32_16x16x32_bf16 v[188:191], v[84:87], a[124:127], v[188:191]
  v_mfma_f32_16x16x32_bf16 v[188:191], v[88:91], a[140:143], v[188:191]
  s_waitcnt lgkmcnt(14)
  v_mfma_f32_16x16x32_bf16 v[128:131], v[56:59], a[144:147], v[128:131]
  s_waitcnt vmcnt(16)
  s_barrier
  s_waitcnt lgkmcnt(13)
  v_mfma_f32_16x16x32_bf16 v[128:131], v[60:63], a[160:163], v[128:131]
  ds_read_b64_tr_b16 v[80:81], v10 offset:4096
  s_add_u32 m0, s33, 8192
  s_waitcnt lgkmcnt(4)
  v_mfma_f32_16x16x32_bf16 v[128:131], v[64:67], a[176:179], v[128:131]
  ds_read_b64_tr_b16 v[82:83], v10 offset:6144
  s_mov_b32 s34, 4423680
  v_mfma_f32_16x16x32_bf16 v[132:135], v[56:59], a[148:151], v[132:135]
  ds_read_b64_tr_b16 v[84:85], v8 offset:40960
  buffer_load_dwordx4 v19, s[4:7], s34 offen lds
  v_mfma_f32_16x16x32_bf16 v[132:135], v[60:63], a[164:167], v[132:135]
  ds_read_b64_tr_b16 v[86:87], v8 offset:43008
  s_add_u32 m0, s33, 12288
  s_waitcnt lgkmcnt(6)
  v_mfma_f32_16x16x32_bf16 v[132:135], v[64:67], a[180:183], v[132:135]
  ds_read_b64_tr_b16 v[88:89], v8 offset:45056
  s_mov_b32 s34, 4718592
  v_mfma_f32_16x16x32_bf16 v[136:139], v[56:59], a[152:155], v[136:139]
  ds_read_b64_tr_b16 v[90:91], v8 offset:47104
  buffer_load_dwordx4 v19, s[4:7], s34 offen lds
  v_mfma_f32_16x16x32_bf16 v[136:139], v[60:63], a[168:171], v[136:139]
  s_add_u32 m0, s33, 90112
  s_waitcnt lgkmcnt(7)
  v_mfma_f32_16x16x32_bf16 v[136:139], v[64:67], a[184:187], v[136:139]
  s_mov_b32 s34, 5013504
  v_mfma_f32_16x16x32_bf16 v[140:143], v[56:59], a[156:159], v[140:143]
  buffer_load_dwordx4 v19, s[4:7], s34 offen lds
  v_mfma_f32_16x16x32_bf16 v[140:143], v[60:63], a[172:175], v[140:143]
  s_waitcnt lgkmcnt(6)
  v_mfma_f32_16x16x32_bf16 v[140:143], v[64:67], a[188:191], v[140:143]
  v_mfma_f32_16x16x32_bf16 v[144:147], v[68:71], a[144:147], v[144:147]
  ds_read_b64_tr_b16 v[56:57], v13 offset:4096
  s_add_u32 m0, s33, 94208
  v_mfma_f32_16x16x32_bf16 v[144:147], v[72:75], a[160:163], v[144:147]
  ds_read_b64_tr_b16 v[58:59], v13 offset:6144
  s_mov_b32 s34, 4423680
  v_mfma_f32_16x16x32_bf16 v[144:147], v[76:79], a[176:179], v[144:147]
  ds_read_b64_tr_b16 v[60:61], v11 offset:40960
  buffer_load_dwordx4 v19, s[8:11], s34 offen lds
  v_mfma_f32_16x16x32_bf16 v[148:151], v[68:71], a[148:151], v[148:151]
  ds_read_b64_tr_b16 v[62:63], v11 offset:43008
  s_add_u32 m0, s33, 98304
  v_mfma_f32_16x16x32_bf16 v[148:151], v[72:75], a[164:167], v[148:151]
  ds_read_b64_tr_b16 v[64:65], v11 offset:45056
  s_mov_b32 s34, 4718592
  v_mfma_f32_16x16x32_bf16 v[148:151], v[76:79], a[180:183], v[148:151]
  ds_read_b64_tr_b16 v[66:67], v11 offset:47104
  buffer_load_dwordx4 v19, s[8:11], s34 offen lds
  v_mfma_f32_16x16x32_bf16 v[152:155], v[68:71], a[152:155], v[152:155]
  ds_read_b128 a[192:195], v26 offset:49152
  s_add_u32 m0, s33, 16384
  v_mfma_f32_16x16x32_bf16 v[152:155], v[72:75], a[168:171], v[152:155]
  ds_read_b128 a[196:199], v26 offset:50176
  s_mov_b32 s34, 5013504
  v_mfma_f32_16x16x32_bf16 v[152:155], v[76:79], a[184:187], v[152:155]
  ds_read_b128 a[200:203], v26 offset:53248
  buffer_load_dwordx4 v19, s[8:11], s34 offen lds
  v_mfma_f32_16x16x32_bf16 v[156:159], v[68:71], a[156:159], v[156:159]
  ds_read_b128 a[204:207], v26 offset:54272
  v_mfma_f32_16x16x32_bf16 v[156:159], v[72:75], a[172:175], v[156:159]
  v_mfma_f32_16x16x32_bf16 v[156:159], v[76:79], a[188:191], v[156:159]
  s_waitcnt lgkmcnt(10)
  v_mfma_f32_16x16x32_bf16 v[160:163], v[80:83], a[144:147], v[160:163]
  s_waitcnt vmcnt(15)
  s_barrier
  v_mfma_f32_16x16x32_bf16 v[160:163], v[84:87], a[160:163], v[160:163]
  ds_read_b64_tr_b16 v[68:69], v10 offset:16384
  s_add_u32 m0, s33, 20480
  v_mfma_f32_16x16x32_bf16 v[160:163], v[88:91], a[176:179], v[160:163]
  ds_read_b64_tr_b16 v[70:71], v10 offset:18432
  s_mov_b32 s34, 128
  v_mfma_f32_16x16x32_bf16 v[164:167], v[80:83], a[148:151], v[164:167]
  ds_read_b64_tr_b16 v[72:73], v10 offset:20480
  buffer_load_dwordx4 v19, s[4:7], s34 offen lds
  v_mfma_f32_16x16x32_bf16 v[164:167], v[84:87], a[164:167], v[164:167]
  ds_read_b64_tr_b16 v[74:75], v10 offset:22528
  s_add_u32 m0, s33, 102400
  v_mfma_f32_16x16x32_bf16 v[164:167], v[88:91], a[180:183], v[164:167]
  ds_read_b64_tr_b16 v[76:77], v9
  s_mov_b32 s34, 295040
  v_mfma_f32_16x16x32_bf16 v[168:171], v[80:83], a[152:155], v[168:171]
  ds_read_b64_tr_b16 v[78:79], v9 offset:2048
  buffer_load_dwordx4 v19, s[4:7], s34 offen lds
  v_mfma_f32_16x16x32_bf16 v[168:171], v[84:87], a[168:171], v[168:171]
  ds_read_b128 a[208:211], v26 offset:57344
  s_add_u32 m0, s33, 106496
  v_mfma_f32_16x16x32_bf16 v[168:171], v[88:91], a[184:187], v[168:171]
  ds_read_b128 a[212:215], v26 offset:58368
  s_mov_b32 s34, 589952
  v_mfma_f32_16x16x32_bf16 v[172:175], v[80:83], a[156:159], v[172:175]
  ds_read_b128 a[216:219], v26 offset:61440
  buffer_load_dwordx4 v19, s[4:7], s34 offen lds
  v_mfma_f32_16x16x32_bf16 v[172:175], v[84:87], a[172:175], v[172:175]
  ds_read_b128 a[220:223], v26 offset:62464
  v_mfma_f32_16x16x32_bf16 v[172:175], v[88:91], a[188:191], v[172:175]
  s_waitcnt lgkmcnt(14)
  v_mfma_f32_16x16x32_bf16 v[176:179], v[56:59], a[144:147], v[176:179]
  ds_read_b64_tr_b16 v[80:81], v13 offset:16384
  s_add_u32 m0, s33, 110592
  v_mfma_f32_16x16x32_bf16 v[176:179], v[60:63], a[160:163], v[176:179]
  ds_read_b64_tr_b16 v[82:83], v13 offset:18432
  s_mov_b32 s34, 128
  v_mfma_f32_16x16x32_bf16 v[176:179], v[64:67], a[176:179], v[176:179]
  ds_read_b64_tr_b16 v[84:85], v13 offset:20480
  buffer_load_dwordx4 v19, s[8:11], s34 offen lds
  v_mfma_f32_16x16x32_bf16 v[180:183], v[56:59], a[148:151], v[180:183]
  ds_read_b64_tr_b16 v[86:87], v13 offset:22528
  s_add_u32 m0, s33, 24576
  v_mfma_f32_16x16x32_bf16 v[180:183], v[60:63], a[164:167], v[180:183]
  ds_read_b64_tr_b16 v[88:89], v12
  s_mov_b32 s34, 295040
  v_mfma_f32_16x16x32_bf16 v[180:183], v[64:67], a[180:183], v[180:183]
  ds_read_b64_tr_b16 v[90:91], v12 offset:2048
  buffer_load_dwordx4 v19, s[8:11], s34 offen lds
  v_mfma_f32_16x16x32_bf16 v[184:187], v[56:59], a[152:155], v[184:187]
  ds_read_b128 a[224:227], v28 offset:8192
  s_add_u32 m0, s33, 28672
  v_mfma_f32_16x16x32_bf16 v[184:187], v[60:63], a[168:171], v[184:187]
  ds_read_b128 a[228:231], v28 offset:9216
  s_mov_b32 s34, 589952
  v_mfma_f32_16x16x32_bf16 v[184:187], v[64:67], a[184:187], v[184:187]
  ds_read_b128 a[232:235], v28 offset:12288
  buffer_load_dwordx4 v19, s[8:11], s34 offen lds
  v_mfma_f32_16x16x32_bf16 v[188:191], v[56:59], a[156:159], v[188:191]
  ds_read_b128 a[236:239], v28 offset:13312
  v_mfma_f32_16x16x32_bf16 v[188:191], v[60:63], a[172:175], v[188:191]
  v_mfma_f32_16x16x32_bf16 v[188:191], v[64:67], a[188:191], v[188:191]
  s_waitcnt lgkmcnt(14)
  v_mfma_f32_16x16x32_bf16 v[128:131], v[68:71], a[192:195], v[128:131]
  s_waitcnt vmcnt(16)
  s_barrier
  s_waitcnt lgkmcnt(13)
  v_mfma_f32_16x16x32_bf16 v[128:131], v[72:75], a[208:211], v[128:131]
  ds_read_b64_tr_b16 v[56:57], v9 offset:4096
  s_waitcnt lgkmcnt(4)
  v_mfma_f32_16x16x32_bf16 v[128:131], v[76:79], a[224:227], v[128:131]
  ds_read_b64_tr_b16 v[58:59], v9 offset:6144
  v_mfma_f32_16x16x32_bf16 v[132:135], v[68:71], a[196:199], v[132:135]
  ds_read_b64_tr_b16 v[60:61], v9 offset:8192
  v_mfma_f32_16x16x32_bf16 v[132:135], v[72:75], a[212:215], v[132:135]
  ds_read_b64_tr_b16 v[62:63], v9 offset:10240
  s_waitcnt lgkmcnt(6)
  v_mfma_f32_16x16x32_bf16 v[132:135], v[76:79], a[228:231], v[132:135]
  ds_read_b64_tr_b16 v[64:65], v10 offset:24576
  v_mfma_f32_16x16x32_bf16 v[136:139], v[68:71], a[200:203], v[136:139]
  ds_read_b64_tr_b16 v[66:67], v10 offset:26624
  v_mfma_f32_16x16x32_bf16 v[136:139], v[72:75], a[216:219], v[136:139]
  s_waitcnt lgkmcnt(7)
  v_mfma_f32_16x16x32_bf16 v[136:139], v[76:79], a[232:235], v[136:139]
  v_mfma_f32_16x16x32_bf16 v[140:143], v[68:71], a[204:207], v[140:143]
  v_mfma_f32_16x16x32_bf16 v[140:143], v[72:75], a[220:223], v[140:143]
  s_waitcnt lgkmcnt(6)
  v_mfma_f32_16x16x32_bf16 v[140:143], v[76:79], a[236:239], v[140:143]
  v_mfma_f32_16x16x32_bf16 v[144:147], v[80:83], a[192:195], v[144:147]
  ds_read_b64_tr_b16 v[68:69], v12 offset:4096
  s_add_u32 m0, s33, 32768
  v_mfma_f32_16x16x32_bf16 v[144:147], v[84:87], a[208:211], v[144:147]
  ds_read_b64_tr_b16 v[70:71], v12 offset:6144
  s_mov_b32 s34, 884864
  v_mfma_f32_16x16x32_bf16 v[144:147], v[88:91], a[224:227], v[144:147]
  ds_read_b64_tr_b16 v[72:73], v12 offset:8192
  buffer_load_dwordx4 v19, s[4:7], s34 offen lds
  v_mfma_f32_16x16x32_bf16 v[148:151], v[80:83], a[196:199], v[148:151]
  ds_read_b64_tr_b16 v[74:75], v12 offset:10240
  s_add_u32 m0, s33, 36864
  v_mfma_f32_16x16x32_bf16 v[148:151], v[84:87], a[212:215], v[148:151]
  ds_read_b64_tr_b16 v[76:77], v13 offset:24576
  s_mov_b32 s34, 1179776
  v_mfma_f32_16x16x32_bf16 v[148:151], v[88:91], a[228:231], v[148:151]
  ds_read_b64_tr_b16 v[78:79], v13 offset:26624
  buffer_load_dwordx4 v19, s[4:7], s34 offen lds
  v_mfma_f32_16x16x32_bf16 v[152:155], v[80:83], a[200:203], v[152:155]
  ds_read_b128 a[240:243], v28 offset:28672
  s_add_u32 m0, s33, 114688
  v_mfma_f32_16x16x32_bf16 v[152:155], v[84:87], a[216:219], v[152:155]
  ds_read_b128 a[244:247], v28 offset:29696
  s_mov_b32 s34, 1474688
  v_mfma_f32_16x16x32_bf16 v[152:155], v[88:91], a[232:235], v[152:155]
  ds_read_b128 a[248:251], v27 offset:12288
  buffer_load_dwordx4 v19, s[4:7], s34 offen lds
  v_mfma_f32_16x16x32_bf16 v[156:159], v[80:83], a[204:207], v[156:159]
  ds_read_b128 a[252:255], v27 offset:13312
  v_mfma_f32_16x16x32_bf16 v[156:159], v[84:87], a[220:223], v[156:159]
  v_mfma_f32_16x16x32_bf16 v[156:159], v[88:91], a[236:239], v[156:159]
  s_waitcnt lgkmcnt(10)
  v_mfma_f32_16x16x32_bf16 v[160:163], v[56:59], a[192:195], v[160:163]
  s_waitcnt vmcnt(12)
  s_barrier
  v_mfma_f32_16x16x32_bf16 v[160:163], v[60:63], a[208:211], v[160:163]
  ds_read_b64_tr_b16 v[80:81], v8 offset:8192
  v_mfma_f32_16x16x32_bf16 v[160:163], v[64:67], a[224:227], v[160:163]
  ds_read_b64_tr_b16 v[82:83], v8 offset:10240
  v_mfma_f32_16x16x32_bf16 v[164:167], v[56:59], a[196:199], v[164:167]
  ds_read_b64_tr_b16 v[84:85], v8 offset:12288
  v_mfma_f32_16x16x32_bf16 v[164:167], v[60:63], a[212:215], v[164:167]
  ds_read_b64_tr_b16 v[86:87], v8 offset:14336
  v_mfma_f32_16x16x32_bf16 v[164:167], v[64:67], a[228:231], v[164:167]
  ds_read_b64_tr_b16 v[88:89], v9 offset:24576
  v_mfma_f32_16x16x32_bf16 v[168:171], v[56:59], a[200:203], v[168:171]
  ds_read_b64_tr_b16 v[90:91], v9 offset:26624
  v_mfma_f32_16x16x32_bf16 v[168:171], v[60:63], a[216:219], v[168:171]
  ds_read_b128 v[96:99], v27 offset:16384
  v_mfma_f32_16x16x32_bf16 v[168:171], v[64:67], a[232:235], v[168:171]
  ds_read_b128 v[100:103], v27 offset:17408
  v_mfma_f32_16x16x32_bf16 v[172:175], v[56:59], a[204:207], v[172:175]
  ds_read_b128 v[104:107], v27 offset:20480
  v_mfma_f32_16x16x32_bf16 v[172:175], v[60:63], a[220:223], v[172:175]
  ds_read_b128 v[108:111], v27 offset:21504
  v_mfma_f32_16x16x32_bf16 v[172:175], v[64:67], a[236:239], v[172:175]
  s_waitcnt lgkmcnt(14)
  v_mfma_f32_16x16x32_bf16 v[176:179], v[68:71], a[192:195], v[176:179]
  ds_read_b64_tr_b16 v[56:57], v11 offset:8192
  s_add_u32 m0, s33, 118784
  v_mfma_f32_16x16x32_bf16 v[176:179], v[72:75], a[208:211], v[176:179]
  ds_read_b64_tr_b16 v[58:59], v11 offset:10240
  s_mov_b32 s34, 884864
  v_mfma_f32_16x16x32_bf16 v[176:179], v[76:79], a[224:227], v[176:179]
  ds_read_b64_tr_b16 v[60:61], v11 offset:12288
  buffer_load_dwordx4 v19, s[8:11], s34 offen lds
  v_mfma_f32_16x16x32_bf16 v[180:183], v[68:71], a[196:199], v[180:183]
  ds_read_b64_tr_b16 v[62:63], v11 offset:14336
  s_add_u32 m0, s33, 122880
  v_mfma_f32_16x16x32_bf16 v[180:183], v[72:75], a[212:215], v[180:183]
  ds_read_b64_tr_b16 v[64:65], v12 offset:24576
  s_mov_b32 s34, 1179776
  v_mfma_f32_16x16x32_bf16 v[180:183], v[76:79], a[228:231], v[180:183]
  ds_read_b64_tr_b16 v[66:67], v12 offset:26624
  buffer_load_dwordx4 v19, s[8:11], s34 offen lds
  v_mfma_f32_16x16x32_bf16 v[184:187], v[68:71], a[200:203], v[184:187]
  ds_read_b128 v[112:115], v26
  s_add_u32 m0, s33, 135168
  v_mfma_f32_16x16x32_bf16 v[184:187], v[72:75], a[216:219], v[184:187]
  ds_read_b128 v[116:119], v26 offset:1024
  s_mov_b32 s34, 1474688
  v_mfma_f32_16x16x32_bf16 v[184:187], v[76:79], a[232:235], v[184:187]
  ds_read_b128 v[120:123], v26 offset:4096
  buffer_load_dwordx4 v19, s[8:11], s34 offen lds
  v_mfma_f32_16x16x32_bf16 v[188:191], v[68:71], a[204:207], v[188:191]
  ds_read_b128 v[124:127], v26 offset:5120
  v_mfma_f32_16x16x32_bf16 v[188:191], v[72:75], a[220:223], v[188:191]
  v_mfma_f32_16x16x32_bf16 v[188:191], v[76:79], a[236:239], v[188:191]
  s_waitcnt lgkmcnt(14)
  v_mfma_f32_16x16x32_bf16 v[128:131], v[80:83], a[240:243], v[128:131]
  s_waitcnt vmcnt(12)
  s_barrier
  s_waitcnt lgkmcnt(13)
  v_mfma_f32_16x16x32_bf16 v[128:131], v[84:87], v[96:99], v[128:131]
  ds_read_b64_tr_b16 v[68:69], v9 offset:28672
  s_waitcnt lgkmcnt(4)
  v_mfma_f32_16x16x32_bf16 v[128:131], v[88:91], v[112:115], v[128:131]
  ds_read_b64_tr_b16 v[70:71], v9 offset:30720
  v_mfma_f32_16x16x32_bf16 v[132:135], v[80:83], a[244:247], v[132:135]
  ds_read_b64_tr_b16 v[72:73], v9 offset:32768
  v_mfma_f32_16x16x32_bf16 v[132:135], v[84:87], v[100:103], v[132:135]
  ds_read_b64_tr_b16 v[74:75], v9 offset:34816
  s_waitcnt lgkmcnt(6)
  v_mfma_f32_16x16x32_bf16 v[132:135], v[88:91], v[116:119], v[132:135]
  ds_read_b64_tr_b16 v[76:77], v8 offset:16384
  v_mfma_f32_16x16x32_bf16 v[136:139], v[80:83], a[248:251], v[136:139]
  ds_read_b64_tr_b16 v[78:79], v8 offset:18432
  v_mfma_f32_16x16x32_bf16 v[136:139], v[84:87], v[104:107], v[136:139]
  s_waitcnt lgkmcnt(7)
  v_mfma_f32_16x16x32_bf16 v[136:139], v[88:91], v[120:123], v[136:139]
  v_mfma_f32_16x16x32_bf16 v[140:143], v[80:83], a[252:255], v[140:143]
  v_mfma_f32_16x16x32_bf16 v[140:143], v[84:87], v[108:111], v[140:143]
  s_waitcnt lgkmcnt(6)
  v_mfma_f32_16x16x32_bf16 v[140:143], v[88:91], v[124:127], v[140:143]
  v_mfma_f32_16x16x32_bf16 v[144:147], v[56:59], a[240:243], v[144:147]
  ds_read_b64_tr_b16 v[80:81], v12 offset:28672
  s_add_u32 m0, s33, 40960
  v_mfma_f32_16x16x32_bf16 v[144:147], v[60:63], v[96:99], v[144:147]
  ds_read_b64_tr_b16 v[82:83], v12 offset:30720
  s_mov_b32 s34, 1769600
  v_mfma_f32_16x16x32_bf16 v[144:147], v[64:67], v[112:115], v[144:147]
  ds_read_b64_tr_b16 v[84:85], v12 offset:32768
  buffer_load_dwordx4 v19, s[4:7], s34 offen lds
  v_mfma_f32_16x16x32_bf16 v[148:151], v[56:59], a[244:247], v[148:151]
  ds_read_b64_tr_b16 v[86:87], v12 offset:34816
  s_add_u32 m0, s33, 45056
  v_mfma_f32_16x16x32_bf16 v[148:151], v[60:63], v[100:103], v[148:151]
  ds_read_b64_tr_b16 v[88:89], v11 offset:16384
  s_mov_b32 s34, 2064512
  v_mfma_f32_16x16x32_bf16 v[148:151], v[64:67], v[116:119], v[148:151]
  ds_read_b64_tr_b16 v[90:91], v11 offset:18432
  buffer_load_dwordx4 v19, s[4:7], s34 offen lds
  v_mfma_f32_16x16x32_bf16 v[152:155], v[56:59], a[248:251], v[152:155]
  s_add_u32 m0, s33, 49152
  v_lshrrev_b32 v4, 1, v0
  v_mfma_f32_16x16x32_bf16 v[152:155], v[60:63], v[104:107], v[152:155]
  s_mov_b32 s34, 2359424
  s_mul_i32 s36, s93, 36
  v_mfma_f32_16x16x32_bf16 v[152:155], v[64:67], v[120:123], v[152:155]
  buffer_load_dwordx4 v19, s[4:7], s34 offen lds
  v_add_u32 v4, s36, v4
  v_mfma_f32_16x16x32_bf16 v[156:159], v[56:59], a[252:255], v[156:159]
  v_mul_u32_u24 v4, 9216, v4
  s_mul_i32 s36, s94, 576
  v_mfma_f32_16x16x32_bf16 v[156:159], v[60:63], v[108:111], v[156:159]
  s_and_b32 s37, s94, 1
  s_lshl_b32 s38, s37, 6
  v_mfma_f32_16x16x32_bf16 v[156:159], v[64:67], v[124:127], v[156:159]
  s_add_u32 s36, s36, s38
  s_waitcnt lgkmcnt(6)
  v_mfma_f32_16x16x32_bf16 v[160:163], v[68:71], a[240:243], v[160:163]
  s_waitcnt vmcnt(12)
  s_barrier
  v_mfma_f32_16x16x32_bf16 v[160:163], v[72:75], v[96:99], v[160:163]
  ds_read_b64_tr_b16 v[56:57], v8 offset:20480
  s_add_u32 s36, s36, 384
  v_mfma_f32_16x16x32_bf16 v[160:163], v[76:79], v[112:115], v[160:163]
  ds_read_b64_tr_b16 v[58:59], v8 offset:22528
  s_cmp_eq_u32 s37, 0
  s_cselect_b32 s37, 2, -7
  v_mfma_f32_16x16x32_bf16 v[164:167], v[68:71], a[244:247], v[164:167]
  ds_read_b64_tr_b16 v[60:61], v9 offset:36864
  s_mul_i32 s37, s37, 64
  v_mfma_f32_16x16x32_bf16 v[164:167], v[72:75], v[100:103], v[164:167]
  ds_read_b64_tr_b16 v[62:63], v9 offset:38912
  v_and_b32 v5, 1, v0
  v_mfma_f32_16x16x32_bf16 v[164:167], v[76:79], v[116:119], v[164:167]
  ds_read_b64_tr_b16 v[64:65], v9 offset:40960
  v_mul_lo_u32 v5, v5, s37
  v_mfma_f32_16x16x32_bf16 v[168:171], v[68:71], a[248:251], v[168:171]
  ds_read_b64_tr_b16 v[66:67], v9 offset:43008
  v_add3_u32 v4, v4, v5, s36
  v_mfma_f32_16x16x32_bf16 v[168:171], v[72:75], v[104:107], v[168:171]
  v_mov_b32 v6, 0x7ffffff0
  v_cmp_gt_u32 vcc, 72, v0
  v_mfma_f32_16x16x32_bf16 v[168:171], v[76:79], v[120:123], v[168:171]
  s_nop 0
  v_cndmask_b32 v92, v6, v4, vcc
  s_lshl_b32 s36, s94, 4
  v_mfma_f32_16x16x32_bf16 v[172:175], v[68:71], a[252:255], v[172:175]
  s_add_u32 s36, s36, s93
  s_mul_i32 s36, s36, 20736
  v_mfma_f32_16x16x32_bf16 v[172:175], v[72:75], v[108:111], v[172:175]
  v_lshl_add_u32 v4, v0, 7, s36
  v_cmp_gt_u32 vcc, 162, v0
  v_mfma_f32_16x16x32_bf16 v[172:175], v[76:79], v[124:127], v[172:175]
  s_nop 0
  v_cndmask_b32 v93, v6, v4, vcc
  s_waitcnt lgkmcnt(6)
  v_mfma_f32_16x16x32_bf16 v[176:179], v[80:83], a[240:243], v[176:179]
  ds_read_b64_tr_b16 v[68:69], v11 offset:20480
  s_add_u32 m0, s33, 53248
  v_mfma_f32_16x16x32_bf16 v[176:179], v[84:87], v[96:99], v[176:179]
  ds_read_b64_tr_b16 v[70:71], v11 offset:22528
  s_mov_b32 s34, 1769600
  v_mfma_f32_16x16x32_bf16 v[176:179], v[88:91], v[112:115], v[176:179]
  ds_read_b64_tr_b16 v[72:73], v12 offset:36864
  buffer_load_dwordx4 v19, s[8:11], s34 offen lds
  v_mfma_f32_16x16x32_bf16 v[180:183], v[80:83], a[244:247], v[180:183]
  ds_read_b64_tr_b16 v[74:75], v12 offset:38912
  s_add_u32 m0, s33, 57344
  v_mfma_f32_16x16x32_bf16 v[180:183], v[84:87], v[100:103], v[180:183]
  ds_read_b64_tr_b16 v[76:77], v12 offset:40960
  s_mov_b32 s34, 2064512
  v_mfma_f32_16x16x32_bf16 v[180:183], v[88:91], v[116:119], v[180:183]
  ds_read_b64_tr_b16 v[78:79], v12 offset:43008
  buffer_load_dwordx4 v19, s[8:11], s34 offen lds
  v_mfma_f32_16x16x32_bf16 v[184:187], v[80:83], a[248:251], v[184:187]
  s_add_u32 m0, s33, 61440
  s_cmp_eq_u32 s95, 0
  s_cselect_b32 s36, 0, 0x7ffffff0
  v_mfma_f32_16x16x32_bf16 v[184:187], v[84:87], v[104:107], v[184:187]
  s_mov_b32 s34, 2359424
  v_or_b32 v92, s36, v92
  v_mfma_f32_16x16x32_bf16 v[184:187], v[88:91], v[120:123], v[184:187]
  buffer_load_dwordx4 v19, s[8:11], s34 offen lds
  v_or_b32 v93, s36, v93
  v_mfma_f32_16x16x32_bf16 v[188:191], v[80:83], a[252:255], v[188:191]
  v_mfma_f32_16x16x32_bf16 v[188:191], v[84:87], v[108:111], v[188:191]
  v_mfma_f32_16x16x32_bf16 v[188:191], v[88:91], v[124:127], v[188:191]
  s_waitcnt lgkmcnt(6)
  v_mfma_f32_16x16x32_bf16 v[192:195], v[56:59], a[0:3], 0
  s_waitcnt vmcnt(9)
  s_barrier
  v_mfma_f32_16x16x32_bf16 v[192:195], v[60:63], a[16:19], v[192:195]
  ds_read_b64_tr_b16 v[80:81], v9 offset:45056
  v_mul_f32 v128, v128, v160
  v_mfma_f32_16x16x32_bf16 v[192:195], v[64:67], a[32:35], v[192:195]
  ds_read_b64_tr_b16 v[82:83], v9 offset:47104
  v_mul_f32 v129, v129, v161
  v_mfma_f32_16x16x32_bf16 v[196:199], v[56:59], a[4:7], 0
  ds_read_b64_tr_b16 v[84:85], v8 offset:24576
  v_mul_f32 v130, v130, v162
  v_mfma_f32_16x16x32_bf16 v[196:199], v[60:63], a[20:23], v[196:199]
  ds_read_b64_tr_b16 v[86:87], v8 offset:26624
  v_mul_f32 v131, v131, v163
  v_mfma_f32_16x16x32_bf16 v[196:199], v[64:67], a[36:39], v[196:199]
  ds_read_b64_tr_b16 v[88:89], v8 offset:28672
  v_cvt_pk_bf16_f32 v32, v128, v129
  v_mfma_f32_16x16x32_bf16 v[200:203], v[56:59], a[8:11], 0
  ds_read_b64_tr_b16 v[90:91], v8 offset:30720
  v_cvt_pk_bf16_f32 v33, v130, v131
  v_mfma_f32_16x16x32_bf16 v[200:203], v[60:63], a[24:27], v[200:203]
  s_add_u32 m0, s33, 139264
  v_mul_f32 v144, v144, v176
  v_mfma_f32_16x16x32_bf16 v[200:203], v[64:67], a[40:43], v[200:203]
  s_mov_b32 s34, 2654336
  v_mul_f32 v145, v145, v177
  v_mfma_f32_16x16x32_bf16 v[204:207], v[56:59], a[12:15], 0
  buffer_load_dwordx4 v19, s[4:7], s34 offen lds
  v_mul_f32 v146, v146, v178
  v_mfma_f32_16x16x32_bf16 v[204:207], v[60:63], a[28:31], v[204:207]
  s_add_u32 m0, s33, 143360
  v_mul_f32 v147, v147, v179
  v_mfma_f32_16x16x32_bf16 v[204:207], v[64:67], a[44:47], v[204:207]
  s_mov_b32 s34, 2949248
  buffer_load_dwordx4 v19, s[4:7], s34 offen lds
  s_waitcnt lgkmcnt(6)
  v_mfma_f32_16x16x32_bf16 v[208:211], v[68:71], a[0:3], 0
  ds_read_b64_tr_b16 v[56:57], v12 offset:45056
  v_cvt_pk_bf16_f32 v34, v144, v145
  v_mfma_f32_16x16x32_bf16 v[208:211], v[72:75], a[16:19], v[208:211]
  ds_read_b64_tr_b16 v[58:59], v12 offset:47104
  v_cvt_pk_bf16_f32 v35, v146, v147
  v_mfma_f32_16x16x32_bf16 v[208:211], v[76:79], a[32:35], v[208:211]
  ds_read_b64_tr_b16 v[60:61], v11 offset:24576
  ds_write_b128 v17, v[32:35]
  v_mfma_f32_16x16x32_bf16 v[212:215], v[68:71], a[4:7], 0
  ds_read_b64_tr_b16 v[62:63], v11 offset:26624
  v_mul_f32 v132, v132, v164
  v_mfma_f32_16x16x32_bf16 v[212:215], v[72:75], a[20:23], v[212:215]
  ds_read_b64_tr_b16 v[64:65], v11 offset:28672
  v_mul_f32 v133, v133, v165
  v_mfma_f32_16x16x32_bf16 v[212:215], v[76:79], a[36:39], v[212:215]
  ds_read_b64_tr_b16 v[66:67], v11 offset:30720
  v_mul_f32 v134, v134, v166
  v_mfma_f32_16x16x32_bf16 v[216:219], v[68:71], a[8:11], 0
  s_add_u32 m0, s33, 147456
  v_mul_f32 v135, v135, v167
  v_mfma_f32_16x16x32_bf16 v[216:219], v[72:75], a[24:27], v[216:219]
  s_mov_b32 s34, 3244160
  v_cvt_pk_bf16_f32 v36, v132, v133
  v_mfma_f32_16x16x32_bf16 v[216:219], v[76:79], a[40:43], v[216:219]
  buffer_load_dwordx4 v19, s[4:7], s34 offen lds
  v_cvt_pk_bf16_f32 v37, v134, v135
  v_mfma_f32_16x16x32_bf16 v[220:223], v[68:71], a[12:15], 0
  s_add_u32 m0, s33, 151552
  v_mul_f32 v148, v148, v180
  v_mfma_f32_16x16x32_bf16 v[220:223], v[72:75], a[28:31], v[220:223]
  s_mov_b32 s34, 2654336
  v_mul_f32 v149, v149, v181
  v_mfma_f32_16x16x32_bf16 v[220:223], v[76:79], a[44:47], v[220:223]
  buffer_load_dwordx4 v19, s[8:11], s34 offen lds
  s_waitcnt lgkmcnt(7)
  v_mfma_f32_16x16x32_bf16 v[224:227], v[80:83], a[0:3], 0
  ds_read_b64_tr_b16 v[68:69], v8 offset:32768
  v_mul_f32 v150, v150, v182
  v_mfma_f32_16x16x32_bf16 v[224:227], v[84:87], a[16:19], v[224:227]
  ds_read_b64_tr_b16 v[70:71], v8 offset:34816
  v_mul_f32 v151, v151, v183
  v_mfma_f32_16x16x32_bf16 v[224:227], v[88:91], a[32:35], v[224:227]
  ds_read_b64_tr_b16 v[72:73], v8 offset:36864
  v_cvt_pk_bf16_f32 v38, v148, v149
  v_mfma_f32_16x16x32_bf16 v[228:231], v[80:83], a[4:7], 0
  ds_read_b64_tr_b16 v[74:75], v8 offset:38912
  v_cvt_pk_bf16_f32 v39, v150, v151
  v_mfma_f32_16x16x32_bf16 v[228:231], v[84:87], a[20:23], v[228:231]
  ds_read_b64_tr_b16 v[76:77], v9 offset:49152
  ds_write_b128 v17, v[36:39] offset:1024
  v_mfma_f32_16x16x32_bf16 v[228:231], v[88:91], a[36:39], v[228:231]
  ds_read_b64_tr_b16 v[78:79], v9 offset:51200
  v_mul_f32 v136, v136, v168
  v_mfma_f32_16x16x32_bf16 v[232:235], v[80:83], a[8:11], 0
  s_add_u32 m0, s33, 65536
  v_mul_f32 v137, v137, v169
  v_mfma_f32_16x16x32_bf16 v[232:235], v[84:87], a[24:27], v[232:235]
  s_mov_b32 s34, 2949248
  v_mul_f32 v138, v138, v170
  v_mfma_f32_16x16x32_bf16 v[232:235], v[88:91], a[40:43], v[232:235]
  buffer_load_dwordx4 v19, s[8:11], s34 offen lds
  v_mul_f32 v139, v139, v171
  v_mfma_f32_16x16x32_bf16 v[236:239], v[80:83], a[12:15], 0
  s_add_u32 m0, s33, 69632
  v_cvt_pk_bf16_f32 v32, v136, v137
  v_mfma_f32_16x16x32_bf16 v[236:239], v[84:87], a[28:31], v[236:239]
  s_mov_b32 s34, 3244160
  v_cvt_pk_bf16_f32 v33, v138, v139
  v_mfma_f32_16x16x32_bf16 v[236:239], v[88:91], a[44:47], v[236:239]
  buffer_load_dwordx4 v19, s[8:11], s34 offen lds
  s_waitcnt lgkmcnt(7)
  v_mfma_f32_16x16x32_bf16 v[240:243], v[56:59], a[0:3], 0
  ds_read_b64_tr_b16 v[80:81], v11 offset:32768
  v_mul_f32 v152, v152, v184
  v_mfma_f32_16x16x32_bf16 v[240:243], v[60:63], a[16:19], v[240:243]
  ds_read_b64_tr_b16 v[82:83], v11 offset:34816
  v_mul_f32 v153, v153, v185
  v_mfma_f32_16x16x32_bf16 v[240:243], v[64:67], a[32:35], v[240:243]
  ds_read_b64_tr_b16 v[84:85], v11 offset:36864
  v_mul_f32 v154, v154, v186
  v_mfma_f32_16x16x32_bf16 v[244:247], v[56:59], a[4:7], 0
  ds_read_b64_tr_b16 v[86:87], v11 offset:38912
  v_mul_f32 v155, v155, v187
  v_mfma_f32_16x16x32_bf16 v[244:247], v[60:63], a[20:23], v[244:247]
  ds_read_b64_tr_b16 v[88:89], v12 offset:49152
  v_cvt_pk_bf16_f32 v34, v152, v153
  v_mfma_f32_16x16x32_bf16 v[244:247], v[64:67], a[36:39], v[244:247]
  ds_read_b64_tr_b16 v[90:91], v12 offset:51200
  v_cvt_pk_bf16_f32 v35, v154, v155
  v_mfma_f32_16x16x32_bf16 v[248:251], v[56:59], a[8:11], 0
  s_add_u32 m0, s33, 73728
  ds_write_b128 v17, v[32:35] offset:2048
  v_mfma_f32_16x16x32_bf16 v[248:251], v[60:63], a[24:27], v[248:251]
  s_mov_b32 s34, 3539072
  v_mul_f32 v140, v140, v172
  v_mfma_f32_16x16x32_bf16 v[248:251], v[64:67], a[40:43], v[248:251]
  buffer_load_dwordx4 v19, s[4:7], s34 offen lds
  v_mul_f32 v141, v141, v173
  v_mfma_f32_16x16x32_bf16 v[252:255], v[56:59], a[12:15], 0
  s_add_u32 m0, s33, 155648
  v_mul_f32 v142, v142, v174
  v_mfma_f32_16x16x32_bf16 v[252:255], v[60:63], a[28:31], v[252:255]
  s_mov_b32 s34, 3833984
  v_mul_f32 v143, v143, v175
  v_mfma_f32_16x16x32_bf16 v[252:255], v[64:67], a[44:47], v[252:255]
  buffer_load_dwordx4 v19, s[4:7], s34 offen lds
  s_waitcnt lgkmcnt(7)
  v_mfma_f32_16x16x32_bf16 v[192:195], v[68:71], a[48:51], v[192:195]
  s_waitcnt vmcnt(11)
  s_barrier
  v_mfma_f32_16x16x32_bf16 v[192:195], v[72:75], a[64:67], v[192:195]
  ds_read_b64_tr_b16 v[56:57], v9 offset:53248
  v_cvt_pk_bf16_f32 v36, v140, v141
  v_mfma_f32_16x16x32_bf16 v[192:195], v[76:79], a[80:83], v[192:195]
  ds_read_b64_tr_b16 v[58:59], v9 offset:55296
  v_cvt_pk_bf16_f32 v37, v142, v143
  v_mfma_f32_16x16x32_bf16 v[196:199], v[68:71], a[52:55], v[196:199]
  ds_read_b64_tr_b16 v[60:61], v9 offset:57344
  v_mul_f32 v156, v156, v188
  v_mfma_f32_16x16x32_bf16 v[196:199], v[72:75], a[68:71], v[196:199]
  ds_read_b64_tr_b16 v[62:63], v9 offset:59392
  v_mul_f32 v157, v157, v189
  v_mfma_f32_16x16x32_bf16 v[196:199], v[76:79], a[84:87], v[196:199]
  ds_read_b64_tr_b16 v[64:65], v10 offset:4096
  v_mul_f32 v158, v158, v190
  v_mfma_f32_16x16x32_bf16 v[200:203], v[68:71], a[56:59], v[200:203]
  ds_read_b64_tr_b16 v[66:67], v10 offset:6144
  v_mul_f32 v159, v159, v191
  v_mfma_f32_16x16x32_bf16 v[200:203], v[72:75], a[72:75], v[200:203]
  s_add_u32 m0, s33, 159744
  v_cvt_pk_bf16_f32 v38, v156, v157
  v_mfma_f32_16x16x32_bf16 v[200:203], v[76:79], a[88:91], v[200:203]
  s_mov_b32 s34, 4128896
  v_cvt_pk_bf16_f32 v39, v158, v159
  v_mfma_f32_16x16x32_bf16 v[204:207], v[68:71], a[60:63], v[204:207]
  buffer_load_dwordx4 v19, s[4:7], s34 offen lds
  ds_write_b128 v17, v[36:39] offset:3072
  v_mfma_f32_16x16x32_bf16 v[204:207], v[72:75], a[76:79], v[204:207]
  s_add_u32 m0, s33, 77824
  v_mfma_f32_16x16x32_bf16 v[204:207], v[76:79], a[92:95], v[204:207]
  s_mov_b32 s34, 3539072
  buffer_load_dwordx4 v19, s[8:11], s34 offen lds
  s_waitcnt lgkmcnt(8)
  v_mfma_f32_16x16x32_bf16 v[208:211], v[80:83], a[48:51], v[208:211]
  ds_read_b64_tr_b16 v[68:69], v12 offset:53248
  v_mfma_f32_16x16x32_bf16 v[208:211], v[84:87], a[64:67], v[208:211]
  ds_read_b64_tr_b16 v[70:71], v12 offset:55296
  v_mfma_f32_16x16x32_bf16 v[208:211], v[88:91], a[80:83], v[208:211]
  ds_read_b64_tr_b16 v[72:73], v12 offset:57344
  v_mfma_f32_16x16x32_bf16 v[212:215], v[80:83], a[52:55], v[212:215]
  ds_read_b64_tr_b16 v[74:75], v12 offset:59392
  v_mfma_f32_16x16x32_bf16 v[212:215], v[84:87], a[68:71], v[212:215]
  ds_read_b64_tr_b16 v[76:77], v13 offset:4096
  v_mfma_f32_16x16x32_bf16 v[212:215], v[88:91], a[84:87], v[212:215]
  ds_read_b64_tr_b16 v[78:79], v13 offset:6144
  v_mfma_f32_16x16x32_bf16 v[216:219], v[80:83], a[56:59], v[216:219]
  s_add_u32 m0, s33, 81920
  v_mfma_f32_16x16x32_bf16 v[216:219], v[84:87], a[72:75], v[216:219]
  s_mov_b32 s34, 3833984
  v_mfma_f32_16x16x32_bf16 v[216:219], v[88:91], a[88:91], v[216:219]
  buffer_load_dwordx4 v19, s[8:11], s34 offen lds
  v_mfma_f32_16x16x32_bf16 v[220:223], v[80:83], a[60:63], v[220:223]
  s_add_u32 m0, s33, 86016
  v_mfma_f32_16x16x32_bf16 v[220:223], v[84:87], a[76:79], v[220:223]
  s_mov_b32 s34, 4128896
  v_mfma_f32_16x16x32_bf16 v[220:223], v[88:91], a[92:95], v[220:223]
  buffer_load_dwordx4 v19, s[8:11], s34 offen lds
  s_waitcnt lgkmcnt(7)
  v_mfma_f32_16x16x32_bf16 v[224:227], v[56:59], a[48:51], v[224:227]
  ds_read_b64_tr_b16 v[80:81], v8 offset:40960
  v_mfma_f32_16x16x32_bf16 v[224:227], v[60:63], a[64:67], v[224:227]
  ds_read_b64_tr_b16 v[82:83], v8 offset:43008
  v_mfma_f32_16x16x32_bf16 v[224:227], v[64:67], a[80:83], v[224:227]
  ds_read_b64_tr_b16 v[84:85], v8 offset:45056
  v_mfma_f32_16x16x32_bf16 v[228:231], v[56:59], a[52:55], v[228:231]
  ds_read_b64_tr_b16 v[86:87], v8 offset:47104
  v_mfma_f32_16x16x32_bf16 v[228:231], v[60:63], a[68:71], v[228:231]
  ds_read_b64_tr_b16 v[88:89], v8 offset:49152
  v_mfma_f32_16x16x32_bf16 v[228:231], v[64:67], a[84:87], v[228:231]
  ds_read_b64_tr_b16 v[90:91], v8 offset:51200
  v_mfma_f32_16x16x32_bf16 v[232:235], v[56:59], a[56:59], v[232:235]
  s_add_u32 m0, s33, 0
  v_mfma_f32_16x16x32_bf16 v[232:235], v[60:63], a[72:75], v[232:235]
  s_mov_b32 s34, 4423808
  v_mfma_f32_16x16x32_bf16 v[232:235], v[64:67], a[88:91], v[232:235]
  buffer_load_dwordx4 v19, s[4:7], s34 offen lds
  v_mfma_f32_16x16x32_bf16 v[236:239], v[56:59], a[60:63], v[236:239]
  s_add_u32 m0, s33, 4096
  v_mfma_f32_16x16x32_bf16 v[236:239], v[60:63], a[76:79], v[236:239]
  s_mov_b32 s34, 4718720
  v_mfma_f32_16x16x32_bf16 v[236:239], v[64:67], a[92:95], v[236:239]
  buffer_load_dwordx4 v19, s[4:7], s34 offen lds
  s_waitcnt lgkmcnt(6)
  v_mfma_f32_16x16x32_bf16 v[240:243], v[68:71], a[48:51], v[240:243]
  ds_read_b64_tr_b16 v[56:57], v11 offset:40960
  v_mfma_f32_16x16x32_bf16 v[240:243], v[72:75], a[64:67], v[240:243]
  ds_read_b64_tr_b16 v[58:59], v11 offset:43008
  v_mfma_f32_16x16x32_bf16 v[240:243], v[76:79], a[80:83], v[240:243]
  ds_read_b64_tr_b16 v[60:61], v11 offset:45056
  v_mfma_f32_16x16x32_bf16 v[244:247], v[68:71], a[52:55], v[244:247]
  ds_read_b64_tr_b16 v[62:63], v11 offset:47104
  v_mfma_f32_16x16x32_bf16 v[244:247], v[72:75], a[68:71], v[244:247]
  ds_read_b64_tr_b16 v[64:65], v11 offset:49152
  v_mfma_f32_16x16x32_bf16 v[244:247], v[76:79], a[84:87], v[244:247]
  ds_read_b64_tr_b16 v[66:67], v11 offset:51200
  v_mfma_f32_16x16x32_bf16 v[248:251], v[68:71], a[56:59], v[248:251]
  s_add_u32 m0, s33, 8192
  v_mfma_f32_16x16x32_bf16 v[248:251], v[72:75], a[72:75], v[248:251]
  s_mov_b32 s34, 5013632
  v_mfma_f32_16x16x32_bf16 v[248:251], v[76:79], a[88:91], v[248:251]
  buffer_load_dwordx4 v19, s[4:7], s34 offen lds
  v_mfma_f32_16x16x32_bf16 v[252:255], v[68:71], a[60:63], v[252:255]
  s_add_u32 m0, s33, 12288
  v_mfma_f32_16x16x32_bf16 v[252:255], v[72:75], a[76:79], v[252:255]
  s_mov_b32 s34, 4423808
  v_mfma_f32_16x16x32_bf16 v[252:255], v[76:79], a[92:95], v[252:255]
  buffer_load_dwordx4 v19, s[8:11], s34 offen lds
  s_waitcnt lgkmcnt(6)
  v_mfma_f32_16x16x32_bf16 v[192:195], v[80:83], a[96:99], v[192:195]
  s_waitcnt vmcnt(13)
  s_barrier
  v_mfma_f32_16x16x32_bf16 v[192:195], v[84:87], a[112:115], v[192:195]
  ds_read_b64_tr_b16 v[68:69], v8 offset:53248
  v_mfma_f32_16x16x32_bf16 v[192:195], v[88:91], a[128:131], v[192:195]
  ds_read_b64_tr_b16 v[70:71], v8 offset:55296
  v_mfma_f32_16x16x32_bf16 v[196:199], v[80:83], a[100:103], v[196:199]
  ds_read_b64_tr_b16 v[72:73], v8 offset:57344
  v_mfma_f32_16x16x32_bf16 v[196:199], v[84:87], a[116:119], v[196:199]
  ds_read_b64_tr_b16 v[74:75], v8 offset:59392
  v_mfma_f32_16x16x32_bf16 v[196:199], v[88:91], a[132:135], v[196:199]
  ds_read_b64_tr_b16 v[76:77], v8 offset:61440
  v_mfma_f32_16x16x32_bf16 v[200:203], v[80:83], a[104:107], v[200:203]
  ds_read_b64_tr_b16 v[78:79], v8 offset:63488
  v_mfma_f32_16x16x32_bf16 v[200:203], v[84:87], a[120:123], v[200:203]
  s_add_u32 m0, s33, 98304
  v_mfma_f32_16x16x32_bf16 v[200:203], v[88:91], a[136:139], v[200:203]
  s_mov_b32 s34, 4718720
  v_mfma_f32_16x16x32_bf16 v[204:207], v[80:83], a[108:111], v[204:207]
  buffer_load_dwordx4 v19, s[8:11], s34 offen lds
  v_mfma_f32_16x16x32_bf16 v[204:207], v[84:87], a[124:127], v[204:207]
  s_add_u32 m0, s33, 16384
  v_mfma_f32_16x16x32_bf16 v[204:207], v[88:91], a[140:143], v[204:207]
  s_mov_b32 s34, 5013632
  buffer_load_dwordx4 v19, s[8:11], s34 offen lds
  s_waitcnt lgkmcnt(6)
  v_mfma_f32_16x16x32_bf16 v[208:211], v[56:59], a[96:99], v[208:211]
  ds_read_b64_tr_b16 v[80:81], v11 offset:53248
  v_mfma_f32_16x16x32_bf16 v[208:211], v[60:63], a[112:115], v[208:211]
  ds_read_b64_tr_b16 v[82:83], v11 offset:55296
  v_mfma_f32_16x16x32_bf16 v[208:211], v[64:67], a[128:131], v[208:211]
  ds_read_b64_tr_b16 v[84:85], v11 offset:57344
  v_mfma_f32_16x16x32_bf16 v[212:215], v[56:59], a[100:103], v[212:215]
  ds_read_b64_tr_b16 v[86:87], v11 offset:59392
  v_mfma_f32_16x16x32_bf16 v[212:215], v[60:63], a[116:119], v[212:215]
  ds_read_b64_tr_b16 v[88:89], v11 offset:61440
  v_mfma_f32_16x16x32_bf16 v[212:215], v[64:67], a[132:135], v[212:215]
  ds_read_b64_tr_b16 v[90:91], v11 offset:63488
  v_mfma_f32_16x16x32_bf16 v[216:219], v[56:59], a[104:107], v[216:219]
  s_add_u32 m0, s33, 20480
  v_mfma_f32_16x16x32_bf16 v[216:219], v[60:63], a[120:123], v[216:219]
  s_mov_b32 s34, 256
  v_mfma_f32_16x16x32_bf16 v[216:219], v[64:67], a[136:139], v[216:219]
  buffer_load_dwordx4 v19, s[4:7], s34 offen lds
  v_mfma_f32_16x16x32_bf16 v[220:223], v[56:59], a[108:111], v[220:223]
  s_add_u32 m0, s33, 106496
  v_mfma_f32_16x16x32_bf16 v[220:223], v[60:63], a[124:127], v[220:223]
  s_mov_b32 s34, 295168
  v_mfma_f32_16x16x32_bf16 v[220:223], v[64:67], a[140:143], v[220:223]
  buffer_load_dwordx4 v19, s[4:7], s34 offen lds
  s_waitcnt lgkmcnt(6)
  v_mfma_f32_16x16x32_bf16 v[224:227], v[68:71], a[96:99], v[224:227]
  ds_read_b64_tr_b16 v[56:57], v10 offset:8192
  buffer_load_dword v94, v92, s[4:7], 0 offen
  v_mfma_f32_16x16x32_bf16 v[224:227], v[72:75], a[112:115], v[224:227]
  ds_read_b64_tr_b16 v[58:59], v10 offset:10240
  buffer_load_dword v95, v92, s[8:11], 0 offen
  v_mfma_f32_16x16x32_bf16 v[224:227], v[76:79], a[128:131], v[224:227]
  ds_read_b64_tr_b16 v[60:61], v10 offset:12288
  v_mfma_f32_16x16x32_bf16 v[228:231], v[68:71], a[100:103], v[228:231]
  ds_read_b64_tr_b16 v[62:63], v10 offset:14336
  v_mfma_f32_16x16x32_bf16 v[228:231], v[72:75], a[116:119], v[228:231]
  ds_read_b64_tr_b16 v[64:65], v10 offset:16384
  v_mfma_f32_16x16x32_bf16 v[228:231], v[76:79], a[132:135], v[228:231]
  ds_read_b64_tr_b16 v[66:67], v10 offset:18432
  v_mfma_f32_16x16x32_bf16 v[232:235], v[68:71], a[104:107], v[232:235]
  s_add_u32 m0, s33, 110592
  v_mfma_f32_16x16x32_bf16 v[232:235], v[72:75], a[120:123], v[232:235]
  s_mov_b32 s34, 590080
  v_mfma_f32_16x16x32_bf16 v[232:235], v[76:79], a[136:139], v[232:235]
  buffer_load_dwordx4 v19, s[4:7], s34 offen lds
  v_mfma_f32_16x16x32_bf16 v[236:239], v[68:71], a[108:111], v[236:239]
  s_add_u32 m0, s33, 24576
  v_mfma_f32_16x16x32_bf16 v[236:239], v[72:75], a[124:127], v[236:239]
  s_mov_b32 s34, 256
  v_mfma_f32_16x16x32_bf16 v[236:239], v[76:79], a[140:143], v[236:239]
  buffer_load_dwordx4 v19, s[8:11], s34 offen lds
  s_waitcnt lgkmcnt(6)
  v_mfma_f32_16x16x32_bf16 v[240:243], v[80:83], a[96:99], v[240:243]
  ds_read_b64_tr_b16 v[68:69], v13 offset:8192
  v_mfma_f32_16x16x32_bf16 v[240:243], v[84:87], a[112:115], v[240:243]
  ds_read_b64_tr_b16 v[70:71], v13 offset:10240
  v_mfma_f32_16x16x32_bf16 v[240:243], v[88:91], a[128:131], v[240:243]
  ds_read_b64_tr_b16 v[72:73], v13 offset:12288
  v_mfma_f32_16x16x32_bf16 v[244:247], v[80:83], a[100:103], v[244:247]
  ds_read_b64_tr_b16 v[74:75], v13 offset:14336
  v_mfma_f32_16x16x32_bf16 v[244:247], v[84:87], a[116:119], v[244:247]
  ds_read_b64_tr_b16 v[76:77], v13 offset:16384
  v_mfma_f32_16x16x32_bf16 v[244:247], v[88:91], a[132:135], v[244:247]
  ds_read_b64_tr_b16 v[78:79], v13 offset:18432
  v_mfma_f32_16x16x32_bf16 v[248:251], v[80:83], a[104:107], v[248:251]
  s_add_u32 m0, s33, 28672
  v_mfma_f32_16x16x32_bf16 v[248:251], v[84:87], a[120:123], v[248:251]
  s_mov_b32 s34, 295168
  v_mfma_f32_16x16x32_bf16 v[248:251], v[88:91], a[136:139], v[248:251]
  buffer_load_dwordx4 v19, s[8:11], s34 offen lds
  v_mfma_f32_16x16x32_bf16 v[252:255], v[80:83], a[108:111], v[252:255]
  s_add_u32 m0, s33, 32768
  v_mfma_f32_16x16x32_bf16 v[252:255], v[84:87], a[124:127], v[252:255]
  s_mov_b32 s34, 590080
  v_mfma_f32_16x16x32_bf16 v[252:255], v[88:91], a[140:143], v[252:255]
  buffer_load_dwordx4 v19, s[8:11], s34 offen lds
  s_waitcnt lgkmcnt(6)
  v_mfma_f32_16x16x32_bf16 v[192:195], v[56:59], a[144:147], v[192:195]
  s_waitcnt vmcnt(17)
  s_barrier
  v_mfma_f32_16x16x32_bf16 v[192:195], v[60:63], a[160:163], v[192:195]
  ds_read_b64_tr_b16 v[80:81], v10 offset:20480
  v_mfma_f32_16x16x32_bf16 v[192:195], v[64:67], a[176:179], v[192:195]
  ds_read_b64_tr_b16 v[82:83], v10 offset:22528
  v_mfma_f32_16x16x32_bf16 v[196:199], v[56:59], a[148:151], v[196:199]
  ds_read_b64_tr_b16 v[84:85], v9
  v_mfma_f32_16x16x32_bf16 v[196:199], v[60:63], a[164:167], v[196:199]
  ds_read_b64_tr_b16 v[86:87], v9 offset:2048
  v_mfma_f32_16x16x32_bf16 v[196:199], v[64:67], a[180:183], v[196:199]
  ds_read_b64_tr_b16 v[88:89], v9 offset:4096
  v_mfma_f32_16x16x32_bf16 v[200:203], v[56:59], a[152:155], v[200:203]
  ds_read_b64_tr_b16 v[90:91], v9 offset:6144
  v_mfma_f32_16x16x32_bf16 v[200:203], v[60:63], a[168:171], v[200:203]
  s_add_u32 m0, s33, 36864
  v_mfma_f32_16x16x32_bf16 v[200:203], v[64:67], a[184:187], v[200:203]
  s_mov_b32 s34, 884992
  v_mfma_f32_16x16x32_bf16 v[204:207], v[56:59], a[156:159], v[204:207]
  buffer_load_dwordx4 v19, s[4:7], s34 offen lds
  v_mfma_f32_16x16x32_bf16 v[204:207], v[60:63], a[172:175], v[204:207]
  s_add_u32 m0, s33, 114688
  v_mfma_f32_16x16x32_bf16 v[204:207], v[64:67], a[188:191], v[204:207]
  s_mov_b32 s34, 1179904
  buffer_load_dwordx4 v19, s[4:7], s34 offen lds
  s_waitcnt lgkmcnt(6)
  v_mfma_f32_16x16x32_bf16 v[208:211], v[68:71], a[144:147], v[208:211]
  ds_read_b64_tr_b16 v[56:57], v13 offset:20480
  v_mfma_f32_16x16x32_bf16 v[208:211], v[72:75], a[160:163], v[208:211]
  ds_read_b64_tr_b16 v[58:59], v13 offset:22528
  v_mfma_f32_16x16x32_bf16 v[208:211], v[76:79], a[176:179], v[208:211]
  ds_read_b64_tr_b16 v[60:61], v12
  v_mfma_f32_16x16x32_bf16 v[212:215], v[68:71], a[148:151], v[212:215]
  ds_read_b64_tr_b16 v[62:63], v12 offset:2048
  v_mfma_f32_16x16x32_bf16 v[212:215], v[72:75], a[164:167], v[212:215]
  ds_read_b64_tr_b16 v[64:65], v12 offset:4096
  v_mfma_f32_16x16x32_bf16 v[212:215], v[76:79], a[180:183], v[212:215]
  ds_read_b64_tr_b16 v[66:67], v12 offset:6144
  v_mfma_f32_16x16x32_bf16 v[216:219], v[68:71], a[152:155], v[216:219]
  s_add_u32 m0, s33, 118784
  v_mfma_f32_16x16x32_bf16 v[216:219], v[72:75], a[168:171], v[216:219]
  s_mov_b32 s34, 1474816
  v_mfma_f32_16x16x32_bf16 v[216:219], v[76:79], a[184:187], v[216:219]
  buffer_load_dwordx4 v19, s[4:7], s34 offen lds
  v_mfma_f32_16x16x32_bf16 v[220:223], v[68:71], a[156:159], v[220:223]
  s_add_u32 m0, s33, 122880
  v_mfma_f32_16x16x32_bf16 v[220:223], v[72:75], a[172:175], v[220:223]
  s_mov_b32 s34, 884992
  v_mfma_f32_16x16x32_bf16 v[220:223], v[76:79], a[188:191], v[220:223]
  buffer_load_dwordx4 v19, s[8:11], s34 offen lds
  s_waitcnt lgkmcnt(6)
  v_mfma_f32_16x16x32_bf16 v[224:227], v[80:83], a[144:147], v[224:227]
  ds_read_b64_tr_b16 v[68:69], v9 offset:8192
  v_mfma_f32_16x16x32_bf16 v[224:227], v[84:87], a[160:163], v[224:227]
  ds_read_b64_tr_b16 v[70:71], v9 offset:10240
  v_mfma_f32_16x16x32_bf16 v[224:227], v[88:91], a[176:179], v[224:227]
  ds_read_b64_tr_b16 v[72:73], v10 offset:24576
  v_mfma_f32_16x16x32_bf16 v[228:231], v[80:83], a[148:151], v[228:231]
  ds_read_b64_tr_b16 v[74:75], v10 offset:26624
  v_mfma_f32_16x16x32_bf16 v[228:231], v[84:87], a[164:167], v[228:231]
  ds_read_b64_tr_b16 v[76:77], v10 offset:28672
  v_mfma_f32_16x16x32_bf16 v[228:231], v[88:91], a[180:183], v[228:231]
  ds_read_b64_tr_b16 v[78:79], v10 offset:30720
  v_mfma_f32_16x16x32_bf16 v[232:235], v[80:83], a[152:155], v[232:235]
  s_add_u32 m0, s33, 40960
  v_mfma_f32_16x16x32_bf16 v[232:235], v[84:87], a[168:171], v[232:235]
  s_mov_b32 s34, 1179904
  v_mfma_f32_16x16x32_bf16 v[232:235], v[88:91], a[184:187], v[232:235]
  buffer_load_dwordx4 v19, s[8:11], s34 offen lds
  v_mfma_f32_16x16x32_bf16 v[236:239], v[80:83], a[156:159], v[236:239]
  s_add_u32 m0, s33, 45056
  v_mfma_f32_16x16x32_bf16 v[236:239], v[84:87], a[172:175], v[236:239]
  s_mov_b32 s34, 1474816
  v_mfma_f32_16x16x32_bf16 v[236:239], v[88:91], a[188:191], v[236:239]
  buffer_load_dwordx4 v19, s[8:11], s34 offen lds
  s_waitcnt lgkmcnt(6)
  v_mfma_f32_16x16x32_bf16 v[240:243], v[56:59], a[144:147], v[240:243]
  ds_read_b64_tr_b16 v[80:81], v12 offset:8192
  v_mfma_f32_16x16x32_bf16 v[240:243], v[60:63], a[160:163], v[240:243]
  ds_read_b64_tr_b16 v[82:83], v12 offset:10240
  v_mfma_f32_16x16x32_bf16 v[240:243], v[64:67], a[176:179], v[240:243]
  ds_read_b64_tr_b16 v[84:85], v13 offset:24576
  v_mfma_f32_16x16x32_bf16 v[244:247], v[56:59], a[148:151], v[244:247]
  ds_read_b64_tr_b16 v[86:87], v13 offset:26624
  v_mfma_f32_16x16x32_bf16 v[244:247], v[60:63], a[164:167], v[244:247]
  ds_read_b64_tr_b16 v[88:89], v13 offset:28672
  v_mfma_f32_16x16x32_bf16 v[244:247], v[64:67], a[180:183], v[244:247]
  ds_read_b64_tr_b16 v[90:91], v13 offset:30720
  v_mfma_f32_16x16x32_bf16 v[248:251], v[56:59], a[152:155], v[248:251]
  s_add_u32 m0, s33, 49152
  v_mfma_f32_16x16x32_bf16 v[248:251], v[60:63], a[168:171], v[248:251]
  s_mov_b32 s34, 1769728
  v_mfma_f32_16x16x32_bf16 v[248:251], v[64:67], a[184:187], v[248:251]
  buffer_load_dwordx4 v19, s[4:7], s34 offen lds
  v_mfma_f32_16x16x32_bf16 v[252:255], v[56:59], a[156:159], v[252:255]
  s_add_u32 m0, s33, 53248
  v_mfma_f32_16x16x32_bf16 v[252:255], v[60:63], a[172:175], v[252:255]
  s_mov_b32 s34, 2064640
  v_mfma_f32_16x16x32_bf16 v[252:255], v[64:67], a[188:191], v[252:255]
  buffer_load_dwordx4 v19, s[4:7], s34 offen lds
  s_waitcnt lgkmcnt(6)
  v_mfma_f32_16x16x32_bf16 v[192:195], v[68:71], a[192:195], v[192:195]
  s_waitcnt vmcnt(19)
  s_barrier
  v_mfma_f32_16x16x32_bf16 v[192:195], v[72:75], a[208:211], v[192:195]
  ds_read_b64_tr_b16 v[56:57], v9 offset:12288
  v_mfma_f32_16x16x32_bf16 v[192:195], v[76:79], a[224:227], v[192:195]
  ds_read_b64_tr_b16 v[58:59], v9 offset:14336
  v_mfma_f32_16x16x32_bf16 v[196:199], v[68:71], a[196:199], v[196:199]
  ds_read_b64_tr_b16 v[60:61], v9 offset:16384
  v_mfma_f32_16x16x32_bf16 v[196:199], v[72:75], a[212:215], v[196:199]
  ds_read_b64_tr_b16 v[62:63], v9 offset:18432
  v_mfma_f32_16x16x32_bf16 v[196:199], v[76:79], a[228:231], v[196:199]
  ds_read_b64_tr_b16 v[64:65], v9 offset:20480
  v_mfma_f32_16x16x32_bf16 v[200:203], v[68:71], a[200:203], v[200:203]
  ds_read_b64_tr_b16 v[66:67], v9 offset:22528
  v_mfma_f32_16x16x32_bf16 v[200:203], v[72:75], a[216:219], v[200:203]
  s_add_u32 m0, s33, 57344
  v_mfma_f32_16x16x32_bf16 v[200:203], v[76:79], a[232:235], v[200:203]
  s_mov_b32 s34, 2359552
  v_mfma_f32_16x16x32_bf16 v[204:207], v[68:71], a[204:207], v[204:207]
  buffer_load_dwordx4 v19, s[4:7], s34 offen lds
  v_mfma_f32_16x16x32_bf16 v[204:207], v[72:75], a[220:223], v[204:207]
  v_mfma_f32_16x16x32_bf16 v[204:207], v[76:79], a[236:239], v[204:207]
  s_waitcnt lgkmcnt(6)
  v_mfma_f32_16x16x32_bf16 v[208:211], v[80:83], a[192:195], v[208:211]
  ds_read_b64_tr_b16 v[68:69], v12 offset:12288
  v_mfma_f32_16x16x32_bf16 v[208:211], v[84:87], a[208:211], v[208:211]
  ds_read_b64_tr_b16 v[70:71], v12 offset:14336
  v_mfma_f32_16x16x32_bf16 v[208:211], v[88:91], a[224:227], v[208:211]
  ds_read_b64_tr_b16 v[72:73], v12 offset:16384
  v_mfma_f32_16x16x32_bf16 v[212:215], v[80:83], a[196:199], v[212:215]
  ds_read_b64_tr_b16 v[74:75], v12 offset:18432
  v_mfma_f32_16x16x32_bf16 v[212:215], v[84:87], a[212:215], v[212:215]
  ds_read_b64_tr_b16 v[76:77], v12 offset:20480
  v_mfma_f32_16x16x32_bf16 v[212:215], v[88:91], a[228:231], v[212:215]
  ds_read_b64_tr_b16 v[78:79], v12 offset:22528
  v_mfma_f32_16x16x32_bf16 v[216:219], v[80:83], a[200:203], v[216:219]
  s_add_u32 m0, s33, 61440
  v_mfma_f32_16x16x32_bf16 v[216:219], v[84:87], a[216:219], v[216:219]
  s_mov_b32 s34, 1769728
  v_mfma_f32_16x16x32_bf16 v[216:219], v[88:91], a[232:235], v[216:219]
  buffer_load_dwordx4 v19, s[8:11], s34 offen lds
  v_mfma_f32_16x16x32_bf16 v[220:223], v[80:83], a[204:207], v[220:223]
  s_add_u32 m0, s33, 143360
  v_mfma_f32_16x16x32_bf16 v[220:223], v[84:87], a[220:223], v[220:223]
  s_mov_b32 s34, 2064640
  v_mfma_f32_16x16x32_bf16 v[220:223], v[88:91], a[236:239], v[220:223]
  buffer_load_dwordx4 v19, s[8:11], s34 offen lds
  s_waitcnt lgkmcnt(6)
  v_mfma_f32_16x16x32_bf16 v[224:227], v[56:59], a[192:195], v[224:227]
  ds_read_b64_tr_b16 v[80:81], v8
  v_mfma_f32_16x16x32_bf16 v[224:227], v[60:63], a[208:211], v[224:227]
  ds_read_b64_tr_b16 v[82:83], v8 offset:2048
  v_mfma_f32_16x16x32_bf16 v[224:227], v[64:67], a[224:227], v[224:227]
  ds_read_b64_tr_b16 v[84:85], v8 offset:4096
  v_mfma_f32_16x16x32_bf16 v[228:231], v[56:59], a[196:199], v[228:231]
  ds_read_b64_tr_b16 v[86:87], v8 offset:6144
  v_mfma_f32_16x16x32_bf16 v[228:231], v[60:63], a[212:215], v[228:231]
  ds_read_b64_tr_b16 v[88:89], v8 offset:8192
  v_mfma_f32_16x16x32_bf16 v[228:231], v[64:67], a[228:231], v[228:231]
  ds_read_b64_tr_b16 v[90:91], v8 offset:10240
  v_mfma_f32_16x16x32_bf16 v[232:235], v[56:59], a[200:203], v[232:235]
  s_add_u32 m0, s33, 147456
  v_mfma_f32_16x16x32_bf16 v[232:235], v[60:63], a[216:219], v[232:235]
  s_mov_b32 s34, 2359552
  v_mfma_f32_16x16x32_bf16 v[232:235], v[64:67], a[232:235], v[232:235]
  buffer_load_dwordx4 v19, s[8:11], s34 offen lds
  v_mfma_f32_16x16x32_bf16 v[236:239], v[56:59], a[204:207], v[236:239]
  v_mfma_f32_16x16x32_bf16 v[236:239], v[60:63], a[220:223], v[236:239]
  v_mfma_f32_16x16x32_bf16 v[236:239], v[64:67], a[236:239], v[236:239]
  s_waitcnt lgkmcnt(6)
  v_mfma_f32_16x16x32_bf16 v[240:243], v[68:71], a[192:195], v[240:243]
  ds_read_b64_tr_b16 v[56:57], v11
  v_mfma_f32_16x16x32_bf16 v[240:243], v[72:75], a[208:211], v[240:243]
  ds_read_b64_tr_b16 v[58:59], v11 offset:2048
  v_mfma_f32_16x16x32_bf16 v[240:243], v[76:79], a[224:227], v[240:243]
  ds_read_b64_tr_b16 v[60:61], v11 offset:4096
  v_mfma_f32_16x16x32_bf16 v[244:247], v[68:71], a[196:199], v[244:247]
  ds_read_b64_tr_b16 v[62:63], v11 offset:6144
  v_mfma_f32_16x16x32_bf16 v[244:247], v[72:75], a[212:215], v[244:247]
  ds_read_b64_tr_b16 v[64:65], v11 offset:8192
  v_mfma_f32_16x16x32_bf16 v[244:247], v[76:79], a[228:231], v[244:247]
  ds_read_b64_tr_b16 v[66:67], v11 offset:10240
  v_mfma_f32_16x16x32_bf16 v[248:251], v[68:71], a[200:203], v[248:251]
  s_add_u32 m0, s33, 151552
  v_mfma_f32_16x16x32_bf16 v[248:251], v[72:75], a[216:219], v[248:251]
  s_mov_b32 s34, 2654464
  v_mfma_f32_16x16x32_bf16 v[248:251], v[76:79], a[232:235], v[248:251]
  buffer_load_dwordx4 v19, s[4:7], s34 offen lds
  v_mfma_f32_16x16x32_bf16 v[252:255], v[68:71], a[204:207], v[252:255]
  s_add_u32 m0, s33, 65536
  v_mfma_f32_16x16x32_bf16 v[252:255], v[72:75], a[220:223], v[252:255]
  s_mov_b32 s34, 2949376
  v_mfma_f32_16x16x32_bf16 v[252:255], v[76:79], a[236:239], v[252:255]
  buffer_load_dwordx4 v19, s[4:7], s34 offen lds
  s_waitcnt lgkmcnt(6)
  v_mfma_f32_16x16x32_bf16 v[192:195], v[80:83], a[240:243], v[192:195]
  s_waitcnt vmcnt(17)
  s_barrier
  v_mfma_f32_16x16x32_bf16 v[192:195], v[84:87], v[96:99], v[192:195]
  ds_read_b64_tr_b16 v[68:69], v8 offset:12288
  v_mfma_f32_16x16x32_bf16 v[192:195], v[88:91], v[112:115], v[192:195]
  ds_read_b64_tr_b16 v[70:71], v8 offset:14336
  v_mfma_f32_16x16x32_bf16 v[196:199], v[80:83], a[244:247], v[196:199]
  ds_read_b64_tr_b16 v[72:73], v9 offset:32768
  v_mfma_f32_16x16x32_bf16 v[196:199], v[84:87], v[100:103], v[196:199]
  ds_read_b64_tr_b16 v[74:75], v9 offset:34816
  v_mfma_f32_16x16x32_bf16 v[196:199], v[88:91], v[116:119], v[196:199]
  ds_read_b64_tr_b16 v[76:77], v8 offset:16384
  v_mfma_f32_16x16x32_bf16 v[200:203], v[80:83], a[248:251], v[200:203]
  ds_read_b64_tr_b16 v[78:79], v8 offset:18432
  v_mfma_f32_16x16x32_bf16 v[200:203], v[84:87], v[104:107], v[200:203]
  s_add_u32 m0, s33, 69632
  v_mfma_f32_16x16x32_bf16 v[200:203], v[88:91], v[120:123], v[200:203]
  s_mov_b32 s34, 3244288
  v_mfma_f32_16x16x32_bf16 v[204:207], v[80:83], a[252:255], v[204:207]
  buffer_load_dwordx4 v19, s[4:7], s34 offen lds
  v_mfma_f32_16x16x32_bf16 v[204:207], v[84:87], v[108:111], v[204:207]
  v_mfma_f32_16x16x32_bf16 v[204:207], v[88:91], v[124:127], v[204:207]
  s_waitcnt lgkmcnt(6)
  v_mfma_f32_16x16x32_bf16 v[208:211], v[56:59], a[240:243], v[208:211]
  ds_read_b64_tr_b16 v[80:81], v11 offset:12288
  v_mfma_f32_16x16x32_bf16 v[208:211], v[60:63], v[96:99], v[208:211]
  ds_read_b64_tr_b16 v[82:83], v11 offset:14336
  v_mfma_f32_16x16x32_bf16 v[208:211], v[64:67], v[112:115], v[208:211]
  ds_read_b64_tr_b16 v[84:85], v12 offset:32768
  v_mfma_f32_16x16x32_bf16 v[212:215], v[56:59], a[244:247], v[212:215]
  ds_read_b64_tr_b16 v[86:87], v12 offset:34816
  v_mfma_f32_16x16x32_bf16 v[212:215], v[60:63], v[100:103], v[212:215]
  ds_read_b64_tr_b16 v[88:89], v11 offset:16384
  v_mfma_f32_16x16x32_bf16 v[212:215], v[64:67], v[116:119], v[212:215]
  ds_read_b64_tr_b16 v[90:91], v11 offset:18432
  v_mfma_f32_16x16x32_bf16 v[216:219], v[56:59], a[248:251], v[216:219]
  s_add_u32 m0, s33, 73728
  v_mfma_f32_16x16x32_bf16 v[216:219], v[60:63], v[104:107], v[216:219]
  s_mov_b32 s34, 2654464
  v_mfma_f32_16x16x32_bf16 v[216:219], v[64:67], v[120:123], v[216:219]
  buffer_load_dwordx4 v19, s[8:11], s34 offen lds
  v_mfma_f32_16x16x32_bf16 v[220:223], v[56:59], a[252:255], v[220:223]
  s_add_u32 m0, s33, 155648
  v_mfma_f32_16x16x32_bf16 v[220:223], v[60:63], v[108:111], v[220:223]
  s_mov_b32 s34, 2949376
  v_mfma_f32_16x16x32_bf16 v[220:223], v[64:67], v[124:127], v[220:223]
  buffer_load_dwordx4 v19, s[8:11], s34 offen lds
  s_waitcnt lgkmcnt(6)
  v_mfma_f32_16x16x32_bf16 v[224:227], v[68:71], a[240:243], v[224:227]
  ds_read_b64_tr_b16 v[56:57], v8 offset:20480
  v_mfma_f32_16x16x32_bf16 v[224:227], v[72:75], v[96:99], v[224:227]
  ds_read_b64_tr_b16 v[58:59], v8 offset:22528
  v_mfma_f32_16x16x32_bf16 v[224:227], v[76:79], v[112:115], v[224:227]
  ds_read_b64_tr_b16 v[60:61], v9 offset:40960
  v_mfma_f32_16x16x32_bf16 v[228:231], v[68:71], a[244:247], v[228:231]
  ds_read_b64_tr_b16 v[62:63], v9 offset:43008
  v_mfma_f32_16x16x32_bf16 v[228:231], v[72:75], v[100:103], v[228:231]
  ds_read_b64_tr_b16 v[64:65], v9 offset:45056
  v_mfma_f32_16x16x32_bf16 v[228:231], v[76:79], v[116:119], v[228:231]
  ds_read_b64_tr_b16 v[66:67], v9 offset:47104
  v_mfma_f32_16x16x32_bf16 v[232:235], v[68:71], a[248:251], v[232:235]
  s_add_u32 m0, s33, 159744
  v_mfma_f32_16x16x32_bf16 v[232:235], v[72:75], v[104:107], v[232:235]
  s_mov_b32 s34, 3244288
  v_mfma_f32_16x16x32_bf16 v[232:235], v[76:79], v[120:123], v[232:235]
  buffer_load_dwordx4 v19, s[8:11], s34 offen lds
  v_mfma_f32_16x16x32_bf16 v[236:239], v[68:71], a[252:255], v[236:239]
  v_mfma_f32_16x16x32_bf16 v[236:239], v[72:75], v[108:111], v[236:239]
  v_mfma_f32_16x16x32_bf16 v[236:239], v[76:79], v[124:127], v[236:239]
  s_waitcnt lgkmcnt(6)
  v_mfma_f32_16x16x32_bf16 v[240:243], v[80:83], a[240:243], v[240:243]
  ds_read_b64_tr_b16 v[68:69], v11 offset:20480
  v_mfma_f32_16x16x32_bf16 v[240:243], v[84:87], v[96:99], v[240:243]
  ds_read_b64_tr_b16 v[70:71], v11 offset:22528
  v_mfma_f32_16x16x32_bf16 v[240:243], v[88:91], v[112:115], v[240:243]
  ds_read_b64_tr_b16 v[72:73], v12 offset:40960
  v_mfma_f32_16x16x32_bf16 v[244:247], v[80:83], a[244:247], v[244:247]
  ds_read_b64_tr_b16 v[74:75], v12 offset:43008
  v_mfma_f32_16x16x32_bf16 v[244:247], v[84:87], v[100:103], v[244:247]
  ds_read_b64_tr_b16 v[76:77], v12 offset:45056
  v_mfma_f32_16x16x32_bf16 v[244:247], v[88:91], v[116:119], v[244:247]
  ds_read_b64_tr_b16 v[78:79], v12 offset:47104
  v_mfma_f32_16x16x32_bf16 v[248:251], v[80:83], a[248:251], v[248:251]
  s_add_u32 m0, s33, 77824
  v_mfma_f32_16x16x32_bf16 v[248:251], v[84:87], v[104:107], v[248:251]
  s_mov_b32 s34, 3539200
  v_mfma_f32_16x16x32_bf16 v[248:251], v[88:91], v[120:123], v[248:251]
  buffer_load_dwordx4 v19, s[4:7], s34 offen lds
  v_mfma_f32_16x16x32_bf16 v[252:255], v[80:83], a[252:255], v[252:255]
  s_add_u32 m0, s33, 81920
  v_mfma_f32_16x16x32_bf16 v[252:255], v[84:87], v[108:111], v[252:255]
  s_mov_b32 s34, 3834112
  v_mfma_f32_16x16x32_bf16 v[252:255], v[88:91], v[124:127], v[252:255]
  buffer_load_dwordx4 v19, s[4:7], s34 offen lds
  s_waitcnt lgkmcnt(6)
  v_mfma_f32_16x16x32_bf16 v[128:131], v[56:59], a[0:3], 0
  s_waitcnt vmcnt(17)
  s_barrier
  v_mfma_f32_16x16x32_bf16 v[128:131], v[60:63], a[16:19], v[128:131]
  ds_read_b64_tr_b16 v[80:81], v8 offset:24576
  v_mul_f32 v192, v192, v224
  v_mfma_f32_16x16x32_bf16 v[128:131], v[64:67], a[32:35], v[128:131]
  ds_read_b64_tr_b16 v[82:83], v8 offset:26624
  v_mul_f32 v193, v193, v225
  v_mfma_f32_16x16x32_bf16 v[132:135], v[56:59], a[4:7], 0
  ds_read_b64_tr_b16 v[84:85], v8 offset:28672
  v_mul_f32 v194, v194, v226
  v_mfma_f32_16x16x32_bf16 v[132:135], v[60:63], a[20:23], v[132:135]
  ds_read_b64_tr_b16 v[86:87], v8 offset:30720
  v_mul_f32 v195, v195, v227
  v_mfma_f32_16x16x32_bf16 v[132:135], v[64:67], a[36:39], v[132:135]
  ds_read_b64_tr_b16 v[88:89], v8 offset:32768
  v_cvt_pk_bf16_f32 v32, v192, v193
  v_mfma_f32_16x16x32_bf16 v[136:139], v[56:59], a[8:11], 0
  ds_read_b64_tr_b16 v[90:91], v8 offset:34816
  v_cvt_pk_bf16_f32 v33, v194, v195
  v_mfma_f32_16x16x32_bf16 v[136:139], v[60:63], a[24:27], v[136:139]
  s_add_u32 m0, s33, 86016
  v_mul_f32 v208, v208, v240
  v_mfma_f32_16x16x32_bf16 v[136:139], v[64:67], a[40:43], v[136:139]
  s_mov_b32 s34, 4129024
  v_mul_f32 v209, v209, v241
  v_mfma_f32_16x16x32_bf16 v[140:143], v[56:59], a[12:15], 0
  buffer_load_dwordx4 v19, s[4:7], s34 offen lds
  v_mul_f32 v210, v210, v242
  v_mfma_f32_16x16x32_bf16 v[140:143], v[60:63], a[28:31], v[140:143]
  v_mul_f32 v211, v211, v243
  v_mfma_f32_16x16x32_bf16 v[140:143], v[64:67], a[44:47], v[140:143]
  v_cvt_pk_bf16_f32 v34, v208, v209
  s_waitcnt lgkmcnt(6)
  v_mfma_f32_16x16x32_bf16 v[144:147], v[68:71], a[0:3], 0
  ds_read_b64_tr_b16 v[56:57], v11 offset:24576
  v_cvt_pk_bf16_f32 v35, v210, v211
  v_mfma_f32_16x16x32_bf16 v[144:147], v[72:75], a[16:19], v[144:147]
  ds_read_b64_tr_b16 v[58:59], v11 offset:26624
  ds_write_b128 v17, v[32:35] offset:8192
  v_mfma_f32_16x16x32_bf16 v[144:147], v[76:79], a[32:35], v[144:147]
  ds_read_b64_tr_b16 v[60:61], v11 offset:28672
  v_mul_f32 v196, v196, v228
  v_mfma_f32_16x16x32_bf16 v[148:151], v[68:71], a[4:7], 0
  ds_read_b64_tr_b16 v[62:63], v11 offset:30720
  v_mul_f32 v197, v197, v229
  v_mfma_f32_16x16x32_bf16 v[148:151], v[72:75], a[20:23], v[148:151]
  ds_read_b64_tr_b16 v[64:65], v11 offset:32768
  v_mul_f32 v198, v198, v230
  v_mfma_f32_16x16x32_bf16 v[148:151], v[76:79], a[36:39], v[148:151]
  ds_read_b64_tr_b16 v[66:67], v11 offset:34816
  v_mul_f32 v199, v199, v231
  v_mfma_f32_16x16x32_bf16 v[152:155], v[68:71], a[8:11], 0
  s_add_u32 m0, s33, 0
  v_cvt_pk_bf16_f32 v36, v196, v197
  v_mfma_f32_16x16x32_bf16 v[152:155], v[72:75], a[24:27], v[152:155]
  s_mov_b32 s34, 3539200
  v_cvt_pk_bf16_f32 v37, v198, v199
  v_mfma_f32_16x16x32_bf16 v[152:155], v[76:79], a[40:43], v[152:155]
  buffer_load_dwordx4 v19, s[8:11], s34 offen lds
  v_mul_f32 v212, v212, v244
  v_mfma_f32_16x16x32_bf16 v[156:159], v[68:71], a[12:15], 0
  s_add_u32 m0, s33, 4096
  v_mul_f32 v213, v213, v245
  v_mfma_f32_16x16x32_bf16 v[156:159], v[72:75], a[28:31], v[156:159]
  s_mov_b32 s34, 3834112
  v_mul_f32 v214, v214, v246
  v_mfma_f32_16x16x32_bf16 v[156:159], v[76:79], a[44:47], v[156:159]
  buffer_load_dwordx4 v19, s[8:11], s34 offen lds
  s_waitcnt lgkmcnt(7)
  v_mfma_f32_16x16x32_bf16 v[160:163], v[80:83], a[0:3], 0
  ds_read_b64_tr_b16 v[68:69], v8 offset:36864
  v_mul_f32 v215, v215, v247
  v_mfma_f32_16x16x32_bf16 v[160:163], v[84:87], a[16:19], v[160:163]
  ds_read_b64_tr_b16 v[70:71], v8 offset:38912
  v_cvt_pk_bf16_f32 v38, v212, v213
  v_mfma_f32_16x16x32_bf16 v[160:163], v[88:91], a[32:35], v[160:163]
  ds_read_b64_tr_b16 v[72:73], v9 offset:49152
  v_cvt_pk_bf16_f32 v39, v214, v215
  v_mfma_f32_16x16x32_bf16 v[164:167], v[80:83], a[4:7], 0
  ds_read_b64_tr_b16 v[74:75], v9 offset:51200
  ds_write_b128 v17, v[36:39] offset:9216
  v_mfma_f32_16x16x32_bf16 v[164:167], v[84:87], a[20:23], v[164:167]
  ds_read_b64_tr_b16 v[76:77], v9 offset:53248
  v_mul_f32 v200, v200, v232
  v_mfma_f32_16x16x32_bf16 v[164:167], v[88:91], a[36:39], v[164:167]
  ds_read_b64_tr_b16 v[78:79], v9 offset:55296
  v_mul_f32 v201, v201, v233
  v_mfma_f32_16x16x32_bf16 v[168:171], v[80:83], a[8:11], 0
  s_add_u32 m0, s33, 8192
  v_mul_f32 v202, v202, v234
  v_mfma_f32_16x16x32_bf16 v[168:171], v[84:87], a[24:27], v[168:171]
  s_mov_b32 s34, 4129024
  v_mul_f32 v203, v203, v235
  v_mfma_f32_16x16x32_bf16 v[168:171], v[88:91], a[40:43], v[168:171]
  buffer_load_dwordx4 v19, s[8:11], s34 offen lds
  v_cvt_pk_bf16_f32 v32, v200, v201
  v_mfma_f32_16x16x32_bf16 v[172:175], v[80:83], a[12:15], 0
  v_cvt_pk_bf16_f32 v33, v202, v203
  v_mfma_f32_16x16x32_bf16 v[172:175], v[84:87], a[28:31], v[172:175]
  v_mul_f32 v216, v216, v248
  v_mfma_f32_16x16x32_bf16 v[172:175], v[88:91], a[44:47], v[172:175]
  v_mul_f32 v217, v217, v249
  s_waitcnt lgkmcnt(7)
  v_mfma_f32_16x16x32_bf16 v[176:179], v[56:59], a[0:3], 0
  ds_read_b64_tr_b16 v[80:81], v11 offset:36864
  v_mul_f32 v218, v218, v250
  v_mfma_f32_16x16x32_bf16 v[176:179], v[60:63], a[16:19], v[176:179]
  ds_read_b64_tr_b16 v[82:83], v11 offset:38912
  v_mul_f32 v219, v219, v251
  v_mfma_f32_16x16x32_bf16 v[176:179], v[64:67], a[32:35], v[176:179]
  ds_read_b64_tr_b16 v[84:85], v12 offset:49152
  v_cvt_pk_bf16_f32 v34, v216, v217
  v_mfma_f32_16x16x32_bf16 v[180:183], v[56:59], a[4:7], 0
  ds_read_b64_tr_b16 v[86:87], v12 offset:51200
  v_cvt_pk_bf16_f32 v35, v218, v219
  v_mfma_f32_16x16x32_bf16 v[180:183], v[60:63], a[20:23], v[180:183]
  ds_read_b64_tr_b16 v[88:89], v12 offset:53248
  ds_write_b128 v17, v[32:35] offset:10240
  v_mfma_f32_16x16x32_bf16 v[180:183], v[64:67], a[36:39], v[180:183]
  ds_read_b64_tr_b16 v[90:91], v12 offset:55296
  v_mul_f32 v204, v204, v236
  v_mfma_f32_16x16x32_bf16 v[184:187], v[56:59], a[8:11], 0
  s_add_u32 m0, s33, 12288
  v_mul_f32 v205, v205, v237
  v_mfma_f32_16x16x32_bf16 v[184:187], v[60:63], a[24:27], v[184:187]
  s_mov_b32 s34, 4423936
  v_mul_f32 v206, v206, v238
  v_mfma_f32_16x16x32_bf16 v[184:187], v[64:67], a[40:43], v[184:187]
  buffer_load_dwordx4 v19, s[4:7], s34 offen lds
  v_mul_f32 v207, v207, v239
  v_mfma_f32_16x16x32_bf16 v[188:191], v[56:59], a[12:15], 0
  s_add_u32 m0, s33, 16384
  v_cvt_pk_bf16_f32 v36, v204, v205
  v_mfma_f32_16x16x32_bf16 v[188:191], v[60:63], a[28:31], v[188:191]
  s_mov_b32 s34, 4718848
  v_cvt_pk_bf16_f32 v37, v206, v207
  v_mfma_f32_16x16x32_bf16 v[188:191], v[64:67], a[44:47], v[188:191]
  buffer_load_dwordx4 v19, s[4:7], s34 offen lds
  s_waitcnt lgkmcnt(7)
  v_mfma_f32_16x16x32_bf16 v[128:131], v[68:71], a[48:51], v[128:131]
  s_waitcnt vmcnt(17)
  s_barrier
  v_mfma_f32_16x16x32_bf16 v[128:131], v[72:75], a[64:67], v[128:131]
  ds_read_b64_tr_b16 v[56:57], v9 offset:57344
  v_mul_f32 v220, v220, v252
  v_mfma_f32_16x16x32_bf16 v[128:131], v[76:79], a[80:83], v[128:131]
  ds_read_b64_tr_b16 v[58:59], v9 offset:59392
  v_mul_f32 v221, v221, v253
  v_mfma_f32_16x16x32_bf16 v[132:135], v[68:71], a[52:55], v[132:135]
  ds_read_b64_tr_b16 v[60:61], v8 offset:40960
  v_mul_f32 v222, v222, v254
  v_mfma_f32_16x16x32_bf16 v[132:135], v[72:75], a[68:71], v[132:135]
  ds_read_b64_tr_b16 v[62:63], v8 offset:43008
  v_mul_f32 v223, v223, v255
  v_mfma_f32_16x16x32_bf16 v[132:135], v[76:79], a[84:87], v[132:135]
  ds_read_b64_tr_b16 v[64:65], v8 offset:45056
  v_cvt_pk_bf16_f32 v38, v220, v221
  v_mfma_f32_16x16x32_bf16 v[136:139], v[68:71], a[56:59], v[136:139]
  ds_read_b64_tr_b16 v[66:67], v8 offset:47104
  v_cvt_pk_bf16_f32 v39, v222, v223
  v_mfma_f32_16x16x32_bf16 v[136:139], v[72:75], a[72:75], v[136:139]
  s_add_u32 m0, s33, 20480
  ds_write_b128 v17, v[36:39] offset:11264
  v_mfma_f32_16x16x32_bf16 v[136:139], v[76:79], a[88:91], v[136:139]
  s_mov_b32 s34, 5013760
  v_mfma_f32_16x16x32_bf16 v[140:143], v[68:71], a[60:63], v[140:143]
  buffer_load_dwordx4 v19, s[4:7], s34 offen lds
  v_mfma_f32_16x16x32_bf16 v[140:143], v[72:75], a[76:79], v[140:143]
  v_mfma_f32_16x16x32_bf16 v[140:143], v[76:79], a[92:95], v[140:143]
  s_waitcnt lgkmcnt(7)
  v_mfma_f32_16x16x32_bf16 v[144:147], v[80:83], a[48:51], v[144:147]
  ds_read_b64_tr_b16 v[68:69], v12 offset:57344
  v_mfma_f32_16x16x32_bf16 v[144:147], v[84:87], a[64:67], v[144:147]
  ds_read_b64_tr_b16 v[70:71], v12 offset:59392
  v_mfma_f32_16x16x32_bf16 v[144:147], v[88:91], a[80:83], v[144:147]
  ds_read_b64_tr_b16 v[72:73], v11 offset:40960
  v_mfma_f32_16x16x32_bf16 v[148:151], v[80:83], a[52:55], v[148:151]
  ds_read_b64_tr_b16 v[74:75], v11 offset:43008
  v_mfma_f32_16x16x32_bf16 v[148:151], v[84:87], a[68:71], v[148:151]
  ds_read_b64_tr_b16 v[76:77], v11 offset:45056
  v_mfma_f32_16x16x32_bf16 v[148:151], v[88:91], a[84:87], v[148:151]
  ds_read_b64_tr_b16 v[78:79], v11 offset:47104
  v_mfma_f32_16x16x32_bf16 v[152:155], v[80:83], a[56:59], v[152:155]
  s_add_u32 m0, s33, 106496
  v_mfma_f32_16x16x32_bf16 v[152:155], v[84:87], a[72:75], v[152:155]
  s_mov_b32 s34, 4423936
  v_mfma_f32_16x16x32_bf16 v[152:155], v[88:91], a[88:91], v[152:155]
  buffer_load_dwordx4 v19, s[8:11], s34 offen lds
  v_mfma_f32_16x16x32_bf16 v[156:159], v[80:83], a[60:63], v[156:159]
  s_add_u32 m0, s33, 110592
  v_mfma_f32_16x16x32_bf16 v[156:159], v[84:87], a[76:79], v[156:159]
  s_mov_b32 s34, 4718848
  v_mfma_f32_16x16x32_bf16 v[156:159], v[88:91], a[92:95], v[156:159]
  buffer_load_dwordx4 v19, s[8:11], s34 offen lds
  s_waitcnt lgkmcnt(7)
  v_mfma_f32_16x16x32_bf16 v[160:163], v[56:59], a[48:51], v[160:163]
  ds_read_b64_tr_b16 v[80:81], v8 offset:49152
  v_mfma_f32_16x16x32_bf16 v[160:163], v[60:63], a[64:67], v[160:163]
  ds_read_b64_tr_b16 v[82:83], v8 offset:51200
  v_mfma_f32_16x16x32_bf16 v[160:163], v[64:67], a[80:83], v[160:163]
  ds_read_b64_tr_b16 v[84:85], v8 offset:53248
  v_mfma_f32_16x16x32_bf16 v[164:167], v[56:59], a[52:55], v[164:167]
  ds_read_b64_tr_b16 v[86:87], v8 offset:55296
  v_mfma_f32_16x16x32_bf16 v[164:167], v[60:63], a[68:71], v[164:167]
  ds_read_b64_tr_b16 v[88:89], v8 offset:57344
  v_mfma_f32_16x16x32_bf16 v[164:167], v[64:67], a[84:87], v[164:167]
  ds_read_b64_tr_b16 v[90:91], v8 offset:59392
  v_mfma_f32_16x16x32_bf16 v[168:171], v[56:59], a[56:59], v[168:171]
  s_add_u32 m0, s33, 24576
  v_mfma_f32_16x16x32_bf16 v[168:171], v[60:63], a[72:75], v[168:171]
  s_mov_b32 s34, 5013760
  v_mfma_f32_16x16x32_bf16 v[168:171], v[64:67], a[88:91], v[168:171]
  buffer_load_dwordx4 v19, s[8:11], s34 offen lds
  v_mfma_f32_16x16x32_bf16 v[172:175], v[56:59], a[60:63], v[172:175]
  v_mfma_f32_16x16x32_bf16 v[172:175], v[60:63], a[76:79], v[172:175]
  v_mfma_f32_16x16x32_bf16 v[172:175], v[64:67], a[92:95], v[172:175]
  s_waitcnt lgkmcnt(6)
  v_mfma_f32_16x16x32_bf16 v[176:179], v[68:71], a[48:51], v[176:179]
  ds_read_b64_tr_b16 v[56:57], v11 offset:49152
  v_mfma_f32_16x16x32_bf16 v[176:179], v[72:75], a[64:67], v[176:179]
  ds_read_b64_tr_b16 v[58:59], v11 offset:51200
  v_mfma_f32_16x16x32_bf16 v[176:179], v[76:79], a[80:83], v[176:179]
  ds_read_b64_tr_b16 v[60:61], v11 offset:53248
  v_mfma_f32_16x16x32_bf16 v[180:183], v[68:71], a[52:55], v[180:183]
  ds_read_b64_tr_b16 v[62:63], v11 offset:55296
  v_mfma_f32_16x16x32_bf16 v[180:183], v[72:75], a[68:71], v[180:183]
  ds_read_b64_tr_b16 v[64:65], v11 offset:57344
  v_mfma_f32_16x16x32_bf16 v[180:183], v[76:79], a[84:87], v[180:183]
  ds_read_b64_tr_b16 v[66:67], v11 offset:59392
  v_mfma_f32_16x16x32_bf16 v[184:187], v[68:71], a[56:59], v[184:187]
  s_add_u32 m0, s33, 28672
  v_mfma_f32_16x16x32_bf16 v[184:187], v[72:75], a[72:75], v[184:187]
  s_mov_b32 s34, 384
  v_mfma_f32_16x16x32_bf16 v[184:187], v[76:79], a[88:91], v[184:187]
  buffer_load_dwordx4 v19, s[4:7], s34 offen lds
  v_mfma_f32_16x16x32_bf16 v[188:191], v[68:71], a[60:63], v[188:191]
  s_add_u32 m0, s33, 32768
  v_mfma_f32_16x16x32_bf16 v[188:191], v[72:75], a[76:79], v[188:191]
  s_mov_b32 s34, 295296
  v_mfma_f32_16x16x32_bf16 v[188:191], v[76:79], a[92:95], v[188:191]
  buffer_load_dwordx4 v19, s[4:7], s34 offen lds
  s_waitcnt lgkmcnt(6)
  v_mfma_f32_16x16x32_bf16 v[128:131], v[80:83], a[96:99], v[128:131]
  s_waitcnt vmcnt(17)
  s_barrier
  v_mfma_f32_16x16x32_bf16 v[128:131], v[84:87], a[112:115], v[128:131]
  ds_read_b64_tr_b16 v[68:69], v8 offset:61440
  v_mfma_f32_16x16x32_bf16 v[128:131], v[88:91], a[128:131], v[128:131]
  ds_read_b64_tr_b16 v[70:71], v8 offset:63488
  v_mfma_f32_16x16x32_bf16 v[132:135], v[80:83], a[100:103], v[132:135]
  ds_read_b64_tr_b16 v[72:73], v10 offset:12288
  v_mfma_f32_16x16x32_bf16 v[132:135], v[84:87], a[116:119], v[132:135]
  ds_read_b64_tr_b16 v[74:75], v10 offset:14336
  v_mfma_f32_16x16x32_bf16 v[132:135], v[88:91], a[132:135], v[132:135]
  ds_read_b64_tr_b16 v[76:77], v10 offset:16384
  v_mfma_f32_16x16x32_bf16 v[136:139], v[80:83], a[104:107], v[136:139]
  ds_read_b64_tr_b16 v[78:79], v10 offset:18432
  v_mfma_f32_16x16x32_bf16 v[136:139], v[84:87], a[120:123], v[136:139]
  s_add_u32 m0, s33, 36864
  v_mfma_f32_16x16x32_bf16 v[136:139], v[88:91], a[136:139], v[136:139]
  s_mov_b32 s34, 590208
  v_mfma_f32_16x16x32_bf16 v[140:143], v[80:83], a[108:111], v[140:143]
  buffer_load_dwordx4 v19, s[4:7], s34 offen lds
  v_mfma_f32_16x16x32_bf16 v[140:143], v[84:87], a[124:127], v[140:143]
  v_mfma_f32_16x16x32_bf16 v[140:143], v[88:91], a[140:143], v[140:143]
  s_waitcnt lgkmcnt(6)
  v_mfma_f32_16x16x32_bf16 v[144:147], v[56:59], a[96:99], v[144:147]
  ds_read_b64_tr_b16 v[80:81], v11 offset:61440
  v_mfma_f32_16x16x32_bf16 v[144:147], v[60:63], a[112:115], v[144:147]
  ds_read_b64_tr_b16 v[82:83], v11 offset:63488
  v_mfma_f32_16x16x32_bf16 v[144:147], v[64:67], a[128:131], v[144:147]
  ds_read_b64_tr_b16 v[84:85], v13 offset:12288
  v_mfma_f32_16x16x32_bf16 v[148:151], v[56:59], a[100:103], v[148:151]
  ds_read_b64_tr_b16 v[86:87], v13 offset:14336
  v_mfma_f32_16x16x32_bf16 v[148:151], v[60:63], a[116:119], v[148:151]
  ds_read_b64_tr_b16 v[88:89], v13 offset:16384
  v_mfma_f32_16x16x32_bf16 v[148:151], v[64:67], a[132:135], v[148:151]
  ds_read_b64_tr_b16 v[90:91], v13 offset:18432
  v_mfma_f32_16x16x32_bf16 v[152:155], v[56:59], a[104:107], v[152:155]
  s_add_u32 m0, s33, 114688
  v_mfma_f32_16x16x32_bf16 v[152:155], v[60:63], a[120:123], v[152:155]
  s_mov_b32 s34, 384
  v_mfma_f32_16x16x32_bf16 v[152:155], v[64:67], a[136:139], v[152:155]
  buffer_load_dwordx4 v19, s[8:11], s34 offen lds
  v_mfma_f32_16x16x32_bf16 v[156:159], v[56:59], a[108:111], v[156:159]
  s_add_u32 m0, s33, 118784
  v_mfma_f32_16x16x32_bf16 v[156:159], v[60:63], a[124:127], v[156:159]
  s_mov_b32 s34, 295296
  v_mfma_f32_16x16x32_bf16 v[156:159], v[64:67], a[140:143], v[156:159]
  buffer_load_dwordx4 v19, s[8:11], s34 offen lds
  s_waitcnt lgkmcnt(6)
  v_mfma_f32_16x16x32_bf16 v[160:163], v[68:71], a[96:99], v[160:163]
  ds_read_b64_tr_b16 v[56:57], v10 offset:20480
  buffer_load_dword v94, v93, s[12:15], 0 offen
  v_mfma_f32_16x16x32_bf16 v[160:163], v[72:75], a[112:115], v[160:163]
  ds_read_b64_tr_b16 v[58:59], v10 offset:22528
  v_mfma_f32_16x16x32_bf16 v[160:163], v[76:79], a[128:131], v[160:163]
  ds_read_b64_tr_b16 v[60:61], v9
  v_mfma_f32_16x16x32_bf16 v[164:167], v[68:71], a[100:103], v[164:167]
  ds_read_b64_tr_b16 v[62:63], v9 offset:2048
  v_mfma_f32_16x16x32_bf16 v[164:167], v[72:75], a[116:119], v[164:167]
  ds_read_b64_tr_b16 v[64:65], v9 offset:4096
  v_mfma_f32_16x16x32_bf16 v[164:167], v[76:79], a[132:135], v[164:167]
  ds_read_b64_tr_b16 v[66:67], v9 offset:6144
  v_mfma_f32_16x16x32_bf16 v[168:171], v[68:71], a[104:107], v[168:171]
  s_add_u32 m0, s33, 122880
  v_mfma_f32_16x16x32_bf16 v[168:171], v[72:75], a[120:123], v[168:171]
  s_mov_b32 s34, 590208
  v_mfma_f32_16x16x32_bf16 v[168:171], v[76:79], a[136:139], v[168:171]
  buffer_load_dwordx4 v19, s[8:11], s34 offen lds
  v_mfma_f32_16x16x32_bf16 v[172:175], v[68:71], a[108:111], v[172:175]
  v_mfma_f32_16x16x32_bf16 v[172:175], v[72:75], a[124:127], v[172:175]
  v_mfma_f32_16x16x32_bf16 v[172:175], v[76:79], a[140:143], v[172:175]
  s_waitcnt lgkmcnt(6)
  v_mfma_f32_16x16x32_bf16 v[176:179], v[80:83], a[96:99], v[176:179]
  ds_read_b64_tr_b16 v[68:69], v13 offset:20480
  v_mfma_f32_16x16x32_bf16 v[176:179], v[84:87], a[112:115], v[176:179]
  ds_read_b64_tr_b16 v[70:71], v13 offset:22528
  v_mfma_f32_16x16x32_bf16 v[176:179], v[88:91], a[128:131], v[176:179]
  ds_read_b64_tr_b16 v[72:73], v12
  v_mfma_f32_16x16x32_bf16 v[180:183], v[80:83], a[100:103], v[180:183]
  ds_read_b64_tr_b16 v[74:75], v12 offset:2048
  v_mfma_f32_16x16x32_bf16 v[180:183], v[84:87], a[116:119], v[180:183]
  ds_read_b64_tr_b16 v[76:77], v12 offset:4096
  v_mfma_f32_16x16x32_bf16 v[180:183], v[88:91], a[132:135], v[180:183]
  ds_read_b64_tr_b16 v[78:79], v12 offset:6144
  v_mfma_f32_16x16x32_bf16 v[184:187], v[80:83], a[104:107], v[184:187]
  s_add_u32 m0, s33, 40960
  v_mfma_f32_16x16x32_bf16 v[184:187], v[84:87], a[120:123], v[184:187]
  s_mov_b32 s34, 885120
  v_mfma_f32_16x16x32_bf16 v[184:187], v[88:91], a[136:139], v[184:187]
  buffer_load_dwordx4 v19, s[4:7], s34 offen lds
  v_mfma_f32_16x16x32_bf16 v[188:191], v[80:83], a[108:111], v[188:191]
  s_add_u32 m0, s33, 45056
  v_mfma_f32_16x16x32_bf16 v[188:191], v[84:87], a[124:127], v[188:191]
  s_mov_b32 s34, 1180032
  v_mfma_f32_16x16x32_bf16 v[188:191], v[88:91], a[140:143], v[188:191]
  buffer_load_dwordx4 v19, s[4:7], s34 offen lds
  s_waitcnt lgkmcnt(6)
  v_mfma_f32_16x16x32_bf16 v[128:131], v[56:59], a[144:147], v[128:131]
  s_waitcnt vmcnt(18)
  s_barrier
  v_mfma_f32_16x16x32_bf16 v[128:131], v[60:63], a[160:163], v[128:131]
  ds_read_b64_tr_b16 v[80:81], v9 offset:8192
  v_mfma_f32_16x16x32_bf16 v[128:131], v[64:67], a[176:179], v[128:131]
  ds_read_b64_tr_b16 v[82:83], v9 offset:10240
  v_mfma_f32_16x16x32_bf16 v[132:135], v[56:59], a[148:151], v[132:135]
  ds_read_b64_tr_b16 v[84:85], v10 offset:24576
  v_mfma_f32_16x16x32_bf16 v[132:135], v[60:63], a[164:167], v[132:135]
  ds_read_b64_tr_b16 v[86:87], v10 offset:26624
  v_mfma_f32_16x16x32_bf16 v[132:135], v[64:67], a[180:183], v[132:135]
  ds_read_b64_tr_b16 v[88:89], v10 offset:28672
  v_mfma_f32_16x16x32_bf16 v[136:139], v[56:59], a[152:155], v[136:139]
  ds_read_b64_tr_b16 v[90:91], v10 offset:30720
  v_mfma_f32_16x16x32_bf16 v[136:139], v[60:63], a[168:171], v[136:139]
  s_add_u32 m0, s33, 49152
  v_mfma_f32_16x16x32_bf16 v[136:139], v[64:67], a[184:187], v[136:139]
  s_mov_b32 s34, 1474944
  v_mfma_f32_16x16x32_bf16 v[140:143], v[56:59], a[156:159], v[140:143]
  buffer_load_dwordx4 v19, s[4:7], s34 offen lds
  v_mfma_f32_16x16x32_bf16 v[140:143], v[60:63], a[172:175], v[140:143]
  v_mfma_f32_16x16x32_bf16 v[140:143], v[64:67], a[188:191], v[140:143]
  s_waitcnt lgkmcnt(6)
  v_mfma_f32_16x16x32_bf16 v[144:147], v[68:71], a[144:147], v[144:147]
  ds_read_b64_tr_b16 v[56:57], v12 offset:8192
  v_mfma_f32_16x16x32_bf16 v[144:147], v[72:75], a[160:163], v[144:147]
  ds_read_b64_tr_b16 v[58:59], v12 offset:10240
  v_mfma_f32_16x16x32_bf16 v[144:147], v[76:79], a[176:179], v[144:147]
  ds_read_b64_tr_b16 v[60:61], v13 offset:24576
  v_mfma_f32_16x16x32_bf16 v[148:151], v[68:71], a[148:151], v[148:151]
  ds_read_b64_tr_b16 v[62:63], v13 offset:26624
  v_mfma_f32_16x16x32_bf16 v[148:151], v[72:75], a[164:167], v[148:151]
  ds_read_b64_tr_b16 v[64:65], v13 offset:28672
  v_mfma_f32_16x16x32_bf16 v[148:151], v[76:79], a[180:183], v[148:151]
  ds_read_b64_tr_b16 v[66:67], v13 offset:30720
  v_mfma_f32_16x16x32_bf16 v[152:155], v[68:71], a[152:155], v[152:155]
  s_add_u32 m0, s33, 53248
  v_mfma_f32_16x16x32_bf16 v[152:155], v[72:75], a[168:171], v[152:155]
  s_mov_b32 s34, 885120
  v_mfma_f32_16x16x32_bf16 v[152:155], v[76:79], a[184:187], v[152:155]
  buffer_load_dwordx4 v19, s[8:11], s34 offen lds
  v_mfma_f32_16x16x32_bf16 v[156:159], v[68:71], a[156:159], v[156:159]
  s_add_u32 m0, s33, 57344
  v_mfma_f32_16x16x32_bf16 v[156:159], v[72:75], a[172:175], v[156:159]
  s_mov_b32 s34, 1180032
  v_mfma_f32_16x16x32_bf16 v[156:159], v[76:79], a[188:191], v[156:159]
  buffer_load_dwordx4 v19, s[8:11], s34 offen lds
  s_waitcnt lgkmcnt(6)
  v_mfma_f32_16x16x32_bf16 v[160:163], v[80:83], a[144:147], v[160:163]
  ds_read_b64_tr_b16 v[68:69], v9 offset:12288
  v_mfma_f32_16x16x32_bf16 v[160:163], v[84:87], a[160:163], v[160:163]
  ds_read_b64_tr_b16 v[70:71], v9 offset:14336
  v_mfma_f32_16x16x32_bf16 v[160:163], v[88:91], a[176:179], v[160:163]
  ds_read_b64_tr_b16 v[72:73], v9 offset:16384
  v_mfma_f32_16x16x32_bf16 v[164:167], v[80:83], a[148:151], v[164:167]
  ds_read_b64_tr_b16 v[74:75], v9 offset:18432
  v_mfma_f32_16x16x32_bf16 v[164:167], v[84:87], a[164:167], v[164:167]
  ds_read_b64_tr_b16 v[76:77], v9 offset:20480
  v_mfma_f32_16x16x32_bf16 v[164:167], v[88:91], a[180:183], v[164:167]
  ds_read_b64_tr_b16 v[78:79], v9 offset:22528
  v_mfma_f32_16x16x32_bf16 v[168:171], v[80:83], a[152:155], v[168:171]
  s_add_u32 m0, s33, 61440
  v_mfma_f32_16x16x32_bf16 v[168:171], v[84:87], a[168:171], v[168:171]
  s_mov_b32 s34, 1474944
  v_mfma_f32_16x16x32_bf16 v[168:171], v[88:91], a[184:187], v[168:171]
  buffer_load_dwordx4 v19, s[8:11], s34 offen lds
  v_mfma_f32_16x16x32_bf16 v[172:175], v[80:83], a[156:159], v[172:175]
  v_mfma_f32_16x16x32_bf16 v[172:175], v[84:87], a[172:175], v[172:175]
  v_mfma_f32_16x16x32_bf16 v[172:175], v[88:91], a[188:191], v[172:175]
  s_waitcnt lgkmcnt(6)
  v_mfma_f32_16x16x32_bf16 v[176:179], v[56:59], a[144:147], v[176:179]
  ds_read_b64_tr_b16 v[80:81], v12 offset:12288
  v_mfma_f32_16x16x32_bf16 v[176:179], v[60:63], a[160:163], v[176:179]
  ds_read_b64_tr_b16 v[82:83], v12 offset:14336
  v_mfma_f32_16x16x32_bf16 v[176:179], v[64:67], a[176:179], v[176:179]
  ds_read_b64_tr_b16 v[84:85], v12 offset:16384
  v_mfma_f32_16x16x32_bf16 v[180:183], v[56:59], a[148:151], v[180:183]
  ds_read_b64_tr_b16 v[86:87], v12 offset:18432
  v_mfma_f32_16x16x32_bf16 v[180:183], v[60:63], a[164:167], v[180:183]
  ds_read_b64_tr_b16 v[88:89], v12 offset:20480
  v_mfma_f32_16x16x32_bf16 v[180:183], v[64:67], a[180:183], v[180:183]
  ds_read_b64_tr_b16 v[90:91], v12 offset:22528
  v_mfma_f32_16x16x32_bf16 v[184:187], v[56:59], a[152:155], v[184:187]
  v_mfma_f32_16x16x32_bf16 v[184:187], v[60:63], a[168:171], v[184:187]
  v_mfma_f32_16x16x32_bf16 v[184:187], v[64:67], a[184:187], v[184:187]
  v_mfma_f32_16x16x32_bf16 v[188:191], v[56:59], a[156:159], v[188:191]
  v_mfma_f32_16x16x32_bf16 v[188:191], v[60:63], a[172:175], v[188:191]
  v_mfma_f32_16x16x32_bf16 v[188:191], v[64:67], a[188:191], v[188:191]
  s_waitcnt lgkmcnt(6)
  v_mfma_f32_16x16x32_bf16 v[128:131], v[68:71], a[192:195], v[128:131]
  s_waitcnt vmcnt(16)
  s_barrier
  v_mfma_f32_16x16x32_bf16 v[128:131], v[72:75], a[208:211], v[128:131]
  ds_read_b64_tr_b16 v[56:57], v8
  v_mfma_f32_16x16x32_bf16 v[128:131], v[76:79], a[224:227], v[128:131]
  ds_read_b64_tr_b16 v[58:59], v8 offset:2048
  v_mfma_f32_16x16x32_bf16 v[132:135], v[68:71], a[196:199], v[132:135]
  ds_read_b64_tr_b16 v[60:61], v8 offset:4096
  v_mfma_f32_16x16x32_bf16 v[132:135], v[72:75], a[212:215], v[132:135]
  ds_read_b64_tr_b16 v[62:63], v8 offset:6144
  v_mfma_f32_16x16x32_bf16 v[132:135], v[76:79], a[228:231], v[132:135]
  ds_read_b64_tr_b16 v[64:65], v8 offset:8192
  v_mfma_f32_16x16x32_bf16 v[136:139], v[68:71], a[200:203], v[136:139]
  ds_read_b64_tr_b16 v[66:67], v8 offset:10240
  v_mfma_f32_16x16x32_bf16 v[136:139], v[72:75], a[216:219], v[136:139]
  s_add_u32 m0, s33, 151552
  v_mfma_f32_16x16x32_bf16 v[136:139], v[76:79], a[232:235], v[136:139]
  s_mov_b32 s34, 1769856
  v_mfma_f32_16x16x32_bf16 v[140:143], v[68:71], a[204:207], v[140:143]
  buffer_load_dwordx4 v19, s[4:7], s34 offen lds
  v_mfma_f32_16x16x32_bf16 v[140:143], v[72:75], a[220:223], v[140:143]
  s_add_u32 m0, s33, 65536
  v_mfma_f32_16x16x32_bf16 v[140:143], v[76:79], a[236:239], v[140:143]
  s_mov_b32 s34, 2064768
  buffer_load_dwordx4 v19, s[4:7], s34 offen lds
  s_waitcnt lgkmcnt(6)
  v_mfma_f32_16x16x32_bf16 v[144:147], v[80:83], a[192:195], v[144:147]
  ds_read_b64_tr_b16 v[68:69], v11
  v_mfma_f32_16x16x32_bf16 v[144:147], v[84:87], a[208:211], v[144:147]
  ds_read_b64_tr_b16 v[70:71], v11 offset:2048
  v_mfma_f32_16x16x32_bf16 v[144:147], v[88:91], a[224:227], v[144:147]
  ds_read_b64_tr_b16 v[72:73], v11 offset:4096
  v_mfma_f32_16x16x32_bf16 v[148:151], v[80:83], a[196:199], v[148:151]
  ds_read_b64_tr_b16 v[74:75], v11 offset:6144
  v_mfma_f32_16x16x32_bf16 v[148:151], v[84:87], a[212:215], v[148:151]
  ds_read_b64_tr_b16 v[76:77], v11 offset:8192
  v_mfma_f32_16x16x32_bf16 v[148:151], v[88:91], a[228:231], v[148:151]
  ds_read_b64_tr_b16 v[78:79], v11 offset:10240
  v_mfma_f32_16x16x32_bf16 v[152:155], v[80:83], a[200:203], v[152:155]
  s_add_u32 m0, s33, 69632
  v_mfma_f32_16x16x32_bf16 v[152:155], v[84:87], a[216:219], v[152:155]
  s_mov_b32 s34, 2359680
  v_mfma_f32_16x16x32_bf16 v[152:155], v[88:91], a[232:235], v[152:155]
  buffer_load_dwordx4 v19, s[4:7], s34 offen lds
  v_mfma_f32_16x16x32_bf16 v[156:159], v[80:83], a[204:207], v[156:159]
  s_add_u32 m0, s33, 73728
  v_mfma_f32_16x16x32_bf16 v[156:159], v[84:87], a[220:223], v[156:159]
  s_mov_b32 s34, 1769856
  v_mfma_f32_16x16x32_bf16 v[156:159], v[88:91], a[236:239], v[156:159]
  buffer_load_dwordx4 v19, s[8:11], s34 offen lds
  s_waitcnt lgkmcnt(6)
  v_mfma_f32_16x16x32_bf16 v[160:163], v[56:59], a[192:195], v[160:163]
  ds_read_b64_tr_b16 v[80:81], v8 offset:12288
  v_mfma_f32_16x16x32_bf16 v[160:163], v[60:63], a[208:211], v[160:163]
  ds_read_b64_tr_b16 v[82:83], v8 offset:14336
  v_mfma_f32_16x16x32_bf16 v[160:163], v[64:67], a[224:227], v[160:163]
  ds_read_b64_tr_b16 v[84:85], v8 offset:16384
  v_mfma_f32_16x16x32_bf16 v[164:167], v[56:59], a[196:199], v[164:167]
  ds_read_b64_tr_b16 v[86:87], v8 offset:18432
  v_mfma_f32_16x16x32_bf16 v[164:167], v[60:63], a[212:215], v[164:167]
  ds_read_b64_tr_b16 v[88:89], v8 offset:20480
  v_mfma_f32_16x16x32_bf16 v[164:167], v[64:67], a[228:231], v[164:167]
  ds_read_b64_tr_b16 v[90:91], v8 offset:22528
  v_mfma_f32_16x16x32_bf16 v[168:171], v[56:59], a[200:203], v[168:171]
  s_add_u32 m0, s33, 155648
  v_mfma_f32_16x16x32_bf16 v[168:171], v[60:63], a[216:219], v[168:171]
  s_mov_b32 s34, 2064768
  v_mfma_f32_16x16x32_bf16 v[168:171], v[64:67], a[232:235], v[168:171]
  buffer_load_dwordx4 v19, s[8:11], s34 offen lds
  v_mfma_f32_16x16x32_bf16 v[172:175], v[56:59], a[204:207], v[172:175]
  s_add_u32 m0, s33, 159744
  v_mfma_f32_16x16x32_bf16 v[172:175], v[60:63], a[220:223], v[172:175]
  s_mov_b32 s34, 2359680
  v_mfma_f32_16x16x32_bf16 v[172:175], v[64:67], a[236:239], v[172:175]
  buffer_load_dwordx4 v19, s[8:11], s34 offen lds
  s_waitcnt lgkmcnt(6)
  v_mfma_f32_16x16x32_bf16 v[176:179], v[68:71], a[192:195], v[176:179]
  ds_read_b64_tr_b16 v[56:57], v11 offset:12288
  v_mfma_f32_16x16x32_bf16 v[176:179], v[72:75], a[208:211], v[176:179]
  ds_read_b64_tr_b16 v[58:59], v11 offset:14336
  v_mfma_f32_16x16x32_bf16 v[176:179], v[76:79], a[224:227], v[176:179]
  ds_read_b64_tr_b16 v[60:61], v11 offset:16384
  v_mfma_f32_16x16x32_bf16 v[180:183], v[68:71], a[196:199], v[180:183]
  ds_read_b64_tr_b16 v[62:63], v11 offset:18432
  v_mfma_f32_16x16x32_bf16 v[180:183], v[72:75], a[212:215], v[180:183]
  ds_read_b64_tr_b16 v[64:65], v11 offset:20480
  v_mfma_f32_16x16x32_bf16 v[180:183], v[76:79], a[228:231], v[180:183]
  ds_read_b64_tr_b16 v[66:67], v11 offset:22528
  v_mfma_f32_16x16x32_bf16 v[184:187], v[68:71], a[200:203], v[184:187]
  v_mfma_f32_16x16x32_bf16 v[184:187], v[72:75], a[216:219], v[184:187]
  v_mfma_f32_16x16x32_bf16 v[184:187], v[76:79], a[232:235], v[184:187]
  v_mfma_f32_16x16x32_bf16 v[188:191], v[68:71], a[204:207], v[188:191]
  v_mfma_f32_16x16x32_bf16 v[188:191], v[72:75], a[220:223], v[188:191]
  v_mfma_f32_16x16x32_bf16 v[188:191], v[76:79], a[236:239], v[188:191]
  s_waitcnt lgkmcnt(6)
  v_mfma_f32_16x16x32_bf16 v[128:131], v[80:83], a[240:243], v[128:131]
  s_waitcnt vmcnt(16)
  s_barrier
  v_mfma_f32_16x16x32_bf16 v[128:131], v[84:87], v[96:99], v[128:131]
  ds_read_b64_tr_b16 v[68:69], v9 offset:40960
  v_mfma_f32_16x16x32_bf16 v[128:131], v[88:91], v[112:115], v[128:131]
  ds_read_b64_tr_b16 v[70:71], v9 offset:43008
  v_mfma_f32_16x16x32_bf16 v[132:135], v[80:83], a[244:247], v[132:135]
  ds_read_b64_tr_b16 v[72:73], v9 offset:45056
  v_mfma_f32_16x16x32_bf16 v[132:135], v[84:87], v[100:103], v[132:135]
  ds_read_b64_tr_b16 v[74:75], v9 offset:47104
  v_mfma_f32_16x16x32_bf16 v[132:135], v[88:91], v[116:119], v[132:135]
  ds_read_b64_tr_b16 v[76:77], v8 offset:24576
  v_mfma_f32_16x16x32_bf16 v[136:139], v[80:83], a[248:251], v[136:139]
  ds_read_b64_tr_b16 v[78:79], v8 offset:26624
  v_mfma_f32_16x16x32_bf16 v[136:139], v[84:87], v[104:107], v[136:139]
  s_add_u32 m0, s33, 77824
  v_mfma_f32_16x16x32_bf16 v[136:139], v[88:91], v[120:123], v[136:139]
  s_mov_b32 s34, 2654592
  v_mfma_f32_16x16x32_bf16 v[140:143], v[80:83], a[252:255], v[140:143]
  buffer_load_dwordx4 v19, s[4:7], s34 offen lds
  v_mfma_f32_16x16x32_bf16 v[140:143], v[84:87], v[108:111], v[140:143]
  s_add_u32 m0, s33, 81920
  v_mfma_f32_16x16x32_bf16 v[140:143], v[88:91], v[124:127], v[140:143]
  s_mov_b32 s34, 2949504
  buffer_load_dwordx4 v19, s[4:7], s34 offen lds
  s_waitcnt lgkmcnt(6)
  v_mfma_f32_16x16x32_bf16 v[144:147], v[56:59], a[240:243], v[144:147]
  ds_read_b64_tr_b16 v[80:81], v12 offset:40960
  v_mfma_f32_16x16x32_bf16 v[144:147], v[60:63], v[96:99], v[144:147]
  ds_read_b64_tr_b16 v[82:83], v12 offset:43008
  v_mfma_f32_16x16x32_bf16 v[144:147], v[64:67], v[112:115], v[144:147]
  ds_read_b64_tr_b16 v[84:85], v12 offset:45056
  v_mfma_f32_16x16x32_bf16 v[148:151], v[56:59], a[244:247], v[148:151]
  ds_read_b64_tr_b16 v[86:87], v12 offset:47104
  v_mfma_f32_16x16x32_bf16 v[148:151], v[60:63], v[100:103], v[148:151]
  ds_read_b64_tr_b16 v[88:89], v11 offset:24576
  v_mfma_f32_16x16x32_bf16 v[148:151], v[64:67], v[116:119], v[148:151]
  ds_read_b64_tr_b16 v[90:91], v11 offset:26624
  v_mfma_f32_16x16x32_bf16 v[152:155], v[56:59], a[248:251], v[152:155]
  s_add_u32 m0, s33, 86016
  v_mfma_f32_16x16x32_bf16 v[152:155], v[60:63], v[104:107], v[152:155]
  s_mov_b32 s34, 3244416
  v_mfma_f32_16x16x32_bf16 v[152:155], v[64:67], v[120:123], v[152:155]
  buffer_load_dwordx4 v19, s[4:7], s34 offen lds
  v_mfma_f32_16x16x32_bf16 v[156:159], v[56:59], a[252:255], v[156:159]
  s_add_u32 m0, s33, 0
  v_mfma_f32_16x16x32_bf16 v[156:159], v[60:63], v[108:111], v[156:159]
  s_mov_b32 s34, 2654592
  v_mfma_f32_16x16x32_bf16 v[156:159], v[64:67], v[124:127], v[156:159]
  buffer_load_dwordx4 v19, s[8:11], s34 offen lds
  s_waitcnt lgkmcnt(6)
  v_mfma_f32_16x16x32_bf16 v[160:163], v[68:71], a[240:243], v[160:163]
  ds_read_b64_tr_b16 v[56:57], v8 offset:28672
  v_mfma_f32_16x16x32_bf16 v[160:163], v[72:75], v[96:99], v[160:163]
  ds_read_b64_tr_b16 v[58:59], v8 offset:30720
  v_mfma_f32_16x16x32_bf16 v[160:163], v[76:79], v[112:115], v[160:163]
  ds_read_b64_tr_b16 v[60:61], v8 offset:32768
  v_mfma_f32_16x16x32_bf16 v[164:167], v[68:71], a[244:247], v[164:167]
  ds_read_b64_tr_b16 v[62:63], v8 offset:34816
  v_mfma_f32_16x16x32_bf16 v[164:167], v[72:75], v[100:103], v[164:167]
  ds_read_b64_tr_b16 v[64:65], v8 offset:36864
  v_mfma_f32_16x16x32_bf16 v[164:167], v[76:79], v[116:119], v[164:167]
  ds_read_b64_tr_b16 v[66:67], v8 offset:38912
  v_mfma_f32_16x16x32_bf16 v[168:171], v[68:71], a[248:251], v[168:171]
  s_add_u32 m0, s33, 4096
  v_mfma_f32_16x16x32_bf16 v[168:171], v[72:75], v[104:107], v[168:171]
  s_mov_b32 s34, 2949504
  v_mfma_f32_16x16x32_bf16 v[168:171], v[76:79], v[120:123], v[168:171]
  buffer_load_dwordx4 v19, s[8:11], s34 offen lds
  v_mfma_f32_16x16x32_bf16 v[172:175], v[68:71], a[252:255], v[172:175]
  s_add_u32 m0, s33, 8192
  v_mfma_f32_16x16x32_bf16 v[172:175], v[72:75], v[108:111], v[172:175]
  s_mov_b32 s34, 3244416
  v_mfma_f32_16x16x32_bf16 v[172:175], v[76:79], v[124:127], v[172:175]
  buffer_load_dwordx4 v19, s[8:11], s34 offen lds
  s_waitcnt lgkmcnt(6)
  v_mfma_f32_16x16x32_bf16 v[176:179], v[80:83], a[240:243], v[176:179]
  ds_read_b64_tr_b16 v[68:69], v11 offset:28672
  v_mfma_f32_16x16x32_bf16 v[176:179], v[84:87], v[96:99], v[176:179]
  ds_read_b64_tr_b16 v[70:71], v11 offset:30720
  v_mfma_f32_16x16x32_bf16 v[176:179], v[88:91], v[112:115], v[176:179]
  ds_read_b64_tr_b16 v[72:73], v11 offset:32768
  v_mfma_f32_16x16x32_bf16 v[180:183], v[80:83], a[244:247], v[180:183]
  ds_read_b64_tr_b16 v[74:75], v11 offset:34816
  v_mfma_f32_16x16x32_bf16 v[180:183], v[84:87], v[100:103], v[180:183]
  ds_read_b64_tr_b16 v[76:77], v11 offset:36864
  v_mfma_f32_16x16x32_bf16 v[180:183], v[88:91], v[116:119], v[180:183]
  ds_read_b64_tr_b16 v[78:79], v11 offset:38912
  v_mfma_f32_16x16x32_bf16 v[184:187], v[80:83], a[248:251], v[184:187]
  v_mfma_f32_16x16x32_bf16 v[184:187], v[84:87], v[104:107], v[184:187]
  v_mfma_f32_16x16x32_bf16 v[184:187], v[88:91], v[120:123], v[184:187]
  v_mfma_f32_16x16x32_bf16 v[188:191], v[80:83], a[252:255], v[188:191]
  v_mfma_f32_16x16x32_bf16 v[188:191], v[84:87], v[108:111], v[188:191]
  v_mfma_f32_16x16x32_bf16 v[188:191], v[88:91], v[124:127], v[188:191]
  s_waitcnt lgkmcnt(6)
  v_mfma_f32_16x16x32_bf16 v[192:195], v[56:59], a[0:3], 0
  s_waitcnt vmcnt(15)
  s_barrier
  v_mfma_f32_16x16x32_bf16 v[192:195], v[60:63], a[16:19], v[192:195]
  ds_read_b64_tr_b16 v[80:81], v9 offset:49152
  v_mul_f32 v128, v128, v160
  v_mfma_f32_16x16x32_bf16 v[192:195], v[64:67], a[32:35], v[192:195]
  ds_read_b64_tr_b16 v[82:83], v9 offset:51200
  v_mul_f32 v129, v129, v161
  v_mfma_f32_16x16x32_bf16 v[196:199], v[56:59], a[4:7], 0
  ds_read_b64_tr_b16 v[84:85], v9 offset:53248
  v_mul_f32 v130, v130, v162
  v_mfma_f32_16x16x32_bf16 v[196:199], v[60:63], a[20:23], v[196:199]
  ds_read_b64_tr_b16 v[86:87], v9 offset:55296
  v_mul_f32 v131, v131, v163
  v_mfma_f32_16x16x32_bf16 v[196:199], v[64:67], a[36:39], v[196:199]
  ds_read_b64_tr_b16 v[88:89], v9 offset:57344
  v_cvt_pk_bf16_f32 v32, v128, v129
  v_mfma_f32_16x16x32_bf16 v[200:203], v[56:59], a[8:11], 0
  ds_read_b64_tr_b16 v[90:91], v9 offset:59392
  v_cvt_pk_bf16_f32 v33, v130, v131
  v_mfma_f32_16x16x32_bf16 v[200:203], v[60:63], a[24:27], v[200:203]
  v_mul_f32 v144, v144, v176
  v_mfma_f32_16x16x32_bf16 v[200:203], v[64:67], a[40:43], v[200:203]
  v_mul_f32 v145, v145, v177
  v_mfma_f32_16x16x32_bf16 v[204:207], v[56:59], a[12:15], 0
  v_mul_f32 v146, v146, v178
  v_mfma_f32_16x16x32_bf16 v[204:207], v[60:63], a[28:31], v[204:207]
  v_mul_f32 v147, v147, v179
  v_mfma_f32_16x16x32_bf16 v[204:207], v[64:67], a[44:47], v[204:207]
  v_cvt_pk_bf16_f32 v34, v144, v145
  s_waitcnt lgkmcnt(6)
  v_mfma_f32_16x16x32_bf16 v[208:211], v[68:71], a[0:3], 0
  ds_read_b64_tr_b16 v[56:57], v12 offset:49152
  v_cvt_pk_bf16_f32 v35, v146, v147
  v_mfma_f32_16x16x32_bf16 v[208:211], v[72:75], a[16:19], v[208:211]
  ds_read_b64_tr_b16 v[58:59], v12 offset:51200
  ds_write_b128 v17, v[32:35] offset:16384
  v_mfma_f32_16x16x32_bf16 v[208:211], v[76:79], a[32:35], v[208:211]
  ds_read_b64_tr_b16 v[60:61], v12 offset:53248
  v_mul_f32 v132, v132, v164
  v_mfma_f32_16x16x32_bf16 v[212:215], v[68:71], a[4:7], 0
  ds_read_b64_tr_b16 v[62:63], v12 offset:55296
  v_mul_f32 v133, v133, v165
  v_mfma_f32_16x16x32_bf16 v[212:215], v[72:75], a[20:23], v[212:215]
  ds_read_b64_tr_b16 v[64:65], v12 offset:57344
  v_mul_f32 v134, v134, v166
  v_mfma_f32_16x16x32_bf16 v[212:215], v[76:79], a[36:39], v[212:215]
  ds_read_b64_tr_b16 v[66:67], v12 offset:59392
  v_mul_f32 v135, v135, v167
  v_mfma_f32_16x16x32_bf16 v[216:219], v[68:71], a[8:11], 0
  v_cvt_pk_bf16_f32 v36, v132, v133
  v_mfma_f32_16x16x32_bf16 v[216:219], v[72:75], a[24:27], v[216:219]
  v_cvt_pk_bf16_f32 v37, v134, v135
  v_mfma_f32_16x16x32_bf16 v[216:219], v[76:79], a[40:43], v[216:219]
  v_mul_f32 v148, v148, v180
  v_mfma_f32_16x16x32_bf16 v[220:223], v[68:71], a[12:15], 0
  v_mul_f32 v149, v149, v181
  v_mfma_f32_16x16x32_bf16 v[220:223], v[72:75], a[28:31], v[220:223]
  v_mul_f32 v150, v150, v182
  v_mfma_f32_16x16x32_bf16 v[220:223], v[76:79], a[44:47], v[220:223]
  v_mul_f32 v151, v151, v183
  s_waitcnt lgkmcnt(7)
  v_mfma_f32_16x16x32_bf16 v[224:227], v[80:83], a[0:3], 0
  ds_read_b64_tr_b16 v[68:69], v8 offset:40960
  v_cvt_pk_bf16_f32 v38, v148, v149
  v_mfma_f32_16x16x32_bf16 v[224:227], v[84:87], a[16:19], v[224:227]
  ds_read_b64_tr_b16 v[70:71], v8 offset:43008
  v_cvt_pk_bf16_f32 v39, v150, v151
  v_mfma_f32_16x16x32_bf16 v[224:227], v[88:91], a[32:35], v[224:227]
  ds_read_b64_tr_b16 v[72:73], v8 offset:45056
  ds_write_b128 v17, v[36:39] offset:17408
  v_mfma_f32_16x16x32_bf16 v[228:231], v[80:83], a[4:7], 0
  ds_read_b64_tr_b16 v[74:75], v8 offset:47104
  v_mul_f32 v136, v136, v168
  v_mfma_f32_16x16x32_bf16 v[228:231], v[84:87], a[20:23], v[228:231]
  ds_read_b64_tr_b16 v[76:77], v8 offset:49152
  v_mul_f32 v137, v137, v169
  v_mfma_f32_16x16x32_bf16 v[228:231], v[88:91], a[36:39], v[228:231]
  ds_read_b64_tr_b16 v[78:79], v8 offset:51200
  v_mul_f32 v138, v138, v170
  v_mfma_f32_16x16x32_bf16 v[232:235], v[80:83], a[8:11], 0
  v_mul_f32 v139, v139, v171
  v_mfma_f32_16x16x32_bf16 v[232:235], v[84:87], a[24:27], v[232:235]
  v_cvt_pk_bf16_f32 v32, v136, v137
  v_mfma_f32_16x16x32_bf16 v[232:235], v[88:91], a[40:43], v[232:235]
  v_cvt_pk_bf16_f32 v33, v138, v139
  v_mfma_f32_16x16x32_bf16 v[236:239], v[80:83], a[12:15], 0
  v_mul_f32 v152, v152, v184
  v_mfma_f32_16x16x32_bf16 v[236:239], v[84:87], a[28:31], v[236:239]
  v_mul_f32 v153, v153, v185
  v_mfma_f32_16x16x32_bf16 v[236:239], v[88:91], a[44:47], v[236:239]
  v_mul_f32 v154, v154, v186
  s_waitcnt lgkmcnt(7)
  v_mfma_f32_16x16x32_bf16 v[240:243], v[56:59], a[0:3], 0
  ds_read_b64_tr_b16 v[80:81], v11 offset:40960
  v_mul_f32 v155, v155, v187
  v_mfma_f32_16x16x32_bf16 v[240:243], v[60:63], a[16:19], v[240:243]
  ds_read_b64_tr_b16 v[82:83], v11 offset:43008
  v_cvt_pk_bf16_f32 v34, v152, v153
  v_mfma_f32_16x16x32_bf16 v[240:243], v[64:67], a[32:35], v[240:243]
  ds_read_b64_tr_b16 v[84:85], v11 offset:45056
  v_cvt_pk_bf16_f32 v35, v154, v155
  v_mfma_f32_16x16x32_bf16 v[244:247], v[56:59], a[4:7], 0
  ds_read_b64_tr_b16 v[86:87], v11 offset:47104
  ds_write_b128 v17, v[32:35] offset:18432
  v_mfma_f32_16x16x32_bf16 v[244:247], v[60:63], a[20:23], v[244:247]
  ds_read_b64_tr_b16 v[88:89], v11 offset:49152
  v_mul_f32 v140, v140, v172
  v_mfma_f32_16x16x32_bf16 v[244:247], v[64:67], a[36:39], v[244:247]
  ds_read_b64_tr_b16 v[90:91], v11 offset:51200
  v_mul_f32 v141, v141, v173
  v_mfma_f32_16x16x32_bf16 v[248:251], v[56:59], a[8:11], 0
  v_mul_f32 v142, v142, v174
  v_mfma_f32_16x16x32_bf16 v[248:251], v[60:63], a[24:27], v[248:251]
  v_mul_f32 v143, v143, v175
  v_mfma_f32_16x16x32_bf16 v[248:251], v[64:67], a[40:43], v[248:251]
  v_cvt_pk_bf16_f32 v36, v140, v141
  v_mfma_f32_16x16x32_bf16 v[252:255], v[56:59], a[12:15], 0
  v_cvt_pk_bf16_f32 v37, v142, v143
  v_mfma_f32_16x16x32_bf16 v[252:255], v[60:63], a[28:31], v[252:255]
  v_mul_f32 v156, v156, v188
  v_mfma_f32_16x16x32_bf16 v[252:255], v[64:67], a[44:47], v[252:255]
  v_mul_f32 v157, v157, v189
  s_waitcnt lgkmcnt(7)
  v_mfma_f32_16x16x32_bf16 v[192:195], v[68:71], a[48:51], v[192:195]
  s_waitcnt vmcnt(9)
  s_barrier
  v_mfma_f32_16x16x32_bf16 v[192:195], v[72:75], a[64:67], v[192:195]
  ds_read_b64_tr_b16 v[56:57], v8 offset:53248
  v_mul_f32 v158, v158, v190
  v_mfma_f32_16x16x32_bf16 v[192:195], v[76:79], a[80:83], v[192:195]
  ds_read_b64_tr_b16 v[58:59], v8 offset:55296
  v_mul_f32 v159, v159, v191
  v_mfma_f32_16x16x32_bf16 v[196:199], v[68:71], a[52:55], v[196:199]
  ds_read_b64_tr_b16 v[60:61], v8 offset:57344
  v_cvt_pk_bf16_f32 v38, v156, v157
  v_mfma_f32_16x16x32_bf16 v[196:199], v[72:75], a[68:71], v[196:199]
  ds_read_b64_tr_b16 v[62:63], v8 offset:59392
  v_cvt_pk_bf16_f32 v39, v158, v159
  v_mfma_f32_16x16x32_bf16 v[196:199], v[76:79], a[84:87], v[196:199]
  ds_read_b64_tr_b16 v[64:65], v8 offset:61440
  ds_write_b128 v17, v[36:39] offset:19456
  v_mfma_f32_16x16x32_bf16 v[200:203], v[68:71], a[56:59], v[200:203]
  ds_read_b64_tr_b16 v[66:67], v8 offset:63488
  v_mfma_f32_16x16x32_bf16 v[200:203], v[72:75], a[72:75], v[200:203]
  v_mfma_f32_16x16x32_bf16 v[200:203], v[76:79], a[88:91], v[200:203]
  v_mfma_f32_16x16x32_bf16 v[204:207], v[68:71], a[60:63], v[204:207]
  v_mfma_f32_16x16x32_bf16 v[204:207], v[72:75], a[76:79], v[204:207]
  v_mfma_f32_16x16x32_bf16 v[204:207], v[76:79], a[92:95], v[204:207]
  s_waitcnt lgkmcnt(7)
  v_mfma_f32_16x16x32_bf16 v[208:211], v[80:83], a[48:51], v[208:211]
  ds_read_b64_tr_b16 v[68:69], v11 offset:53248
  v_mfma_f32_16x16x32_bf16 v[208:211], v[84:87], a[64:67], v[208:211]
  ds_read_b64_tr_b16 v[70:71], v11 offset:55296
  v_mfma_f32_16x16x32_bf16 v[208:211], v[88:91], a[80:83], v[208:211]
  ds_read_b64_tr_b16 v[72:73], v11 offset:57344
  v_mfma_f32_16x16x32_bf16 v[212:215], v[80:83], a[52:55], v[212:215]
  ds_read_b64_tr_b16 v[74:75], v11 offset:59392
  v_mfma_f32_16x16x32_bf16 v[212:215], v[84:87], a[68:71], v[212:215]
  ds_read_b64_tr_b16 v[76:77], v11 offset:61440
  v_mfma_f32_16x16x32_bf16 v[212:215], v[88:91], a[84:87], v[212:215]
  ds_read_b64_tr_b16 v[78:79], v11 offset:63488
  v_mfma_f32_16x16x32_bf16 v[216:219], v[80:83], a[56:59], v[216:219]
  s_add_u32 m0, s33, 12288
  v_mfma_f32_16x16x32_bf16 v[216:219], v[84:87], a[72:75], v[216:219]
  s_mov_b32 s34, 3539328
  v_mfma_f32_16x16x32_bf16 v[216:219], v[88:91], a[88:91], v[216:219]
  buffer_load_dwordx4 v19, s[4:7], s34 offen lds
  v_mfma_f32_16x16x32_bf16 v[220:223], v[80:83], a[60:63], v[220:223]
  s_add_u32 m0, s33, 16384
  v_mfma_f32_16x16x32_bf16 v[220:223], v[84:87], a[76:79], v[220:223]
  s_mov_b32 s34, 3834240
  v_mfma_f32_16x16x32_bf16 v[220:223], v[88:91], a[92:95], v[220:223]
  buffer_load_dwordx4 v19, s[4:7], s34 offen lds
  s_waitcnt lgkmcnt(6)
  v_mfma_f32_16x16x32_bf16 v[224:227], v[56:59], a[48:51], v[224:227]
  ds_read_b64_tr_b16 v[80:81], v10 offset:20480
  v_mfma_f32_16x16x32_bf16 v[224:227], v[60:63], a[64:67], v[224:227]
  ds_read_b64_tr_b16 v[82:83], v10 offset:22528
  v_mfma_f32_16x16x32_bf16 v[224:227], v[64:67], a[80:83], v[224:227]
  ds_read_b64_tr_b16 v[84:85], v9
  v_mfma_f32_16x16x32_bf16 v[228:231], v[56:59], a[52:55], v[228:231]
  ds_read_b64_tr_b16 v[86:87], v9 offset:2048
  v_mfma_f32_16x16x32_bf16 v[228:231], v[60:63], a[68:71], v[228:231]
  ds_read_b64_tr_b16 v[88:89], v9 offset:4096
  v_mfma_f32_16x16x32_bf16 v[228:231], v[64:67], a[84:87], v[228:231]
  ds_read_b64_tr_b16 v[90:91], v9 offset:6144
  v_mfma_f32_16x16x32_bf16 v[232:235], v[56:59], a[56:59], v[232:235]
  s_add_u32 m0, s33, 20480
  v_mfma_f32_16x16x32_bf16 v[232:235], v[60:63], a[72:75], v[232:235]
  s_mov_b32 s34, 4129152
  v_mfma_f32_16x16x32_bf16 v[232:235], v[64:67], a[88:91], v[232:235]
  buffer_load_dwordx4 v19, s[4:7], s34 offen lds
  v_mfma_f32_16x16x32_bf16 v[236:239], v[56:59], a[60:63], v[236:239]
  v_mfma_f32_16x16x32_bf16 v[236:239], v[60:63], a[76:79], v[236:239]
  v_mfma_f32_16x16x32_bf16 v[236:239], v[64:67], a[92:95], v[236:239]
  s_waitcnt lgkmcnt(6)
  v_mfma_f32_16x16x32_bf16 v[240:243], v[68:71], a[48:51], v[240:243]
  ds_read_b64_tr_b16 v[56:57], v13 offset:20480
  v_mfma_f32_16x16x32_bf16 v[240:243], v[72:75], a[64:67], v[240:243]
  ds_read_b64_tr_b16 v[58:59], v13 offset:22528
  v_mfma_f32_16x16x32_bf16 v[240:243], v[76:79], a[80:83], v[240:243]
  ds_read_b64_tr_b16 v[60:61], v12
  v_mfma_f32_16x16x32_bf16 v[244:247], v[68:71], a[52:55], v[244:247]
  ds_read_b64_tr_b16 v[62:63], v12 offset:2048
  v_mfma_f32_16x16x32_bf16 v[244:247], v[72:75], a[68:71], v[244:247]
  ds_read_b64_tr_b16 v[64:65], v12 offset:4096
  v_mfma_f32_16x16x32_bf16 v[244:247], v[76:79], a[84:87], v[244:247]
  ds_read_b64_tr_b16 v[66:67], v12 offset:6144
  v_mfma_f32_16x16x32_bf16 v[248:251], v[68:71], a[56:59], v[248:251]
  s_add_u32 m0, s33, 24576
  v_mfma_f32_16x16x32_bf16 v[248:251], v[72:75], a[72:75], v[248:251]
  s_mov_b32 s34, 3539328
  v_mfma_f32_16x16x32_bf16 v[248:251], v[76:79], a[88:91], v[248:251]
  buffer_load_dwordx4 v19, s[8:11], s34 offen lds
  v_mfma_f32_16x16x32_bf16 v[252:255], v[68:71], a[60:63], v[252:255]
  s_add_u32 m0, s33, 28672
  v_mfma_f32_16x16x32_bf16 v[252:255], v[72:75], a[76:79], v[252:255]
  s_mov_b32 s34, 3834240
  v_mfma_f32_16x16x32_bf16 v[252:255], v[76:79], a[92:95], v[252:255]
  buffer_load_dwordx4 v19, s[8:11], s34 offen lds
  s_waitcnt lgkmcnt(6)
  v_mfma_f32_16x16x32_bf16 v[192:195], v[80:83], a[96:99], v[192:195]
  s_waitcnt vmcnt(8)
  s_barrier
  v_mfma_f32_16x16x32_bf16 v[192:195], v[84:87], a[112:115], v[192:195]
  ds_read_b64_tr_b16 v[68:69], v9 offset:8192
  v_mfma_f32_16x16x32_bf16 v[192:195], v[88:91], a[128:131], v[192:195]
  ds_read_b64_tr_b16 v[70:71], v9 offset:10240
  v_mfma_f32_16x16x32_bf16 v[196:199], v[80:83], a[100:103], v[196:199]
  ds_read_b64_tr_b16 v[72:73], v10 offset:24576
  v_mfma_f32_16x16x32_bf16 v[196:199], v[84:87], a[116:119], v[196:199]
  ds_read_b64_tr_b16 v[74:75], v10 offset:26624
  v_mfma_f32_16x16x32_bf16 v[196:199], v[88:91], a[132:135], v[196:199]
  ds_read_b64_tr_b16 v[76:77], v10 offset:28672
  v_mfma_f32_16x16x32_bf16 v[200:203], v[80:83], a[104:107], v[200:203]
  ds_read_b64_tr_b16 v[78:79], v10 offset:30720
  v_mfma_f32_16x16x32_bf16 v[200:203], v[84:87], a[120:123], v[200:203]
  s_add_u32 m0, s33, 32768
  v_mfma_f32_16x16x32_bf16 v[200:203], v[88:91], a[136:139], v[200:203]
  s_mov_b32 s34, 4129152
  v_mfma_f32_16x16x32_bf16 v[204:207], v[80:83], a[108:111], v[204:207]
  buffer_load_dwordx4 v19, s[8:11], s34 offen lds
  v_mfma_f32_16x16x32_bf16 v[204:207], v[84:87], a[124:127], v[204:207]
  v_mfma_f32_16x16x32_bf16 v[204:207], v[88:91], a[140:143], v[204:207]
  s_waitcnt lgkmcnt(6)
  v_mfma_f32_16x16x32_bf16 v[208:211], v[56:59], a[96:99], v[208:211]
  ds_read_b64_tr_b16 v[80:81], v12 offset:8192
  v_mfma_f32_16x16x32_bf16 v[208:211], v[60:63], a[112:115], v[208:211]
  ds_read_b64_tr_b16 v[82:83], v12 offset:10240
  v_mfma_f32_16x16x32_bf16 v[208:211], v[64:67], a[128:131], v[208:211]
  ds_read_b64_tr_b16 v[84:85], v13 offset:24576
  v_mfma_f32_16x16x32_bf16 v[212:215], v[56:59], a[100:103], v[212:215]
  ds_read_b64_tr_b16 v[86:87], v13 offset:26624
  v_mfma_f32_16x16x32_bf16 v[212:215], v[60:63], a[116:119], v[212:215]
  ds_read_b64_tr_b16 v[88:89], v13 offset:28672
  v_mfma_f32_16x16x32_bf16 v[212:215], v[64:67], a[132:135], v[212:215]
  ds_read_b64_tr_b16 v[90:91], v13 offset:30720
  v_mfma_f32_16x16x32_bf16 v[216:219], v[56:59], a[104:107], v[216:219]
  s_add_u32 m0, s33, 36864
  v_mfma_f32_16x16x32_bf16 v[216:219], v[60:63], a[120:123], v[216:219]
  s_mov_b32 s34, 4424064
  v_mfma_f32_16x16x32_bf16 v[216:219], v[64:67], a[136:139], v[216:219]
  buffer_load_dwordx4 v19, s[4:7], s34 offen lds
  v_mfma_f32_16x16x32_bf16 v[220:223], v[56:59], a[108:111], v[220:223]
  s_add_u32 m0, s33, 114688
  v_mfma_f32_16x16x32_bf16 v[220:223], v[60:63], a[124:127], v[220:223]
  s_mov_b32 s34, 4718976
  v_mfma_f32_16x16x32_bf16 v[220:223], v[64:67], a[140:143], v[220:223]
  buffer_load_dwordx4 v19, s[4:7], s34 offen lds
  s_waitcnt lgkmcnt(6)
  v_mfma_f32_16x16x32_bf16 v[224:227], v[68:71], a[96:99], v[224:227]
  ds_read_b64_tr_b16 v[56:57], v9 offset:12288
  s_add_u32 s28, s90, 7266304
  s_addc_u32 s29, s91, 0
  v_mfma_f32_16x16x32_bf16 v[224:227], v[72:75], a[112:115], v[224:227]
  ds_read_b64_tr_b16 v[58:59], v9 offset:14336
  s_and_b32 s29, s29, 0xffff
  v_mfma_f32_16x16x32_bf16 v[224:227], v[76:79], a[128:131], v[224:227]
  ds_read_b64_tr_b16 v[60:61], v9 offset:16384
  s_mov_b32 s30, 37748736
  v_mfma_f32_16x16x32_bf16 v[228:231], v[68:71], a[100:103], v[228:231]
  ds_read_b64_tr_b16 v[62:63], v9 offset:18432
  s_mov_b32 s31, 0x20000
  v_mfma_f32_16x16x32_bf16 v[228:231], v[72:75], a[116:119], v[228:231]
  ds_read_b64_tr_b16 v[64:65], v9 offset:20480
  s_add_u32 s48, s90, 7102464
  s_addc_u32 s49, s91, 0
  v_mfma_f32_16x16x32_bf16 v[228:231], v[76:79], a[132:135], v[228:231]
  ds_read_b64_tr_b16 v[66:67], v9 offset:22528
  s_and_b32 s49, s49, 0xffff
  v_mfma_f32_16x16x32_bf16 v[232:235], v[68:71], a[104:107], v[232:235]
  s_add_u32 m0, s33, 118784
  s_mov_b32 s50, 131072
  v_mfma_f32_16x16x32_bf16 v[232:235], v[72:75], a[120:123], v[232:235]
  s_mov_b32 s34, 5013888
  s_mov_b32 s51, 0x20000
  v_mfma_f32_16x16x32_bf16 v[232:235], v[76:79], a[136:139], v[232:235]
  buffer_load_dwordx4 v19, s[4:7], s34 offen lds
  s_add_u32 s52, s90, 7086080
  s_addc_u32 s53, s91, 0
  v_mfma_f32_16x16x32_bf16 v[236:239], v[68:71], a[108:111], v[236:239]
  s_and_b32 s53, s53, 0xffff
  v_mfma_f32_16x16x32_bf16 v[236:239], v[72:75], a[124:127], v[236:239]
  s_mov_b32 s54, 8192
  v_mfma_f32_16x16x32_bf16 v[236:239], v[76:79], a[140:143], v[236:239]
  s_mov_b32 s55, 0x20000
  s_waitcnt lgkmcnt(6)
  v_mfma_f32_16x16x32_bf16 v[240:243], v[80:83], a[96:99], v[240:243]
  ds_read_b64_tr_b16 v[68:69], v12 offset:12288
  s_add_u32 s56, s90, 7094272
  s_addc_u32 s57, s91, 0
  v_mfma_f32_16x16x32_bf16 v[240:243], v[84:87], a[112:115], v[240:243]
  ds_read_b64_tr_b16 v[70:71], v12 offset:14336
  s_and_b32 s57, s57, 0xffff
  v_mfma_f32_16x16x32_bf16 v[240:243], v[88:91], a[128:131], v[240:243]
  ds_read_b64_tr_b16 v[72:73], v12 offset:16384
  s_mov_b32 s58, 8192
  v_mfma_f32_16x16x32_bf16 v[244:247], v[80:83], a[100:103], v[244:247]
  ds_read_b64_tr_b16 v[74:75], v12 offset:18432
  s_mov_b32 s59, 0x20000
  v_mfma_f32_16x16x32_bf16 v[244:247], v[84:87], a[116:119], v[244:247]
  ds_read_b64_tr_b16 v[76:77], v12 offset:20480
  v_and_b32 v1, 63, v0
  v_mfma_f32_16x16x32_bf16 v[244:247], v[88:91], a[132:135], v[244:247]
  ds_read_b64_tr_b16 v[78:79], v12 offset:22528
  v_lshrrev_b32 v2, 4, v1
  v_mfma_f32_16x16x32_bf16 v[248:251], v[80:83], a[104:107], v[248:251]
  s_add_u32 m0, s33, 122880
  v_mov_b32 v169, 0x7ffffff0
  v_mfma_f32_16x16x32_bf16 v[248:251], v[84:87], a[120:123], v[248:251]
  s_mov_b32 s34, 4424064
  s_lshl_b32 s36, s93, 4
  v_mfma_f32_16x16x32_bf16 v[248:251], v[88:91], a[136:139], v[248:251]
  buffer_load_dwordx4 v19, s[8:11], s34 offen lds
  s_add_u32 s36, s36, s94
  v_mfma_f32_16x16x32_bf16 v[252:255], v[80:83], a[108:111], v[252:255]
  s_add_u32 m0, s33, 40960
  s_lshl_b32 s37, s36, 3
  v_mfma_f32_16x16x32_bf16 v[252:255], v[84:87], a[124:127], v[252:255]
  s_mov_b32 s34, 4718976
  v_and_b32 v4, 7, v1
  v_mfma_f32_16x16x32_bf16 v[252:255], v[88:91], a[140:143], v[252:255]
  buffer_load_dwordx4 v19, s[8:11], s34 offen lds
  s_waitcnt lgkmcnt(6)
  v_mfma_f32_16x16x32_bf16 v[192:195], v[56:59], a[144:147], v[192:195]
  s_waitcnt vmcnt(8)
  s_barrier
  v_mfma_f32_16x16x32_bf16 v[192:195], v[60:63], a[160:163], v[192:195]
  ds_read_b64_tr_b16 v[80:81], v8
  v_add_u32 v5, s37, v4
  v_mfma_f32_16x16x32_bf16 v[192:195], v[64:67], a[176:179], v[192:195]
  ds_read_b64_tr_b16 v[82:83], v8 offset:2048
  v_lshlrev_b32 v165, 2, v5
  v_mfma_f32_16x16x32_bf16 v[196:199], v[56:59], a[148:151], v[196:199]
  ds_read_b64_tr_b16 v[84:85], v8 offset:4096
  v_lshrrev_b32 v6, 3, v1
  v_mfma_f32_16x16x32_bf16 v[196:199], v[60:63], a[164:167], v[196:199]
  ds_read_b64_tr_b16 v[86:87], v8 offset:6144
  v_lshlrev_b32 v6, 3, v6
  v_mfma_f32_16x16x32_bf16 v[196:199], v[64:67], a[180:183], v[196:199]
  ds_read_b64_tr_b16 v[88:89], v8 offset:8192
  v_lshl_add_u32 v166, v5, 6, v6
  v_mfma_f32_16x16x32_bf16 v[200:203], v[56:59], a[152:155], v[200:203]
  ds_read_b64_tr_b16 v[90:91], v8 offset:10240
  buffer_load_dwordx2 v[190:191], v166, s[48:51], 0 offen sc1
  v_mfma_f32_16x16x32_bf16 v[200:203], v[60:63], a[168:171], v[200:203]
  s_add_u32 m0, s33, 45056
  buffer_load_dword v189, v165, s[52:55], 0 offen sc1
  v_mfma_f32_16x16x32_bf16 v[200:203], v[64:67], a[184:187], v[200:203]
  s_mov_b32 s34, 5013888
  buffer_load_dword v188, v165, s[56:59], 0 offen sc1
  v_mfma_f32_16x16x32_bf16 v[204:207], v[56:59], a[156:159], v[204:207]
  buffer_load_dwordx4 v19, s[8:11], s34 offen lds
  v_lshlrev_b32 v168, 4, v4
  v_mfma_f32_16x16x32_bf16 v[204:207], v[60:63], a[172:175], v[204:207]
  v_add_u32 v168, 163328, v168
  v_mfma_f32_16x16x32_bf16 v[204:207], v[64:67], a[188:191], v[204:207]
  s_lshl_b32 s37, s92, 2
  s_waitcnt lgkmcnt(6)
  v_mfma_f32_16x16x32_bf16 v[208:211], v[68:71], a[144:147], v[208:211]
  ds_read_b64_tr_b16 v[56:57], v11
  v_add_u32 v167, s37, v168
  v_mfma_f32_16x16x32_bf16 v[208:211], v[72:75], a[160:163], v[208:211]
  ds_read_b64_tr_b16 v[58:59], v11 offset:2048
  v_mul_u32_u24 v5, 1152, v5
  v_mfma_f32_16x16x32_bf16 v[208:211], v[76:79], a[176:179], v[208:211]
  ds_read_b64_tr_b16 v[60:61], v11 offset:4096
  v_bfe_u32 v6, v1, 3, 1
  v_mfma_f32_16x16x32_bf16 v[212:215], v[68:71], a[148:151], v[212:215]
  ds_read_b64_tr_b16 v[62:63], v11 offset:6144
  v_lshl_add_u32 v5, v6, 3, v5
  v_mfma_f32_16x16x32_bf16 v[212:215], v[72:75], a[164:167], v[212:215]
  ds_read_b64_tr_b16 v[64:65], v11 offset:8192
  s_lshr_b32 s37, s92, 1
  v_mfma_f32_16x16x32_bf16 v[212:215], v[76:79], a[180:183], v[212:215]
  ds_read_b64_tr_b16 v[66:67], v11 offset:10240
  s_lshl_b32 s37, s37, 6
  v_mfma_f32_16x16x32_bf16 v[216:219], v[68:71], a[152:155], v[216:219]
  s_add_u32 m0, s33, 49152
  s_and_b32 s38, s92, 1
  v_mfma_f32_16x16x32_bf16 v[216:219], v[72:75], a[168:171], v[216:219]
  s_mov_b32 s34, 0
  s_lshl_b32 s38, s38, 4
  v_mfma_f32_16x16x32_bf16 v[216:219], v[76:79], a[184:187], v[216:219]
  buffer_load_dwordx4 v20, s[24:27], s34 offen lds
  s_add_u32 s37, s37, s38
  v_mfma_f32_16x16x32_bf16 v[220:223], v[68:71], a[156:159], v[220:223]
  s_add_u32 m0, s33, 53248
  v_add_u32 v5, s37, v5
  v_mfma_f32_16x16x32_bf16 v[220:223], v[72:75], a[172:175], v[220:223]
  s_mov_b32 s34, 294912
  v_lshl_add_u32 v163, v2, 7, v5
  v_mfma_f32_16x16x32_bf16 v[220:223], v[76:79], a[188:191], v[220:223]
  buffer_load_dwordx4 v20, s[24:27], s34 offen lds
  s_waitcnt lgkmcnt(6)
  v_mfma_f32_16x16x32_bf16 v[224:227], v[80:83], a[144:147], v[224:227]
  ds_read_b64_tr_b16 v[68:69], v8 offset:12288
  v_lshrrev_b32 v164, 1, v2
  v_mfma_f32_16x16x32_bf16 v[224:227], v[84:87], a[160:163], v[224:227]
  ds_read_b64_tr_b16 v[70:71], v8 offset:14336
  v_lshl_add_u32 v5, v164, 5, v5
  v_mfma_f32_16x16x32_bf16 v[224:227], v[88:91], a[176:179], v[224:227]
  ds_read_b64_tr_b16 v[72:73], v8 offset:16384
  v_and_b32 v164, 1, v2
  v_mfma_f32_16x16x32_bf16 v[228:231], v[80:83], a[148:151], v[228:231]
  ds_read_b64_tr_b16 v[74:75], v8 offset:18432
  v_lshl_add_u32 v164, v164, 2, v5
  v_mfma_f32_16x16x32_bf16 v[228:231], v[84:87], a[164:167], v[228:231]
  ds_read_b64_tr_b16 v[76:77], v8 offset:20480
  s_lshr_b32 s37, s36, 1
  v_mfma_f32_16x16x32_bf16 v[228:231], v[88:91], a[180:183], v[228:231]
  ds_read_b64_tr_b16 v[78:79], v8 offset:22528
  s_mul_i32 s37, s37, 18432
  v_mfma_f32_16x16x32_bf16 v[232:235], v[80:83], a[152:155], v[232:235]
  s_add_u32 m0, s33, 57344
  s_and_b32 s38, s36, 1
  v_mfma_f32_16x16x32_bf16 v[232:235], v[84:87], a[168:171], v[232:235]
  s_mov_b32 s34, 589824
  s_lshl_b32 s38, s38, 7
  v_mfma_f32_16x16x32_bf16 v[232:235], v[88:91], a[184:187], v[232:235]
  buffer_load_dwordx4 v20, s[24:27], s34 offen lds
  s_add_u32 s37, s37, s38
  v_mfma_f32_16x16x32_bf16 v[236:239], v[80:83], a[156:159], v[236:239]
  s_lshl_b32 s38, s92, 9
  v_mfma_f32_16x16x32_bf16 v[236:239], v[84:87], a[172:175], v[236:239]
  s_add_u32 s37, s37, s38
  v_mfma_f32_16x16x32_bf16 v[236:239], v[88:91], a[188:191], v[236:239]
  v_lshlrev_b32 v4, 4, v4
  s_waitcnt lgkmcnt(6)
  v_mfma_f32_16x16x32_bf16 v[240:243], v[56:59], a[144:147], v[240:243]
  ds_read_b64_tr_b16 v[80:81], v11 offset:12288
  v_lshl_add_u32 v4, v6, 8, v4
  v_mfma_f32_16x16x32_bf16 v[240:243], v[60:63], a[160:163], v[240:243]
  ds_read_b64_tr_b16 v[82:83], v11 offset:14336
  v_add_u32 v4, s37, v4
  v_mfma_f32_16x16x32_bf16 v[240:243], v[64:67], a[176:179], v[240:243]
  ds_read_b64_tr_b16 v[84:85], v11 offset:16384
  v_lshl_add_u32 v161, v2, 2, v4
  v_mfma_f32_16x16x32_bf16 v[244:247], v[56:59], a[148:151], v[244:247]
  ds_read_b64_tr_b16 v[86:87], v11 offset:18432
  v_lshl_add_u32 v162, v2, 11, v4
  v_mfma_f32_16x16x32_bf16 v[244:247], v[60:63], a[164:167], v[244:247]
  ds_read_b64_tr_b16 v[88:89], v11 offset:20480
  s_mov_b32 s37, 2359296
  v_mfma_f32_16x16x32_bf16 v[244:247], v[64:67], a[180:183], v[244:247]
  ds_read_b64_tr_b16 v[90:91], v11 offset:22528
  v_mul_lo_u32 v5, v2, s37
  v_mfma_f32_16x16x32_bf16 v[248:251], v[56:59], a[152:155], v[248:251]
  s_add_u32 m0, s33, 61440
  v_add_u32 v160, v4, v5
  v_mfma_f32_16x16x32_bf16 v[248:251], v[60:63], a[168:171], v[248:251]
  s_mov_b32 s34, 884736
  s_mov_b32 s60, 9437184
  v_mfma_f32_16x16x32_bf16 v[248:251], v[64:67], a[184:187], v[248:251]
  buffer_load_dwordx4 v20, s[24:27], s34 offen lds
  s_mov_b32 s61, 18874368
  v_mfma_f32_16x16x32_bf16 v[252:255], v[56:59], a[156:159], v[252:255]
  s_add_u32 m0, s33, 65536
  s_mov_b32 s62, 28311552
  v_mfma_f32_16x16x32_bf16 v[252:255], v[60:63], a[172:175], v[252:255]
  s_mov_b32 s34, 1179648
  s_mov_b32 s65, 0
  v_mfma_f32_16x16x32_bf16 v[252:255], v[64:67], a[188:191], v[252:255]
  buffer_load_dwordx4 v20, s[24:27], s34 offen lds
  s_waitcnt lgkmcnt(6)
  v_mfma_f32_16x16x32_bf16 v[192:195], v[68:71], a[192:195], v[192:195]
  s_waitcnt vmcnt(11)
  s_barrier
  v_mfma_f32_16x16x32_bf16 v[192:195], v[72:75], a[208:211], v[192:195]
  ds_read_b64_tr_b16 v[56:57], v8 offset:24576
  buffer_load_dword v170, v161, s[16:19], s65 offen sc1
  v_mfma_f32_16x16x32_bf16 v[192:195], v[76:79], a[224:227], v[192:195]
  ds_read_b64_tr_b16 v[58:59], v8 offset:26624
  buffer_load_dword v171, v161, s[16:19], s65 offen offset:2048 sc1
  v_mfma_f32_16x16x32_bf16 v[196:199], v[68:71], a[196:199], v[196:199]
  ds_read_b64_tr_b16 v[60:61], v8 offset:28672
  s_mov_b32 s65, 4096
  v_mfma_f32_16x16x32_bf16 v[196:199], v[72:75], a[212:215], v[196:199]
  ds_read_b64_tr_b16 v[62:63], v8 offset:30720
  buffer_load_dword v172, v161, s[16:19], s65 offen sc1
  v_mfma_f32_16x16x32_bf16 v[196:199], v[76:79], a[228:231], v[196:199]
  ds_read_b64_tr_b16 v[64:65], v8 offset:32768
  buffer_load_dword v173, v161, s[16:19], s65 offen offset:2048 sc1
  v_mfma_f32_16x16x32_bf16 v[200:203], v[68:71], a[200:203], v[200:203]
  ds_read_b64_tr_b16 v[66:67], v8 offset:34816
  s_mov_b32 s65, 8192
  v_mfma_f32_16x16x32_bf16 v[200:203], v[72:75], a[216:219], v[200:203]
  s_add_u32 m0, s33, 69632
  buffer_load_dword v174, v161, s[16:19], s65 offen sc1
  v_mfma_f32_16x16x32_bf16 v[200:203], v[76:79], a[232:235], v[200:203]
  s_mov_b32 s34, 1474560
  buffer_load_dword v175, v161, s[16:19], s65 offen offset:2048 sc1
  v_mfma_f32_16x16x32_bf16 v[204:207], v[68:71], a[204:207], v[204:207]
  buffer_load_dwordx4 v20, s[24:27], s34 offen lds
  s_mov_b32 s65, 12288
  v_mfma_f32_16x16x32_bf16 v[204:207], v[72:75], a[220:223], v[204:207]
  buffer_load_dword v176, v161, s[16:19], s65 offen sc1
  v_mfma_f32_16x16x32_bf16 v[204:207], v[76:79], a[236:239], v[204:207]
  buffer_load_dword v177, v161, s[16:19], s65 offen offset:2048 sc1
  s_waitcnt lgkmcnt(6)
  v_mfma_f32_16x16x32_bf16 v[208:211], v[80:83], a[192:195], v[208:211]
  ds_read_b64_tr_b16 v[68:69], v11 offset:24576
  s_mov_b32 s65, 16384
  v_mfma_f32_16x16x32_bf16 v[208:211], v[84:87], a[208:211], v[208:211]
  ds_read_b64_tr_b16 v[70:71], v11 offset:26624
  buffer_load_dword v178, v161, s[16:19], s65 offen sc1
  v_mfma_f32_16x16x32_bf16 v[208:211], v[88:91], a[224:227], v[208:211]
  ds_read_b64_tr_b16 v[72:73], v11 offset:28672
  v_and_b32 v4, 1, v1
  v_mfma_f32_16x16x32_bf16 v[212:215], v[80:83], a[196:199], v[212:215]
  ds_read_b64_tr_b16 v[74:75], v11 offset:30720
  v_lshlrev_b32 v4, 4, v4
  v_mfma_f32_16x16x32_bf16 v[212:215], v[84:87], a[212:215], v[212:215]
  ds_read_b64_tr_b16 v[76:77], v11 offset:32768
  v_mov_b32 v5, 0x3f80
  v_mfma_f32_16x16x32_bf16 v[212:215], v[88:91], a[228:231], v[212:215]
  ds_read_b64_tr_b16 v[78:79], v11 offset:34816
  v_lshlrev_b32 v4, v4, v5
  v_mfma_f32_16x16x32_bf16 v[216:219], v[80:83], a[200:203], v[216:219]
  s_add_u32 m0, s33, 73728
  v_bfe_u32 v5, v1, 1, 3
  v_mfma_f32_16x16x32_bf16 v[216:219], v[84:87], a[216:219], v[216:219]
  s_mov_b32 s34, 1769472
  v_cmp_eq_u32 vcc, 0, v5
  v_mfma_f32_16x16x32_bf16 v[216:219], v[88:91], a[232:235], v[216:219]
  buffer_load_dwordx4 v20, s[24:27], s34 offen lds
  v_cndmask_b32 v180, 0, v4, vcc
  v_mfma_f32_16x16x32_bf16 v[220:223], v[80:83], a[204:207], v[220:223]
  s_add_u32 m0, s33, 159744
  v_cmp_eq_u32 vcc, 2, v5
  v_mfma_f32_16x16x32_bf16 v[220:223], v[84:87], a[220:223], v[220:223]
  s_mov_b32 s34, 2064384
  v_cndmask_b32 v181, 0, v4, vcc
  v_mfma_f32_16x16x32_bf16 v[220:223], v[88:91], a[236:239], v[220:223]
  buffer_load_dwordx4 v20, s[24:27], s34 offen lds
  s_waitcnt lgkmcnt(6)
  v_mfma_f32_16x16x32_bf16 v[224:227], v[56:59], a[192:195], v[224:227]
  ds_read_b64_tr_b16 v[80:81], v8 offset:36864
  v_cmp_eq_u32 vcc, 4, v5
  v_mfma_f32_16x16x32_bf16 v[224:227], v[60:63], a[208:211], v[224:227]
  ds_read_b64_tr_b16 v[82:83], v8 offset:38912
  v_cndmask_b32 v182, 0, v4, vcc
  v_mfma_f32_16x16x32_bf16 v[224:227], v[64:67], a[224:227], v[224:227]
  ds_read_b64_tr_b16 v[84:85], v9 offset:49152
  v_cmp_eq_u32 vcc, 6, v5
  v_mfma_f32_16x16x32_bf16 v[228:231], v[56:59], a[196:199], v[228:231]
  ds_read_b64_tr_b16 v[86:87], v9 offset:51200
  v_cndmask_b32 v183, 0, v4, vcc
  v_mfma_f32_16x16x32_bf16 v[228:231], v[60:63], a[212:215], v[228:231]
  ds_read_b64_tr_b16 v[88:89], v9 offset:53248
  v_cmp_eq_u32 vcc, 1, v5
  v_mfma_f32_16x16x32_bf16 v[228:231], v[64:67], a[228:231], v[228:231]
  ds_read_b64_tr_b16 v[90:91], v9 offset:55296
  v_cndmask_b32 v184, 0, v4, vcc
  v_mfma_f32_16x16x32_bf16 v[232:235], v[56:59], a[200:203], v[232:235]
  s_add_u32 m0, s33, 77824
  v_cmp_eq_u32 vcc, 3, v5
  v_mfma_f32_16x16x32_bf16 v[232:235], v[60:63], a[216:219], v[232:235]
  s_mov_b32 s34, 2359296
  v_cndmask_b32 v185, 0, v4, vcc
  v_mfma_f32_16x16x32_bf16 v[232:235], v[64:67], a[232:235], v[232:235]
  buffer_load_dwordx4 v20, s[24:27], s34 offen lds
  v_cmp_eq_u32 vcc, 5, v5
  v_mfma_f32_16x16x32_bf16 v[236:239], v[56:59], a[204:207], v[236:239]
  s_nop 0
  v_cndmask_b32 v186, 0, v4, vcc
  v_mfma_f32_16x16x32_bf16 v[236:239], v[60:63], a[220:223], v[236:239]
  v_cmp_eq_u32 vcc, 7, v5
  v_mfma_f32_16x16x32_bf16 v[236:239], v[64:67], a[236:239], v[236:239]
  s_nop 0
  v_cndmask_b32 v187, 0, v4, vcc
  s_waitcnt lgkmcnt(6)
  v_mfma_f32_16x16x32_bf16 v[240:243], v[68:71], a[192:195], v[240:243]
  ds_read_b64_tr_b16 v[56:57], v11 offset:36864
  s_waitcnt vmcnt(19)
  v_add_f32 v189, v189, v188
  v_mfma_f32_16x16x32_bf16 v[240:243], v[72:75], a[208:211], v[240:243]
  ds_read_b64_tr_b16 v[58:59], v11 offset:38912
  v_add_f32 v190, v190, v191
  v_mfma_f32_16x16x32_bf16 v[240:243], v[76:79], a[224:227], v[240:243]
  ds_read_b64_tr_b16 v[60:61], v12 offset:49152
  v_add_f32_dpp v190, v190, v190 row_ror:8 row_mask:0xf bank_mask:0xf
  v_mfma_f32_16x16x32_bf16 v[244:247], v[68:71], a[196:199], v[244:247]
  ds_read_b64_tr_b16 v[62:63], v12 offset:51200
  v_mov_b32 v191, v190
  v_mfma_f32_16x16x32_bf16 v[244:247], v[72:75], a[212:215], v[244:247]
  ds_read_b64_tr_b16 v[64:65], v12 offset:53248
  v_permlane16_swap_b32 v190, v191
  v_mfma_f32_16x16x32_bf16 v[244:247], v[76:79], a[228:231], v[244:247]
  ds_read_b64_tr_b16 v[66:67], v12 offset:55296
  v_add_f32 v190, v190, v191
  v_mfma_f32_16x16x32_bf16 v[248:251], v[68:71], a[200:203], v[248:251]
  s_add_u32 m0, s33, 81920
  v_mov_b32 v191, v190
  v_mfma_f32_16x16x32_bf16 v[248:251], v[72:75], a[216:219], v[248:251]
  s_mov_b32 s34, 2654208
  v_permlane32_swap_b32 v190, v191
  v_mfma_f32_16x16x32_bf16 v[248:251], v[76:79], a[232:235], v[248:251]
  buffer_load_dwordx4 v20, s[24:27], s34 offen lds
  v_add_f32 v190, v190, v191
  v_mfma_f32_16x16x32_bf16 v[252:255], v[68:71], a[204:207], v[252:255]
  s_add_u32 m0, s33, 86016
  v_mov_b32 v191, 0x3727c5ac
  v_mfma_f32_16x16x32_bf16 v[252:255], v[72:75], a[220:223], v[252:255]
  s_mov_b32 s34, 2949120
  v_fmac_f32 v191, 0x3ae38e39, v190
  v_mfma_f32_16x16x32_bf16 v[252:255], v[76:79], a[236:239], v[252:255]
  buffer_load_dwordx4 v20, s[24:27], s34 offen lds
  s_waitcnt lgkmcnt(6)
  v_mfma_f32_16x16x32_bf16 v[192:195], v[80:83], a[240:243], v[192:195]
  s_waitcnt vmcnt(17)
  s_barrier
  v_mfma_f32_16x16x32_bf16 v[192:195], v[84:87], v[96:99], v[192:195]
  ds_read_b64_tr_b16 v[68:69], v9 offset:57344
  v_rcp_f32 v188, v191
  v_mfma_f32_16x16x32_bf16 v[192:195], v[88:91], v[112:115], v[192:195]
  ds_read_b64_tr_b16 v[70:71], v9 offset:59392
  s_add_u32 s44, s86, 0
  s_addc_u32 s45, s87, 0
  v_mfma_f32_16x16x32_bf16 v[196:199], v[80:83], a[244:247], v[196:199]
  ds_read_b64_tr_b16 v[72:73], v8 offset:40960
  s_and_b32 s45, s45, 0xffff
  v_mfma_f32_16x16x32_bf16 v[196:199], v[84:87], v[100:103], v[196:199]
  ds_read_b64_tr_b16 v[74:75], v8 offset:43008
  s_mov_b32 s46, 2064384
  v_mfma_f32_16x16x32_bf16 v[196:199], v[88:91], v[116:119], v[196:199]
  ds_read_b64_tr_b16 v[76:77], v8 offset:45056
  s_mov_b32 s47, 0x20000
  v_mfma_f32_16x16x32_bf16 v[200:203], v[80:83], a[248:251], v[200:203]
  ds_read_b64_tr_b16 v[78:79], v8 offset:47104
  s_cmp_eq_u32 s95, 0
  s_cselect_b32 s46, s46, 0
  v_mfma_f32_16x16x32_bf16 v[200:203], v[84:87], v[104:107], v[200:203]
  s_add_u32 m0, s33, 0
  s_mul_i32 s36, s94, 129024
  v_mfma_f32_16x16x32_bf16 v[200:203], v[88:91], v[120:123], v[200:203]
  s_mov_b32 s34, 3244032
  s_lshl_b32 s66, s92, 12
  v_mfma_f32_16x16x32_bf16 v[204:207], v[80:83], a[252:255], v[204:207]
  buffer_load_dwordx4 v20, s[24:27], s34 offen lds
  s_add_u32 s36, s36, s66
  v_mfma_f32_16x16x32_bf16 v[204:207], v[84:87], v[108:111], v[204:207]
  v_and_b32 v7, 63, v0
  v_mfma_f32_16x16x32_bf16 v[204:207], v[88:91], v[124:127], v[204:207]
  v_lshlrev_b32 v7, 4, v7
  s_waitcnt lgkmcnt(6)
  v_mfma_f32_16x16x32_bf16 v[208:211], v[56:59], a[240:243], v[208:211]
  ds_read_b64_tr_b16 v[80:81], v12 offset:57344
  v_add_u32 v7, s36, v7
  v_mfma_f32_16x16x32_bf16 v[208:211], v[60:63], v[96:99], v[208:211]
  ds_read_b64_tr_b16 v[82:83], v12 offset:59392
  v_mfma_f32_16x16x32_bf16 v[208:211], v[64:67], v[112:115], v[208:211]
  ds_read_b64_tr_b16 v[84:85], v11 offset:40960
  v_mfma_f32_16x16x32_bf16 v[212:215], v[56:59], a[244:247], v[212:215]
  ds_read_b64_tr_b16 v[86:87], v11 offset:43008
  v_mfma_f32_16x16x32_bf16 v[212:215], v[60:63], v[100:103], v[212:215]
  ds_read_b64_tr_b16 v[88:89], v11 offset:45056
  v_mfma_f32_16x16x32_bf16 v[212:215], v[64:67], v[116:119], v[212:215]
  ds_read_b64_tr_b16 v[90:91], v11 offset:47104
  v_mfma_f32_16x16x32_bf16 v[216:219], v[56:59], a[248:251], v[216:219]
  s_add_u32 m0, s33, 4096
  v_mfma_f32_16x16x32_bf16 v[216:219], v[60:63], v[104:107], v[216:219]
  s_mov_b32 s34, 3538944
  v_mfma_f32_16x16x32_bf16 v[216:219], v[64:67], v[120:123], v[216:219]
  buffer_load_dwordx4 v20, s[24:27], s34 offen lds
  v_mfma_f32_16x16x32_bf16 v[220:223], v[56:59], a[252:255], v[220:223]
  s_add_u32 m0, s33, 8192
  v_mfma_f32_16x16x32_bf16 v[220:223], v[60:63], v[108:111], v[220:223]
  s_mov_b32 s34, 3833856
  v_mfma_f32_16x16x32_bf16 v[220:223], v[64:67], v[124:127], v[220:223]
  buffer_load_dwordx4 v20, s[24:27], s34 offen lds
  s_waitcnt lgkmcnt(6)
  v_mfma_f32_16x16x32_bf16 v[224:227], v[68:71], a[240:243], v[224:227]
  ds_read_b64_tr_b16 v[56:57], v14 offset:49152
  v_mfma_f32_16x16x32_bf16 v[224:227], v[72:75], v[96:99], v[224:227]
  ds_read_b64_tr_b16 v[58:59], v14 offset:50176
  v_mfma_f32_16x16x32_bf16 v[224:227], v[76:79], v[112:115], v[224:227]
  ds_read_b64_tr_b16 v[60:61], v14 offset:53248
  v_mfma_f32_16x16x32_bf16 v[228:231], v[68:71], a[244:247], v[228:231]
  ds_read_b64_tr_b16 v[62:63], v14 offset:54272
  v_mfma_f32_16x16x32_bf16 v[228:231], v[72:75], v[100:103], v[228:231]
  ds_read_b64_tr_b16 v[64:65], v14 offset:57344
  v_mfma_f32_16x16x32_bf16 v[228:231], v[76:79], v[116:119], v[228:231]
  ds_read_b64_tr_b16 v[66:67], v14 offset:58368
  v_mfma_f32_16x16x32_bf16 v[232:235], v[68:71], a[248:251], v[232:235]
  s_add_u32 m0, s33, 12288
  v_mfma_f32_16x16x32_bf16 v[232:235], v[72:75], v[104:107], v[232:235]
  s_mov_b32 s34, 4128768
  v_mfma_f32_16x16x32_bf16 v[232:235], v[76:79], v[120:123], v[232:235]
  buffer_load_dwordx4 v20, s[24:27], s34 offen lds
  v_mfma_f32_16x16x32_bf16 v[236:239], v[68:71], a[252:255], v[236:239]
  v_mfma_f32_16x16x32_bf16 v[236:239], v[72:75], v[108:111], v[236:239]
  v_mfma_f32_16x16x32_bf16 v[236:239], v[76:79], v[124:127], v[236:239]
  s_waitcnt lgkmcnt(6)
  v_mfma_f32_16x16x32_bf16 v[240:243], v[80:83], a[240:243], v[240:243]
  ds_read_b64_tr_b16 v[68:69], v14 offset:51200
  v_mfma_f32_16x16x32_bf16 v[240:243], v[84:87], v[96:99], v[240:243]
  ds_read_b64_tr_b16 v[70:71], v14 offset:52224
  v_mfma_f32_16x16x32_bf16 v[240:243], v[88:91], v[112:115], v[240:243]
  ds_read_b64_tr_b16 v[72:73], v14 offset:55296
  v_mfma_f32_16x16x32_bf16 v[244:247], v[80:83], a[244:247], v[244:247]
  ds_read_b64_tr_b16 v[74:75], v14 offset:56320
  v_mfma_f32_16x16x32_bf16 v[244:247], v[84:87], v[100:103], v[244:247]
  ds_read_b64_tr_b16 v[76:77], v14 offset:59392
  v_mfma_f32_16x16x32_bf16 v[244:247], v[88:91], v[116:119], v[244:247]
  ds_read_b64_tr_b16 v[78:79], v14 offset:60416
  v_mfma_f32_16x16x32_bf16 v[248:251], v[80:83], a[248:251], v[248:251]
  s_add_u32 m0, s33, 16384
  v_mfma_f32_16x16x32_bf16 v[248:251], v[84:87], v[104:107], v[248:251]
  s_mov_b32 s34, 4423680
  v_mfma_f32_16x16x32_bf16 v[248:251], v[88:91], v[120:123], v[248:251]
  buffer_load_dwordx4 v20, s[24:27], s34 offen lds
  v_mfma_f32_16x16x32_bf16 v[252:255], v[80:83], a[252:255], v[252:255]
  s_add_u32 m0, s33, 20480
  v_mfma_f32_16x16x32_bf16 v[252:255], v[84:87], v[108:111], v[252:255]
  s_mov_b32 s34, 4718592
  v_mfma_f32_16x16x32_bf16 v[252:255], v[88:91], v[124:127], v[252:255]
  buffer_load_dwordx4 v20, s[24:27], s34 offen lds
  s_waitcnt lgkmcnt(6)
  v_mfma_f32_16x16x32_bf16 v[128:131], v[56:59], a[0:3], 0
  s_waitcnt vmcnt(8)
  s_barrier
  v_mfma_f32_16x16x32_bf16 v[128:131], v[60:63], a[16:19], v[128:131]
  ds_read_b64_tr_b16 v[80:81], v14 offset:61440
  v_mul_f32 v192, v192, v224
  v_mfma_f32_16x16x32_bf16 v[128:131], v[64:67], a[32:35], v[128:131]
  ds_read_b64_tr_b16 v[82:83], v14 offset:62464
  v_mul_f32 v193, v193, v225
  v_mfma_f32_16x16x32_bf16 v[132:135], v[56:59], a[4:7], 0
  ds_read_b64_tr_b16 v[84:85], v15
  v_mul_f32 v194, v194, v226
  v_mfma_f32_16x16x32_bf16 v[132:135], v[60:63], a[20:23], v[132:135]
  ds_read_b64_tr_b16 v[86:87], v15 offset:1024
  v_mul_f32 v195, v195, v227
  v_mfma_f32_16x16x32_bf16 v[132:135], v[64:67], a[36:39], v[132:135]
  ds_read_b64_tr_b16 v[88:89], v15 offset:4096
  v_cvt_pk_bf16_f32 v32, v192, v193
  v_mfma_f32_16x16x32_bf16 v[136:139], v[56:59], a[8:11], 0
  ds_read_b64_tr_b16 v[90:91], v15 offset:5120
  v_cvt_pk_bf16_f32 v33, v194, v195
  v_mfma_f32_16x16x32_bf16 v[136:139], v[60:63], a[24:27], v[136:139]
  s_add_u32 m0, s33, 24576
  v_mul_f32 v208, v208, v240
  v_mfma_f32_16x16x32_bf16 v[136:139], v[64:67], a[40:43], v[136:139]
  s_mov_b32 s34, 5013504
  v_mul_f32 v209, v209, v241
  v_mfma_f32_16x16x32_bf16 v[140:143], v[56:59], a[12:15], 0
  buffer_load_dwordx4 v20, s[24:27], s34 offen lds
  v_mul_f32 v210, v210, v242
  v_mfma_f32_16x16x32_bf16 v[140:143], v[60:63], a[28:31], v[140:143]
  v_mul_f32 v211, v211, v243
  v_cvt_pk_bf16_f32 v34, v208, v209
  v_mfma_f32_16x16x32_bf16 v[140:143], v[64:67], a[44:47], v[140:143]
  v_cvt_pk_bf16_f32 v35, v210, v211
  s_waitcnt lgkmcnt(6)
  v_mfma_f32_16x16x32_bf16 v[144:147], v[68:71], a[0:3], 0
  ds_read_b64_tr_b16 v[56:57], v14 offset:63488
  ds_write_b128 v17, v[32:35] offset:24576
  v_mfma_f32_16x16x32_bf16 v[144:147], v[72:75], a[16:19], v[144:147]
  ds_read_b64_tr_b16 v[58:59], v14 offset:64512
  v_mul_f32 v196, v196, v228
  v_mfma_f32_16x16x32_bf16 v[144:147], v[76:79], a[32:35], v[144:147]
  ds_read_b64_tr_b16 v[60:61], v15 offset:2048
  v_mul_f32 v197, v197, v229
  v_mfma_f32_16x16x32_bf16 v[148:151], v[68:71], a[4:7], 0
  ds_read_b64_tr_b16 v[62:63], v15 offset:3072
  v_mul_f32 v198, v198, v230
  v_mfma_f32_16x16x32_bf16 v[148:151], v[72:75], a[20:23], v[148:151]
  ds_read_b64_tr_b16 v[64:65], v15 offset:6144
  v_mul_f32 v199, v199, v231
  v_mfma_f32_16x16x32_bf16 v[148:151], v[76:79], a[36:39], v[148:151]
  ds_read_b64_tr_b16 v[66:67], v15 offset:7168
  v_cvt_pk_bf16_f32 v36, v196, v197
  v_mfma_f32_16x16x32_bf16 v[152:155], v[68:71], a[8:11], 0
  s_add_u32 m0, s33, 28672
  v_cvt_pk_bf16_f32 v37, v198, v199
  v_mfma_f32_16x16x32_bf16 v[152:155], v[72:75], a[24:27], v[152:155]
  s_mov_b32 s34, 0
  v_mul_f32 v212, v212, v244
  v_mfma_f32_16x16x32_bf16 v[152:155], v[76:79], a[40:43], v[152:155]
  buffer_load_dwordx4 v21, s[12:15], s34 offen lds
  v_mul_f32 v213, v213, v245
  v_mfma_f32_16x16x32_bf16 v[156:159], v[68:71], a[12:15], 0
  s_add_u32 m0, s33, 32768
  v_mul_f32 v214, v214, v246
  v_mfma_f32_16x16x32_bf16 v[156:159], v[72:75], a[28:31], v[156:159]
  s_mov_b32 s34, 36864
  v_mul_f32 v215, v215, v247
  v_mfma_f32_16x16x32_bf16 v[156:159], v[76:79], a[44:47], v[156:159]
  buffer_load_dwordx4 v21, s[12:15], s34 offen lds
  s_waitcnt lgkmcnt(7)
  v_mfma_f32_16x16x32_bf16 v[128:131], v[80:83], a[48:51], v[128:131]
  ds_read_b64_tr_b16 v[68:69], v15 offset:8192
  v_cvt_pk_bf16_f32 v38, v212, v213
  v_mfma_f32_16x16x32_bf16 v[128:131], v[84:87], a[64:67], v[128:131]
  ds_read_b64_tr_b16 v[70:71], v15 offset:9216
  v_cvt_pk_bf16_f32 v39, v214, v215
  v_mfma_f32_16x16x32_bf16 v[128:131], v[88:91], a[80:83], v[128:131]
  ds_read_b64_tr_b16 v[72:73], v25 offset:28672
  ds_write_b128 v17, v[36:39] offset:25600
  v_mfma_f32_16x16x32_bf16 v[132:135], v[80:83], a[52:55], v[132:135]
  ds_read_b64_tr_b16 v[74:75], v25 offset:29696
  v_mul_f32 v200, v200, v232
  v_mfma_f32_16x16x32_bf16 v[132:135], v[84:87], a[68:71], v[132:135]
  ds_read_b64_tr_b16 v[76:77], v15 offset:12288
  v_mul_f32 v201, v201, v233
  v_mfma_f32_16x16x32_bf16 v[132:135], v[88:91], a[84:87], v[132:135]
  ds_read_b64_tr_b16 v[78:79], v15 offset:13312
  v_mul_f32 v202, v202, v234
  v_mfma_f32_16x16x32_bf16 v[136:139], v[80:83], a[56:59], v[136:139]
  s_add_u32 m0, s33, 36864
  v_mul_f32 v203, v203, v235
  v_mfma_f32_16x16x32_bf16 v[136:139], v[84:87], a[72:75], v[136:139]
  s_mov_b32 s34, 73728
  v_cvt_pk_bf16_f32 v32, v200, v201
  v_mfma_f32_16x16x32_bf16 v[136:139], v[88:91], a[88:91], v[136:139]
  buffer_load_dwordx4 v21, s[12:15], s34 offen lds
  v_cvt_pk_bf16_f32 v33, v202, v203
  v_mfma_f32_16x16x32_bf16 v[140:143], v[80:83], a[60:63], v[140:143]
  v_mul_f32 v216, v216, v248
  v_mul_f32 v217, v217, v249
  v_mfma_f32_16x16x32_bf16 v[140:143], v[84:87], a[76:79], v[140:143]
  v_mul_f32 v218, v218, v250
  v_mul_f32 v219, v219, v251
  v_mfma_f32_16x16x32_bf16 v[140:143], v[88:91], a[92:95], v[140:143]
  v_cvt_pk_bf16_f32 v34, v216, v217
  s_waitcnt lgkmcnt(7)
  v_mfma_f32_16x16x32_bf16 v[144:147], v[56:59], a[48:51], v[144:147]
  s_waitcnt vmcnt(9)
  s_barrier
  v_mfma_f32_16x16x32_bf16 v[144:147], v[60:63], a[64:67], v[144:147]
  ds_read_b64_tr_b16 v[80:81], v15 offset:10240
  v_cvt_pk_bf16_f32 v35, v218, v219
  v_mfma_f32_16x16x32_bf16 v[144:147], v[64:67], a[80:83], v[144:147]
  ds_read_b64_tr_b16 v[82:83], v15 offset:11264
  ds_write_b128 v17, v[32:35] offset:26624
  v_mfma_f32_16x16x32_bf16 v[148:151], v[56:59], a[52:55], v[148:151]
  ds_read_b64_tr_b16 v[84:85], v25 offset:30720
  v_mul_f32 v204, v204, v236
  v_mfma_f32_16x16x32_bf16 v[148:151], v[60:63], a[68:71], v[148:151]
  ds_read_b64_tr_b16 v[86:87], v25 offset:31744
  v_mul_f32 v205, v205, v237
  v_mfma_f32_16x16x32_bf16 v[148:151], v[64:67], a[84:87], v[148:151]
  ds_read_b64_tr_b16 v[88:89], v15 offset:14336
  v_mul_f32 v206, v206, v238
  v_mfma_f32_16x16x32_bf16 v[152:155], v[56:59], a[56:59], v[152:155]
  ds_read_b64_tr_b16 v[90:91], v15 offset:15360
  v_mul_f32 v207, v207, v239
  v_mfma_f32_16x16x32_bf16 v[152:155], v[60:63], a[72:75], v[152:155]
  s_add_u32 m0, s33, 40960
  v_cvt_pk_bf16_f32 v36, v204, v205
  v_mfma_f32_16x16x32_bf16 v[152:155], v[64:67], a[88:91], v[152:155]
  s_mov_b32 s34, 110592
  v_cvt_pk_bf16_f32 v37, v206, v207
  v_mfma_f32_16x16x32_bf16 v[156:159], v[56:59], a[60:63], v[156:159]
  buffer_load_dwordx4 v21, s[12:15], s34 offen lds
  v_mul_f32 v220, v220, v252
  v_mfma_f32_16x16x32_bf16 v[156:159], v[60:63], a[76:79], v[156:159]
  s_add_u32 m0, s33, 45056
  v_mul_f32 v221, v221, v253
  v_mfma_f32_16x16x32_bf16 v[156:159], v[64:67], a[92:95], v[156:159]
  s_mov_b32 s34, 147456
  buffer_load_dwordx4 v21, s[12:15], s34 offen lds
  s_waitcnt lgkmcnt(7)
  v_mfma_f32_16x16x32_bf16 v[128:131], v[68:71], a[96:99], v[128:131]
  ds_read_b64_tr_b16 v[56:57], v15 offset:16384
  v_mul_f32 v222, v222, v254
  v_mfma_f32_16x16x32_bf16 v[128:131], v[72:75], a[112:115], v[128:131]
  ds_read_b64_tr_b16 v[58:59], v15 offset:17408
  v_mul_f32 v223, v223, v255
  v_mfma_f32_16x16x32_bf16 v[128:131], v[76:79], a[128:131], v[128:131]
  ds_read_b64_tr_b16 v[60:61], v15 offset:20480
  v_cvt_pk_bf16_f32 v38, v220, v221
  v_mfma_f32_16x16x32_bf16 v[132:135], v[68:71], a[100:103], v[132:135]
  ds_read_b64_tr_b16 v[62:63], v15 offset:21504
  v_cvt_pk_bf16_f32 v39, v222, v223
  v_mfma_f32_16x16x32_bf16 v[132:135], v[72:75], a[116:119], v[132:135]
  ds_read_b64_tr_b16 v[64:65], v14
  ds_write_b128 v17, v[36:39] offset:27648
  v_mfma_f32_16x16x32_bf16 v[132:135], v[76:79], a[132:135], v[132:135]
  ds_read_b64_tr_b16 v[66:67], v14 offset:1024
  ds_read_b128 a[0:3], v16
  v_mfma_f32_16x16x32_bf16 v[136:139], v[68:71], a[104:107], v[136:139]
  s_add_u32 m0, s33, 49152
  ds_read_b128 a[4:7], v16 offset:1024
  v_mfma_f32_16x16x32_bf16 v[136:139], v[72:75], a[120:123], v[136:139]
  s_mov_b32 s34, 184320
  ds_read_b128 a[8:11], v16 offset:2048
  v_mfma_f32_16x16x32_bf16 v[136:139], v[76:79], a[136:139], v[136:139]
  buffer_load_dwordx4 v21, s[12:15], s34 offen lds
  ds_read_b128 a[12:15], v16 offset:3072
  v_mfma_f32_16x16x32_bf16 v[140:143], v[68:71], a[108:111], v[140:143]
  ds_read_b128 a[16:19], v16 offset:4096
  ds_read_b128 a[20:23], v16 offset:5120
  v_mfma_f32_16x16x32_bf16 v[140:143], v[72:75], a[124:127], v[140:143]
  ds_read_b128 a[24:27], v16 offset:6144
  ds_read_b128 a[28:31], v16 offset:7168
  v_mfma_f32_16x16x32_bf16 v[140:143], v[76:79], a[140:143], v[140:143]
  ds_read_b128 a[32:35], v16 offset:8192
  s_waitcnt lgkmcnt(15)
  v_mfma_f32_16x16x32_bf16 v[144:147], v[80:83], a[96:99], v[144:147]
  ds_read_b64_tr_b16 v[68:69], v15 offset:18432
  ds_read_b128 a[36:39], v16 offset:9216
  v_mfma_f32_16x16x32_bf16 v[144:147], v[84:87], a[112:115], v[144:147]
  ds_read_b64_tr_b16 v[70:71], v15 offset:19456
  ds_read_b128 a[40:43], v16 offset:10240
  v_mfma_f32_16x16x32_bf16 v[144:147], v[88:91], a[128:131], v[144:147]
  ds_read_b64_tr_b16 v[72:73], v15 offset:22528
  ds_read_b128 a[44:47], v16 offset:11264
  v_mfma_f32_16x16x32_bf16 v[148:151], v[80:83], a[100:103], v[148:151]
  ds_read_b64_tr_b16 v[74:75], v15 offset:23552
  ds_read_b128 a[48:51], v16 offset:12288
  v_mfma_f32_16x16x32_bf16 v[148:151], v[84:87], a[116:119], v[148:151]
  ds_read_b64_tr_b16 v[76:77], v14 offset:2048
  ds_read_b128 a[52:55], v16 offset:13312
  v_mfma_f32_16x16x32_bf16 v[148:151], v[88:91], a[132:135], v[148:151]
  ds_read_b64_tr_b16 v[78:79], v14 offset:3072
  ds_read_b128 a[56:59], v16 offset:14336
  v_mfma_f32_16x16x32_bf16 v[152:155], v[80:83], a[104:107], v[152:155]
  s_add_u32 m0, s33, 53248
  ds_read_b128 a[60:63], v16 offset:15360
  v_mfma_f32_16x16x32_bf16 v[152:155], v[84:87], a[120:123], v[152:155]
  s_mov_b32 s34, 221184
  ds_read_b128 a[64:67], v16 offset:16384
  v_mfma_f32_16x16x32_bf16 v[152:155], v[88:91], a[136:139], v[152:155]
  buffer_load_dwordx4 v21, s[12:15], s34 offen lds
  ds_read_b128 a[68:71], v16 offset:17408
  v_mfma_f32_16x16x32_bf16 v[156:159], v[80:83], a[108:111], v[156:159]
  s_add_u32 m0, s33, 57344
  ds_read_b128 a[72:75], v16 offset:18432
  v_mfma_f32_16x16x32_bf16 v[156:159], v[84:87], a[124:127], v[156:159]
  s_mov_b32 s34, 258048
  ds_read_b128 a[76:79], v16 offset:19456
  v_mfma_f32_16x16x32_bf16 v[156:159], v[88:91], a[140:143], v[156:159]
  buffer_load_dwordx4 v21, s[12:15], s34 offen lds
  s_waitcnt lgkmcnt(15)
  v_mfma_f32_16x16x32_bf16 v[128:131], v[56:59], a[144:147], v[128:131]
  s_waitcnt vmcnt(8)
  s_barrier
  v_mfma_f32_16x16x32_bf16 v[128:131], v[60:63], a[160:163], v[128:131]
  ds_read_b64_tr_b16 v[80:81], v14 offset:4096
  ds_read_b128 a[80:83], v16 offset:20480
  v_mfma_f32_16x16x32_bf16 v[128:131], v[64:67], a[176:179], v[128:131]
  ds_read_b64_tr_b16 v[82:83], v14 offset:5120
  ds_read_b128 a[84:87], v16 offset:21504
  v_mfma_f32_16x16x32_bf16 v[132:135], v[56:59], a[148:151], v[132:135]
  ds_read_b64_tr_b16 v[84:85], v14 offset:8192
  ds_read_b128 a[88:91], v16 offset:22528
  v_mfma_f32_16x16x32_bf16 v[132:135], v[60:63], a[164:167], v[132:135]
  ds_read_b64_tr_b16 v[86:87], v14 offset:9216
  ds_read_b128 a[92:95], v16 offset:23552
  v_mfma_f32_16x16x32_bf16 v[132:135], v[64:67], a[180:183], v[132:135]
  ds_read_b64_tr_b16 v[88:89], v14 offset:12288
  ds_read_b128 a[96:99], v16 offset:24576
  v_mfma_f32_16x16x32_bf16 v[136:139], v[56:59], a[152:155], v[136:139]
  ds_read_b64_tr_b16 v[90:91], v14 offset:13312
  ds_read_b128 a[100:103], v16 offset:25600
  v_mfma_f32_16x16x32_bf16 v[136:139], v[60:63], a[168:171], v[136:139]
  s_add_u32 m0, s33, 61440
  ds_read_b128 a[104:107], v16 offset:26624
  v_mfma_f32_16x16x32_bf16 v[136:139], v[64:67], a[184:187], v[136:139]
  s_mov_b32 s34, 0
  ds_read_b128 a[108:111], v16 offset:27648
  v_mfma_f32_16x16x32_bf16 v[140:143], v[56:59], a[156:159], v[140:143]
  buffer_load_dwordx4 v22, s[12:15], s34 offen lds
  ds_read_b128 a[112:115], v16 offset:28672
  v_mfma_f32_16x16x32_bf16 v[140:143], v[60:63], a[172:175], v[140:143]
  ds_read_b128 a[116:119], v16 offset:29696
  ds_read_b128 a[120:123], v16 offset:30720
  v_mfma_f32_16x16x32_bf16 v[140:143], v[64:67], a[188:191], v[140:143]
  ds_read_b128 a[124:127], v16 offset:31744
  s_waitcnt lgkmcnt(15)
  v_mfma_f32_16x16x32_bf16 v[144:147], v[68:71], a[144:147], v[144:147]
  ds_read_b64_tr_b16 v[56:57], v14 offset:6144
  v_mfma_f32_16x16x32_bf16 v[144:147], v[72:75], a[160:163], v[144:147]
  ds_read_b64_tr_b16 v[58:59], v14 offset:7168
  v_mfma_f32_16x16x32_bf16 v[144:147], v[76:79], a[176:179], v[144:147]
  ds_read_b64_tr_b16 v[60:61], v14 offset:10240
  v_mfma_f32_16x16x32_bf16 v[148:151], v[68:71], a[148:151], v[148:151]
  ds_read_b64_tr_b16 v[62:63], v14 offset:11264
  v_mfma_f32_16x16x32_bf16 v[148:151], v[72:75], a[164:167], v[148:151]
  ds_read_b64_tr_b16 v[64:65], v14 offset:14336
  v_mfma_f32_16x16x32_bf16 v[148:151], v[76:79], a[180:183], v[148:151]
  ds_read_b64_tr_b16 v[66:67], v14 offset:15360
  v_mfma_f32_16x16x32_bf16 v[152:155], v[68:71], a[152:155], v[152:155]
  s_add_u32 m0, s33, 65536
  v_mfma_f32_16x16x32_bf16 v[152:155], v[72:75], a[168:171], v[152:155]
  s_mov_b32 s34, 128
  v_mfma_f32_16x16x32_bf16 v[152:155], v[76:79], a[184:187], v[152:155]
  buffer_load_dwordx4 v21, s[12:15], s34 offen lds
  v_mfma_f32_16x16x32_bf16 v[156:159], v[68:71], a[156:159], v[156:159]
  s_add_u32 m0, s33, 69632
  v_mfma_f32_16x16x32_bf16 v[156:159], v[72:75], a[172:175], v[156:159]
  s_mov_b32 s34, 36992
  v_mfma_f32_16x16x32_bf16 v[156:159], v[76:79], a[188:191], v[156:159]
  buffer_load_dwordx4 v21, s[12:15], s34 offen lds
  s_waitcnt lgkmcnt(13)
  v_mfma_f32_16x16x32_bf16 v[128:131], v[80:83], a[192:195], v[128:131]
  ds_read_b64_tr_b16 v[68:69], v14 offset:16384
  v_mfma_f32_16x16x32_bf16 v[128:131], v[84:87], a[208:211], v[128:131]
  ds_read_b64_tr_b16 v[70:71], v14 offset:17408
  v_mfma_f32_16x16x32_bf16 v[128:131], v[88:91], a[224:227], v[128:131]
  ds_read_b64_tr_b16 v[72:73], v14 offset:20480
  v_mfma_f32_16x16x32_bf16 v[132:135], v[80:83], a[196:199], v[132:135]
  ds_read_b64_tr_b16 v[74:75], v14 offset:21504
  v_mfma_f32_16x16x32_bf16 v[132:135], v[84:87], a[212:215], v[132:135]
  ds_read_b64_tr_b16 v[76:77], v14 offset:24576
  v_mfma_f32_16x16x32_bf16 v[132:135], v[88:91], a[228:231], v[132:135]
  ds_read_b64_tr_b16 v[78:79], v14 offset:25600
  v_mfma_f32_16x16x32_bf16 v[136:139], v[80:83], a[200:203], v[136:139]
  s_add_u32 m0, s33, 73728
  v_mfma_f32_16x16x32_bf16 v[136:139], v[84:87], a[216:219], v[136:139]
  s_mov_b32 s34, 73856
  v_mfma_f32_16x16x32_bf16 v[136:139], v[88:91], a[232:235], v[136:139]
  buffer_load_dwordx4 v21, s[12:15], s34 offen lds
  v_mfma_f32_16x16x32_bf16 v[140:143], v[80:83], a[204:207], v[140:143]
  v_mfma_f32_16x16x32_bf16 v[140:143], v[84:87], a[220:223], v[140:143]
  v_mfma_f32_16x16x32_bf16 v[140:143], v[88:91], a[236:239], v[140:143]
  s_waitcnt lgkmcnt(6)
  v_mfma_f32_16x16x32_bf16 v[144:147], v[56:59], a[192:195], v[144:147]
  s_waitcnt vmcnt(9)
  s_barrier
  v_mfma_f32_16x16x32_bf16 v[144:147], v[60:63], a[208:211], v[144:147]
  ds_read_b64_tr_b16 v[80:81], v14 offset:18432
  v_mfma_f32_16x16x32_bf16 v[144:147], v[64:67], a[224:227], v[144:147]
  ds_read_b64_tr_b16 v[82:83], v14 offset:19456
  v_mfma_f32_16x16x32_bf16 v[148:151], v[56:59], a[196:199], v[148:151]
  ds_read_b64_tr_b16 v[84:85], v14 offset:22528
  v_mfma_f32_16x16x32_bf16 v[148:151], v[60:63], a[212:215], v[148:151]
  ds_read_b64_tr_b16 v[86:87], v14 offset:23552
  v_mfma_f32_16x16x32_bf16 v[148:151], v[64:67], a[228:231], v[148:151]
  ds_read_b64_tr_b16 v[88:89], v14 offset:26624
  v_mfma_f32_16x16x32_bf16 v[152:155], v[56:59], a[200:203], v[152:155]
  ds_read_b64_tr_b16 v[90:91], v14 offset:27648
  v_mfma_f32_16x16x32_bf16 v[152:155], v[60:63], a[216:219], v[152:155]
  s_add_u32 m0, s33, 77824
  v_mfma_f32_16x16x32_bf16 v[152:155], v[64:67], a[232:235], v[152:155]
  s_mov_b32 s34, 110720
  v_mfma_f32_16x16x32_bf16 v[156:159], v[56:59], a[204:207], v[156:159]
  buffer_load_dwordx4 v21, s[12:15], s34 offen lds
  v_mfma_f32_16x16x32_bf16 v[156:159], v[60:63], a[220:223], v[156:159]
  s_add_u32 m0, s33, 81920
  v_mfma_f32_16x16x32_bf16 v[156:159], v[64:67], a[236:239], v[156:159]
  s_mov_b32 s34, 147584
  buffer_load_dwordx4 v21, s[12:15], s34 offen lds
  s_waitcnt lgkmcnt(6)
  v_mfma_f32_16x16x32_bf16 v[128:131], v[68:71], a[240:243], v[128:131]
  ds_read_b64_tr_b16 v[56:57], v8 offset:28672
  v_mfma_f32_16x16x32_bf16 v[128:131], v[72:75], v[96:99], v[128:131]
  ds_read_b64_tr_b16 v[58:59], v8 offset:30720
  v_mfma_f32_16x16x32_bf16 v[128:131], v[76:79], v[112:115], v[128:131]
  ds_read_b64_tr_b16 v[60:61], v8 offset:32768
  v_mfma_f32_16x16x32_bf16 v[132:135], v[68:71], a[244:247], v[132:135]
  ds_read_b64_tr_b16 v[62:63], v8 offset:34816
  v_mfma_f32_16x16x32_bf16 v[132:135], v[72:75], v[100:103], v[132:135]
  ds_read_b64_tr_b16 v[64:65], v8 offset:36864
  v_mfma_f32_16x16x32_bf16 v[132:135], v[76:79], v[116:119], v[132:135]
  ds_read_b64_tr_b16 v[66:67], v8 offset:38912
  v_mfma_f32_16x16x32_bf16 v[136:139], v[68:71], a[248:251], v[136:139]
  s_add_u32 m0, s33, 86016
  v_mfma_f32_16x16x32_bf16 v[136:139], v[72:75], v[104:107], v[136:139]
  s_mov_b32 s34, 184448
  v_mfma_f32_16x16x32_bf16 v[136:139], v[76:79], v[120:123], v[136:139]
  buffer_load_dwordx4 v21, s[12:15], s34 offen lds
  v_mfma_f32_16x16x32_bf16 v[140:143], v[68:71], a[252:255], v[140:143]
  v_mfma_f32_16x16x32_bf16 v[140:143], v[72:75], v[108:111], v[140:143]
  v_mfma_f32_16x16x32_bf16 v[140:143], v[76:79], v[124:127], v[140:143]
  s_waitcnt lgkmcnt(6)
  v_mfma_f32_16x16x32_bf16 v[144:147], v[80:83], a[240:243], v[144:147]
  ds_read_b64_tr_b16 v[68:69], v11 offset:28672
  v_mfma_f32_16x16x32_bf16 v[144:147], v[84:87], v[96:99], v[144:147]
  ds_read_b64_tr_b16 v[70:71], v11 offset:30720
  v_mfma_f32_16x16x32_bf16 v[144:147], v[88:91], v[112:115], v[144:147]
  ds_read_b64_tr_b16 v[72:73], v11 offset:32768
  v_mfma_f32_16x16x32_bf16 v[148:151], v[80:83], a[244:247], v[148:151]
  ds_read_b64_tr_b16 v[74:75], v11 offset:34816
  v_mfma_f32_16x16x32_bf16 v[148:151], v[84:87], v[100:103], v[148:151]
  ds_read_b64_tr_b16 v[76:77], v11 offset:36864
  v_mfma_f32_16x16x32_bf16 v[148:151], v[88:91], v[116:119], v[148:151]
  ds_read_b64_tr_b16 v[78:79], v11 offset:38912
  v_mfma_f32_16x16x32_bf16 v[152:155], v[80:83], a[248:251], v[152:155]
  s_add_u32 m0, s33, 0
  v_mfma_f32_16x16x32_bf16 v[152:155], v[84:87], v[104:107], v[152:155]
  s_mov_b32 s34, 221312
  v_mfma_f32_16x16x32_bf16 v[152:155], v[88:91], v[120:123], v[152:155]
  buffer_load_dwordx4 v21, s[12:15], s34 offen lds
  v_mfma_f32_16x16x32_bf16 v[156:159], v[80:83], a[252:255], v[156:159]
  s_add_u32 m0, s33, 4096
  v_mfma_f32_16x16x32_bf16 v[156:159], v[84:87], v[108:111], v[156:159]
  s_mov_b32 s34, 258176
  v_mfma_f32_16x16x32_bf16 v[156:159], v[88:91], v[124:127], v[156:159]
  buffer_load_dwordx4 v21, s[12:15], s34 offen lds
  s_waitcnt lgkmcnt(6)
  v_mfma_f32_16x16x32_bf16 v[192:195], v[56:59], a[0:3], 0
  s_waitcnt vmcnt(8)
  s_barrier
  v_mfma_f32_16x16x32_bf16 v[192:195], v[60:63], a[16:19], v[192:195]
  ds_read_b64_tr_b16 v[80:81], v8 offset:40960
  v_mul_f32 v128, v128, v144
  v_mfma_f32_16x16x32_bf16 v[192:195], v[64:67], a[32:35], v[192:195]
  ds_read_b64_tr_b16 v[82:83], v8 offset:43008
  v_mul_f32 v129, v129, v145
  v_mfma_f32_16x16x32_bf16 v[196:199], v[56:59], a[4:7], 0
  ds_read_b64_tr_b16 v[84:85], v8 offset:45056
  v_mul_f32 v130, v130, v146
  v_mfma_f32_16x16x32_bf16 v[196:199], v[60:63], a[20:23], v[196:199]
  ds_read_b64_tr_b16 v[86:87], v8 offset:47104
  v_mul_f32 v131, v131, v147
  v_mfma_f32_16x16x32_bf16 v[196:199], v[64:67], a[36:39], v[196:199]
  ds_read_b64_tr_b16 v[88:89], v8 offset:49152
  v_cvt_pk_bf16_f32 v32, v128, v129
  v_mfma_f32_16x16x32_bf16 v[200:203], v[56:59], a[8:11], 0
  ds_read_b64_tr_b16 v[90:91], v8 offset:51200
  v_cvt_pk_bf16_f32 v33, v130, v131
  v_mfma_f32_16x16x32_bf16 v[200:203], v[60:63], a[24:27], v[200:203]
  s_add_u32 m0, s33, 8192
  ds_write_b64 v18, v[32:33] offset:32768
  v_mfma_f32_16x16x32_bf16 v[200:203], v[64:67], a[40:43], v[200:203]
  s_mov_b32 s34, 128
  v_mul_f32 v132, v132, v148
  v_mfma_f32_16x16x32_bf16 v[204:207], v[56:59], a[12:15], 0
  buffer_load_dwordx4 v22, s[12:15], s34 offen lds
  v_mul_f32 v133, v133, v149
  v_mfma_f32_16x16x32_bf16 v[204:207], v[60:63], a[28:31], v[204:207]
  v_mul_f32 v134, v134, v150
  v_mul_f32 v135, v135, v151
  v_mfma_f32_16x16x32_bf16 v[204:207], v[64:67], a[44:47], v[204:207]
  v_cvt_pk_bf16_f32 v34, v132, v133
  s_waitcnt lgkmcnt(7)
  v_mfma_f32_16x16x32_bf16 v[208:211], v[68:71], a[0:3], 0
  ds_read_b64_tr_b16 v[56:57], v11 offset:40960
  v_cvt_pk_bf16_f32 v35, v134, v135
  v_mfma_f32_16x16x32_bf16 v[208:211], v[72:75], a[16:19], v[208:211]
  ds_read_b64_tr_b16 v[58:59], v11 offset:43008
  ds_write_b64 v18, v[34:35] offset:33792
  v_mfma_f32_16x16x32_bf16 v[208:211], v[76:79], a[32:35], v[208:211]
  ds_read_b64_tr_b16 v[60:61], v11 offset:45056
  v_mul_f32 v136, v136, v152
  v_mfma_f32_16x16x32_bf16 v[212:215], v[68:71], a[4:7], 0
  ds_read_b64_tr_b16 v[62:63], v11 offset:47104
  v_mul_f32 v137, v137, v153
  v_mfma_f32_16x16x32_bf16 v[212:215], v[72:75], a[20:23], v[212:215]
  ds_read_b64_tr_b16 v[64:65], v11 offset:49152
  v_mul_f32 v138, v138, v154
  v_mfma_f32_16x16x32_bf16 v[212:215], v[76:79], a[36:39], v[212:215]
  ds_read_b64_tr_b16 v[66:67], v11 offset:51200
  v_mul_f32 v139, v139, v155
  v_mfma_f32_16x16x32_bf16 v[216:219], v[68:71], a[8:11], 0
  s_add_u32 m0, s33, 12288
  v_cvt_pk_bf16_f32 v36, v136, v137
  v_mfma_f32_16x16x32_bf16 v[216:219], v[72:75], a[24:27], v[216:219]
  s_mov_b32 s34, 256
  v_cvt_pk_bf16_f32 v37, v138, v139
  v_mfma_f32_16x16x32_bf16 v[216:219], v[76:79], a[40:43], v[216:219]
  buffer_load_dwordx4 v21, s[12:15], s34 offen lds
  ds_write_b64 v18, v[36:37] offset:34816
  v_mfma_f32_16x16x32_bf16 v[220:223], v[68:71], a[12:15], 0
  s_add_u32 m0, s33, 16384
  v_mul_f32 v140, v140, v156
  v_mfma_f32_16x16x32_bf16 v[220:223], v[72:75], a[28:31], v[220:223]
  s_mov_b32 s34, 37120
  v_mul_f32 v141, v141, v157
  v_mfma_f32_16x16x32_bf16 v[220:223], v[76:79], a[44:47], v[220:223]
  buffer_load_dwordx4 v21, s[12:15], s34 offen lds
  s_waitcnt lgkmcnt(9)
  v_mfma_f32_16x16x32_bf16 v[192:195], v[80:83], a[48:51], v[192:195]
  ds_read_b64_tr_b16 v[68:69], v8 offset:53248
  v_mul_f32 v142, v142, v158
  v_mfma_f32_16x16x32_bf16 v[192:195], v[84:87], a[64:67], v[192:195]
  ds_read_b64_tr_b16 v[70:71], v8 offset:55296
  v_mul_f32 v143, v143, v159
  v_mfma_f32_16x16x32_bf16 v[192:195], v[88:91], a[80:83], v[192:195]
  ds_read_b64_tr_b16 v[72:73], v8 offset:57344
  v_cvt_pk_bf16_f32 v38, v140, v141
  v_mfma_f32_16x16x32_bf16 v[196:199], v[80:83], a[52:55], v[196:199]
  ds_read_b64_tr_b16 v[74:75], v8 offset:59392
  v_cvt_pk_bf16_f32 v39, v142, v143
  v_mfma_f32_16x16x32_bf16 v[196:199], v[84:87], a[68:71], v[196:199]
  ds_read_b64_tr_b16 v[76:77], v8 offset:61440
  ds_write_b64 v18, v[38:39] offset:35840
  v_mfma_f32_16x16x32_bf16 v[196:199], v[88:91], a[84:87], v[196:199]
  ds_read_b64_tr_b16 v[78:79], v8 offset:63488
  v_mfma_f32_16x16x32_bf16 v[200:203], v[80:83], a[56:59], v[200:203]
  s_add_u32 m0, s33, 20480
  v_mfma_f32_16x16x32_bf16 v[200:203], v[84:87], a[72:75], v[200:203]
  s_mov_b32 s34, 73984
  v_mfma_f32_16x16x32_bf16 v[200:203], v[88:91], a[88:91], v[200:203]
  buffer_load_dwordx4 v21, s[12:15], s34 offen lds
  v_mfma_f32_16x16x32_bf16 v[204:207], v[80:83], a[60:63], v[204:207]
  v_mfma_f32_16x16x32_bf16 v[204:207], v[84:87], a[76:79], v[204:207]
  v_mfma_f32_16x16x32_bf16 v[204:207], v[88:91], a[92:95], v[204:207]
  s_waitcnt lgkmcnt(8)
  v_mfma_f32_16x16x32_bf16 v[208:211], v[56:59], a[48:51], v[208:211]
  s_waitcnt vmcnt(9) lgkmcnt(1)
  s_barrier
  v_mfma_f32_16x16x32_bf16 v[208:211], v[60:63], a[64:67], v[208:211]
  ds_read_b64_tr_b16 v[80:81], v11 offset:53248
  ds_read_b128 a[128:131], v16 offset:32768
  v_mfma_f32_16x16x32_bf16 v[208:211], v[64:67], a[80:83], v[208:211]
  ds_read_b64_tr_b16 v[82:83], v11 offset:55296
  ds_read_b128 a[132:135], v16 offset:33792
  v_mfma_f32_16x16x32_bf16 v[212:215], v[56:59], a[52:55], v[212:215]
  ds_read_b64_tr_b16 v[84:85], v11 offset:57344
  ds_read_b128 a[136:139], v16 offset:34816
  v_mfma_f32_16x16x32_bf16 v[212:215], v[60:63], a[68:71], v[212:215]
  ds_read_b64_tr_b16 v[86:87], v11 offset:59392
  ds_read_b128 a[140:143], v16 offset:35840
  v_mfma_f32_16x16x32_bf16 v[212:215], v[64:67], a[84:87], v[212:215]
  ds_read_b64_tr_b16 v[88:89], v11 offset:61440
  v_mfma_f32_16x16x32_bf16 v[216:219], v[56:59], a[56:59], v[216:219]
  ds_read_b64_tr_b16 v[90:91], v11 offset:63488
  v_mfma_f32_16x16x32_bf16 v[216:219], v[60:63], a[72:75], v[216:219]
  s_add_u32 m0, s33, 24576
  v_mfma_f32_16x16x32_bf16 v[216:219], v[64:67], a[88:91], v[216:219]
  s_mov_b32 s34, 110848
  v_mfma_f32_16x16x32_bf16 v[220:223], v[56:59], a[60:63], v[220:223]
  buffer_load_dwordx4 v21, s[12:15], s34 offen lds
  v_mfma_f32_16x16x32_bf16 v[220:223], v[60:63], a[76:79], v[220:223]
  s_add_u32 m0, s33, 28672
  v_mfma_f32_16x16x32_bf16 v[220:223], v[64:67], a[92:95], v[220:223]
  s_mov_b32 s34, 147712
  buffer_load_dwordx4 v21, s[12:15], s34 offen lds
  s_waitcnt lgkmcnt(10)
  v_mfma_f32_16x16x32_bf16 v[192:195], v[68:71], a[96:99], v[192:195]
  ds_read_b64_tr_b16 v[56:57], v9
  v_mfma_f32_16x16x32_bf16 v[192:195], v[72:75], a[112:115], v[192:195]
  ds_read_b64_tr_b16 v[58:59], v9 offset:2048
  s_waitcnt lgkmcnt(10)
  v_mfma_f32_16x16x32_bf16 v[192:195], v[76:79], a[128:131], v[192:195]
  ds_read_b64_tr_b16 v[60:61], v9 offset:4096
  v_mfma_f32_16x16x32_bf16 v[196:199], v[68:71], a[100:103], v[196:199]
  ds_read_b64_tr_b16 v[62:63], v9 offset:6144
  v_mfma_f32_16x16x32_bf16 v[196:199], v[72:75], a[116:119], v[196:199]
  ds_read_b64_tr_b16 v[64:65], v9 offset:8192
  s_waitcnt lgkmcnt(11)
  v_mfma_f32_16x16x32_bf16 v[196:199], v[76:79], a[132:135], v[196:199]
  ds_read_b64_tr_b16 v[66:67], v9 offset:10240
  v_mfma_f32_16x16x32_bf16 v[200:203], v[68:71], a[104:107], v[200:203]
  s_add_u32 m0, s33, 32768
  v_mfma_f32_16x16x32_bf16 v[200:203], v[72:75], a[120:123], v[200:203]
  s_mov_b32 s34, 184576
  s_waitcnt lgkmcnt(10)
  v_mfma_f32_16x16x32_bf16 v[200:203], v[76:79], a[136:139], v[200:203]
  buffer_load_dwordx4 v21, s[12:15], s34 offen lds
  v_mfma_f32_16x16x32_bf16 v[204:207], v[68:71], a[108:111], v[204:207]
  v_mfma_f32_16x16x32_bf16 v[204:207], v[72:75], a[124:127], v[204:207]
  s_waitcnt lgkmcnt(8)
  v_mfma_f32_16x16x32_bf16 v[204:207], v[76:79], a[140:143], v[204:207]
  s_waitcnt lgkmcnt(6)
  v_mfma_f32_16x16x32_bf16 v[208:211], v[80:83], a[96:99], v[208:211]
  ds_read_b64_tr_b16 v[68:69], v12
  v_mfma_f32_16x16x32_bf16 v[208:211], v[84:87], a[112:115], v[208:211]
  ds_read_b64_tr_b16 v[70:71], v12 offset:2048
  v_mfma_f32_16x16x32_bf16 v[208:211], v[88:91], a[128:131], v[208:211]
  ds_read_b64_tr_b16 v[72:73], v12 offset:4096
  v_mfma_f32_16x16x32_bf16 v[212:215], v[80:83], a[100:103], v[212:215]
  ds_read_b64_tr_b16 v[74:75], v12 offset:6144
  v_mfma_f32_16x16x32_bf16 v[212:215], v[84:87], a[116:119], v[212:215]
  ds_read_b64_tr_b16 v[76:77], v12 offset:8192
  v_mfma_f32_16x16x32_bf16 v[212:215], v[88:91], a[132:135], v[212:215]
  ds_read_b64_tr_b16 v[78:79], v12 offset:10240
  v_mfma_f32_16x16x32_bf16 v[216:219], v[80:83], a[104:107], v[216:219]
  s_add_u32 m0, s33, 36864
  v_mfma_f32_16x16x32_bf16 v[216:219], v[84:87], a[120:123], v[216:219]
  s_mov_b32 s34, 221440
  v_mfma_f32_16x16x32_bf16 v[216:219], v[88:91], a[136:139], v[216:219]
  buffer_load_dwordx4 v21, s[12:15], s34 offen lds
  v_mfma_f32_16x16x32_bf16 v[220:223], v[80:83], a[108:111], v[220:223]
  s_add_u32 m0, s33, 40960
  v_mfma_f32_16x16x32_bf16 v[220:223], v[84:87], a[124:127], v[220:223]
  s_mov_b32 s34, 258304
  v_mfma_f32_16x16x32_bf16 v[220:223], v[88:91], a[140:143], v[220:223]
  buffer_load_dwordx4 v21, s[12:15], s34 offen lds
  s_waitcnt lgkmcnt(6)
  v_mfma_f32_16x16x32_bf16 v[224:227], v[56:59], a[0:3], 0
  s_waitcnt vmcnt(8)
  s_barrier
  v_mfma_f32_16x16x32_bf16 v[224:227], v[60:63], a[16:19], v[224:227]
  ds_read_b64_tr_b16 v[80:81], v9 offset:12288
  v_cvt_pk_bf16_f32 v40, v192, v193
  v_mfma_f32_16x16x32_bf16 v[224:227], v[64:67], a[32:35], v[224:227]
  ds_read_b64_tr_b16 v[82:83], v9 offset:14336
  v_cvt_pk_bf16_f32 v41, v194, v195
  v_mfma_f32_16x16x32_bf16 v[228:231], v[56:59], a[4:7], 0
  ds_read_b64_tr_b16 v[84:85], v9 offset:16384
  v_cvt_pk_bf16_f32 v42, v208, v209
  v_mfma_f32_16x16x32_bf16 v[228:231], v[60:63], a[20:23], v[228:231]
  ds_read_b64_tr_b16 v[86:87], v9 offset:18432
  v_cvt_pk_bf16_f32 v43, v210, v211
  v_mfma_f32_16x16x32_bf16 v[228:231], v[64:67], a[36:39], v[228:231]
  ds_read_b64_tr_b16 v[88:89], v9 offset:20480
  s_mov_b32 s35, 0
  v_mfma_f32_16x16x32_bf16 v[232:235], v[56:59], a[8:11], 0
  ds_read_b64_tr_b16 v[90:91], v9 offset:22528
  buffer_store_dwordx4 v[40:43], v24, s[20:23], s35 offen sc1
  v_mfma_f32_16x16x32_bf16 v[232:235], v[60:63], a[24:27], v[232:235]
  s_add_u32 m0, s33, 126976
  v_cvt_pk_bf16_f32 v44, v196, v197
  v_mfma_f32_16x16x32_bf16 v[232:235], v[64:67], a[40:43], v[232:235]
  s_mov_b32 s34, 256
  v_cvt_pk_bf16_f32 v45, v198, v199
  v_mfma_f32_16x16x32_bf16 v[236:239], v[56:59], a[12:15], 0
  buffer_load_dwordx4 v22, s[12:15], s34 offen lds
  v_cvt_pk_bf16_f32 v46, v212, v213
  v_mfma_f32_16x16x32_bf16 v[236:239], v[60:63], a[28:31], v[236:239]
  v_cvt_pk_bf16_f32 v47, v214, v215
  s_mov_b32 s35, 18432
  v_mfma_f32_16x16x32_bf16 v[236:239], v[64:67], a[44:47], v[236:239]
  buffer_store_dwordx4 v[44:47], v24, s[20:23], s35 offen sc1
  s_waitcnt lgkmcnt(6)
  v_mfma_f32_16x16x32_bf16 v[240:243], v[68:71], a[0:3], 0
  ds_read_b64_tr_b16 v[56:57], v12 offset:12288
  v_cvt_pk_bf16_f32 v48, v200, v201
  v_mfma_f32_16x16x32_bf16 v[240:243], v[72:75], a[16:19], v[240:243]
  ds_read_b64_tr_b16 v[58:59], v12 offset:14336
  v_cvt_pk_bf16_f32 v49, v202, v203
  v_mfma_f32_16x16x32_bf16 v[240:243], v[76:79], a[32:35], v[240:243]
  ds_read_b64_tr_b16 v[60:61], v12 offset:16384
  v_cvt_pk_bf16_f32 v50, v216, v217
  v_mfma_f32_16x16x32_bf16 v[244:247], v[68:71], a[4:7], 0
  ds_read_b64_tr_b16 v[62:63], v12 offset:18432
  v_cvt_pk_bf16_f32 v51, v218, v219
  v_mfma_f32_16x16x32_bf16 v[244:247], v[72:75], a[20:23], v[244:247]
  ds_read_b64_tr_b16 v[64:65], v12 offset:20480
  s_mov_b32 s35, 36864
  v_mfma_f32_16x16x32_bf16 v[244:247], v[76:79], a[36:39], v[244:247]
  ds_read_b64_tr_b16 v[66:67], v12 offset:22528
  buffer_store_dwordx4 v[48:51], v24, s[20:23], s35 offen sc1
  v_mfma_f32_16x16x32_bf16 v[248:251], v[68:71], a[8:11], 0
  s_add_u32 m0, s33, 131072
  v_cvt_pk_bf16_f32 v52, v204, v205
  v_mfma_f32_16x16x32_bf16 v[248:251], v[72:75], a[24:27], v[248:251]
  s_mov_b32 s34, 384
  v_cvt_pk_bf16_f32 v53, v206, v207
  v_mfma_f32_16x16x32_bf16 v[248:251], v[76:79], a[40:43], v[248:251]
  buffer_load_dwordx4 v21, s[12:15], s34 offen lds
  v_cvt_pk_bf16_f32 v54, v220, v221
  v_mfma_f32_16x16x32_bf16 v[252:255], v[68:71], a[12:15], 0
  s_add_u32 m0, s33, 90112
  v_cvt_pk_bf16_f32 v55, v222, v223
  v_mfma_f32_16x16x32_bf16 v[252:255], v[72:75], a[28:31], v[252:255]
  s_mov_b32 s34, 37248
  s_mov_b32 s35, 55296
  v_mfma_f32_16x16x32_bf16 v[252:255], v[76:79], a[44:47], v[252:255]
  buffer_load_dwordx4 v21, s[12:15], s34 offen lds
  s_waitcnt lgkmcnt(6)
  v_mfma_f32_16x16x32_bf16 v[224:227], v[80:83], a[48:51], v[224:227]
  ds_read_b64_tr_b16 v[68:69], v8
  buffer_store_dwordx4 v[52:55], v24, s[20:23], s35 offen sc1
  v_mfma_f32_16x16x32_bf16 v[224:227], v[84:87], a[64:67], v[224:227]
  ds_read_b64_tr_b16 v[70:71], v8 offset:2048
  v_mfma_f32_16x16x32_bf16 v[224:227], v[88:91], a[80:83], v[224:227]
  ds_read_b64_tr_b16 v[72:73], v8 offset:4096
  v_mfma_f32_16x16x32_bf16 v[228:231], v[80:83], a[52:55], v[228:231]
  ds_read_b64_tr_b16 v[74:75], v8 offset:6144
  v_mfma_f32_16x16x32_bf16 v[228:231], v[84:87], a[68:71], v[228:231]
  ds_read_b64_tr_b16 v[76:77], v8 offset:8192
  v_mfma_f32_16x16x32_bf16 v[228:231], v[88:91], a[84:87], v[228:231]
  ds_read_b64_tr_b16 v[78:79], v8 offset:10240
  v_mfma_f32_16x16x32_bf16 v[232:235], v[80:83], a[56:59], v[232:235]
  s_add_u32 m0, s33, 94208
  v_mfma_f32_16x16x32_bf16 v[232:235], v[84:87], a[72:75], v[232:235]
  s_mov_b32 s34, 74112
  v_mfma_f32_16x16x32_bf16 v[232:235], v[88:91], a[88:91], v[232:235]
  buffer_load_dwordx4 v21, s[12:15], s34 offen lds
  v_mfma_f32_16x16x32_bf16 v[236:239], v[80:83], a[60:63], v[236:239]
  v_mfma_f32_16x16x32_bf16 v[236:239], v[84:87], a[76:79], v[236:239]
  v_mfma_f32_16x16x32_bf16 v[236:239], v[88:91], a[92:95], v[236:239]
  s_waitcnt lgkmcnt(6)
  v_mfma_f32_16x16x32_bf16 v[240:243], v[56:59], a[48:51], v[240:243]
  s_waitcnt vmcnt(13)
  s_barrier
  v_mfma_f32_16x16x32_bf16 v[240:243], v[60:63], a[64:67], v[240:243]
  ds_read_b64_tr_b16 v[80:81], v11
  v_mfma_f32_16x16x32_bf16 v[240:243], v[64:67], a[80:83], v[240:243]
  ds_read_b64_tr_b16 v[82:83], v11 offset:2048
  v_mfma_f32_16x16x32_bf16 v[244:247], v[56:59], a[52:55], v[244:247]
  ds_read_b64_tr_b16 v[84:85], v11 offset:4096
  v_mfma_f32_16x16x32_bf16 v[244:247], v[60:63], a[68:71], v[244:247]
  ds_read_b64_tr_b16 v[86:87], v11 offset:6144
  v_mfma_f32_16x16x32_bf16 v[244:247], v[64:67], a[84:87], v[244:247]
  ds_read_b64_tr_b16 v[88:89], v11 offset:8192
  v_mfma_f32_16x16x32_bf16 v[248:251], v[56:59], a[56:59], v[248:251]
  ds_read_b64_tr_b16 v[90:91], v11 offset:10240
  v_mfma_f32_16x16x32_bf16 v[248:251], v[60:63], a[72:75], v[248:251]
  s_add_u32 m0, s33, 102400
  v_mfma_f32_16x16x32_bf16 v[248:251], v[64:67], a[88:91], v[248:251]
  s_mov_b32 s34, 110976
  v_mfma_f32_16x16x32_bf16 v[252:255], v[56:59], a[60:63], v[252:255]
  buffer_load_dwordx4 v21, s[12:15], s34 offen lds
  v_mfma_f32_16x16x32_bf16 v[252:255], v[60:63], a[76:79], v[252:255]
  s_add_u32 m0, s33, 135168
  v_mfma_f32_16x16x32_bf16 v[252:255], v[64:67], a[92:95], v[252:255]
  s_mov_b32 s34, 147840
  buffer_load_dwordx4 v21, s[12:15], s34 offen lds
  s_waitcnt lgkmcnt(6)
  v_mfma_f32_16x16x32_bf16 v[224:227], v[68:71], a[96:99], v[224:227]
  ds_read_b64_tr_b16 v[56:57], v8 offset:12288
  v_mfma_f32_16x16x32_bf16 v[224:227], v[72:75], a[112:115], v[224:227]
  ds_read_b64_tr_b16 v[58:59], v8 offset:14336
  v_mfma_f32_16x16x32_bf16 v[224:227], v[76:79], a[128:131], v[224:227]
  ds_read_b64_tr_b16 v[60:61], v8 offset:16384
  v_mfma_f32_16x16x32_bf16 v[228:231], v[68:71], a[100:103], v[228:231]
  ds_read_b64_tr_b16 v[62:63], v8 offset:18432
  v_mfma_f32_16x16x32_bf16 v[228:231], v[72:75], a[116:119], v[228:231]
  ds_read_b64_tr_b16 v[64:65], v8 offset:20480
  v_mfma_f32_16x16x32_bf16 v[228:231], v[76:79], a[132:135], v[228:231]
  ds_read_b64_tr_b16 v[66:67], v8 offset:22528
  v_mfma_f32_16x16x32_bf16 v[232:235], v[68:71], a[104:107], v[232:235]
  s_add_u32 m0, s33, 139264
  v_mfma_f32_16x16x32_bf16 v[232:235], v[72:75], a[120:123], v[232:235]
  s_mov_b32 s34, 184704
  v_mfma_f32_16x16x32_bf16 v[232:235], v[76:79], a[136:139], v[232:235]
  buffer_load_dwordx4 v21, s[12:15], s34 offen lds
  v_mfma_f32_16x16x32_bf16 v[236:239], v[68:71], a[108:111], v[236:239]
  v_mfma_f32_16x16x32_bf16 v[236:239], v[72:75], a[124:127], v[236:239]
  v_mfma_f32_16x16x32_bf16 v[236:239], v[76:79], a[140:143], v[236:239]
  s_waitcnt lgkmcnt(6)
  v_mfma_f32_16x16x32_bf16 v[240:243], v[80:83], a[96:99], v[240:243]
  ds_read_b64_tr_b16 v[68:69], v11 offset:12288
  v_mfma_f32_16x16x32_bf16 v[240:243], v[84:87], a[112:115], v[240:243]
  ds_read_b64_tr_b16 v[70:71], v11 offset:14336
  v_mfma_f32_16x16x32_bf16 v[240:243], v[88:91], a[128:131], v[240:243]
  ds_read_b64_tr_b16 v[72:73], v11 offset:16384
  v_mfma_f32_16x16x32_bf16 v[244:247], v[80:83], a[100:103], v[244:247]
  ds_read_b64_tr_b16 v[74:75], v11 offset:18432
  v_mfma_f32_16x16x32_bf16 v[244:247], v[84:87], a[116:119], v[244:247]
  ds_read_b64_tr_b16 v[76:77], v11 offset:20480
  v_mfma_f32_16x16x32_bf16 v[244:247], v[88:91], a[132:135], v[244:247]
  ds_read_b64_tr_b16 v[78:79], v11 offset:22528
  v_mfma_f32_16x16x32_bf16 v[248:251], v[80:83], a[104:107], v[248:251]
  s_add_u32 m0, s33, 98304
  v_mfma_f32_16x16x32_bf16 v[248:251], v[84:87], a[120:123], v[248:251]
  s_mov_b32 s34, 221568
  v_mfma_f32_16x16x32_bf16 v[248:251], v[88:91], a[136:139], v[248:251]
  buffer_load_dwordx4 v21, s[12:15], s34 offen lds
  v_mfma_f32_16x16x32_bf16 v[252:255], v[80:83], a[108:111], v[252:255]
  s_add_u32 m0, s33, 143360
  v_mfma_f32_16x16x32_bf16 v[252:255], v[84:87], a[124:127], v[252:255]
  s_mov_b32 s34, 258432
  v_mfma_f32_16x16x32_bf16 v[252:255], v[88:91], a[140:143], v[252:255]
  buffer_load_dwordx4 v21, s[12:15], s34 offen lds
  s_waitcnt lgkmcnt(6)
  v_mfma_f32_16x16x32_bf16 v[192:195], v[56:59], a[0:3], 0
  s_waitcnt vmcnt(11)
  s_barrier
  v_mfma_f32_16x16x32_bf16 v[192:195], v[60:63], a[16:19], v[192:195]
  ds_read_b64_tr_b16 v[80:81], v8 offset:24576
  v_cvt_pk_bf16_f32 v40, v224, v225
  v_mfma_f32_16x16x32_bf16 v[192:195], v[64:67], a[32:35], v[192:195]
  ds_read_b64_tr_b16 v[82:83], v8 offset:26624
  v_cvt_pk_bf16_f32 v41, v226, v227
  v_mfma_f32_16x16x32_bf16 v[196:199], v[56:59], a[4:7], 0
  ds_read_b64_tr_b16 v[84:85], v8 offset:28672
  v_cvt_pk_bf16_f32 v42, v240, v241
  v_mfma_f32_16x16x32_bf16 v[196:199], v[60:63], a[20:23], v[196:199]
  ds_read_b64_tr_b16 v[86:87], v8 offset:30720
  v_cvt_pk_bf16_f32 v43, v242, v243
  v_mfma_f32_16x16x32_bf16 v[196:199], v[64:67], a[36:39], v[196:199]
  ds_read_b64_tr_b16 v[88:89], v8 offset:32768
  s_mov_b32 s35, 2048
  v_mfma_f32_16x16x32_bf16 v[200:203], v[56:59], a[8:11], 0
  ds_read_b64_tr_b16 v[90:91], v8 offset:34816
  buffer_store_dwordx4 v[40:43], v24, s[20:23], s35 offen sc1
  v_mfma_f32_16x16x32_bf16 v[200:203], v[60:63], a[24:27], v[200:203]
  s_add_u32 m0, s33, 147456
  v_cvt_pk_bf16_f32 v44, v228, v229
  v_mfma_f32_16x16x32_bf16 v[200:203], v[64:67], a[40:43], v[200:203]
  s_mov_b32 s34, 384
  v_cvt_pk_bf16_f32 v45, v230, v231
  v_mfma_f32_16x16x32_bf16 v[204:207], v[56:59], a[12:15], 0
  buffer_load_dwordx4 v22, s[12:15], s34 offen lds
  v_cvt_pk_bf16_f32 v46, v244, v245
  v_mfma_f32_16x16x32_bf16 v[204:207], v[60:63], a[28:31], v[204:207]
  v_cvt_pk_bf16_f32 v47, v246, v247
  s_mov_b32 s35, 20480
  v_mfma_f32_16x16x32_bf16 v[204:207], v[64:67], a[44:47], v[204:207]
  buffer_store_dwordx4 v[44:47], v24, s[20:23], s35 offen sc1
  s_waitcnt lgkmcnt(6)
  v_mfma_f32_16x16x32_bf16 v[208:211], v[68:71], a[0:3], 0
  ds_read_b64_tr_b16 v[56:57], v11 offset:24576
  v_cvt_pk_bf16_f32 v48, v232, v233
  v_mfma_f32_16x16x32_bf16 v[208:211], v[72:75], a[16:19], v[208:211]
  ds_read_b64_tr_b16 v[58:59], v11 offset:26624
  v_cvt_pk_bf16_f32 v49, v234, v235
  v_mfma_f32_16x16x32_bf16 v[208:211], v[76:79], a[32:35], v[208:211]
  ds_read_b64_tr_b16 v[60:61], v11 offset:28672
  v_cvt_pk_bf16_f32 v50, v248, v249
  v_mfma_f32_16x16x32_bf16 v[212:215], v[68:71], a[4:7], 0
  ds_read_b64_tr_b16 v[62:63], v11 offset:30720
  v_cvt_pk_bf16_f32 v51, v250, v251
  v_mfma_f32_16x16x32_bf16 v[212:215], v[72:75], a[20:23], v[212:215]
  ds_read_b64_tr_b16 v[64:65], v11 offset:32768
  s_mov_b32 s35, 38912
  v_mfma_f32_16x16x32_bf16 v[212:215], v[76:79], a[36:39], v[212:215]
  ds_read_b64_tr_b16 v[66:67], v11 offset:34816
  buffer_store_dwordx4 v[48:51], v24, s[20:23], s35 offen sc1
  v_mfma_f32_16x16x32_bf16 v[216:219], v[68:71], a[8:11], 0
  s_add_u32 m0, s33, 106496
  v_cvt_pk_bf16_f32 v52, v236, v237
  v_mfma_f32_16x16x32_bf16 v[216:219], v[72:75], a[24:27], v[216:219]
  s_mov_b32 s34, 512
  v_cvt_pk_bf16_f32 v53, v238, v239
  v_mfma_f32_16x16x32_bf16 v[216:219], v[76:79], a[40:43], v[216:219]
  buffer_load_dwordx4 v21, s[12:15], s34 offen lds
  v_cvt_pk_bf16_f32 v54, v252, v253
  v_mfma_f32_16x16x32_bf16 v[220:223], v[68:71], a[12:15], 0
  s_add_u32 m0, s33, 110592
  v_cvt_pk_bf16_f32 v55, v254, v255
  v_mfma_f32_16x16x32_bf16 v[220:223], v[72:75], a[28:31], v[220:223]
  s_mov_b32 s34, 37376
  s_mov_b32 s35, 57344
  v_mfma_f32_16x16x32_bf16 v[220:223], v[76:79], a[44:47], v[220:223]
  buffer_load_dwordx4 v21, s[12:15], s34 offen lds
  s_waitcnt lgkmcnt(6)
  v_mfma_f32_16x16x32_bf16 v[192:195], v[80:83], a[48:51], v[192:195]
  ds_read_b64_tr_b16 v[68:69], v8 offset:36864
  buffer_store_dwordx4 v[52:55], v24, s[20:23], s35 offen sc1
  v_mfma_f32_16x16x32_bf16 v[192:195], v[84:87], a[64:67], v[192:195]
  ds_read_b64_tr_b16 v[70:71], v8 offset:38912
  v_mfma_f32_16x16x32_bf16 v[192:195], v[88:91], a[80:83], v[192:195]
  ds_read_b64_tr_b16 v[72:73], v8 offset:40960
  v_mfma_f32_16x16x32_bf16 v[196:199], v[80:83], a[52:55], v[196:199]
  ds_read_b64_tr_b16 v[74:75], v8 offset:43008
  v_mfma_f32_16x16x32_bf16 v[196:199], v[84:87], a[68:71], v[196:199]
  ds_read_b64_tr_b16 v[76:77], v9 offset:61440
  v_mfma_f32_16x16x32_bf16 v[196:199], v[88:91], a[84:87], v[196:199]
  ds_read_b64_tr_b16 v[78:79], v9 offset:63488
  v_mfma_f32_16x16x32_bf16 v[200:203], v[80:83], a[56:59], v[200:203]
  s_add_u32 m0, s33, 151552
  v_mfma_f32_16x16x32_bf16 v[200:203], v[84:87], a[72:75], v[200:203]
  s_mov_b32 s34, 74240
  v_mfma_f32_16x16x32_bf16 v[200:203], v[88:91], a[88:91], v[200:203]
  buffer_load_dwordx4 v21, s[12:15], s34 offen lds
  v_mfma_f32_16x16x32_bf16 v[204:207], v[80:83], a[60:63], v[204:207]
  v_mfma_f32_16x16x32_bf16 v[204:207], v[84:87], a[76:79], v[204:207]
  v_mfma_f32_16x16x32_bf16 v[204:207], v[88:91], a[92:95], v[204:207]
  s_waitcnt lgkmcnt(6)
  v_mfma_f32_16x16x32_bf16 v[208:211], v[56:59], a[48:51], v[208:211]
  s_waitcnt vmcnt(13)
  s_barrier
  s_mov_b32 s63, 8192
  v_mov_b32 v179, 1
  buffer_store_dword v179, v29, s[96:99], s63 offen sc1
  v_mfma_f32_16x16x32_bf16 v[208:211], v[60:63], a[64:67], v[208:211]
  ds_read_b64_tr_b16 v[80:81], v11 offset:36864
  v_mfma_f32_16x16x32_bf16 v[208:211], v[64:67], a[80:83], v[208:211]
  ds_read_b64_tr_b16 v[82:83], v11 offset:38912
  v_mfma_f32_16x16x32_bf16 v[212:215], v[56:59], a[52:55], v[212:215]
  ds_read_b64_tr_b16 v[84:85], v11 offset:40960
  v_mfma_f32_16x16x32_bf16 v[212:215], v[60:63], a[68:71], v[212:215]
  ds_read_b64_tr_b16 v[86:87], v11 offset:43008
  v_mfma_f32_16x16x32_bf16 v[212:215], v[64:67], a[84:87], v[212:215]
  ds_read_b64_tr_b16 v[88:89], v12 offset:61440
  v_mfma_f32_16x16x32_bf16 v[216:219], v[56:59], a[56:59], v[216:219]
  ds_read_b64_tr_b16 v[90:91], v12 offset:63488
  v_mfma_f32_16x16x32_bf16 v[216:219], v[60:63], a[72:75], v[216:219]
  s_add_u32 m0, s33, 155648
  v_mfma_f32_16x16x32_bf16 v[216:219], v[64:67], a[88:91], v[216:219]
  s_mov_b32 s34, 111104
  v_mfma_f32_16x16x32_bf16 v[220:223], v[56:59], a[60:63], v[220:223]
  buffer_load_dwordx4 v21, s[12:15], s34 offen lds
  v_mfma_f32_16x16x32_bf16 v[220:223], v[60:63], a[76:79], v[220:223]
  s_add_u32 m0, s33, 114688
  v_mfma_f32_16x16x32_bf16 v[220:223], v[64:67], a[92:95], v[220:223]
  s_mov_b32 s34, 147968
  buffer_load_dwordx4 v21, s[12:15], s34 offen lds
  s_waitcnt lgkmcnt(6)
  v_mfma_f32_16x16x32_bf16 v[192:195], v[68:71], a[96:99], v[192:195]
  ds_read_b64_tr_b16 v[56:57], v10
  v_mfma_f32_16x16x32_bf16 v[192:195], v[72:75], a[112:115], v[192:195]
  ds_read_b64_tr_b16 v[58:59], v10 offset:2048
  v_mfma_f32_16x16x32_bf16 v[192:195], v[76:79], a[128:131], v[192:195]
  ds_read_b64_tr_b16 v[60:61], v9 offset:24576
  v_mfma_f32_16x16x32_bf16 v[196:199], v[68:71], a[100:103], v[196:199]
  ds_read_b64_tr_b16 v[62:63], v9 offset:26624
  v_mfma_f32_16x16x32_bf16 v[196:199], v[72:75], a[116:119], v[196:199]
  ds_read_b64_tr_b16 v[64:65], v9 offset:28672
  v_mfma_f32_16x16x32_bf16 v[196:199], v[76:79], a[132:135], v[196:199]
  ds_read_b64_tr_b16 v[66:67], v9 offset:30720
  v_mfma_f32_16x16x32_bf16 v[200:203], v[68:71], a[104:107], v[200:203]
  s_add_u32 m0, s33, 118784
  v_mfma_f32_16x16x32_bf16 v[200:203], v[72:75], a[120:123], v[200:203]
  s_mov_b32 s34, 184832
  v_mfma_f32_16x16x32_bf16 v[200:203], v[76:79], a[136:139], v[200:203]
  buffer_load_dwordx4 v21, s[12:15], s34 offen lds
  v_mfma_f32_16x16x32_bf16 v[204:207], v[68:71], a[108:111], v[204:207]
  v_mfma_f32_16x16x32_bf16 v[204:207], v[72:75], a[124:127], v[204:207]
  v_mfma_f32_16x16x32_bf16 v[204:207], v[76:79], a[140:143], v[204:207]
  s_waitcnt lgkmcnt(6)
  v_mfma_f32_16x16x32_bf16 v[208:211], v[80:83], a[96:99], v[208:211]
  ds_read_b64_tr_b16 v[68:69], v13
  v_mfma_f32_16x16x32_bf16 v[208:211], v[84:87], a[112:115], v[208:211]
  ds_read_b64_tr_b16 v[70:71], v13 offset:2048
  v_mfma_f32_16x16x32_bf16 v[208:211], v[88:91], a[128:131], v[208:211]
  ds_read_b64_tr_b16 v[72:73], v12 offset:24576
  v_mfma_f32_16x16x32_bf16 v[212:215], v[80:83], a[100:103], v[212:215]
  ds_read_b64_tr_b16 v[74:75], v12 offset:26624
  v_mfma_f32_16x16x32_bf16 v[212:215], v[84:87], a[116:119], v[212:215]
  ds_read_b64_tr_b16 v[76:77], v12 offset:28672
  v_mfma_f32_16x16x32_bf16 v[212:215], v[88:91], a[132:135], v[212:215]
  ds_read_b64_tr_b16 v[78:79], v12 offset:30720
  v_mfma_f32_16x16x32_bf16 v[216:219], v[80:83], a[104:107], v[216:219]
  s_add_u32 m0, s33, 122880
  v_mfma_f32_16x16x32_bf16 v[216:219], v[84:87], a[120:123], v[216:219]
  s_mov_b32 s34, 221696
  v_mfma_f32_16x16x32_bf16 v[216:219], v[88:91], a[136:139], v[216:219]
  buffer_load_dwordx4 v21, s[12:15], s34 offen lds
  v_mfma_f32_16x16x32_bf16 v[220:223], v[80:83], a[108:111], v[220:223]
  s_add_u32 m0, s33, 159744
  v_mfma_f32_16x16x32_bf16 v[220:223], v[84:87], a[124:127], v[220:223]
  s_mov_b32 s34, 258560
  v_mfma_f32_16x16x32_bf16 v[220:223], v[88:91], a[140:143], v[220:223]
  buffer_load_dwordx4 v21, s[12:15], s34 offen lds
  s_waitcnt lgkmcnt(6)
  v_mfma_f32_16x16x32_bf16 v[224:227], v[56:59], a[0:3], 0
  s_waitcnt vmcnt(12)
  s_barrier
  v_mfma_f32_16x16x32_bf16 v[224:227], v[60:63], a[16:19], v[224:227]
  ds_read_b64_tr_b16 v[80:81], v9 offset:36864
  v_cvt_pk_bf16_f32 v40, v192, v193
  v_mfma_f32_16x16x32_bf16 v[224:227], v[64:67], a[32:35], v[224:227]
  ds_read_b64_tr_b16 v[82:83], v9 offset:38912
  v_cvt_pk_bf16_f32 v41, v194, v195
  v_mfma_f32_16x16x32_bf16 v[228:231], v[56:59], a[4:7], 0
  ds_read_b64_tr_b16 v[84:85], v10 offset:4096
  v_cvt_pk_bf16_f32 v42, v208, v209
  v_mfma_f32_16x16x32_bf16 v[228:231], v[60:63], a[20:23], v[228:231]
  ds_read_b64_tr_b16 v[86:87], v10 offset:6144
  v_cvt_pk_bf16_f32 v43, v210, v211
  v_mfma_f32_16x16x32_bf16 v[228:231], v[64:67], a[36:39], v[228:231]
  ds_read_b64_tr_b16 v[88:89], v10 offset:8192
  s_mov_b32 s35, 4096
  v_mfma_f32_16x16x32_bf16 v[232:235], v[56:59], a[8:11], 0
  ds_read_b64_tr_b16 v[90:91], v10 offset:10240
  buffer_store_dwordx4 v[40:43], v24, s[20:23], s35 offen sc1
  v_mfma_f32_16x16x32_bf16 v[232:235], v[60:63], a[24:27], v[232:235]
  s_add_u32 m0, s33, 45056
  v_cvt_pk_bf16_f32 v44, v196, v197
  v_mfma_f32_16x16x32_bf16 v[232:235], v[64:67], a[40:43], v[232:235]
  s_mov_b32 s34, 512
  v_cvt_pk_bf16_f32 v45, v198, v199
  v_mfma_f32_16x16x32_bf16 v[236:239], v[56:59], a[12:15], 0
  buffer_load_dwordx4 v22, s[12:15], s34 offen lds
  v_cvt_pk_bf16_f32 v46, v212, v213
  v_mfma_f32_16x16x32_bf16 v[236:239], v[60:63], a[28:31], v[236:239]
  v_cvt_pk_bf16_f32 v47, v214, v215
  s_mov_b32 s35, 22528
  v_mfma_f32_16x16x32_bf16 v[236:239], v[64:67], a[44:47], v[236:239]
  buffer_store_dwordx4 v[44:47], v24, s[20:23], s35 offen sc1
  s_waitcnt lgkmcnt(6)
  v_mfma_f32_16x16x32_bf16 v[240:243], v[68:71], a[0:3], 0
  ds_read_b64_tr_b16 v[56:57], v12 offset:36864
  v_cvt_pk_bf16_f32 v48, v200, v201
  v_mfma_f32_16x16x32_bf16 v[240:243], v[72:75], a[16:19], v[240:243]
  ds_read_b64_tr_b16 v[58:59], v12 offset:38912
  v_cvt_pk_bf16_f32 v49, v202, v203
  v_mfma_f32_16x16x32_bf16 v[240:243], v[76:79], a[32:35], v[240:243]
  ds_read_b64_tr_b16 v[60:61], v13 offset:4096
  v_cvt_pk_bf16_f32 v50, v216, v217
  v_mfma_f32_16x16x32_bf16 v[244:247], v[68:71], a[4:7], 0
  ds_read_b64_tr_b16 v[62:63], v13 offset:6144
  v_cvt_pk_bf16_f32 v51, v218, v219
  v_mfma_f32_16x16x32_bf16 v[244:247], v[72:75], a[20:23], v[244:247]
  ds_read_b64_tr_b16 v[64:65], v13 offset:8192
  s_mov_b32 s35, 40960
  v_mfma_f32_16x16x32_bf16 v[244:247], v[76:79], a[36:39], v[244:247]
  ds_read_b64_tr_b16 v[66:67], v13 offset:10240
  buffer_store_dwordx4 v[48:51], v24, s[20:23], s35 offen sc1
  v_mfma_f32_16x16x32_bf16 v[248:251], v[68:71], a[8:11], 0
  s_add_u32 m0, s33, 49152
  v_cvt_pk_bf16_f32 v52, v204, v205
  v_mfma_f32_16x16x32_bf16 v[248:251], v[72:75], a[24:27], v[248:251]
  s_mov_b32 s34, 640
  v_cvt_pk_bf16_f32 v53, v206, v207
  v_mfma_f32_16x16x32_bf16 v[248:251], v[76:79], a[40:43], v[248:251]
  buffer_load_dwordx4 v21, s[12:15], s34 offen lds
  v_cvt_pk_bf16_f32 v54, v220, v221
  v_mfma_f32_16x16x32_bf16 v[252:255], v[68:71], a[12:15], 0
  s_add_u32 m0, s33, 53248
  v_cvt_pk_bf16_f32 v55, v222, v223
  v_mfma_f32_16x16x32_bf16 v[252:255], v[72:75], a[28:31], v[252:255]
  s_mov_b32 s34, 37504
  s_mov_b32 s35, 59392
  v_mfma_f32_16x16x32_bf16 v[252:255], v[76:79], a[44:47], v[252:255]
  buffer_load_dwordx4 v21, s[12:15], s34 offen lds
  s_waitcnt lgkmcnt(6)
  v_mfma_f32_16x16x32_bf16 v[224:227], v[80:83], a[48:51], v[224:227]
  ds_read_b64_tr_b16 v[68:69], v9 offset:32768
  buffer_store_dwordx4 v[52:55], v24, s[20:23], s35 offen sc1
  v_mfma_f32_16x16x32_bf16 v[224:227], v[84:87], a[64:67], v[224:227]
  ds_read_b64_tr_b16 v[70:71], v9 offset:34816
  s_mov_b32 s63, 8192
  buffer_load_dword v31, v30, s[96:99], s63 offen sc1
  v_mfma_f32_16x16x32_bf16 v[224:227], v[88:91], a[80:83], v[224:227]
  ds_read_b64_tr_b16 v[72:73], v10 offset:12288
  v_mfma_f32_16x16x32_bf16 v[228:231], v[80:83], a[52:55], v[228:231]
  ds_read_b64_tr_b16 v[74:75], v10 offset:14336
  v_mfma_f32_16x16x32_bf16 v[228:231], v[84:87], a[68:71], v[228:231]
  ds_read_b64_tr_b16 v[76:77], v10 offset:16384
  v_mfma_f32_16x16x32_bf16 v[228:231], v[88:91], a[84:87], v[228:231]
  ds_read_b64_tr_b16 v[78:79], v10 offset:18432
  v_mfma_f32_16x16x32_bf16 v[232:235], v[80:83], a[56:59], v[232:235]
  s_add_u32 m0, s33, 57344
  v_mfma_f32_16x16x32_bf16 v[232:235], v[84:87], a[72:75], v[232:235]
  s_mov_b32 s34, 74368
  v_mfma_f32_16x16x32_bf16 v[232:235], v[88:91], a[88:91], v[232:235]
  buffer_load_dwordx4 v21, s[12:15], s34 offen lds
  v_mfma_f32_16x16x32_bf16 v[236:239], v[80:83], a[60:63], v[236:239]
  v_mfma_f32_16x16x32_bf16 v[236:239], v[84:87], a[76:79], v[236:239]
  v_mfma_f32_16x16x32_bf16 v[236:239], v[88:91], a[92:95], v[236:239]
  s_waitcnt lgkmcnt(6)
  v_mfma_f32_16x16x32_bf16 v[240:243], v[56:59], a[48:51], v[240:243]
  s_waitcnt vmcnt(15)
  s_barrier
  s_mov_b32 s63, 10240
  v_mov_b32 v179, 1
  buffer_store_dword v179, v29, s[96:99], s63 offen sc1
  v_mfma_f32_16x16x32_bf16 v[240:243], v[60:63], a[64:67], v[240:243]
  ds_read_b64_tr_b16 v[80:81], v12 offset:32768
  v_mfma_f32_16x16x32_bf16 v[240:243], v[64:67], a[80:83], v[240:243]
  ds_read_b64_tr_b16 v[82:83], v12 offset:34816
  v_mfma_f32_16x16x32_bf16 v[244:247], v[56:59], a[52:55], v[244:247]
  ds_read_b64_tr_b16 v[84:85], v13 offset:12288
  v_mfma_f32_16x16x32_bf16 v[244:247], v[60:63], a[68:71], v[244:247]
  ds_read_b64_tr_b16 v[86:87], v13 offset:14336
  v_mfma_f32_16x16x32_bf16 v[244:247], v[64:67], a[84:87], v[244:247]
  ds_read_b64_tr_b16 v[88:89], v13 offset:16384
  v_mfma_f32_16x16x32_bf16 v[248:251], v[56:59], a[56:59], v[248:251]
  ds_read_b64_tr_b16 v[90:91], v13 offset:18432
  v_mfma_f32_16x16x32_bf16 v[248:251], v[60:63], a[72:75], v[248:251]
  s_add_u32 m0, s33, 61440
  v_mfma_f32_16x16x32_bf16 v[248:251], v[64:67], a[88:91], v[248:251]
  s_mov_b32 s34, 111232
  v_mfma_f32_16x16x32_bf16 v[252:255], v[56:59], a[60:63], v[252:255]
  buffer_load_dwordx4 v21, s[12:15], s34 offen lds
  v_mfma_f32_16x16x32_bf16 v[252:255], v[60:63], a[76:79], v[252:255]
  s_add_u32 m0, s33, 65536
  v_mfma_f32_16x16x32_bf16 v[252:255], v[64:67], a[92:95], v[252:255]
  s_mov_b32 s34, 148096
  buffer_load_dwordx4 v21, s[12:15], s34 offen lds
  s_waitcnt lgkmcnt(6)
  v_mfma_f32_16x16x32_bf16 v[224:227], v[68:71], a[96:99], v[224:227]
  ds_read_b64_tr_b16 v[56:57], v9 offset:40960
  v_mfma_f32_16x16x32_bf16 v[224:227], v[72:75], a[112:115], v[224:227]
  ds_read_b64_tr_b16 v[58:59], v9 offset:43008
  v_mfma_f32_16x16x32_bf16 v[224:227], v[76:79], a[128:131], v[224:227]
  ds_read_b64_tr_b16 v[60:61], v9 offset:45056
  v_mfma_f32_16x16x32_bf16 v[228:231], v[68:71], a[100:103], v[228:231]
  ds_read_b64_tr_b16 v[62:63], v9 offset:47104
  v_mfma_f32_16x16x32_bf16 v[228:231], v[72:75], a[116:119], v[228:231]
  ds_read_b64_tr_b16 v[64:65], v10 offset:20480
  v_mfma_f32_16x16x32_bf16 v[228:231], v[76:79], a[132:135], v[228:231]
  ds_read_b64_tr_b16 v[66:67], v10 offset:22528
  v_mfma_f32_16x16x32_bf16 v[232:235], v[68:71], a[104:107], v[232:235]
  s_add_u32 m0, s33, 69632
  v_mfma_f32_16x16x32_bf16 v[232:235], v[72:75], a[120:123], v[232:235]
  s_mov_b32 s34, 184960
  v_mfma_f32_16x16x32_bf16 v[232:235], v[76:79], a[136:139], v[232:235]
  buffer_load_dwordx4 v21, s[12:15], s34 offen lds
  v_mfma_f32_16x16x32_bf16 v[236:239], v[68:71], a[108:111], v[236:239]
  v_mfma_f32_16x16x32_bf16 v[236:239], v[72:75], a[124:127], v[236:239]
  v_mfma_f32_16x16x32_bf16 v[236:239], v[76:79], a[140:143], v[236:239]
  s_waitcnt lgkmcnt(6)
  v_mfma_f32_16x16x32_bf16 v[240:243], v[80:83], a[96:99], v[240:243]
  ds_read_b64_tr_b16 v[68:69], v12 offset:40960
  v_mfma_f32_16x16x32_bf16 v[240:243], v[84:87], a[112:115], v[240:243]
  ds_read_b64_tr_b16 v[70:71], v12 offset:43008
  v_mfma_f32_16x16x32_bf16 v[240:243], v[88:91], a[128:131], v[240:243]
  ds_read_b64_tr_b16 v[72:73], v12 offset:45056
  v_mfma_f32_16x16x32_bf16 v[244:247], v[80:83], a[100:103], v[244:247]
  ds_read_b64_tr_b16 v[74:75], v12 offset:47104
  v_mfma_f32_16x16x32_bf16 v[244:247], v[84:87], a[116:119], v[244:247]
  ds_read_b64_tr_b16 v[76:77], v13 offset:20480
  v_mfma_f32_16x16x32_bf16 v[244:247], v[88:91], a[132:135], v[244:247]
  ds_read_b64_tr_b16 v[78:79], v13 offset:22528
  v_mfma_f32_16x16x32_bf16 v[248:251], v[80:83], a[104:107], v[248:251]
  s_add_u32 m0, s33, 73728
  v_mfma_f32_16x16x32_bf16 v[248:251], v[84:87], a[120:123], v[248:251]
  s_mov_b32 s34, 221824
  v_mfma_f32_16x16x32_bf16 v[248:251], v[88:91], a[136:139], v[248:251]
  buffer_load_dwordx4 v21, s[12:15], s34 offen lds
  v_mfma_f32_16x16x32_bf16 v[252:255], v[80:83], a[108:111], v[252:255]
  s_add_u32 m0, s33, 77824
  v_mfma_f32_16x16x32_bf16 v[252:255], v[84:87], a[124:127], v[252:255]
  s_mov_b32 s34, 258688
  v_mfma_f32_16x16x32_bf16 v[252:255], v[88:91], a[140:143], v[252:255]
  buffer_load_dwordx4 v21, s[12:15], s34 offen lds
  s_waitcnt lgkmcnt(6)
  v_mfma_f32_16x16x32_bf16 v[192:195], v[56:59], a[0:3], 0
  s_waitcnt vmcnt(13)
  s_barrier
  v_mfma_f32_16x16x32_bf16 v[192:195], v[60:63], a[16:19], v[192:195]
  ds_read_b64_tr_b16 v[80:81], v10 offset:24576
  s_add_u32 m0, s33, 81920
  s_waitcnt vmcnt(7)
  v_cmp_eq_u32 vcc, 0, v31
  s_cbranch_vccnz L_sp_11
L_bk_12:
  v_mfma_f32_16x16x32_bf16 v[192:195], v[64:67], a[32:35], v[192:195]
  ds_read_b64_tr_b16 v[82:83], v10 offset:26624
  s_mov_b32 s34, 640
  v_mfma_f32_16x16x32_bf16 v[196:199], v[56:59], a[4:7], 0
  ds_read_b64_tr_b16 v[84:85], v9 offset:49152
  buffer_load_dwordx4 v22, s[12:15], s34 offen lds
  v_mfma_f32_16x16x32_bf16 v[196:199], v[60:63], a[20:23], v[196:199]
  ds_read_b64_tr_b16 v[86:87], v9 offset:51200
  s_add_u32 m0, s66, 0
  v_mfma_f32_16x16x32_bf16 v[196:199], v[64:67], a[36:39], v[196:199]
  ds_read_b64_tr_b16 v[88:89], v9 offset:53248
  s_mov_b32 s64, 0
  v_mfma_f32_16x16x32_bf16 v[200:203], v[56:59], a[8:11], 0
  ds_read_b64_tr_b16 v[90:91], v9 offset:55296
  buffer_load_dwordx4 v7, s[44:47], s64 offen lds
  v_mfma_f32_16x16x32_bf16 v[200:203], v[60:63], a[24:27], v[200:203]
  s_add_u32 m0, s66, 0
  v_cvt_pk_bf16_f32 v40, v224, v225
  v_mfma_f32_16x16x32_bf16 v[200:203], v[64:67], a[40:43], v[200:203]
  s_mov_b32 s64, 0
  v_cvt_pk_bf16_f32 v41, v226, v227
  v_mfma_f32_16x16x32_bf16 v[204:207], v[56:59], a[12:15], 0
  buffer_load_dwordx4 v7, s[44:47], s64 offen offset:1024 lds
  v_cvt_pk_bf16_f32 v42, v240, v241
  v_mfma_f32_16x16x32_bf16 v[204:207], v[60:63], a[28:31], v[204:207]
  v_cvt_pk_bf16_f32 v43, v242, v243
  s_mov_b32 s35, 6144
  v_mfma_f32_16x16x32_bf16 v[204:207], v[64:67], a[44:47], v[204:207]
  buffer_store_dwordx4 v[40:43], v24, s[20:23], s35 offen sc1
  s_waitcnt lgkmcnt(6)
  v_mfma_f32_16x16x32_bf16 v[208:211], v[68:71], a[0:3], 0
  ds_read_b64_tr_b16 v[56:57], v13 offset:24576
  s_add_u32 m0, s33, 86016
  v_mfma_f32_16x16x32_bf16 v[208:211], v[72:75], a[16:19], v[208:211]
  ds_read_b64_tr_b16 v[58:59], v13 offset:26624
  s_mov_b32 s34, 768
  v_mfma_f32_16x16x32_bf16 v[208:211], v[76:79], a[32:35], v[208:211]
  ds_read_b64_tr_b16 v[60:61], v12 offset:49152
  buffer_load_dwordx4 v21, s[12:15], s34 offen lds
  v_mfma_f32_16x16x32_bf16 v[212:215], v[68:71], a[4:7], 0
  ds_read_b64_tr_b16 v[62:63], v12 offset:51200
  s_add_u32 m0, s33, 126976
  v_mfma_f32_16x16x32_bf16 v[212:215], v[72:75], a[20:23], v[212:215]
  ds_read_b64_tr_b16 v[64:65], v12 offset:53248
  s_mov_b32 s34, 37632
  v_mfma_f32_16x16x32_bf16 v[212:215], v[76:79], a[36:39], v[212:215]
  ds_read_b64_tr_b16 v[66:67], v12 offset:55296
  buffer_load_dwordx4 v21, s[12:15], s34 offen lds
  v_mfma_f32_16x16x32_bf16 v[216:219], v[68:71], a[8:11], 0
  s_add_u32 m0, s66, 0
  v_cvt_pk_bf16_f32 v44, v228, v229
  v_mfma_f32_16x16x32_bf16 v[216:219], v[72:75], a[24:27], v[216:219]
  s_mov_b32 s64, 0
  v_cvt_pk_bf16_f32 v45, v230, v231
  v_mfma_f32_16x16x32_bf16 v[216:219], v[76:79], a[40:43], v[216:219]
  buffer_load_dwordx4 v7, s[44:47], s64 offen offset:2048 lds
  v_cvt_pk_bf16_f32 v46, v244, v245
  v_mfma_f32_16x16x32_bf16 v[220:223], v[68:71], a[12:15], 0
  v_cvt_pk_bf16_f32 v47, v246, v247
  s_mov_b32 s35, 24576
  v_mfma_f32_16x16x32_bf16 v[220:223], v[72:75], a[28:31], v[220:223]
  buffer_store_dwordx4 v[44:47], v24, s[20:23], s35 offen sc1
  v_cvt_pk_bf16_f32 v48, v232, v233
  v_mfma_f32_16x16x32_bf16 v[220:223], v[76:79], a[44:47], v[220:223]
  v_cvt_pk_bf16_f32 v49, v234, v235
  s_waitcnt lgkmcnt(6)
  v_mfma_f32_16x16x32_bf16 v[192:195], v[80:83], a[48:51], v[192:195]
  ds_read_b64_tr_b16 v[68:69], v9 offset:57344
  v_cvt_pk_bf16_f32 v50, v248, v249
  v_mfma_f32_16x16x32_bf16 v[192:195], v[84:87], a[64:67], v[192:195]
  ds_read_b64_tr_b16 v[70:71], v9 offset:59392
  v_cvt_pk_bf16_f32 v51, v250, v251
  v_mfma_f32_16x16x32_bf16 v[192:195], v[88:91], a[80:83], v[192:195]
  ds_read_b64_tr_b16 v[72:73], v10 offset:28672
  s_mov_b32 s35, 43008
  v_mfma_f32_16x16x32_bf16 v[196:199], v[80:83], a[52:55], v[196:199]
  ds_read_b64_tr_b16 v[74:75], v10 offset:30720
  buffer_store_dwordx4 v[48:51], v24, s[20:23], s35 offen sc1
  v_mfma_f32_16x16x32_bf16 v[196:199], v[84:87], a[68:71], v[196:199]
  ds_read_b64_tr_b16 v[76:77], v8 offset:45056
  v_cvt_pk_bf16_f32 v52, v236, v237
  v_mfma_f32_16x16x32_bf16 v[196:199], v[88:91], a[84:87], v[196:199]
  ds_read_b64_tr_b16 v[78:79], v8 offset:47104
  v_cvt_pk_bf16_f32 v53, v238, v239
  v_mfma_f32_16x16x32_bf16 v[200:203], v[80:83], a[56:59], v[200:203]
  s_add_u32 m0, s33, 131072
  v_cvt_pk_bf16_f32 v54, v252, v253
  v_mfma_f32_16x16x32_bf16 v[200:203], v[84:87], a[72:75], v[200:203]
  s_mov_b32 s34, 74496
  v_cvt_pk_bf16_f32 v55, v254, v255
  v_mfma_f32_16x16x32_bf16 v[200:203], v[88:91], a[88:91], v[200:203]
  buffer_load_dwordx4 v21, s[12:15], s34 offen lds
  s_mov_b32 s35, 61440
  v_mfma_f32_16x16x32_bf16 v[204:207], v[80:83], a[60:63], v[204:207]
  s_add_u32 m0, s66, 0
  buffer_store_dwordx4 v[52:55], v24, s[20:23], s35 offen sc1
  v_mfma_f32_16x16x32_bf16 v[204:207], v[84:87], a[76:79], v[204:207]
  s_mov_b32 s64, 0
  buffer_load_dwordx4 a[144:147], v160, s[28:31], 0 offen sc1
  v_mfma_f32_16x16x32_bf16 v[204:207], v[88:91], a[92:95], v[204:207]
  buffer_load_dwordx4 v7, s[44:47], s64 offen offset:3072 lds
  s_waitcnt lgkmcnt(6)
  v_mfma_f32_16x16x32_bf16 v[208:211], v[56:59], a[48:51], v[208:211]
  s_waitcnt vmcnt(19)
  s_barrier
  s_mov_b32 s63, 12288
  v_mov_b32 v179, 1
  buffer_store_dword v179, v29, s[96:99], s63 offen sc1
  v_mfma_f32_16x16x32_bf16 v[208:211], v[60:63], a[64:67], v[208:211]
  ds_read_b64_tr_b16 v[80:81], v12 offset:57344
  s_add_u32 m0, s33, 90112
  v_mfma_f32_16x16x32_bf16 v[208:211], v[64:67], a[80:83], v[208:211]
  ds_read_b64_tr_b16 v[82:83], v12 offset:59392
  s_mov_b32 s34, 111360
  v_mfma_f32_16x16x32_bf16 v[212:215], v[56:59], a[52:55], v[212:215]
  ds_read_b64_tr_b16 v[84:85], v13 offset:28672
  buffer_load_dwordx4 v21, s[12:15], s34 offen lds
  v_mfma_f32_16x16x32_bf16 v[212:215], v[60:63], a[68:71], v[212:215]
  ds_read_b64_tr_b16 v[86:87], v13 offset:30720
  s_add_u32 m0, s33, 94208
  v_mfma_f32_16x16x32_bf16 v[212:215], v[64:67], a[84:87], v[212:215]
  ds_read_b64_tr_b16 v[88:89], v11 offset:45056
  s_mov_b32 s34, 148224
  v_mfma_f32_16x16x32_bf16 v[216:219], v[56:59], a[56:59], v[216:219]
  ds_read_b64_tr_b16 v[90:91], v11 offset:47104
  buffer_load_dwordx4 v21, s[12:15], s34 offen lds
  v_mfma_f32_16x16x32_bf16 v[216:219], v[60:63], a[72:75], v[216:219]
  s_add_u32 m0, s66, 16384
  buffer_load_dwordx4 a[148:151], v160, s[28:31], s60 offen sc1
  v_mfma_f32_16x16x32_bf16 v[216:219], v[64:67], a[88:91], v[216:219]
  s_mov_b32 s64, 16384
  buffer_load_dwordx4 a[152:155], v160, s[28:31], s61 offen sc1
  v_mfma_f32_16x16x32_bf16 v[220:223], v[56:59], a[60:63], v[220:223]
  buffer_load_dwordx4 v7, s[44:47], s64 offen lds
  buffer_load_dwordx4 a[156:159], v160, s[28:31], s62 offen sc1
  v_mfma_f32_16x16x32_bf16 v[220:223], v[60:63], a[76:79], v[220:223]
  v_mfma_f32_16x16x32_bf16 v[220:223], v[64:67], a[92:95], v[220:223]
  s_waitcnt lgkmcnt(6)
  v_mfma_f32_16x16x32_bf16 v[192:195], v[68:71], a[96:99], v[192:195]
  ds_read_b64_tr_b16 v[56:57], v8 offset:49152
  s_add_u32 m0, s33, 102400
  v_mfma_f32_16x16x32_bf16 v[192:195], v[72:75], a[112:115], v[192:195]
  ds_read_b64_tr_b16 v[58:59], v8 offset:51200
  s_mov_b32 s34, 185088
  v_mfma_f32_16x16x32_bf16 v[192:195], v[76:79], a[128:131], v[192:195]
  ds_read_b64_tr_b16 v[60:61], v8 offset:53248
  buffer_load_dwordx4 v21, s[12:15], s34 offen lds
  v_mfma_f32_16x16x32_bf16 v[196:199], v[68:71], a[100:103], v[196:199]
  ds_read_b64_tr_b16 v[62:63], v8 offset:55296
  s_add_u32 m0, s66, 16384
  v_mfma_f32_16x16x32_bf16 v[196:199], v[72:75], a[116:119], v[196:199]
  ds_read_b64_tr_b16 v[64:65], v8 offset:57344
  s_mov_b32 s64, 16384
  v_mfma_f32_16x16x32_bf16 v[196:199], v[76:79], a[132:135], v[196:199]
  ds_read_b64_tr_b16 v[66:67], v8 offset:59392
  buffer_load_dwordx4 v7, s[44:47], s64 offen offset:1024 lds
  v_mfma_f32_16x16x32_bf16 v[200:203], v[68:71], a[104:107], v[200:203]
  s_add_u32 m0, s66, 16384
  s_mov_b32 s63, 10240
  buffer_load_dword v31, v30, s[96:99], s63 offen sc1
  v_mfma_f32_16x16x32_bf16 v[200:203], v[72:75], a[120:123], v[200:203]
  s_mov_b32 s64, 16384
  v_mfma_f32_16x16x32_bf16 v[200:203], v[76:79], a[136:139], v[200:203]
  buffer_load_dwordx4 v7, s[44:47], s64 offen offset:2048 lds
  v_mfma_f32_16x16x32_bf16 v[204:207], v[68:71], a[108:111], v[204:207]
  v_mfma_f32_16x16x32_bf16 v[204:207], v[72:75], a[124:127], v[204:207]
  v_mfma_f32_16x16x32_bf16 v[204:207], v[76:79], a[140:143], v[204:207]
  s_waitcnt lgkmcnt(6)
  v_mfma_f32_16x16x32_bf16 v[208:211], v[80:83], a[96:99], v[208:211]
  ds_read_b64_tr_b16 v[68:69], v11 offset:49152
  s_add_u32 m0, s33, 135168
  v_mfma_f32_16x16x32_bf16 v[208:211], v[84:87], a[112:115], v[208:211]
  ds_read_b64_tr_b16 v[70:71], v11 offset:51200
  s_mov_b32 s34, 221952
  v_mfma_f32_16x16x32_bf16 v[208:211], v[88:91], a[128:131], v[208:211]
  ds_read_b64_tr_b16 v[72:73], v11 offset:53248
  buffer_load_dwordx4 v21, s[12:15], s34 offen lds
  v_mfma_f32_16x16x32_bf16 v[212:215], v[80:83], a[100:103], v[212:215]
  ds_read_b64_tr_b16 v[74:75], v11 offset:55296
  s_add_u32 m0, s33, 139264
  v_mfma_f32_16x16x32_bf16 v[212:215], v[84:87], a[116:119], v[212:215]
  ds_read_b64_tr_b16 v[76:77], v11 offset:57344
  s_mov_b32 s34, 258816
  v_mfma_f32_16x16x32_bf16 v[212:215], v[88:91], a[132:135], v[212:215]
  ds_read_b64_tr_b16 v[78:79], v11 offset:59392
  buffer_load_dwordx4 v21, s[12:15], s34 offen lds
  v_mfma_f32_16x16x32_bf16 v[216:219], v[80:83], a[104:107], v[216:219]
  s_add_u32 m0, s66, 16384
  v_mfma_f32_16x16x32_bf16 v[216:219], v[84:87], a[120:123], v[216:219]
  s_mov_b32 s64, 16384
  v_mfma_f32_16x16x32_bf16 v[216:219], v[88:91], a[136:139], v[216:219]
  buffer_load_dwordx4 v7, s[44:47], s64 offen offset:3072 lds
  v_mfma_f32_16x16x32_bf16 v[220:223], v[80:83], a[108:111], v[220:223]
  v_mfma_f32_16x16x32_bf16 v[220:223], v[84:87], a[124:127], v[220:223]
  v_mfma_f32_16x16x32_bf16 v[220:223], v[88:91], a[140:143], v[220:223]
  s_waitcnt lgkmcnt(6)
  v_mfma_f32_16x16x32_bf16 v[224:227], v[56:59], a[0:3], 0
  s_waitcnt vmcnt(26)
  s_barrier
  v_mfma_f32_16x16x32_bf16 v[224:227], v[60:63], a[16:19], v[224:227]
  ds_read_b64_tr_b16 v[80:81], v8 offset:61440
  s_add_u32 m0, s33, 98304
  v_mfma_f32_16x16x32_bf16 v[224:227], v[64:67], a[32:35], v[224:227]
  ds_read_b64_tr_b16 v[82:83], v8 offset:63488
  s_mov_b32 s34, 768
  v_mfma_f32_16x16x32_bf16 v[228:231], v[56:59], a[4:7], 0
  ds_read_b64_tr_b16 v[84:85], v9
  buffer_load_dwordx4 v22, s[12:15], s34 offen lds
  v_mfma_f32_16x16x32_bf16 v[228:231], v[60:63], a[20:23], v[228:231]
  ds_read_b64_tr_b16 v[86:87], v9 offset:2048
  s_add_u32 m0, s66, 32768
  v_mfma_f32_16x16x32_bf16 v[228:231], v[64:67], a[36:39], v[228:231]
  ds_read_b64_tr_b16 v[88:89], v9 offset:4096
  s_mov_b32 s64, 32768
  v_mfma_f32_16x16x32_bf16 v[232:235], v[56:59], a[8:11], 0
  ds_read_b64_tr_b16 v[90:91], v9 offset:6144
  buffer_load_dwordx4 v7, s[44:47], s64 offen lds
  v_mfma_f32_16x16x32_bf16 v[232:235], v[60:63], a[24:27], v[232:235]
  s_add_u32 m0, s66, 32768
  v_cvt_pk_bf16_f32 v40, v192, v193
  v_mfma_f32_16x16x32_bf16 v[232:235], v[64:67], a[40:43], v[232:235]
  s_mov_b32 s64, 32768
  v_cvt_pk_bf16_f32 v41, v194, v195
  v_mfma_f32_16x16x32_bf16 v[236:239], v[56:59], a[12:15], 0
  buffer_load_dwordx4 v7, s[44:47], s64 offen offset:1024 lds
  v_cvt_pk_bf16_f32 v42, v208, v209
  v_mfma_f32_16x16x32_bf16 v[236:239], v[60:63], a[28:31], v[236:239]
  v_cvt_pk_bf16_f32 v43, v210, v211
  s_mov_b32 s35, 8192
  v_mfma_f32_16x16x32_bf16 v[236:239], v[64:67], a[44:47], v[236:239]
  buffer_store_dwordx4 v[40:43], v24, s[20:23], s35 offen sc1
  s_waitcnt lgkmcnt(6)
  v_mfma_f32_16x16x32_bf16 v[240:243], v[68:71], a[0:3], 0
  ds_read_b64_tr_b16 v[56:57], v11 offset:61440
  s_add_u32 m0, s33, 143360
  v_mfma_f32_16x16x32_bf16 v[240:243], v[72:75], a[16:19], v[240:243]
  ds_read_b64_tr_b16 v[58:59], v11 offset:63488
  s_mov_b32 s34, 896
  v_mfma_f32_16x16x32_bf16 v[240:243], v[76:79], a[32:35], v[240:243]
  ds_read_b64_tr_b16 v[60:61], v12
  buffer_load_dwordx4 v21, s[12:15], s34 offen lds
  v_mfma_f32_16x16x32_bf16 v[244:247], v[68:71], a[4:7], 0
  ds_read_b64_tr_b16 v[62:63], v12 offset:2048
  s_add_u32 m0, s33, 147456
  v_mfma_f32_16x16x32_bf16 v[244:247], v[72:75], a[20:23], v[244:247]
  ds_read_b64_tr_b16 v[64:65], v12 offset:4096
  s_mov_b32 s34, 37760
  v_mfma_f32_16x16x32_bf16 v[244:247], v[76:79], a[36:39], v[244:247]
  ds_read_b64_tr_b16 v[66:67], v12 offset:6144
  buffer_load_dwordx4 v21, s[12:15], s34 offen lds
  v_mfma_f32_16x16x32_bf16 v[248:251], v[68:71], a[8:11], 0
  s_add_u32 m0, s66, 32768
  v_cvt_pk_bf16_f32 v44, v196, v197
  v_mfma_f32_16x16x32_bf16 v[248:251], v[72:75], a[24:27], v[248:251]
  s_mov_b32 s64, 32768
  v_cvt_pk_bf16_f32 v45, v198, v199
  v_mfma_f32_16x16x32_bf16 v[248:251], v[76:79], a[40:43], v[248:251]
  buffer_load_dwordx4 v7, s[44:47], s64 offen offset:2048 lds
  v_cvt_pk_bf16_f32 v46, v212, v213
  v_mfma_f32_16x16x32_bf16 v[252:255], v[68:71], a[12:15], 0
  v_cvt_pk_bf16_f32 v47, v214, v215
  s_mov_b32 s35, 26624
  v_mfma_f32_16x16x32_bf16 v[252:255], v[72:75], a[28:31], v[252:255]
  buffer_store_dwordx4 v[44:47], v24, s[20:23], s35 offen sc1
  v_cvt_pk_bf16_f32 v48, v200, v201
  v_mfma_f32_16x16x32_bf16 v[252:255], v[76:79], a[44:47], v[252:255]
  v_cvt_pk_bf16_f32 v49, v202, v203
  s_waitcnt lgkmcnt(6)
  v_mfma_f32_16x16x32_bf16 v[224:227], v[80:83], a[48:51], v[224:227]
  ds_read_b64_tr_b16 v[68:69], v9 offset:8192
  v_cvt_pk_bf16_f32 v50, v216, v217
  v_mfma_f32_16x16x32_bf16 v[224:227], v[84:87], a[64:67], v[224:227]
  ds_read_b64_tr_b16 v[70:71], v9 offset:10240
  v_cvt_pk_bf16_f32 v51, v218, v219
  s_waitcnt vmcnt(12)
  v_cmp_eq_u32 vcc, 0, v31
  s_cbranch_vccnz L_sp_14
L_bk_15:
  v_mfma_f32_16x16x32_bf16 v[224:227], v[88:91], a[80:83], v[224:227]
  ds_read_b64_tr_b16 v[72:73], v9 offset:12288
  s_mov_b32 s35, 45056
  v_mfma_f32_16x16x32_bf16 v[228:231], v[80:83], a[52:55], v[228:231]
  ds_read_b64_tr_b16 v[74:75], v9 offset:14336
  buffer_store_dwordx4 v[48:51], v24, s[20:23], s35 offen sc1
  v_mfma_f32_16x16x32_bf16 v[228:231], v[84:87], a[68:71], v[228:231]
  ds_read_b64_tr_b16 v[76:77], v9 offset:16384
  v_cvt_pk_bf16_f32 v52, v204, v205
  v_mfma_f32_16x16x32_bf16 v[228:231], v[88:91], a[84:87], v[228:231]
  ds_read_b64_tr_b16 v[78:79], v9 offset:18432
  v_cvt_pk_bf16_f32 v53, v206, v207
  v_mfma_f32_16x16x32_bf16 v[232:235], v[80:83], a[56:59], v[232:235]
  s_add_u32 m0, s33, 106496
  v_cvt_pk_bf16_f32 v54, v220, v221
  v_mfma_f32_16x16x32_bf16 v[232:235], v[84:87], a[72:75], v[232:235]
  s_mov_b32 s34, 74624
  v_cvt_pk_bf16_f32 v55, v222, v223
  v_mfma_f32_16x16x32_bf16 v[232:235], v[88:91], a[88:91], v[232:235]
  buffer_load_dwordx4 v21, s[12:15], s34 offen lds
  s_mov_b32 s35, 63488
  v_mfma_f32_16x16x32_bf16 v[236:239], v[80:83], a[60:63], v[236:239]
  s_add_u32 m0, s66, 32768
  buffer_store_dwordx4 v[52:55], v24, s[20:23], s35 offen sc1
  v_mfma_f32_16x16x32_bf16 v[236:239], v[84:87], a[76:79], v[236:239]
  s_mov_b32 s64, 32768
  v_mfma_f32_16x16x32_bf16 v[96:99], v[180:183], a[144:147], 0
  v_mfma_f32_16x16x32_bf16 v[236:239], v[88:91], a[92:95], v[236:239]
  buffer_load_dwordx4 v7, s[44:47], s64 offen offset:3072 lds
  s_waitcnt lgkmcnt(6)
  v_mfma_f32_16x16x32_bf16 v[240:243], v[56:59], a[48:51], v[240:243]
  s_barrier
  s_mov_b32 s63, 14336
  v_mov_b32 v179, 1
  buffer_store_dword v179, v29, s[96:99], s63 offen sc1
  v_mfma_f32_16x16x32_bf16 v[240:243], v[60:63], a[64:67], v[240:243]
  ds_read_b64_tr_b16 v[80:81], v12 offset:8192
  s_add_u32 m0, s33, 110592
  v_mfma_f32_16x16x32_bf16 v[240:243], v[64:67], a[80:83], v[240:243]
  ds_read_b64_tr_b16 v[82:83], v12 offset:10240
  s_mov_b32 s34, 111488
  v_mfma_f32_16x16x32_bf16 v[244:247], v[56:59], a[52:55], v[244:247]
  ds_read_b64_tr_b16 v[84:85], v12 offset:12288
  buffer_load_dwordx4 v21, s[12:15], s34 offen lds
  v_mfma_f32_16x16x32_bf16 v[244:247], v[60:63], a[68:71], v[244:247]
  ds_read_b64_tr_b16 v[86:87], v12 offset:14336
  s_add_u32 m0, s33, 151552
  v_mfma_f32_16x16x32_bf16 v[244:247], v[64:67], a[84:87], v[244:247]
  ds_read_b64_tr_b16 v[88:89], v12 offset:16384
  s_mov_b32 s34, 148352
  v_mfma_f32_16x16x32_bf16 v[248:251], v[56:59], a[56:59], v[248:251]
  ds_read_b64_tr_b16 v[90:91], v12 offset:18432
  buffer_load_dwordx4 v21, s[12:15], s34 offen lds
  v_mfma_f32_16x16x32_bf16 v[248:251], v[60:63], a[72:75], v[248:251]
  s_add_u32 m0, s66, 49152
  v_mfma_f32_16x16x32_bf16 v[96:99], v[180:183], a[148:151], v[96:99]
  v_mfma_f32_16x16x32_bf16 v[248:251], v[64:67], a[88:91], v[248:251]
  s_mov_b32 s64, 49152
  v_mfma_f32_16x16x32_bf16 v[96:99], v[180:183], a[152:155], v[96:99]
  v_mfma_f32_16x16x32_bf16 v[252:255], v[56:59], a[60:63], v[252:255]
  buffer_load_dwordx4 v7, s[44:47], s64 offen lds
  v_mfma_f32_16x16x32_bf16 v[96:99], v[180:183], a[156:159], v[96:99]
  v_mfma_f32_16x16x32_bf16 v[252:255], v[60:63], a[76:79], v[252:255]
  buffer_load_dwordx4 a[160:163], v160, s[28:31], 0 offen offset:2048 sc1
  v_mfma_f32_16x16x32_bf16 v[252:255], v[64:67], a[92:95], v[252:255]
  buffer_load_dwordx4 a[164:167], v160, s[28:31], s60 offen offset:2048 sc1
  s_waitcnt lgkmcnt(6)
  v_mfma_f32_16x16x32_bf16 v[224:227], v[68:71], a[96:99], v[224:227]
  ds_read_b64_tr_b16 v[56:57], v9 offset:20480
  s_add_u32 m0, s33, 155648
  v_mfma_f32_16x16x32_bf16 v[224:227], v[72:75], a[112:115], v[224:227]
  ds_read_b64_tr_b16 v[58:59], v9 offset:22528
  s_mov_b32 s34, 185216
  v_mfma_f32_16x16x32_bf16 v[224:227], v[76:79], a[128:131], v[224:227]
  ds_read_b64_tr_b16 v[60:61], v9 offset:61440
  buffer_load_dwordx4 v21, s[12:15], s34 offen lds
  v_mfma_f32_16x16x32_bf16 v[228:231], v[68:71], a[100:103], v[228:231]
  ds_read_b64_tr_b16 v[62:63], v9 offset:63488
  s_add_u32 m0, s66, 49152
  v_mfma_f32_16x16x32_bf16 v[228:231], v[72:75], a[116:119], v[228:231]
  ds_read_b64_tr_b16 v[64:65], v10
  s_mov_b32 s64, 49152
  v_mfma_f32_16x16x32_bf16 v[228:231], v[76:79], a[132:135], v[228:231]
  ds_read_b64_tr_b16 v[66:67], v10 offset:2048
  buffer_load_dwordx4 v7, s[44:47], s64 offen offset:1024 lds
  v_mfma_f32_16x16x32_bf16 v[232:235], v[68:71], a[104:107], v[232:235]
  s_add_u32 m0, s66, 49152
  buffer_load_dwordx4 a[168:171], v160, s[28:31], s61 offen offset:2048 sc1
  v_mfma_f32_16x16x32_bf16 v[232:235], v[72:75], a[120:123], v[232:235]
  s_mov_b32 s64, 49152
  buffer_load_dwordx4 a[172:175], v160, s[28:31], s62 offen offset:2048 sc1
  v_mfma_f32_16x16x32_bf16 v[232:235], v[76:79], a[136:139], v[232:235]
  buffer_load_dwordx4 v7, s[44:47], s64 offen offset:2048 lds
  v_mfma_f32_16x16x32_bf16 v[236:239], v[68:71], a[108:111], v[236:239]
  v_mfma_f32_16x16x32_bf16 v[236:239], v[72:75], a[124:127], v[236:239]
  v_mfma_f32_16x16x32_bf16 v[236:239], v[76:79], a[140:143], v[236:239]
  s_waitcnt lgkmcnt(6)
  v_mfma_f32_16x16x32_bf16 v[240:243], v[80:83], a[96:99], v[240:243]
  ds_read_b64_tr_b16 v[68:69], v12 offset:20480
  s_add_u32 m0, s33, 114688
  v_mfma_f32_16x16x32_bf16 v[240:243], v[84:87], a[112:115], v[240:243]
  ds_read_b64_tr_b16 v[70:71], v12 offset:22528
  s_mov_b32 s34, 222080
  v_mfma_f32_16x16x32_bf16 v[240:243], v[88:91], a[128:131], v[240:243]
  ds_read_b64_tr_b16 v[72:73], v12 offset:61440
  buffer_load_dwordx4 v21, s[12:15], s34 offen lds
  v_mfma_f32_16x16x32_bf16 v[244:247], v[80:83], a[100:103], v[244:247]
  ds_read_b64_tr_b16 v[74:75], v12 offset:63488
  s_add_u32 m0, s33, 118784
  v_mfma_f32_16x16x32_bf16 v[244:247], v[84:87], a[116:119], v[244:247]
  ds_read_b64_tr_b16 v[76:77], v13
  s_mov_b32 s34, 258944
  v_mfma_f32_16x16x32_bf16 v[244:247], v[88:91], a[132:135], v[244:247]
  ds_read_b64_tr_b16 v[78:79], v13 offset:2048
  buffer_load_dwordx4 v21, s[12:15], s34 offen lds
  v_mfma_f32_16x16x32_bf16 v[248:251], v[80:83], a[104:107], v[248:251]
  s_add_u32 m0, s66, 49152
  s_mov_b32 s63, 12288
  buffer_load_dword v31, v30, s[96:99], s63 offen sc1
  v_mfma_f32_16x16x32_bf16 v[248:251], v[84:87], a[120:123], v[248:251]
  s_mov_b32 s64, 49152
  v_mfma_f32_16x16x32_bf16 v[248:251], v[88:91], a[136:139], v[248:251]
  buffer_load_dwordx4 v7, s[44:47], s64 offen offset:3072 lds
  v_mfma_f32_16x16x32_bf16 v[252:255], v[80:83], a[108:111], v[252:255]
  v_mfma_f32_16x16x32_bf16 v[252:255], v[84:87], a[124:127], v[252:255]
  v_mfma_f32_16x16x32_bf16 v[252:255], v[88:91], a[140:143], v[252:255]
  s_waitcnt lgkmcnt(6)
  v_mfma_f32_16x16x32_bf16 v[192:195], v[56:59], a[0:3], 0
  s_waitcnt vmcnt(26)
  s_barrier
  v_mfma_f32_16x16x32_bf16 v[192:195], v[60:63], a[16:19], v[192:195]
  ds_read_b64_tr_b16 v[80:81], v9 offset:24576
  s_add_u32 m0, s33, 122880
  v_mfma_f32_16x16x32_bf16 v[192:195], v[64:67], a[32:35], v[192:195]
  ds_read_b64_tr_b16 v[82:83], v9 offset:26624
  s_mov_b32 s34, 896
  v_mfma_f32_16x16x32_bf16 v[196:199], v[56:59], a[4:7], 0
  ds_read_b64_tr_b16 v[84:85], v9 offset:28672
  buffer_load_dwordx4 v22, s[12:15], s34 offen lds
  v_mfma_f32_16x16x32_bf16 v[196:199], v[60:63], a[20:23], v[196:199]
  ds_read_b64_tr_b16 v[86:87], v9 offset:30720
  s_add_u32 m0, s66, 65536
  v_mfma_f32_16x16x32_bf16 v[196:199], v[64:67], a[36:39], v[196:199]
  ds_read_b64_tr_b16 v[88:89], v9 offset:36864
  s_mov_b32 s64, 65536
  v_mfma_f32_16x16x32_bf16 v[200:203], v[56:59], a[8:11], 0
  ds_read_b64_tr_b16 v[90:91], v9 offset:38912
  buffer_load_dwordx4 v7, s[44:47], s64 offen lds
  v_mfma_f32_16x16x32_bf16 v[200:203], v[60:63], a[24:27], v[200:203]
  s_add_u32 m0, s66, 65536
  v_cvt_pk_bf16_f32 v40, v224, v225
  v_mfma_f32_16x16x32_bf16 v[200:203], v[64:67], a[40:43], v[200:203]
  s_mov_b32 s64, 65536
  v_cvt_pk_bf16_f32 v41, v226, v227
  v_mfma_f32_16x16x32_bf16 v[204:207], v[56:59], a[12:15], 0
  buffer_load_dwordx4 v7, s[44:47], s64 offen offset:1024 lds
  v_cvt_pk_bf16_f32 v42, v240, v241
  v_mfma_f32_16x16x32_bf16 v[204:207], v[60:63], a[28:31], v[204:207]
  v_cvt_pk_bf16_f32 v43, v242, v243
  s_mov_b32 s35, 10240
  v_mfma_f32_16x16x32_bf16 v[204:207], v[64:67], a[44:47], v[204:207]
  buffer_store_dwordx4 v[40:43], v24, s[20:23], s35 offen sc1
  s_waitcnt lgkmcnt(6)
  v_mfma_f32_16x16x32_bf16 v[208:211], v[68:71], a[0:3], 0
  ds_read_b64_tr_b16 v[56:57], v12 offset:24576
  s_add_u32 m0, s33, 159744
  v_mfma_f32_16x16x32_bf16 v[208:211], v[72:75], a[16:19], v[208:211]
  ds_read_b64_tr_b16 v[58:59], v12 offset:26624
  s_mov_b32 s34, 1024
  v_mfma_f32_16x16x32_bf16 v[208:211], v[76:79], a[32:35], v[208:211]
  ds_read_b64_tr_b16 v[60:61], v12 offset:28672
  buffer_load_dwordx4 v21, s[12:15], s34 offen lds
  v_mfma_f32_16x16x32_bf16 v[212:215], v[68:71], a[4:7], 0
  ds_read_b64_tr_b16 v[62:63], v12 offset:30720
  s_add_u32 m0, s66, 65536
  v_mfma_f32_16x16x32_bf16 v[212:215], v[72:75], a[20:23], v[212:215]
  ds_read_b64_tr_b16 v[64:65], v12 offset:36864
  s_mov_b32 s64, 65536
  v_mfma_f32_16x16x32_bf16 v[212:215], v[76:79], a[36:39], v[212:215]
  ds_read_b64_tr_b16 v[66:67], v12 offset:38912
  buffer_load_dwordx4 v7, s[44:47], s64 offen offset:2048 lds
  v_mfma_f32_16x16x32_bf16 v[216:219], v[68:71], a[8:11], 0
  s_add_u32 m0, s66, 65536
  v_cvt_pk_bf16_f32 v44, v228, v229
  v_mfma_f32_16x16x32_bf16 v[216:219], v[72:75], a[24:27], v[216:219]
  s_mov_b32 s64, 65536
  v_cvt_pk_bf16_f32 v45, v230, v231
  v_mfma_f32_16x16x32_bf16 v[216:219], v[76:79], a[40:43], v[216:219]
  buffer_load_dwordx4 v7, s[44:47], s64 offen offset:3072 lds
  v_cvt_pk_bf16_f32 v46, v244, v245
  v_mfma_f32_16x16x32_bf16 v[220:223], v[68:71], a[12:15], 0
  v_cvt_pk_bf16_f32 v47, v246, v247
  s_mov_b32 s35, 28672
  v_mfma_f32_16x16x32_bf16 v[220:223], v[72:75], a[28:31], v[220:223]
  buffer_store_dwordx4 v[44:47], v24, s[20:23], s35 offen sc1
  v_cvt_pk_bf16_f32 v48, v232, v233
  v_mfma_f32_16x16x32_bf16 v[220:223], v[76:79], a[44:47], v[220:223]
  v_cvt_pk_bf16_f32 v49, v234, v235
  s_waitcnt lgkmcnt(6)
  v_mfma_f32_16x16x32_bf16 v[192:195], v[80:83], a[48:51], v[192:195]
  ds_read_b64_tr_b16 v[68:69], v10 offset:4096
  v_cvt_pk_bf16_f32 v50, v248, v249
  v_mfma_f32_16x16x32_bf16 v[192:195], v[84:87], a[64:67], v[192:195]
  ds_read_b64_tr_b16 v[70:71], v10 offset:6144
  v_cvt_pk_bf16_f32 v51, v250, v251
  v_mfma_f32_16x16x32_bf16 v[192:195], v[88:91], a[80:83], v[192:195]
  ds_read_b64_tr_b16 v[72:73], v10 offset:8192
  s_mov_b32 s35, 47104
  v_mfma_f32_16x16x32_bf16 v[196:199], v[80:83], a[52:55], v[196:199]
  ds_read_b64_tr_b16 v[74:75], v10 offset:10240
  buffer_store_dwordx4 v[48:51], v24, s[20:23], s35 offen sc1
  v_mfma_f32_16x16x32_bf16 v[196:199], v[84:87], a[68:71], v[196:199]
  ds_read_b64_tr_b16 v[76:77], v9 offset:32768
  v_cvt_pk_bf16_f32 v52, v236, v237
  v_mfma_f32_16x16x32_bf16 v[196:199], v[88:91], a[84:87], v[196:199]
  ds_read_b64_tr_b16 v[78:79], v9 offset:34816
  v_cvt_pk_bf16_f32 v53, v238, v239
  v_mfma_f32_16x16x32_bf16 v[200:203], v[80:83], a[56:59], v[200:203]
  v_cvt_pk_bf16_f32 v54, v252, v253
  v_cvt_pk_bf16_f32 v55, v254, v255
  v_mfma_f32_16x16x32_bf16 v[200:203], v[84:87], a[72:75], v[200:203]
  s_mov_b32 s35, 65536
  buffer_store_dwordx4 v[52:55], v24, s[20:23], s35 offen sc1
  v_mfma_f32_16x16x32_bf16 v[200:203], v[88:91], a[88:91], v[200:203]
  s_waitcnt vmcnt(20)
  v_mfma_f32_16x16x32_bf16 v[96:99], v[184:187], a[160:163], v[96:99]
  v_mfma_f32_16x16x32_bf16 v[204:207], v[80:83], a[60:63], v[204:207]
  s_waitcnt vmcnt(19)
  v_mfma_f32_16x16x32_bf16 v[96:99], v[184:187], a[164:167], v[96:99]
  v_mfma_f32_16x16x32_bf16 v[204:207], v[84:87], a[76:79], v[204:207]
  s_waitcnt vmcnt(16)
  v_mfma_f32_16x16x32_bf16 v[96:99], v[184:187], a[168:171], v[96:99]
  v_mfma_f32_16x16x32_bf16 v[204:207], v[88:91], a[92:95], v[204:207]
  s_waitcnt vmcnt(15)
  v_mfma_f32_16x16x32_bf16 v[96:99], v[184:187], a[172:175], v[96:99]
  s_waitcnt lgkmcnt(6)
  v_mfma_f32_16x16x32_bf16 v[208:211], v[56:59], a[48:51], v[208:211]
  s_barrier
  s_mov_b32 s63, 16384
  v_mov_b32 v179, 1
  buffer_store_dword v179, v29, s[96:99], s63 offen sc1
  v_mfma_f32_16x16x32_bf16 v[208:211], v[60:63], a[64:67], v[208:211]
  ds_read_b64_tr_b16 v[80:81], v13 offset:4096
  s_add_u32 m0, s33, 126976
  s_waitcnt vmcnt(12)
  v_cmp_eq_u32 vcc, 0, v31
  s_cbranch_vccnz L_sp_17
L_bk_18:
  v_mfma_f32_16x16x32_bf16 v[208:211], v[64:67], a[80:83], v[208:211]
  ds_read_b64_tr_b16 v[82:83], v13 offset:6144
  s_mov_b32 s34, 37888
  v_mfma_f32_16x16x32_bf16 v[212:215], v[56:59], a[52:55], v[212:215]
  ds_read_b64_tr_b16 v[84:85], v13 offset:8192
  buffer_load_dwordx4 v21, s[12:15], s34 offen lds
  v_mfma_f32_16x16x32_bf16 v[212:215], v[60:63], a[68:71], v[212:215]
  ds_read_b64_tr_b16 v[86:87], v13 offset:10240
  s_add_u32 m0, s33, 131072
  v_mfma_f32_16x16x32_bf16 v[212:215], v[64:67], a[84:87], v[212:215]
  ds_read_b64_tr_b16 v[88:89], v12 offset:32768
  s_mov_b32 s34, 74752
  v_mfma_f32_16x16x32_bf16 v[216:219], v[56:59], a[56:59], v[216:219]
  ds_read_b64_tr_b16 v[90:91], v12 offset:34816
  buffer_load_dwordx4 v21, s[12:15], s34 offen lds
  v_mfma_f32_16x16x32_bf16 v[216:219], v[60:63], a[72:75], v[216:219]
  s_add_u32 m0, s66, 81920
  v_mfma_f32_16x16x32_bf16 v[216:219], v[64:67], a[88:91], v[216:219]
  s_mov_b32 s64, 81920
  v_mfma_f32_16x16x32_bf16 v[220:223], v[56:59], a[60:63], v[220:223]
  buffer_load_dwordx4 v7, s[44:47], s64 offen lds
  v_mfma_f32_16x16x32_bf16 v[220:223], v[60:63], a[76:79], v[220:223]
  v_mfma_f32_16x16x32_bf16 v[220:223], v[64:67], a[92:95], v[220:223]
  s_waitcnt lgkmcnt(6)
  v_mfma_f32_16x16x32_bf16 v[192:195], v[68:71], a[96:99], v[192:195]
  ds_read_b64_tr_b16 v[56:57], v10 offset:12288
  s_add_u32 m0, s33, 102400
  v_mfma_f32_16x16x32_bf16 v[192:195], v[72:75], a[112:115], v[192:195]
  ds_read_b64_tr_b16 v[58:59], v10 offset:14336
  s_mov_b32 s34, 111616
  v_mfma_f32_16x16x32_bf16 v[192:195], v[76:79], a[128:131], v[192:195]
  ds_read_b64_tr_b16 v[60:61], v10 offset:16384
  buffer_load_dwordx4 v21, s[12:15], s34 offen lds
  v_mfma_f32_16x16x32_bf16 v[196:199], v[68:71], a[100:103], v[196:199]
  ds_read_b64_tr_b16 v[62:63], v10 offset:18432
  s_add_u32 m0, s66, 81920
  v_mfma_f32_16x16x32_bf16 v[196:199], v[72:75], a[116:119], v[196:199]
  ds_read_b64_tr_b16 v[64:65], v9 offset:40960
  s_mov_b32 s64, 81920
  v_mfma_f32_16x16x32_bf16 v[196:199], v[76:79], a[132:135], v[196:199]
  ds_read_b64_tr_b16 v[66:67], v9 offset:43008
  buffer_load_dwordx4 v7, s[44:47], s64 offen offset:1024 lds
  v_mfma_f32_16x16x32_bf16 v[200:203], v[68:71], a[104:107], v[200:203]
  s_add_u32 m0, s66, 81920
  v_add_u32 v160, 4096, v160
  v_mfma_f32_16x16x32_bf16 v[200:203], v[72:75], a[120:123], v[200:203]
  s_mov_b32 s64, 81920
  buffer_load_dwordx4 a[176:179], v160, s[28:31], 0 offen sc1
  v_mfma_f32_16x16x32_bf16 v[200:203], v[76:79], a[136:139], v[200:203]
  buffer_load_dwordx4 v7, s[44:47], s64 offen offset:2048 lds
  buffer_load_dwordx4 a[180:183], v160, s[28:31], s60 offen sc1
  v_mfma_f32_16x16x32_bf16 v[204:207], v[68:71], a[108:111], v[204:207]
  buffer_load_dwordx4 a[184:187], v160, s[28:31], s61 offen sc1
  v_mfma_f32_16x16x32_bf16 v[204:207], v[72:75], a[124:127], v[204:207]
  buffer_load_dwordx4 a[188:191], v160, s[28:31], s62 offen sc1
  v_mfma_f32_16x16x32_bf16 v[204:207], v[76:79], a[140:143], v[204:207]
  s_waitcnt lgkmcnt(6)
  v_mfma_f32_16x16x32_bf16 v[208:211], v[80:83], a[96:99], v[208:211]
  ds_read_b64_tr_b16 v[68:69], v13 offset:12288
  v_mfma_f32_16x16x32_bf16 v[208:211], v[84:87], a[112:115], v[208:211]
  ds_read_b64_tr_b16 v[70:71], v13 offset:14336
  s_mov_b32 s63, 14336
  buffer_load_dword v31, v30, s[96:99], s63 offen sc1
  v_mfma_f32_16x16x32_bf16 v[208:211], v[88:91], a[128:131], v[208:211]
  ds_read_b64_tr_b16 v[72:73], v13 offset:16384
  v_mfma_f32_16x16x32_bf16 v[212:215], v[80:83], a[100:103], v[212:215]
  ds_read_b64_tr_b16 v[74:75], v13 offset:18432
  v_mfma_f32_16x16x32_bf16 v[212:215], v[84:87], a[116:119], v[212:215]
  ds_read_b64_tr_b16 v[76:77], v12 offset:40960
  v_mfma_f32_16x16x32_bf16 v[212:215], v[88:91], a[132:135], v[212:215]
  ds_read_b64_tr_b16 v[78:79], v12 offset:43008
  v_mfma_f32_16x16x32_bf16 v[216:219], v[80:83], a[104:107], v[216:219]
  s_add_u32 m0, s66, 81920
  v_mfma_f32_16x16x32_bf16 v[216:219], v[84:87], a[120:123], v[216:219]
  s_mov_b32 s64, 81920
  v_mfma_f32_16x16x32_bf16 v[216:219], v[88:91], a[136:139], v[216:219]
  buffer_load_dwordx4 v7, s[44:47], s64 offen offset:3072 lds
  v_mfma_f32_16x16x32_bf16 v[220:223], v[80:83], a[108:111], v[220:223]
  v_mfma_f32_16x16x32_bf16 v[220:223], v[84:87], a[124:127], v[220:223]
  v_mfma_f32_16x16x32_bf16 v[220:223], v[88:91], a[140:143], v[220:223]
  s_waitcnt lgkmcnt(6)
  v_mfma_f32_16x16x32_bf16 v[224:227], v[56:59], a[0:3], 0
  s_waitcnt vmcnt(22)
  s_barrier
  v_mfma_f32_16x16x32_bf16 v[224:227], v[60:63], a[16:19], v[224:227]
  ds_read_b64_tr_b16 v[80:81], v9 offset:45056
  v_cvt_pk_bf16_f32 v40, v192, v193
  v_mfma_f32_16x16x32_bf16 v[224:227], v[64:67], a[32:35], v[224:227]
  ds_read_b64_tr_b16 v[82:83], v9 offset:47104
  v_cvt_pk_bf16_f32 v41, v194, v195
  v_mfma_f32_16x16x32_bf16 v[228:231], v[56:59], a[4:7], 0
  ds_read_b64_tr_b16 v[84:85], v10 offset:20480
  v_cvt_pk_bf16_f32 v42, v208, v209
  v_mfma_f32_16x16x32_bf16 v[228:231], v[60:63], a[20:23], v[228:231]
  ds_read_b64_tr_b16 v[86:87], v10 offset:22528
  v_cvt_pk_bf16_f32 v43, v210, v211
  v_mfma_f32_16x16x32_bf16 v[228:231], v[64:67], a[36:39], v[228:231]
  ds_read_b64_tr_b16 v[88:89], v10 offset:24576
  s_mov_b32 s35, 12288
  v_mfma_f32_16x16x32_bf16 v[232:235], v[56:59], a[8:11], 0
  ds_read_b64_tr_b16 v[90:91], v10 offset:26624
  buffer_store_dwordx4 v[40:43], v24, s[20:23], s35 offen sc1
  v_mfma_f32_16x16x32_bf16 v[232:235], v[60:63], a[24:27], v[232:235]
  s_add_u32 m0, s33, 135168
  v_cvt_pk_bf16_f32 v44, v196, v197
  v_mfma_f32_16x16x32_bf16 v[232:235], v[64:67], a[40:43], v[232:235]
  s_mov_b32 s34, 148480
  v_cvt_pk_bf16_f32 v45, v198, v199
  v_mfma_f32_16x16x32_bf16 v[236:239], v[56:59], a[12:15], 0
  buffer_load_dwordx4 v21, s[12:15], s34 offen lds
  v_cvt_pk_bf16_f32 v46, v212, v213
  v_mfma_f32_16x16x32_bf16 v[236:239], v[60:63], a[28:31], v[236:239]
  s_add_u32 m0, s33, 139264
  v_cvt_pk_bf16_f32 v47, v214, v215
  v_mfma_f32_16x16x32_bf16 v[236:239], v[64:67], a[44:47], v[236:239]
  s_mov_b32 s34, 185344
  buffer_load_dwordx4 v21, s[12:15], s34 offen lds
  s_waitcnt lgkmcnt(6)
  v_mfma_f32_16x16x32_bf16 v[240:243], v[68:71], a[0:3], 0
  ds_read_b64_tr_b16 v[56:57], v12 offset:45056
  s_mov_b32 s35, 30720
  v_mfma_f32_16x16x32_bf16 v[240:243], v[72:75], a[16:19], v[240:243]
  ds_read_b64_tr_b16 v[58:59], v12 offset:47104
  buffer_store_dwordx4 v[44:47], v24, s[20:23], s35 offen sc1
  v_mfma_f32_16x16x32_bf16 v[240:243], v[76:79], a[32:35], v[240:243]
  ds_read_b64_tr_b16 v[60:61], v13 offset:20480
  v_cvt_pk_bf16_f32 v48, v200, v201
  v_mfma_f32_16x16x32_bf16 v[244:247], v[68:71], a[4:7], 0
  ds_read_b64_tr_b16 v[62:63], v13 offset:22528
  v_cvt_pk_bf16_f32 v49, v202, v203
  v_mfma_f32_16x16x32_bf16 v[244:247], v[72:75], a[20:23], v[244:247]
  ds_read_b64_tr_b16 v[64:65], v13 offset:24576
  v_cvt_pk_bf16_f32 v50, v216, v217
  v_mfma_f32_16x16x32_bf16 v[244:247], v[76:79], a[36:39], v[244:247]
  ds_read_b64_tr_b16 v[66:67], v13 offset:26624
  v_cvt_pk_bf16_f32 v51, v218, v219
  v_mfma_f32_16x16x32_bf16 v[248:251], v[68:71], a[8:11], 0
  s_add_u32 m0, s33, 98304
  s_mov_b32 s35, 49152
  v_mfma_f32_16x16x32_bf16 v[248:251], v[72:75], a[24:27], v[248:251]
  s_mov_b32 s34, 222208
  buffer_store_dwordx4 v[48:51], v24, s[20:23], s35 offen sc1
  v_mfma_f32_16x16x32_bf16 v[248:251], v[76:79], a[40:43], v[248:251]
  buffer_load_dwordx4 v21, s[12:15], s34 offen lds
  v_cvt_pk_bf16_f32 v52, v204, v205
  v_mfma_f32_16x16x32_bf16 v[252:255], v[68:71], a[12:15], 0
  v_cvt_pk_bf16_f32 v53, v206, v207
  v_cvt_pk_bf16_f32 v54, v220, v221
  v_mfma_f32_16x16x32_bf16 v[252:255], v[72:75], a[28:31], v[252:255]
  v_cvt_pk_bf16_f32 v55, v222, v223
  s_mov_b32 s35, 67584
  v_mfma_f32_16x16x32_bf16 v[252:255], v[76:79], a[44:47], v[252:255]
  buffer_store_dwordx4 v[52:55], v24, s[20:23], s35 offen sc1
  s_waitcnt lgkmcnt(6)
  v_mfma_f32_16x16x32_bf16 v[224:227], v[80:83], a[48:51], v[224:227]
  ds_read_b64_tr_b16 v[68:69], v9 offset:49152
  v_mfma_f32_16x16x32_bf16 v[224:227], v[84:87], a[64:67], v[224:227]
  ds_read_b64_tr_b16 v[70:71], v9 offset:51200
  s_waitcnt vmcnt(13)
  v_mfma_f32_16x16x32_bf16 v[100:103], v[180:183], a[176:179], 0
  v_mfma_f32_16x16x32_bf16 v[224:227], v[88:91], a[80:83], v[224:227]
  ds_read_b64_tr_b16 v[72:73], v9 offset:53248
  s_waitcnt vmcnt(11)
  v_mfma_f32_16x16x32_bf16 v[100:103], v[180:183], a[180:183], v[100:103]
  v_mfma_f32_16x16x32_bf16 v[228:231], v[80:83], a[52:55], v[228:231]
  ds_read_b64_tr_b16 v[74:75], v9 offset:55296
  s_waitcnt vmcnt(10)
  v_mfma_f32_16x16x32_bf16 v[100:103], v[180:183], a[184:187], v[100:103]
  v_mfma_f32_16x16x32_bf16 v[228:231], v[84:87], a[68:71], v[228:231]
  ds_read_b64_tr_b16 v[76:77], v9 offset:57344
  s_waitcnt vmcnt(9)
  v_mfma_f32_16x16x32_bf16 v[100:103], v[180:183], a[188:191], v[100:103]
  v_mfma_f32_16x16x32_bf16 v[228:231], v[88:91], a[84:87], v[228:231]
  ds_read_b64_tr_b16 v[78:79], v9 offset:59392
  v_mfma_f32_16x16x32_bf16 v[232:235], v[80:83], a[56:59], v[232:235]
  v_mfma_f32_16x16x32_bf16 v[232:235], v[84:87], a[72:75], v[232:235]
  v_mfma_f32_16x16x32_bf16 v[232:235], v[88:91], a[88:91], v[232:235]
  v_mfma_f32_16x16x32_bf16 v[236:239], v[80:83], a[60:63], v[236:239]
  v_mfma_f32_16x16x32_bf16 v[236:239], v[84:87], a[76:79], v[236:239]
  v_mfma_f32_16x16x32_bf16 v[236:239], v[88:91], a[92:95], v[236:239]
  s_waitcnt lgkmcnt(6)
  v_mfma_f32_16x16x32_bf16 v[240:243], v[56:59], a[48:51], v[240:243]
  s_barrier
  s_mov_b32 s63, 18432
  v_mov_b32 v179, 1
  buffer_store_dword v179, v29, s[96:99], s63 offen sc1
  v_mfma_f32_16x16x32_bf16 v[240:243], v[60:63], a[64:67], v[240:243]
  ds_read_b64_tr_b16 v[80:81], v12 offset:49152
  s_waitcnt vmcnt(9)
  v_cmp_eq_u32 vcc, 0, v31
  s_cbranch_vccnz L_sp_20
L_bk_21:
  v_mfma_f32_16x16x32_bf16 v[240:243], v[64:67], a[80:83], v[240:243]
  ds_read_b64_tr_b16 v[82:83], v12 offset:51200
  v_mfma_f32_16x16x32_bf16 v[244:247], v[56:59], a[52:55], v[244:247]
  ds_read_b64_tr_b16 v[84:85], v12 offset:53248
  v_mfma_f32_16x16x32_bf16 v[244:247], v[60:63], a[68:71], v[244:247]
  ds_read_b64_tr_b16 v[86:87], v12 offset:55296
  v_mfma_f32_16x16x32_bf16 v[244:247], v[64:67], a[84:87], v[244:247]
  ds_read_b64_tr_b16 v[88:89], v12 offset:57344
  v_mfma_f32_16x16x32_bf16 v[248:251], v[56:59], a[56:59], v[248:251]
  ds_read_b64_tr_b16 v[90:91], v12 offset:59392
  v_mfma_f32_16x16x32_bf16 v[248:251], v[60:63], a[72:75], v[248:251]
  s_add_u32 m0, s33, 143360
  v_mfma_f32_16x16x32_bf16 v[248:251], v[64:67], a[88:91], v[248:251]
  s_mov_b32 s34, 259072
  v_mfma_f32_16x16x32_bf16 v[252:255], v[56:59], a[60:63], v[252:255]
  buffer_load_dwordx4 v21, s[12:15], s34 offen lds
  v_mfma_f32_16x16x32_bf16 v[252:255], v[60:63], a[76:79], v[252:255]
  s_add_u32 m0, s33, 147456
  v_mfma_f32_16x16x32_bf16 v[252:255], v[64:67], a[92:95], v[252:255]
  s_mov_b32 s34, 1024
  buffer_load_dwordx4 v22, s[12:15], s34 offen lds
  s_waitcnt lgkmcnt(6)
  v_mfma_f32_16x16x32_bf16 v[224:227], v[68:71], a[96:99], v[224:227]
  ds_read_b64_tr_b16 v[56:57], v10 offset:28672
  v_mfma_f32_16x16x32_bf16 v[224:227], v[72:75], a[112:115], v[224:227]
  ds_read_b64_tr_b16 v[58:59], v10 offset:30720
  buffer_load_dwordx4 a[192:195], v160, s[28:31], 0 offen offset:2048 sc1
  v_mfma_f32_16x16x32_bf16 v[224:227], v[76:79], a[128:131], v[224:227]
  ds_read_b64_tr_b16 v[60:61], v9 offset:61440
  buffer_load_dwordx4 a[196:199], v160, s[28:31], s60 offen offset:2048 sc1
  v_mfma_f32_16x16x32_bf16 v[228:231], v[68:71], a[100:103], v[228:231]
  ds_read_b64_tr_b16 v[62:63], v9 offset:63488
  buffer_load_dwordx4 a[200:203], v160, s[28:31], s61 offen offset:2048 sc1
  v_mfma_f32_16x16x32_bf16 v[228:231], v[72:75], a[116:119], v[228:231]
  ds_read_b64_tr_b16 v[64:65], v10
  buffer_load_dwordx4 a[204:207], v160, s[28:31], s62 offen offset:2048 sc1
  v_mfma_f32_16x16x32_bf16 v[228:231], v[76:79], a[132:135], v[228:231]
  ds_read_b64_tr_b16 v[66:67], v10 offset:2048
  v_mfma_f32_16x16x32_bf16 v[232:235], v[68:71], a[104:107], v[232:235]
  v_mfma_f32_16x16x32_bf16 v[232:235], v[72:75], a[120:123], v[232:235]
  v_mfma_f32_16x16x32_bf16 v[232:235], v[76:79], a[136:139], v[232:235]
  v_mfma_f32_16x16x32_bf16 v[236:239], v[68:71], a[108:111], v[236:239]
  v_mfma_f32_16x16x32_bf16 v[236:239], v[72:75], a[124:127], v[236:239]
  v_mfma_f32_16x16x32_bf16 v[236:239], v[76:79], a[140:143], v[236:239]
  s_waitcnt lgkmcnt(6)
  v_mfma_f32_16x16x32_bf16 v[240:243], v[80:83], a[96:99], v[240:243]
  ds_read_b64_tr_b16 v[68:69], v13 offset:28672
  v_mfma_f32_16x16x32_bf16 v[240:243], v[84:87], a[112:115], v[240:243]
  ds_read_b64_tr_b16 v[70:71], v13 offset:30720
  s_mov_b32 s63, 16384
  buffer_load_dword v31, v30, s[96:99], s63 offen sc1
  v_mfma_f32_16x16x32_bf16 v[240:243], v[88:91], a[128:131], v[240:243]
  ds_read_b64_tr_b16 v[72:73], v12 offset:61440
  v_mfma_f32_16x16x32_bf16 v[244:247], v[80:83], a[100:103], v[244:247]
  ds_read_b64_tr_b16 v[74:75], v12 offset:63488
  v_mfma_f32_16x16x32_bf16 v[244:247], v[84:87], a[116:119], v[244:247]
  ds_read_b64_tr_b16 v[76:77], v13
  v_mfma_f32_16x16x32_bf16 v[244:247], v[88:91], a[132:135], v[244:247]
  ds_read_b64_tr_b16 v[78:79], v13 offset:2048
  v_mfma_f32_16x16x32_bf16 v[248:251], v[80:83], a[104:107], v[248:251]
  v_mfma_f32_16x16x32_bf16 v[248:251], v[84:87], a[120:123], v[248:251]
  v_mfma_f32_16x16x32_bf16 v[248:251], v[88:91], a[136:139], v[248:251]
  v_mfma_f32_16x16x32_bf16 v[252:255], v[80:83], a[108:111], v[252:255]
  v_mfma_f32_16x16x32_bf16 v[252:255], v[84:87], a[124:127], v[252:255]
  v_mfma_f32_16x16x32_bf16 v[252:255], v[88:91], a[140:143], v[252:255]
  s_waitcnt lgkmcnt(6)
  v_mfma_f32_16x16x32_bf16 v[192:195], v[56:59], a[0:3], 0
  s_waitcnt vmcnt(5)
  s_barrier
  s_mov_b32 s63, 20480
  v_mov_b32 v179, 1
  buffer_store_dword v179, v29, s[96:99], s63 offen sc1
  v_mfma_f32_16x16x32_bf16 v[192:195], v[60:63], a[16:19], v[192:195]
  ds_read_b64_tr_b16 v[80:81], v9 offset:36864
  v_cvt_pk_bf16_f32 v40, v224, v225
  v_mfma_f32_16x16x32_bf16 v[192:195], v[64:67], a[32:35], v[192:195]
  ds_read_b64_tr_b16 v[82:83], v9 offset:38912
  v_cvt_pk_bf16_f32 v41, v226, v227
  v_mfma_f32_16x16x32_bf16 v[196:199], v[56:59], a[4:7], 0
  ds_read_b64_tr_b16 v[84:85], v10 offset:4096
  v_cvt_pk_bf16_f32 v42, v240, v241
  v_mfma_f32_16x16x32_bf16 v[196:199], v[60:63], a[20:23], v[196:199]
  ds_read_b64_tr_b16 v[86:87], v10 offset:6144
  v_cvt_pk_bf16_f32 v43, v242, v243
  v_mfma_f32_16x16x32_bf16 v[196:199], v[64:67], a[36:39], v[196:199]
  ds_read_b64_tr_b16 v[88:89], v10 offset:8192
  s_mov_b32 s35, 14336
  v_mfma_f32_16x16x32_bf16 v[200:203], v[56:59], a[8:11], 0
  ds_read_b64_tr_b16 v[90:91], v10 offset:10240
  buffer_store_dwordx4 v[40:43], v24, s[20:23], s35 offen sc1
  v_mfma_f32_16x16x32_bf16 v[200:203], v[60:63], a[24:27], v[200:203]
  v_cvt_pk_bf16_f32 v44, v228, v229
  v_cvt_pk_bf16_f32 v45, v230, v231
  v_mfma_f32_16x16x32_bf16 v[200:203], v[64:67], a[40:43], v[200:203]
  v_cvt_pk_bf16_f32 v46, v244, v245
  v_cvt_pk_bf16_f32 v47, v246, v247
  v_mfma_f32_16x16x32_bf16 v[204:207], v[56:59], a[12:15], 0
  s_mov_b32 s35, 32768
  buffer_store_dwordx4 v[44:47], v24, s[20:23], s35 offen sc1
  v_mfma_f32_16x16x32_bf16 v[204:207], v[60:63], a[28:31], v[204:207]
  v_cvt_pk_bf16_f32 v48, v232, v233
  v_cvt_pk_bf16_f32 v49, v234, v235
  v_mfma_f32_16x16x32_bf16 v[204:207], v[64:67], a[44:47], v[204:207]
  v_cvt_pk_bf16_f32 v50, v248, v249
  s_waitcnt lgkmcnt(6)
  v_mfma_f32_16x16x32_bf16 v[208:211], v[68:71], a[0:3], 0
  ds_read_b64_tr_b16 v[56:57], v12 offset:36864
  v_cvt_pk_bf16_f32 v51, v250, v251
  v_mfma_f32_16x16x32_bf16 v[208:211], v[72:75], a[16:19], v[208:211]
  ds_read_b64_tr_b16 v[58:59], v12 offset:38912
  s_mov_b32 s35, 51200
  v_mfma_f32_16x16x32_bf16 v[208:211], v[76:79], a[32:35], v[208:211]
  ds_read_b64_tr_b16 v[60:61], v13 offset:4096
  buffer_store_dwordx4 v[48:51], v24, s[20:23], s35 offen sc1
  v_mfma_f32_16x16x32_bf16 v[212:215], v[68:71], a[4:7], 0
  ds_read_b64_tr_b16 v[62:63], v13 offset:6144
  v_cvt_pk_bf16_f32 v52, v236, v237
  v_mfma_f32_16x16x32_bf16 v[212:215], v[72:75], a[20:23], v[212:215]
  ds_read_b64_tr_b16 v[64:65], v13 offset:8192
  v_cvt_pk_bf16_f32 v53, v238, v239
  v_mfma_f32_16x16x32_bf16 v[212:215], v[76:79], a[36:39], v[212:215]
  ds_read_b64_tr_b16 v[66:67], v13 offset:10240
  v_cvt_pk_bf16_f32 v54, v252, v253
  v_mfma_f32_16x16x32_bf16 v[216:219], v[68:71], a[8:11], 0
  v_cvt_pk_bf16_f32 v55, v254, v255
  s_mov_b32 s35, 69632
  v_mfma_f32_16x16x32_bf16 v[216:219], v[72:75], a[24:27], v[216:219]
  buffer_store_dwordx4 v[52:55], v24, s[20:23], s35 offen sc1
  v_mfma_f32_16x16x32_bf16 v[216:219], v[76:79], a[40:43], v[216:219]
  v_mfma_f32_16x16x32_bf16 v[220:223], v[68:71], a[12:15], 0
  v_mfma_f32_16x16x32_bf16 v[220:223], v[72:75], a[28:31], v[220:223]
  v_mfma_f32_16x16x32_bf16 v[220:223], v[76:79], a[44:47], v[220:223]
  s_waitcnt lgkmcnt(6)
  v_mfma_f32_16x16x32_bf16 v[192:195], v[80:83], a[48:51], v[192:195]
  ds_read_b64_tr_b16 v[68:69], v9 offset:32768
  v_mfma_f32_16x16x32_bf16 v[192:195], v[84:87], a[64:67], v[192:195]
  ds_read_b64_tr_b16 v[70:71], v9 offset:34816
  s_waitcnt vmcnt(9)
  v_mfma_f32_16x16x32_bf16 v[100:103], v[184:187], a[192:195], v[100:103]
  v_mfma_f32_16x16x32_bf16 v[192:195], v[88:91], a[80:83], v[192:195]
  ds_read_b64_tr_b16 v[72:73], v10 offset:12288
  s_waitcnt vmcnt(8)
  v_mfma_f32_16x16x32_bf16 v[100:103], v[184:187], a[196:199], v[100:103]
  v_mfma_f32_16x16x32_bf16 v[196:199], v[80:83], a[52:55], v[196:199]
  ds_read_b64_tr_b16 v[74:75], v10 offset:14336
  s_waitcnt vmcnt(7)
  v_mfma_f32_16x16x32_bf16 v[100:103], v[184:187], a[200:203], v[100:103]
  v_mfma_f32_16x16x32_bf16 v[196:199], v[84:87], a[68:71], v[196:199]
  ds_read_b64_tr_b16 v[76:77], v10 offset:16384
  s_waitcnt vmcnt(6)
  v_mfma_f32_16x16x32_bf16 v[100:103], v[184:187], a[204:207], v[100:103]
  v_mfma_f32_16x16x32_bf16 v[196:199], v[88:91], a[84:87], v[196:199]
  ds_read_b64_tr_b16 v[78:79], v10 offset:18432
  v_mfma_f32_16x16x32_bf16 v[200:203], v[80:83], a[56:59], v[200:203]
  v_mfma_f32_16x16x32_bf16 v[200:203], v[84:87], a[72:75], v[200:203]
  v_mfma_f32_16x16x32_bf16 v[200:203], v[88:91], a[88:91], v[200:203]
  v_mfma_f32_16x16x32_bf16 v[204:207], v[80:83], a[60:63], v[204:207]
  v_mfma_f32_16x16x32_bf16 v[204:207], v[84:87], a[76:79], v[204:207]
  v_mfma_f32_16x16x32_bf16 v[204:207], v[88:91], a[92:95], v[204:207]
  s_waitcnt lgkmcnt(6)
  v_mfma_f32_16x16x32_bf16 v[208:211], v[56:59], a[48:51], v[208:211]
  s_barrier
  v_mfma_f32_16x16x32_bf16 v[208:211], v[60:63], a[64:67], v[208:211]
  ds_read_b64_tr_b16 v[80:81], v12 offset:32768
  s_waitcnt vmcnt(5)
  v_cmp_eq_u32 vcc, 0, v31
  s_cbranch_vccnz L_sp_23
L_bk_24:
  v_mfma_f32_16x16x32_bf16 v[208:211], v[64:67], a[80:83], v[208:211]
  ds_read_b64_tr_b16 v[82:83], v12 offset:34816
  v_mfma_f32_16x16x32_bf16 v[212:215], v[56:59], a[52:55], v[212:215]
  ds_read_b64_tr_b16 v[84:85], v13 offset:12288
  v_mfma_f32_16x16x32_bf16 v[212:215], v[60:63], a[68:71], v[212:215]
  ds_read_b64_tr_b16 v[86:87], v13 offset:14336
  v_mfma_f32_16x16x32_bf16 v[212:215], v[64:67], a[84:87], v[212:215]
  ds_read_b64_tr_b16 v[88:89], v13 offset:16384
  v_mfma_f32_16x16x32_bf16 v[216:219], v[56:59], a[56:59], v[216:219]
  ds_read_b64_tr_b16 v[90:91], v13 offset:18432
  v_mfma_f32_16x16x32_bf16 v[216:219], v[60:63], a[72:75], v[216:219]
  v_mfma_f32_16x16x32_bf16 v[216:219], v[64:67], a[88:91], v[216:219]
  v_mfma_f32_16x16x32_bf16 v[220:223], v[56:59], a[60:63], v[220:223]
  v_mfma_f32_16x16x32_bf16 v[220:223], v[60:63], a[76:79], v[220:223]
  v_mfma_f32_16x16x32_bf16 v[220:223], v[64:67], a[92:95], v[220:223]
  s_waitcnt lgkmcnt(6)
  v_mfma_f32_16x16x32_bf16 v[192:195], v[68:71], a[96:99], v[192:195]
  v_mfma_f32_16x16x32_bf16 v[192:195], v[72:75], a[112:115], v[192:195]
  v_add_u32 v160, 4096, v160
  v_mfma_f32_16x16x32_bf16 v[192:195], v[76:79], a[128:131], v[192:195]
  buffer_load_dwordx4 a[208:211], v160, s[28:31], 0 offen sc1
  v_mfma_f32_16x16x32_bf16 v[196:199], v[68:71], a[100:103], v[196:199]
  buffer_load_dwordx4 a[212:215], v160, s[28:31], s60 offen sc1
  v_mfma_f32_16x16x32_bf16 v[196:199], v[72:75], a[116:119], v[196:199]
  buffer_load_dwordx4 a[216:219], v160, s[28:31], s61 offen sc1
  v_mfma_f32_16x16x32_bf16 v[196:199], v[76:79], a[132:135], v[196:199]
  buffer_load_dwordx4 a[220:223], v160, s[28:31], s62 offen sc1
  v_mfma_f32_16x16x32_bf16 v[200:203], v[68:71], a[104:107], v[200:203]
  v_mfma_f32_16x16x32_bf16 v[200:203], v[72:75], a[120:123], v[200:203]
  v_mfma_f32_16x16x32_bf16 v[200:203], v[76:79], a[136:139], v[200:203]
  v_mfma_f32_16x16x32_bf16 v[204:207], v[68:71], a[108:111], v[204:207]
  v_mfma_f32_16x16x32_bf16 v[204:207], v[72:75], a[124:127], v[204:207]
  v_mfma_f32_16x16x32_bf16 v[204:207], v[76:79], a[140:143], v[204:207]
  s_waitcnt lgkmcnt(0)
  v_mfma_f32_16x16x32_bf16 v[208:211], v[80:83], a[96:99], v[208:211]
  v_mfma_f32_16x16x32_bf16 v[208:211], v[84:87], a[112:115], v[208:211]
  v_mfma_f32_16x16x32_bf16 v[208:211], v[88:91], a[128:131], v[208:211]
  v_mfma_f32_16x16x32_bf16 v[212:215], v[80:83], a[100:103], v[212:215]
  v_mfma_f32_16x16x32_bf16 v[212:215], v[84:87], a[116:119], v[212:215]
  v_mfma_f32_16x16x32_bf16 v[212:215], v[88:91], a[132:135], v[212:215]
  v_mfma_f32_16x16x32_bf16 v[216:219], v[80:83], a[104:107], v[216:219]
  v_mfma_f32_16x16x32_bf16 v[216:219], v[84:87], a[120:123], v[216:219]
  v_mfma_f32_16x16x32_bf16 v[216:219], v[88:91], a[136:139], v[216:219]
  v_mfma_f32_16x16x32_bf16 v[220:223], v[80:83], a[108:111], v[220:223]
  v_mfma_f32_16x16x32_bf16 v[220:223], v[84:87], a[124:127], v[220:223]
  v_mfma_f32_16x16x32_bf16 v[220:223], v[88:91], a[140:143], v[220:223]
  v_cvt_pk_bf16_f32 v40, v192, v193
  v_cvt_pk_bf16_f32 v41, v194, v195
  v_cvt_pk_bf16_f32 v42, v208, v209
  v_cvt_pk_bf16_f32 v43, v210, v211
  s_mov_b32 s35, 16384
  buffer_store_dwordx4 v[40:43], v24, s[20:23], s35 offen sc1
  v_cvt_pk_bf16_f32 v44, v196, v197
  v_cvt_pk_bf16_f32 v45, v198, v199
  v_cvt_pk_bf16_f32 v46, v212, v213
  v_cvt_pk_bf16_f32 v47, v214, v215
  s_mov_b32 s35, 34816
  buffer_store_dwordx4 v[44:47], v24, s[20:23], s35 offen sc1
  v_cvt_pk_bf16_f32 v48, v200, v201
  v_cvt_pk_bf16_f32 v49, v202, v203
  v_cvt_pk_bf16_f32 v50, v216, v217
  v_cvt_pk_bf16_f32 v51, v218, v219
  s_mov_b32 s35, 53248
  buffer_store_dwordx4 v[48:51], v24, s[20:23], s35 offen sc1
  v_cvt_pk_bf16_f32 v52, v204, v205
  v_cvt_pk_bf16_f32 v53, v206, v207
  v_cvt_pk_bf16_f32 v54, v220, v221
  v_cvt_pk_bf16_f32 v55, v222, v223
  s_mov_b32 s35, 71680
  buffer_store_dwordx4 v[52:55], v24, s[20:23], s35 offen sc1
  s_waitcnt vmcnt(8)
  s_barrier
  s_mov_b32 s63, 22528
  v_mov_b32 v179, 1
  buffer_store_dword v179, v29, s[96:99], s63 offen sc1
  s_mov_b32 s63, 20480
  buffer_load_dword v31, v30, s[96:99], s63 offen sc1
  s_waitcnt vmcnt(0)
  v_cmp_eq_u32 vcc, 0, v31
  s_cbranch_vccnz L_sp_26
L_bk_27:
  buffer_load_dwordx4 a[224:227], v160, s[28:31], 0 offen offset:2048 sc1
  buffer_load_dwordx4 a[228:231], v160, s[28:31], s60 offen offset:2048 sc1
  buffer_load_dwordx4 a[232:235], v160, s[28:31], s61 offen offset:2048 sc1
  buffer_load_dwordx4 a[236:239], v160, s[28:31], s62 offen offset:2048 sc1
  v_add_u32 v160, 4096, v160
  buffer_load_dwordx4 a[240:243], v160, s[28:31], 0 offen sc1
  buffer_load_dwordx4 a[244:247], v160, s[28:31], s60 offen sc1
  buffer_load_dwordx4 a[248:251], v160, s[28:31], s61 offen sc1
  buffer_load_dwordx4 a[252:255], v160, s[28:31], s62 offen sc1
  v_mfma_f32_16x16x32_bf16 v[104:107], v[180:183], a[208:211], 0
  v_mfma_f32_16x16x32_bf16 v[104:107], v[180:183], a[212:215], v[104:107]
  v_mfma_f32_16x16x32_bf16 v[104:107], v[180:183], a[216:219], v[104:107]
  v_mfma_f32_16x16x32_bf16 v[104:107], v[180:183], a[220:223], v[104:107]
  s_barrier
  s_mov_b32 s63, 24576
  v_mov_b32 v179, 1
  buffer_store_dword v179, v29, s[96:99], s63 offen sc1
  s_mov_b32 s63, 24576
  buffer_load_dword v31, v30, s[96:99], s63 offen sc1
  s_waitcnt vmcnt(9)
  v_mfma_f32_16x16x32_bf16 v[104:107], v[184:187], a[224:227], v[104:107]
  s_waitcnt vmcnt(8)
  v_mfma_f32_16x16x32_bf16 v[104:107], v[184:187], a[228:231], v[104:107]
  s_waitcnt vmcnt(7)
  v_mfma_f32_16x16x32_bf16 v[104:107], v[184:187], a[232:235], v[104:107]
  s_waitcnt vmcnt(6)
  v_mfma_f32_16x16x32_bf16 v[104:107], v[184:187], a[236:239], v[104:107]
  s_waitcnt vmcnt(5)
  v_mfma_f32_16x16x32_bf16 v[108:111], v[180:183], a[240:243], 0
  s_waitcnt vmcnt(4)
  v_mfma_f32_16x16x32_bf16 v[108:111], v[180:183], a[244:247], v[108:111]
  s_waitcnt vmcnt(3)
  v_mfma_f32_16x16x32_bf16 v[108:111], v[180:183], a[248:251], v[108:111]
  s_waitcnt vmcnt(2)
  v_mfma_f32_16x16x32_bf16 v[108:111], v[180:183], a[252:255], v[108:111]
  s_waitcnt vmcnt(0)
  v_cmp_eq_u32 vcc, 0, v31
  s_cbranch_vccnz L_sp_29
L_bk_30:
  buffer_load_dwordx4 a[144:147], v160, s[28:31], 0 offen offset:2048 sc1
  buffer_load_dwordx4 a[148:151], v160, s[28:31], s60 offen offset:2048 sc1
  buffer_load_dwordx4 a[152:155], v160, s[28:31], s61 offen offset:2048 sc1
  buffer_load_dwordx4 a[156:159], v160, s[28:31], s62 offen offset:2048 sc1
  v_add_u32 v160, 4096, v160
  buffer_load_dwordx4 a[160:163], v160, s[28:31], 0 offen sc1
  buffer_load_dwordx4 a[164:167], v160, s[28:31], s60 offen sc1
  buffer_load_dwordx4 a[168:171], v160, s[28:31], s61 offen sc1
  buffer_load_dwordx4 a[172:175], v160, s[28:31], s62 offen sc1
  s_add_u32 m0, s66, 98304
  s_mov_b32 s64, 98304
  buffer_load_dwordx4 v7, s[44:47], s64 offen lds
  s_add_u32 m0, s66, 98304
  s_mov_b32 s64, 98304
  buffer_load_dwordx4 v7, s[44:47], s64 offen offset:1024 lds
  s_add_u32 m0, s66, 98304
  s_mov_b32 s64, 98304
  buffer_load_dwordx4 v7, s[44:47], s64 offen offset:2048 lds
  s_add_u32 m0, s66, 98304
  s_mov_b32 s64, 98304
  buffer_load_dwordx4 v7, s[44:47], s64 offen offset:3072 lds
  s_add_u32 m0, s66, 114688
  s_mov_b32 s64, 114688
  buffer_load_dwordx4 v7, s[44:47], s64 offen lds
  s_add_u32 m0, s66, 114688
  s_mov_b32 s64, 114688
  buffer_load_dwordx4 v7, s[44:47], s64 offen offset:1024 lds
  s_add_u32 m0, s66, 114688
  s_mov_b32 s64, 114688
  buffer_load_dwordx4 v7, s[44:47], s64 offen offset:2048 lds
  s_add_u32 m0, s66, 114688
  s_mov_b32 s64, 114688
  buffer_load_dwordx4 v7, s[44:47], s64 offen offset:3072 lds
  s_waitcnt vmcnt(15)
  v_mfma_f32_16x16x32_bf16 v[108:111], v[184:187], a[144:147], v[108:111]
  s_waitcnt vmcnt(14)
  v_mfma_f32_16x16x32_bf16 v[108:111], v[184:187], a[148:151], v[108:111]
  s_waitcnt vmcnt(13)
  v_mfma_f32_16x16x32_bf16 v[108:111], v[184:187], a[152:155], v[108:111]
  s_waitcnt vmcnt(12)
  v_mfma_f32_16x16x32_bf16 v[108:111], v[184:187], a[156:159], v[108:111]
  s_waitcnt vmcnt(11)
  v_mfma_f32_16x16x32_bf16 v[112:115], v[180:183], a[160:163], 0
  s_waitcnt vmcnt(10)
  v_mfma_f32_16x16x32_bf16 v[112:115], v[180:183], a[164:167], v[112:115]
  s_waitcnt vmcnt(9)
  v_mfma_f32_16x16x32_bf16 v[112:115], v[180:183], a[168:171], v[112:115]
  s_waitcnt vmcnt(8)
  v_mfma_f32_16x16x32_bf16 v[112:115], v[180:183], a[172:175], v[112:115]
  s_cmp_lg_u32 s95, 0
  s_cbranch_scc1 L_last
  s_add_u32 s48, s90, 45015040
  s_addc_u32 s49, s91, 0
  s_and_b32 s49, s49, 0xffff
  s_mov_b32 s50, 2359296
  s_mov_b32 s51, 0x20000
  s_add_u32 s52, s90, 52092928
  s_addc_u32 s53, s91, 0
  s_and_b32 s53, s53, 0xffff
  s_mov_b32 s54, 8192
  s_mov_b32 s55, 0x20000
  s_add_u32 s56, s90, 52101120
  s_addc_u32 s57, s91, 0
  s_and_b32 s57, s57, 0xffff
  s_mov_b32 s58, 8192
  s_mov_b32 s59, 0x20000
  v_lshlrev_b32 v190, 16, v170
  v_and_b32 v191, 0xffff0000, v170
  v_fma_f32 v96, v96, v188, v190
  v_fma_f32 v97, v97, v188, v191
  v_lshlrev_b32 v190, 16, v171
  v_and_b32 v191, 0xffff0000, v171
  v_fma_f32 v98, v98, v188, v190
  v_fma_f32 v99, v99, v188, v191
  v_lshlrev_b32 v190, 16, v172
  v_and_b32 v191, 0xffff0000, v172
  v_fma_f32 v100, v100, v188, v190
  v_fma_f32 v101, v101, v188, v191
  v_lshlrev_b32 v190, 16, v173
  v_and_b32 v191, 0xffff0000, v173
  v_fma_f32 v102, v102, v188, v190
  v_fma_f32 v103, v103, v188, v191
  v_lshlrev_b32 v190, 16, v174
  v_and_b32 v191, 0xffff0000, v174
  v_fma_f32 v104, v104, v188, v190
  v_fma_f32 v105, v105, v188, v191
  v_lshlrev_b32 v190, 16, v175
  v_and_b32 v191, 0xffff0000, v175
  v_fma_f32 v106, v106, v188, v190
  v_fma_f32 v107, v107, v188, v191
  v_lshlrev_b32 v190, 16, v176
  v_and_b32 v191, 0xffff0000, v176
  v_fma_f32 v108, v108, v188, v190
  v_fma_f32 v109, v109, v188, v191
  v_lshlrev_b32 v190, 16, v177
  v_and_b32 v191, 0xffff0000, v177
  v_fma_f32 v110, v110, v188, v190
  v_fma_f32 v111, v111, v188, v191
  v_lshlrev_b32 v190, 16, v178
  v_and_b32 v191, 0xffff0000, v178
  v_fma_f32 v112, v112, v188, v190
  v_fma_f32 v113, v113, v188, v191
  v_add_f32 v32, v96, v97
  v_add_f32 v33, v98, v99
  v_add_f32 v32, v32, v100
  v_add_f32 v33, v33, v101
  v_add_f32 v32, v32, v102
  v_add_f32 v33, v33, v103
  v_add_f32 v32, v32, v104
  v_add_f32 v33, v33, v105
  v_add_f32 v32, v32, v106
  v_add_f32 v33, v33, v107
  v_add_f32 v32, v32, v108
  v_add_f32 v33, v33, v109
  v_add_f32 v32, v32, v110
  v_add_f32 v33, v33, v111
  v_add_f32 v32, v32, v112
  v_add_f32 v33, v33, v113
  v_add_f32 v32, v32, v33
  s_nop 1
  v_add_f32_dpp v32, v32, v32 row_ror:8 row_mask:0xf bank_mask:0xf
  v_mov_b32 v33, v32
  s_nop 1
  v_permlane16_swap_b32 v32, v33
  v_add_f32 v32, v32, v33
  v_mov_b32 v33, v32
  s_nop 1
  v_permlane32_swap_b32 v32, v33
  v_add_f32 v32, v32, v33
  ds_write_b32 v167, v32
  s_waitcnt lgkmcnt(0)
  s_barrier
  ds_read_b128 v[36:39], v168
  s_waitcnt lgkmcnt(0)
  v_add_f32 v36, v36, v37
  v_add_f32 v38, v38, v39
  v_add_f32 v32, v36, v38
  v_mul_f32 v32, 0x3ae38e39, v32
  v_sub_f32 v96, v96, v32
  v_sub_f32 v97, v97, v32
  v_sub_f32 v98, v98, v32
  v_sub_f32 v99, v99, v32
  v_sub_f32 v100, v100, v32
  v_sub_f32 v101, v101, v32
  v_sub_f32 v102, v102, v32
  v_sub_f32 v103, v103, v32
  v_sub_f32 v104, v104, v32
  v_sub_f32 v105, v105, v32
  v_sub_f32 v106, v106, v32
  v_sub_f32 v107, v107, v32
  v_sub_f32 v108, v108, v32
  v_sub_f32 v109, v109, v32
  v_sub_f32 v110, v110, v32
  v_sub_f32 v111, v111, v32
  v_sub_f32 v112, v112, v32
  v_sub_f32 v113, v113, v32
  v_cvt_pk_bf16_f32 v40, v96, v97
  v_cvt_pk_bf16_f32 v41, v98, v99
  v_cvt_pk_bf16_f32 v42, v100, v101
  v_cvt_pk_bf16_f32 v43, v102, v103
  v_cvt_pk_bf16_f32 v44, v104, v105
  v_cvt_pk_bf16_f32 v45, v106, v107
  v_cvt_pk_bf16_f32 v46, v108, v109
  v_cvt_pk_bf16_f32 v47, v110, v111
  v_cvt_pk_bf16_f32 v48, v112, v113
  v_permlane32_swap_b32 v40, v42
  v_permlane32_swap_b32 v41, v43
  v_permlane32_swap_b32 v44, v46
  v_permlane32_swap_b32 v45, v47
  v_permlane16_swap_b32 v40, v41
  v_permlane16_swap_b32 v42, v43
  v_permlane16_swap_b32 v44, v45
  v_permlane16_swap_b32 v46, v47
  s_mov_b32 s34, 8192
  s_mov_b32 s35, 16384
  buffer_store_dwordx4 v[40:43], v162, s[48:51], 0 offen sc1
  buffer_store_dwordx4 v[44:47], v162, s[48:51], s34 offen sc1
  buffer_store_dword v48, v161, s[48:51], s35 offen sc1
  v_mul_f32 v34, v96, v96
  v_mul_f32 v35, v97, v97
  v_fmac_f32 v34, v98, v98
  v_fmac_f32 v35, v99, v99
  v_fmac_f32 v34, v100, v100
  v_fmac_f32 v35, v101, v101
  v_fmac_f32 v34, v102, v102
  v_fmac_f32 v35, v103, v103
  v_fmac_f32 v34, v104, v104
  v_fmac_f32 v35, v105, v105
  v_fmac_f32 v34, v106, v106
  v_fmac_f32 v35, v107, v107
  v_fmac_f32 v34, v108, v108
  v_fmac_f32 v35, v109, v109
  v_fmac_f32 v34, v110, v110
  v_fmac_f32 v35, v111, v111
  v_fmac_f32 v34, v112, v112
  v_fmac_f32 v35, v113, v113
  v_add_f32 v34, v34, v35
  s_nop 1
  v_add_f32_dpp v34, v34, v34 row_ror:8 row_mask:0xf bank_mask:0xf
  v_mov_b32 v33, v34
  s_nop 1
  v_permlane16_swap_b32 v34, v33
  v_add_f32 v34, v34, v33
  v_mov_b32 v33, v34
  s_nop 1
  v_permlane32_swap_b32 v34, v33
  v_add_f32 v34, v34, v33
  ds_write_b32 v167, v34 offset:128
  s_waitcnt lgkmcnt(0)
  s_barrier
  ds_read_b128 v[36:39], v168 offset:128
  s_waitcnt lgkmcnt(0)
  v_add_f32 v36, v36, v37
  v_add_f32 v38, v38, v39
  v_add_f32 v34, v36, v38
  v_mov_b32 v33, 0x3727c5ac
  v_fmac_f32 v33, 0x3ae38e39, v34
  v_rsq_f32 v33, v33
  v_add_f32 v32, v32, v189
  v_cmp_gt_u32 vcc, 8, v0
  s_nop 1
  v_cndmask_b32 v35, v169, v165, vcc
  buffer_store_dword v33, v35, s[52:55], 0 offen sc1
  buffer_store_dword v32, v35, s[56:59], 0 offen sc1
  s_waitcnt vmcnt(0)
  s_barrier
  s_mov_b32 s36, 45015040
  v_mov_b32 v1, 1
  buffer_store_dword v1, v29, s[96:99], s36 offen sc1
  s_mov_b32 s95, 1
  s_add_u32 s90, s90, 45015040
  s_addc_u32 s91, s91, 0
  s_add_u32 s96, s90, 7233536
  s_addc_u32 s97, s91, 0
  s_and_b32 s97, s97, 0xffff
  s_mov_b32 s98, 45047808
  s_mov_b32 s99, 0x20000
  s_branch L_layer
L_last:
  s_mov_b32 s48, s88
  s_and_b32 s49, s89, 0xffff
  s_mov_b32 s50, 2359296
  s_mov_b32 s51, 0x20000
  v_lshlrev_b32 v190, 16, v170
  v_and_b32 v191, 0xffff0000, v170
  v_fma_f32 v96, v96, v188, v190
  v_fma_f32 v97, v97, v188, v191
  v_lshlrev_b32 v190, 16, v171
  v_and_b32 v191, 0xffff0000, v171
  v_fma_f32 v98, v98, v188, v190
  v_fma_f32 v99, v99, v188, v191
  v_lshlrev_b32 v190, 16, v172
  v_and_b32 v191, 0xffff0000, v172
  v_fma_f32 v100, v100, v188, v190
  v_fma_f32 v101, v101, v188, v191
  v_lshlrev_b32 v190, 16, v173
  v_and_b32 v191, 0xffff0000, v173
  v_fma_f32 v102, v102, v188, v190
  v_fma_f32 v103, v103, v188, v191
  v_lshlrev_b32 v190, 16, v174
  v_and_b32 v191, 0xffff0000, v174
  v_fma_f32 v104, v104, v188, v190
  v_fma_f32 v105, v105, v188, v191
  v_lshlrev_b32 v190, 16, v175
  v_and_b32 v191, 0xffff0000, v175
  v_fma_f32 v106, v106, v188, v190
  v_fma_f32 v107, v107, v188, v191
  v_lshlrev_b32 v190, 16, v176
  v_and_b32 v191, 0xffff0000, v176
  v_fma_f32 v108, v108, v188, v190
  v_fma_f32 v109, v109, v188, v191
  v_lshlrev_b32 v190, 16, v177
  v_and_b32 v191, 0xffff0000, v177
  v_fma_f32 v110, v110, v188, v190
  v_fma_f32 v111, v111, v188, v191
  v_lshlrev_b32 v190, 16, v178
  v_and_b32 v191, 0xffff0000, v178
  v_fma_f32 v112, v112, v188, v190
  v_fma_f32 v113, v113, v188, v191
  v_add_f32 v96, v96, v189
  v_add_f32 v97, v97, v189
  v_add_f32 v98, v98, v189
  v_add_f32 v99, v99, v189
  v_add_f32 v100, v100, v189
  v_add_f32 v101, v101, v189
  v_add_f32 v102, v102, v189
  v_add_f32 v103, v103, v189
  v_add_f32 v104, v104, v189
  v_add_f32 v105, v105, v189
  v_add_f32 v106, v106, v189
  v_add_f32 v107, v107, v189
  v_add_f32 v108, v108, v189
  v_add_f32 v109, v109, v189
  v_add_f32 v110, v110, v189
  v_add_f32 v111, v111, v189
  v_add_f32 v112, v112, v189
  v_add_f32 v113, v113, v189
  v_cvt_pk_bf16_f32 v40, v96, v97
  v_cvt_pk_bf16_f32 v41, v98, v99
  v_cvt_pk_bf16_f32 v42, v100, v101
  v_cvt_pk_bf16_f32 v43, v102, v103
  v_cvt_pk_bf16_f32 v44, v104, v105
  v_cvt_pk_bf16_f32 v45, v106, v107
  v_cvt_pk_bf16_f32 v46, v108, v109
  v_cvt_pk_bf16_f32 v47, v110, v111
  v_cvt_pk_bf16_f32 v48, v112, v113
  v_permlane32_swap_b32 v40, v42
  v_permlane32_swap_b32 v41, v43
  v_permlane32_swap_b32 v44, v46
  v_permlane32_swap_b32 v45, v47
  v_permlane16_swap_b32 v40, v41
  v_permlane16_swap_b32 v42, v43
  v_permlane16_swap_b32 v44, v45
  v_permlane16_swap_b32 v46, v47
  buffer_store_dwordx2 v[40:41], v163, s[48:51], 0 offen
  buffer_store_dwordx2 v[42:43], v163, s[48:51], 0 offen offset:32
  buffer_store_dwordx2 v[44:45], v163, s[48:51], 0 offen offset:512
  buffer_store_dwordx2 v[46:47], v163, s[48:51], 0 offen offset:544
  buffer_store_dword v48, v164, s[48:51], 0 offen offset:1024
L_main_end:
  s_endpgm
L_sp_2:
  s_mov_b32 s100, 0
  s_mov_b32 s36, 0
L_sp_2_l:
  buffer_load_dword v31, v25, s[96:99], s36 offen sc1
  s_add_u32 s100, s100, 1
  s_cmp_gt_u32 s100, 1048576
  s_cbranch_scc1 L_bk_3
  s_waitcnt vmcnt(0)
  v_cmp_eq_u32 vcc, 0, v31
  s_cbranch_vccnz L_sp_2_l
  s_branch L_bk_3
L_sp_5:
  s_mov_b32 s100, 0
  s_mov_b32 s36, 2048
L_sp_5_l:
  buffer_load_dword v31, v30, s[96:99], s36 offen sc1
  s_add_u32 s100, s100, 1
  s_cmp_gt_u32 s100, 1048576
  s_cbranch_scc1 L_bk_6
  s_waitcnt vmcnt(0)
  v_cmp_eq_u32 vcc, 0, v31
  s_cbranch_vccnz L_sp_5_l
  s_branch L_bk_6
L_sp_8:
  s_mov_b32 s100, 0
  s_mov_b32 s36, 4096
L_sp_8_l:
  buffer_load_dword v31, v30, s[96:99], s36 offen sc1
  s_add_u32 s100, s100, 1
  s_cmp_gt_u32 s100, 1048576
  s_cbranch_scc1 L_bk_9
  s_waitcnt vmcnt(0)
  v_cmp_eq_u32 vcc, 0, v31
  s_cbranch_vccnz L_sp_8_l
  s_branch L_bk_9
L_sp_11:
  s_mov_b32 s100, 0
  s_mov_b32 s63, 8192
L_sp_11_l:
  buffer_load_dword v31, v30, s[96:99], s63 offen sc1
  s_add_u32 s100, s100, 1
  s_cmp_gt_u32 s100, 1048576
  s_cbranch_scc1 L_bk_12
  s_waitcnt vmcnt(0)
  v_cmp_eq_u32 vcc, 0, v31
  s_cbranch_vccnz L_sp_11_l
  s_branch L_bk_12
L_sp_14:
  s_mov_b32 s100, 0
  s_mov_b32 s63, 10240
L_sp_14_l:
  buffer_load_dword v31, v30, s[96:99], s63 offen sc1
  s_add_u32 s100, s100, 1
  s_cmp_gt_u32 s100, 1048576
  s_cbranch_scc1 L_bk_15
  s_waitcnt vmcnt(0)
  v_cmp_eq_u32 vcc, 0, v31
  s_cbranch_vccnz L_sp_14_l
  s_branch L_bk_15
L_sp_17:
  s_mov_b32 s100, 0
  s_mov_b32 s63, 12288
L_sp_17_l:
  buffer_load_dword v31, v30, s[96:99], s63 offen sc1
  s_add_u32 s100, s100, 1
  s_cmp_gt_u32 s100, 1048576
  s_cbranch_scc1 L_bk_18
  s_waitcnt vmcnt(0)
  v_cmp_eq_u32 vcc, 0, v31
  s_cbranch_vccnz L_sp_17_l
  s_branch L_bk_18
L_sp_20:
  s_mov_b32 s100, 0
  s_mov_b32 s63, 14336
L_sp_20_l:
  buffer_load_dword v31, v30, s[96:99], s63 offen sc1
  s_add_u32 s100, s100, 1
  s_cmp_gt_u32 s100, 1048576
  s_cbranch_scc1 L_bk_21
  s_waitcnt vmcnt(0)
  v_cmp_eq_u32 vcc, 0, v31
  s_cbranch_vccnz L_sp_20_l
  s_branch L_bk_21
L_sp_23:
  s_mov_b32 s100, 0
  s_mov_b32 s63, 16384
L_sp_23_l:
  buffer_load_dword v31, v30, s[96:99], s63 offen sc1
  s_add_u32 s100, s100, 1
  s_cmp_gt_u32 s100, 1048576
  s_cbranch_scc1 L_bk_24
  s_waitcnt vmcnt(0)
  v_cmp_eq_u32 vcc, 0, v31
  s_cbranch_vccnz L_sp_23_l
  s_branch L_bk_24
L_sp_26:
  s_mov_b32 s100, 0
  s_mov_b32 s63, 20480
L_sp_26_l:
  buffer_load_dword v31, v30, s[96:99], s63 offen sc1
  s_add_u32 s100, s100, 1
  s_cmp_gt_u32 s100, 1048576
  s_cbranch_scc1 L_bk_27
  s_waitcnt vmcnt(0)
  v_cmp_eq_u32 vcc, 0, v31
  s_cbranch_vccnz L_sp_26_l
  s_branch L_bk_27
L_sp_29:
  s_mov_b32 s100, 0
  s_mov_b32 s63, 24576
L_sp_29_l:
  buffer_load_dword v31, v30, s[96:99], s63 offen sc1
  s_add_u32 s100, s100, 1
  s_cmp_gt_u32 s100, 1048576
  s_cbranch_scc1 L_bk_30
  s_waitcnt vmcnt(0)
  v_cmp_eq_u32 vcc, 0, v31
  s_cbranch_vccnz L_sp_29_l
  s_branch L_bk_30
.section .rodata,"a"
.p2align 6
.amdhsa_kernel interleave_layers__sliding_local_dilated__glu_gated_bilinear__prompt_kernel
  .amdhsa_next_free_vgpr 128
  .amdhsa_next_free_sgpr 102
  .amdhsa_accum_offset 128
  .amdhsa_group_segment_fixed_size 0
  .amdhsa_kernarg_size 80
  .amdhsa_user_sgpr_count 2
  .amdhsa_user_sgpr_kernarg_segment_ptr 1
  .amdhsa_system_sgpr_workgroup_id_x 1
  .amdhsa_float_denorm_mode_32 3
.end_amdhsa_kernel
.p2align 6
.amdhsa_kernel main_kernel
  .amdhsa_next_free_vgpr 512
  .amdhsa_next_free_sgpr 102
  .amdhsa_accum_offset 256
  .amdhsa_group_segment_fixed_size 0
  .amdhsa_kernarg_size 80
  .amdhsa_user_sgpr_count 2
  .amdhsa_user_sgpr_kernarg_segment_ptr 1
  .amdhsa_system_sgpr_workgroup_id_x 1
  .amdhsa_float_denorm_mode_32 3
.end_amdhsa_kernel
```

```asm
; @launch kernel=interleave_layers__sliding_local_dilated__glu_gated_bilinear__prompt_kernel grid=(256,1,1) block=(256,1,1) lds=9216
; @launch kernel=main_kernel grid=(256,1,1) block=(256,1,1) lds=163840
.amdgcn_target "amdgcn-amd-amdhsa--gfx950"
.text
.globl interleave_layers__sliding_local_dilated__glu_gated_bilinear__prompt_kernel
.p2align 8
.type interleave_layers__sliding_local_dilated__glu_gated_bilinear__prompt_kernel,@function
interleave_layers__sliding_local_dilated__glu_gated_bilinear__prompt_kernel:
  s_cmp_ge_u32 s2, 256
  s_cbranch_scc1 L_prep_end
  s_load_dwordx4 s[44:47], s[0:1], 0
  s_load_dwordx2 s[48:49], s[0:1], 16
  s_load_dwordx2 s[50:51], s[0:1], 72
  s_load_dwordx4 s[76:79], s[0:1], 32
  v_lshrrev_b32 v12, 6, v0
  v_and_b32 v1, 63, v0
  v_readfirstlane_b32 s32, v12
  v_lshrrev_b32 v2, 3, v1
  v_and_b32 v3, 7, v1
  v_mov_b32 v11, 0x7ffffff0
  s_and_b32 s36, s2, 7
  s_lshl_b32 s36, s36, 5
  s_lshr_b32 s37, s2, 3
  s_add_u32 s33, s36, s37
  s_lshr_b32 s36, s33, 1
  s_mul_i32 s36, s36, 18432
  s_and_b32 s37, s33, 1
  s_lshl_b32 s37, s37, 7
  s_add_u32 s36, s36, s37
  v_lshlrev_b32 v12, 8, v2
  v_lshl_add_u32 v12, v3, 4, v12
  s_lshl_b32 s37, s32, 12
  s_add_u32 s37, s37, s36
  v_add_u32 v4, s37, v12
  s_lshl_b32 s37, s32, 2
  s_add_u32 s37, s37, s36
  s_add_u32 s37, s37, 16384
  v_add_u32 v5, s37, v12
  s_lshl_b32 s36, s33, 3
  v_add_u32 v13, s36, v3
  v_lshlrev_b32 v8, 2, v13
  v_mul_u32_u24 v13, 1152, v13
  v_lshrrev_b32 v12, 2, v2
  v_lshl_add_u32 v13, v12, 6, v13
  v_and_b32 v12, 3, v2
  v_lshl_add_u32 v13, v12, 3, v13
  s_lshl_b32 s37, s32, 8
  v_add_u32 v6, s37, v13
  s_lshr_b32 s37, s32, 1
  s_lshl_b32 s37, s37, 5
  s_and_b32 s38, s32, 1
  s_lshl_b32 s38, s38, 2
  s_add_u32 s37, s37, s38
  s_add_u32 s37, s37, 1024
  v_add_u32 v7, s37, v13
  v_lshlrev_b32 v10, 4, v3
  s_lshl_b32 s37, s32, 2
  v_add_u32 v9, s37, v10
  s_waitcnt lgkmcnt(0)
  s_mov_b32 s4, s44
  s_and_b32 s5, s45, 0xffff
  s_mov_b32 s6, 2359296
  s_mov_b32 s7, 0x20000
  s_mov_b32 s8, s46
  s_and_b32 s9, s47, 0xffff
  s_mov_b32 s10, 1990656
  s_mov_b32 s11, 0x20000
  s_mov_b32 s12, s48
  s_and_b32 s13, s49, 0xffff
  s_mov_b32 s14, 663552
  s_mov_b32 s15, 0x20000
  buffer_load_dwordx2 v[24:25], v6, s[4:7], 0 offen
  buffer_load_dwordx2 v[26:27], v6, s[4:7], 0 offen offset:32
  buffer_load_dwordx2 v[28:29], v6, s[4:7], 0 offen offset:128
  buffer_load_dwordx2 v[30:31], v6, s[4:7], 0 offen offset:160
  buffer_load_dword v32, v7, s[4:7], 0 offen
  s_add_u32 s16, s50, 3796992
  s_addc_u32 s17, s51, 0
  s_and_b32 s17, s17, 0xffff
  s_mov_b32 s18, 2359296
  s_mov_b32 s19, 0x20000
  s_add_u32 s20, s50, 10874880
  s_addc_u32 s21, s51, 0
  s_and_b32 s21, s21, 0xffff
  s_mov_b32 s22, 32768
  s_mov_b32 s23, 0x20000
  s_add_u32 s28, s50, 0
  s_addc_u32 s29, s51, 0
  s_and_b32 s29, s29, 0xffff
  s_mov_b32 s30, 2064384
  s_mov_b32 s31, 0x20000
  s_add_u32 s40, s50, 2064384
  s_addc_u32 s41, s51, 0
  s_and_b32 s41, s41, 0xffff
  s_mov_b32 s42, 681984
  s_mov_b32 s43, 0x20000
  s_lshl_b32 s52, s2, 2
  s_add_u32 s52, s52, s32
  v_and_b32 v34, 15, v1
  v_lshrrev_b32 v35, 4, v1
  s_mov_b32 s57, 6912
  s_mov_b32 s58, 55296
  s_mov_b32 s59, 62208
  s_lshl_b32 s53, s52, 1
  s_add_u32 s53, s53, 0
  s_mul_hi_u32 s36, s53, 613566757
  s_mul_i32 s37, s36, 7
  s_sub_u32 s54, s53, s37
  s_mul_hi_u32 s56, s36, 238609295
  s_mul_i32 s37, s56, 18
  s_sub_u32 s55, s36, s37
  s_lshl_b32 s37, s54, 4
  v_add_u32 v36, s37, v34
  v_cmp_le_u32 vcc, 40, v36
  s_nop 1
  v_cndmask_b32 v37, 0, 1, vcc
  v_mul_u32_u24 v38, 40, v37
  v_sub_u32 v39, v36, v38
  v_mul_u32_u24 v37, 18, v37
  v_add_u32 v37, v37, v39
  v_cmp_le_u32 vcc, 18, v39
  s_nop 1
  v_cndmask_b32 v38, 0, 1, vcc
  v_mul_u32_u24 v38, 558, v38
  v_add_u32 v37, v37, v38
  v_add_u32 v37, 576, v37
  v_subrev_u32 v38, 76, v36
  v_cmp_le_u32 vcc, 76, v36
  s_nop 1
  v_cndmask_b32 v37, v37, v38, vcc
  s_mul_i32 s37, s56, 36
  v_add_u32 v37, s37, v37
  s_lshl_b32 s37, s55, 5
  v_lshl_add_u32 v38, v35, 2, s37
  v_mul_u32_u24 v38, 3456, v38
  v_lshl_add_u32 v52, v37, 1, v38
  v_subrev_u32 v38, 36, v36
  v_cmp_gt_u32 vcc, 4, v38
  s_nop 1
  v_cndmask_b32 v52, v52, v11, vcc
  s_lshl_b32 s37, s53, 10
  v_lshl_add_u32 v56, v1, 4, s37
  s_cmp_lt_u32 s53, 2016
  s_cselect_b32 s37, 0, 0x7ffffff0
  v_or_b32 v52, s37, v52
  buffer_load_ushort v40, v52, s[8:11], 0 offen
  buffer_load_ushort v84, v52, s[8:11], 0 offen offset:3456
  buffer_load_ushort v41, v52, s[8:11], s57 offen
  buffer_load_ushort v85, v52, s[8:11], s57 offen offset:3456
  buffer_load_ushort v42, v52, s[8:11], s58 offen
  buffer_load_ushort v86, v52, s[8:11], s58 offen offset:3456
  buffer_load_ushort v43, v52, s[8:11], s59 offen
  buffer_load_ushort v87, v52, s[8:11], s59 offen offset:3456
  s_lshl_b32 s53, s52, 1
  s_add_u32 s53, s53, 1
  s_mul_hi_u32 s36, s53, 613566757
  s_mul_i32 s37, s36, 7
  s_sub_u32 s54, s53, s37
  s_mul_hi_u32 s56, s36, 238609295
  s_mul_i32 s37, s56, 18
  s_sub_u32 s55, s36, s37
  s_lshl_b32 s37, s54, 4
  v_add_u32 v36, s37, v34
  v_cmp_le_u32 vcc, 40, v36
  s_nop 1
  v_cndmask_b32 v37, 0, 1, vcc
  v_mul_u32_u24 v38, 40, v37
  v_sub_u32 v39, v36, v38
  v_mul_u32_u24 v37, 18, v37
  v_add_u32 v37, v37, v39
  v_cmp_le_u32 vcc, 18, v39
  s_nop 1
  v_cndmask_b32 v38, 0, 1, vcc
  v_mul_u32_u24 v38, 558, v38
  v_add_u32 v37, v37, v38
  v_add_u32 v37, 576, v37
  v_subrev_u32 v38, 76, v36
  v_cmp_le_u32 vcc, 76, v36
  s_nop 1
  v_cndmask_b32 v37, v37, v38, vcc
  s_mul_i32 s37, s56, 36
  v_add_u32 v37, s37, v37
  s_lshl_b32 s37, s55, 5
  v_lshl_add_u32 v38, v35, 2, s37
  v_mul_u32_u24 v38, 3456, v38
  v_lshl_add_u32 v53, v37, 1, v38
  v_subrev_u32 v38, 36, v36
  v_cmp_gt_u32 vcc, 4, v38
  s_nop 1
  v_cndmask_b32 v53, v53, v11, vcc
  s_lshl_b32 s37, s53, 10
  v_lshl_add_u32 v57, v1, 4, s37
  s_cmp_lt_u32 s53, 2016
  s_cselect_b32 s37, 0, 0x7ffffff0
  v_or_b32 v53, s37, v53
  buffer_load_ushort v44, v53, s[8:11], 0 offen
  buffer_load_ushort v88, v53, s[8:11], 0 offen offset:3456
  buffer_load_ushort v45, v53, s[8:11], s57 offen
  buffer_load_ushort v89, v53, s[8:11], s57 offen offset:3456
  buffer_load_ushort v46, v53, s[8:11], s58 offen
  buffer_load_ushort v90, v53, s[8:11], s58 offen offset:3456
  buffer_load_ushort v47, v53, s[8:11], s59 offen
  buffer_load_ushort v91, v53, s[8:11], s59 offen offset:3456
  s_mul_hi_u32 s54, s52, 238609295
  s_mul_i32 s37, s54, 18
  s_sub_u32 s55, s52, s37
  v_lshrrev_b32 v36, 1, v35
  v_mul_u32_u24 v36, 18, v36
  v_and_b32 v37, 1, v35
  v_lshl_add_u32 v36, v37, 3, v36
  s_mul_i32 s37, s55, 36
  v_add_u32 v36, s37, v36
  v_mul_u32_u24 v37, 72, v35
  s_mul_i32 s37, s55, 288
  s_sub_u32 s37, s37, 4592
  v_add_u32 v37, s37, v37
  s_cmp_lt_u32 s55, 16
  s_cselect_b64 vcc, -1, 0
  v_cndmask_b32 v38, v37, v36, vcc
  s_cselect_b32 s60, 2, 18
  s_mul_i32 s60, s60, 1152
  s_mul_i32 s61, s60, 2
  s_mul_i32 s62, s60, 3
  v_mul_u32_u24 v38, 1152, v38
  s_lshl_b32 s37, s54, 5
  v_lshl_add_u32 v36, v34, 1, s37
  v_add_u32 v54, v38, v36
  s_lshl_b32 s37, s52, 10
  v_lshl_add_u32 v58, v1, 4, s37
  s_cmp_lt_u32 s52, 648
  s_cselect_b32 s37, 0, 0x7ffffff0
  v_or_b32 v54, s37, v54
  v_or_b32 v58, s37, v58
  buffer_load_ushort v48, v54, s[12:15], 0 offen
  buffer_load_ushort v92, v54, s[12:15], 0 offen offset:1152
  buffer_load_ushort v49, v54, s[12:15], s60 offen
  buffer_load_ushort v93, v54, s[12:15], s60 offen offset:1152
  buffer_load_ushort v50, v54, s[12:15], s61 offen
  buffer_load_ushort v94, v54, s[12:15], s61 offen offset:1152
  buffer_load_ushort v51, v54, s[12:15], s62 offen
  buffer_load_ushort v95, v54, s[12:15], s62 offen offset:1152
  s_mov_b32 s64, s76
  s_and_b32 s65, s77, 0xffff
  s_mov_b32 s66, 5308416
  s_mov_b32 s67, 0x20000
  s_mov_b32 s68, s78
  s_and_b32 s69, s79, 0xffff
  s_mov_b32 s70, 5308416
  s_mov_b32 s71, 0x20000
  v_mul_u32_u24 v36, 21846, v0
  v_lshrrev_b32 v36, 16, v36
  v_mul_u32_u24 v37, 3, v36
  v_sub_u32 v37, v0, v37
  s_lshr_b32 s36, s2, 4
  s_mul_i32 s36, s36, 36
  v_add_u32 v36, s36, v36
  v_mul_u32_u24 v36, 9216, v36
  v_lshl_add_u32 v36, v37, 7, v36
  s_and_b32 s36, s2, 15
  s_mul_i32 s36, s36, 576
  s_add_u32 s36, s36, 64
  s_and_b32 s36, s36, 0xffffff80
  v_add_u32 v36, s36, v36
  v_cmp_gt_u32 vcc, 108, v0
  s_nop 1
  v_cndmask_b32 v36, v11, v36, vcc
  buffer_load_dword v60, v36, s[64:67], 0 offen
  buffer_load_dword v61, v36, s[68:71], 0 offen
  s_getpc_b64 s[80:81]
L_pc:
  s_add_u32 s80, s80, main_kernel-L_pc
  s_addc_u32 s81, s81, 0
  s_lshr_b32 s36, s2, 3
  s_lshl_b32 s36, s36, 11
  v_and_b32 v36, 15, v0
  v_lshl_add_u32 v36, v36, 7, s36
  v_min_u32 v36, L_code_end-main_kernel-4, v36
  global_load_dword v62, v36, s[80:81]
  s_add_u32 s72, s50, 11046912
  s_addc_u32 s73, s51, 0
  s_and_b32 s73, s73, 0xffff
  s_mov_b32 s74, 46047232
  s_mov_b32 s75, 0x20000
  s_and_b32 s36, s2, 127
  s_lshl_b32 s36, s36, 12
  s_lshr_b32 s37, s2, 7
  s_mul_i32 s37, s37, 45522944
  s_add_u32 s36, s36, s37
  v_lshl_add_u32 v36, v0, 4, s36
  v_mov_b32 v100, 0
  v_mov_b32 v101, 0
  v_mov_b32 v102, 0
  v_mov_b32 v103, 0
  buffer_store_dwordx4 v[100:103], v36, s[72:75], 0 offen
  s_waitcnt vmcnt(32)
  v_lshlrev_b32 v64, 16, v24
  v_and_b32 v65, 0xffff0000, v24
  v_lshlrev_b32 v66, 16, v25
  v_and_b32 v67, 0xffff0000, v25
  s_waitcnt vmcnt(31)
  v_lshlrev_b32 v68, 16, v26
  v_and_b32 v69, 0xffff0000, v26
  v_lshlrev_b32 v70, 16, v27
  v_and_b32 v71, 0xffff0000, v27
  s_waitcnt vmcnt(30)
  v_lshlrev_b32 v72, 16, v28
  v_and_b32 v73, 0xffff0000, v28
  v_lshlrev_b32 v74, 16, v29
  v_and_b32 v75, 0xffff0000, v29
  s_waitcnt vmcnt(29)
  v_lshlrev_b32 v76, 16, v30
  v_and_b32 v77, 0xffff0000, v30
  v_lshlrev_b32 v78, 16, v31
  v_and_b32 v79, 0xffff0000, v31
  s_waitcnt vmcnt(28)
  v_lshlrev_b32 v80, 16, v32
  v_and_b32 v81, 0xffff0000, v32
  v_add_f32 v14, v64, v65
  v_add_f32 v15, v66, v67
  v_add_f32 v14, v14, v68
  v_add_f32 v15, v15, v69
  v_add_f32 v14, v14, v70
  v_add_f32 v15, v15, v71
  v_add_f32 v14, v14, v72
  v_add_f32 v15, v15, v73
  v_add_f32 v14, v14, v74
  v_add_f32 v15, v15, v75
  v_add_f32 v14, v14, v76
  v_add_f32 v15, v15, v77
  v_add_f32 v14, v14, v78
  v_add_f32 v15, v15, v79
  v_add_f32 v14, v14, v80
  v_add_f32 v15, v15, v81
  v_add_f32 v14, v14, v15
  s_nop 1
  v_add_f32_dpp v14, v14, v14 row_ror:8 row_mask:0xf bank_mask:0xf
  v_mov_b32 v15, v14
  s_nop 1
  v_permlane16_swap_b32 v14, v15
  v_add_f32 v14, v14, v15
  v_mov_b32 v15, v14
  s_nop 1
  v_permlane32_swap_b32 v14, v15
  v_add_f32 v14, v14, v15
  ds_write_b32 v9, v14
  s_waitcnt lgkmcnt(0)
  s_barrier
  ds_read_b128 v[16:19], v10
  s_waitcnt lgkmcnt(0)
  v_add_f32 v16, v16, v17
  v_add_f32 v18, v18, v19
  v_add_f32 v14, v16, v18
  v_mul_f32 v14, 0x3ae38e39, v14
  v_sub_f32 v64, v64, v14
  v_sub_f32 v65, v65, v14
  v_sub_f32 v66, v66, v14
  v_sub_f32 v67, v67, v14
  v_sub_f32 v68, v68, v14
  v_sub_f32 v69, v69, v14
  v_sub_f32 v70, v70, v14
  v_sub_f32 v71, v71, v14
  v_sub_f32 v72, v72, v14
  v_sub_f32 v73, v73, v14
  v_sub_f32 v74, v74, v14
  v_sub_f32 v75, v75, v14
  v_sub_f32 v76, v76, v14
  v_sub_f32 v77, v77, v14
  v_sub_f32 v78, v78, v14
  v_sub_f32 v79, v79, v14
  v_sub_f32 v80, v80, v14
  v_sub_f32 v81, v81, v14
  v_mul_f32 v20, v64, v64
  v_mul_f32 v21, v65, v65
  v_fmac_f32 v20, v66, v66
  v_fmac_f32 v21, v67, v67
  v_fmac_f32 v20, v68, v68
  v_fmac_f32 v21, v69, v69
  v_fmac_f32 v20, v70, v70
  v_fmac_f32 v21, v71, v71
  v_fmac_f32 v20, v72, v72
  v_fmac_f32 v21, v73, v73
  v_fmac_f32 v20, v74, v74
  v_fmac_f32 v21, v75, v75
  v_fmac_f32 v20, v76, v76
  v_fmac_f32 v21, v77, v77
  v_fmac_f32 v20, v78, v78
  v_fmac_f32 v21, v79, v79
  v_fmac_f32 v20, v80, v80
  v_fmac_f32 v21, v81, v81
  v_add_f32 v20, v20, v21
  v_cvt_pk_bf16_f32 v24, v64, v65
  v_cvt_pk_bf16_f32 v25, v66, v67
  v_cvt_pk_bf16_f32 v26, v68, v69
  v_cvt_pk_bf16_f32 v27, v70, v71
  v_cvt_pk_bf16_f32 v28, v72, v73
  v_cvt_pk_bf16_f32 v29, v74, v75
  v_cvt_pk_bf16_f32 v30, v76, v77
  v_cvt_pk_bf16_f32 v31, v78, v79
  v_cvt_pk_bf16_f32 v32, v80, v81
  buffer_store_dwordx4 v[24:27], v4, s[16:19], 0 offen
  buffer_store_dwordx4 v[28:31], v4, s[16:19], 0 offen offset:2048
  buffer_store_dword v32, v5, s[16:19], 0 offen
  v_add_f32_dpp v20, v20, v20 row_ror:8 row_mask:0xf bank_mask:0xf
  v_mov_b32 v15, v20
  s_nop 1
  v_permlane16_swap_b32 v20, v15
  v_add_f32 v20, v20, v15
  v_mov_b32 v15, v20
  s_nop 1
  v_permlane32_swap_b32 v20, v15
  v_add_f32 v20, v20, v15
  ds_write_b32 v9, v20 offset:128
  s_waitcnt lgkmcnt(0)
  s_barrier
  ds_read_b128 v[16:19], v10 offset:128
  s_waitcnt lgkmcnt(0)
  v_add_f32 v16, v16, v17
  v_add_f32 v18, v18, v19
  v_add_f32 v20, v16, v18
  v_mov_b32 v15, 0x3727c5ac
  v_fmac_f32 v15, 0x3ae38e39, v20
  v_rsq_f32 v15, v15
  v_and_b32 v22, 8, v0
  v_cmp_eq_u32 vcc, 0, v22
  s_nop 1
  v_cndmask_b32 v14, v14, v15, vcc
  s_lshl_b32 s36, s33, 7
  v_lshl_add_u32 v22, v0, 2, s36
  v_cmp_gt_u32 vcc, 32, v0
  s_nop 1
  v_cndmask_b32 v22, v11, v22, vcc
  buffer_store_dword v14, v22, s[20:23], 0 offen
  s_waitcnt vmcnt(30)
  v_lshl_or_b32 v40, v84, 16, v40
  s_waitcnt vmcnt(28)
  v_lshl_or_b32 v41, v85, 16, v41
  s_waitcnt vmcnt(26)
  v_lshl_or_b32 v42, v86, 16, v42
  s_waitcnt vmcnt(24)
  v_lshl_or_b32 v43, v87, 16, v43
  s_waitcnt vmcnt(22)
  v_lshl_or_b32 v44, v88, 16, v44
  s_waitcnt vmcnt(20)
  v_lshl_or_b32 v45, v89, 16, v45
  s_waitcnt vmcnt(18)
  v_lshl_or_b32 v46, v90, 16, v46
  s_waitcnt vmcnt(16)
  v_lshl_or_b32 v47, v91, 16, v47
  s_waitcnt vmcnt(14)
  v_lshl_or_b32 v48, v92, 16, v48
  s_waitcnt vmcnt(12)
  v_lshl_or_b32 v49, v93, 16, v49
  s_waitcnt vmcnt(10)
  v_lshl_or_b32 v50, v94, 16, v50
  s_waitcnt vmcnt(8)
  v_lshl_or_b32 v51, v95, 16, v51
  buffer_store_dwordx4 v[40:43], v56, s[28:31], 0 offen
  buffer_store_dwordx4 v[44:47], v57, s[28:31], 0 offen
  buffer_store_dwordx4 v[48:51], v58, s[40:43], 0 offen
  s_waitcnt vmcnt(0)
  s_cmp_lt_u32 s2, 238
  s_cbranch_scc1 L_prep_done
  s_sub_u32 s55, s2, 238
  v_mov_b32 v35, s32
  v_lshrrev_b32 v36, 1, v35
  v_mul_u32_u24 v36, 18, v36
  v_and_b32 v37, 1, v35
  v_lshl_add_u32 v36, v37, 3, v36
  s_mul_i32 s37, s55, 36
  v_add_u32 v36, s37, v36
  v_mul_u32_u24 v37, 72, v35
  s_mul_i32 s37, s55, 288
  s_sub_u32 s37, s37, 4592
  v_add_u32 v37, s37, v37
  s_cmp_lt_u32 s55, 16
  s_cselect_b64 vcc, -1, 0
  v_cndmask_b32 v38, v37, v36, vcc
  v_lshrrev_b32 v36, 1, v2
  v_mul_u32_u24 v36, 18, v36
  v_and_b32 v37, 1, v2
  v_add_u32 v36, v36, v37
  v_cndmask_b32 v36, v36, v2, vcc
  v_add_u32 v38, v38, v36
  v_mul_u32_u24 v38, 1152, v38
  v_lshl_add_u32 v54, v3, 4, v38
  buffer_load_dwordx4 v[64:67], v54, s[12:15], 0 offen
  buffer_load_dwordx4 v[68:71], v54, s[12:15], 0 offen offset:128
  buffer_load_dwordx4 v[72:75], v54, s[12:15], 0 offen offset:256
  buffer_load_dwordx4 v[76:79], v54, s[12:15], 0 offen offset:384
  buffer_load_dwordx4 v[80:83], v54, s[12:15], 0 offen offset:512
  buffer_load_dwordx4 v[84:87], v54, s[12:15], 0 offen offset:640
  buffer_load_dwordx4 v[88:91], v54, s[12:15], 0 offen offset:768
  buffer_load_dwordx4 v[92:95], v54, s[12:15], 0 offen offset:896
  buffer_load_dwordx4 v[96:99], v54, s[12:15], 0 offen offset:1024
  v_mov_b32 v36, 0
  v_mov_b32 v37, 0
  s_mov_b32 s37, 0x3f803f80
  s_waitcnt vmcnt(8)
  v_dot2c_f32_bf16 v36, s37, v64
  v_dot2c_f32_bf16 v37, s37, v65
  v_dot2c_f32_bf16 v36, s37, v66
  v_dot2c_f32_bf16 v37, s37, v67
  s_waitcnt vmcnt(7)
  v_dot2c_f32_bf16 v36, s37, v68
  v_dot2c_f32_bf16 v37, s37, v69
  v_dot2c_f32_bf16 v36, s37, v70
  v_dot2c_f32_bf16 v37, s37, v71
  s_waitcnt vmcnt(6)
  v_dot2c_f32_bf16 v36, s37, v72
  v_dot2c_f32_bf16 v37, s37, v73
  v_dot2c_f32_bf16 v36, s37, v74
  v_dot2c_f32_bf16 v37, s37, v75
  s_waitcnt vmcnt(5)
  v_dot2c_f32_bf16 v36, s37, v76
  v_dot2c_f32_bf16 v37, s37, v77
  v_dot2c_f32_bf16 v36, s37, v78
  v_dot2c_f32_bf16 v37, s37, v79
  s_waitcnt vmcnt(4)
  v_dot2c_f32_bf16 v36, s37, v80
  v_dot2c_f32_bf16 v37, s37, v81
  v_dot2c_f32_bf16 v36, s37, v82
  v_dot2c_f32_bf16 v37, s37, v83
  s_waitcnt vmcnt(3)
  v_dot2c_f32_bf16 v36, s37, v84
  v_dot2c_f32_bf16 v37, s37, v85
  v_dot2c_f32_bf16 v36, s37, v86
  v_dot2c_f32_bf16 v37, s37, v87
  s_waitcnt vmcnt(2)
  v_dot2c_f32_bf16 v36, s37, v88
  v_dot2c_f32_bf16 v37, s37, v89
  v_dot2c_f32_bf16 v36, s37, v90
  v_dot2c_f32_bf16 v37, s37, v91
  s_waitcnt vmcnt(1)
  v_dot2c_f32_bf16 v36, s37, v92
  v_dot2c_f32_bf16 v37, s37, v93
  v_dot2c_f32_bf16 v36, s37, v94
  v_dot2c_f32_bf16 v37, s37, v95
  s_waitcnt vmcnt(0)
  v_dot2c_f32_bf16 v36, s37, v96
  v_dot2c_f32_bf16 v37, s37, v97
  v_dot2c_f32_bf16 v36, s37, v98
  v_dot2c_f32_bf16 v37, s37, v99
  s_nop 2
  v_add_f32 v36, v36, v37
  s_nop 1
  v_add_f32_dpp v36, v36, v36 quad_perm:[1,0,3,2] row_mask:0xf bank_mask:0xf
  s_nop 1
  v_add_f32_dpp v36, v36, v36 quad_perm:[2,3,0,1] row_mask:0xf bank_mask:0xf
  s_nop 1
  v_add_f32_dpp v36, v36, v36 row_half_mirror row_mask:0xf bank_mask:0xf
  v_mul_f32 v36, 0x3ae38e39, v36
  v_cvt_pk_bf16_f32 v37, v36, v36
  v_and_b32 v37, 0xffff0000, v37
  v_sub_f32 v36, v36, v37
  v_cvt_pk_bf16_f32 v36, v36, v36
  s_add_u32 s37, s55, 648
  s_lshl_b32 s37, s37, 10
  s_lshl_b32 s38, s32, 8
  s_add_u32 s37, s37, s38
  v_lshl_add_u32 v38, v2, 1, s37
  v_cmp_eq_u32 vcc, 0, v3
  s_nop 1
  v_cndmask_b32 v38, v11, v38, vcc
  buffer_store_short_d16_hi v37, v38, s[40:43], 0 offen
  buffer_store_short v36, v38, s[40:43], 0 offen offset:16
  v_lshl_add_u32 v38, v1, 4, s37
  v_cmp_gt_u32 vcc, 14, v1
  s_nop 1
  v_cndmask_b32 v38, v11, v38, vcc
  v_mov_b32 v40, 0
  v_mov_b32 v41, 0
  v_mov_b32 v42, 0
  v_mov_b32 v43, 0
  buffer_store_dwordx4 v[40:43], v38, s[40:43], 0 offen offset:32
L_prep_done:
L_prep_end:
  s_endpgm
.globl main_kernel
.p2align 8
.type main_kernel,@function
main_kernel:
  s_cmp_ge_u32 s2, 256
  s_cbranch_scc1 L_main_end
  s_load_dwordx4 s[80:83], s[0:1], 32
  s_load_dwordx2 s[84:85], s[0:1], 48
  s_load_dwordx2 s[86:87], s[0:1], 72
  s_load_dwordx2 s[88:89], s[0:1], 56
  v_lshrrev_b32 v1, 6, v0
  s_mov_b32 s95, 0
  s_mov_b32 s101, 0
  v_readfirstlane_b32 s92, v1
  s_and_b32 s36, s2, 7
  s_lshr_b32 s37, s2, 3
  s_and_b32 s94, s36, 3
  s_lshl_b32 s94, s94, 2
  s_and_b32 s38, s37, 3
  s_add_u32 s94, s94, s38
  s_lshr_b32 s93, s36, 2
  s_lshl_b32 s93, s93, 3
  s_lshr_b32 s38, s37, 2
  s_add_u32 s93, s93, s38
  s_waitcnt lgkmcnt(0)
  s_add_u32 s44, s86, 0
  s_addc_u32 s45, s87, 0
  s_and_b32 s45, s45, 0xffff
  s_mov_b32 s46, 2064384
  s_mov_b32 s47, 0x20000
  s_mul_i32 s36, s94, 129024
  s_lshl_b32 s66, s92, 12
  s_add_u32 s36, s36, s66
  v_and_b32 v7, 63, v0
  v_lshlrev_b32 v7, 4, v7
  v_add_u32 v7, s36, v7
  s_add_u32 m0, s66, 0
  s_mov_b32 s38, 0
  buffer_load_dwordx4 v7, s[44:47], s38 offen lds
  buffer_load_dwordx4 v7, s[44:47], s38 offen offset:1024 lds
  buffer_load_dwordx4 v7, s[44:47], s38 offen offset:2048 lds
  buffer_load_dwordx4 v7, s[44:47], s38 offen offset:3072 lds
  s_add_u32 m0, s66, 16384
  s_mov_b32 s38, 16384
  buffer_load_dwordx4 v7, s[44:47], s38 offen lds
  buffer_load_dwordx4 v7, s[44:47], s38 offen offset:1024 lds
  buffer_load_dwordx4 v7, s[44:47], s38 offen offset:2048 lds
  buffer_load_dwordx4 v7, s[44:47], s38 offen offset:3072 lds
  s_add_u32 m0, s66, 32768
  s_mov_b32 s38, 32768
  buffer_load_dwordx4 v7, s[44:47], s38 offen lds
  buffer_load_dwordx4 v7, s[44:47], s38 offen offset:1024 lds
  buffer_load_dwordx4 v7, s[44:47], s38 offen offset:2048 lds
  buffer_load_dwordx4 v7, s[44:47], s38 offen offset:3072 lds
  s_add_u32 m0, s66, 49152
  s_mov_b32 s38, 49152
  buffer_load_dwordx4 v7, s[44:47], s38 offen lds
  buffer_load_dwordx4 v7, s[44:47], s38 offen offset:1024 lds
  buffer_load_dwordx4 v7, s[44:47], s38 offen offset:2048 lds
  buffer_load_dwordx4 v7, s[44:47], s38 offen offset:3072 lds
  s_add_u32 m0, s66, 65536
  s_mov_b32 s38, 65536
  buffer_load_dwordx4 v7, s[44:47], s38 offen lds
  buffer_load_dwordx4 v7, s[44:47], s38 offen offset:1024 lds
  buffer_load_dwordx4 v7, s[44:47], s38 offen offset:2048 lds
  buffer_load_dwordx4 v7, s[44:47], s38 offen offset:3072 lds
  s_add_u32 m0, s66, 81920
  s_mov_b32 s38, 81920
  buffer_load_dwordx4 v7, s[44:47], s38 offen lds
  buffer_load_dwordx4 v7, s[44:47], s38 offen offset:1024 lds
  buffer_load_dwordx4 v7, s[44:47], s38 offen offset:2048 lds
  buffer_load_dwordx4 v7, s[44:47], s38 offen offset:3072 lds
  s_add_u32 m0, s66, 98304
  s_mov_b32 s38, 98304
  buffer_load_dwordx4 v7, s[44:47], s38 offen lds
  buffer_load_dwordx4 v7, s[44:47], s38 offen offset:1024 lds
  buffer_load_dwordx4 v7, s[44:47], s38 offen offset:2048 lds
  buffer_load_dwordx4 v7, s[44:47], s38 offen offset:3072 lds
  s_add_u32 m0, s66, 114688
  s_mov_b32 s38, 114688
  buffer_load_dwordx4 v7, s[44:47], s38 offen lds
  buffer_load_dwordx4 v7, s[44:47], s38 offen offset:1024 lds
  buffer_load_dwordx4 v7, s[44:47], s38 offen offset:2048 lds
  buffer_load_dwordx4 v7, s[44:47], s38 offen offset:3072 lds
  s_add_u32 s90, s86, 3796992
  s_addc_u32 s91, s87, 0
  s_lshl_b32 s36, s93, 11
  s_lshl_b32 s37, s94, 7
  s_add_u32 s37, s37, s36
  v_mov_b32 v31, 0x7ffffff0
  v_mov_b32 v29, s37
  v_cmp_eq_u32 vcc, 0, v0
  s_nop 1
  v_cndmask_b32 v29, v31, v29, vcc
  v_and_b32 v30, 15, v0
  v_lshlrev_b32 v30, 7, v30
  v_add_u32 v30, s36, v30
  s_add_u32 s96, s90, 7249920
  s_addc_u32 s97, s91, 0
  s_and_b32 s97, s97, 0xffff
  s_mov_b32 s98, 46047232
  s_mov_b32 s99, 0x20000
L_layer:
  v_and_b32 v20, 63, v0
  v_and_b32 v21, 15, v20
  v_lshrrev_b32 v22, 4, v20
  v_lshlrev_b32 v1, 4, v20
  v_add_u32 v2, 65536, v1
  v_add_u32 v19, 131072, v1
  s_lshl_b32 s36, s92, 10
  v_add_u32 v3, s36, v1
  v_add_u32 v4, 65536, v3
  s_lshl_b32 s36, s93, 3
  s_max_u32 s37, s36, 1
  s_sub_u32 s37, s37, 1
  s_lshl_b32 s38, s92, 1
  s_add_u32 s36, s36, s38
  v_lshrrev_b32 v23, 3, v21
  v_lshlrev_b32 v23, 7, v23
  v_and_b32 v24, 7, v21
  v_lshl_add_u32 v23, v24, 2, v23
  s_lshl_b32 s38, s37, 8
  v_add_u32 v8, s38, v23
  s_lshl_b32 s38, s36, 8
  v_add_u32 v9, s38, v23
  s_mul_i32 s37, s37, 18432
  s_mul_i32 s35, s92, 5120
  s_add_u32 s37, s37, s35
  v_add_u32 v5, s37, v1
  s_add_u32 s35, s35, 131072
  s_mul_i32 s36, s36, 18432
  v_add_u32 v6, s36, v1
  s_max_u32 s36, s93, 1
  s_sub_u32 s36, s36, 1
  s_lshl_b32 s36, s36, 11
  s_add_u32 s36, s36, 1792
  v_and_b32 v23, 1, v20
  v_lshl_add_u32 v23, v23, 7, s36
  v_cmp_gt_u32 vcc, 16, v20
  s_nop 1
  v_cndmask_b32 v25, v23, v30, vcc
  s_mov_b32 s48, 0
  s_mov_b32 s53, 18432
  s_mov_b32 s49, 4096
  s_mov_b32 s54, 22528
  s_mov_b32 s50, 8192
  s_mov_b32 s55, 26624
  s_mov_b32 s51, 12288
  s_mov_b32 s56, 30720
  s_mov_b32 s52, 16384
  s_mov_b32 s57, 34816
  s_add_u32 s4, s90, 0
  s_addc_u32 s5, s91, 0
  s_and_b32 s5, s5, 0xffff
  s_mov_b32 s6, 2359296
  s_mov_b32 s7, 0x20000
  s_add_u32 s8, s90, 7077888
  s_addc_u32 s9, s91, 0
  s_and_b32 s9, s9, 0xffff
  s_mov_b32 s10, 32768
  s_mov_b32 s11, 0x20000
  s_add_u32 s12, s90, 4718592
  s_addc_u32 s13, s91, 0
  s_and_b32 s13, s13, 0xffff
  s_mov_b32 s14, 2359296
  s_mov_b32 s15, 0x20000
  v_mul_u32_u24 v23, 240, v21
  v_lshl_add_u32 v23, v22, 3, v23
  v_add_u32 v12, 129152, v23
  s_lshl_b32 s36, s92, 5
  s_add_u32 s37, s36, 129024
  v_add_u32 v11, s37, v23
  s_mul_i32 s36, s36, 240
  s_add_u32 s36, s36, 132864
  v_add_u32 v13, s36, v23
  v_lshrrev_b32 v26, 5, v20
  v_and_b32 v23, 31, v20
  s_lshl_b32 s36, s92, 5
  v_add_u32 v23, s36, v23
  v_mul_u32_u24 v24, 240, v23
  v_mul_u32_u24 v14, 80, v26
  v_add_u32 v14, v14, v24
  v_add_u32 v14, 129504, v14
  v_mul_u32_u24 v15, 36, v26
  v_add_u32 v15, v15, v24
  v_add_u32 v15, 133016, v15
  s_lshl_b32 s37, s93, 7
  v_add_u32 v23, s37, v23
  v_cmp_le_u32 s[64:65], 2, v23
  v_cmp_le_u32 s[66:67], 4, v23
  v_cmp_le_u32 s[68:69], 6, v23
  v_cmp_le_u32 s[70:71], 8, v23
  v_cmp_le_u32 s[72:73], 10, v23
  v_cmp_le_u32 s[74:75], 12, v23
  v_cmp_le_u32 s[76:77], 14, v23
  v_lshrrev_b32 v24, 4, v23
  v_mul_u32_u24 v24, 18432, v24
  v_lshl_add_u32 v16, v21, 4, v24
  v_lshl_add_u32 v16, v26, 9, v16
  s_lshl_b32 s37, s94, 10
  v_add_u32 v16, s37, v16
  v_lshl_add_u32 v17, v21, 2, v24
  v_lshl_add_u32 v17, v26, 6, v17
  s_lshl_b32 s37, s94, 7
  s_add_u32 s37, s37, 16384
  v_add_u32 v17, s37, v17
  v_mov_b32 v18, 0xceabfb8f
  s_mov_b32 s32, 0x05040100
  s_mov_b32 s33, 0x07060302
  s_mov_b32 s34, 0x3f803f80
  s_add_u32 s60, s86, 2064384
  s_addc_u32 s61, s87, 0
  s_and_b32 s61, s61, 0xffff
  s_mov_b32 s62, 681984
  s_mov_b32 s63, 0x20000
  s_and_b32 s36, s94, 3
  s_and_b32 s37, s36, 1
  s_mul_i32 s36, s36, 9
  s_add_u32 s38, s36, s37
  s_xor_b32 s37, s37, 1
  s_lshl_b32 s37, s37, 3
  s_add_u32 s36, s36, s37
  s_lshl_b32 s37, s92, 1
  s_add_u32 s38, s38, s37
  s_mul_i32 s38, s38, 18432
  v_add_u32 v250, s38, v1
  s_cmp_lt_u32 s92, 2
  s_cselect_b32 s36, s36, 36
  s_mul_i32 s36, s36, 18432
  v_add_u32 v251, s36, v1
  s_cmp_eq_u32 s95, 0
  s_cbranch_scc1 L_a1np_1
  s_mov_b32 s36, 0
  buffer_load_dword v31, v25, s[96:99], s36 offen sc1
  s_waitcnt vmcnt(0)
  v_cmp_eq_u32 vcc, 0, v31
  s_cbranch_vccnz L_sp_2
L_bk_3:
L_a1np_1:
  buffer_load_dwordx4 a[0:3], v6, s[4:7], s48 offen sc1
  buffer_load_dwordx4 a[72:75], v6, s[4:7], s53 offen sc1
  buffer_load_dwordx4 a[4:7], v6, s[4:7], s48 offen offset:1024 sc1
  buffer_load_dwordx4 a[76:79], v6, s[4:7], s53 offen offset:1024 sc1
  s_mov_b32 m0, s35
  s_nop 0
  buffer_load_dwordx4 v5, s[4:7], 0 offen sc1 lds
  buffer_load_dwordx4 v5, s[4:7], 0 offen offset:1024 sc1 lds
  buffer_load_dwordx4 v5, s[4:7], 0 offen offset:2048 sc1 lds
  buffer_load_dwordx4 v5, s[4:7], 0 offen offset:3072 sc1 lds
  s_add_u32 m0, s35, 4096
  s_nop 0
  buffer_load_dwordx4 v5, s[4:7], s49 offen sc1 lds
  buffer_load_dwordx4 a[8:11], v6, s[4:7], s48 offen offset:2048 sc1
  buffer_load_dwordx4 a[80:83], v6, s[4:7], s53 offen offset:2048 sc1
  buffer_load_dwordx4 a[12:15], v6, s[4:7], s48 offen offset:3072 sc1
  buffer_load_dwordx4 a[84:87], v6, s[4:7], s53 offen offset:3072 sc1
  s_waitcnt vmcnt(11)
  s_barrier
  ds_read_b128 v[176:179], v1
  ds_read_b128 v[180:183], v1 offset:1024
  ds_read_b128 v[184:187], v1 offset:2048
  ds_read_b128 v[188:191], v1 offset:3072
  ds_read_b128 v[192:195], v1 offset:4096
  ds_read_b128 v[196:199], v1 offset:5120
  ds_read_b128 v[200:203], v1 offset:6144
  s_waitcnt lgkmcnt(0)
  v_mfma_f32_16x16x32_bf16 v[112:115], v[176:179], a[0:3], 0
  ds_read_b128 v[204:207], v1 offset:7168
  v_mfma_f32_16x16x32_bf16 v[140:143], v[176:179], a[72:75], 0
  ds_read_b128 v[208:211], v1 offset:8192
  v_mfma_f32_16x16x32_bf16 v[116:119], v[180:183], a[0:3], 0
  ds_read_b128 v[212:215], v1 offset:9216
  v_mfma_f32_16x16x32_bf16 v[144:147], v[180:183], a[72:75], 0
  ds_read_b128 v[216:219], v1 offset:10240
  v_mfma_f32_16x16x32_bf16 v[120:123], v[184:187], a[0:3], 0
  ds_read_b128 v[220:223], v1 offset:11264
  v_mfma_f32_16x16x32_bf16 v[148:151], v[184:187], a[72:75], 0
  ds_read_b128 v[224:227], v1 offset:12288
  v_mfma_f32_16x16x32_bf16 v[124:127], v[188:191], a[0:3], 0
  ds_read_b128 v[228:231], v1 offset:13312
  v_mfma_f32_16x16x32_bf16 v[152:155], v[188:191], a[72:75], 0
  buffer_load_dwordx4 a[16:19], v6, s[4:7], s49 offen sc1
  v_mfma_f32_16x16x32_bf16 v[128:131], v[192:195], a[0:3], 0
  buffer_load_dwordx4 a[88:91], v6, s[4:7], s54 offen sc1
  v_mfma_f32_16x16x32_bf16 v[156:159], v[192:195], a[72:75], 0
  buffer_load_dwordx4 a[144:147], v251, s[60:63], s48 offen
  v_mfma_f32_16x16x32_bf16 v[132:135], v[196:199], a[0:3], 0
  v_mfma_f32_16x16x32_bf16 v[160:163], v[196:199], a[72:75], 0
  v_mfma_f32_16x16x32_bf16 v[136:139], v[200:203], a[0:3], 0
  v_mfma_f32_16x16x32_bf16 v[164:167], v[200:203], a[72:75], 0
  s_waitcnt vmcnt(12) lgkmcnt(0)
  v_mfma_f32_16x16x32_bf16 v[112:115], v[204:207], a[4:7], v[112:115]
  ds_read_b128 v[176:179], v1 offset:14336
  v_mfma_f32_16x16x32_bf16 v[140:143], v[204:207], a[76:79], v[140:143]
  ds_read_b128 v[180:183], v1 offset:15360
  v_mfma_f32_16x16x32_bf16 v[116:119], v[208:211], a[4:7], v[116:119]
  ds_read_b128 v[184:187], v1 offset:16384
  v_mfma_f32_16x16x32_bf16 v[144:147], v[208:211], a[76:79], v[144:147]
  ds_read_b128 v[188:191], v1 offset:17408
  v_mfma_f32_16x16x32_bf16 v[120:123], v[212:215], a[4:7], v[120:123]
  ds_read_b128 v[192:195], v1 offset:18432
  v_mfma_f32_16x16x32_bf16 v[148:151], v[212:215], a[76:79], v[148:151]
  ds_read_b128 v[196:199], v1 offset:19456
  v_mfma_f32_16x16x32_bf16 v[124:127], v[216:219], a[4:7], v[124:127]
  ds_read_b128 v[200:203], v1 offset:20480
  v_mfma_f32_16x16x32_bf16 v[152:155], v[216:219], a[76:79], v[152:155]
  buffer_load_dwordx4 a[20:23], v6, s[4:7], s49 offen offset:1024 sc1
  v_mfma_f32_16x16x32_bf16 v[128:131], v[220:223], a[4:7], v[128:131]
  buffer_load_dwordx4 a[92:95], v6, s[4:7], s54 offen offset:1024 sc1
  v_mfma_f32_16x16x32_bf16 v[156:159], v[220:223], a[76:79], v[156:159]
  buffer_load_dwordx4 a[148:151], v251, s[60:63], s48 offen offset:1024
  v_mfma_f32_16x16x32_bf16 v[132:135], v[224:227], a[4:7], v[132:135]
  v_mfma_f32_16x16x32_bf16 v[160:163], v[224:227], a[76:79], v[160:163]
  v_mfma_f32_16x16x32_bf16 v[136:139], v[228:231], a[4:7], v[136:139]
  v_mfma_f32_16x16x32_bf16 v[164:167], v[228:231], a[76:79], v[164:167]
  s_waitcnt vmcnt(8) lgkmcnt(0)
  v_mfma_f32_16x16x32_bf16 v[112:115], v[176:179], a[8:11], v[112:115]
  s_barrier
  v_mfma_f32_16x16x32_bf16 v[140:143], v[176:179], a[80:83], v[140:143]
  ds_read_b128 v[204:207], v1 offset:21504
  v_mfma_f32_16x16x32_bf16 v[116:119], v[180:183], a[8:11], v[116:119]
  ds_read_b128 v[208:211], v1 offset:22528
  v_mfma_f32_16x16x32_bf16 v[144:147], v[180:183], a[80:83], v[144:147]
  ds_read_b128 v[212:215], v1 offset:23552
  v_mfma_f32_16x16x32_bf16 v[120:123], v[184:187], a[8:11], v[120:123]
  ds_read_b128 v[216:219], v1 offset:24576
  v_mfma_f32_16x16x32_bf16 v[148:151], v[184:187], a[80:83], v[148:151]
  ds_read_b128 v[220:223], v1 offset:25600
  v_mfma_f32_16x16x32_bf16 v[124:127], v[188:191], a[8:11], v[124:127]
  ds_read_b128 v[224:227], v1 offset:26624
  v_mfma_f32_16x16x32_bf16 v[152:155], v[188:191], a[80:83], v[152:155]
  ds_read_b128 v[228:231], v1 offset:27648
  v_mfma_f32_16x16x32_bf16 v[128:131], v[192:195], a[8:11], v[128:131]
  ds_read_b128 v[32:35], v3
  v_mfma_f32_16x16x32_bf16 v[156:159], v[192:195], a[80:83], v[156:159]
  ds_read_b128 v[36:39], v1 offset:4096
  v_mfma_f32_16x16x32_bf16 v[132:135], v[196:199], a[8:11], v[132:135]
  ds_read_b128 v[40:43], v19
  v_mfma_f32_16x16x32_bf16 v[160:163], v[196:199], a[80:83], v[160:163]
  buffer_load_dwordx4 a[24:27], v6, s[4:7], s49 offen offset:2048 sc1
  v_mfma_f32_16x16x32_bf16 v[136:139], v[200:203], a[8:11], v[136:139]
  buffer_load_dwordx4 a[96:99], v6, s[4:7], s54 offen offset:2048 sc1
  v_mfma_f32_16x16x32_bf16 v[164:167], v[200:203], a[80:83], v[164:167]
  buffer_load_dwordx4 a[152:155], v251, s[60:63], s48 offen offset:2048
  s_waitcnt vmcnt(9) lgkmcnt(0)
  v_mfma_f32_16x16x32_bf16 v[112:115], v[204:207], a[12:15], v[112:115]
  ds_read_b128 v[176:179], v1 offset:28672
  v_mfma_f32_16x16x32_bf16 v[140:143], v[204:207], a[84:87], v[140:143]
  ds_read_b128 v[180:183], v1 offset:29696
  v_mfma_f32_16x16x32_bf16 v[116:119], v[208:211], a[12:15], v[116:119]
  ds_read_b128 v[184:187], v1 offset:30720
  v_mfma_f32_16x16x32_bf16 v[144:147], v[208:211], a[84:87], v[144:147]
  ds_read_b128 v[188:191], v1 offset:31744
  v_mfma_f32_16x16x32_bf16 v[120:123], v[212:215], a[12:15], v[120:123]
  ds_read_b128 v[192:195], v1 offset:32768
  v_mfma_f32_16x16x32_bf16 v[148:151], v[212:215], a[84:87], v[148:151]
  ds_read_b128 v[196:199], v1 offset:33792
  v_mfma_f32_16x16x32_bf16 v[124:127], v[216:219], a[12:15], v[124:127]
  ds_read_b128 v[200:203], v1 offset:34816
  v_mfma_f32_16x16x32_bf16 v[152:155], v[216:219], a[84:87], v[152:155]
  ds_read_b128 v[44:47], v3 offset:7168
  v_mfma_f32_16x16x32_bf16 v[128:131], v[220:223], a[12:15], v[128:131]
  ds_read_b128 v[48:51], v1 offset:11264
  v_mfma_f32_16x16x32_bf16 v[156:159], v[220:223], a[84:87], v[156:159]
  ds_read_b128 v[52:55], v19 offset:1024
  v_mfma_f32_16x16x32_bf16 v[132:135], v[224:227], a[12:15], v[132:135]
  buffer_load_dwordx4 a[28:31], v6, s[4:7], s49 offen offset:3072 sc1
  v_mfma_f32_16x16x32_bf16 v[160:163], v[224:227], a[84:87], v[160:163]
  buffer_load_dwordx4 a[100:103], v6, s[4:7], s54 offen offset:3072 sc1
  v_mfma_f32_16x16x32_bf16 v[136:139], v[228:231], a[12:15], v[136:139]
  buffer_load_dwordx4 a[156:159], v251, s[60:63], s48 offen offset:3072
  v_mfma_f32_16x16x32_bf16 v[164:167], v[228:231], a[84:87], v[164:167]
  v_mfma_f32_16x16x32_bf16 v[168:171], v[32:35], v[40:43], 0
  v_mfma_f32_16x16x32_bf16 v[172:175], v[36:39], v[40:43], 0
  s_waitcnt vmcnt(10) lgkmcnt(0)
  v_mfma_f32_16x16x32_bf16 v[112:115], v[176:179], a[16:19], v[112:115]
  ds_read_b128 v[204:207], v1 offset:35840
  v_mfma_f32_16x16x32_bf16 v[140:143], v[176:179], a[88:91], v[140:143]
  ds_read_b128 v[208:211], v1 offset:36864
  v_mfma_f32_16x16x32_bf16 v[116:119], v[180:183], a[16:19], v[116:119]
  ds_read_b128 v[212:215], v1 offset:37888
  v_mfma_f32_16x16x32_bf16 v[144:147], v[180:183], a[88:91], v[144:147]
  ds_read_b128 v[216:219], v1 offset:38912
  v_mfma_f32_16x16x32_bf16 v[120:123], v[184:187], a[16:19], v[120:123]
  ds_read_b128 v[220:223], v1 offset:39936
  v_mfma_f32_16x16x32_bf16 v[148:151], v[184:187], a[88:91], v[148:151]
  ds_read_b128 v[224:227], v1 offset:40960
  v_mfma_f32_16x16x32_bf16 v[124:127], v[188:191], a[16:19], v[124:127]
  ds_read_b128 v[228:231], v1 offset:41984
  v_mfma_f32_16x16x32_bf16 v[152:155], v[188:191], a[88:91], v[152:155]
  ds_read_b128 v[32:35], v3 offset:14336
  v_mfma_f32_16x16x32_bf16 v[128:131], v[192:195], a[16:19], v[128:131]
  ds_read_b128 v[36:39], v1 offset:18432
  v_mfma_f32_16x16x32_bf16 v[156:159], v[192:195], a[88:91], v[156:159]
  ds_read_b128 v[40:43], v19 offset:2048
  v_mfma_f32_16x16x32_bf16 v[132:135], v[196:199], a[16:19], v[132:135]
  buffer_load_dwordx4 a[32:35], v6, s[4:7], s50 offen sc1
  v_mfma_f32_16x16x32_bf16 v[160:163], v[196:199], a[88:91], v[160:163]
  buffer_load_dwordx4 a[104:107], v6, s[4:7], s55 offen sc1
  v_mfma_f32_16x16x32_bf16 v[136:139], v[200:203], a[16:19], v[136:139]
  buffer_load_dwordx4 a[160:163], v251, s[60:63], s49 offen
  v_mfma_f32_16x16x32_bf16 v[164:167], v[200:203], a[88:91], v[164:167]
  v_mfma_f32_16x16x32_bf16 v[168:171], v[44:47], v[52:55], v[168:171]
  v_mfma_f32_16x16x32_bf16 v[172:175], v[48:51], v[52:55], v[172:175]
  s_waitcnt vmcnt(10) lgkmcnt(0)
  v_mfma_f32_16x16x32_bf16 v[112:115], v[204:207], a[20:23], v[112:115]
  ds_read_b128 v[176:179], v1 offset:43008
  v_mfma_f32_16x16x32_bf16 v[140:143], v[204:207], a[92:95], v[140:143]
  ds_read_b128 v[180:183], v1 offset:44032
  v_mfma_f32_16x16x32_bf16 v[116:119], v[208:211], a[20:23], v[116:119]
  ds_read_b128 v[184:187], v1 offset:45056
  v_mfma_f32_16x16x32_bf16 v[144:147], v[208:211], a[92:95], v[144:147]
  ds_read_b128 v[188:191], v1 offset:46080
  v_mfma_f32_16x16x32_bf16 v[120:123], v[212:215], a[20:23], v[120:123]
  ds_read_b128 v[192:195], v1 offset:47104
  v_mfma_f32_16x16x32_bf16 v[148:151], v[212:215], a[92:95], v[148:151]
  ds_read_b128 v[196:199], v1 offset:48128
  v_mfma_f32_16x16x32_bf16 v[124:127], v[216:219], a[20:23], v[124:127]
  ds_read_b128 v[200:203], v1 offset:49152
  v_mfma_f32_16x16x32_bf16 v[152:155], v[216:219], a[92:95], v[152:155]
  ds_read_b128 v[44:47], v3 offset:21504
  v_mfma_f32_16x16x32_bf16 v[128:131], v[220:223], a[20:23], v[128:131]
  ds_read_b128 v[48:51], v1 offset:25600
  v_mfma_f32_16x16x32_bf16 v[156:159], v[220:223], a[92:95], v[156:159]
  ds_read_b128 v[52:55], v19 offset:3072
  v_mfma_f32_16x16x32_bf16 v[132:135], v[224:227], a[20:23], v[132:135]
  buffer_load_dwordx4 a[36:39], v6, s[4:7], s50 offen offset:1024 sc1
  v_mfma_f32_16x16x32_bf16 v[160:163], v[224:227], a[92:95], v[160:163]
  buffer_load_dwordx4 a[108:111], v6, s[4:7], s55 offen offset:1024 sc1
  v_mfma_f32_16x16x32_bf16 v[136:139], v[228:231], a[20:23], v[136:139]
  buffer_load_dwordx4 a[164:167], v251, s[60:63], s49 offen offset:1024
  v_mfma_f32_16x16x32_bf16 v[164:167], v[228:231], a[92:95], v[164:167]
  v_mfma_f32_16x16x32_bf16 v[168:171], v[32:35], v[40:43], v[168:171]
  v_mfma_f32_16x16x32_bf16 v[172:175], v[36:39], v[40:43], v[172:175]
  s_waitcnt vmcnt(10) lgkmcnt(0)
  v_mfma_f32_16x16x32_bf16 v[112:115], v[176:179], a[24:27], v[112:115]
  ds_read_b128 v[204:207], v1 offset:50176
  v_mfma_f32_16x16x32_bf16 v[140:143], v[176:179], a[96:99], v[140:143]
  ds_read_b128 v[208:211], v1 offset:51200
  v_mfma_f32_16x16x32_bf16 v[116:119], v[180:183], a[24:27], v[116:119]
  ds_read_b128 v[212:215], v1 offset:52224
  v_mfma_f32_16x16x32_bf16 v[144:147], v[180:183], a[96:99], v[144:147]
  ds_read_b128 v[216:219], v1 offset:53248
  v_mfma_f32_16x16x32_bf16 v[120:123], v[184:187], a[24:27], v[120:123]
  ds_read_b128 v[220:223], v1 offset:54272
  v_mfma_f32_16x16x32_bf16 v[148:151], v[184:187], a[96:99], v[148:151]
  ds_read_b128 v[224:227], v1 offset:55296
  v_mfma_f32_16x16x32_bf16 v[124:127], v[188:191], a[24:27], v[124:127]
  ds_read_b128 v[228:231], v1 offset:56320
  v_mfma_f32_16x16x32_bf16 v[152:155], v[188:191], a[96:99], v[152:155]
  ds_read_b128 v[32:35], v3 offset:28672
  v_mfma_f32_16x16x32_bf16 v[128:131], v[192:195], a[24:27], v[128:131]
  ds_read_b128 v[36:39], v1 offset:32768
  v_mfma_f32_16x16x32_bf16 v[156:159], v[192:195], a[96:99], v[156:159]
  ds_read_b128 v[40:43], v19 offset:4096
  v_mfma_f32_16x16x32_bf16 v[132:135], v[196:199], a[24:27], v[132:135]
  buffer_load_dwordx4 a[40:43], v6, s[4:7], s50 offen offset:2048 sc1
  v_mfma_f32_16x16x32_bf16 v[160:163], v[196:199], a[96:99], v[160:163]
  buffer_load_dwordx4 a[112:115], v6, s[4:7], s55 offen offset:2048 sc1
  v_mfma_f32_16x16x32_bf16 v[136:139], v[200:203], a[24:27], v[136:139]
  buffer_load_dwordx4 a[168:171], v251, s[60:63], s49 offen offset:2048
  v_mfma_f32_16x16x32_bf16 v[164:167], v[200:203], a[96:99], v[164:167]
  v_mfma_f32_16x16x32_bf16 v[168:171], v[44:47], v[52:55], v[168:171]
  v_mfma_f32_16x16x32_bf16 v[172:175], v[48:51], v[52:55], v[172:175]
  s_waitcnt vmcnt(10) lgkmcnt(0)
  v_mfma_f32_16x16x32_bf16 v[112:115], v[204:207], a[28:31], v[112:115]
  ds_read_b128 v[176:179], v1 offset:57344
  v_mfma_f32_16x16x32_bf16 v[140:143], v[204:207], a[100:103], v[140:143]
  ds_read_b128 v[180:183], v1 offset:58368
  v_mfma_f32_16x16x32_bf16 v[116:119], v[208:211], a[28:31], v[116:119]
  ds_read_b128 v[184:187], v1 offset:59392
  v_mfma_f32_16x16x32_bf16 v[144:147], v[208:211], a[100:103], v[144:147]
  ds_read_b128 v[188:191], v1 offset:60416
  v_mfma_f32_16x16x32_bf16 v[120:123], v[212:215], a[28:31], v[120:123]
  ds_read_b128 v[192:195], v1 offset:61440
  v_mfma_f32_16x16x32_bf16 v[148:151], v[212:215], a[100:103], v[148:151]
  ds_read_b128 v[196:199], v1 offset:62464
  v_mfma_f32_16x16x32_bf16 v[124:127], v[216:219], a[28:31], v[124:127]
  ds_read_b128 v[200:203], v1 offset:63488
  v_mfma_f32_16x16x32_bf16 v[152:155], v[216:219], a[100:103], v[152:155]
  ds_read_b128 v[44:47], v3 offset:35840
  v_mfma_f32_16x16x32_bf16 v[128:131], v[220:223], a[28:31], v[128:131]
  ds_read_b128 v[48:51], v1 offset:39936
  v_mfma_f32_16x16x32_bf16 v[156:159], v[220:223], a[100:103], v[156:159]
  ds_read_b128 v[52:55], v19 offset:5120
  v_mfma_f32_16x16x32_bf16 v[132:135], v[224:227], a[28:31], v[132:135]
  buffer_load_dwordx4 a[44:47], v6, s[4:7], s50 offen offset:3072 sc1
  v_mfma_f32_16x16x32_bf16 v[160:163], v[224:227], a[100:103], v[160:163]
  buffer_load_dwordx4 a[116:119], v6, s[4:7], s55 offen offset:3072 sc1
  v_mfma_f32_16x16x32_bf16 v[136:139], v[228:231], a[28:31], v[136:139]
  buffer_load_dwordx4 a[172:175], v251, s[60:63], s49 offen offset:3072
  v_mfma_f32_16x16x32_bf16 v[164:167], v[228:231], a[100:103], v[164:167]
  v_mfma_f32_16x16x32_bf16 v[168:171], v[32:35], v[40:43], v[168:171]
  v_mfma_f32_16x16x32_bf16 v[172:175], v[36:39], v[40:43], v[172:175]
  s_waitcnt vmcnt(10) lgkmcnt(0)
  v_mfma_f32_16x16x32_bf16 v[112:115], v[176:179], a[32:35], v[112:115]
  ds_read_b128 v[204:207], v1 offset:64512
  v_mfma_f32_16x16x32_bf16 v[140:143], v[176:179], a[104:107], v[140:143]
  ds_read_b128 v[208:211], v2
  v_mfma_f32_16x16x32_bf16 v[116:119], v[180:183], a[32:35], v[116:119]
  ds_read_b128 v[212:215], v2 offset:1024
  v_mfma_f32_16x16x32_bf16 v[144:147], v[180:183], a[104:107], v[144:147]
  ds_read_b128 v[216:219], v2 offset:2048
  v_mfma_f32_16x16x32_bf16 v[120:123], v[184:187], a[32:35], v[120:123]
  ds_read_b128 v[220:223], v2 offset:3072
  v_mfma_f32_16x16x32_bf16 v[148:151], v[184:187], a[104:107], v[148:151]
  ds_read_b128 v[224:227], v2 offset:4096
  v_mfma_f32_16x16x32_bf16 v[124:127], v[188:191], a[32:35], v[124:127]
  ds_read_b128 v[228:231], v2 offset:5120
  v_mfma_f32_16x16x32_bf16 v[152:155], v[188:191], a[104:107], v[152:155]
  ds_read_b128 v[32:35], v3 offset:43008
  v_mfma_f32_16x16x32_bf16 v[128:131], v[192:195], a[32:35], v[128:131]
  ds_read_b128 v[36:39], v1 offset:47104
  v_mfma_f32_16x16x32_bf16 v[156:159], v[192:195], a[104:107], v[156:159]
  ds_read_b128 v[40:43], v19 offset:6144
  v_mfma_f32_16x16x32_bf16 v[132:135], v[196:199], a[32:35], v[132:135]
  buffer_load_dwordx4 a[48:51], v6, s[4:7], s51 offen sc1
  v_mfma_f32_16x16x32_bf16 v[160:163], v[196:199], a[104:107], v[160:163]
  buffer_load_dwordx4 a[120:123], v6, s[4:7], s56 offen sc1
  v_mfma_f32_16x16x32_bf16 v[136:139], v[200:203], a[32:35], v[136:139]
  buffer_load_dwordx4 a[176:179], v251, s[60:63], s50 offen
  v_mfma_f32_16x16x32_bf16 v[164:167], v[200:203], a[104:107], v[164:167]
  v_mfma_f32_16x16x32_bf16 v[168:171], v[44:47], v[52:55], v[168:171]
  v_mfma_f32_16x16x32_bf16 v[172:175], v[48:51], v[52:55], v[172:175]
  s_waitcnt vmcnt(10) lgkmcnt(0)
  v_mfma_f32_16x16x32_bf16 v[112:115], v[204:207], a[36:39], v[112:115]
  ds_read_b128 v[176:179], v2 offset:6144
  v_mfma_f32_16x16x32_bf16 v[140:143], v[204:207], a[108:111], v[140:143]
  ds_read_b128 v[180:183], v2 offset:7168
  v_mfma_f32_16x16x32_bf16 v[116:119], v[208:211], a[36:39], v[116:119]
  ds_read_b128 v[184:187], v2 offset:8192
  v_mfma_f32_16x16x32_bf16 v[144:147], v[208:211], a[108:111], v[144:147]
  ds_read_b128 v[188:191], v2 offset:9216
  v_mfma_f32_16x16x32_bf16 v[120:123], v[212:215], a[36:39], v[120:123]
  ds_read_b128 v[192:195], v2 offset:10240
  v_mfma_f32_16x16x32_bf16 v[148:151], v[212:215], a[108:111], v[148:151]
  ds_read_b128 v[196:199], v2 offset:11264
  v_mfma_f32_16x16x32_bf16 v[124:127], v[216:219], a[36:39], v[124:127]
  ds_read_b128 v[200:203], v2 offset:12288
  v_mfma_f32_16x16x32_bf16 v[152:155], v[216:219], a[108:111], v[152:155]
  ds_read_b128 v[44:47], v3 offset:50176
  v_mfma_f32_16x16x32_bf16 v[128:131], v[220:223], a[36:39], v[128:131]
  ds_read_b128 v[48:51], v1 offset:54272
  v_mfma_f32_16x16x32_bf16 v[156:159], v[220:223], a[108:111], v[156:159]
  ds_read_b128 v[52:55], v19 offset:7168
  v_mfma_f32_16x16x32_bf16 v[132:135], v[224:227], a[36:39], v[132:135]
  buffer_load_dwordx4 a[52:55], v6, s[4:7], s51 offen offset:1024 sc1
  v_mfma_f32_16x16x32_bf16 v[160:163], v[224:227], a[108:111], v[160:163]
  buffer_load_dwordx4 a[124:127], v6, s[4:7], s56 offen offset:1024 sc1
  v_mfma_f32_16x16x32_bf16 v[136:139], v[228:231], a[36:39], v[136:139]
  buffer_load_dwordx4 a[180:183], v251, s[60:63], s50 offen offset:1024
  v_mfma_f32_16x16x32_bf16 v[164:167], v[228:231], a[108:111], v[164:167]
  v_mfma_f32_16x16x32_bf16 v[168:171], v[32:35], v[40:43], v[168:171]
  v_mfma_f32_16x16x32_bf16 v[172:175], v[36:39], v[40:43], v[172:175]
  s_waitcnt vmcnt(10) lgkmcnt(0)
  v_mfma_f32_16x16x32_bf16 v[112:115], v[176:179], a[40:43], v[112:115]
  ds_read_b128 v[204:207], v2 offset:13312
  v_mfma_f32_16x16x32_bf16 v[140:143], v[176:179], a[112:115], v[140:143]
  ds_read_b128 v[208:211], v2 offset:14336
  v_mfma_f32_16x16x32_bf16 v[116:119], v[180:183], a[40:43], v[116:119]
  ds_read_b128 v[212:215], v2 offset:15360
  v_mfma_f32_16x16x32_bf16 v[144:147], v[180:183], a[112:115], v[144:147]
  ds_read_b128 v[216:219], v2 offset:16384
  v_mfma_f32_16x16x32_bf16 v[120:123], v[184:187], a[40:43], v[120:123]
  ds_read_b128 v[220:223], v2 offset:17408
  v_mfma_f32_16x16x32_bf16 v[148:151], v[184:187], a[112:115], v[148:151]
  ds_read_b128 v[224:227], v2 offset:18432
  v_mfma_f32_16x16x32_bf16 v[124:127], v[188:191], a[40:43], v[124:127]
  ds_read_b128 v[228:231], v2 offset:19456
  v_mfma_f32_16x16x32_bf16 v[152:155], v[188:191], a[112:115], v[152:155]
  ds_read_b128 v[32:35], v3 offset:57344
  v_mfma_f32_16x16x32_bf16 v[128:131], v[192:195], a[40:43], v[128:131]
  ds_read_b128 v[36:39], v1 offset:61440
  v_mfma_f32_16x16x32_bf16 v[156:159], v[192:195], a[112:115], v[156:159]
  ds_read_b128 v[40:43], v19 offset:8192
  v_mfma_f32_16x16x32_bf16 v[132:135], v[196:199], a[40:43], v[132:135]
  buffer_load_dwordx4 a[56:59], v6, s[4:7], s51 offen offset:2048 sc1
  v_mfma_f32_16x16x32_bf16 v[160:163], v[196:199], a[112:115], v[160:163]
  buffer_load_dwordx4 a[128:131], v6, s[4:7], s56 offen offset:2048 sc1
  v_mfma_f32_16x16x32_bf16 v[136:139], v[200:203], a[40:43], v[136:139]
  buffer_load_dwordx4 a[184:187], v251, s[60:63], s50 offen offset:2048
  v_mfma_f32_16x16x32_bf16 v[164:167], v[200:203], a[112:115], v[164:167]
  v_mfma_f32_16x16x32_bf16 v[168:171], v[44:47], v[52:55], v[168:171]
  v_mfma_f32_16x16x32_bf16 v[172:175], v[48:51], v[52:55], v[172:175]
  s_waitcnt vmcnt(10) lgkmcnt(0)
  v_mfma_f32_16x16x32_bf16 v[112:115], v[204:207], a[44:47], v[112:115]
  ds_read_b128 v[176:179], v2 offset:20480
  v_mfma_f32_16x16x32_bf16 v[140:143], v[204:207], a[116:119], v[140:143]
  ds_read_b128 v[180:183], v2 offset:21504
  v_mfma_f32_16x16x32_bf16 v[116:119], v[208:211], a[44:47], v[116:119]
  ds_read_b128 v[184:187], v2 offset:22528
  v_mfma_f32_16x16x32_bf16 v[144:147], v[208:211], a[116:119], v[144:147]
  ds_read_b128 v[188:191], v2 offset:23552
  v_mfma_f32_16x16x32_bf16 v[120:123], v[212:215], a[44:47], v[120:123]
  ds_read_b128 v[192:195], v2 offset:24576
  v_mfma_f32_16x16x32_bf16 v[148:151], v[212:215], a[116:119], v[148:151]
  ds_read_b128 v[196:199], v2 offset:25600
  v_mfma_f32_16x16x32_bf16 v[124:127], v[216:219], a[44:47], v[124:127]
  ds_read_b128 v[200:203], v2 offset:26624
  v_mfma_f32_16x16x32_bf16 v[152:155], v[216:219], a[116:119], v[152:155]
  ds_read_b128 v[44:47], v3 offset:64512
  v_mfma_f32_16x16x32_bf16 v[128:131], v[220:223], a[44:47], v[128:131]
  ds_read_b128 v[48:51], v2 offset:3072
  v_mfma_f32_16x16x32_bf16 v[156:159], v[220:223], a[116:119], v[156:159]
  ds_read_b128 v[52:55], v19 offset:9216
  v_mfma_f32_16x16x32_bf16 v[132:135], v[224:227], a[44:47], v[132:135]
  buffer_load_dwordx4 a[60:63], v6, s[4:7], s51 offen offset:3072 sc1
  v_mfma_f32_16x16x32_bf16 v[160:163], v[224:227], a[116:119], v[160:163]
  buffer_load_dwordx4 a[132:135], v6, s[4:7], s56 offen offset:3072 sc1
  v_mfma_f32_16x16x32_bf16 v[136:139], v[228:231], a[44:47], v[136:139]
  buffer_load_dwordx4 a[188:191], v251, s[60:63], s50 offen offset:3072
  v_mfma_f32_16x16x32_bf16 v[164:167], v[228:231], a[116:119], v[164:167]
  v_mfma_f32_16x16x32_bf16 v[168:171], v[32:35], v[40:43], v[168:171]
  v_mfma_f32_16x16x32_bf16 v[172:175], v[36:39], v[40:43], v[172:175]
  s_waitcnt vmcnt(10) lgkmcnt(0)
  v_mfma_f32_16x16x32_bf16 v[112:115], v[176:179], a[48:51], v[112:115]
  ds_read_b128 v[204:207], v2 offset:27648
  v_mfma_f32_16x16x32_bf16 v[140:143], v[176:179], a[120:123], v[140:143]
  ds_read_b128 v[208:211], v2 offset:28672
  v_mfma_f32_16x16x32_bf16 v[116:119], v[180:183], a[48:51], v[116:119]
  ds_read_b128 v[212:215], v2 offset:29696
  v_mfma_f32_16x16x32_bf16 v[144:147], v[180:183], a[120:123], v[144:147]
  ds_read_b128 v[216:219], v2 offset:30720
  v_mfma_f32_16x16x32_bf16 v[120:123], v[184:187], a[48:51], v[120:123]
  ds_read_b128 v[220:223], v2 offset:31744
  v_mfma_f32_16x16x32_bf16 v[148:151], v[184:187], a[120:123], v[148:151]
  ds_read_b128 v[224:227], v2 offset:32768
  v_mfma_f32_16x16x32_bf16 v[124:127], v[188:191], a[48:51], v[124:127]
  ds_read_b128 v[228:231], v2 offset:33792
  v_mfma_f32_16x16x32_bf16 v[152:155], v[188:191], a[120:123], v[152:155]
  ds_read_b128 v[32:35], v4 offset:6144
  v_mfma_f32_16x16x32_bf16 v[128:131], v[192:195], a[48:51], v[128:131]
  ds_read_b128 v[36:39], v2 offset:10240
  v_mfma_f32_16x16x32_bf16 v[156:159], v[192:195], a[120:123], v[156:159]
  ds_read_b128 v[40:43], v19 offset:10240
  v_mfma_f32_16x16x32_bf16 v[132:135], v[196:199], a[48:51], v[132:135]
  buffer_load_dwordx4 a[64:67], v6, s[4:7], s52 offen sc1
  v_mfma_f32_16x16x32_bf16 v[160:163], v[196:199], a[120:123], v[160:163]
  buffer_load_dwordx4 a[136:139], v6, s[4:7], s57 offen sc1
  v_mfma_f32_16x16x32_bf16 v[136:139], v[200:203], a[48:51], v[136:139]
  buffer_load_dwordx4 a[192:195], v251, s[60:63], s51 offen
  v_mfma_f32_16x16x32_bf16 v[164:167], v[200:203], a[120:123], v[164:167]
  v_mfma_f32_16x16x32_bf16 v[168:171], v[44:47], v[52:55], v[168:171]
  v_mfma_f32_16x16x32_bf16 v[172:175], v[48:51], v[52:55], v[172:175]
  s_waitcnt vmcnt(10) lgkmcnt(0)
  v_mfma_f32_16x16x32_bf16 v[112:115], v[204:207], a[52:55], v[112:115]
  ds_read_b128 v[176:179], v2 offset:34816
  v_mfma_f32_16x16x32_bf16 v[140:143], v[204:207], a[124:127], v[140:143]
  ds_read_b128 v[180:183], v2 offset:35840
  v_mfma_f32_16x16x32_bf16 v[116:119], v[208:211], a[52:55], v[116:119]
  ds_read_b128 v[184:187], v2 offset:36864
  v_mfma_f32_16x16x32_bf16 v[144:147], v[208:211], a[124:127], v[144:147]
  ds_read_b128 v[188:191], v2 offset:37888
  v_mfma_f32_16x16x32_bf16 v[120:123], v[212:215], a[52:55], v[120:123]
  ds_read_b128 v[192:195], v2 offset:38912
  v_mfma_f32_16x16x32_bf16 v[148:151], v[212:215], a[124:127], v[148:151]
  ds_read_b128 v[196:199], v2 offset:39936
  v_mfma_f32_16x16x32_bf16 v[124:127], v[216:219], a[52:55], v[124:127]
  ds_read_b128 v[200:203], v2 offset:40960
  v_mfma_f32_16x16x32_bf16 v[152:155], v[216:219], a[124:127], v[152:155]
  ds_read_b128 v[44:47], v4 offset:13312
  v_mfma_f32_16x16x32_bf16 v[128:131], v[220:223], a[52:55], v[128:131]
  ds_read_b128 v[48:51], v2 offset:17408
  v_mfma_f32_16x16x32_bf16 v[156:159], v[220:223], a[124:127], v[156:159]
  ds_read_b128 v[52:55], v19 offset:11264
  v_mfma_f32_16x16x32_bf16 v[132:135], v[224:227], a[52:55], v[132:135]
  buffer_load_dwordx4 a[68:71], v6, s[4:7], s52 offen offset:1024 sc1
  v_mfma_f32_16x16x32_bf16 v[160:163], v[224:227], a[124:127], v[160:163]
  buffer_load_dwordx4 a[140:143], v6, s[4:7], s57 offen offset:1024 sc1
  v_mfma_f32_16x16x32_bf16 v[136:139], v[228:231], a[52:55], v[136:139]
  buffer_load_dwordx4 a[196:199], v251, s[60:63], s51 offen offset:1024
  v_mfma_f32_16x16x32_bf16 v[164:167], v[228:231], a[124:127], v[164:167]
  v_mfma_f32_16x16x32_bf16 v[168:171], v[32:35], v[40:43], v[168:171]
  v_mfma_f32_16x16x32_bf16 v[172:175], v[36:39], v[40:43], v[172:175]
  s_waitcnt vmcnt(10) lgkmcnt(0)
  v_mfma_f32_16x16x32_bf16 v[112:115], v[176:179], a[56:59], v[112:115]
  ds_read_b128 v[204:207], v2 offset:41984
  v_mfma_f32_16x16x32_bf16 v[140:143], v[176:179], a[128:131], v[140:143]
  ds_read_b128 v[208:211], v2 offset:43008
  v_mfma_f32_16x16x32_bf16 v[116:119], v[180:183], a[56:59], v[116:119]
  ds_read_b128 v[212:215], v2 offset:44032
  v_mfma_f32_16x16x32_bf16 v[144:147], v[180:183], a[128:131], v[144:147]
  ds_read_b128 v[216:219], v2 offset:45056
  v_mfma_f32_16x16x32_bf16 v[120:123], v[184:187], a[56:59], v[120:123]
  ds_read_b128 v[220:223], v2 offset:46080
  v_mfma_f32_16x16x32_bf16 v[148:151], v[184:187], a[128:131], v[148:151]
  ds_read_b128 v[224:227], v2 offset:47104
  v_mfma_f32_16x16x32_bf16 v[124:127], v[188:191], a[56:59], v[124:127]
  ds_read_b128 v[228:231], v2 offset:48128
  v_mfma_f32_16x16x32_bf16 v[152:155], v[188:191], a[128:131], v[152:155]
  ds_read_b128 v[32:35], v4 offset:20480
  v_mfma_f32_16x16x32_bf16 v[128:131], v[192:195], a[56:59], v[128:131]
  ds_read_b128 v[36:39], v2 offset:24576
  v_mfma_f32_16x16x32_bf16 v[156:159], v[192:195], a[128:131], v[156:159]
  ds_read_b128 v[40:43], v19 offset:12288
  v_mfma_f32_16x16x32_bf16 v[132:135], v[196:199], a[56:59], v[132:135]
  buffer_load_dword v10, v9, s[8:11], 0 offen offset:256 sc1
  v_mfma_f32_16x16x32_bf16 v[160:163], v[196:199], a[128:131], v[160:163]
  buffer_load_dword v8, v8, s[8:11], 0 offen sc1
  v_mfma_f32_16x16x32_bf16 v[136:139], v[200:203], a[56:59], v[136:139]
  buffer_load_dword v9, v9, s[8:11], 0 offen sc1
  v_mfma_f32_16x16x32_bf16 v[164:167], v[200:203], a[128:131], v[164:167]
  buffer_load_dwordx4 a[200:203], v251, s[60:63], s51 offen offset:2048
  v_mfma_f32_16x16x32_bf16 v[168:171], v[44:47], v[52:55], v[168:171]
  v_mfma_f32_16x16x32_bf16 v[172:175], v[48:51], v[52:55], v[172:175]
  s_waitcnt vmcnt(11) lgkmcnt(0)
  v_mfma_f32_16x16x32_bf16 v[112:115], v[204:207], a[60:63], v[112:115]
  ds_read_b128 v[176:179], v2 offset:49152
  v_mfma_f32_16x16x32_bf16 v[140:143], v[204:207], a[132:135], v[140:143]
  ds_read_b128 v[180:183], v2 offset:50176
  v_mfma_f32_16x16x32_bf16 v[116:119], v[208:211], a[60:63], v[116:119]
  ds_read_b128 v[184:187], v2 offset:51200
  v_mfma_f32_16x16x32_bf16 v[144:147], v[208:211], a[132:135], v[144:147]
  ds_read_b128 v[188:191], v2 offset:52224
  v_mfma_f32_16x16x32_bf16 v[120:123], v[212:215], a[60:63], v[120:123]
  ds_read_b128 v[192:195], v2 offset:53248
  v_mfma_f32_16x16x32_bf16 v[148:151], v[212:215], a[132:135], v[148:151]
  ds_read_b128 v[196:199], v2 offset:54272
  v_mfma_f32_16x16x32_bf16 v[124:127], v[216:219], a[60:63], v[124:127]
  ds_read_b128 v[200:203], v2 offset:55296
  v_mfma_f32_16x16x32_bf16 v[152:155], v[216:219], a[132:135], v[152:155]
  ds_read_b128 v[44:47], v4 offset:27648
  v_mfma_f32_16x16x32_bf16 v[128:131], v[220:223], a[60:63], v[128:131]
  ds_read_b128 v[48:51], v2 offset:31744
  v_mfma_f32_16x16x32_bf16 v[156:159], v[220:223], a[132:135], v[156:159]
  ds_read_b128 v[52:55], v19 offset:13312
  v_mfma_f32_16x16x32_bf16 v[132:135], v[224:227], a[60:63], v[132:135]
  buffer_load_dwordx4 a[0:3], v250, s[60:63], s48 offen
  v_mfma_f32_16x16x32_bf16 v[160:163], v[224:227], a[132:135], v[160:163]
  buffer_load_dwordx4 a[72:75], v250, s[60:63], s53 offen
  v_mfma_f32_16x16x32_bf16 v[136:139], v[228:231], a[60:63], v[136:139]
  buffer_load_dwordx4 a[204:207], v251, s[60:63], s51 offen offset:3072
  v_mfma_f32_16x16x32_bf16 v[164:167], v[228:231], a[132:135], v[164:167]
  v_mfma_f32_16x16x32_bf16 v[168:171], v[32:35], v[40:43], v[168:171]
  v_mfma_f32_16x16x32_bf16 v[172:175], v[36:39], v[40:43], v[172:175]
  s_waitcnt vmcnt(11) lgkmcnt(0)
  v_mfma_f32_16x16x32_bf16 v[112:115], v[176:179], a[64:67], v[112:115]
  ds_read_b128 v[204:207], v2 offset:56320
  v_mfma_f32_16x16x32_bf16 v[140:143], v[176:179], a[136:139], v[140:143]
  ds_read_b128 v[208:211], v2 offset:57344
  v_mfma_f32_16x16x32_bf16 v[116:119], v[180:183], a[64:67], v[116:119]
  ds_read_b128 v[212:215], v2 offset:58368
  v_mfma_f32_16x16x32_bf16 v[144:147], v[180:183], a[136:139], v[144:147]
  ds_read_b128 v[216:219], v2 offset:59392
  v_mfma_f32_16x16x32_bf16 v[120:123], v[184:187], a[64:67], v[120:123]
  ds_read_b128 v[220:223], v2 offset:60416
  v_mfma_f32_16x16x32_bf16 v[148:151], v[184:187], a[136:139], v[148:151]
  ds_read_b128 v[224:227], v2 offset:61440
  v_mfma_f32_16x16x32_bf16 v[124:127], v[188:191], a[64:67], v[124:127]
  ds_read_b128 v[228:231], v2 offset:62464
  v_mfma_f32_16x16x32_bf16 v[152:155], v[188:191], a[136:139], v[152:155]
  ds_read_b128 v[32:35], v4 offset:34816
  v_mfma_f32_16x16x32_bf16 v[128:131], v[192:195], a[64:67], v[128:131]
  ds_read_b128 v[36:39], v2 offset:38912
  v_mfma_f32_16x16x32_bf16 v[156:159], v[192:195], a[136:139], v[156:159]
  ds_read_b128 v[40:43], v19 offset:14336
  v_mfma_f32_16x16x32_bf16 v[132:135], v[196:199], a[64:67], v[132:135]
  buffer_load_dwordx4 a[4:7], v250, s[60:63], s48 offen offset:1024
  v_mfma_f32_16x16x32_bf16 v[160:163], v[196:199], a[136:139], v[160:163]
  buffer_load_dwordx4 a[76:79], v250, s[60:63], s53 offen offset:1024
  v_mfma_f32_16x16x32_bf16 v[136:139], v[200:203], a[64:67], v[136:139]
  buffer_load_dwordx4 a[208:211], v251, s[60:63], s52 offen
  v_mfma_f32_16x16x32_bf16 v[164:167], v[200:203], a[136:139], v[164:167]
  v_mfma_f32_16x16x32_bf16 v[168:171], v[44:47], v[52:55], v[168:171]
  v_mfma_f32_16x16x32_bf16 v[172:175], v[48:51], v[52:55], v[172:175]
  s_waitcnt vmcnt(11) lgkmcnt(0)
  v_mfma_f32_16x16x32_bf16 v[112:115], v[204:207], a[68:71], v[112:115]
  ds_read_b128 v[44:47], v4 offset:41984
  v_mfma_f32_16x16x32_bf16 v[140:143], v[204:207], a[140:143], v[140:143]
  ds_read_b128 v[48:51], v2 offset:46080
  v_mfma_f32_16x16x32_bf16 v[116:119], v[208:211], a[68:71], v[116:119]
  ds_read_b128 v[52:55], v19 offset:15360
  v_mfma_f32_16x16x32_bf16 v[144:147], v[208:211], a[140:143], v[144:147]
  buffer_load_dwordx4 a[8:11], v250, s[60:63], s48 offen offset:2048
  v_mfma_f32_16x16x32_bf16 v[120:123], v[212:215], a[68:71], v[120:123]
  buffer_load_dwordx4 a[80:83], v250, s[60:63], s53 offen offset:2048
  v_mfma_f32_16x16x32_bf16 v[148:151], v[212:215], a[140:143], v[148:151]
  buffer_load_dwordx4 a[212:215], v251, s[60:63], s52 offen offset:1024
  v_mfma_f32_16x16x32_bf16 v[124:127], v[216:219], a[68:71], v[124:127]
  v_mfma_f32_16x16x32_bf16 v[152:155], v[216:219], a[140:143], v[152:155]
  v_mfma_f32_16x16x32_bf16 v[128:131], v[220:223], a[68:71], v[128:131]
  v_mfma_f32_16x16x32_bf16 v[156:159], v[220:223], a[140:143], v[156:159]
  v_mfma_f32_16x16x32_bf16 v[132:135], v[224:227], a[68:71], v[132:135]
  v_mfma_f32_16x16x32_bf16 v[160:163], v[224:227], a[140:143], v[160:163]
  v_mfma_f32_16x16x32_bf16 v[136:139], v[228:231], a[68:71], v[136:139]
  v_mfma_f32_16x16x32_bf16 v[164:167], v[228:231], a[140:143], v[164:167]
  v_mfma_f32_16x16x32_bf16 v[168:171], v[32:35], v[40:43], v[168:171]
  v_mfma_f32_16x16x32_bf16 v[172:175], v[36:39], v[40:43], v[172:175]
  s_waitcnt lgkmcnt(0)
  v_mfma_f32_16x16x32_bf16 v[168:171], v[44:47], v[52:55], v[168:171]
  ds_read_b128 v[32:35], v4 offset:49152
  v_mfma_f32_16x16x32_bf16 v[172:175], v[48:51], v[52:55], v[172:175]
  ds_read_b128 v[36:39], v2 offset:53248
  ds_read_b128 v[40:43], v19 offset:16384
  s_waitcnt lgkmcnt(0)
  v_mfma_f32_16x16x32_bf16 v[168:171], v[32:35], v[40:43], v[168:171]
  ds_read_b128 v[44:47], v4 offset:56320
  v_mfma_f32_16x16x32_bf16 v[172:175], v[36:39], v[40:43], v[172:175]
  ds_read_b128 v[48:51], v2 offset:60416
  ds_read_b128 v[52:55], v19 offset:17408
  s_waitcnt lgkmcnt(0)
  v_mfma_f32_16x16x32_bf16 v[168:171], v[44:47], v[52:55], v[168:171]
  v_mfma_f32_16x16x32_bf16 v[172:175], v[48:51], v[52:55], v[172:175]
  s_barrier
  s_waitcnt vmcnt(10)
  v_mul_f32 v112, v112, v9
  v_mul_f32 v113, v113, v9
  v_mul_f32 v114, v114, v9
  v_mul_f32 v115, v115, v9
  v_cvt_pk_bf16_f32 v176, v112, v113
  v_cvt_pk_bf16_f32 v177, v114, v115
  ds_write_b64 v13, v[176:177]
  v_mul_f32 v140, v140, v10
  v_mul_f32 v141, v141, v10
  v_mul_f32 v142, v142, v10
  v_mul_f32 v143, v143, v10
  buffer_load_dwordx4 a[12:15], v250, s[60:63], s48 offen offset:3072
  v_cvt_pk_bf16_f32 v178, v140, v141
  v_cvt_pk_bf16_f32 v179, v142, v143
  ds_write_b64 v13, v[178:179] offset:3840
  v_mul_f32 v116, v116, v9
  v_mul_f32 v117, v117, v9
  v_mul_f32 v118, v118, v9
  v_mul_f32 v119, v119, v9
  v_cvt_pk_bf16_f32 v180, v116, v117
  v_cvt_pk_bf16_f32 v181, v118, v119
  ds_write_b64 v13, v[180:181] offset:32
  v_mul_f32 v144, v144, v10
  buffer_load_dwordx4 a[84:87], v250, s[60:63], s53 offen offset:3072
  v_mul_f32 v145, v145, v10
  v_mul_f32 v146, v146, v10
  v_mul_f32 v147, v147, v10
  v_cvt_pk_bf16_f32 v182, v144, v145
  v_cvt_pk_bf16_f32 v183, v146, v147
  ds_write_b64 v13, v[182:183] offset:3872
  v_mul_f32 v120, v120, v9
  v_mul_f32 v121, v121, v9
  v_mul_f32 v122, v122, v9
  v_mul_f32 v123, v123, v9
  v_cvt_pk_bf16_f32 v176, v120, v121
  buffer_load_dwordx4 a[16:19], v250, s[60:63], s49 offen
  v_cvt_pk_bf16_f32 v177, v122, v123
  ds_write_b64 v13, v[176:177] offset:64
  v_mul_f32 v148, v148, v10
  v_mul_f32 v149, v149, v10
  v_mul_f32 v150, v150, v10
  v_mul_f32 v151, v151, v10
  v_cvt_pk_bf16_f32 v178, v148, v149
  v_cvt_pk_bf16_f32 v179, v150, v151
  ds_write_b64 v13, v[178:179] offset:3904
  v_mul_f32 v124, v124, v9
  v_mul_f32 v125, v125, v9
  buffer_load_dwordx4 a[88:91], v250, s[60:63], s54 offen
  v_mul_f32 v126, v126, v9
  v_mul_f32 v127, v127, v9
  v_cvt_pk_bf16_f32 v180, v124, v125
  v_cvt_pk_bf16_f32 v181, v126, v127
  ds_write_b64 v13, v[180:181] offset:96
  v_mul_f32 v152, v152, v10
  v_mul_f32 v153, v153, v10
  v_mul_f32 v154, v154, v10
  v_mul_f32 v155, v155, v10
  v_cvt_pk_bf16_f32 v182, v152, v153
  v_cvt_pk_bf16_f32 v183, v154, v155
  buffer_load_dwordx4 a[20:23], v250, s[60:63], s49 offen offset:1024
  ds_write_b64 v13, v[182:183] offset:3936
  v_mul_f32 v128, v128, v9
  v_mul_f32 v129, v129, v9
  v_mul_f32 v130, v130, v9
  v_mul_f32 v131, v131, v9
  v_cvt_pk_bf16_f32 v176, v128, v129
  v_cvt_pk_bf16_f32 v177, v130, v131
  ds_write_b64 v13, v[176:177] offset:128
  v_mul_f32 v156, v156, v10
  v_mul_f32 v157, v157, v10
  v_mul_f32 v158, v158, v10
  buffer_load_dwordx4 a[92:95], v250, s[60:63], s54 offen offset:1024
  v_mul_f32 v159, v159, v10
  v_cvt_pk_bf16_f32 v178, v156, v157
  v_cvt_pk_bf16_f32 v179, v158, v159
  ds_write_b64 v13, v[178:179] offset:3968
  v_mul_f32 v132, v132, v9
  v_mul_f32 v133, v133, v9
  v_mul_f32 v134, v134, v9
  v_mul_f32 v135, v135, v9
  v_cvt_pk_bf16_f32 v180, v132, v133
  v_cvt_pk_bf16_f32 v181, v134, v135
  ds_write_b64 v13, v[180:181] offset:160
  buffer_load_dwordx4 a[24:27], v250, s[60:63], s49 offen offset:2048
  v_mul_f32 v160, v160, v10
  v_mul_f32 v161, v161, v10
  v_mul_f32 v162, v162, v10
  v_mul_f32 v163, v163, v10
  v_cvt_pk_bf16_f32 v182, v160, v161
  v_cvt_pk_bf16_f32 v183, v162, v163
  ds_write_b64 v13, v[182:183] offset:4000
  v_mul_f32 v136, v136, v9
  v_mul_f32 v137, v137, v9
  v_mul_f32 v138, v138, v9
  v_mul_f32 v139, v139, v9
  buffer_load_dwordx4 a[96:99], v250, s[60:63], s54 offen offset:2048
  v_cvt_pk_bf16_f32 v176, v136, v137
  v_cvt_pk_bf16_f32 v177, v138, v139
  ds_write_b64 v13, v[176:177] offset:192
  v_mul_f32 v164, v164, v10
  v_mul_f32 v165, v165, v10
  v_mul_f32 v166, v166, v10
  v_mul_f32 v167, v167, v10
  v_cvt_pk_bf16_f32 v178, v164, v165
  v_cvt_pk_bf16_f32 v179, v166, v167
  ds_write_b64 v13, v[178:179] offset:4032
  v_mul_f32 v168, v168, v8
  buffer_load_dwordx4 a[28:31], v250, s[60:63], s49 offen offset:3072
  v_mul_f32 v169, v169, v8
  v_mul_f32 v170, v170, v8
  v_mul_f32 v171, v171, v8
  v_cvt_pk_bf16_f32 v180, v168, v169
  v_cvt_pk_bf16_f32 v181, v170, v171
  ds_write_b64 v11, v[180:181]
  v_mul_f32 v172, v172, v8
  v_mul_f32 v173, v173, v8
  v_mul_f32 v174, v174, v8
  v_mul_f32 v175, v175, v8
  v_cvt_pk_bf16_f32 v182, v172, v173
  buffer_load_dwordx4 a[100:103], v250, s[60:63], s54 offen offset:3072
  v_cvt_pk_bf16_f32 v183, v174, v175
  ds_write_b64 v12, v[182:183]
  s_waitcnt lgkmcnt(0)
  s_barrier
  ds_read2_b32 v[196:197], v15 offset0:0 offset1:1
  ds_read2_b32 v[198:199], v15 offset0:2 offset1:3
  ds_read2_b32 v[200:201], v15 offset0:4 offset1:5
  ds_read2_b32 v[202:203], v15 offset0:6 offset1:7
  ds_read_b32 v204, v15 offset:32
  ds_read_b128 v[36:39], v14 offset:3360
  ds_read_b128 v[40:43], v14 offset:3376
  buffer_load_dwordx4 a[32:35], v250, s[60:63], s50 offen
  ds_read_b128 v[44:47], v14 offset:3392
  ds_read_b128 v[56:59], v14 offset:2880
  ds_read_b128 v[60:63], v14 offset:2896
  ds_read_b128 v[64:67], v14 offset:2912
  ds_read_b128 v[76:79], v14 offset:2400
  ds_read_b128 v[80:83], v14 offset:2416
  ds_read_b128 v[84:87], v14 offset:2432
  ds_read_b128 v[96:99], v14 offset:1920
  ds_read_b128 v[100:103], v14 offset:1936
  ds_read_b128 v[104:107], v14 offset:1952
  ds_read_b128 v[116:119], v14 offset:1440
  buffer_load_dwordx4 a[104:107], v250, s[60:63], s55 offen
  ds_read_b128 v[120:123], v14 offset:1456
  ds_read_b128 v[124:127], v14 offset:1472
  ds_read_b128 v[136:139], v14 offset:960
  ds_read_b128 v[140:143], v14 offset:976
  ds_read_b128 v[144:147], v14 offset:992
  ds_read_b128 v[156:159], v14 offset:480
  ds_read_b128 v[160:163], v14 offset:496
  ds_read_b128 v[164:167], v14 offset:512
  ds_read_b128 v[176:179], v14
  ds_read_b128 v[180:183], v14 offset:16
  ds_read_b128 v[184:187], v14 offset:32
  buffer_load_dwordx4 a[36:39], v250, s[60:63], s50 offen offset:1024
  s_waitcnt lgkmcnt(15)
  v_dot2_f32_bf16 v208, v196, v36, 0
  v_dot2_f32_bf16 v209, v196, v56, 0
  v_dot2_f32_bf16 v210, v196, v76, 0
  s_waitcnt lgkmcnt(14)
  v_dot2_f32_bf16 v211, v196, v96, 0
  ds_read_b128 v[48:51], v14 offset:3408
  ds_read_b64 v[52:53], v14 offset:3424
  v_dot2_f32_bf16 v208, v197, v37, v208
  v_dot2_f32_bf16 v209, v197, v57, v209
  v_dot2_f32_bf16 v210, v197, v77, v210
  v_dot2_f32_bf16 v211, v197, v97, v211
  ds_read_b128 v[68:71], v14 offset:2928
  buffer_load_dwordx4 a[108:111], v250, s[60:63], s55 offen offset:1024
  ds_read_b64 v[72:73], v14 offset:2944
  v_dot2_f32_bf16 v208, v198, v38, v208
  v_dot2_f32_bf16 v209, v198, v58, v209
  v_dot2_f32_bf16 v210, v198, v78, v210
  v_dot2_f32_bf16 v211, v198, v98, v211
  ds_read_b128 v[88:91], v14 offset:2448
  ds_read_b64 v[92:93], v14 offset:2464
  v_dot2_f32_bf16 v208, v199, v39, v208
  v_dot2_f32_bf16 v209, v199, v59, v209
  v_dot2_f32_bf16 v210, v199, v79, v210
  v_dot2_f32_bf16 v211, v199, v99, v211
  buffer_load_dwordx4 a[40:43], v250, s[60:63], s50 offen offset:2048
  ds_read_b128 v[108:111], v14 offset:1968
  ds_read_b64 v[112:113], v14 offset:1984
  v_dot2_f32_bf16 v208, v200, v40, v208
  v_dot2_f32_bf16 v209, v200, v60, v209
  v_dot2_f32_bf16 v210, v200, v80, v210
  s_waitcnt lgkmcnt(15)
  v_dot2_f32_bf16 v211, v200, v100, v211
  ds_read_b128 v[128:131], v14 offset:1488
  ds_read_b64 v[132:133], v14 offset:1504
  v_dot2_f32_bf16 v208, v201, v41, v208
  v_dot2_f32_bf16 v209, v201, v61, v209
  v_dot2_f32_bf16 v210, v201, v81, v210
  buffer_load_dwordx4 a[112:115], v250, s[60:63], s55 offen offset:2048
  v_dot2_f32_bf16 v211, v201, v101, v211
  ds_read_b128 v[148:151], v14 offset:1008
  ds_read_b64 v[152:153], v14 offset:1024
  v_dot2_f32_bf16 v208, v202, v42, v208
  v_dot2_f32_bf16 v209, v202, v62, v209
  v_dot2_f32_bf16 v210, v202, v82, v210
  v_dot2_f32_bf16 v211, v202, v102, v211
  ds_read_b128 v[168:171], v14 offset:528
  ds_read_b64 v[172:173], v14 offset:544
  v_dot2_f32_bf16 v208, v203, v43, v208
  v_dot2_f32_bf16 v209, v203, v63, v209
  buffer_load_dwordx4 a[44:47], v250, s[60:63], s50 offen offset:3072
  v_dot2_f32_bf16 v210, v203, v83, v210
  v_dot2_f32_bf16 v211, v203, v103, v211
  ds_read_b128 v[188:191], v14 offset:48
  ds_read_b64 v[192:193], v14 offset:64
  v_dot2_f32_bf16 v208, v204, v44, v208
  v_dot2_f32_bf16 v209, v204, v64, v209
  v_dot2_f32_bf16 v210, v204, v84, v210
  v_dot2_f32_bf16 v211, v204, v104, v211
  v_dot2_f32_bf16 v212, v196, v116, 0
  v_dot2_f32_bf16 v213, v196, v136, 0
  s_waitcnt lgkmcnt(15)
  v_dot2_f32_bf16 v214, v196, v156, 0
  buffer_load_dwordx4 a[116:119], v250, s[60:63], s55 offen offset:3072
  v_dot2_f32_bf16 v215, v196, v176, 0
  v_dot2_f32_bf16 v212, v197, v117, v212
  v_dot2_f32_bf16 v213, v197, v137, v213
  v_dot2_f32_bf16 v214, v197, v157, v214
  v_dot2_f32_bf16 v215, v197, v177, v215
  v_dot2_f32_bf16 v212, v198, v118, v212
  v_dot2_f32_bf16 v213, v198, v138, v213
  v_dot2_f32_bf16 v214, v198, v158, v214
  v_dot2_f32_bf16 v215, v198, v178, v215
  v_dot2_f32_bf16 v212, v199, v119, v212
  v_dot2_f32_bf16 v213, v199, v139, v213
  buffer_load_dwordx4 a[48:51], v250, s[60:63], s51 offen
  v_dot2_f32_bf16 v214, v199, v159, v214
  v_dot2_f32_bf16 v215, v199, v179, v215
  v_dot2_f32_bf16 v212, v200, v120, v212
  v_dot2_f32_bf16 v213, v200, v140, v213
  v_dot2_f32_bf16 v214, v200, v160, v214
  v_dot2_f32_bf16 v215, v200, v180, v215
  v_dot2_f32_bf16 v212, v201, v121, v212
  v_dot2_f32_bf16 v213, v201, v141, v213
  v_dot2_f32_bf16 v214, v201, v161, v214
  v_dot2_f32_bf16 v215, v201, v181, v215
  v_dot2_f32_bf16 v212, v202, v122, v212
  buffer_load_dwordx4 a[120:123], v250, s[60:63], s56 offen
  v_dot2_f32_bf16 v213, v202, v142, v213
  v_dot2_f32_bf16 v214, v202, v162, v214
  v_dot2_f32_bf16 v215, v202, v182, v215
  v_dot2_f32_bf16 v212, v203, v123, v212
  v_dot2_f32_bf16 v213, v203, v143, v213
  v_dot2_f32_bf16 v214, v203, v163, v214
  v_dot2_f32_bf16 v215, v203, v183, v215
  v_dot2_f32_bf16 v212, v204, v124, v212
  v_dot2_f32_bf16 v213, v204, v144, v213
  v_dot2_f32_bf16 v214, v204, v164, v214
  v_dot2_f32_bf16 v215, v204, v184, v215
  buffer_load_dwordx4 a[52:55], v250, s[60:63], s51 offen offset:1024
  v_mul_f32 v208, 0x3eae1a93, v208
  v_mul_f32 v209, 0x3eae1a93, v209
  v_mul_f32 v210, 0x3eae1a93, v210
  v_mul_f32 v211, 0x3eae1a93, v211
  v_mul_f32 v212, 0x3eae1a93, v212
  v_mul_f32 v213, 0x3eae1a93, v213
  v_mul_f32 v214, 0x3eae1a93, v214
  v_mul_f32 v215, 0x3eae1a93, v215
  v_cndmask_b32 v209, v18, v209, s[64:65]
  v_cndmask_b32 v210, v18, v210, s[66:67]
  v_cndmask_b32 v211, v18, v211, s[68:69]
  buffer_load_dwordx4 a[124:127], v250, s[60:63], s56 offen offset:1024
  v_cndmask_b32 v212, v18, v212, s[70:71]
  v_cndmask_b32 v213, v18, v213, s[72:73]
  v_cndmask_b32 v214, v18, v214, s[74:75]
  v_cndmask_b32 v215, v18, v215, s[76:77]
  v_max3_f32 v246, v208, v209, v210
  v_max3_f32 v247, v211, v212, v213
  v_max3_f32 v246, v246, v214, v215
  v_max_f32 v246, v246, v247
  v_sub_f32 v208, v208, v246
  v_sub_f32 v209, v209, v246
  v_sub_f32 v210, v210, v246
  buffer_load_dwordx4 a[56:59], v250, s[60:63], s51 offen offset:2048
  v_sub_f32 v211, v211, v246
  v_sub_f32 v212, v212, v246
  v_sub_f32 v213, v213, v246
  v_sub_f32 v214, v214, v246
  v_sub_f32 v215, v215, v246
  v_exp_f32 v208, v208
  v_exp_f32 v209, v209
  v_exp_f32 v210, v210
  v_exp_f32 v211, v211
  v_exp_f32 v212, v212
  v_exp_f32 v213, v213
  buffer_load_dwordx4 a[128:131], v250, s[60:63], s56 offen offset:2048
  v_exp_f32 v214, v214
  v_exp_f32 v215, v215
  v_cvt_pk_bf16_f32 v216, v208, v209
  v_cvt_pk_bf16_f32 v217, v210, v211
  v_cvt_pk_bf16_f32 v218, v212, v213
  v_cvt_pk_bf16_f32 v219, v214, v215
  v_dot2_f32_bf16 v248, v216, s34, 0
  v_dot2_f32_bf16 v248, v217, s34, v248
  v_dot2_f32_bf16 v248, v218, s34, v248
  v_dot2_f32_bf16 v248, v219, s34, v248
  v_perm_b32 v238, v65, v45, s32
  buffer_load_dwordx4 a[60:63], v250, s[60:63], s51 offen offset:3072
  v_perm_b32 v239, v65, v45, s33
  v_perm_b32 v240, v66, v46, s32
  v_perm_b32 v241, v66, v46, s33
  v_dot2_f32_bf16 v220, v216, v238, 0
  v_dot2_f32_bf16 v221, v216, v239, 0
  v_perm_b32 v242, v67, v47, s32
  v_perm_b32 v243, v67, v47, s33
  v_dot2_f32_bf16 v222, v216, v240, 0
  v_dot2_f32_bf16 v223, v216, v241, 0
  s_waitcnt lgkmcnt(13)
  v_perm_b32 v244, v68, v48, s32
  v_perm_b32 v245, v68, v48, s33
  buffer_load_dwordx4 a[132:135], v250, s[60:63], s56 offen offset:3072
  v_dot2_f32_bf16 v224, v216, v242, 0
  v_dot2_f32_bf16 v225, v216, v243, 0
  v_perm_b32 v238, v69, v49, s32
  v_perm_b32 v239, v69, v49, s33
  v_dot2_f32_bf16 v226, v216, v244, 0
  v_dot2_f32_bf16 v227, v216, v245, 0
  v_perm_b32 v240, v70, v50, s32
  v_perm_b32 v241, v70, v50, s33
  v_dot2_f32_bf16 v228, v216, v238, 0
  v_dot2_f32_bf16 v229, v216, v239, 0
  v_perm_b32 v242, v71, v51, s32
  buffer_load_dwordx4 a[64:67], v250, s[60:63], s52 offen
  v_perm_b32 v243, v71, v51, s33
  v_dot2_f32_bf16 v230, v216, v240, 0
  v_dot2_f32_bf16 v231, v216, v241, 0
  s_waitcnt lgkmcnt(12)
  v_perm_b32 v244, v72, v52, s32
  v_perm_b32 v245, v72, v52, s33
  v_dot2_f32_bf16 v232, v216, v242, 0
  v_dot2_f32_bf16 v233, v216, v243, 0
  v_perm_b32 v238, v73, v53, s32
  v_perm_b32 v239, v73, v53, s33
  v_dot2_f32_bf16 v234, v216, v244, 0
  v_dot2_f32_bf16 v235, v216, v245, 0
  buffer_load_dwordx4 a[136:139], v250, s[60:63], s57 offen
  v_perm_b32 v240, v105, v85, s32
  v_perm_b32 v241, v105, v85, s33
  v_dot2_f32_bf16 v236, v216, v238, 0
  v_dot2_f32_bf16 v237, v216, v239, 0
  v_rcp_f32 v248, v248
  v_perm_b32 v242, v106, v86, s32
  v_perm_b32 v243, v106, v86, s33
  v_dot2_f32_bf16 v220, v217, v240, v220
  v_dot2_f32_bf16 v221, v217, v241, v221
  v_perm_b32 v244, v107, v87, s32
  v_perm_b32 v245, v107, v87, s33
  buffer_load_dwordx4 a[68:71], v250, s[60:63], s52 offen offset:1024
  v_dot2_f32_bf16 v222, v217, v242, v222
  v_dot2_f32_bf16 v223, v217, v243, v223
  s_waitcnt lgkmcnt(9)
  v_perm_b32 v238, v108, v88, s32
  v_perm_b32 v239, v108, v88, s33
  v_dot2_f32_bf16 v224, v217, v244, v224
  v_dot2_f32_bf16 v225, v217, v245, v225
  v_perm_b32 v240, v109, v89, s32
  v_perm_b32 v241, v109, v89, s33
  v_dot2_f32_bf16 v226, v217, v238, v226
  v_dot2_f32_bf16 v227, v217, v239, v227
  v_perm_b32 v242, v110, v90, s32
  buffer_load_dwordx4 a[140:143], v250, s[60:63], s57 offen offset:1024
  v_perm_b32 v243, v110, v90, s33
  v_dot2_f32_bf16 v228, v217, v240, v228
  v_dot2_f32_bf16 v229, v217, v241, v229
  v_perm_b32 v244, v111, v91, s32
  v_perm_b32 v245, v111, v91, s33
  v_dot2_f32_bf16 v230, v217, v242, v230
  v_dot2_f32_bf16 v231, v217, v243, v231
  s_waitcnt lgkmcnt(8)
  v_perm_b32 v238, v112, v92, s32
  v_perm_b32 v239, v112, v92, s33
  v_dot2_f32_bf16 v232, v217, v244, v232
  v_dot2_f32_bf16 v233, v217, v245, v233
  v_perm_b32 v240, v113, v93, s32
  v_perm_b32 v241, v113, v93, s33
  v_dot2_f32_bf16 v234, v217, v238, v234
  v_dot2_f32_bf16 v235, v217, v239, v235
  v_perm_b32 v242, v145, v125, s32
  v_perm_b32 v243, v145, v125, s33
  v_dot2_f32_bf16 v236, v217, v240, v236
  v_dot2_f32_bf16 v237, v217, v241, v237
  v_perm_b32 v244, v146, v126, s32
  v_perm_b32 v245, v146, v126, s33
  v_dot2_f32_bf16 v220, v218, v242, v220
  v_dot2_f32_bf16 v221, v218, v243, v221
  v_perm_b32 v238, v147, v127, s32
  v_perm_b32 v239, v147, v127, s33
  v_dot2_f32_bf16 v222, v218, v244, v222
  v_dot2_f32_bf16 v223, v218, v245, v223
  s_waitcnt lgkmcnt(5)
  v_perm_b32 v240, v148, v128, s32
  v_perm_b32 v241, v148, v128, s33
  v_dot2_f32_bf16 v224, v218, v238, v224
  v_dot2_f32_bf16 v225, v218, v239, v225
  v_perm_b32 v242, v149, v129, s32
  v_perm_b32 v243, v149, v129, s33
  v_dot2_f32_bf16 v226, v218, v240, v226
  v_dot2_f32_bf16 v227, v218, v241, v227
  v_perm_b32 v244, v150, v130, s32
  v_perm_b32 v245, v150, v130, s33
  v_dot2_f32_bf16 v228, v218, v242, v228
  v_dot2_f32_bf16 v229, v218, v243, v229
  v_perm_b32 v238, v151, v131, s32
  v_perm_b32 v239, v151, v131, s33
  v_dot2_f32_bf16 v230, v218, v244, v230
  v_dot2_f32_bf16 v231, v218, v245, v231
  s_waitcnt lgkmcnt(4)
  v_perm_b32 v240, v152, v132, s32
  v_perm_b32 v241, v152, v132, s33
  v_dot2_f32_bf16 v232, v218, v238, v232
  v_dot2_f32_bf16 v233, v218, v239, v233
  v_perm_b32 v242, v153, v133, s32
  v_perm_b32 v243, v153, v133, s33
  v_dot2_f32_bf16 v234, v218, v240, v234
  v_dot2_f32_bf16 v235, v218, v241, v235
  v_perm_b32 v244, v185, v165, s32
  v_perm_b32 v245, v185, v165, s33
  v_dot2_f32_bf16 v236, v218, v242, v236
  v_dot2_f32_bf16 v237, v218, v243, v237
  v_perm_b32 v238, v186, v166, s32
  v_perm_b32 v239, v186, v166, s33
  v_dot2_f32_bf16 v220, v219, v244, v220
  v_dot2_f32_bf16 v221, v219, v245, v221
  v_perm_b32 v240, v187, v167, s32
  v_perm_b32 v241, v187, v167, s33
  v_dot2_f32_bf16 v222, v219, v238, v222
  v_dot2_f32_bf16 v223, v219, v239, v223
  s_waitcnt lgkmcnt(1)
  v_perm_b32 v242, v188, v168, s32
  v_perm_b32 v243, v188, v168, s33
  v_dot2_f32_bf16 v224, v219, v240, v224
  v_dot2_f32_bf16 v225, v219, v241, v225
  v_perm_b32 v244, v189, v169, s32
  v_perm_b32 v245, v189, v169, s33
  v_dot2_f32_bf16 v226, v219, v242, v226
  v_dot2_f32_bf16 v227, v219, v243, v227
  v_perm_b32 v238, v190, v170, s32
  v_perm_b32 v239, v190, v170, s33
  v_dot2_f32_bf16 v228, v219, v244, v228
  v_dot2_f32_bf16 v229, v219, v245, v229
  v_perm_b32 v240, v191, v171, s32
  v_perm_b32 v241, v191, v171, s33
  v_dot2_f32_bf16 v230, v219, v238, v230
  v_dot2_f32_bf16 v231, v219, v239, v231
  s_waitcnt lgkmcnt(0)
  v_perm_b32 v242, v192, v172, s32
  v_perm_b32 v243, v192, v172, s33
  v_dot2_f32_bf16 v232, v219, v240, v232
  v_dot2_f32_bf16 v233, v219, v241, v233
  v_perm_b32 v244, v193, v173, s32
  v_perm_b32 v245, v193, v173, s33
  v_dot2_f32_bf16 v234, v219, v242, v234
  v_dot2_f32_bf16 v235, v219, v243, v235
  v_dot2_f32_bf16 v236, v219, v244, v236
  v_dot2_f32_bf16 v237, v219, v245, v237
  v_mul_f32 v220, v220, v248
  v_mul_f32 v221, v221, v248
  v_mul_f32 v222, v222, v248
  v_mul_f32 v223, v223, v248
  v_mul_f32 v224, v224, v248
  v_mul_f32 v225, v225, v248
  v_mul_f32 v226, v226, v248
  v_mul_f32 v227, v227, v248
  v_mul_f32 v228, v228, v248
  v_mul_f32 v229, v229, v248
  v_mul_f32 v230, v230, v248
  v_mul_f32 v231, v231, v248
  v_mul_f32 v232, v232, v248
  v_mul_f32 v233, v233, v248
  v_mul_f32 v234, v234, v248
  v_mul_f32 v235, v235, v248
  v_mul_f32 v236, v236, v248
  v_mul_f32 v237, v237, v248
  v_cvt_pk_bf16_f32 v196, v220, v221
  v_cvt_pk_bf16_f32 v197, v222, v223
  v_cvt_pk_bf16_f32 v198, v224, v225
  v_cvt_pk_bf16_f32 v199, v226, v227
  v_cvt_pk_bf16_f32 v200, v228, v229
  v_cvt_pk_bf16_f32 v201, v230, v231
  v_cvt_pk_bf16_f32 v202, v232, v233
  v_cvt_pk_bf16_f32 v203, v234, v235
  v_cvt_pk_bf16_f32 v204, v236, v237
  buffer_store_dwordx4 v[196:199], v16, s[12:15], 0 offen sc1
  buffer_store_dwordx4 v[200:203], v16, s[12:15], 0 offen offset:256 sc1
  buffer_store_dword v204, v17, s[12:15], 0 offen sc1
  s_waitcnt vmcnt(0)
  s_barrier
  s_mov_b32 s36, 32768
  v_mov_b32 v26, 1
  buffer_store_dword v26, v29, s[96:99], s36 offen sc1
  v_and_b32 v170, 63, v0
  v_and_b32 v171, 15, v170
  v_lshlrev_b32 v160, 4, v170
  v_mov_b32 v175, 0x7ffffff0
  s_lshl_b32 s35, s93, 2
  s_lshr_b32 s36, s94, 2
  s_add_u32 s35, s35, s36
  s_and_b32 s40, s94, 3
  s_mul_i32 s3, s92, 9216
  s_and_b32 s34, s92, 1
  s_mul_i32 s39, s35, 36864
  s_add_u32 s36, s39, s3
  v_add_u32 v162, s36, v160
  s_add_u32 s64, s90, 4718592
  s_addc_u32 s65, s91, 0
  s_and_b32 s65, s65, 0xffff
  s_mov_b32 s66, 2359296
  s_mov_b32 s67, 0x20000
  s_mov_b32 s36, 32768
  buffer_load_dword v31, v30, s[96:99], s36 offen sc1
  s_waitcnt vmcnt(0)
  v_cmp_eq_u32 vcc, 0, v31
  s_cbranch_vccnz L_sp_5
L_bk_6:
  s_add_u32 m0, s3, 0
  s_nop 0
  buffer_load_dwordx4 v162, s[64:67], s48 offen sc1 lds
  buffer_load_dwordx4 v162, s[64:67], s48 offen offset:1024 sc1 lds
  buffer_load_dwordx4 v162, s[64:67], s48 offen offset:2048 sc1 lds
  buffer_load_dwordx4 v162, s[64:67], s48 offen offset:3072 sc1 lds
  s_add_u32 m0, s3, 4096
  s_nop 0
  buffer_load_dwordx4 v162, s[64:67], s49 offen sc1 lds
  buffer_load_dwordx4 v162, s[64:67], s49 offen offset:1024 sc1 lds
  buffer_load_dwordx4 v162, s[64:67], s49 offen offset:2048 sc1 lds
  buffer_load_dwordx4 v162, s[64:67], s49 offen offset:3072 sc1 lds
  s_add_u32 m0, s3, 8192
  s_nop 0
  buffer_load_dwordx4 v162, s[64:67], s50 offen sc1 lds
  s_mul_i32 s36, s40, 9
  s_and_b32 s37, s40, 1
  s_add_u32 s32, s36, s37
  s_xor_b32 s37, s37, 1
  s_lshl_b32 s37, s37, 3
  s_add_u32 s33, s36, s37
  s_lshl_b32 s36, s92, 1
  s_add_u32 s32, s32, s36
  s_cmp_lt_u32 s92, 2
  s_cselect_b32 s38, 0, 0x7ffffff0
  s_lshl_b32 s36, s32, 9
  s_add_u32 s36, s36, s39
  v_add_u32 v163, s36, v160
  s_lshr_b32 s36, s33, 1
  s_lshl_b32 s36, s36, 10
  s_and_b32 s37, s33, 1
  s_lshl_b32 s37, s37, 3
  s_add_u32 s36, s36, s37
  s_mul_i32 s37, s34, 18432
  v_add_u32 v161, s37, v160
  s_add_u32 s36, s36, s39
  v_add_u32 v164, s36, v161
  v_or_b32 v164, s38, v164
  s_lshl_b32 s36, s33, 9
  s_add_u32 s36, s36, s39
  s_add_u32 s36, s36, s37
  v_lshl_add_u32 v180, v170, 3, s36
  v_or_b32 v180, s38, v180
  v_lshrrev_b32 v173, 4, v170
  v_lshlrev_b32 v173, 8, v173
  v_lshl_add_u32 v181, v171, 2, v173
  v_add_u32 v181, 16384, v181
  v_add_u32 v182, s37, v181
  s_add_u32 s68, s90, 0
  s_addc_u32 s69, s91, 0
  s_and_b32 s69, s69, 0xffff
  s_mov_b32 s70, 2359296
  s_mov_b32 s71, 0x20000
  buffer_load_dwordx4 v[84:87], v163, s[68:71], 0 offen sc1
  buffer_load_dwordx4 v[88:91], v163, s[68:71], s53 offen sc1
  buffer_load_dwordx2 v[92:93], v164, s[68:71], 0 offen sc1
  s_add_u32 s72, s90, 2359296
  s_addc_u32 s73, s91, 0
  s_and_b32 s73, s73, 0xffff
  s_mov_b32 s74, 2359296
  s_mov_b32 s75, 0x20000
  s_add_u32 s60, s90, 7118848
  s_addc_u32 s61, s91, 0
  s_and_b32 s61, s61, 0xffff
  s_mov_b32 s62, 131072
  s_mov_b32 s63, 0x20000
  s_add_u32 s44, s90, 7110656
  s_addc_u32 s45, s91, 0
  s_and_b32 s45, s45, 0xffff
  s_mov_b32 s46, 8192
  s_mov_b32 s47, 0x20000
  v_lshlrev_b32 v173, 2, v171
  v_add_u32 v166, 36864, v173
  s_lshl_b32 s36, s34, 6
  v_add_u32 v167, s36, v166
  v_lshlrev_b32 v174, 2, v0
  v_add_u32 v174, 36992, v174
  v_and_b32 v173, 176, v0
  v_cmp_eq_u32 vcc, 128, v173
  s_nop 1
  v_cndmask_b32 v165, v174, v167, vcc
  v_lshrrev_b32 v173, 5, v170
  v_lshl_add_u32 v173, v173, 4, v171
  v_lshlrev_b32 v173, 2, v173
  s_lshl_b32 s36, s35, 7
  v_add_u32 v173, s36, v173
  s_lshl_b32 s37, s40, 2
  s_add_u32 s37, s37, s92
  s_lshl_b32 s38, s37, 13
  v_add_u32 v174, s38, v173
  v_and_b32 v169, 16, v170
  v_cmp_eq_u32 vcc, 0, v169
  s_nop 1
  v_cndmask_b32 v169, v175, v174, vcc
  v_cndmask_b32 v168, v175, v173, vcc
  s_cmp_eq_u32 s37, 0
  s_cselect_b32 s37, 0, 0x7ffffff0
  v_or_b32 v168, s37, v168
  v_cmp_gt_u32 s[78:79], 32, v170
  s_cmp_eq_u32 s92, 0
  s_cselect_b32 s58, 1.0, 0
  s_cmp_eq_u32 s92, 1
  s_cselect_b32 s59, 1.0, 0
  v_and_b32 v1, 63, v0
  v_and_b32 v2, 15, v1
  v_lshrrev_b32 v3, 4, v1
  v_lshlrev_b32 v24, 4, v1
  s_lshl_b32 s33, s92, 10
  s_and_b32 s41, s92, 1
  s_lshr_b32 s42, s92, 1
  s_and_b32 s43, s94, 1
  v_lshrrev_b32 v4, 2, v2
  v_lshl_add_u32 v4, v3, 2, v4
  v_and_b32 v5, 3, v2
  v_lshlrev_b32 v5, 3, v5
  v_lshrrev_b32 v6, 1, v4
  v_and_b32 v6, 3, v6
  s_lshl_b32 s36, s41, 1
  s_add_u32 s37, s36, 0
  v_xor_b32 v8, s37, v6
  v_lshlrev_b32 v8, 5, v8
  v_lshl_add_u32 v8, v4, 7, v8
  v_add_u32 v8, v8, v5
  v_add_u32 v9, 65536, v8
  v_add_u32 v10, 131072, v8
  s_add_u32 s37, s36, 1
  v_xor_b32 v11, s37, v6
  v_lshlrev_b32 v11, 5, v11
  v_lshl_add_u32 v11, v4, 7, v11
  v_add_u32 v11, v11, v5
  v_add_u32 v12, 65536, v11
  v_add_u32 v13, 131072, v11
  v_and_b32 v6, 1, v3
  v_xor_b32 v6, s41, v6
  v_lshlrev_b32 v6, 5, v6
  v_lshl_add_u32 v14, v4, 6, v6
  v_add_u32 v14, v14, v5
  v_add_u32 v15, 65536, v14
  v_add_u32 v25, 131072, v14
  s_lshl_b32 s36, s42, 11
  v_add_u32 v26, s36, v24
  v_add_u32 v27, 65536, v26
  v_add_u32 v28, 131072, v26
  s_mul_i32 s36, s42, 36864
  s_add_u32 s36, s36, 90112
  v_add_u32 v16, s36, v24
  s_lshl_b32 s37, s41, 12
  v_add_u32 v17, s37, v16
  s_lshl_b32 s37, s41, 3
  v_add_u32 v18, s37, v16
  v_bfe_u32 v4, v1, 1, 2
  v_xor_b32 v4, v4, v3
  v_lshlrev_b32 v4, 5, v4
  v_and_b32 v5, 1, v1
  v_lshl_add_u32 v4, v5, 4, v4
  v_lshrrev_b32 v5, 3, v1
  s_lshl_b32 s36, s92, 3
  v_add_u32 v5, s36, v5
  s_mul_i32 s36, s94, 576
  s_lshl_b32 s37, s43, 6
  s_add_u32 s37, s36, s37
  v_mul_u32_u24 v6, 9216, v5
  v_add3_u32 v19, v6, v4, s37
  v_mul_u32_u24 v6, 1152, v5
  v_add_u32 v21, v6, v4
  v_lshlrev_b32 v6, 3, v1
  s_lshl_b32 s37, s42, 11
  v_add_u32 v22, s37, v6
  v_bfe_u32 v4, v1, 1, 1
  v_and_b32 v5, 1, v3
  v_xor_b32 v4, v4, v5
  v_lshlrev_b32 v4, 5, v4
  v_and_b32 v5, 1, v1
  v_lshl_add_u32 v4, v5, 4, v4
  v_lshrrev_b32 v5, 2, v1
  s_lshl_b32 s37, s41, 4
  v_add_u32 v5, s37, v5
  v_mul_u32_u24 v5, 9216, v5
  s_xor_b32 s38, s43, 1
  s_lshl_b32 s38, s38, 9
  s_add_u32 s38, s38, s36
  v_add3_u32 v20, v5, v4, s38
  s_lshl_b32 s37, s93, 1
  s_add_u32 s37, s37, s42
  s_lshl_b32 s37, s37, 2
  s_add_u32 s37, s37, s41
  s_mul_i32 s37, s37, 18432
  v_add_u32 v23, s37, v24
  s_mov_b32 s4, s80
  s_and_b32 s5, s81, 0xffff
  s_mov_b32 s6, 5308416
  s_mov_b32 s7, 0x20000
  s_mov_b32 s8, s82
  s_and_b32 s9, s83, 0xffff
  s_mov_b32 s10, 5308416
  s_mov_b32 s11, 0x20000
  s_mov_b32 s12, s84
  s_and_b32 s13, s85, 0xffff
  s_mov_b32 s14, 5308416
  s_mov_b32 s15, 0x20000
  s_cmp_eq_u32 s42, 0
  s_cselect_b32 s24, s80, s82
  s_cselect_b32 s25, s5, s9
  s_mov_b32 s26, 5308416
  s_mov_b32 s27, 0x20000
  s_add_u32 s16, s90, 2359296
  s_addc_u32 s17, s91, 0
  s_and_b32 s17, s17, 0xffff
  s_mov_b32 s18, 2359296
  s_mov_b32 s19, 0x20000
  s_lshr_b32 s36, s94, 1
  s_mul_i32 s36, s36, 2359296
  s_lshl_b32 s37, s93, 1
  s_add_u32 s37, s37, s42
  s_mul_i32 s37, s37, 73728
  s_add_u32 s36, s36, s37
  s_add_u32 s36, s36, 26648576
  s_add_u32 s20, s90, s36
  s_addc_u32 s21, s91, 0
  s_and_b32 s21, s21, 0xffff
  s_mov_b32 s22, 73728
  s_mov_b32 s23, 0x20000
  s_lshl_b32 s36, s93, 4
  s_add_u32 s36, s36, s94
  s_lshl_b32 s36, s36, 1
  s_add_u32 s36, s36, s42
  s_mul_i32 s36, s36, 36864
  s_add_u32 s36, s36, 7774208
  s_add_u32 s28, s90, s36
  s_addc_u32 s29, s91, 0
  s_and_b32 s29, s29, 0xffff
  s_mov_b32 s30, 36864
  s_mov_b32 s31, 0x20000
  s_waitcnt vmcnt(3)
  s_barrier
  ds_read_b128 v[96:99], v160
  ds_read_b128 v[100:103], v160 offset:18432
  ds_read_b128 v[104:107], v161
  ds_read_b128 v[108:111], v160 offset:1024
  ds_read_b128 v[112:115], v160 offset:19456
  ds_read_b128 v[116:119], v161 offset:1024
  s_waitcnt lgkmcnt(3)
  v_mfma_f32_16x16x32_bf16 v[80:83], a[144:147], v[104:107], 0
  ds_read_b128 v[120:123], v160 offset:2048
  v_mfma_f32_16x16x32_bf16 v[64:67], a[0:3], v[96:99], 0
  ds_read_b128 v[124:127], v160 offset:20480
  v_mfma_f32_16x16x32_bf16 v[68:71], a[0:3], v[100:103], 0
  ds_read_b128 v[128:131], v161 offset:2048
  s_add_u32 m0, s33, 65536
  v_mfma_f32_16x16x32_bf16 v[72:75], a[72:75], v[96:99], 0
  s_mov_b32 s34, 0
  v_mfma_f32_16x16x32_bf16 v[76:79], a[72:75], v[100:103], 0
  buffer_load_dwordx4 v19, s[4:7], s34 offen lds
  s_waitcnt lgkmcnt(3)
  v_mfma_f32_16x16x32_bf16 v[80:83], a[148:151], v[116:119], v[80:83]
  ds_read_b128 v[96:99], v160 offset:3072
  v_mfma_f32_16x16x32_bf16 v[64:67], a[4:7], v[108:111], v[64:67]
  ds_read_b128 v[100:103], v160 offset:21504
  v_mfma_f32_16x16x32_bf16 v[68:71], a[4:7], v[112:115], v[68:71]
  ds_read_b128 v[104:107], v161 offset:3072
  s_add_u32 m0, s33, 69632
  v_mfma_f32_16x16x32_bf16 v[72:75], a[76:79], v[108:111], v[72:75]
  s_mov_b32 s34, 294912
  v_mfma_f32_16x16x32_bf16 v[76:79], a[76:79], v[112:115], v[76:79]
  buffer_load_dwordx4 v19, s[4:7], s34 offen lds
  s_waitcnt lgkmcnt(3)
  v_mfma_f32_16x16x32_bf16 v[80:83], a[152:155], v[128:131], v[80:83]
  ds_read_b128 v[108:111], v160 offset:4096
  v_mfma_f32_16x16x32_bf16 v[64:67], a[8:11], v[120:123], v[64:67]
  ds_read_b128 v[112:115], v160 offset:22528
  v_mfma_f32_16x16x32_bf16 v[68:71], a[8:11], v[124:127], v[68:71]
  ds_read_b128 v[116:119], v161 offset:4096
  s_add_u32 m0, s33, 73728
  v_mfma_f32_16x16x32_bf16 v[72:75], a[80:83], v[120:123], v[72:75]
  s_mov_b32 s34, 589824
  v_mfma_f32_16x16x32_bf16 v[76:79], a[80:83], v[124:127], v[76:79]
  buffer_load_dwordx4 v19, s[4:7], s34 offen lds
  s_waitcnt lgkmcnt(3)
  v_mfma_f32_16x16x32_bf16 v[80:83], a[156:159], v[104:107], v[80:83]
  ds_read_b128 v[120:123], v160 offset:5120
  v_mfma_f32_16x16x32_bf16 v[64:67], a[12:15], v[96:99], v[64:67]
  ds_read_b128 v[124:127], v160 offset:23552
  v_mfma_f32_16x16x32_bf16 v[68:71], a[12:15], v[100:103], v[68:71]
  ds_read_b128 v[128:131], v161 offset:5120
  s_add_u32 m0, s33, 77824
  v_mfma_f32_16x16x32_bf16 v[72:75], a[84:87], v[96:99], v[72:75]
  s_mov_b32 s34, 0
  v_mfma_f32_16x16x32_bf16 v[76:79], a[84:87], v[100:103], v[76:79]
  buffer_load_dwordx4 v19, s[8:11], s34 offen lds
  s_waitcnt lgkmcnt(3)
  v_mfma_f32_16x16x32_bf16 v[80:83], a[160:163], v[116:119], v[80:83]
  ds_read_b128 v[96:99], v160 offset:6144
  v_mfma_f32_16x16x32_bf16 v[64:67], a[16:19], v[108:111], v[64:67]
  ds_read_b128 v[100:103], v160 offset:24576
  v_mfma_f32_16x16x32_bf16 v[68:71], a[16:19], v[112:115], v[68:71]
  ds_read_b128 v[104:107], v161 offset:6144
  s_add_u32 m0, s33, 81920
  v_mfma_f32_16x16x32_bf16 v[72:75], a[88:91], v[108:111], v[72:75]
  s_mov_b32 s34, 294912
  v_mfma_f32_16x16x32_bf16 v[76:79], a[88:91], v[112:115], v[76:79]
  buffer_load_dwordx4 v19, s[8:11], s34 offen lds
  s_waitcnt lgkmcnt(3)
  v_mfma_f32_16x16x32_bf16 v[80:83], a[164:167], v[128:131], v[80:83]
  ds_read_b128 v[108:111], v160 offset:7168
  v_mfma_f32_16x16x32_bf16 v[64:67], a[20:23], v[120:123], v[64:67]
  ds_read_b128 v[112:115], v160 offset:25600
  v_mfma_f32_16x16x32_bf16 v[68:71], a[20:23], v[124:127], v[68:71]
  ds_read_b128 v[116:119], v161 offset:7168
  s_add_u32 m0, s33, 86016
  v_mfma_f32_16x16x32_bf16 v[72:75], a[92:95], v[120:123], v[72:75]
  s_mov_b32 s34, 589824
  v_mfma_f32_16x16x32_bf16 v[76:79], a[92:95], v[124:127], v[76:79]
  buffer_load_dwordx4 v19, s[8:11], s34 offen lds
  s_waitcnt lgkmcnt(3)
  v_mfma_f32_16x16x32_bf16 v[80:83], a[168:171], v[104:107], v[80:83]
  ds_read_b128 v[120:123], v160 offset:8192
  v_mfma_f32_16x16x32_bf16 v[64:67], a[24:27], v[96:99], v[64:67]
  ds_read_b128 v[124:127], v160 offset:26624
  v_mfma_f32_16x16x32_bf16 v[68:71], a[24:27], v[100:103], v[68:71]
  ds_read_b128 v[128:131], v161 offset:8192
  s_add_u32 m0, s33, 90112
  v_mfma_f32_16x16x32_bf16 v[72:75], a[96:99], v[96:99], v[72:75]
  s_mov_b32 s34, 884736
  v_mfma_f32_16x16x32_bf16 v[76:79], a[96:99], v[100:103], v[76:79]
  buffer_load_dwordx4 v19, s[4:7], s34 offen lds
  s_waitcnt lgkmcnt(3)
  v_mfma_f32_16x16x32_bf16 v[80:83], a[172:175], v[116:119], v[80:83]
  ds_read_b128 v[96:99], v160 offset:9216
  v_mfma_f32_16x16x32_bf16 v[64:67], a[28:31], v[108:111], v[64:67]
  ds_read_b128 v[100:103], v160 offset:27648
  v_mfma_f32_16x16x32_bf16 v[68:71], a[28:31], v[112:115], v[68:71]
  ds_read_b128 v[104:107], v161 offset:9216
  s_add_u32 m0, s33, 94208
  v_mfma_f32_16x16x32_bf16 v[72:75], a[100:103], v[108:111], v[72:75]
  s_mov_b32 s34, 1179648
  v_mfma_f32_16x16x32_bf16 v[76:79], a[100:103], v[112:115], v[76:79]
  buffer_load_dwordx4 v19, s[4:7], s34 offen lds
  s_waitcnt lgkmcnt(3)
  v_mfma_f32_16x16x32_bf16 v[80:83], a[176:179], v[128:131], v[80:83]
  ds_read_b128 v[108:111], v160 offset:10240
  v_mfma_f32_16x16x32_bf16 v[64:67], a[32:35], v[120:123], v[64:67]
  ds_read_b128 v[112:115], v160 offset:28672
  v_mfma_f32_16x16x32_bf16 v[68:71], a[32:35], v[124:127], v[68:71]
  ds_read_b128 v[116:119], v161 offset:10240
  s_add_u32 m0, s33, 98304
  v_mfma_f32_16x16x32_bf16 v[72:75], a[104:107], v[120:123], v[72:75]
  s_mov_b32 s34, 1474560
  v_mfma_f32_16x16x32_bf16 v[76:79], a[104:107], v[124:127], v[76:79]
  buffer_load_dwordx4 v19, s[4:7], s34 offen lds
  s_waitcnt lgkmcnt(3)
  v_mfma_f32_16x16x32_bf16 v[80:83], a[180:183], v[104:107], v[80:83]
  ds_read_b128 v[120:123], v160 offset:11264
  v_mfma_f32_16x16x32_bf16 v[64:67], a[36:39], v[96:99], v[64:67]
  ds_read_b128 v[124:127], v160 offset:29696
  v_mfma_f32_16x16x32_bf16 v[68:71], a[36:39], v[100:103], v[68:71]
  ds_read_b128 v[128:131], v161 offset:11264
  s_add_u32 m0, s33, 102400
  v_mfma_f32_16x16x32_bf16 v[72:75], a[108:111], v[96:99], v[72:75]
  s_mov_b32 s34, 884736
  v_mfma_f32_16x16x32_bf16 v[76:79], a[108:111], v[100:103], v[76:79]
  buffer_load_dwordx4 v19, s[8:11], s34 offen lds
  s_waitcnt lgkmcnt(3)
  v_mfma_f32_16x16x32_bf16 v[80:83], a[184:187], v[116:119], v[80:83]
  ds_read_b128 v[96:99], v160 offset:12288
  v_mfma_f32_16x16x32_bf16 v[64:67], a[40:43], v[108:111], v[64:67]
  ds_read_b128 v[100:103], v160 offset:30720
  v_mfma_f32_16x16x32_bf16 v[68:71], a[40:43], v[112:115], v[68:71]
  ds_read_b128 v[104:107], v161 offset:12288
  s_add_u32 m0, s33, 106496
  v_mfma_f32_16x16x32_bf16 v[72:75], a[112:115], v[108:111], v[72:75]
  s_mov_b32 s34, 1179648
  v_mfma_f32_16x16x32_bf16 v[76:79], a[112:115], v[112:115], v[76:79]
  buffer_load_dwordx4 v19, s[8:11], s34 offen lds
  s_waitcnt lgkmcnt(3)
  v_mfma_f32_16x16x32_bf16 v[80:83], a[188:191], v[128:131], v[80:83]
  ds_read_b128 v[108:111], v160 offset:13312
  v_mfma_f32_16x16x32_bf16 v[64:67], a[44:47], v[120:123], v[64:67]
  ds_read_b128 v[112:115], v160 offset:31744
  v_mfma_f32_16x16x32_bf16 v[68:71], a[44:47], v[124:127], v[68:71]
  ds_read_b128 v[116:119], v161 offset:13312
  s_add_u32 m0, s33, 110592
  v_mfma_f32_16x16x32_bf16 v[72:75], a[116:119], v[120:123], v[72:75]
  s_mov_b32 s34, 1474560
  v_mfma_f32_16x16x32_bf16 v[76:79], a[116:119], v[124:127], v[76:79]
  buffer_load_dwordx4 v19, s[8:11], s34 offen lds
  s_waitcnt lgkmcnt(3)
  v_mfma_f32_16x16x32_bf16 v[80:83], a[192:195], v[104:107], v[80:83]
  ds_read_b128 v[120:123], v160 offset:14336
  v_mfma_f32_16x16x32_bf16 v[64:67], a[48:51], v[96:99], v[64:67]
  ds_read_b128 v[124:127], v160 offset:32768
  v_mfma_f32_16x16x32_bf16 v[68:71], a[48:51], v[100:103], v[68:71]
  ds_read_b128 v[128:131], v161 offset:14336
  v_mfma_f32_16x16x32_bf16 v[72:75], a[120:123], v[96:99], v[72:75]
  v_mfma_f32_16x16x32_bf16 v[76:79], a[120:123], v[100:103], v[76:79]
  s_waitcnt lgkmcnt(3)
  v_mfma_f32_16x16x32_bf16 v[80:83], a[196:199], v[116:119], v[80:83]
  ds_read_b128 v[96:99], v160 offset:15360
  v_mfma_f32_16x16x32_bf16 v[64:67], a[52:55], v[108:111], v[64:67]
  ds_read_b128 v[100:103], v160 offset:33792
  v_mfma_f32_16x16x32_bf16 v[68:71], a[52:55], v[112:115], v[68:71]
  ds_read_b128 v[104:107], v161 offset:15360
  v_mfma_f32_16x16x32_bf16 v[72:75], a[124:127], v[108:111], v[72:75]
  v_mfma_f32_16x16x32_bf16 v[76:79], a[124:127], v[112:115], v[76:79]
  s_waitcnt lgkmcnt(3)
  v_mfma_f32_16x16x32_bf16 v[80:83], a[200:203], v[128:131], v[80:83]
  ds_read_b32 v108, v181
  ds_read_b32 v109, v181 offset:64
  ds_read_b32 v110, v181 offset:128
  v_mfma_f32_16x16x32_bf16 v[64:67], a[56:59], v[120:123], v[64:67]
  ds_read_b32 v111, v181 offset:192
  ds_read_b32 v112, v181 offset:18432
  ds_read_b32 v113, v181 offset:18496
  v_mfma_f32_16x16x32_bf16 v[68:71], a[56:59], v[124:127], v[68:71]
  ds_read_b32 v114, v181 offset:18560
  ds_read_b32 v115, v181 offset:18624
  ds_read_b32 v116, v182
  v_mfma_f32_16x16x32_bf16 v[72:75], a[128:131], v[120:123], v[72:75]
  ds_read_b32 v117, v182 offset:64
  ds_read_b32 v118, v182 offset:128
  ds_read_b32 v119, v182 offset:192
  v_mfma_f32_16x16x32_bf16 v[76:79], a[128:131], v[124:127], v[76:79]
  s_waitcnt lgkmcnt(12)
  v_mfma_f32_16x16x32_bf16 v[80:83], a[204:207], v[104:107], v[80:83]
  ds_read_b32 v120, v181 offset:1024
  ds_read_b32 v121, v181 offset:1088
  ds_read_b32 v122, v181 offset:1152
  v_mfma_f32_16x16x32_bf16 v[64:67], a[60:63], v[96:99], v[64:67]
  ds_read_b32 v123, v181 offset:1216
  ds_read_b32 v124, v181 offset:19456
  ds_read_b32 v125, v181 offset:19520
  v_mfma_f32_16x16x32_bf16 v[68:71], a[60:63], v[100:103], v[68:71]
  ds_read_b32 v126, v181 offset:19584
  ds_read_b32 v127, v181 offset:19648
  ds_read_b32 v128, v182 offset:1024
  v_mfma_f32_16x16x32_bf16 v[72:75], a[132:135], v[96:99], v[72:75]
  ds_read_b32 v129, v182 offset:1088
  ds_read_b32 v130, v182 offset:1152
  ds_read_b32 v131, v182 offset:1216
  v_mfma_f32_16x16x32_bf16 v[76:79], a[132:135], v[100:103], v[76:79]
  s_waitcnt lgkmcnt(12)
  v_mfma_f32_16x16x32_bf16 v[80:83], a[208:211], v[116:119], v[80:83]
  v_mfma_f32_16x16x32_bf16 v[64:67], a[64:67], v[108:111], v[64:67]
  v_mfma_f32_16x16x32_bf16 v[68:71], a[64:67], v[112:115], v[68:71]
  v_mfma_f32_16x16x32_bf16 v[72:75], a[136:139], v[108:111], v[72:75]
  v_mfma_f32_16x16x32_bf16 v[76:79], a[136:139], v[112:115], v[76:79]
  s_waitcnt lgkmcnt(0)
  v_mfma_f32_16x16x32_bf16 v[80:83], a[212:215], v[128:131], v[80:83]
  v_mfma_f32_16x16x32_bf16 v[64:67], a[68:71], v[120:123], v[64:67]
  v_mfma_f32_16x16x32_bf16 v[68:71], a[68:71], v[124:127], v[68:71]
  v_mfma_f32_16x16x32_bf16 v[72:75], a[140:143], v[120:123], v[72:75]
  v_mfma_f32_16x16x32_bf16 v[76:79], a[140:143], v[124:127], v[76:79]
  s_nop 3
  v_add_f32 v176, v80, v81
  ds_write_b32 v165, v176
  s_waitcnt lgkmcnt(0)
  s_barrier
  ds_read_b32 v177, v166
  ds_read_b32 v178, v166 offset:64
  ds_read_b32 v179, v167
  s_waitcnt vmcnt(14)
  v_lshlrev_b32 v32, 16, v84
  v_and_b32 v33, 0xffff0000, v84
  v_add_f32 v64, v64, v32
  v_add_f32 v65, v65, v33
  v_lshlrev_b32 v32, 16, v85
  v_and_b32 v33, 0xffff0000, v85
  v_add_f32 v66, v66, v32
  v_add_f32 v67, v67, v33
  s_waitcnt vmcnt(13)
  v_lshlrev_b32 v32, 16, v88
  v_and_b32 v33, 0xffff0000, v88
  v_add_f32 v68, v68, v32
  v_add_f32 v69, v69, v33
  v_lshlrev_b32 v32, 16, v89
  v_and_b32 v33, 0xffff0000, v89
  v_add_f32 v70, v70, v32
  v_add_f32 v71, v71, v33
  v_lshlrev_b32 v32, 16, v86
  v_and_b32 v33, 0xffff0000, v86
  v_add_f32 v72, v72, v32
  v_add_f32 v73, v73, v33
  v_lshlrev_b32 v32, 16, v87
  v_and_b32 v33, 0xffff0000, v87
  v_add_f32 v74, v74, v32
  v_add_f32 v75, v75, v33
  v_lshlrev_b32 v32, 16, v90
  v_and_b32 v33, 0xffff0000, v90
  v_add_f32 v76, v76, v32
  v_add_f32 v77, v77, v33
  v_lshlrev_b32 v32, 16, v91
  v_and_b32 v33, 0xffff0000, v91
  v_add_f32 v78, v78, v32
  v_add_f32 v79, v79, v33
  s_waitcnt vmcnt(12)
  v_lshlrev_b32 v32, 16, v92
  v_and_b32 v33, 0xffff0000, v92
  v_add_f32 v80, v80, v32
  v_add_f32 v81, v81, v33
  v_lshlrev_b32 v32, 16, v93
  v_and_b32 v33, 0xffff0000, v93
  v_add_f32 v82, v82, v32
  v_add_f32 v83, v83, v33
  s_waitcnt lgkmcnt(1)
  v_cndmask_b32 v176, v178, v177, s[78:79]
  buffer_store_dword v176, v168, s[44:47], 0 offen sc1
  v_sub_f32 v64, v64, v177
  v_sub_f32 v65, v65, v177
  v_sub_f32 v66, v66, v177
  v_sub_f32 v67, v67, v177
  v_sub_f32 v68, v68, v178
  v_sub_f32 v69, v69, v178
  v_sub_f32 v70, v70, v178
  v_sub_f32 v71, v71, v178
  v_sub_f32 v72, v72, v177
  v_sub_f32 v73, v73, v177
  v_sub_f32 v74, v74, v177
  v_sub_f32 v75, v75, v177
  v_sub_f32 v76, v76, v178
  v_sub_f32 v77, v77, v178
  v_sub_f32 v78, v78, v178
  v_sub_f32 v79, v79, v178
  s_waitcnt lgkmcnt(0)
  v_sub_f32 v80, v80, v179
  v_sub_f32 v81, v81, v179
  v_sub_f32 v82, v82, v179
  v_sub_f32 v83, v83, v179
  v_cvt_pk_bf16_f32 v36, v64, v65
  v_cvt_pk_bf16_f32 v37, v66, v67
  v_cvt_pk_bf16_f32 v38, v72, v73
  v_cvt_pk_bf16_f32 v39, v74, v75
  v_cvt_pk_bf16_f32 v40, v68, v69
  v_cvt_pk_bf16_f32 v41, v70, v71
  v_cvt_pk_bf16_f32 v42, v76, v77
  v_cvt_pk_bf16_f32 v43, v78, v79
  v_cvt_pk_bf16_f32 v44, v80, v81
  v_cvt_pk_bf16_f32 v45, v82, v83
  buffer_store_dwordx4 v[36:39], v163, s[72:75], 0 offen sc1
  buffer_store_dwordx4 v[40:43], v163, s[72:75], s53 offen sc1
  buffer_store_dwordx2 v[44:45], v180, s[72:75], 0 offen sc1
  v_mul_f32 v48, v64, v64
  v_mul_f32 v49, v68, v68
  v_mul_f32 v50, v80, v80
  v_fmac_f32 v48, v72, v72
  v_fmac_f32 v49, v76, v76
  v_fmac_f32 v48, v65, v65
  v_fmac_f32 v49, v69, v69
  v_fmac_f32 v50, v81, v81
  v_fmac_f32 v48, v73, v73
  v_fmac_f32 v49, v77, v77
  v_fmac_f32 v48, v66, v66
  v_fmac_f32 v49, v70, v70
  v_fmac_f32 v50, v82, v82
  v_fmac_f32 v48, v74, v74
  v_fmac_f32 v49, v78, v78
  v_fmac_f32 v48, v67, v67
  v_fmac_f32 v49, v71, v71
  v_fmac_f32 v50, v83, v83
  v_fmac_f32 v48, v75, v75
  v_fmac_f32 v49, v79, v79
  v_fmac_f32 v48, s58, v50
  v_fmac_f32 v49, s59, v50
  s_nop 1
  v_permlane32_swap_b32 v48, v49
  v_add_f32 v48, v48, v49
  v_mov_b32 v49, v48
  s_nop 1
  v_permlane16_swap_b32 v48, v49
  v_add_f32 v48, v48, v49
  buffer_store_dword v48, v169, s[60:63], 0 offen sc1
  s_waitcnt vmcnt(0)
  s_barrier
  s_mov_b32 s36, 65536
  v_mov_b32 v1, 1
  buffer_store_dword v1, v29, s[96:99], s36 offen sc1
  s_add_u32 m0, s33, 114688
  s_mov_b32 s34, 1769472
  buffer_load_dwordx4 v19, s[4:7], s34 offen lds
  s_add_u32 m0, s33, 118784
  s_mov_b32 s34, 2064384
  buffer_load_dwordx4 v19, s[4:7], s34 offen lds
  s_add_u32 m0, s33, 122880
  s_mov_b32 s34, 2359296
  buffer_load_dwordx4 v19, s[4:7], s34 offen lds
  s_add_u32 m0, s33, 126976
  s_mov_b32 s34, 1769472
  buffer_load_dwordx4 v19, s[8:11], s34 offen lds
  s_add_u32 m0, s33, 131072
  s_mov_b32 s34, 2064384
  buffer_load_dwordx4 v19, s[8:11], s34 offen lds
  s_add_u32 m0, s33, 135168
  s_mov_b32 s34, 2359296
  buffer_load_dwordx4 v19, s[8:11], s34 offen lds
  s_mov_b32 s36, 65536
  buffer_load_dword v31, v30, s[96:99], s36 offen sc1
  s_waitcnt vmcnt(0)
  v_cmp_eq_u32 vcc, 0, v31
  s_cbranch_vccnz L_sp_8
L_bk_9:
  s_add_u32 m0, s33, 40960
  s_mov_b32 s34, 0
  buffer_load_dwordx4 v23, s[16:19], s34 offen sc1 lds
  s_add_u32 m0, s33, 45056
  s_mov_b32 s34, 36864
  buffer_load_dwordx4 v23, s[16:19], s34 offen sc1 lds
  s_add_u32 m0, s33, 49152
  s_mov_b32 s34, 1024
  buffer_load_dwordx4 v23, s[16:19], s34 offen sc1 lds
  s_add_u32 m0, s33, 53248
  s_mov_b32 s34, 37888
  buffer_load_dwordx4 v23, s[16:19], s34 offen sc1 lds
  s_add_u32 m0, s33, 57344
  s_mov_b32 s34, 2048
  buffer_load_dwordx4 v23, s[16:19], s34 offen sc1 lds
  s_add_u32 m0, s33, 61440
  s_mov_b32 s34, 38912
  buffer_load_dwordx4 v23, s[16:19], s34 offen sc1 lds
  s_add_u32 m0, s33, 139264
  s_mov_b32 s34, 3072
  buffer_load_dwordx4 v23, s[16:19], s34 offen sc1 lds
  s_add_u32 m0, s33, 143360
  s_mov_b32 s34, 39936
  buffer_load_dwordx4 v23, s[16:19], s34 offen sc1 lds
  s_add_u32 m0, s33, 0
  s_mov_b32 s34, 4096
  buffer_load_dwordx4 v23, s[16:19], s34 offen sc1 lds
  s_add_u32 m0, s33, 4096
  s_mov_b32 s34, 40960
  buffer_load_dwordx4 v23, s[16:19], s34 offen sc1 lds
  s_add_u32 m0, s33, 147456
  s_mov_b32 s34, 5120
  buffer_load_dwordx4 v23, s[16:19], s34 offen sc1 lds
  s_add_u32 m0, s33, 151552
  s_mov_b32 s34, 41984
  buffer_load_dwordx4 v23, s[16:19], s34 offen sc1 lds
  s_waitcnt vmcnt(6)
  s_barrier
  ds_read_b64_tr_b16 v[56:57], v9
  ds_read_b64_tr_b16 v[58:59], v9 offset:2048
  ds_read_b64_tr_b16 v[60:61], v9 offset:4096
  ds_read_b64_tr_b16 v[62:63], v9 offset:6144
  ds_read_b64_tr_b16 v[64:65], v9 offset:8192
  ds_read_b64_tr_b16 v[66:67], v9 offset:10240
  ds_read_b128 a[0:3], v26 offset:40960
  ds_read_b128 a[4:7], v26 offset:41984
  ds_read_b128 a[8:11], v26 offset:45056
  ds_read_b128 a[12:15], v26 offset:46080
  ds_read_b128 a[16:19], v26 offset:49152
  ds_read_b128 a[20:23], v26 offset:50176
  ds_read_b128 a[24:27], v26 offset:53248
  ds_read_b128 a[28:31], v26 offset:54272
  ds_read_b128 a[32:35], v26 offset:57344
  ds_read_b128 a[36:39], v26 offset:58368
  ds_read_b128 a[40:43], v26 offset:61440
  ds_read_b128 a[44:47], v26 offset:62464
  s_waitcnt lgkmcnt(12)
  s_waitcnt lgkmcnt(11)
  v_mfma_f32_16x16x32_bf16 v[128:131], v[56:59], a[0:3], 0
  s_waitcnt vmcnt(4)
  s_barrier
  s_waitcnt lgkmcnt(7)
  v_mfma_f32_16x16x32_bf16 v[128:131], v[60:63], a[16:19], v[128:131]
  ds_read_b64_tr_b16 v[68:69], v12
  s_add_u32 m0, s33, 155648
  s_waitcnt lgkmcnt(4)
  v_mfma_f32_16x16x32_bf16 v[128:131], v[64:67], a[32:35], v[128:131]
  ds_read_b64_tr_b16 v[70:71], v12 offset:2048
  s_mov_b32 s34, 6144
  v_mfma_f32_16x16x32_bf16 v[132:135], v[56:59], a[4:7], 0
  ds_read_b64_tr_b16 v[72:73], v12 offset:4096
  buffer_load_dwordx4 v23, s[16:19], s34 offen sc1 lds
  v_mfma_f32_16x16x32_bf16 v[132:135], v[60:63], a[20:23], v[132:135]
  ds_read_b64_tr_b16 v[74:75], v12 offset:6144
  s_add_u32 m0, s33, 159744
  s_waitcnt lgkmcnt(6)
  v_mfma_f32_16x16x32_bf16 v[132:135], v[64:67], a[36:39], v[132:135]
  ds_read_b64_tr_b16 v[76:77], v12 offset:8192
  s_mov_b32 s34, 43008
  v_mfma_f32_16x16x32_bf16 v[136:139], v[56:59], a[8:11], 0
  ds_read_b64_tr_b16 v[78:79], v12 offset:10240
  buffer_load_dwordx4 v23, s[16:19], s34 offen sc1 lds
  v_mfma_f32_16x16x32_bf16 v[136:139], v[60:63], a[24:27], v[136:139]
  s_add_u32 m0, s33, 8192
  s_waitcnt lgkmcnt(7)
  v_mfma_f32_16x16x32_bf16 v[136:139], v[64:67], a[40:43], v[136:139]
  s_mov_b32 s34, 7168
  v_mfma_f32_16x16x32_bf16 v[140:143], v[56:59], a[12:15], 0
  buffer_load_dwordx4 v23, s[16:19], s34 offen sc1 lds
  v_mfma_f32_16x16x32_bf16 v[140:143], v[60:63], a[28:31], v[140:143]
  s_waitcnt lgkmcnt(6)
  v_mfma_f32_16x16x32_bf16 v[140:143], v[64:67], a[44:47], v[140:143]
  s_waitcnt lgkmcnt(0)
  v_mfma_f32_16x16x32_bf16 v[144:147], v[68:71], a[0:3], 0
  ds_read_b64_tr_b16 v[56:57], v9 offset:12288
  s_add_u32 m0, s33, 12288
  v_mfma_f32_16x16x32_bf16 v[144:147], v[72:75], a[16:19], v[144:147]
  ds_read_b64_tr_b16 v[58:59], v9 offset:14336
  s_mov_b32 s34, 44032
  v_mfma_f32_16x16x32_bf16 v[144:147], v[76:79], a[32:35], v[144:147]
  ds_read_b64_tr_b16 v[60:61], v9 offset:16384
  buffer_load_dwordx4 v23, s[16:19], s34 offen sc1 lds
  v_mfma_f32_16x16x32_bf16 v[148:151], v[68:71], a[4:7], 0
  ds_read_b64_tr_b16 v[62:63], v9 offset:18432
  s_add_u32 m0, s33, 16384
  v_mfma_f32_16x16x32_bf16 v[148:151], v[72:75], a[20:23], v[148:151]
  ds_read_b64_tr_b16 v[64:65], v9 offset:20480
  s_mov_b32 s34, 8192
  v_mfma_f32_16x16x32_bf16 v[148:151], v[76:79], a[36:39], v[148:151]
  ds_read_b64_tr_b16 v[66:67], v9 offset:22528
  buffer_load_dwordx4 v23, s[16:19], s34 offen sc1 lds
  v_mfma_f32_16x16x32_bf16 v[152:155], v[68:71], a[8:11], 0
  ds_read_b128 a[48:51], v28 offset:8192
  s_add_u32 m0, s33, 20480
  v_mfma_f32_16x16x32_bf16 v[152:155], v[72:75], a[24:27], v[152:155]
  ds_read_b128 a[52:55], v28 offset:9216
  s_mov_b32 s34, 45056
  v_mfma_f32_16x16x32_bf16 v[152:155], v[76:79], a[40:43], v[152:155]
  ds_read_b128 a[56:59], v28 offset:12288
  buffer_load_dwordx4 v23, s[16:19], s34 offen sc1 lds
  v_mfma_f32_16x16x32_bf16 v[156:159], v[68:71], a[12:15], 0
  ds_read_b128 a[60:63], v28 offset:13312
  v_mfma_f32_16x16x32_bf16 v[156:159], v[72:75], a[28:31], v[156:159]
  v_mfma_f32_16x16x32_bf16 v[156:159], v[76:79], a[44:47], v[156:159]
  s_waitcnt lgkmcnt(4)
  v_mfma_f32_16x16x32_bf16 v[160:163], v[56:59], a[0:3], 0
  s_waitcnt vmcnt(6)
  s_barrier
  v_mfma_f32_16x16x32_bf16 v[160:163], v[60:63], a[16:19], v[160:163]
  ds_read_b64_tr_b16 v[68:69], v12 offset:12288
  s_add_u32 m0, s33, 24576
  v_mfma_f32_16x16x32_bf16 v[160:163], v[64:67], a[32:35], v[160:163]
  ds_read_b64_tr_b16 v[70:71], v12 offset:14336
  s_mov_b32 s34, 9216
  v_mfma_f32_16x16x32_bf16 v[164:167], v[56:59], a[4:7], 0
  ds_read_b64_tr_b16 v[72:73], v12 offset:16384
  buffer_load_dwordx4 v23, s[16:19], s34 offen sc1 lds
  v_mfma_f32_16x16x32_bf16 v[164:167], v[60:63], a[20:23], v[164:167]
  ds_read_b64_tr_b16 v[74:75], v12 offset:18432
  s_add_u32 m0, s33, 28672
  v_mfma_f32_16x16x32_bf16 v[164:167], v[64:67], a[36:39], v[164:167]
  ds_read_b64_tr_b16 v[76:77], v12 offset:20480
  s_mov_b32 s34, 46080
  v_mfma_f32_16x16x32_bf16 v[168:171], v[56:59], a[8:11], 0
  ds_read_b64_tr_b16 v[78:79], v12 offset:22528
  ds_read_b64 a[64:65], v22
  buffer_load_dwordx4 v23, s[16:19], s34 offen sc1 lds
  v_mfma_f32_16x16x32_bf16 v[168:171], v[60:63], a[24:27], v[168:171]
  ds_read_b64 a[66:67], v22 offset:512
  ds_read_b64 a[68:69], v22 offset:1024
  s_add_u32 m0, s33, 32768
  v_mfma_f32_16x16x32_bf16 v[168:171], v[64:67], a[40:43], v[168:171]
  ds_read_b64 a[70:71], v22 offset:1536
  ds_read_b64 a[72:73], v22 offset:4096
  s_mov_b32 s34, 10240
  v_mfma_f32_16x16x32_bf16 v[172:175], v[56:59], a[12:15], 0
  ds_read_b64 a[74:75], v22 offset:4608
  ds_read_b64 a[76:77], v22 offset:5120
  buffer_load_dwordx4 v23, s[16:19], s34 offen sc1 lds
  v_mfma_f32_16x16x32_bf16 v[172:175], v[60:63], a[28:31], v[172:175]
  ds_read_b64 a[78:79], v22 offset:5632
  v_mfma_f32_16x16x32_bf16 v[172:175], v[64:67], a[44:47], v[172:175]
  s_waitcnt lgkmcnt(8)
  v_mfma_f32_16x16x32_bf16 v[176:179], v[68:71], a[0:3], 0
  ds_read_b64_tr_b16 v[56:57], v9 offset:24576
  s_add_u32 m0, s33, 36864
  v_mfma_f32_16x16x32_bf16 v[176:179], v[72:75], a[16:19], v[176:179]
  ds_read_b64_tr_b16 v[58:59], v9 offset:26624
  s_mov_b32 s34, 47104
  v_mfma_f32_16x16x32_bf16 v[176:179], v[76:79], a[32:35], v[176:179]
  ds_read_b64_tr_b16 v[60:61], v9 offset:28672
  buffer_load_dwordx4 v23, s[16:19], s34 offen sc1 lds
  v_mfma_f32_16x16x32_bf16 v[180:183], v[68:71], a[4:7], 0
  ds_read_b64_tr_b16 v[62:63], v9 offset:30720
  s_add_u32 m0, s33, 40960
  v_mfma_f32_16x16x32_bf16 v[180:183], v[72:75], a[20:23], v[180:183]
  ds_read_b64_tr_b16 v[64:65], v9 offset:32768
  s_mov_b32 s34, 11264
  v_mfma_f32_16x16x32_bf16 v[180:183], v[76:79], a[36:39], v[180:183]
  ds_read_b64_tr_b16 v[66:67], v9 offset:34816
  buffer_load_dwordx4 v23, s[16:19], s34 offen sc1 lds
  v_mfma_f32_16x16x32_bf16 v[184:187], v[68:71], a[8:11], 0
  ds_read_b128 a[80:83], v28 offset:16384
  s_add_u32 m0, s33, 45056
  v_mfma_f32_16x16x32_bf16 v[184:187], v[72:75], a[24:27], v[184:187]
  ds_read_b128 a[84:87], v28 offset:17408
  s_mov_b32 s34, 48128
  v_mfma_f32_16x16x32_bf16 v[184:187], v[76:79], a[40:43], v[184:187]
  ds_read_b128 a[88:91], v28 offset:20480
  buffer_load_dwordx4 v23, s[16:19], s34 offen sc1 lds
  v_mfma_f32_16x16x32_bf16 v[188:191], v[68:71], a[12:15], 0
  ds_read_b128 a[92:95], v28 offset:21504
  v_mfma_f32_16x16x32_bf16 v[188:191], v[72:75], a[28:31], v[188:191]
  v_mfma_f32_16x16x32_bf16 v[188:191], v[76:79], a[44:47], v[188:191]
  s_waitcnt lgkmcnt(4)
  v_mfma_f32_16x16x32_bf16 v[128:131], v[56:59], a[48:51], v[128:131]
  s_waitcnt vmcnt(10)
  s_barrier
  v_mfma_f32_16x16x32_bf16 v[128:131], v[60:63], a[64:67], v[128:131]
  ds_read_b64_tr_b16 v[68:69], v12 offset:24576
  s_add_u32 m0, s33, 49152
  s_waitcnt lgkmcnt(4)
  v_mfma_f32_16x16x32_bf16 v[128:131], v[64:67], a[80:83], v[128:131]
  ds_read_b64_tr_b16 v[70:71], v12 offset:26624
  s_mov_b32 s34, 2654208
  v_mfma_f32_16x16x32_bf16 v[132:135], v[56:59], a[52:55], v[132:135]
  ds_read_b64_tr_b16 v[72:73], v12 offset:28672
  buffer_load_dwordx4 v19, s[4:7], s34 offen lds
  v_mfma_f32_16x16x32_bf16 v[132:135], v[60:63], a[68:71], v[132:135]
  ds_read_b64_tr_b16 v[74:75], v12 offset:30720
  s_add_u32 m0, s33, 53248
  s_waitcnt lgkmcnt(6)
  v_mfma_f32_16x16x32_bf16 v[132:135], v[64:67], a[84:87], v[132:135]
  ds_read_b64_tr_b16 v[76:77], v12 offset:32768
  s_mov_b32 s34, 2949120
  v_mfma_f32_16x16x32_bf16 v[136:139], v[56:59], a[56:59], v[136:139]
  ds_read_b64_tr_b16 v[78:79], v12 offset:34816
  buffer_load_dwordx4 v19, s[4:7], s34 offen lds
  v_mfma_f32_16x16x32_bf16 v[136:139], v[60:63], a[72:75], v[136:139]
  s_add_u32 m0, s33, 57344
  s_waitcnt lgkmcnt(7)
  v_mfma_f32_16x16x32_bf16 v[136:139], v[64:67], a[88:91], v[136:139]
  s_mov_b32 s34, 3244032
  v_mfma_f32_16x16x32_bf16 v[140:143], v[56:59], a[60:63], v[140:143]
  buffer_load_dwordx4 v19, s[4:7], s34 offen lds
  v_mfma_f32_16x16x32_bf16 v[140:143], v[60:63], a[76:79], v[140:143]
  s_waitcnt lgkmcnt(6)
  v_mfma_f32_16x16x32_bf16 v[140:143], v[64:67], a[92:95], v[140:143]
  s_waitcnt lgkmcnt(0)
  v_mfma_f32_16x16x32_bf16 v[144:147], v[68:71], a[48:51], v[144:147]
  ds_read_b64_tr_b16 v[56:57], v9 offset:36864
  s_add_u32 m0, s33, 61440
  v_mfma_f32_16x16x32_bf16 v[144:147], v[72:75], a[64:67], v[144:147]
  ds_read_b64_tr_b16 v[58:59], v9 offset:38912
  s_mov_b32 s34, 2654208
  v_mfma_f32_16x16x32_bf16 v[144:147], v[76:79], a[80:83], v[144:147]
  ds_read_b64_tr_b16 v[60:61], v9 offset:40960
  buffer_load_dwordx4 v19, s[8:11], s34 offen lds
  v_mfma_f32_16x16x32_bf16 v[148:151], v[68:71], a[52:55], v[148:151]
  ds_read_b64_tr_b16 v[62:63], v9 offset:43008
  s_add_u32 m0, s33, 65536
  v_mfma_f32_16x16x32_bf16 v[148:151], v[72:75], a[68:71], v[148:151]
  ds_read_b64_tr_b16 v[64:65], v9 offset:45056
  s_mov_b32 s34, 2949120
  v_mfma_f32_16x16x32_bf16 v[148:151], v[76:79], a[84:87], v[148:151]
  ds_read_b64_tr_b16 v[66:67], v9 offset:47104
  buffer_load_dwordx4 v19, s[8:11], s34 offen lds
  v_mfma_f32_16x16x32_bf16 v[152:155], v[68:71], a[56:59], v[152:155]
  ds_read_b128 a[96:99], v28 offset:24576
  s_add_u32 m0, s33, 69632
  v_mfma_f32_16x16x32_bf16 v[152:155], v[72:75], a[72:75], v[152:155]
  ds_read_b128 a[100:103], v28 offset:25600
  s_mov_b32 s34, 3244032
  v_mfma_f32_16x16x32_bf16 v[152:155], v[76:79], a[88:91], v[152:155]
  ds_read_b128 a[104:107], v28 offset:28672
  buffer_load_dwordx4 v19, s[8:11], s34 offen lds
  v_mfma_f32_16x16x32_bf16 v[156:159], v[68:71], a[60:63], v[156:159]
  ds_read_b128 a[108:111], v28 offset:29696
  v_mfma_f32_16x16x32_bf16 v[156:159], v[72:75], a[76:79], v[156:159]
  v_mfma_f32_16x16x32_bf16 v[156:159], v[76:79], a[92:95], v[156:159]
  s_waitcnt lgkmcnt(4)
  v_mfma_f32_16x16x32_bf16 v[160:163], v[56:59], a[48:51], v[160:163]
  s_waitcnt vmcnt(12)
  s_barrier
  v_mfma_f32_16x16x32_bf16 v[160:163], v[60:63], a[64:67], v[160:163]
  ds_read_b64_tr_b16 v[68:69], v12 offset:36864
  s_add_u32 m0, s33, 73728
  v_mfma_f32_16x16x32_bf16 v[160:163], v[64:67], a[80:83], v[160:163]
  ds_read_b64_tr_b16 v[70:71], v12 offset:38912
  s_mov_b32 s34, 12288
  v_mfma_f32_16x16x32_bf16 v[164:167], v[56:59], a[52:55], v[164:167]
  ds_read_b64_tr_b16 v[72:73], v12 offset:40960
  buffer_load_dwordx4 v23, s[16:19], s34 offen sc1 lds
  v_mfma_f32_16x16x32_bf16 v[164:167], v[60:63], a[68:71], v[164:167]
  ds_read_b64_tr_b16 v[74:75], v12 offset:43008
  s_add_u32 m0, s33, 77824
  v_mfma_f32_16x16x32_bf16 v[164:167], v[64:67], a[84:87], v[164:167]
  ds_read_b64_tr_b16 v[76:77], v12 offset:45056
  s_mov_b32 s34, 49152
  v_mfma_f32_16x16x32_bf16 v[168:171], v[56:59], a[56:59], v[168:171]
  ds_read_b64_tr_b16 v[78:79], v12 offset:47104
  buffer_load_dwordx4 v23, s[16:19], s34 offen sc1 lds
  v_mfma_f32_16x16x32_bf16 v[168:171], v[60:63], a[72:75], v[168:171]
  ds_read_b128 a[112:115], v26 offset:8192
  s_add_u32 m0, s33, 0
  v_mfma_f32_16x16x32_bf16 v[168:171], v[64:67], a[88:91], v[168:171]
  ds_read_b128 a[116:119], v26 offset:9216
  s_mov_b32 s34, 13312
  v_mfma_f32_16x16x32_bf16 v[172:175], v[56:59], a[60:63], v[172:175]
  ds_read_b128 a[120:123], v26 offset:12288
  buffer_load_dwordx4 v23, s[16:19], s34 offen sc1 lds
  v_mfma_f32_16x16x32_bf16 v[172:175], v[60:63], a[76:79], v[172:175]
  ds_read_b128 a[124:127], v26 offset:13312
  v_mfma_f32_16x16x32_bf16 v[172:175], v[64:67], a[92:95], v[172:175]
  s_waitcnt lgkmcnt(4)
  v_mfma_f32_16x16x32_bf16 v[176:179], v[68:71], a[48:51], v[176:179]
  ds_read_b64_tr_b16 v[56:57], v9 offset:49152
  s_add_u32 m0, s33, 4096
  v_mfma_f32_16x16x32_bf16 v[176:179], v[72:75], a[64:67], v[176:179]
  ds_read_b64_tr_b16 v[58:59], v9 offset:51200
  s_mov_b32 s34, 50176
  v_mfma_f32_16x16x32_bf16 v[176:179], v[76:79], a[80:83], v[176:179]
  ds_read_b64_tr_b16 v[60:61], v9 offset:53248
  buffer_load_dwordx4 v23, s[16:19], s34 offen sc1 lds
  v_mfma_f32_16x16x32_bf16 v[180:183], v[68:71], a[52:55], v[180:183]
  ds_read_b64_tr_b16 v[62:63], v9 offset:55296
  s_add_u32 m0, s33, 81920
  v_mfma_f32_16x16x32_bf16 v[180:183], v[72:75], a[68:71], v[180:183]
  ds_read_b64_tr_b16 v[64:65], v9 offset:57344
  s_mov_b32 s34, 14336
  v_mfma_f32_16x16x32_bf16 v[180:183], v[76:79], a[84:87], v[180:183]
  ds_read_b64_tr_b16 v[66:67], v9 offset:59392
  buffer_load_dwordx4 v23, s[16:19], s34 offen sc1 lds
  v_mfma_f32_16x16x32_bf16 v[184:187], v[68:71], a[56:59], v[184:187]
  ds_read_b128 a[128:131], v26 offset:16384
  s_add_u32 m0, s33, 86016
  v_mfma_f32_16x16x32_bf16 v[184:187], v[72:75], a[72:75], v[184:187]
  ds_read_b128 a[132:135], v26 offset:17408
  s_mov_b32 s34, 51200
  v_mfma_f32_16x16x32_bf16 v[184:187], v[76:79], a[88:91], v[184:187]
  ds_read_b128 a[136:139], v26 offset:20480
  buffer_load_dwordx4 v23, s[16:19], s34 offen sc1 lds
  v_mfma_f32_16x16x32_bf16 v[188:191], v[68:71], a[60:63], v[188:191]
  ds_read_b128 a[140:143], v26 offset:21504
  v_mfma_f32_16x16x32_bf16 v[188:191], v[72:75], a[76:79], v[188:191]
  v_mfma_f32_16x16x32_bf16 v[188:191], v[76:79], a[92:95], v[188:191]
  s_waitcnt lgkmcnt(4)
  v_mfma_f32_16x16x32_bf16 v[128:131], v[56:59], a[96:99], v[128:131]
  s_waitcnt vmcnt(16)
  s_barrier
  v_mfma_f32_16x16x32_bf16 v[128:131], v[60:63], a[112:115], v[128:131]
  ds_read_b64_tr_b16 v[68:69], v12 offset:49152
  s_add_u32 m0, s33, 139264
  s_waitcnt lgkmcnt(4)
  v_mfma_f32_16x16x32_bf16 v[128:131], v[64:67], a[128:131], v[128:131]
  ds_read_b64_tr_b16 v[70:71], v12 offset:51200
  s_mov_b32 s34, 3538944
  v_mfma_f32_16x16x32_bf16 v[132:135], v[56:59], a[100:103], v[132:135]
  ds_read_b64_tr_b16 v[72:73], v12 offset:53248
  buffer_load_dwordx4 v19, s[4:7], s34 offen lds
  v_mfma_f32_16x16x32_bf16 v[132:135], v[60:63], a[116:119], v[132:135]
  ds_read_b64_tr_b16 v[74:75], v12 offset:55296
  s_add_u32 m0, s33, 143360
  s_waitcnt lgkmcnt(6)
  v_mfma_f32_16x16x32_bf16 v[132:135], v[64:67], a[132:135], v[132:135]
  ds_read_b64_tr_b16 v[76:77], v12 offset:57344
  s_mov_b32 s34, 3833856
  v_mfma_f32_16x16x32_bf16 v[136:139], v[56:59], a[104:107], v[136:139]
  ds_read_b64_tr_b16 v[78:79], v12 offset:59392
  buffer_load_dwordx4 v19, s[4:7], s34 offen lds
  v_mfma_f32_16x16x32_bf16 v[136:139], v[60:63], a[120:123], v[136:139]
  s_add_u32 m0, s33, 90112
  s_waitcnt lgkmcnt(7)
  v_mfma_f32_16x16x32_bf16 v[136:139], v[64:67], a[136:139], v[136:139]
  s_mov_b32 s34, 4128768
  v_mfma_f32_16x16x32_bf16 v[140:143], v[56:59], a[108:111], v[140:143]
  buffer_load_dwordx4 v19, s[4:7], s34 offen lds
  v_mfma_f32_16x16x32_bf16 v[140:143], v[60:63], a[124:127], v[140:143]
  s_waitcnt lgkmcnt(6)
  v_mfma_f32_16x16x32_bf16 v[140:143], v[64:67], a[140:143], v[140:143]
  s_waitcnt lgkmcnt(0)
  v_mfma_f32_16x16x32_bf16 v[144:147], v[68:71], a[96:99], v[144:147]
  ds_read_b64_tr_b16 v[56:57], v9 offset:61440
  s_add_u32 m0, s33, 94208
  v_mfma_f32_16x16x32_bf16 v[144:147], v[72:75], a[112:115], v[144:147]
  ds_read_b64_tr_b16 v[58:59], v9 offset:63488
  s_mov_b32 s34, 3538944
  v_mfma_f32_16x16x32_bf16 v[144:147], v[76:79], a[128:131], v[144:147]
  ds_read_b64_tr_b16 v[60:61], v10
  buffer_load_dwordx4 v19, s[8:11], s34 offen lds
  v_mfma_f32_16x16x32_bf16 v[148:151], v[68:71], a[100:103], v[148:151]
  ds_read_b64_tr_b16 v[62:63], v10 offset:2048
  s_add_u32 m0, s33, 98304
  v_mfma_f32_16x16x32_bf16 v[148:151], v[72:75], a[116:119], v[148:151]
  ds_read_b64_tr_b16 v[64:65], v10 offset:4096
  s_mov_b32 s34, 3833856
  v_mfma_f32_16x16x32_bf16 v[148:151], v[76:79], a[132:135], v[148:151]
  ds_read_b64_tr_b16 v[66:67], v10 offset:6144
  buffer_load_dwordx4 v19, s[8:11], s34 offen lds
  v_mfma_f32_16x16x32_bf16 v[152:155], v[68:71], a[104:107], v[152:155]
  ds_read_b128 a[144:147], v26 offset:24576
  s_add_u32 m0, s33, 147456
  v_mfma_f32_16x16x32_bf16 v[152:155], v[72:75], a[120:123], v[152:155]
  ds_read_b128 a[148:151], v26 offset:25600
  s_mov_b32 s34, 4128768
  v_mfma_f32_16x16x32_bf16 v[152:155], v[76:79], a[136:139], v[152:155]
  ds_read_b128 a[152:155], v26 offset:28672
  buffer_load_dwordx4 v19, s[8:11], s34 offen lds
  v_mfma_f32_16x16x32_bf16 v[156:159], v[68:71], a[108:111], v[156:159]
  ds_read_b128 a[156:159], v26 offset:29696
  v_mfma_f32_16x16x32_bf16 v[156:159], v[72:75], a[124:127], v[156:159]
  v_mfma_f32_16x16x32_bf16 v[156:159], v[76:79], a[140:143], v[156:159]
  s_waitcnt lgkmcnt(4)
  v_mfma_f32_16x16x32_bf16 v[160:163], v[56:59], a[96:99], v[160:163]
  s_waitcnt vmcnt(15)
  s_barrier
  v_mfma_f32_16x16x32_bf16 v[160:163], v[60:63], a[112:115], v[160:163]
  ds_read_b64_tr_b16 v[68:69], v12 offset:61440
  s_add_u32 m0, s33, 151552
  v_mfma_f32_16x16x32_bf16 v[160:163], v[64:67], a[128:131], v[160:163]
  ds_read_b64_tr_b16 v[70:71], v12 offset:63488
  s_mov_b32 s34, 15360
  v_mfma_f32_16x16x32_bf16 v[164:167], v[56:59], a[100:103], v[164:167]
  ds_read_b64_tr_b16 v[72:73], v13
  buffer_load_dwordx4 v23, s[16:19], s34 offen sc1 lds
  v_mfma_f32_16x16x32_bf16 v[164:167], v[60:63], a[116:119], v[164:167]
  ds_read_b64_tr_b16 v[74:75], v13 offset:2048
  s_add_u32 m0, s33, 102400
  v_mfma_f32_16x16x32_bf16 v[164:167], v[64:67], a[132:135], v[164:167]
  ds_read_b64_tr_b16 v[76:77], v13 offset:4096
  s_mov_b32 s34, 52224
  v_mfma_f32_16x16x32_bf16 v[168:171], v[56:59], a[104:107], v[168:171]
  ds_read_b64_tr_b16 v[78:79], v13 offset:6144
  buffer_load_dwordx4 v23, s[16:19], s34 offen sc1 lds
  v_mfma_f32_16x16x32_bf16 v[168:171], v[60:63], a[120:123], v[168:171]
  ds_read_b128 a[160:163], v26 offset:32768
  s_add_u32 m0, s33, 106496
  v_mfma_f32_16x16x32_bf16 v[168:171], v[64:67], a[136:139], v[168:171]
  ds_read_b128 a[164:167], v26 offset:33792
  s_mov_b32 s34, 16384
  v_mfma_f32_16x16x32_bf16 v[172:175], v[56:59], a[108:111], v[172:175]
  ds_read_b128 a[168:171], v26 offset:36864
  buffer_load_dwordx4 v23, s[16:19], s34 offen sc1 lds
  v_mfma_f32_16x16x32_bf16 v[172:175], v[60:63], a[124:127], v[172:175]
  ds_read_b128 a[172:175], v26 offset:37888
  v_mfma_f32_16x16x32_bf16 v[172:175], v[64:67], a[140:143], v[172:175]
  s_waitcnt lgkmcnt(4)
  v_mfma_f32_16x16x32_bf16 v[176:179], v[68:71], a[96:99], v[176:179]
  ds_read_b64_tr_b16 v[56:57], v8 offset:49152
  s_add_u32 m0, s33, 110592
  v_mfma_f32_16x16x32_bf16 v[176:179], v[72:75], a[112:115], v[176:179]
  ds_read_b64_tr_b16 v[58:59], v8 offset:51200
  s_mov_b32 s34, 53248
  v_mfma_f32_16x16x32_bf16 v[176:179], v[76:79], a[128:131], v[176:179]
  ds_read_b64_tr_b16 v[60:61], v8 offset:53248
  buffer_load_dwordx4 v23, s[16:19], s34 offen sc1 lds
  v_mfma_f32_16x16x32_bf16 v[180:183], v[68:71], a[100:103], v[180:183]
  ds_read_b64_tr_b16 v[62:63], v8 offset:55296
  s_add_u32 m0, s33, 155648
  v_mfma_f32_16x16x32_bf16 v[180:183], v[72:75], a[116:119], v[180:183]
  ds_read_b64_tr_b16 v[64:65], v8 offset:57344
  s_mov_b32 s34, 17408
  v_mfma_f32_16x16x32_bf16 v[180:183], v[76:79], a[132:135], v[180:183]
  ds_read_b64_tr_b16 v[66:67], v8 offset:59392
  buffer_load_dwordx4 v23, s[16:19], s34 offen sc1 lds
  v_mfma_f32_16x16x32_bf16 v[184:187], v[68:71], a[104:107], v[184:187]
  ds_read_b128 a[176:179], v26 offset:40960
  s_add_u32 m0, s33, 159744
  v_mfma_f32_16x16x32_bf16 v[184:187], v[72:75], a[120:123], v[184:187]
  ds_read_b128 a[180:183], v26 offset:41984
  s_mov_b32 s34, 54272
  v_mfma_f32_16x16x32_bf16 v[184:187], v[76:79], a[136:139], v[184:187]
  ds_read_b128 a[184:187], v26 offset:45056
  buffer_load_dwordx4 v23, s[16:19], s34 offen sc1 lds
  v_mfma_f32_16x16x32_bf16 v[188:191], v[68:71], a[108:111], v[188:191]
  ds_read_b128 a[188:191], v26 offset:46080
  v_mfma_f32_16x16x32_bf16 v[188:191], v[72:75], a[124:127], v[188:191]
  v_mfma_f32_16x16x32_bf16 v[188:191], v[76:79], a[140:143], v[188:191]
  s_waitcnt lgkmcnt(4)
  v_mfma_f32_16x16x32_bf16 v[128:131], v[56:59], a[144:147], v[128:131]
  s_waitcnt vmcnt(16)
  s_barrier
  v_mfma_f32_16x16x32_bf16 v[128:131], v[60:63], a[160:163], v[128:131]
  ds_read_b64_tr_b16 v[68:69], v11 offset:49152
  s_add_u32 m0, s33, 8192
  s_waitcnt lgkmcnt(4)
  v_mfma_f32_16x16x32_bf16 v[128:131], v[64:67], a[176:179], v[128:131]
  ds_read_b64_tr_b16 v[70:71], v11 offset:51200
  s_mov_b32 s34, 4423680
  v_mfma_f32_16x16x32_bf16 v[132:135], v[56:59], a[148:151], v[132:135]
  ds_read_b64_tr_b16 v[72:73], v11 offset:53248
  buffer_load_dwordx4 v19, s[4:7], s34 offen lds
  v_mfma_f32_16x16x32_bf16 v[132:135], v[60:63], a[164:167], v[132:135]
  ds_read_b64_tr_b16 v[74:75], v11 offset:55296
  s_add_u32 m0, s33, 12288
  s_waitcnt lgkmcnt(6)
  v_mfma_f32_16x16x32_bf16 v[132:135], v[64:67], a[180:183], v[132:135]
  ds_read_b64_tr_b16 v[76:77], v11 offset:57344
  s_mov_b32 s34, 4718592
  v_mfma_f32_16x16x32_bf16 v[136:139], v[56:59], a[152:155], v[136:139]
  ds_read_b64_tr_b16 v[78:79], v11 offset:59392
  buffer_load_dwordx4 v19, s[4:7], s34 offen lds
  v_mfma_f32_16x16x32_bf16 v[136:139], v[60:63], a[168:171], v[136:139]
  s_add_u32 m0, s33, 114688
  s_and_b32 s36, s92, 1
  s_waitcnt lgkmcnt(7)
  v_mfma_f32_16x16x32_bf16 v[136:139], v[64:67], a[184:187], v[136:139]
  s_mov_b32 s34, 5013504
  s_lshl_b32 s37, s36, 12
  v_mfma_f32_16x16x32_bf16 v[140:143], v[56:59], a[156:159], v[140:143]
  buffer_load_dwordx4 v19, s[4:7], s34 offen lds
  v_add_u32 v80, s37, v24
  v_mfma_f32_16x16x32_bf16 v[140:143], v[60:63], a[172:175], v[140:143]
  s_lshl_b32 s37, s36, 9
  v_lshrrev_b32 v81, 1, v24
  s_waitcnt lgkmcnt(6)
  v_mfma_f32_16x16x32_bf16 v[140:143], v[64:67], a[188:191], v[140:143]
  v_add_u32 v81, s37, v81
  s_waitcnt lgkmcnt(0)
  v_mfma_f32_16x16x32_bf16 v[144:147], v[68:71], a[144:147], v[144:147]
  ds_read_b64_tr_b16 v[56:57], v8 offset:61440
  s_add_u32 m0, s33, 118784
  v_mfma_f32_16x16x32_bf16 v[144:147], v[72:75], a[160:163], v[144:147]
  ds_read_b64_tr_b16 v[58:59], v8 offset:63488
  s_mov_b32 s34, 4423680
  v_mfma_f32_16x16x32_bf16 v[144:147], v[76:79], a[176:179], v[144:147]
  ds_read_b64_tr_b16 v[60:61], v9
  buffer_load_dwordx4 v19, s[8:11], s34 offen lds
  v_mfma_f32_16x16x32_bf16 v[148:151], v[68:71], a[148:151], v[148:151]
  ds_read_b64_tr_b16 v[62:63], v9 offset:2048
  s_add_u32 m0, s33, 122880
  v_mfma_f32_16x16x32_bf16 v[148:151], v[72:75], a[164:167], v[148:151]
  ds_read_b64_tr_b16 v[64:65], v9 offset:4096
  s_mov_b32 s34, 4718592
  v_mfma_f32_16x16x32_bf16 v[148:151], v[76:79], a[180:183], v[148:151]
  ds_read_b64_tr_b16 v[66:67], v9 offset:6144
  buffer_load_dwordx4 v19, s[8:11], s34 offen lds
  v_mfma_f32_16x16x32_bf16 v[152:155], v[68:71], a[152:155], v[152:155]
  ds_read_b128 a[192:195], v27 offset:8192
  s_add_u32 m0, s33, 16384
  v_mfma_f32_16x16x32_bf16 v[152:155], v[72:75], a[168:171], v[152:155]
  ds_read_b128 a[196:199], v27 offset:9216
  s_mov_b32 s34, 5013504
  v_mfma_f32_16x16x32_bf16 v[152:155], v[76:79], a[184:187], v[152:155]
  ds_read_b128 a[200:203], v27 offset:12288
  buffer_load_dwordx4 v19, s[8:11], s34 offen lds
  v_mfma_f32_16x16x32_bf16 v[156:159], v[68:71], a[156:159], v[156:159]
  ds_read_b128 a[204:207], v27 offset:13312
  v_mfma_f32_16x16x32_bf16 v[156:159], v[72:75], a[172:175], v[156:159]
  v_mfma_f32_16x16x32_bf16 v[156:159], v[76:79], a[188:191], v[156:159]
  s_waitcnt lgkmcnt(4)
  v_mfma_f32_16x16x32_bf16 v[160:163], v[56:59], a[144:147], v[160:163]
  s_waitcnt vmcnt(15)
  s_barrier
  v_mfma_f32_16x16x32_bf16 v[160:163], v[60:63], a[160:163], v[160:163]
  ds_read_b64_tr_b16 v[68:69], v11 offset:61440
  s_add_u32 m0, s33, 20480
  v_mfma_f32_16x16x32_bf16 v[160:163], v[64:67], a[176:179], v[160:163]
  ds_read_b64_tr_b16 v[70:71], v11 offset:63488
  s_mov_b32 s34, 128
  v_mfma_f32_16x16x32_bf16 v[164:167], v[56:59], a[148:151], v[164:167]
  ds_read_b64_tr_b16 v[72:73], v12
  buffer_load_dwordx4 v19, s[4:7], s34 offen lds
  v_mfma_f32_16x16x32_bf16 v[164:167], v[60:63], a[164:167], v[164:167]
  ds_read_b64_tr_b16 v[74:75], v12 offset:2048
  s_add_u32 m0, s33, 135168
  v_mfma_f32_16x16x32_bf16 v[164:167], v[64:67], a[180:183], v[164:167]
  ds_read_b64_tr_b16 v[76:77], v12 offset:4096
  s_mov_b32 s34, 295040
  v_mfma_f32_16x16x32_bf16 v[168:171], v[56:59], a[152:155], v[168:171]
  ds_read_b64_tr_b16 v[78:79], v12 offset:6144
  ds_read_b64 a[208:209], v22
  buffer_load_dwordx4 v19, s[4:7], s34 offen lds
  v_mfma_f32_16x16x32_bf16 v[168:171], v[60:63], a[168:171], v[168:171]
  ds_read_b64 a[210:211], v22 offset:512
  ds_read_b64 a[212:213], v22 offset:1024
  s_add_u32 m0, s33, 24576
  v_mfma_f32_16x16x32_bf16 v[168:171], v[64:67], a[184:187], v[168:171]
  ds_read_b64 a[214:215], v22 offset:1536
  ds_read_b64 a[216:217], v22 offset:4096
  s_mov_b32 s34, 589952
  v_mfma_f32_16x16x32_bf16 v[172:175], v[56:59], a[156:159], v[172:175]
  ds_read_b64 a[218:219], v22 offset:4608
  ds_read_b64 a[220:221], v22 offset:5120
  buffer_load_dwordx4 v19, s[4:7], s34 offen lds
  v_mfma_f32_16x16x32_bf16 v[172:175], v[60:63], a[172:175], v[172:175]
  ds_read_b64 a[222:223], v22 offset:5632
  v_mfma_f32_16x16x32_bf16 v[172:175], v[64:67], a[188:191], v[172:175]
  s_waitcnt lgkmcnt(8)
  v_mfma_f32_16x16x32_bf16 v[176:179], v[68:71], a[144:147], v[176:179]
  ds_read_b64_tr_b16 v[56:57], v10 offset:8192
  v_mfma_f32_16x16x32_bf16 v[176:179], v[72:75], a[160:163], v[176:179]
  ds_read_b64_tr_b16 v[58:59], v10 offset:10240
  v_mfma_f32_16x16x32_bf16 v[176:179], v[76:79], a[176:179], v[176:179]
  ds_read_b64_tr_b16 v[60:61], v10 offset:12288
  v_mfma_f32_16x16x32_bf16 v[180:183], v[68:71], a[148:151], v[180:183]
  ds_read_b64_tr_b16 v[62:63], v10 offset:14336
  v_mfma_f32_16x16x32_bf16 v[180:183], v[72:75], a[164:167], v[180:183]
  ds_read_b64_tr_b16 v[64:65], v9 offset:24576
  v_mfma_f32_16x16x32_bf16 v[180:183], v[76:79], a[180:183], v[180:183]
  ds_read_b64_tr_b16 v[66:67], v9 offset:26624
  v_mfma_f32_16x16x32_bf16 v[184:187], v[68:71], a[152:155], v[184:187]
  ds_read_b128 a[224:227], v27 offset:16384
  v_mfma_f32_16x16x32_bf16 v[184:187], v[72:75], a[168:171], v[184:187]
  ds_read_b128 a[228:231], v27 offset:17408
  v_mfma_f32_16x16x32_bf16 v[184:187], v[76:79], a[184:187], v[184:187]
  ds_read_b128 a[232:235], v27 offset:20480
  v_mfma_f32_16x16x32_bf16 v[188:191], v[68:71], a[156:159], v[188:191]
  ds_read_b128 a[236:239], v27 offset:21504
  v_mfma_f32_16x16x32_bf16 v[188:191], v[72:75], a[172:175], v[188:191]
  v_mfma_f32_16x16x32_bf16 v[188:191], v[76:79], a[188:191], v[188:191]
  s_waitcnt lgkmcnt(4)
  v_mfma_f32_16x16x32_bf16 v[128:131], v[56:59], a[192:195], v[128:131]
  s_waitcnt vmcnt(13)
  s_barrier
  v_mfma_f32_16x16x32_bf16 v[128:131], v[60:63], a[208:211], v[128:131]
  ds_read_b64_tr_b16 v[68:69], v13 offset:8192
  s_add_u32 m0, s33, 28672
  s_waitcnt lgkmcnt(4)
  v_mfma_f32_16x16x32_bf16 v[128:131], v[64:67], a[224:227], v[128:131]
  ds_read_b64_tr_b16 v[70:71], v13 offset:10240
  s_mov_b32 s34, 128
  v_mfma_f32_16x16x32_bf16 v[132:135], v[56:59], a[196:199], v[132:135]
  ds_read_b64_tr_b16 v[72:73], v13 offset:12288
  buffer_load_dwordx4 v19, s[8:11], s34 offen lds
  v_mfma_f32_16x16x32_bf16 v[132:135], v[60:63], a[212:215], v[132:135]
  ds_read_b64_tr_b16 v[74:75], v13 offset:14336
  s_add_u32 m0, s33, 32768
  s_waitcnt lgkmcnt(6)
  v_mfma_f32_16x16x32_bf16 v[132:135], v[64:67], a[228:231], v[132:135]
  ds_read_b64_tr_b16 v[76:77], v12 offset:24576
  s_mov_b32 s34, 295040
  v_mfma_f32_16x16x32_bf16 v[136:139], v[56:59], a[200:203], v[136:139]
  ds_read_b64_tr_b16 v[78:79], v12 offset:26624
  buffer_load_dwordx4 v19, s[8:11], s34 offen lds
  v_mfma_f32_16x16x32_bf16 v[136:139], v[60:63], a[216:219], v[136:139]
  s_add_u32 m0, s33, 36864
  s_waitcnt lgkmcnt(7)
  v_mfma_f32_16x16x32_bf16 v[136:139], v[64:67], a[232:235], v[136:139]
  s_mov_b32 s34, 589952
  v_mfma_f32_16x16x32_bf16 v[140:143], v[56:59], a[204:207], v[140:143]
  buffer_load_dwordx4 v19, s[8:11], s34 offen lds
  v_mfma_f32_16x16x32_bf16 v[140:143], v[60:63], a[220:223], v[140:143]
  s_waitcnt lgkmcnt(6)
  v_mfma_f32_16x16x32_bf16 v[140:143], v[64:67], a[236:239], v[140:143]
  s_waitcnt lgkmcnt(0)
  v_mfma_f32_16x16x32_bf16 v[144:147], v[68:71], a[192:195], v[144:147]
  ds_read_b64_tr_b16 v[56:57], v9 offset:28672
  v_mfma_f32_16x16x32_bf16 v[144:147], v[72:75], a[208:211], v[144:147]
  ds_read_b64_tr_b16 v[58:59], v9 offset:30720
  v_mfma_f32_16x16x32_bf16 v[144:147], v[76:79], a[224:227], v[144:147]
  ds_read_b64_tr_b16 v[60:61], v9 offset:32768
  v_mfma_f32_16x16x32_bf16 v[148:151], v[68:71], a[196:199], v[148:151]
  ds_read_b64_tr_b16 v[62:63], v9 offset:34816
  v_mfma_f32_16x16x32_bf16 v[148:151], v[72:75], a[212:215], v[148:151]
  ds_read_b64_tr_b16 v[64:65], v10 offset:16384
  v_mfma_f32_16x16x32_bf16 v[148:151], v[76:79], a[228:231], v[148:151]
  ds_read_b64_tr_b16 v[66:67], v10 offset:18432
  v_mfma_f32_16x16x32_bf16 v[152:155], v[68:71], a[200:203], v[152:155]
  ds_read_b128 a[240:243], v28 offset:20480
  v_mfma_f32_16x16x32_bf16 v[152:155], v[72:75], a[216:219], v[152:155]
  ds_read_b128 a[244:247], v28 offset:21504
  v_mfma_f32_16x16x32_bf16 v[152:155], v[76:79], a[232:235], v[152:155]
  ds_read_b128 a[248:251], v27 offset:36864
  v_mfma_f32_16x16x32_bf16 v[156:159], v[68:71], a[204:207], v[156:159]
  ds_read_b128 a[252:255], v27 offset:37888
  v_mfma_f32_16x16x32_bf16 v[156:159], v[72:75], a[220:223], v[156:159]
  v_mfma_f32_16x16x32_bf16 v[156:159], v[76:79], a[236:239], v[156:159]
  s_waitcnt lgkmcnt(4)
  v_mfma_f32_16x16x32_bf16 v[160:163], v[56:59], a[192:195], v[160:163]
  s_waitcnt vmcnt(9)
  s_barrier
  v_mfma_f32_16x16x32_bf16 v[160:163], v[60:63], a[208:211], v[160:163]
  ds_read_b64_tr_b16 v[68:69], v12 offset:28672
  s_add_u32 m0, s33, 40960
  v_mfma_f32_16x16x32_bf16 v[160:163], v[64:67], a[224:227], v[160:163]
  ds_read_b64_tr_b16 v[70:71], v12 offset:30720
  s_mov_b32 s34, 884864
  v_mfma_f32_16x16x32_bf16 v[164:167], v[56:59], a[196:199], v[164:167]
  ds_read_b64_tr_b16 v[72:73], v12 offset:32768
  buffer_load_dwordx4 v19, s[4:7], s34 offen lds
  v_mfma_f32_16x16x32_bf16 v[164:167], v[60:63], a[212:215], v[164:167]
  ds_read_b64_tr_b16 v[74:75], v12 offset:34816
  s_add_u32 m0, s33, 45056
  v_mfma_f32_16x16x32_bf16 v[164:167], v[64:67], a[228:231], v[164:167]
  ds_read_b64_tr_b16 v[76:77], v13 offset:16384
  s_mov_b32 s34, 1179776
  v_mfma_f32_16x16x32_bf16 v[168:171], v[56:59], a[200:203], v[168:171]
  ds_read_b64_tr_b16 v[78:79], v13 offset:18432
  buffer_load_dwordx4 v19, s[4:7], s34 offen lds
  v_mfma_f32_16x16x32_bf16 v[168:171], v[60:63], a[216:219], v[168:171]
  ds_read_b128 v[96:99], v27 offset:40960
  s_add_u32 m0, s33, 49152
  v_mfma_f32_16x16x32_bf16 v[168:171], v[64:67], a[232:235], v[168:171]
  ds_read_b128 v[100:103], v27 offset:41984
  s_mov_b32 s34, 1474688
  v_mfma_f32_16x16x32_bf16 v[172:175], v[56:59], a[204:207], v[172:175]
  ds_read_b128 v[104:107], v27 offset:45056
  buffer_load_dwordx4 v19, s[4:7], s34 offen lds
  v_mfma_f32_16x16x32_bf16 v[172:175], v[60:63], a[220:223], v[172:175]
  ds_read_b128 v[108:111], v27 offset:46080
  v_mfma_f32_16x16x32_bf16 v[172:175], v[64:67], a[236:239], v[172:175]
  s_waitcnt lgkmcnt(4)
  v_mfma_f32_16x16x32_bf16 v[176:179], v[68:71], a[192:195], v[176:179]
  ds_read_b64_tr_b16 v[56:57], v8 offset:8192
  v_mfma_f32_16x16x32_bf16 v[176:179], v[72:75], a[208:211], v[176:179]
  ds_read_b64_tr_b16 v[58:59], v8 offset:10240
  v_mfma_f32_16x16x32_bf16 v[176:179], v[76:79], a[224:227], v[176:179]
  ds_read_b64_tr_b16 v[60:61], v8 offset:12288
  v_mfma_f32_16x16x32_bf16 v[180:183], v[68:71], a[196:199], v[180:183]
  ds_read_b64_tr_b16 v[62:63], v8 offset:14336
  v_mfma_f32_16x16x32_bf16 v[180:183], v[72:75], a[212:215], v[180:183]
  ds_read_b64_tr_b16 v[64:65], v9 offset:49152
  v_mfma_f32_16x16x32_bf16 v[180:183], v[76:79], a[228:231], v[180:183]
  ds_read_b64_tr_b16 v[66:67], v9 offset:51200
  v_mfma_f32_16x16x32_bf16 v[184:187], v[68:71], a[200:203], v[184:187]
  ds_read_b128 v[112:115], v28 offset:24576
  v_mfma_f32_16x16x32_bf16 v[184:187], v[72:75], a[216:219], v[184:187]
  ds_read_b128 v[116:119], v28 offset:25600
  v_mfma_f32_16x16x32_bf16 v[184:187], v[76:79], a[232:235], v[184:187]
  ds_read_b128 v[120:123], v28 offset:28672
  v_mfma_f32_16x16x32_bf16 v[188:191], v[68:71], a[204:207], v[188:191]
  ds_read_b128 v[124:127], v28 offset:29696
  v_mfma_f32_16x16x32_bf16 v[188:191], v[72:75], a[220:223], v[188:191]
  v_mfma_f32_16x16x32_bf16 v[188:191], v[76:79], a[236:239], v[188:191]
  s_waitcnt lgkmcnt(4)
  v_mfma_f32_16x16x32_bf16 v[128:131], v[56:59], a[240:243], v[128:131]
  s_waitcnt vmcnt(9)
  s_barrier
  v_mfma_f32_16x16x32_bf16 v[128:131], v[60:63], v[96:99], v[128:131]
  ds_read_b64_tr_b16 v[68:69], v11 offset:8192
  s_add_u32 m0, s33, 53248
  s_waitcnt lgkmcnt(4)
  v_mfma_f32_16x16x32_bf16 v[128:131], v[64:67], v[112:115], v[128:131]
  ds_read_b64_tr_b16 v[70:71], v11 offset:10240
  s_mov_b32 s34, 884864
  v_mfma_f32_16x16x32_bf16 v[132:135], v[56:59], a[244:247], v[132:135]
  ds_read_b64_tr_b16 v[72:73], v11 offset:12288
  buffer_load_dwordx4 v19, s[8:11], s34 offen lds
  v_mfma_f32_16x16x32_bf16 v[132:135], v[60:63], v[100:103], v[132:135]
  ds_read_b64_tr_b16 v[74:75], v11 offset:14336
  s_add_u32 m0, s33, 57344
  s_waitcnt lgkmcnt(6)
  v_mfma_f32_16x16x32_bf16 v[132:135], v[64:67], v[116:119], v[132:135]
  ds_read_b64_tr_b16 v[76:77], v12 offset:49152
  s_mov_b32 s34, 1179776
  v_mfma_f32_16x16x32_bf16 v[136:139], v[56:59], a[248:251], v[136:139]
  ds_read_b64_tr_b16 v[78:79], v12 offset:51200
  buffer_load_dwordx4 v19, s[8:11], s34 offen lds
  v_mfma_f32_16x16x32_bf16 v[136:139], v[60:63], v[104:107], v[136:139]
  s_add_u32 m0, s33, 61440
  v_lshrrev_b32 v4, 1, v0
  s_waitcnt lgkmcnt(7)
  v_mfma_f32_16x16x32_bf16 v[136:139], v[64:67], v[120:123], v[136:139]
  s_mov_b32 s34, 1474688
  s_mul_i32 s36, s93, 36
  v_mfma_f32_16x16x32_bf16 v[140:143], v[56:59], a[252:255], v[140:143]
  buffer_load_dwordx4 v19, s[8:11], s34 offen lds
  v_add_u32 v4, s36, v4
  v_mfma_f32_16x16x32_bf16 v[140:143], v[60:63], v[108:111], v[140:143]
  v_mul_u32_u24 v4, 9216, v4
  s_mul_i32 s36, s94, 576
  s_waitcnt lgkmcnt(6)
  v_mfma_f32_16x16x32_bf16 v[140:143], v[64:67], v[124:127], v[140:143]
  s_and_b32 s37, s94, 1
  s_waitcnt lgkmcnt(0)
  v_mfma_f32_16x16x32_bf16 v[144:147], v[68:71], a[240:243], v[144:147]
  ds_read_b64_tr_b16 v[56:57], v9 offset:53248
  s_lshl_b32 s38, s37, 6
  v_mfma_f32_16x16x32_bf16 v[144:147], v[72:75], v[96:99], v[144:147]
  ds_read_b64_tr_b16 v[58:59], v9 offset:55296
  s_add_u32 s36, s36, s38
  v_mfma_f32_16x16x32_bf16 v[144:147], v[76:79], v[112:115], v[144:147]
  ds_read_b64_tr_b16 v[60:61], v9 offset:57344
  s_add_u32 s36, s36, 384
  v_mfma_f32_16x16x32_bf16 v[148:151], v[68:71], a[244:247], v[148:151]
  ds_read_b64_tr_b16 v[62:63], v9 offset:59392
  s_cmp_eq_u32 s37, 0
  s_cselect_b32 s37, 2, -7
  v_mfma_f32_16x16x32_bf16 v[148:151], v[72:75], v[100:103], v[148:151]
  ds_read_b64_tr_b16 v[64:65], v8 offset:16384
  s_mul_i32 s37, s37, 64
  v_mfma_f32_16x16x32_bf16 v[148:151], v[76:79], v[116:119], v[148:151]
  ds_read_b64_tr_b16 v[66:67], v8 offset:18432
  v_and_b32 v5, 1, v0
  v_mfma_f32_16x16x32_bf16 v[152:155], v[68:71], a[248:251], v[152:155]
  v_mul_lo_u32 v5, v5, s37
  v_add3_u32 v4, v4, v5, s36
  v_mfma_f32_16x16x32_bf16 v[152:155], v[72:75], v[104:107], v[152:155]
  v_mov_b32 v6, 0x7ffffff0
  v_cmp_gt_u32 vcc, 72, v0
  v_mfma_f32_16x16x32_bf16 v[152:155], v[76:79], v[120:123], v[152:155]
  s_nop 0
  v_cndmask_b32 v92, v6, v4, vcc
  s_cmp_eq_u32 s95, 0
  s_cselect_b32 s36, 0, 0x7ffffff0
  v_mfma_f32_16x16x32_bf16 v[156:159], v[68:71], a[252:255], v[156:159]
  v_or_b32 v92, s36, v92
  s_mul_i32 s36, s94, 16
  v_mfma_f32_16x16x32_bf16 v[156:159], v[72:75], v[108:111], v[156:159]
  s_and_b32 s37, s93, 15
  s_add_u32 s36, s36, s37
  v_mfma_f32_16x16x32_bf16 v[156:159], v[76:79], v[124:127], v[156:159]
  s_mul_i32 s36, s36, 20736
  s_waitcnt lgkmcnt(0)
  v_mfma_f32_16x16x32_bf16 v[160:163], v[56:59], a[240:243], v[160:163]
  s_waitcnt vmcnt(9)
  s_barrier
  v_mfma_f32_16x16x32_bf16 v[160:163], v[60:63], v[96:99], v[160:163]
  ds_read_b64_tr_b16 v[68:69], v12 offset:53248
  s_add_u32 m0, s33, 65536
  v_mfma_f32_16x16x32_bf16 v[160:163], v[64:67], v[112:115], v[160:163]
  ds_read_b64_tr_b16 v[70:71], v12 offset:55296
  s_mov_b32 s34, 1769600
  v_mfma_f32_16x16x32_bf16 v[164:167], v[56:59], a[244:247], v[164:167]
  ds_read_b64_tr_b16 v[72:73], v12 offset:57344
  buffer_load_dwordx4 v19, s[4:7], s34 offen lds
  v_mfma_f32_16x16x32_bf16 v[164:167], v[60:63], v[100:103], v[164:167]
  ds_read_b64_tr_b16 v[74:75], v12 offset:59392
  s_add_u32 m0, s33, 69632
  v_mfma_f32_16x16x32_bf16 v[164:167], v[64:67], v[116:119], v[164:167]
  ds_read_b64_tr_b16 v[76:77], v11 offset:16384
  s_mov_b32 s34, 2064512
  v_mfma_f32_16x16x32_bf16 v[168:171], v[56:59], a[248:251], v[168:171]
  ds_read_b64_tr_b16 v[78:79], v11 offset:18432
  buffer_load_dwordx4 v19, s[4:7], s34 offen lds
  v_mfma_f32_16x16x32_bf16 v[168:171], v[60:63], v[104:107], v[168:171]
  s_add_u32 m0, s33, 73728
  v_lshl_add_u32 v93, v0, 7, s36
  v_mfma_f32_16x16x32_bf16 v[168:171], v[64:67], v[120:123], v[168:171]
  s_mov_b32 s34, 2359424
  s_cmp_eq_u32 s95, 0
  s_cselect_b32 s36, 0, 0x7ffffff0
  v_mfma_f32_16x16x32_bf16 v[172:175], v[56:59], a[252:255], v[172:175]
  buffer_load_dwordx4 v19, s[4:7], s34 offen lds
  v_or_b32 v93, s36, v93
  v_mfma_f32_16x16x32_bf16 v[172:175], v[60:63], v[108:111], v[172:175]
  v_mfma_f32_16x16x32_bf16 v[172:175], v[64:67], v[124:127], v[172:175]
  s_waitcnt lgkmcnt(0)
  v_mfma_f32_16x16x32_bf16 v[176:179], v[68:71], a[240:243], v[176:179]
  ds_read_b64_tr_b16 v[56:57], v8 offset:20480
  v_mfma_f32_16x16x32_bf16 v[176:179], v[72:75], v[96:99], v[176:179]
  ds_read_b64_tr_b16 v[58:59], v8 offset:22528
  v_mfma_f32_16x16x32_bf16 v[176:179], v[76:79], v[112:115], v[176:179]
  ds_read_b64_tr_b16 v[60:61], v10 offset:4096
  v_mfma_f32_16x16x32_bf16 v[180:183], v[68:71], a[244:247], v[180:183]
  ds_read_b64_tr_b16 v[62:63], v10 offset:6144
  v_mfma_f32_16x16x32_bf16 v[180:183], v[72:75], v[100:103], v[180:183]
  ds_read_b64_tr_b16 v[64:65], v8 offset:24576
  v_mfma_f32_16x16x32_bf16 v[180:183], v[76:79], v[116:119], v[180:183]
  ds_read_b64_tr_b16 v[66:67], v8 offset:26624
  v_mfma_f32_16x16x32_bf16 v[184:187], v[68:71], a[248:251], v[184:187]
  v_mfma_f32_16x16x32_bf16 v[184:187], v[72:75], v[104:107], v[184:187]
  v_mfma_f32_16x16x32_bf16 v[184:187], v[76:79], v[120:123], v[184:187]
  v_mfma_f32_16x16x32_bf16 v[188:191], v[68:71], a[252:255], v[188:191]
  v_mfma_f32_16x16x32_bf16 v[188:191], v[72:75], v[108:111], v[188:191]
  v_mfma_f32_16x16x32_bf16 v[188:191], v[76:79], v[124:127], v[188:191]
  s_waitcnt lgkmcnt(0)
  v_mfma_f32_16x16x32_bf16 v[192:195], v[56:59], a[0:3], 0
  s_waitcnt vmcnt(6)
  s_barrier
  v_mfma_f32_16x16x32_bf16 v[192:195], v[60:63], a[16:19], v[192:195]
  ds_read_b64_tr_b16 v[68:69], v11 offset:20480
  v_mul_f32 v128, v128, v160
  v_mfma_f32_16x16x32_bf16 v[192:195], v[64:67], a[32:35], v[192:195]
  ds_read_b64_tr_b16 v[70:71], v11 offset:22528
  v_mul_f32 v129, v129, v161
  v_mfma_f32_16x16x32_bf16 v[196:199], v[56:59], a[4:7], 0
  ds_read_b64_tr_b16 v[72:73], v13 offset:4096
  v_mul_f32 v130, v130, v162
  v_mfma_f32_16x16x32_bf16 v[196:199], v[60:63], a[20:23], v[196:199]
  ds_read_b64_tr_b16 v[74:75], v13 offset:6144
  v_mul_f32 v131, v131, v163
  v_mfma_f32_16x16x32_bf16 v[196:199], v[64:67], a[36:39], v[196:199]
  ds_read_b64_tr_b16 v[76:77], v11 offset:24576
  v_cvt_pk_bf16_f32 v32, v128, v129
  v_mfma_f32_16x16x32_bf16 v[200:203], v[56:59], a[8:11], 0
  ds_read_b64_tr_b16 v[78:79], v11 offset:26624
  v_cvt_pk_bf16_f32 v33, v130, v131
  v_mfma_f32_16x16x32_bf16 v[200:203], v[60:63], a[24:27], v[200:203]
  s_add_u32 m0, s33, 77824
  v_mul_f32 v144, v144, v176
  v_mfma_f32_16x16x32_bf16 v[200:203], v[64:67], a[40:43], v[200:203]
  s_mov_b32 s34, 1769600
  v_mul_f32 v145, v145, v177
  v_mfma_f32_16x16x32_bf16 v[204:207], v[56:59], a[12:15], 0
  buffer_load_dwordx4 v19, s[8:11], s34 offen lds
  v_mul_f32 v146, v146, v178
  v_mfma_f32_16x16x32_bf16 v[204:207], v[60:63], a[28:31], v[204:207]
  s_add_u32 m0, s33, 0
  v_mul_f32 v147, v147, v179
  v_mfma_f32_16x16x32_bf16 v[204:207], v[64:67], a[44:47], v[204:207]
  s_mov_b32 s34, 2064512
  buffer_load_dwordx4 v19, s[8:11], s34 offen lds
  s_waitcnt lgkmcnt(0)
  v_mfma_f32_16x16x32_bf16 v[208:211], v[68:71], a[0:3], 0
  ds_read_b64_tr_b16 v[56:57], v8 offset:28672
  v_cvt_pk_bf16_f32 v34, v144, v145
  v_mfma_f32_16x16x32_bf16 v[208:211], v[72:75], a[16:19], v[208:211]
  ds_read_b64_tr_b16 v[58:59], v8 offset:30720
  v_cvt_pk_bf16_f32 v35, v146, v147
  v_mfma_f32_16x16x32_bf16 v[208:211], v[76:79], a[32:35], v[208:211]
  ds_read_b64_tr_b16 v[60:61], v8 offset:32768
  ds_write_b128 v17, v[32:35]
  v_mfma_f32_16x16x32_bf16 v[212:215], v[68:71], a[4:7], 0
  ds_read_b64_tr_b16 v[62:63], v8 offset:34816
  s_mov_b32 s61, 0
  v_mfma_f32_16x16x32_bf16 v[212:215], v[72:75], a[20:23], v[212:215]
  ds_read_b64_tr_b16 v[64:65], v8 offset:36864
  buffer_store_dwordx4 v[32:35], v80, s[28:31], s61 offen sc1
  v_mfma_f32_16x16x32_bf16 v[212:215], v[76:79], a[36:39], v[212:215]
  ds_read_b64_tr_b16 v[66:67], v8 offset:38912
  v_mul_f32 v132, v132, v164
  v_mfma_f32_16x16x32_bf16 v[216:219], v[68:71], a[8:11], 0
  s_add_u32 m0, s33, 4096
  v_mul_f32 v133, v133, v165
  v_mfma_f32_16x16x32_bf16 v[216:219], v[72:75], a[24:27], v[216:219]
  s_mov_b32 s34, 2359424
  v_mul_f32 v134, v134, v166
  v_mfma_f32_16x16x32_bf16 v[216:219], v[76:79], a[40:43], v[216:219]
  buffer_load_dwordx4 v19, s[8:11], s34 offen lds
  v_mul_f32 v135, v135, v167
  v_mfma_f32_16x16x32_bf16 v[220:223], v[68:71], a[12:15], 0
  s_add_u32 m0, s33, 81920
  v_cvt_pk_bf16_f32 v36, v132, v133
  v_mfma_f32_16x16x32_bf16 v[220:223], v[72:75], a[28:31], v[220:223]
  s_mov_b32 s34, 2654336
  v_cvt_pk_bf16_f32 v37, v134, v135
  v_mfma_f32_16x16x32_bf16 v[220:223], v[76:79], a[44:47], v[220:223]
  buffer_load_dwordx4 v19, s[4:7], s34 offen lds
  s_waitcnt lgkmcnt(0)
  v_mfma_f32_16x16x32_bf16 v[224:227], v[56:59], a[0:3], 0
  ds_read_b64_tr_b16 v[68:69], v11 offset:28672
  v_mul_f32 v148, v148, v180
  v_mfma_f32_16x16x32_bf16 v[224:227], v[60:63], a[16:19], v[224:227]
  ds_read_b64_tr_b16 v[70:71], v11 offset:30720
  v_mul_f32 v149, v149, v181
  v_mfma_f32_16x16x32_bf16 v[224:227], v[64:67], a[32:35], v[224:227]
  ds_read_b64_tr_b16 v[72:73], v11 offset:32768
  v_mul_f32 v150, v150, v182
  v_mfma_f32_16x16x32_bf16 v[228:231], v[56:59], a[4:7], 0
  ds_read_b64_tr_b16 v[74:75], v11 offset:34816
  v_mul_f32 v151, v151, v183
  v_mfma_f32_16x16x32_bf16 v[228:231], v[60:63], a[20:23], v[228:231]
  ds_read_b64_tr_b16 v[76:77], v11 offset:36864
  v_cvt_pk_bf16_f32 v38, v148, v149
  v_mfma_f32_16x16x32_bf16 v[228:231], v[64:67], a[36:39], v[228:231]
  ds_read_b64_tr_b16 v[78:79], v11 offset:38912
  v_cvt_pk_bf16_f32 v39, v150, v151
  v_mfma_f32_16x16x32_bf16 v[232:235], v[56:59], a[8:11], 0
  s_add_u32 m0, s33, 86016
  ds_write_b128 v17, v[36:39] offset:1024
  v_mfma_f32_16x16x32_bf16 v[232:235], v[60:63], a[24:27], v[232:235]
  s_mov_b32 s34, 2949248
  s_mov_b32 s61, 1024
  v_mfma_f32_16x16x32_bf16 v[232:235], v[64:67], a[40:43], v[232:235]
  buffer_load_dwordx4 v19, s[4:7], s34 offen lds
  buffer_store_dwordx4 v[36:39], v80, s[28:31], s61 offen sc1
  v_mfma_f32_16x16x32_bf16 v[236:239], v[56:59], a[12:15], 0
  s_add_u32 m0, s33, 139264
  v_mul_f32 v136, v136, v168
  v_mfma_f32_16x16x32_bf16 v[236:239], v[60:63], a[28:31], v[236:239]
  s_mov_b32 s34, 3244160
  v_mul_f32 v137, v137, v169
  v_mfma_f32_16x16x32_bf16 v[236:239], v[64:67], a[44:47], v[236:239]
  buffer_load_dwordx4 v19, s[4:7], s34 offen lds
  s_waitcnt lgkmcnt(1)
  v_mfma_f32_16x16x32_bf16 v[240:243], v[68:71], a[0:3], 0
  ds_read_b64_tr_b16 v[56:57], v8 offset:40960
  v_mul_f32 v138, v138, v170
  v_mfma_f32_16x16x32_bf16 v[240:243], v[72:75], a[16:19], v[240:243]
  ds_read_b64_tr_b16 v[58:59], v8 offset:43008
  v_mul_f32 v139, v139, v171
  v_mfma_f32_16x16x32_bf16 v[240:243], v[76:79], a[32:35], v[240:243]
  ds_read_b64_tr_b16 v[60:61], v8 offset:45056
  v_cvt_pk_bf16_f32 v32, v136, v137
  v_mfma_f32_16x16x32_bf16 v[244:247], v[68:71], a[4:7], 0
  ds_read_b64_tr_b16 v[62:63], v8 offset:47104
  v_cvt_pk_bf16_f32 v33, v138, v139
  v_mfma_f32_16x16x32_bf16 v[244:247], v[72:75], a[20:23], v[244:247]
  ds_read_b64_tr_b16 v[64:65], v8 offset:49152
  v_mul_f32 v152, v152, v184
  v_mfma_f32_16x16x32_bf16 v[244:247], v[76:79], a[36:39], v[244:247]
  ds_read_b64_tr_b16 v[66:67], v8 offset:51200
  v_mul_f32 v153, v153, v185
  v_mfma_f32_16x16x32_bf16 v[248:251], v[68:71], a[8:11], 0
  s_add_u32 m0, s33, 143360
  v_mul_f32 v154, v154, v186
  v_mfma_f32_16x16x32_bf16 v[248:251], v[72:75], a[24:27], v[248:251]
  s_mov_b32 s34, 2654336
  v_mul_f32 v155, v155, v187
  v_mfma_f32_16x16x32_bf16 v[248:251], v[76:79], a[40:43], v[248:251]
  buffer_load_dwordx4 v19, s[8:11], s34 offen lds
  v_cvt_pk_bf16_f32 v34, v152, v153
  v_mfma_f32_16x16x32_bf16 v[252:255], v[68:71], a[12:15], 0
  s_add_u32 m0, s33, 98304
  v_cvt_pk_bf16_f32 v35, v154, v155
  v_mfma_f32_16x16x32_bf16 v[252:255], v[72:75], a[28:31], v[252:255]
  s_mov_b32 s34, 2949248
  ds_write_b128 v17, v[32:35] offset:2048
  v_mfma_f32_16x16x32_bf16 v[252:255], v[76:79], a[44:47], v[252:255]
  buffer_load_dwordx4 v19, s[8:11], s34 offen lds
  s_waitcnt lgkmcnt(1)
  v_mfma_f32_16x16x32_bf16 v[192:195], v[56:59], a[48:51], v[192:195]
  s_waitcnt vmcnt(10)
  s_barrier
  v_mfma_f32_16x16x32_bf16 v[192:195], v[60:63], a[64:67], v[192:195]
  ds_read_b64_tr_b16 v[68:69], v11 offset:40960
  s_mov_b32 s61, 2048
  v_mfma_f32_16x16x32_bf16 v[192:195], v[64:67], a[80:83], v[192:195]
  ds_read_b64_tr_b16 v[70:71], v11 offset:43008
  buffer_store_dwordx4 v[32:35], v80, s[28:31], s61 offen sc1
  v_mfma_f32_16x16x32_bf16 v[196:199], v[56:59], a[52:55], v[196:199]
  ds_read_b64_tr_b16 v[72:73], v11 offset:45056
  v_mul_f32 v140, v140, v172
  v_mfma_f32_16x16x32_bf16 v[196:199], v[60:63], a[68:71], v[196:199]
  ds_read_b64_tr_b16 v[74:75], v11 offset:47104
  v_mul_f32 v141, v141, v173
  v_mfma_f32_16x16x32_bf16 v[196:199], v[64:67], a[84:87], v[196:199]
  ds_read_b64_tr_b16 v[76:77], v11 offset:49152
  v_mul_f32 v142, v142, v174
  v_mfma_f32_16x16x32_bf16 v[200:203], v[56:59], a[56:59], v[200:203]
  ds_read_b64_tr_b16 v[78:79], v11 offset:51200
  v_mul_f32 v143, v143, v175
  v_mfma_f32_16x16x32_bf16 v[200:203], v[60:63], a[72:75], v[200:203]
  s_add_u32 m0, s33, 147456
  v_cvt_pk_bf16_f32 v36, v140, v141
  v_mfma_f32_16x16x32_bf16 v[200:203], v[64:67], a[88:91], v[200:203]
  s_mov_b32 s34, 3244160
  v_cvt_pk_bf16_f32 v37, v142, v143
  v_mfma_f32_16x16x32_bf16 v[204:207], v[56:59], a[60:63], v[204:207]
  buffer_load_dwordx4 v19, s[8:11], s34 offen lds
  v_mul_f32 v156, v156, v188
  v_mfma_f32_16x16x32_bf16 v[204:207], v[60:63], a[76:79], v[204:207]
  s_add_u32 m0, s33, 151552
  v_mul_f32 v157, v157, v189
  v_mfma_f32_16x16x32_bf16 v[204:207], v[64:67], a[92:95], v[204:207]
  s_mov_b32 s34, 3539072
  buffer_load_dwordx4 v19, s[4:7], s34 offen lds
  s_waitcnt lgkmcnt(0)
  v_mfma_f32_16x16x32_bf16 v[208:211], v[68:71], a[48:51], v[208:211]
  ds_read_b64_tr_b16 v[56:57], v8 offset:53248
  v_mul_f32 v158, v158, v190
  v_mfma_f32_16x16x32_bf16 v[208:211], v[72:75], a[64:67], v[208:211]
  ds_read_b64_tr_b16 v[58:59], v8 offset:55296
  v_mul_f32 v159, v159, v191
  v_mfma_f32_16x16x32_bf16 v[208:211], v[76:79], a[80:83], v[208:211]
  ds_read_b64_tr_b16 v[60:61], v8 offset:57344
  v_cvt_pk_bf16_f32 v38, v156, v157
  v_mfma_f32_16x16x32_bf16 v[212:215], v[68:71], a[52:55], v[212:215]
  ds_read_b64_tr_b16 v[62:63], v8 offset:59392
  v_cvt_pk_bf16_f32 v39, v158, v159
  v_mfma_f32_16x16x32_bf16 v[212:215], v[72:75], a[68:71], v[212:215]
  ds_read_b64_tr_b16 v[64:65], v8 offset:61440
  ds_write_b128 v17, v[36:39] offset:3072
  v_mfma_f32_16x16x32_bf16 v[212:215], v[76:79], a[84:87], v[212:215]
  ds_read_b64_tr_b16 v[66:67], v8 offset:63488
  s_mov_b32 s61, 3072
  v_mfma_f32_16x16x32_bf16 v[216:219], v[68:71], a[56:59], v[216:219]
  s_add_u32 m0, s33, 102400
  buffer_store_dwordx4 v[36:39], v80, s[28:31], s61 offen sc1
  v_mfma_f32_16x16x32_bf16 v[216:219], v[72:75], a[72:75], v[216:219]
  s_mov_b32 s34, 3833984
  v_mfma_f32_16x16x32_bf16 v[216:219], v[76:79], a[88:91], v[216:219]
  buffer_load_dwordx4 v19, s[4:7], s34 offen lds
  v_mfma_f32_16x16x32_bf16 v[220:223], v[68:71], a[60:63], v[220:223]
  s_add_u32 m0, s33, 106496
  v_mfma_f32_16x16x32_bf16 v[220:223], v[72:75], a[76:79], v[220:223]
  s_mov_b32 s34, 4128896
  v_mfma_f32_16x16x32_bf16 v[220:223], v[76:79], a[92:95], v[220:223]
  buffer_load_dwordx4 v19, s[4:7], s34 offen lds
  s_waitcnt lgkmcnt(0)
  v_mfma_f32_16x16x32_bf16 v[224:227], v[56:59], a[48:51], v[224:227]
  ds_read_b64_tr_b16 v[68:69], v11 offset:53248
  v_mfma_f32_16x16x32_bf16 v[224:227], v[60:63], a[64:67], v[224:227]
  ds_read_b64_tr_b16 v[70:71], v11 offset:55296
  v_mfma_f32_16x16x32_bf16 v[224:227], v[64:67], a[80:83], v[224:227]
  ds_read_b64_tr_b16 v[72:73], v11 offset:57344
  v_mfma_f32_16x16x32_bf16 v[228:231], v[56:59], a[52:55], v[228:231]
  ds_read_b64_tr_b16 v[74:75], v11 offset:59392
  v_mfma_f32_16x16x32_bf16 v[228:231], v[60:63], a[68:71], v[228:231]
  ds_read_b64_tr_b16 v[76:77], v11 offset:61440
  v_mfma_f32_16x16x32_bf16 v[228:231], v[64:67], a[84:87], v[228:231]
  ds_read_b64_tr_b16 v[78:79], v11 offset:63488
  v_mfma_f32_16x16x32_bf16 v[232:235], v[56:59], a[56:59], v[232:235]
  s_add_u32 m0, s33, 110592
  v_mfma_f32_16x16x32_bf16 v[232:235], v[60:63], a[72:75], v[232:235]
  s_mov_b32 s34, 3539072
  v_mfma_f32_16x16x32_bf16 v[232:235], v[64:67], a[88:91], v[232:235]
  buffer_load_dwordx4 v19, s[8:11], s34 offen lds
  v_mfma_f32_16x16x32_bf16 v[236:239], v[56:59], a[60:63], v[236:239]
  s_add_u32 m0, s33, 155648
  v_mfma_f32_16x16x32_bf16 v[236:239], v[60:63], a[76:79], v[236:239]
  s_mov_b32 s34, 3833984
  v_mfma_f32_16x16x32_bf16 v[236:239], v[64:67], a[92:95], v[236:239]
  buffer_load_dwordx4 v19, s[8:11], s34 offen lds
  s_waitcnt lgkmcnt(0)
  v_mfma_f32_16x16x32_bf16 v[240:243], v[68:71], a[48:51], v[240:243]
  ds_read_b64_tr_b16 v[56:57], v9
  v_mfma_f32_16x16x32_bf16 v[240:243], v[72:75], a[64:67], v[240:243]
  ds_read_b64_tr_b16 v[58:59], v9 offset:2048
  v_mfma_f32_16x16x32_bf16 v[240:243], v[76:79], a[80:83], v[240:243]
  ds_read_b64_tr_b16 v[60:61], v9 offset:4096
  v_mfma_f32_16x16x32_bf16 v[244:247], v[68:71], a[52:55], v[244:247]
  ds_read_b64_tr_b16 v[62:63], v9 offset:6144
  v_mfma_f32_16x16x32_bf16 v[244:247], v[72:75], a[68:71], v[244:247]
  ds_read_b64_tr_b16 v[64:65], v9 offset:8192
  v_mfma_f32_16x16x32_bf16 v[244:247], v[76:79], a[84:87], v[244:247]
  ds_read_b64_tr_b16 v[66:67], v9 offset:10240
  v_mfma_f32_16x16x32_bf16 v[248:251], v[68:71], a[56:59], v[248:251]
  s_add_u32 m0, s33, 159744
  v_mfma_f32_16x16x32_bf16 v[248:251], v[72:75], a[72:75], v[248:251]
  s_mov_b32 s34, 4128896
  v_mfma_f32_16x16x32_bf16 v[248:251], v[76:79], a[88:91], v[248:251]
  buffer_load_dwordx4 v19, s[8:11], s34 offen lds
  v_mfma_f32_16x16x32_bf16 v[252:255], v[68:71], a[60:63], v[252:255]
  s_add_u32 m0, s33, 8192
  v_mfma_f32_16x16x32_bf16 v[252:255], v[72:75], a[76:79], v[252:255]
  s_mov_b32 s34, 4423808
  v_mfma_f32_16x16x32_bf16 v[252:255], v[76:79], a[92:95], v[252:255]
  buffer_load_dwordx4 v19, s[4:7], s34 offen lds
  s_waitcnt lgkmcnt(0)
  v_mfma_f32_16x16x32_bf16 v[192:195], v[56:59], a[96:99], v[192:195]
  s_waitcnt vmcnt(12)
  s_barrier
  v_mfma_f32_16x16x32_bf16 v[192:195], v[60:63], a[112:115], v[192:195]
  ds_read_b64_tr_b16 v[68:69], v12
  v_mfma_f32_16x16x32_bf16 v[192:195], v[64:67], a[128:131], v[192:195]
  ds_read_b64_tr_b16 v[70:71], v12 offset:2048
  v_mfma_f32_16x16x32_bf16 v[196:199], v[56:59], a[100:103], v[196:199]
  ds_read_b64_tr_b16 v[72:73], v12 offset:4096
  v_mfma_f32_16x16x32_bf16 v[196:199], v[60:63], a[116:119], v[196:199]
  ds_read_b64_tr_b16 v[74:75], v12 offset:6144
  v_mfma_f32_16x16x32_bf16 v[196:199], v[64:67], a[132:135], v[196:199]
  ds_read_b64_tr_b16 v[76:77], v12 offset:8192
  v_mfma_f32_16x16x32_bf16 v[200:203], v[56:59], a[104:107], v[200:203]
  ds_read_b64_tr_b16 v[78:79], v12 offset:10240
  v_mfma_f32_16x16x32_bf16 v[200:203], v[60:63], a[120:123], v[200:203]
  s_add_u32 m0, s33, 12288
  v_mfma_f32_16x16x32_bf16 v[200:203], v[64:67], a[136:139], v[200:203]
  s_mov_b32 s34, 4718720
  v_mfma_f32_16x16x32_bf16 v[204:207], v[56:59], a[108:111], v[204:207]
  buffer_load_dwordx4 v19, s[4:7], s34 offen lds
  v_mfma_f32_16x16x32_bf16 v[204:207], v[60:63], a[124:127], v[204:207]
  s_add_u32 m0, s33, 114688
  v_mfma_f32_16x16x32_bf16 v[204:207], v[64:67], a[140:143], v[204:207]
  s_mov_b32 s34, 5013632
  buffer_load_dwordx4 v19, s[4:7], s34 offen lds
  s_waitcnt lgkmcnt(0)
  v_mfma_f32_16x16x32_bf16 v[208:211], v[68:71], a[96:99], v[208:211]
  ds_read_b64_tr_b16 v[56:57], v9 offset:12288
  v_mfma_f32_16x16x32_bf16 v[208:211], v[72:75], a[112:115], v[208:211]
  ds_read_b64_tr_b16 v[58:59], v9 offset:14336
  v_mfma_f32_16x16x32_bf16 v[208:211], v[76:79], a[128:131], v[208:211]
  ds_read_b64_tr_b16 v[60:61], v8
  v_mfma_f32_16x16x32_bf16 v[212:215], v[68:71], a[100:103], v[212:215]
  ds_read_b64_tr_b16 v[62:63], v8 offset:2048
  v_mfma_f32_16x16x32_bf16 v[212:215], v[72:75], a[116:119], v[212:215]
  ds_read_b64_tr_b16 v[64:65], v8 offset:4096
  v_mfma_f32_16x16x32_bf16 v[212:215], v[76:79], a[132:135], v[212:215]
  ds_read_b64_tr_b16 v[66:67], v8 offset:6144
  v_mfma_f32_16x16x32_bf16 v[216:219], v[68:71], a[104:107], v[216:219]
  s_add_u32 m0, s33, 118784
  v_mfma_f32_16x16x32_bf16 v[216:219], v[72:75], a[120:123], v[216:219]
  s_mov_b32 s34, 4423808
  v_mfma_f32_16x16x32_bf16 v[216:219], v[76:79], a[136:139], v[216:219]
  buffer_load_dwordx4 v19, s[8:11], s34 offen lds
  v_mfma_f32_16x16x32_bf16 v[220:223], v[68:71], a[108:111], v[220:223]
  s_add_u32 m0, s33, 122880
  v_mfma_f32_16x16x32_bf16 v[220:223], v[72:75], a[124:127], v[220:223]
  s_mov_b32 s34, 4718720
  v_mfma_f32_16x16x32_bf16 v[220:223], v[76:79], a[140:143], v[220:223]
  buffer_load_dwordx4 v19, s[8:11], s34 offen lds
  s_waitcnt lgkmcnt(0)
  v_mfma_f32_16x16x32_bf16 v[224:227], v[56:59], a[96:99], v[224:227]
  ds_read_b64_tr_b16 v[68:69], v12 offset:12288
  buffer_load_dword v94, v92, s[4:7], 0 offen
  v_mfma_f32_16x16x32_bf16 v[224:227], v[60:63], a[112:115], v[224:227]
  ds_read_b64_tr_b16 v[70:71], v12 offset:14336
  buffer_load_dword v94, v92, s[8:11], 0 offen
  v_mfma_f32_16x16x32_bf16 v[224:227], v[64:67], a[128:131], v[224:227]
  ds_read_b64_tr_b16 v[72:73], v11
  v_mfma_f32_16x16x32_bf16 v[228:231], v[56:59], a[100:103], v[228:231]
  ds_read_b64_tr_b16 v[74:75], v11 offset:2048
  v_mfma_f32_16x16x32_bf16 v[228:231], v[60:63], a[116:119], v[228:231]
  ds_read_b64_tr_b16 v[76:77], v11 offset:4096
  v_mfma_f32_16x16x32_bf16 v[228:231], v[64:67], a[132:135], v[228:231]
  ds_read_b64_tr_b16 v[78:79], v11 offset:6144
  v_mfma_f32_16x16x32_bf16 v[232:235], v[56:59], a[104:107], v[232:235]
  s_add_u32 m0, s33, 16384
  v_mfma_f32_16x16x32_bf16 v[232:235], v[60:63], a[120:123], v[232:235]
  s_mov_b32 s34, 5013632
  v_mfma_f32_16x16x32_bf16 v[232:235], v[64:67], a[136:139], v[232:235]
  buffer_load_dwordx4 v19, s[8:11], s34 offen lds
  v_mfma_f32_16x16x32_bf16 v[236:239], v[56:59], a[108:111], v[236:239]
  s_add_u32 m0, s33, 20480
  v_mfma_f32_16x16x32_bf16 v[236:239], v[60:63], a[124:127], v[236:239]
  s_mov_b32 s34, 256
  v_mfma_f32_16x16x32_bf16 v[236:239], v[64:67], a[140:143], v[236:239]
  buffer_load_dwordx4 v19, s[4:7], s34 offen lds
  s_waitcnt lgkmcnt(0)
  v_mfma_f32_16x16x32_bf16 v[240:243], v[68:71], a[96:99], v[240:243]
  ds_read_b64_tr_b16 v[56:57], v9 offset:16384
  v_mfma_f32_16x16x32_bf16 v[240:243], v[72:75], a[112:115], v[240:243]
  ds_read_b64_tr_b16 v[58:59], v9 offset:18432
  v_mfma_f32_16x16x32_bf16 v[240:243], v[76:79], a[128:131], v[240:243]
  ds_read_b64_tr_b16 v[60:61], v9 offset:20480
  v_mfma_f32_16x16x32_bf16 v[244:247], v[68:71], a[100:103], v[244:247]
  ds_read_b64_tr_b16 v[62:63], v9 offset:22528
  v_mfma_f32_16x16x32_bf16 v[244:247], v[72:75], a[116:119], v[244:247]
  ds_read_b64_tr_b16 v[64:65], v10 offset:8192
  v_mfma_f32_16x16x32_bf16 v[244:247], v[76:79], a[132:135], v[244:247]
  ds_read_b64_tr_b16 v[66:67], v10 offset:10240
  v_mfma_f32_16x16x32_bf16 v[248:251], v[68:71], a[104:107], v[248:251]
  s_add_u32 m0, s33, 24576
  v_mfma_f32_16x16x32_bf16 v[248:251], v[72:75], a[120:123], v[248:251]
  s_mov_b32 s34, 295168
  v_mfma_f32_16x16x32_bf16 v[248:251], v[76:79], a[136:139], v[248:251]
  buffer_load_dwordx4 v19, s[4:7], s34 offen lds
  v_mfma_f32_16x16x32_bf16 v[252:255], v[68:71], a[108:111], v[252:255]
  s_add_u32 m0, s33, 28672
  v_mfma_f32_16x16x32_bf16 v[252:255], v[72:75], a[124:127], v[252:255]
  s_mov_b32 s34, 590080
  v_mfma_f32_16x16x32_bf16 v[252:255], v[76:79], a[140:143], v[252:255]
  buffer_load_dwordx4 v19, s[4:7], s34 offen lds
  s_waitcnt lgkmcnt(0)
  v_mfma_f32_16x16x32_bf16 v[192:195], v[56:59], a[144:147], v[192:195]
  s_waitcnt vmcnt(14)
  s_barrier
  v_mfma_f32_16x16x32_bf16 v[192:195], v[60:63], a[160:163], v[192:195]
  ds_read_b64_tr_b16 v[68:69], v12 offset:16384
  v_mfma_f32_16x16x32_bf16 v[192:195], v[64:67], a[176:179], v[192:195]
  ds_read_b64_tr_b16 v[70:71], v12 offset:18432
  v_mfma_f32_16x16x32_bf16 v[196:199], v[56:59], a[148:151], v[196:199]
  ds_read_b64_tr_b16 v[72:73], v12 offset:20480
  v_mfma_f32_16x16x32_bf16 v[196:199], v[60:63], a[164:167], v[196:199]
  ds_read_b64_tr_b16 v[74:75], v12 offset:22528
  v_mfma_f32_16x16x32_bf16 v[196:199], v[64:67], a[180:183], v[196:199]
  ds_read_b64_tr_b16 v[76:77], v13 offset:8192
  v_mfma_f32_16x16x32_bf16 v[200:203], v[56:59], a[152:155], v[200:203]
  ds_read_b64_tr_b16 v[78:79], v13 offset:10240
  v_mfma_f32_16x16x32_bf16 v[200:203], v[60:63], a[168:171], v[200:203]
  s_add_u32 m0, s33, 32768
  v_mfma_f32_16x16x32_bf16 v[200:203], v[64:67], a[184:187], v[200:203]
  s_mov_b32 s34, 256
  v_mfma_f32_16x16x32_bf16 v[204:207], v[56:59], a[156:159], v[204:207]
  buffer_load_dwordx4 v19, s[8:11], s34 offen lds
  v_mfma_f32_16x16x32_bf16 v[204:207], v[60:63], a[172:175], v[204:207]
  s_add_u32 m0, s33, 36864
  v_mfma_f32_16x16x32_bf16 v[204:207], v[64:67], a[188:191], v[204:207]
  s_mov_b32 s34, 295168
  buffer_load_dwordx4 v19, s[8:11], s34 offen lds
  s_waitcnt lgkmcnt(0)
  v_mfma_f32_16x16x32_bf16 v[208:211], v[68:71], a[144:147], v[208:211]
  ds_read_b64_tr_b16 v[56:57], v10 offset:12288
  v_mfma_f32_16x16x32_bf16 v[208:211], v[72:75], a[160:163], v[208:211]
  ds_read_b64_tr_b16 v[58:59], v10 offset:14336
  v_mfma_f32_16x16x32_bf16 v[208:211], v[76:79], a[176:179], v[208:211]
  ds_read_b64_tr_b16 v[60:61], v9 offset:32768
  v_mfma_f32_16x16x32_bf16 v[212:215], v[68:71], a[148:151], v[212:215]
  ds_read_b64_tr_b16 v[62:63], v9 offset:34816
  v_mfma_f32_16x16x32_bf16 v[212:215], v[72:75], a[164:167], v[212:215]
  ds_read_b64_tr_b16 v[64:65], v10 offset:16384
  v_mfma_f32_16x16x32_bf16 v[212:215], v[76:79], a[180:183], v[212:215]
  ds_read_b64_tr_b16 v[66:67], v10 offset:18432
  v_mfma_f32_16x16x32_bf16 v[216:219], v[68:71], a[152:155], v[216:219]
  s_add_u32 m0, s33, 40960
  v_mfma_f32_16x16x32_bf16 v[216:219], v[72:75], a[168:171], v[216:219]
  s_mov_b32 s34, 590080
  v_mfma_f32_16x16x32_bf16 v[216:219], v[76:79], a[184:187], v[216:219]
  buffer_load_dwordx4 v19, s[8:11], s34 offen lds
  v_mfma_f32_16x16x32_bf16 v[220:223], v[68:71], a[156:159], v[220:223]
  s_add_u32 m0, s33, 45056
  v_mfma_f32_16x16x32_bf16 v[220:223], v[72:75], a[172:175], v[220:223]
  s_mov_b32 s34, 884992
  v_mfma_f32_16x16x32_bf16 v[220:223], v[76:79], a[188:191], v[220:223]
  buffer_load_dwordx4 v19, s[4:7], s34 offen lds
  s_waitcnt lgkmcnt(0)
  v_mfma_f32_16x16x32_bf16 v[224:227], v[56:59], a[144:147], v[224:227]
  ds_read_b64_tr_b16 v[68:69], v13 offset:12288
  v_mfma_f32_16x16x32_bf16 v[224:227], v[60:63], a[160:163], v[224:227]
  ds_read_b64_tr_b16 v[70:71], v13 offset:14336
  v_mfma_f32_16x16x32_bf16 v[224:227], v[64:67], a[176:179], v[224:227]
  ds_read_b64_tr_b16 v[72:73], v12 offset:32768
  v_mfma_f32_16x16x32_bf16 v[228:231], v[56:59], a[148:151], v[228:231]
  ds_read_b64_tr_b16 v[74:75], v12 offset:34816
  v_mfma_f32_16x16x32_bf16 v[228:231], v[60:63], a[164:167], v[228:231]
  ds_read_b64_tr_b16 v[76:77], v13 offset:16384
  v_mfma_f32_16x16x32_bf16 v[228:231], v[64:67], a[180:183], v[228:231]
  ds_read_b64_tr_b16 v[78:79], v13 offset:18432
  v_mfma_f32_16x16x32_bf16 v[232:235], v[56:59], a[152:155], v[232:235]
  s_add_u32 m0, s33, 49152
  v_mfma_f32_16x16x32_bf16 v[232:235], v[60:63], a[168:171], v[232:235]
  s_mov_b32 s34, 1179904
  v_mfma_f32_16x16x32_bf16 v[232:235], v[64:67], a[184:187], v[232:235]
  buffer_load_dwordx4 v19, s[4:7], s34 offen lds
  v_mfma_f32_16x16x32_bf16 v[236:239], v[56:59], a[156:159], v[236:239]
  s_add_u32 m0, s33, 53248
  v_mfma_f32_16x16x32_bf16 v[236:239], v[60:63], a[172:175], v[236:239]
  s_mov_b32 s34, 1474816
  v_mfma_f32_16x16x32_bf16 v[236:239], v[64:67], a[188:191], v[236:239]
  buffer_load_dwordx4 v19, s[4:7], s34 offen lds
  s_waitcnt lgkmcnt(0)
  v_mfma_f32_16x16x32_bf16 v[240:243], v[68:71], a[144:147], v[240:243]
  ds_read_b64_tr_b16 v[56:57], v10 offset:20480
  v_mfma_f32_16x16x32_bf16 v[240:243], v[72:75], a[160:163], v[240:243]
  ds_read_b64_tr_b16 v[58:59], v10 offset:22528
  v_mfma_f32_16x16x32_bf16 v[240:243], v[76:79], a[176:179], v[240:243]
  ds_read_b64_tr_b16 v[60:61], v9 offset:36864
  v_mfma_f32_16x16x32_bf16 v[244:247], v[68:71], a[148:151], v[244:247]
  ds_read_b64_tr_b16 v[62:63], v9 offset:38912
  v_mfma_f32_16x16x32_bf16 v[244:247], v[72:75], a[164:167], v[244:247]
  ds_read_b64_tr_b16 v[64:65], v9 offset:40960
  v_mfma_f32_16x16x32_bf16 v[244:247], v[76:79], a[180:183], v[244:247]
  ds_read_b64_tr_b16 v[66:67], v9 offset:43008
  v_mfma_f32_16x16x32_bf16 v[248:251], v[68:71], a[152:155], v[248:251]
  s_add_u32 m0, s33, 57344
  v_mfma_f32_16x16x32_bf16 v[248:251], v[72:75], a[168:171], v[248:251]
  s_mov_b32 s34, 884992
  v_mfma_f32_16x16x32_bf16 v[248:251], v[76:79], a[184:187], v[248:251]
  buffer_load_dwordx4 v19, s[8:11], s34 offen lds
  v_mfma_f32_16x16x32_bf16 v[252:255], v[68:71], a[156:159], v[252:255]
  s_add_u32 m0, s33, 61440
  v_mfma_f32_16x16x32_bf16 v[252:255], v[72:75], a[172:175], v[252:255]
  s_mov_b32 s34, 1179904
  v_mfma_f32_16x16x32_bf16 v[252:255], v[76:79], a[188:191], v[252:255]
  buffer_load_dwordx4 v19, s[8:11], s34 offen lds
  s_waitcnt lgkmcnt(0)
  v_mfma_f32_16x16x32_bf16 v[192:195], v[56:59], a[192:195], v[192:195]
  s_waitcnt vmcnt(16)
  s_barrier
  v_mfma_f32_16x16x32_bf16 v[192:195], v[60:63], a[208:211], v[192:195]
  ds_read_b64_tr_b16 v[68:69], v13 offset:20480
  v_mfma_f32_16x16x32_bf16 v[192:195], v[64:67], a[224:227], v[192:195]
  ds_read_b64_tr_b16 v[70:71], v13 offset:22528
  v_mfma_f32_16x16x32_bf16 v[196:199], v[56:59], a[196:199], v[196:199]
  ds_read_b64_tr_b16 v[72:73], v12 offset:36864
  v_mfma_f32_16x16x32_bf16 v[196:199], v[60:63], a[212:215], v[196:199]
  ds_read_b64_tr_b16 v[74:75], v12 offset:38912
  v_mfma_f32_16x16x32_bf16 v[196:199], v[64:67], a[228:231], v[196:199]
  ds_read_b64_tr_b16 v[76:77], v12 offset:40960
  v_mfma_f32_16x16x32_bf16 v[200:203], v[56:59], a[200:203], v[200:203]
  ds_read_b64_tr_b16 v[78:79], v12 offset:43008
  v_mfma_f32_16x16x32_bf16 v[200:203], v[60:63], a[216:219], v[200:203]
  s_add_u32 m0, s33, 65536
  v_mfma_f32_16x16x32_bf16 v[200:203], v[64:67], a[232:235], v[200:203]
  s_mov_b32 s34, 1474816
  v_mfma_f32_16x16x32_bf16 v[204:207], v[56:59], a[204:207], v[204:207]
  buffer_load_dwordx4 v19, s[8:11], s34 offen lds
  v_mfma_f32_16x16x32_bf16 v[204:207], v[60:63], a[220:223], v[204:207]
  s_add_u32 m0, s33, 69632
  v_mfma_f32_16x16x32_bf16 v[204:207], v[64:67], a[236:239], v[204:207]
  s_mov_b32 s34, 1769728
  buffer_load_dwordx4 v19, s[4:7], s34 offen lds
  s_waitcnt lgkmcnt(0)
  v_mfma_f32_16x16x32_bf16 v[208:211], v[68:71], a[192:195], v[208:211]
  ds_read_b64_tr_b16 v[56:57], v9 offset:45056
  v_mfma_f32_16x16x32_bf16 v[208:211], v[72:75], a[208:211], v[208:211]
  ds_read_b64_tr_b16 v[58:59], v9 offset:47104
  v_mfma_f32_16x16x32_bf16 v[208:211], v[76:79], a[224:227], v[208:211]
  ds_read_b64_tr_b16 v[60:61], v10 offset:24576
  v_mfma_f32_16x16x32_bf16 v[212:215], v[68:71], a[196:199], v[212:215]
  ds_read_b64_tr_b16 v[62:63], v10 offset:26624
  v_mfma_f32_16x16x32_bf16 v[212:215], v[72:75], a[212:215], v[212:215]
  ds_read_b64_tr_b16 v[64:65], v10 offset:28672
  v_mfma_f32_16x16x32_bf16 v[212:215], v[76:79], a[228:231], v[212:215]
  ds_read_b64_tr_b16 v[66:67], v10 offset:30720
  v_mfma_f32_16x16x32_bf16 v[216:219], v[68:71], a[200:203], v[216:219]
  s_add_u32 m0, s33, 73728
  v_mfma_f32_16x16x32_bf16 v[216:219], v[72:75], a[216:219], v[216:219]
  s_mov_b32 s34, 2064640
  v_mfma_f32_16x16x32_bf16 v[216:219], v[76:79], a[232:235], v[216:219]
  buffer_load_dwordx4 v19, s[4:7], s34 offen lds
  v_mfma_f32_16x16x32_bf16 v[220:223], v[68:71], a[204:207], v[220:223]
  s_add_u32 m0, s33, 77824
  v_mfma_f32_16x16x32_bf16 v[220:223], v[72:75], a[220:223], v[220:223]
  s_mov_b32 s34, 2359552
  v_mfma_f32_16x16x32_bf16 v[220:223], v[76:79], a[236:239], v[220:223]
  buffer_load_dwordx4 v19, s[4:7], s34 offen lds
  s_waitcnt lgkmcnt(0)
  v_mfma_f32_16x16x32_bf16 v[224:227], v[56:59], a[192:195], v[224:227]
  ds_read_b64_tr_b16 v[68:69], v12 offset:45056
  v_mfma_f32_16x16x32_bf16 v[224:227], v[60:63], a[208:211], v[224:227]
  ds_read_b64_tr_b16 v[70:71], v12 offset:47104
  v_mfma_f32_16x16x32_bf16 v[224:227], v[64:67], a[224:227], v[224:227]
  ds_read_b64_tr_b16 v[72:73], v13 offset:24576
  v_mfma_f32_16x16x32_bf16 v[228:231], v[56:59], a[196:199], v[228:231]
  ds_read_b64_tr_b16 v[74:75], v13 offset:26624
  v_mfma_f32_16x16x32_bf16 v[228:231], v[60:63], a[212:215], v[228:231]
  ds_read_b64_tr_b16 v[76:77], v13 offset:28672
  v_mfma_f32_16x16x32_bf16 v[228:231], v[64:67], a[228:231], v[228:231]
  ds_read_b64_tr_b16 v[78:79], v13 offset:30720
  v_mfma_f32_16x16x32_bf16 v[232:235], v[56:59], a[200:203], v[232:235]
  s_add_u32 m0, s33, 0
  v_mfma_f32_16x16x32_bf16 v[232:235], v[60:63], a[216:219], v[232:235]
  s_mov_b32 s34, 1769728
  v_mfma_f32_16x16x32_bf16 v[232:235], v[64:67], a[232:235], v[232:235]
  buffer_load_dwordx4 v19, s[8:11], s34 offen lds
  v_mfma_f32_16x16x32_bf16 v[236:239], v[56:59], a[204:207], v[236:239]
  s_add_u32 m0, s33, 4096
  v_mfma_f32_16x16x32_bf16 v[236:239], v[60:63], a[220:223], v[236:239]
  s_mov_b32 s34, 2064640
  v_mfma_f32_16x16x32_bf16 v[236:239], v[64:67], a[236:239], v[236:239]
  buffer_load_dwordx4 v19, s[8:11], s34 offen lds
  s_waitcnt lgkmcnt(0)
  v_mfma_f32_16x16x32_bf16 v[240:243], v[68:71], a[192:195], v[240:243]
  ds_read_b64_tr_b16 v[56:57], v8 offset:8192
  v_mfma_f32_16x16x32_bf16 v[240:243], v[72:75], a[208:211], v[240:243]
  ds_read_b64_tr_b16 v[58:59], v8 offset:10240
  v_mfma_f32_16x16x32_bf16 v[240:243], v[76:79], a[224:227], v[240:243]
  ds_read_b64_tr_b16 v[60:61], v8 offset:12288
  v_mfma_f32_16x16x32_bf16 v[244:247], v[68:71], a[196:199], v[244:247]
  ds_read_b64_tr_b16 v[62:63], v8 offset:14336
  v_mfma_f32_16x16x32_bf16 v[244:247], v[72:75], a[212:215], v[244:247]
  ds_read_b64_tr_b16 v[64:65], v9 offset:49152
  v_mfma_f32_16x16x32_bf16 v[244:247], v[76:79], a[228:231], v[244:247]
  ds_read_b64_tr_b16 v[66:67], v9 offset:51200
  v_mfma_f32_16x16x32_bf16 v[248:251], v[68:71], a[200:203], v[248:251]
  s_add_u32 m0, s33, 81920
  v_mfma_f32_16x16x32_bf16 v[248:251], v[72:75], a[216:219], v[248:251]
  s_mov_b32 s34, 2359552
  v_mfma_f32_16x16x32_bf16 v[248:251], v[76:79], a[232:235], v[248:251]
  buffer_load_dwordx4 v19, s[8:11], s34 offen lds
  v_mfma_f32_16x16x32_bf16 v[252:255], v[68:71], a[204:207], v[252:255]
  v_mfma_f32_16x16x32_bf16 v[252:255], v[72:75], a[220:223], v[252:255]
  v_mfma_f32_16x16x32_bf16 v[252:255], v[76:79], a[236:239], v[252:255]
  s_waitcnt lgkmcnt(0)
  v_mfma_f32_16x16x32_bf16 v[192:195], v[56:59], a[240:243], v[192:195]
  s_waitcnt vmcnt(15)
  s_barrier
  v_mfma_f32_16x16x32_bf16 v[192:195], v[60:63], v[96:99], v[192:195]
  ds_read_b64_tr_b16 v[68:69], v11 offset:8192
  v_mfma_f32_16x16x32_bf16 v[192:195], v[64:67], v[112:115], v[192:195]
  ds_read_b64_tr_b16 v[70:71], v11 offset:10240
  v_mfma_f32_16x16x32_bf16 v[196:199], v[56:59], a[244:247], v[196:199]
  ds_read_b64_tr_b16 v[72:73], v11 offset:12288
  v_mfma_f32_16x16x32_bf16 v[196:199], v[60:63], v[100:103], v[196:199]
  ds_read_b64_tr_b16 v[74:75], v11 offset:14336
  v_mfma_f32_16x16x32_bf16 v[196:199], v[64:67], v[116:119], v[196:199]
  ds_read_b64_tr_b16 v[76:77], v12 offset:49152
  v_mfma_f32_16x16x32_bf16 v[200:203], v[56:59], a[248:251], v[200:203]
  ds_read_b64_tr_b16 v[78:79], v12 offset:51200
  v_mfma_f32_16x16x32_bf16 v[200:203], v[60:63], v[104:107], v[200:203]
  s_add_u32 m0, s33, 86016
  v_mfma_f32_16x16x32_bf16 v[200:203], v[64:67], v[120:123], v[200:203]
  s_mov_b32 s34, 2654464
  v_mfma_f32_16x16x32_bf16 v[204:207], v[56:59], a[252:255], v[204:207]
  buffer_load_dwordx4 v19, s[4:7], s34 offen lds
  v_mfma_f32_16x16x32_bf16 v[204:207], v[60:63], v[108:111], v[204:207]
  s_add_u32 m0, s33, 143360
  v_mfma_f32_16x16x32_bf16 v[204:207], v[64:67], v[124:127], v[204:207]
  s_mov_b32 s34, 2949376
  buffer_load_dwordx4 v19, s[4:7], s34 offen lds
  s_waitcnt lgkmcnt(0)
  v_mfma_f32_16x16x32_bf16 v[208:211], v[68:71], a[240:243], v[208:211]
  ds_read_b64_tr_b16 v[56:57], v9 offset:53248
  v_mfma_f32_16x16x32_bf16 v[208:211], v[72:75], v[96:99], v[208:211]
  ds_read_b64_tr_b16 v[58:59], v9 offset:55296
  v_mfma_f32_16x16x32_bf16 v[208:211], v[76:79], v[112:115], v[208:211]
  ds_read_b64_tr_b16 v[60:61], v9 offset:57344
  v_mfma_f32_16x16x32_bf16 v[212:215], v[68:71], a[244:247], v[212:215]
  ds_read_b64_tr_b16 v[62:63], v9 offset:59392
  v_mfma_f32_16x16x32_bf16 v[212:215], v[72:75], v[100:103], v[212:215]
  ds_read_b64_tr_b16 v[64:65], v8 offset:16384
  v_mfma_f32_16x16x32_bf16 v[212:215], v[76:79], v[116:119], v[212:215]
  ds_read_b64_tr_b16 v[66:67], v8 offset:18432
  v_mfma_f32_16x16x32_bf16 v[216:219], v[68:71], a[248:251], v[216:219]
  s_add_u32 m0, s33, 147456
  v_mfma_f32_16x16x32_bf16 v[216:219], v[72:75], v[104:107], v[216:219]
  s_mov_b32 s34, 3244288
  v_mfma_f32_16x16x32_bf16 v[216:219], v[76:79], v[120:123], v[216:219]
  buffer_load_dwordx4 v19, s[4:7], s34 offen lds
  v_mfma_f32_16x16x32_bf16 v[220:223], v[68:71], a[252:255], v[220:223]
  v_mfma_f32_16x16x32_bf16 v[220:223], v[72:75], v[108:111], v[220:223]
  v_mfma_f32_16x16x32_bf16 v[220:223], v[76:79], v[124:127], v[220:223]
  s_waitcnt lgkmcnt(0)
  v_mfma_f32_16x16x32_bf16 v[224:227], v[56:59], a[240:243], v[224:227]
  ds_read_b64_tr_b16 v[68:69], v12 offset:53248
  v_mfma_f32_16x16x32_bf16 v[224:227], v[60:63], v[96:99], v[224:227]
  ds_read_b64_tr_b16 v[70:71], v12 offset:55296
  v_mfma_f32_16x16x32_bf16 v[224:227], v[64:67], v[112:115], v[224:227]
  ds_read_b64_tr_b16 v[72:73], v12 offset:57344
  v_mfma_f32_16x16x32_bf16 v[228:231], v[56:59], a[244:247], v[228:231]
  ds_read_b64_tr_b16 v[74:75], v12 offset:59392
  v_mfma_f32_16x16x32_bf16 v[228:231], v[60:63], v[100:103], v[228:231]
  ds_read_b64_tr_b16 v[76:77], v11 offset:16384
  v_mfma_f32_16x16x32_bf16 v[228:231], v[64:67], v[116:119], v[228:231]
  ds_read_b64_tr_b16 v[78:79], v11 offset:18432
  v_mfma_f32_16x16x32_bf16 v[232:235], v[56:59], a[248:251], v[232:235]
  s_add_u32 m0, s33, 151552
  v_mfma_f32_16x16x32_bf16 v[232:235], v[60:63], v[104:107], v[232:235]
  s_mov_b32 s34, 2654464
  v_mfma_f32_16x16x32_bf16 v[232:235], v[64:67], v[120:123], v[232:235]
  buffer_load_dwordx4 v19, s[8:11], s34 offen lds
  v_mfma_f32_16x16x32_bf16 v[236:239], v[56:59], a[252:255], v[236:239]
  s_add_u32 m0, s33, 106496
  v_mfma_f32_16x16x32_bf16 v[236:239], v[60:63], v[108:111], v[236:239]
  s_mov_b32 s34, 2949376
  v_mfma_f32_16x16x32_bf16 v[236:239], v[64:67], v[124:127], v[236:239]
  buffer_load_dwordx4 v19, s[8:11], s34 offen lds
  s_waitcnt lgkmcnt(0)
  v_mfma_f32_16x16x32_bf16 v[240:243], v[68:71], a[240:243], v[240:243]
  ds_read_b64_tr_b16 v[56:57], v8 offset:20480
  v_mfma_f32_16x16x32_bf16 v[240:243], v[72:75], v[96:99], v[240:243]
  ds_read_b64_tr_b16 v[58:59], v8 offset:22528
  v_mfma_f32_16x16x32_bf16 v[240:243], v[76:79], v[112:115], v[240:243]
  ds_read_b64_tr_b16 v[60:61], v8 offset:24576
  v_mfma_f32_16x16x32_bf16 v[244:247], v[68:71], a[244:247], v[244:247]
  ds_read_b64_tr_b16 v[62:63], v8 offset:26624
  v_mfma_f32_16x16x32_bf16 v[244:247], v[72:75], v[100:103], v[244:247]
  ds_read_b64_tr_b16 v[64:65], v8 offset:28672
  v_mfma_f32_16x16x32_bf16 v[244:247], v[76:79], v[116:119], v[244:247]
  ds_read_b64_tr_b16 v[66:67], v8 offset:30720
  v_mfma_f32_16x16x32_bf16 v[248:251], v[68:71], a[248:251], v[248:251]
  s_add_u32 m0, s33, 110592
  v_mfma_f32_16x16x32_bf16 v[248:251], v[72:75], v[104:107], v[248:251]
  s_mov_b32 s34, 3244288
  v_mfma_f32_16x16x32_bf16 v[248:251], v[76:79], v[120:123], v[248:251]
  buffer_load_dwordx4 v19, s[8:11], s34 offen lds
  v_mfma_f32_16x16x32_bf16 v[252:255], v[68:71], a[252:255], v[252:255]
  v_mfma_f32_16x16x32_bf16 v[252:255], v[72:75], v[108:111], v[252:255]
  v_mfma_f32_16x16x32_bf16 v[252:255], v[76:79], v[124:127], v[252:255]
  s_waitcnt lgkmcnt(0)
  v_mfma_f32_16x16x32_bf16 v[128:131], v[56:59], a[0:3], 0
  s_waitcnt vmcnt(15)
  s_barrier
  v_mfma_f32_16x16x32_bf16 v[128:131], v[60:63], a[16:19], v[128:131]
  ds_read_b64_tr_b16 v[68:69], v11 offset:20480
  v_mul_f32 v192, v192, v224
  v_mfma_f32_16x16x32_bf16 v[128:131], v[64:67], a[32:35], v[128:131]
  ds_read_b64_tr_b16 v[70:71], v11 offset:22528
  v_mul_f32 v193, v193, v225
  v_mfma_f32_16x16x32_bf16 v[132:135], v[56:59], a[4:7], 0
  ds_read_b64_tr_b16 v[72:73], v11 offset:24576
  v_mul_f32 v194, v194, v226
  v_mfma_f32_16x16x32_bf16 v[132:135], v[60:63], a[20:23], v[132:135]
  ds_read_b64_tr_b16 v[74:75], v11 offset:26624
  v_mul_f32 v195, v195, v227
  v_mfma_f32_16x16x32_bf16 v[132:135], v[64:67], a[36:39], v[132:135]
  ds_read_b64_tr_b16 v[76:77], v11 offset:28672
  v_cvt_pk_bf16_f32 v32, v192, v193
  v_mfma_f32_16x16x32_bf16 v[136:139], v[56:59], a[8:11], 0
  ds_read_b64_tr_b16 v[78:79], v11 offset:30720
  v_cvt_pk_bf16_f32 v33, v194, v195
  v_mfma_f32_16x16x32_bf16 v[136:139], v[60:63], a[24:27], v[136:139]
  s_add_u32 m0, s33, 155648
  v_mul_f32 v208, v208, v240
  v_mfma_f32_16x16x32_bf16 v[136:139], v[64:67], a[40:43], v[136:139]
  s_mov_b32 s34, 3539200
  v_mul_f32 v209, v209, v241
  v_mfma_f32_16x16x32_bf16 v[140:143], v[56:59], a[12:15], 0
  buffer_load_dwordx4 v19, s[4:7], s34 offen lds
  v_mul_f32 v210, v210, v242
  v_mfma_f32_16x16x32_bf16 v[140:143], v[60:63], a[28:31], v[140:143]
  s_add_u32 m0, s33, 159744
  v_mul_f32 v211, v211, v243
  v_mfma_f32_16x16x32_bf16 v[140:143], v[64:67], a[44:47], v[140:143]
  s_mov_b32 s34, 3834112
  buffer_load_dwordx4 v19, s[4:7], s34 offen lds
  s_waitcnt lgkmcnt(0)
  v_mfma_f32_16x16x32_bf16 v[144:147], v[68:71], a[0:3], 0
  ds_read_b64_tr_b16 v[56:57], v8 offset:32768
  v_cvt_pk_bf16_f32 v34, v208, v209
  v_mfma_f32_16x16x32_bf16 v[144:147], v[72:75], a[16:19], v[144:147]
  ds_read_b64_tr_b16 v[58:59], v8 offset:34816
  v_cvt_pk_bf16_f32 v35, v210, v211
  v_mfma_f32_16x16x32_bf16 v[144:147], v[76:79], a[32:35], v[144:147]
  ds_read_b64_tr_b16 v[60:61], v8 offset:36864
  ds_write_b128 v17, v[32:35] offset:8192
  v_mfma_f32_16x16x32_bf16 v[148:151], v[68:71], a[4:7], 0
  ds_read_b64_tr_b16 v[62:63], v8 offset:38912
  s_mov_b32 s61, 8192
  v_mfma_f32_16x16x32_bf16 v[148:151], v[72:75], a[20:23], v[148:151]
  ds_read_b64_tr_b16 v[64:65], v8 offset:40960
  buffer_store_dwordx4 v[32:35], v80, s[28:31], s61 offen sc1
  v_mfma_f32_16x16x32_bf16 v[148:151], v[76:79], a[36:39], v[148:151]
  ds_read_b64_tr_b16 v[66:67], v8 offset:43008
  v_mul_f32 v196, v196, v228
  v_mfma_f32_16x16x32_bf16 v[152:155], v[68:71], a[8:11], 0
  s_add_u32 m0, s33, 8192
  v_mul_f32 v197, v197, v229
  v_mfma_f32_16x16x32_bf16 v[152:155], v[72:75], a[24:27], v[152:155]
  s_mov_b32 s34, 4129024
  v_mul_f32 v198, v198, v230
  v_mfma_f32_16x16x32_bf16 v[152:155], v[76:79], a[40:43], v[152:155]
  buffer_load_dwordx4 v19, s[4:7], s34 offen lds
  v_mul_f32 v199, v199, v231
  v_mfma_f32_16x16x32_bf16 v[156:159], v[68:71], a[12:15], 0
  v_cvt_pk_bf16_f32 v36, v196, v197
  v_mfma_f32_16x16x32_bf16 v[156:159], v[72:75], a[28:31], v[156:159]
  v_cvt_pk_bf16_f32 v37, v198, v199
  v_mfma_f32_16x16x32_bf16 v[156:159], v[76:79], a[44:47], v[156:159]
  v_mul_f32 v212, v212, v244
  s_waitcnt lgkmcnt(0)
  v_mfma_f32_16x16x32_bf16 v[160:163], v[56:59], a[0:3], 0
  ds_read_b64_tr_b16 v[68:69], v11 offset:32768
  v_mul_f32 v213, v213, v245
  v_mfma_f32_16x16x32_bf16 v[160:163], v[60:63], a[16:19], v[160:163]
  ds_read_b64_tr_b16 v[70:71], v11 offset:34816
  v_mul_f32 v214, v214, v246
  v_mfma_f32_16x16x32_bf16 v[160:163], v[64:67], a[32:35], v[160:163]
  ds_read_b64_tr_b16 v[72:73], v11 offset:36864
  v_mul_f32 v215, v215, v247
  v_mfma_f32_16x16x32_bf16 v[164:167], v[56:59], a[4:7], 0
  ds_read_b64_tr_b16 v[74:75], v11 offset:38912
  v_cvt_pk_bf16_f32 v38, v212, v213
  v_mfma_f32_16x16x32_bf16 v[164:167], v[60:63], a[20:23], v[164:167]
  ds_read_b64_tr_b16 v[76:77], v11 offset:40960
  v_cvt_pk_bf16_f32 v39, v214, v215
  v_mfma_f32_16x16x32_bf16 v[164:167], v[64:67], a[36:39], v[164:167]
  ds_read_b64_tr_b16 v[78:79], v11 offset:43008
  ds_write_b128 v17, v[36:39] offset:9216
  v_mfma_f32_16x16x32_bf16 v[168:171], v[56:59], a[8:11], 0
  s_add_u32 m0, s33, 12288
  s_mov_b32 s61, 9216
  v_mfma_f32_16x16x32_bf16 v[168:171], v[60:63], a[24:27], v[168:171]
  s_mov_b32 s34, 3539200
  buffer_store_dwordx4 v[36:39], v80, s[28:31], s61 offen sc1
  v_mfma_f32_16x16x32_bf16 v[168:171], v[64:67], a[40:43], v[168:171]
  buffer_load_dwordx4 v19, s[8:11], s34 offen lds
  v_mul_f32 v200, v200, v232
  v_mfma_f32_16x16x32_bf16 v[172:175], v[56:59], a[12:15], 0
  s_add_u32 m0, s33, 114688
  v_mul_f32 v201, v201, v233
  v_mfma_f32_16x16x32_bf16 v[172:175], v[60:63], a[28:31], v[172:175]
  s_mov_b32 s34, 3834112
  v_mul_f32 v202, v202, v234
  v_mfma_f32_16x16x32_bf16 v[172:175], v[64:67], a[44:47], v[172:175]
  buffer_load_dwordx4 v19, s[8:11], s34 offen lds
  s_waitcnt lgkmcnt(1)
  v_mfma_f32_16x16x32_bf16 v[176:179], v[68:71], a[0:3], 0
  ds_read_b64_tr_b16 v[56:57], v8 offset:45056
  v_mul_f32 v203, v203, v235
  v_mfma_f32_16x16x32_bf16 v[176:179], v[72:75], a[16:19], v[176:179]
  ds_read_b64_tr_b16 v[58:59], v8 offset:47104
  v_cvt_pk_bf16_f32 v32, v200, v201
  v_mfma_f32_16x16x32_bf16 v[176:179], v[76:79], a[32:35], v[176:179]
  ds_read_b64_tr_b16 v[60:61], v8 offset:49152
  v_cvt_pk_bf16_f32 v33, v202, v203
  v_mfma_f32_16x16x32_bf16 v[180:183], v[68:71], a[4:7], 0
  ds_read_b64_tr_b16 v[62:63], v8 offset:51200
  v_mul_f32 v216, v216, v248
  v_mfma_f32_16x16x32_bf16 v[180:183], v[72:75], a[20:23], v[180:183]
  ds_read_b64_tr_b16 v[64:65], v8 offset:53248
  v_mul_f32 v217, v217, v249
  v_mfma_f32_16x16x32_bf16 v[180:183], v[76:79], a[36:39], v[180:183]
  ds_read_b64_tr_b16 v[66:67], v8 offset:55296
  v_mul_f32 v218, v218, v250
  v_mfma_f32_16x16x32_bf16 v[184:187], v[68:71], a[8:11], 0
  s_add_u32 m0, s33, 118784
  v_mul_f32 v219, v219, v251
  v_mfma_f32_16x16x32_bf16 v[184:187], v[72:75], a[24:27], v[184:187]
  s_mov_b32 s34, 4129024
  v_cvt_pk_bf16_f32 v34, v216, v217
  v_mfma_f32_16x16x32_bf16 v[184:187], v[76:79], a[40:43], v[184:187]
  buffer_load_dwordx4 v19, s[8:11], s34 offen lds
  v_cvt_pk_bf16_f32 v35, v218, v219
  v_mfma_f32_16x16x32_bf16 v[188:191], v[68:71], a[12:15], 0
  ds_write_b128 v17, v[32:35] offset:10240
  v_mfma_f32_16x16x32_bf16 v[188:191], v[72:75], a[28:31], v[188:191]
  s_mov_b32 s61, 10240
  v_mfma_f32_16x16x32_bf16 v[188:191], v[76:79], a[44:47], v[188:191]
  buffer_store_dwordx4 v[32:35], v80, s[28:31], s61 offen sc1
  s_waitcnt lgkmcnt(1)
  v_mfma_f32_16x16x32_bf16 v[128:131], v[56:59], a[48:51], v[128:131]
  s_waitcnt vmcnt(18)
  s_barrier
  v_mfma_f32_16x16x32_bf16 v[128:131], v[60:63], a[64:67], v[128:131]
  ds_read_b64_tr_b16 v[68:69], v11 offset:45056
  v_mul_f32 v204, v204, v236
  v_mfma_f32_16x16x32_bf16 v[128:131], v[64:67], a[80:83], v[128:131]
  ds_read_b64_tr_b16 v[70:71], v11 offset:47104
  v_mul_f32 v205, v205, v237
  v_mfma_f32_16x16x32_bf16 v[132:135], v[56:59], a[52:55], v[132:135]
  ds_read_b64_tr_b16 v[72:73], v11 offset:49152
  v_mul_f32 v206, v206, v238
  v_mfma_f32_16x16x32_bf16 v[132:135], v[60:63], a[68:71], v[132:135]
  ds_read_b64_tr_b16 v[74:75], v11 offset:51200
  v_mul_f32 v207, v207, v239
  v_mfma_f32_16x16x32_bf16 v[132:135], v[64:67], a[84:87], v[132:135]
  ds_read_b64_tr_b16 v[76:77], v11 offset:53248
  v_cvt_pk_bf16_f32 v36, v204, v205
  v_mfma_f32_16x16x32_bf16 v[136:139], v[56:59], a[56:59], v[136:139]
  ds_read_b64_tr_b16 v[78:79], v11 offset:55296
  v_cvt_pk_bf16_f32 v37, v206, v207
  v_mfma_f32_16x16x32_bf16 v[136:139], v[60:63], a[72:75], v[136:139]
  s_add_u32 m0, s33, 122880
  v_mul_f32 v220, v220, v252
  v_mfma_f32_16x16x32_bf16 v[136:139], v[64:67], a[88:91], v[136:139]
  s_mov_b32 s34, 4423936
  v_mul_f32 v221, v221, v253
  v_mfma_f32_16x16x32_bf16 v[140:143], v[56:59], a[60:63], v[140:143]
  buffer_load_dwordx4 v19, s[4:7], s34 offen lds
  v_mul_f32 v222, v222, v254
  v_mfma_f32_16x16x32_bf16 v[140:143], v[60:63], a[76:79], v[140:143]
  s_add_u32 m0, s33, 16384
  v_mul_f32 v223, v223, v255
  v_mfma_f32_16x16x32_bf16 v[140:143], v[64:67], a[92:95], v[140:143]
  s_mov_b32 s34, 4718848
  buffer_load_dwordx4 v19, s[4:7], s34 offen lds
  s_waitcnt lgkmcnt(0)
  v_mfma_f32_16x16x32_bf16 v[144:147], v[68:71], a[48:51], v[144:147]
  ds_read_b64_tr_b16 v[56:57], v8 offset:57344
  v_cvt_pk_bf16_f32 v38, v220, v221
  v_mfma_f32_16x16x32_bf16 v[144:147], v[72:75], a[64:67], v[144:147]
  ds_read_b64_tr_b16 v[58:59], v8 offset:59392
  v_cvt_pk_bf16_f32 v39, v222, v223
  v_mfma_f32_16x16x32_bf16 v[144:147], v[76:79], a[80:83], v[144:147]
  ds_read_b64_tr_b16 v[60:61], v8 offset:61440
  ds_write_b128 v17, v[36:39] offset:11264
  v_mfma_f32_16x16x32_bf16 v[148:151], v[68:71], a[52:55], v[148:151]
  ds_read_b64_tr_b16 v[62:63], v8 offset:63488
  s_mov_b32 s61, 11264
  v_mfma_f32_16x16x32_bf16 v[148:151], v[72:75], a[68:71], v[148:151]
  ds_read_b64_tr_b16 v[64:65], v9
  buffer_store_dwordx4 v[36:39], v80, s[28:31], s61 offen sc1
  v_mfma_f32_16x16x32_bf16 v[148:151], v[76:79], a[84:87], v[148:151]
  ds_read_b64_tr_b16 v[66:67], v9 offset:2048
  v_mfma_f32_16x16x32_bf16 v[152:155], v[68:71], a[56:59], v[152:155]
  s_add_u32 m0, s33, 20480
  v_mfma_f32_16x16x32_bf16 v[152:155], v[72:75], a[72:75], v[152:155]
  s_mov_b32 s34, 5013760
  v_mfma_f32_16x16x32_bf16 v[152:155], v[76:79], a[88:91], v[152:155]
  buffer_load_dwordx4 v19, s[4:7], s34 offen lds
  v_mfma_f32_16x16x32_bf16 v[156:159], v[68:71], a[60:63], v[156:159]
  v_mfma_f32_16x16x32_bf16 v[156:159], v[72:75], a[76:79], v[156:159]
  v_mfma_f32_16x16x32_bf16 v[156:159], v[76:79], a[92:95], v[156:159]
  s_waitcnt lgkmcnt(0)
  v_mfma_f32_16x16x32_bf16 v[160:163], v[56:59], a[48:51], v[160:163]
  ds_read_b64_tr_b16 v[68:69], v11 offset:57344
  v_mfma_f32_16x16x32_bf16 v[160:163], v[60:63], a[64:67], v[160:163]
  ds_read_b64_tr_b16 v[70:71], v11 offset:59392
  v_mfma_f32_16x16x32_bf16 v[160:163], v[64:67], a[80:83], v[160:163]
  ds_read_b64_tr_b16 v[72:73], v11 offset:61440
  v_mfma_f32_16x16x32_bf16 v[164:167], v[56:59], a[52:55], v[164:167]
  ds_read_b64_tr_b16 v[74:75], v11 offset:63488
  v_mfma_f32_16x16x32_bf16 v[164:167], v[60:63], a[68:71], v[164:167]
  ds_read_b64_tr_b16 v[76:77], v12
  v_mfma_f32_16x16x32_bf16 v[164:167], v[64:67], a[84:87], v[164:167]
  ds_read_b64_tr_b16 v[78:79], v12 offset:2048
  v_mfma_f32_16x16x32_bf16 v[168:171], v[56:59], a[56:59], v[168:171]
  s_add_u32 m0, s33, 24576
  v_mfma_f32_16x16x32_bf16 v[168:171], v[60:63], a[72:75], v[168:171]
  s_mov_b32 s34, 4423936
  v_mfma_f32_16x16x32_bf16 v[168:171], v[64:67], a[88:91], v[168:171]
  buffer_load_dwordx4 v19, s[8:11], s34 offen lds
  v_mfma_f32_16x16x32_bf16 v[172:175], v[56:59], a[60:63], v[172:175]
  s_add_u32 m0, s33, 28672
  v_mfma_f32_16x16x32_bf16 v[172:175], v[60:63], a[76:79], v[172:175]
  s_mov_b32 s34, 4718848
  v_mfma_f32_16x16x32_bf16 v[172:175], v[64:67], a[92:95], v[172:175]
  buffer_load_dwordx4 v19, s[8:11], s34 offen lds
  s_waitcnt lgkmcnt(0)
  v_mfma_f32_16x16x32_bf16 v[176:179], v[68:71], a[48:51], v[176:179]
  ds_read_b64_tr_b16 v[56:57], v9 offset:4096
  v_mfma_f32_16x16x32_bf16 v[176:179], v[72:75], a[64:67], v[176:179]
  ds_read_b64_tr_b16 v[58:59], v9 offset:6144
  v_mfma_f32_16x16x32_bf16 v[176:179], v[76:79], a[80:83], v[176:179]
  ds_read_b64_tr_b16 v[60:61], v9 offset:8192
  v_mfma_f32_16x16x32_bf16 v[180:183], v[68:71], a[52:55], v[180:183]
  ds_read_b64_tr_b16 v[62:63], v9 offset:10240
  v_mfma_f32_16x16x32_bf16 v[180:183], v[72:75], a[68:71], v[180:183]
  ds_read_b64_tr_b16 v[64:65], v9 offset:12288
  v_mfma_f32_16x16x32_bf16 v[180:183], v[76:79], a[84:87], v[180:183]
  ds_read_b64_tr_b16 v[66:67], v9 offset:14336
  v_mfma_f32_16x16x32_bf16 v[184:187], v[68:71], a[56:59], v[184:187]
  s_add_u32 m0, s33, 32768
  v_mfma_f32_16x16x32_bf16 v[184:187], v[72:75], a[72:75], v[184:187]
  s_mov_b32 s34, 5013760
  v_mfma_f32_16x16x32_bf16 v[184:187], v[76:79], a[88:91], v[184:187]
  buffer_load_dwordx4 v19, s[8:11], s34 offen lds
  v_mfma_f32_16x16x32_bf16 v[188:191], v[68:71], a[60:63], v[188:191]
  v_mfma_f32_16x16x32_bf16 v[188:191], v[72:75], a[76:79], v[188:191]
  v_mfma_f32_16x16x32_bf16 v[188:191], v[76:79], a[92:95], v[188:191]
  s_waitcnt lgkmcnt(0)
  v_mfma_f32_16x16x32_bf16 v[128:131], v[56:59], a[96:99], v[128:131]
  s_waitcnt vmcnt(19)
  s_barrier
  v_mfma_f32_16x16x32_bf16 v[128:131], v[60:63], a[112:115], v[128:131]
  ds_read_b64_tr_b16 v[68:69], v12 offset:4096
  v_mfma_f32_16x16x32_bf16 v[128:131], v[64:67], a[128:131], v[128:131]
  ds_read_b64_tr_b16 v[70:71], v12 offset:6144
  v_mfma_f32_16x16x32_bf16 v[132:135], v[56:59], a[100:103], v[132:135]
  ds_read_b64_tr_b16 v[72:73], v12 offset:8192
  v_mfma_f32_16x16x32_bf16 v[132:135], v[60:63], a[116:119], v[132:135]
  ds_read_b64_tr_b16 v[74:75], v12 offset:10240
  v_mfma_f32_16x16x32_bf16 v[132:135], v[64:67], a[132:135], v[132:135]
  ds_read_b64_tr_b16 v[76:77], v12 offset:12288
  v_mfma_f32_16x16x32_bf16 v[136:139], v[56:59], a[104:107], v[136:139]
  ds_read_b64_tr_b16 v[78:79], v12 offset:14336
  v_mfma_f32_16x16x32_bf16 v[136:139], v[60:63], a[120:123], v[136:139]
  s_add_u32 m0, s33, 36864
  v_mfma_f32_16x16x32_bf16 v[136:139], v[64:67], a[136:139], v[136:139]
  s_mov_b32 s34, 384
  v_mfma_f32_16x16x32_bf16 v[140:143], v[56:59], a[108:111], v[140:143]
  buffer_load_dwordx4 v19, s[4:7], s34 offen lds
  v_mfma_f32_16x16x32_bf16 v[140:143], v[60:63], a[124:127], v[140:143]
  s_add_u32 m0, s33, 40960
  v_mfma_f32_16x16x32_bf16 v[140:143], v[64:67], a[140:143], v[140:143]
  s_mov_b32 s34, 295296
  buffer_load_dwordx4 v19, s[4:7], s34 offen lds
  s_waitcnt lgkmcnt(0)
  v_mfma_f32_16x16x32_bf16 v[144:147], v[68:71], a[96:99], v[144:147]
  ds_read_b64_tr_b16 v[56:57], v8
  v_mfma_f32_16x16x32_bf16 v[144:147], v[72:75], a[112:115], v[144:147]
  ds_read_b64_tr_b16 v[58:59], v8 offset:2048
  v_mfma_f32_16x16x32_bf16 v[144:147], v[76:79], a[128:131], v[144:147]
  ds_read_b64_tr_b16 v[60:61], v8 offset:4096
  v_mfma_f32_16x16x32_bf16 v[148:151], v[68:71], a[100:103], v[148:151]
  ds_read_b64_tr_b16 v[62:63], v8 offset:6144
  v_mfma_f32_16x16x32_bf16 v[148:151], v[72:75], a[116:119], v[148:151]
  ds_read_b64_tr_b16 v[64:65], v9 offset:16384
  v_mfma_f32_16x16x32_bf16 v[148:151], v[76:79], a[132:135], v[148:151]
  ds_read_b64_tr_b16 v[66:67], v9 offset:18432
  v_mfma_f32_16x16x32_bf16 v[152:155], v[68:71], a[104:107], v[152:155]
  s_add_u32 m0, s33, 45056
  v_mfma_f32_16x16x32_bf16 v[152:155], v[72:75], a[120:123], v[152:155]
  s_mov_b32 s34, 590208
  v_mfma_f32_16x16x32_bf16 v[152:155], v[76:79], a[136:139], v[152:155]
  buffer_load_dwordx4 v19, s[4:7], s34 offen lds
  v_mfma_f32_16x16x32_bf16 v[156:159], v[68:71], a[108:111], v[156:159]
  v_mfma_f32_16x16x32_bf16 v[156:159], v[72:75], a[124:127], v[156:159]
  v_mfma_f32_16x16x32_bf16 v[156:159], v[76:79], a[140:143], v[156:159]
  s_waitcnt lgkmcnt(0)
  v_mfma_f32_16x16x32_bf16 v[160:163], v[56:59], a[96:99], v[160:163]
  ds_read_b64_tr_b16 v[68:69], v11
  v_mov_b32 v6, 0x7ffffff0
  v_mfma_f32_16x16x32_bf16 v[160:163], v[60:63], a[112:115], v[160:163]
  ds_read_b64_tr_b16 v[70:71], v11 offset:2048
  v_cmp_gt_u32 vcc, 162, v0
  v_mfma_f32_16x16x32_bf16 v[160:163], v[64:67], a[128:131], v[160:163]
  ds_read_b64_tr_b16 v[72:73], v11 offset:4096
  v_cndmask_b32 v93, v6, v93, vcc
  v_mfma_f32_16x16x32_bf16 v[164:167], v[56:59], a[100:103], v[164:167]
  ds_read_b64_tr_b16 v[74:75], v11 offset:6144
  s_mov_b32 s65, 0
  v_mfma_f32_16x16x32_bf16 v[164:167], v[60:63], a[116:119], v[164:167]
  ds_read_b64_tr_b16 v[76:77], v12 offset:16384
  buffer_load_dword v94, v93, s[12:15], s65 offen
  v_mfma_f32_16x16x32_bf16 v[164:167], v[64:67], a[132:135], v[164:167]
  ds_read_b64_tr_b16 v[78:79], v12 offset:18432
  v_mfma_f32_16x16x32_bf16 v[168:171], v[56:59], a[104:107], v[168:171]
  s_add_u32 m0, s33, 49152
  v_mfma_f32_16x16x32_bf16 v[168:171], v[60:63], a[120:123], v[168:171]
  s_mov_b32 s34, 384
  v_mfma_f32_16x16x32_bf16 v[168:171], v[64:67], a[136:139], v[168:171]
  buffer_load_dwordx4 v19, s[8:11], s34 offen lds
  v_mfma_f32_16x16x32_bf16 v[172:175], v[56:59], a[108:111], v[172:175]
  s_add_u32 m0, s33, 53248
  v_mfma_f32_16x16x32_bf16 v[172:175], v[60:63], a[124:127], v[172:175]
  s_mov_b32 s34, 295296
  v_mfma_f32_16x16x32_bf16 v[172:175], v[64:67], a[140:143], v[172:175]
  buffer_load_dwordx4 v19, s[8:11], s34 offen lds
  s_waitcnt lgkmcnt(0)
  v_mfma_f32_16x16x32_bf16 v[176:179], v[68:71], a[96:99], v[176:179]
  ds_read_b64_tr_b16 v[56:57], v9 offset:20480
  v_mfma_f32_16x16x32_bf16 v[176:179], v[72:75], a[112:115], v[176:179]
  ds_read_b64_tr_b16 v[58:59], v9 offset:22528
  v_mfma_f32_16x16x32_bf16 v[176:179], v[76:79], a[128:131], v[176:179]
  ds_read_b64_tr_b16 v[60:61], v10 offset:12288
  v_mfma_f32_16x16x32_bf16 v[180:183], v[68:71], a[100:103], v[180:183]
  ds_read_b64_tr_b16 v[62:63], v10 offset:14336
  v_mfma_f32_16x16x32_bf16 v[180:183], v[72:75], a[116:119], v[180:183]
  ds_read_b64_tr_b16 v[64:65], v10 offset:16384
  v_mfma_f32_16x16x32_bf16 v[180:183], v[76:79], a[132:135], v[180:183]
  ds_read_b64_tr_b16 v[66:67], v10 offset:18432
  v_mfma_f32_16x16x32_bf16 v[184:187], v[68:71], a[104:107], v[184:187]
  s_add_u32 m0, s33, 57344
  v_mfma_f32_16x16x32_bf16 v[184:187], v[72:75], a[120:123], v[184:187]
  s_mov_b32 s34, 590208
  v_mfma_f32_16x16x32_bf16 v[184:187], v[76:79], a[136:139], v[184:187]
  buffer_load_dwordx4 v19, s[8:11], s34 offen lds
  v_mfma_f32_16x16x32_bf16 v[188:191], v[68:71], a[108:111], v[188:191]
  v_mfma_f32_16x16x32_bf16 v[188:191], v[72:75], a[124:127], v[188:191]
  v_mfma_f32_16x16x32_bf16 v[188:191], v[76:79], a[140:143], v[188:191]
  s_waitcnt lgkmcnt(0)
  v_mfma_f32_16x16x32_bf16 v[128:131], v[56:59], a[144:147], v[128:131]
  s_waitcnt vmcnt(19)
  s_barrier
  v_mfma_f32_16x16x32_bf16 v[128:131], v[60:63], a[160:163], v[128:131]
  ds_read_b64_tr_b16 v[68:69], v12 offset:20480
  s_and_b32 s36, s94, 1
  v_mfma_f32_16x16x32_bf16 v[128:131], v[64:67], a[176:179], v[128:131]
  ds_read_b64_tr_b16 v[70:71], v12 offset:22528
  s_lshr_b32 s37, s94, 1
  v_mfma_f32_16x16x32_bf16 v[132:135], v[56:59], a[148:151], v[132:135]
  ds_read_b64_tr_b16 v[72:73], v13 offset:12288
  s_mul_i32 s37, s37, 663552
  v_mfma_f32_16x16x32_bf16 v[132:135], v[60:63], a[164:167], v[132:135]
  ds_read_b64_tr_b16 v[74:75], v13 offset:14336
  s_lshr_b32 s39, s92, 1
  v_mfma_f32_16x16x32_bf16 v[132:135], v[64:67], a[180:183], v[132:135]
  ds_read_b64_tr_b16 v[76:77], v13 offset:16384
  s_and_b32 s40, s92, 1
  v_mfma_f32_16x16x32_bf16 v[136:139], v[56:59], a[152:155], v[136:139]
  ds_read_b64_tr_b16 v[78:79], v13 offset:18432
  s_mul_i32 s38, s36, 640
  v_mfma_f32_16x16x32_bf16 v[136:139], v[60:63], a[168:171], v[136:139]
  s_add_u32 m0, s33, 61440
  s_add_u32 s38, s38, s37
  v_mfma_f32_16x16x32_bf16 v[136:139], v[64:67], a[184:187], v[136:139]
  s_mov_b32 s34, 885120
  v_add_u32 v4, s38, v21
  v_mfma_f32_16x16x32_bf16 v[140:143], v[56:59], a[156:159], v[140:143]
  buffer_load_dwordx4 v19, s[4:7], s34 offen lds
  s_mul_i32 s38, s36, 368640
  v_mfma_f32_16x16x32_bf16 v[140:143], v[60:63], a[172:175], v[140:143]
  s_add_u32 m0, s33, 65536
  v_add_u32 v82, s38, v4
  v_mfma_f32_16x16x32_bf16 v[140:143], v[64:67], a[188:191], v[140:143]
  s_mov_b32 s34, 1180032
  buffer_load_dwordx4 v19, s[4:7], s34 offen lds
  s_waitcnt lgkmcnt(0)
  v_mfma_f32_16x16x32_bf16 v[144:147], v[68:71], a[144:147], v[144:147]
  ds_read_b64_tr_b16 v[56:57], v10 offset:20480
  v_add_u32 v82, 0, v82
  v_mfma_f32_16x16x32_bf16 v[144:147], v[72:75], a[160:163], v[144:147]
  ds_read_b64_tr_b16 v[58:59], v10 offset:22528
  s_mul_i32 s38, s36, 36864
  v_mfma_f32_16x16x32_bf16 v[144:147], v[76:79], a[176:179], v[144:147]
  ds_read_b64_tr_b16 v[60:61], v9 offset:40960
  v_add_u32 v83, s38, v4
  v_mfma_f32_16x16x32_bf16 v[148:151], v[68:71], a[148:151], v[148:151]
  ds_read_b64_tr_b16 v[62:63], v9 offset:43008
  v_add_u32 v83, 294912, v83
  v_mfma_f32_16x16x32_bf16 v[148:151], v[72:75], a[164:167], v[148:151]
  ds_read_b64_tr_b16 v[64:65], v9 offset:45056
  s_mul_i32 s38, s36, -368640
  v_mfma_f32_16x16x32_bf16 v[148:151], v[76:79], a[180:183], v[148:151]
  ds_read_b64_tr_b16 v[66:67], v9 offset:47104
  v_add_u32 v84, s38, v4
  v_mfma_f32_16x16x32_bf16 v[152:155], v[68:71], a[152:155], v[152:155]
  s_add_u32 m0, s33, 69632
  v_add_u32 v84, 368640, v84
  v_mfma_f32_16x16x32_bf16 v[152:155], v[72:75], a[168:171], v[152:155]
  s_mov_b32 s34, 1474944
  s_mul_i32 s38, s36, -36864
  v_mfma_f32_16x16x32_bf16 v[152:155], v[76:79], a[184:187], v[152:155]
  buffer_load_dwordx4 v19, s[4:7], s34 offen lds
  v_add_u32 v85, s38, v4
  v_mfma_f32_16x16x32_bf16 v[156:159], v[68:71], a[156:159], v[156:159]
  v_add_u32 v85, 331776, v85
  v_mfma_f32_16x16x32_bf16 v[156:159], v[72:75], a[172:175], v[156:159]
  v_and_b32 v1, 63, v0
  v_mfma_f32_16x16x32_bf16 v[156:159], v[76:79], a[188:191], v[156:159]
  v_bfe_u32 v4, v1, 1, 1
  s_waitcnt lgkmcnt(0)
  v_mfma_f32_16x16x32_bf16 v[160:163], v[56:59], a[144:147], v[160:163]
  ds_read_b64_tr_b16 v[68:69], v13 offset:20480
  v_bfe_u32 v5, v1, 4, 1
  v_mfma_f32_16x16x32_bf16 v[160:163], v[60:63], a[160:163], v[160:163]
  ds_read_b64_tr_b16 v[70:71], v13 offset:22528
  v_xor_b32 v4, v4, v5
  v_mfma_f32_16x16x32_bf16 v[160:163], v[64:67], a[176:179], v[160:163]
  ds_read_b64_tr_b16 v[72:73], v12 offset:40960
  v_lshlrev_b32 v4, 5, v4
  v_mfma_f32_16x16x32_bf16 v[164:167], v[56:59], a[148:151], v[164:167]
  ds_read_b64_tr_b16 v[74:75], v12 offset:43008
  v_and_b32 v5, 1, v1
  v_mfma_f32_16x16x32_bf16 v[164:167], v[60:63], a[164:167], v[164:167]
  ds_read_b64_tr_b16 v[76:77], v12 offset:45056
  v_lshl_add_u32 v4, v5, 4, v4
  v_mfma_f32_16x16x32_bf16 v[164:167], v[64:67], a[180:183], v[164:167]
  ds_read_b64_tr_b16 v[78:79], v12 offset:47104
  v_lshrrev_b32 v5, 2, v1
  v_mfma_f32_16x16x32_bf16 v[168:171], v[56:59], a[152:155], v[168:171]
  s_add_u32 m0, s33, 73728
  s_lshl_b32 s38, s40, 4
  v_mfma_f32_16x16x32_bf16 v[168:171], v[60:63], a[168:171], v[168:171]
  s_mov_b32 s34, 885120
  v_add_u32 v5, s38, v5
  v_mfma_f32_16x16x32_bf16 v[168:171], v[64:67], a[184:187], v[168:171]
  buffer_load_dwordx4 v19, s[8:11], s34 offen lds
  v_mul_u32_u24 v5, 1152, v5
  v_mfma_f32_16x16x32_bf16 v[172:175], v[56:59], a[156:159], v[172:175]
  s_add_u32 m0, s33, 77824
  s_lshl_b32 s38, s36, 6
  v_mfma_f32_16x16x32_bf16 v[172:175], v[60:63], a[172:175], v[172:175]
  s_mov_b32 s34, 1180032
  s_add_u32 s38, s38, s37
  v_mfma_f32_16x16x32_bf16 v[172:175], v[64:67], a[188:191], v[172:175]
  buffer_load_dwordx4 v19, s[8:11], s34 offen lds
  s_waitcnt lgkmcnt(0)
  v_mfma_f32_16x16x32_bf16 v[176:179], v[68:71], a[144:147], v[176:179]
  ds_read_b64_tr_b16 v[56:57], v10 offset:24576
  s_add_u32 s38, s38, 512
  v_mfma_f32_16x16x32_bf16 v[176:179], v[72:75], a[160:163], v[176:179]
  ds_read_b64_tr_b16 v[58:59], v10 offset:26624
  v_add3_u32 v4, v4, v5, s38
  v_mfma_f32_16x16x32_bf16 v[176:179], v[76:79], a[176:179], v[176:179]
  ds_read_b64_tr_b16 v[60:61], v10 offset:28672
  s_xor_b32 s38, s36, s39
  v_mfma_f32_16x16x32_bf16 v[180:183], v[68:71], a[148:151], v[180:183]
  ds_read_b64_tr_b16 v[62:63], v10 offset:30720
  s_mul_i32 s41, s38, 368640
  v_mfma_f32_16x16x32_bf16 v[180:183], v[72:75], a[164:167], v[180:183]
  ds_read_b64_tr_b16 v[64:65], v8 offset:8192
  v_add_u32 v86, s41, v4
  v_mfma_f32_16x16x32_bf16 v[180:183], v[76:79], a[180:183], v[180:183]
  ds_read_b64_tr_b16 v[66:67], v8 offset:10240
  s_mul_i32 s41, s38, 36864
  v_mfma_f32_16x16x32_bf16 v[184:187], v[68:71], a[152:155], v[184:187]
  s_add_u32 m0, s33, 0
  s_add_u32 s41, s41, 294912
  v_mfma_f32_16x16x32_bf16 v[184:187], v[72:75], a[168:171], v[184:187]
  s_mov_b32 s34, 1474944
  v_add_u32 v87, s41, v4
  v_mfma_f32_16x16x32_bf16 v[184:187], v[76:79], a[184:187], v[184:187]
  buffer_load_dwordx4 v19, s[8:11], s34 offen lds
  s_mul_i32 s38, s39, 36864
  v_mfma_f32_16x16x32_bf16 v[188:191], v[68:71], a[156:159], v[188:191]
  v_add_u32 v89, s38, v24
  v_mfma_f32_16x16x32_bf16 v[188:191], v[72:75], a[172:175], v[188:191]
  v_lshlrev_b32 v4, 3, v1
  v_mfma_f32_16x16x32_bf16 v[188:191], v[76:79], a[188:191], v[188:191]
  v_add_u32 v90, s38, v4
  s_waitcnt lgkmcnt(0)
  v_mfma_f32_16x16x32_bf16 v[128:131], v[56:59], a[192:195], v[128:131]
  s_waitcnt vmcnt(16)
  s_barrier
  v_mfma_f32_16x16x32_bf16 v[128:131], v[60:63], a[208:211], v[128:131]
  ds_read_b64_tr_b16 v[68:69], v13 offset:24576
  s_lshl_b32 s41, s40, 10
  v_mfma_f32_16x16x32_bf16 v[128:131], v[64:67], a[224:227], v[128:131]
  ds_read_b64_tr_b16 v[70:71], v13 offset:26624
  v_add_u32 v88, s41, v89
  v_mfma_f32_16x16x32_bf16 v[132:135], v[56:59], a[196:199], v[132:135]
  ds_read_b64_tr_b16 v[72:73], v13 offset:28672
  s_xor_b32 s38, s94, 1
  v_mfma_f32_16x16x32_bf16 v[132:135], v[60:63], a[212:215], v[132:135]
  ds_read_b64_tr_b16 v[74:75], v13 offset:30720
  s_lshl_b32 s41, s93, 4
  v_mfma_f32_16x16x32_bf16 v[132:135], v[64:67], a[228:231], v[132:135]
  ds_read_b64_tr_b16 v[76:77], v11 offset:8192
  s_add_u32 s41, s41, s38
  v_mfma_f32_16x16x32_bf16 v[136:139], v[56:59], a[200:203], v[136:139]
  ds_read_b64_tr_b16 v[78:79], v11 offset:10240
  s_lshl_b32 s39, s93, 11
  v_mfma_f32_16x16x32_bf16 v[136:139], v[60:63], a[216:219], v[136:139]
  s_add_u32 m0, s33, 4096
  s_lshl_b32 s38, s38, 7
  v_mfma_f32_16x16x32_bf16 v[136:139], v[64:67], a[232:235], v[136:139]
  s_mov_b32 s34, 1769856
  s_add_u32 s38, s38, s39
  v_mfma_f32_16x16x32_bf16 v[140:143], v[56:59], a[204:207], v[140:143]
  buffer_load_dwordx4 v19, s[4:7], s34 offen lds
  v_mov_b32 v91, s38
  v_mfma_f32_16x16x32_bf16 v[140:143], v[60:63], a[220:223], v[140:143]
  s_add_u32 m0, s33, 81920
  s_mul_i32 s41, s41, 73728
  v_mfma_f32_16x16x32_bf16 v[140:143], v[64:67], a[236:239], v[140:143]
  s_mov_b32 s34, 2064768
  buffer_load_dwordx4 v19, s[4:7], s34 offen lds
  s_waitcnt lgkmcnt(0)
  v_mfma_f32_16x16x32_bf16 v[144:147], v[68:71], a[192:195], v[144:147]
  ds_read_b64_tr_b16 v[56:57], v8 offset:12288
  s_add_u32 s41, s41, 7774208
  v_mfma_f32_16x16x32_bf16 v[144:147], v[72:75], a[208:211], v[144:147]
  ds_read_b64_tr_b16 v[58:59], v8 offset:14336
  s_add_u32 s68, s90, s41
  s_addc_u32 s69, s91, 0
  v_mfma_f32_16x16x32_bf16 v[144:147], v[76:79], a[224:227], v[144:147]
  ds_read_b64_tr_b16 v[60:61], v9 offset:49152
  s_and_b32 s69, s69, 0xffff
  v_mfma_f32_16x16x32_bf16 v[148:151], v[68:71], a[196:199], v[148:151]
  ds_read_b64_tr_b16 v[62:63], v9 offset:51200
  s_mov_b32 s70, 73728
  v_mfma_f32_16x16x32_bf16 v[148:151], v[72:75], a[212:215], v[148:151]
  ds_read_b64_tr_b16 v[64:65], v9 offset:53248
  s_mov_b32 s71, 0x20000
  v_mfma_f32_16x16x32_bf16 v[148:151], v[76:79], a[228:231], v[148:151]
  ds_read_b64_tr_b16 v[66:67], v9 offset:55296
  v_mfma_f32_16x16x32_bf16 v[152:155], v[68:71], a[200:203], v[152:155]
  s_add_u32 m0, s33, 86016
  v_mfma_f32_16x16x32_bf16 v[152:155], v[72:75], a[216:219], v[152:155]
  s_mov_b32 s34, 2359680
  v_mfma_f32_16x16x32_bf16 v[152:155], v[76:79], a[232:235], v[152:155]
  buffer_load_dwordx4 v19, s[4:7], s34 offen lds
  v_mfma_f32_16x16x32_bf16 v[156:159], v[68:71], a[204:207], v[156:159]
  v_mfma_f32_16x16x32_bf16 v[156:159], v[72:75], a[220:223], v[156:159]
  v_mfma_f32_16x16x32_bf16 v[156:159], v[76:79], a[236:239], v[156:159]
  s_waitcnt lgkmcnt(0)
  v_mfma_f32_16x16x32_bf16 v[160:163], v[56:59], a[192:195], v[160:163]
  ds_read_b64_tr_b16 v[68:69], v11 offset:12288
  v_mfma_f32_16x16x32_bf16 v[160:163], v[60:63], a[208:211], v[160:163]
  ds_read_b64_tr_b16 v[70:71], v11 offset:14336
  v_mfma_f32_16x16x32_bf16 v[160:163], v[64:67], a[224:227], v[160:163]
  ds_read_b64_tr_b16 v[72:73], v12 offset:49152
  v_mfma_f32_16x16x32_bf16 v[164:167], v[56:59], a[196:199], v[164:167]
  ds_read_b64_tr_b16 v[74:75], v12 offset:51200
  v_mfma_f32_16x16x32_bf16 v[164:167], v[60:63], a[212:215], v[164:167]
  ds_read_b64_tr_b16 v[76:77], v12 offset:53248
  v_mfma_f32_16x16x32_bf16 v[164:167], v[64:67], a[228:231], v[164:167]
  ds_read_b64_tr_b16 v[78:79], v12 offset:55296
  v_mfma_f32_16x16x32_bf16 v[168:171], v[56:59], a[200:203], v[168:171]
  s_add_u32 m0, s33, 151552
  v_mfma_f32_16x16x32_bf16 v[168:171], v[60:63], a[216:219], v[168:171]
  s_mov_b32 s34, 1769856
  v_mfma_f32_16x16x32_bf16 v[168:171], v[64:67], a[232:235], v[168:171]
  buffer_load_dwordx4 v19, s[8:11], s34 offen lds
  v_mfma_f32_16x16x32_bf16 v[172:175], v[56:59], a[204:207], v[172:175]
  v_mfma_f32_16x16x32_bf16 v[172:175], v[60:63], a[220:223], v[172:175]
  v_mfma_f32_16x16x32_bf16 v[172:175], v[64:67], a[236:239], v[172:175]
  s_waitcnt lgkmcnt(0)
  v_mfma_f32_16x16x32_bf16 v[176:179], v[68:71], a[192:195], v[176:179]
  ds_read_b64_tr_b16 v[56:57], v9 offset:57344
  v_mfma_f32_16x16x32_bf16 v[176:179], v[72:75], a[208:211], v[176:179]
  ds_read_b64_tr_b16 v[58:59], v9 offset:59392
  v_mfma_f32_16x16x32_bf16 v[176:179], v[76:79], a[224:227], v[176:179]
  ds_read_b64_tr_b16 v[60:61], v8 offset:16384
  v_mfma_f32_16x16x32_bf16 v[180:183], v[68:71], a[196:199], v[180:183]
  ds_read_b64_tr_b16 v[62:63], v8 offset:18432
  v_mfma_f32_16x16x32_bf16 v[180:183], v[72:75], a[212:215], v[180:183]
  ds_read_b64_tr_b16 v[64:65], v8 offset:20480
  v_mfma_f32_16x16x32_bf16 v[180:183], v[76:79], a[228:231], v[180:183]
  ds_read_b64_tr_b16 v[66:67], v8 offset:22528
  v_mfma_f32_16x16x32_bf16 v[184:187], v[68:71], a[200:203], v[184:187]
  v_mfma_f32_16x16x32_bf16 v[184:187], v[72:75], a[216:219], v[184:187]
  v_mfma_f32_16x16x32_bf16 v[184:187], v[76:79], a[232:235], v[184:187]
  v_mfma_f32_16x16x32_bf16 v[188:191], v[68:71], a[204:207], v[188:191]
  v_mfma_f32_16x16x32_bf16 v[188:191], v[72:75], a[220:223], v[188:191]
  v_mfma_f32_16x16x32_bf16 v[188:191], v[76:79], a[236:239], v[188:191]
  s_waitcnt lgkmcnt(0)
  v_mfma_f32_16x16x32_bf16 v[128:131], v[56:59], a[240:243], v[128:131]
  s_waitcnt vmcnt(14)
  s_barrier
  v_mfma_f32_16x16x32_bf16 v[128:131], v[60:63], v[96:99], v[128:131]
  ds_read_b64_tr_b16 v[68:69], v12 offset:57344
  v_mfma_f32_16x16x32_bf16 v[128:131], v[64:67], v[112:115], v[128:131]
  ds_read_b64_tr_b16 v[70:71], v12 offset:59392
  v_mfma_f32_16x16x32_bf16 v[132:135], v[56:59], a[244:247], v[132:135]
  ds_read_b64_tr_b16 v[72:73], v11 offset:16384
  v_mfma_f32_16x16x32_bf16 v[132:135], v[60:63], v[100:103], v[132:135]
  ds_read_b64_tr_b16 v[74:75], v11 offset:18432
  v_mfma_f32_16x16x32_bf16 v[132:135], v[64:67], v[116:119], v[132:135]
  ds_read_b64_tr_b16 v[76:77], v11 offset:20480
  v_mfma_f32_16x16x32_bf16 v[136:139], v[56:59], a[248:251], v[136:139]
  ds_read_b64_tr_b16 v[78:79], v11 offset:22528
  v_mfma_f32_16x16x32_bf16 v[136:139], v[60:63], v[104:107], v[136:139]
  s_add_u32 m0, s33, 155648
  v_mfma_f32_16x16x32_bf16 v[136:139], v[64:67], v[120:123], v[136:139]
  s_mov_b32 s34, 2064768
  v_mfma_f32_16x16x32_bf16 v[140:143], v[56:59], a[252:255], v[140:143]
  buffer_load_dwordx4 v19, s[8:11], s34 offen lds
  v_mfma_f32_16x16x32_bf16 v[140:143], v[60:63], v[108:111], v[140:143]
  s_add_u32 m0, s33, 159744
  v_mfma_f32_16x16x32_bf16 v[140:143], v[64:67], v[124:127], v[140:143]
  s_mov_b32 s34, 2359680
  buffer_load_dwordx4 v19, s[8:11], s34 offen lds
  s_waitcnt lgkmcnt(0)
  v_mfma_f32_16x16x32_bf16 v[144:147], v[68:71], a[240:243], v[144:147]
  ds_read_b64_tr_b16 v[56:57], v8 offset:24576
  v_mfma_f32_16x16x32_bf16 v[144:147], v[72:75], v[96:99], v[144:147]
  ds_read_b64_tr_b16 v[58:59], v8 offset:26624
  v_mfma_f32_16x16x32_bf16 v[144:147], v[76:79], v[112:115], v[144:147]
  ds_read_b64_tr_b16 v[60:61], v8 offset:28672
  v_mfma_f32_16x16x32_bf16 v[148:151], v[68:71], a[244:247], v[148:151]
  ds_read_b64_tr_b16 v[62:63], v8 offset:30720
  v_mfma_f32_16x16x32_bf16 v[148:151], v[72:75], v[100:103], v[148:151]
  ds_read_b64_tr_b16 v[64:65], v8 offset:32768
  v_mfma_f32_16x16x32_bf16 v[148:151], v[76:79], v[116:119], v[148:151]
  ds_read_b64_tr_b16 v[66:67], v8 offset:34816
  v_mfma_f32_16x16x32_bf16 v[152:155], v[68:71], a[248:251], v[152:155]
  s_add_u32 m0, s33, 8192
  v_mfma_f32_16x16x32_bf16 v[152:155], v[72:75], v[104:107], v[152:155]
  s_mov_b32 s34, 2654592
  v_mfma_f32_16x16x32_bf16 v[152:155], v[76:79], v[120:123], v[152:155]
  buffer_load_dwordx4 v19, s[4:7], s34 offen lds
  v_mfma_f32_16x16x32_bf16 v[156:159], v[68:71], a[252:255], v[156:159]
  s_add_u32 m0, s33, 12288
  v_mfma_f32_16x16x32_bf16 v[156:159], v[72:75], v[108:111], v[156:159]
  s_mov_b32 s34, 2949504
  v_mfma_f32_16x16x32_bf16 v[156:159], v[76:79], v[124:127], v[156:159]
  buffer_load_dwordx4 v19, s[4:7], s34 offen lds
  s_waitcnt lgkmcnt(0)
  v_mfma_f32_16x16x32_bf16 v[160:163], v[56:59], a[240:243], v[160:163]
  ds_read_b64_tr_b16 v[68:69], v11 offset:24576
  v_mfma_f32_16x16x32_bf16 v[160:163], v[60:63], v[96:99], v[160:163]
  ds_read_b64_tr_b16 v[70:71], v11 offset:26624
  v_mfma_f32_16x16x32_bf16 v[160:163], v[64:67], v[112:115], v[160:163]
  ds_read_b64_tr_b16 v[72:73], v11 offset:28672
  v_mfma_f32_16x16x32_bf16 v[164:167], v[56:59], a[244:247], v[164:167]
  ds_read_b64_tr_b16 v[74:75], v11 offset:30720
  v_mfma_f32_16x16x32_bf16 v[164:167], v[60:63], v[100:103], v[164:167]
  ds_read_b64_tr_b16 v[76:77], v11 offset:32768
  v_mfma_f32_16x16x32_bf16 v[164:167], v[64:67], v[116:119], v[164:167]
  ds_read_b64_tr_b16 v[78:79], v11 offset:34816
  v_mfma_f32_16x16x32_bf16 v[168:171], v[56:59], a[248:251], v[168:171]
  s_add_u32 m0, s33, 114688
  v_mfma_f32_16x16x32_bf16 v[168:171], v[60:63], v[104:107], v[168:171]
  s_mov_b32 s34, 3244416
  v_mfma_f32_16x16x32_bf16 v[168:171], v[64:67], v[120:123], v[168:171]
  buffer_load_dwordx4 v19, s[4:7], s34 offen lds
  v_mfma_f32_16x16x32_bf16 v[172:175], v[56:59], a[252:255], v[172:175]
  s_add_u32 m0, s33, 118784
  v_mfma_f32_16x16x32_bf16 v[172:175], v[60:63], v[108:111], v[172:175]
  s_mov_b32 s34, 2654592
  v_mfma_f32_16x16x32_bf16 v[172:175], v[64:67], v[124:127], v[172:175]
  buffer_load_dwordx4 v19, s[8:11], s34 offen lds
  s_waitcnt lgkmcnt(0)
  v_mfma_f32_16x16x32_bf16 v[176:179], v[68:71], a[240:243], v[176:179]
  ds_read_b64_tr_b16 v[56:57], v8 offset:36864
  v_mfma_f32_16x16x32_bf16 v[176:179], v[72:75], v[96:99], v[176:179]
  ds_read_b64_tr_b16 v[58:59], v8 offset:38912
  v_mfma_f32_16x16x32_bf16 v[176:179], v[76:79], v[112:115], v[176:179]
  ds_read_b64_tr_b16 v[60:61], v8 offset:40960
  v_mfma_f32_16x16x32_bf16 v[180:183], v[68:71], a[244:247], v[180:183]
  ds_read_b64_tr_b16 v[62:63], v8 offset:43008
  v_mfma_f32_16x16x32_bf16 v[180:183], v[72:75], v[100:103], v[180:183]
  ds_read_b64_tr_b16 v[64:65], v8 offset:45056
  v_mfma_f32_16x16x32_bf16 v[180:183], v[76:79], v[116:119], v[180:183]
  ds_read_b64_tr_b16 v[66:67], v8 offset:47104
  v_mfma_f32_16x16x32_bf16 v[184:187], v[68:71], a[248:251], v[184:187]
  v_mfma_f32_16x16x32_bf16 v[184:187], v[72:75], v[104:107], v[184:187]
  v_mfma_f32_16x16x32_bf16 v[184:187], v[76:79], v[120:123], v[184:187]
  v_mfma_f32_16x16x32_bf16 v[188:191], v[68:71], a[252:255], v[188:191]
  v_mfma_f32_16x16x32_bf16 v[188:191], v[72:75], v[108:111], v[188:191]
  v_mfma_f32_16x16x32_bf16 v[188:191], v[76:79], v[124:127], v[188:191]
  s_waitcnt lgkmcnt(0)
  v_mfma_f32_16x16x32_bf16 v[192:195], v[56:59], a[0:3], 0
  s_waitcnt vmcnt(13)
  s_barrier
  v_mfma_f32_16x16x32_bf16 v[192:195], v[60:63], a[16:19], v[192:195]
  ds_read_b64_tr_b16 v[68:69], v11 offset:36864
  v_mul_f32 v128, v128, v160
  v_mfma_f32_16x16x32_bf16 v[192:195], v[64:67], a[32:35], v[192:195]
  ds_read_b64_tr_b16 v[70:71], v11 offset:38912
  v_mul_f32 v129, v129, v161
  v_mfma_f32_16x16x32_bf16 v[196:199], v[56:59], a[4:7], 0
  ds_read_b64_tr_b16 v[72:73], v11 offset:40960
  v_mul_f32 v130, v130, v162
  v_mfma_f32_16x16x32_bf16 v[196:199], v[60:63], a[20:23], v[196:199]
  ds_read_b64_tr_b16 v[74:75], v11 offset:43008
  v_mul_f32 v131, v131, v163
  v_mfma_f32_16x16x32_bf16 v[196:199], v[64:67], a[36:39], v[196:199]
  ds_read_b64_tr_b16 v[76:77], v11 offset:45056
  v_cvt_pk_bf16_f32 v32, v128, v129
  v_mfma_f32_16x16x32_bf16 v[200:203], v[56:59], a[8:11], 0
  ds_read_b64_tr_b16 v[78:79], v11 offset:47104
  v_cvt_pk_bf16_f32 v33, v130, v131
  v_mfma_f32_16x16x32_bf16 v[200:203], v[60:63], a[24:27], v[200:203]
  v_mul_f32 v144, v144, v176
  v_mfma_f32_16x16x32_bf16 v[200:203], v[64:67], a[40:43], v[200:203]
  v_mul_f32 v145, v145, v177
  v_mfma_f32_16x16x32_bf16 v[204:207], v[56:59], a[12:15], 0
  v_mul_f32 v146, v146, v178
  v_mfma_f32_16x16x32_bf16 v[204:207], v[60:63], a[28:31], v[204:207]
  v_mul_f32 v147, v147, v179
  v_mfma_f32_16x16x32_bf16 v[204:207], v[64:67], a[44:47], v[204:207]
  v_cvt_pk_bf16_f32 v34, v144, v145
  s_waitcnt lgkmcnt(0)
  v_mfma_f32_16x16x32_bf16 v[208:211], v[68:71], a[0:3], 0
  ds_read_b64_tr_b16 v[56:57], v8 offset:49152
  v_cvt_pk_bf16_f32 v35, v146, v147
  v_mfma_f32_16x16x32_bf16 v[208:211], v[72:75], a[16:19], v[208:211]
  ds_read_b64_tr_b16 v[58:59], v8 offset:51200
  ds_write_b128 v17, v[32:35] offset:16384
  v_mfma_f32_16x16x32_bf16 v[208:211], v[76:79], a[32:35], v[208:211]
  ds_read_b64_tr_b16 v[60:61], v8 offset:53248
  s_mov_b32 s61, 16384
  v_mfma_f32_16x16x32_bf16 v[212:215], v[68:71], a[4:7], 0
  ds_read_b64_tr_b16 v[62:63], v8 offset:55296
  buffer_store_dwordx4 v[32:35], v80, s[28:31], s61 offen sc1
  v_mfma_f32_16x16x32_bf16 v[212:215], v[72:75], a[20:23], v[212:215]
  ds_read_b64_tr_b16 v[64:65], v8 offset:57344
  v_mul_f32 v132, v132, v164
  v_mfma_f32_16x16x32_bf16 v[212:215], v[76:79], a[36:39], v[212:215]
  ds_read_b64_tr_b16 v[66:67], v8 offset:59392
  v_mul_f32 v133, v133, v165
  v_mfma_f32_16x16x32_bf16 v[216:219], v[68:71], a[8:11], 0
  v_mul_f32 v134, v134, v166
  v_mfma_f32_16x16x32_bf16 v[216:219], v[72:75], a[24:27], v[216:219]
  v_mul_f32 v135, v135, v167
  v_mfma_f32_16x16x32_bf16 v[216:219], v[76:79], a[40:43], v[216:219]
  v_cvt_pk_bf16_f32 v36, v132, v133
  v_mfma_f32_16x16x32_bf16 v[220:223], v[68:71], a[12:15], 0
  v_cvt_pk_bf16_f32 v37, v134, v135
  v_mfma_f32_16x16x32_bf16 v[220:223], v[72:75], a[28:31], v[220:223]
  v_mul_f32 v148, v148, v180
  v_mfma_f32_16x16x32_bf16 v[220:223], v[76:79], a[44:47], v[220:223]
  v_mul_f32 v149, v149, v181
  s_waitcnt lgkmcnt(0)
  v_mfma_f32_16x16x32_bf16 v[224:227], v[56:59], a[0:3], 0
  ds_read_b64_tr_b16 v[68:69], v11 offset:49152
  v_mul_f32 v150, v150, v182
  v_mfma_f32_16x16x32_bf16 v[224:227], v[60:63], a[16:19], v[224:227]
  ds_read_b64_tr_b16 v[70:71], v11 offset:51200
  v_mul_f32 v151, v151, v183
  v_mfma_f32_16x16x32_bf16 v[224:227], v[64:67], a[32:35], v[224:227]
  ds_read_b64_tr_b16 v[72:73], v11 offset:53248
  v_cvt_pk_bf16_f32 v38, v148, v149
  v_mfma_f32_16x16x32_bf16 v[228:231], v[56:59], a[4:7], 0
  ds_read_b64_tr_b16 v[74:75], v11 offset:55296
  v_cvt_pk_bf16_f32 v39, v150, v151
  v_mfma_f32_16x16x32_bf16 v[228:231], v[60:63], a[20:23], v[228:231]
  ds_read_b64_tr_b16 v[76:77], v11 offset:57344
  ds_write_b128 v17, v[36:39] offset:17408
  v_mfma_f32_16x16x32_bf16 v[228:231], v[64:67], a[36:39], v[228:231]
  ds_read_b64_tr_b16 v[78:79], v11 offset:59392
  s_mov_b32 s61, 17408
  v_mfma_f32_16x16x32_bf16 v[232:235], v[56:59], a[8:11], 0
  buffer_store_dwordx4 v[36:39], v80, s[28:31], s61 offen sc1
  v_mfma_f32_16x16x32_bf16 v[232:235], v[60:63], a[24:27], v[232:235]
  v_mul_f32 v136, v136, v168
  v_mfma_f32_16x16x32_bf16 v[232:235], v[64:67], a[40:43], v[232:235]
  v_mul_f32 v137, v137, v169
  v_mfma_f32_16x16x32_bf16 v[236:239], v[56:59], a[12:15], 0
  v_mul_f32 v138, v138, v170
  v_mfma_f32_16x16x32_bf16 v[236:239], v[60:63], a[28:31], v[236:239]
  v_mul_f32 v139, v139, v171
  v_mfma_f32_16x16x32_bf16 v[236:239], v[64:67], a[44:47], v[236:239]
  v_cvt_pk_bf16_f32 v32, v136, v137
  s_waitcnt lgkmcnt(0)
  v_mfma_f32_16x16x32_bf16 v[240:243], v[68:71], a[0:3], 0
  ds_read_b64_tr_b16 v[56:57], v8 offset:61440
  v_cvt_pk_bf16_f32 v33, v138, v139
  v_mfma_f32_16x16x32_bf16 v[240:243], v[72:75], a[16:19], v[240:243]
  ds_read_b64_tr_b16 v[58:59], v8 offset:63488
  v_mul_f32 v152, v152, v184
  v_mfma_f32_16x16x32_bf16 v[240:243], v[76:79], a[32:35], v[240:243]
  ds_read_b64_tr_b16 v[60:61], v9
  v_mul_f32 v153, v153, v185
  v_mfma_f32_16x16x32_bf16 v[244:247], v[68:71], a[4:7], 0
  ds_read_b64_tr_b16 v[62:63], v9 offset:2048
  v_mul_f32 v154, v154, v186
  v_mfma_f32_16x16x32_bf16 v[244:247], v[72:75], a[20:23], v[244:247]
  ds_read_b64_tr_b16 v[64:65], v9 offset:4096
  v_mul_f32 v155, v155, v187
  v_mfma_f32_16x16x32_bf16 v[244:247], v[76:79], a[36:39], v[244:247]
  ds_read_b64_tr_b16 v[66:67], v9 offset:6144
  v_cvt_pk_bf16_f32 v34, v152, v153
  v_mfma_f32_16x16x32_bf16 v[248:251], v[68:71], a[8:11], 0
  v_cvt_pk_bf16_f32 v35, v154, v155
  v_mfma_f32_16x16x32_bf16 v[248:251], v[72:75], a[24:27], v[248:251]
  ds_write_b128 v17, v[32:35] offset:18432
  v_mfma_f32_16x16x32_bf16 v[248:251], v[76:79], a[40:43], v[248:251]
  s_mov_b32 s61, 18432
  v_mfma_f32_16x16x32_bf16 v[252:255], v[68:71], a[12:15], 0
  buffer_store_dwordx4 v[32:35], v80, s[28:31], s61 offen sc1
  v_mfma_f32_16x16x32_bf16 v[252:255], v[72:75], a[28:31], v[252:255]
  v_mul_f32 v140, v140, v172
  v_mfma_f32_16x16x32_bf16 v[252:255], v[76:79], a[44:47], v[252:255]
  v_mul_f32 v141, v141, v173
  s_waitcnt lgkmcnt(1)
  v_mfma_f32_16x16x32_bf16 v[192:195], v[56:59], a[48:51], v[192:195]
  s_waitcnt vmcnt(10)
  s_barrier
  v_mfma_f32_16x16x32_bf16 v[192:195], v[60:63], a[64:67], v[192:195]
  ds_read_b64_tr_b16 v[68:69], v11 offset:61440
  v_mul_f32 v142, v142, v174
  v_mfma_f32_16x16x32_bf16 v[192:195], v[64:67], a[80:83], v[192:195]
  ds_read_b64_tr_b16 v[70:71], v11 offset:63488
  v_mul_f32 v143, v143, v175
  v_mfma_f32_16x16x32_bf16 v[196:199], v[56:59], a[52:55], v[196:199]
  ds_read_b64_tr_b16 v[72:73], v12
  v_cvt_pk_bf16_f32 v36, v140, v141
  v_mfma_f32_16x16x32_bf16 v[196:199], v[60:63], a[68:71], v[196:199]
  ds_read_b64_tr_b16 v[74:75], v12 offset:2048
  v_cvt_pk_bf16_f32 v37, v142, v143
  v_mfma_f32_16x16x32_bf16 v[196:199], v[64:67], a[84:87], v[196:199]
  ds_read_b64_tr_b16 v[76:77], v12 offset:4096
  v_mul_f32 v156, v156, v188
  v_mfma_f32_16x16x32_bf16 v[200:203], v[56:59], a[56:59], v[200:203]
  ds_read_b64_tr_b16 v[78:79], v12 offset:6144
  v_mul_f32 v157, v157, v189
  v_mfma_f32_16x16x32_bf16 v[200:203], v[60:63], a[72:75], v[200:203]
  s_add_u32 m0, s33, 122880
  v_mul_f32 v158, v158, v190
  v_mfma_f32_16x16x32_bf16 v[200:203], v[64:67], a[88:91], v[200:203]
  s_mov_b32 s34, 2949504
  v_mul_f32 v159, v159, v191
  v_mfma_f32_16x16x32_bf16 v[204:207], v[56:59], a[60:63], v[204:207]
  buffer_load_dwordx4 v19, s[8:11], s34 offen lds
  v_cvt_pk_bf16_f32 v38, v156, v157
  v_mfma_f32_16x16x32_bf16 v[204:207], v[60:63], a[76:79], v[204:207]
  s_add_u32 m0, s33, 16384
  v_cvt_pk_bf16_f32 v39, v158, v159
  v_mfma_f32_16x16x32_bf16 v[204:207], v[64:67], a[92:95], v[204:207]
  s_mov_b32 s34, 3244416
  buffer_load_dwordx4 v19, s[8:11], s34 offen lds
  s_waitcnt lgkmcnt(0)
  v_mfma_f32_16x16x32_bf16 v[208:211], v[68:71], a[48:51], v[208:211]
  ds_read_b64_tr_b16 v[56:57], v9 offset:8192
  ds_write_b128 v17, v[36:39] offset:19456
  v_mfma_f32_16x16x32_bf16 v[208:211], v[72:75], a[64:67], v[208:211]
  ds_read_b64_tr_b16 v[58:59], v9 offset:10240
  s_mov_b32 s61, 19456
  v_mfma_f32_16x16x32_bf16 v[208:211], v[76:79], a[80:83], v[208:211]
  ds_read_b64_tr_b16 v[60:61], v9 offset:12288
  buffer_store_dwordx4 v[36:39], v80, s[28:31], s61 offen sc1
  v_mfma_f32_16x16x32_bf16 v[212:215], v[68:71], a[52:55], v[212:215]
  ds_read_b64_tr_b16 v[62:63], v9 offset:14336
  v_mfma_f32_16x16x32_bf16 v[212:215], v[72:75], a[68:71], v[212:215]
  ds_read_b64_tr_b16 v[64:65], v8
  v_mfma_f32_16x16x32_bf16 v[212:215], v[76:79], a[84:87], v[212:215]
  ds_read_b64_tr_b16 v[66:67], v8 offset:2048
  v_mfma_f32_16x16x32_bf16 v[216:219], v[68:71], a[56:59], v[216:219]
  v_mfma_f32_16x16x32_bf16 v[216:219], v[72:75], a[72:75], v[216:219]
  v_mfma_f32_16x16x32_bf16 v[216:219], v[76:79], a[88:91], v[216:219]
  v_mfma_f32_16x16x32_bf16 v[220:223], v[68:71], a[60:63], v[220:223]
  v_mfma_f32_16x16x32_bf16 v[220:223], v[72:75], a[76:79], v[220:223]
  v_mfma_f32_16x16x32_bf16 v[220:223], v[76:79], a[92:95], v[220:223]
  s_waitcnt lgkmcnt(0)
  v_mfma_f32_16x16x32_bf16 v[224:227], v[56:59], a[48:51], v[224:227]
  ds_read_b64_tr_b16 v[68:69], v12 offset:8192
  s_add_u32 s72, s90, 26648576
  s_addc_u32 s73, s91, 0
  v_mfma_f32_16x16x32_bf16 v[224:227], v[60:63], a[64:67], v[224:227]
  ds_read_b64_tr_b16 v[70:71], v12 offset:10240
  s_and_b32 s73, s73, 0xffff
  v_mfma_f32_16x16x32_bf16 v[224:227], v[64:67], a[80:83], v[224:227]
  ds_read_b64_tr_b16 v[72:73], v12 offset:12288
  s_mov_b32 s74, 18874368
  v_mfma_f32_16x16x32_bf16 v[228:231], v[56:59], a[52:55], v[228:231]
  ds_read_b64_tr_b16 v[74:75], v12 offset:14336
  s_mov_b32 s75, 0x20000
  v_mfma_f32_16x16x32_bf16 v[228:231], v[60:63], a[68:71], v[228:231]
  ds_read_b64_tr_b16 v[76:77], v11
  s_and_b32 s36, s94, 1
  v_mfma_f32_16x16x32_bf16 v[228:231], v[64:67], a[84:87], v[228:231]
  ds_read_b64_tr_b16 v[78:79], v11 offset:2048
  s_and_b32 s37, s92, 1
  v_mfma_f32_16x16x32_bf16 v[232:235], v[56:59], a[56:59], v[232:235]
  s_add_u32 m0, s33, 20480
  s_mul_i32 s38, s36, 10
  v_mfma_f32_16x16x32_bf16 v[232:235], v[60:63], a[72:75], v[232:235]
  s_mov_b32 s34, 3539328
  s_add_u32 s38, s38, s37
  v_mfma_f32_16x16x32_bf16 v[232:235], v[64:67], a[88:91], v[232:235]
  buffer_load_dwordx4 v19, s[4:7], s34 offen lds
  s_lshl_b32 s38, s38, 10
  v_mfma_f32_16x16x32_bf16 v[236:239], v[56:59], a[60:63], v[236:239]
  s_add_u32 m0, s33, 24576
  v_add_u32 v191, s38, v24
  v_mfma_f32_16x16x32_bf16 v[236:239], v[60:63], a[76:79], v[236:239]
  s_mov_b32 s34, 3834240
  s_lshl_b32 s36, s36, 1
  v_mfma_f32_16x16x32_bf16 v[236:239], v[64:67], a[92:95], v[236:239]
  buffer_load_dwordx4 v19, s[4:7], s34 offen lds
  s_waitcnt lgkmcnt(0)
  v_mfma_f32_16x16x32_bf16 v[240:243], v[68:71], a[48:51], v[240:243]
  ds_read_b64_tr_b16 v[56:57], v8 offset:4096
  s_add_u32 s36, s36, s37
  v_mfma_f32_16x16x32_bf16 v[240:243], v[72:75], a[64:67], v[240:243]
  ds_read_b64_tr_b16 v[58:59], v8 offset:6144
  s_add_u32 s36, s36, 16
  v_mfma_f32_16x16x32_bf16 v[240:243], v[76:79], a[80:83], v[240:243]
  ds_read_b64_tr_b16 v[60:61], v9 offset:16384
  s_lshl_b32 s36, s36, 9
  v_mfma_f32_16x16x32_bf16 v[244:247], v[68:71], a[52:55], v[244:247]
  ds_read_b64_tr_b16 v[62:63], v9 offset:18432
  v_lshrrev_b32 v4, 1, v24
  v_mfma_f32_16x16x32_bf16 v[244:247], v[72:75], a[68:71], v[244:247]
  ds_read_b64_tr_b16 v[64:65], v9 offset:20480
  v_add_u32 v3, s36, v4
  v_mfma_f32_16x16x32_bf16 v[244:247], v[76:79], a[84:87], v[244:247]
  ds_read_b64_tr_b16 v[66:67], v9 offset:22528
  s_lshl_b32 s36, s93, 4
  v_mfma_f32_16x16x32_bf16 v[248:251], v[68:71], a[56:59], v[248:251]
  s_add_u32 m0, s33, 28672
  s_add_u32 s36, s36, s94
  v_mfma_f32_16x16x32_bf16 v[248:251], v[72:75], a[72:75], v[248:251]
  s_mov_b32 s34, 4129152
  s_lshr_b32 s37, s36, 1
  v_mfma_f32_16x16x32_bf16 v[248:251], v[76:79], a[88:91], v[248:251]
  buffer_load_dwordx4 v19, s[4:7], s34 offen lds
  s_mul_i32 s37, s37, 18432
  v_mfma_f32_16x16x32_bf16 v[252:255], v[68:71], a[60:63], v[252:255]
  s_and_b32 s38, s36, 1
  v_mfma_f32_16x16x32_bf16 v[252:255], v[72:75], a[76:79], v[252:255]
  s_lshl_b32 s38, s38, 7
  v_mfma_f32_16x16x32_bf16 v[252:255], v[76:79], a[92:95], v[252:255]
  s_add_u32 s39, s37, s38
  s_waitcnt lgkmcnt(0)
  v_mfma_f32_16x16x32_bf16 v[192:195], v[56:59], a[96:99], v[192:195]
  s_waitcnt vmcnt(10)
  s_barrier
  v_mfma_f32_16x16x32_bf16 v[192:195], v[60:63], a[112:115], v[192:195]
  ds_read_b64_tr_b16 v[68:69], v11 offset:4096
  s_lshl_b32 s38, s92, 9
  v_mfma_f32_16x16x32_bf16 v[192:195], v[64:67], a[128:131], v[192:195]
  ds_read_b64_tr_b16 v[70:71], v11 offset:6144
  s_add_u32 s39, s39, s38
  v_mfma_f32_16x16x32_bf16 v[196:199], v[56:59], a[100:103], v[196:199]
  ds_read_b64_tr_b16 v[72:73], v12 offset:16384
  v_and_b32 v4, 7, v0
  v_mfma_f32_16x16x32_bf16 v[196:199], v[60:63], a[116:119], v[196:199]
  ds_read_b64_tr_b16 v[74:75], v12 offset:18432
  v_bfe_u32 v6, v0, 3, 1
  v_mfma_f32_16x16x32_bf16 v[196:199], v[64:67], a[132:135], v[196:199]
  ds_read_b64_tr_b16 v[76:77], v12 offset:20480
  v_lshlrev_b32 v4, 4, v4
  v_mfma_f32_16x16x32_bf16 v[200:203], v[56:59], a[104:107], v[200:203]
  ds_read_b64_tr_b16 v[78:79], v12 offset:22528
  v_lshl_add_u32 v4, v6, 8, v4
  v_mfma_f32_16x16x32_bf16 v[200:203], v[60:63], a[120:123], v[200:203]
  s_add_u32 m0, s33, 32768
  v_add_u32 v4, s39, v4
  v_mfma_f32_16x16x32_bf16 v[200:203], v[64:67], a[136:139], v[200:203]
  s_mov_b32 s34, 3539328
  v_subrev_u32 v189, s37, v4
  v_mfma_f32_16x16x32_bf16 v[204:207], v[56:59], a[108:111], v[204:207]
  buffer_load_dwordx4 v19, s[8:11], s34 offen lds
  v_and_b32 v189, 1023, v189
  v_mfma_f32_16x16x32_bf16 v[204:207], v[60:63], a[124:127], v[204:207]
  s_add_u32 m0, s33, 36864
  v_lshrrev_b32 v189, 1, v189
  v_mfma_f32_16x16x32_bf16 v[204:207], v[64:67], a[140:143], v[204:207]
  s_mov_b32 s34, 3834240
  buffer_load_dwordx4 v19, s[8:11], s34 offen lds
  s_waitcnt lgkmcnt(0)
  v_mfma_f32_16x16x32_bf16 v[208:211], v[68:71], a[96:99], v[208:211]
  ds_read_b64_tr_b16 v[56:57], v10 offset:20480
  s_lshr_b32 s38, s92, 1
  v_mfma_f32_16x16x32_bf16 v[208:211], v[72:75], a[112:115], v[208:211]
  ds_read_b64_tr_b16 v[58:59], v10 offset:22528
  s_lshl_b32 s38, s38, 10
  v_mfma_f32_16x16x32_bf16 v[208:211], v[76:79], a[128:131], v[208:211]
  ds_read_b64_tr_b16 v[60:61], v10 offset:24576
  s_add_u32 s38, s38, s37
  v_mfma_f32_16x16x32_bf16 v[212:215], v[68:71], a[100:103], v[212:215]
  ds_read_b64_tr_b16 v[62:63], v10 offset:26624
  v_add_u32 v189, s38, v189
  v_mfma_f32_16x16x32_bf16 v[212:215], v[72:75], a[116:119], v[212:215]
  ds_read_b64_tr_b16 v[64:65], v10 offset:28672
  v_bfe_u32 v2, v0, 4, 2
  v_mfma_f32_16x16x32_bf16 v[212:215], v[76:79], a[132:135], v[212:215]
  ds_read_b64_tr_b16 v[66:67], v10 offset:30720
  s_mov_b32 s38, 2359296
  v_mfma_f32_16x16x32_bf16 v[216:219], v[68:71], a[104:107], v[216:219]
  s_add_u32 m0, s33, 40960
  v_mul_lo_u32 v5, v2, s38
  v_mfma_f32_16x16x32_bf16 v[216:219], v[72:75], a[120:123], v[216:219]
  s_mov_b32 s34, 4129152
  v_add_u32 v188, v4, v5
  v_mfma_f32_16x16x32_bf16 v[216:219], v[76:79], a[136:139], v[216:219]
  buffer_load_dwordx4 v19, s[8:11], s34 offen lds
  v_add_u32 v189, v189, v5
  v_mfma_f32_16x16x32_bf16 v[220:223], v[68:71], a[108:111], v[220:223]
  v_and_b32 v4, 1, v0
  v_mfma_f32_16x16x32_bf16 v[220:223], v[72:75], a[124:127], v[220:223]
  v_lshlrev_b32 v4, 4, v4
  v_mfma_f32_16x16x32_bf16 v[220:223], v[76:79], a[140:143], v[220:223]
  v_mov_b32 v5, 0x3f80
  s_waitcnt lgkmcnt(0)
  v_mfma_f32_16x16x32_bf16 v[224:227], v[56:59], a[96:99], v[224:227]
  ds_read_b64_tr_b16 v[68:69], v13 offset:20480
  v_lshlrev_b32 v4, v4, v5
  v_mfma_f32_16x16x32_bf16 v[224:227], v[60:63], a[112:115], v[224:227]
  ds_read_b64_tr_b16 v[70:71], v13 offset:22528
  v_bfe_u32 v5, v0, 1, 3
  v_mfma_f32_16x16x32_bf16 v[224:227], v[64:67], a[128:131], v[224:227]
  ds_read_b64_tr_b16 v[72:73], v13 offset:24576
  v_cmp_eq_u32 vcc, 0, v5
  v_mfma_f32_16x16x32_bf16 v[228:231], v[56:59], a[100:103], v[228:231]
  ds_read_b64_tr_b16 v[74:75], v13 offset:26624
  v_cndmask_b32 v180, 0, v4, vcc
  v_mfma_f32_16x16x32_bf16 v[228:231], v[60:63], a[116:119], v[228:231]
  ds_read_b64_tr_b16 v[76:77], v13 offset:28672
  v_cmp_eq_u32 vcc, 2, v5
  v_mfma_f32_16x16x32_bf16 v[228:231], v[64:67], a[132:135], v[228:231]
  ds_read_b64_tr_b16 v[78:79], v13 offset:30720
  v_cndmask_b32 v181, 0, v4, vcc
  v_mfma_f32_16x16x32_bf16 v[232:235], v[56:59], a[104:107], v[232:235]
  s_add_u32 m0, s33, 45056
  v_cmp_eq_u32 vcc, 4, v5
  v_mfma_f32_16x16x32_bf16 v[232:235], v[60:63], a[120:123], v[232:235]
  s_mov_b32 s34, 4424064
  v_cndmask_b32 v182, 0, v4, vcc
  v_mfma_f32_16x16x32_bf16 v[232:235], v[64:67], a[136:139], v[232:235]
  buffer_load_dwordx4 v19, s[4:7], s34 offen lds
  v_cmp_eq_u32 vcc, 6, v5
  v_mfma_f32_16x16x32_bf16 v[236:239], v[56:59], a[108:111], v[236:239]
  s_add_u32 m0, s33, 49152
  v_cndmask_b32 v183, 0, v4, vcc
  v_mfma_f32_16x16x32_bf16 v[236:239], v[60:63], a[124:127], v[236:239]
  s_mov_b32 s34, 4718976
  v_cmp_eq_u32 vcc, 1, v5
  v_mfma_f32_16x16x32_bf16 v[236:239], v[64:67], a[140:143], v[236:239]
  buffer_load_dwordx4 v19, s[4:7], s34 offen lds
  s_waitcnt lgkmcnt(0)
  v_mfma_f32_16x16x32_bf16 v[240:243], v[68:71], a[96:99], v[240:243]
  ds_read_b64_tr_b16 v[56:57], v8 offset:8192
  v_cndmask_b32 v184, 0, v4, vcc
  v_mfma_f32_16x16x32_bf16 v[240:243], v[72:75], a[112:115], v[240:243]
  ds_read_b64_tr_b16 v[58:59], v8 offset:10240
  v_cmp_eq_u32 vcc, 3, v5
  v_mfma_f32_16x16x32_bf16 v[240:243], v[76:79], a[128:131], v[240:243]
  ds_read_b64_tr_b16 v[60:61], v8 offset:12288
  v_cndmask_b32 v185, 0, v4, vcc
  v_mfma_f32_16x16x32_bf16 v[244:247], v[68:71], a[100:103], v[244:247]
  ds_read_b64_tr_b16 v[62:63], v8 offset:14336
  v_cmp_eq_u32 vcc, 5, v5
  v_mfma_f32_16x16x32_bf16 v[244:247], v[72:75], a[116:119], v[244:247]
  ds_read_b64_tr_b16 v[64:65], v9 offset:49152
  v_cndmask_b32 v186, 0, v4, vcc
  v_mfma_f32_16x16x32_bf16 v[244:247], v[76:79], a[132:135], v[244:247]
  ds_read_b64_tr_b16 v[66:67], v9 offset:51200
  v_cmp_eq_u32 vcc, 7, v5
  v_mfma_f32_16x16x32_bf16 v[248:251], v[68:71], a[104:107], v[248:251]
  s_add_u32 m0, s33, 53248
  v_cndmask_b32 v187, 0, v4, vcc
  v_mfma_f32_16x16x32_bf16 v[248:251], v[72:75], a[120:123], v[248:251]
  s_mov_b32 s34, 5013888
  s_add_u32 s44, s86, 0
  s_addc_u32 s45, s87, 0
  v_mfma_f32_16x16x32_bf16 v[248:251], v[76:79], a[136:139], v[248:251]
  buffer_load_dwordx4 v19, s[4:7], s34 offen lds
  s_and_b32 s45, s45, 0xffff
  v_mfma_f32_16x16x32_bf16 v[252:255], v[68:71], a[108:111], v[252:255]
  s_mov_b32 s46, 2064384
  v_mfma_f32_16x16x32_bf16 v[252:255], v[72:75], a[124:127], v[252:255]
  s_mov_b32 s47, 0x20000
  v_mfma_f32_16x16x32_bf16 v[252:255], v[76:79], a[140:143], v[252:255]
  s_cmp_eq_u32 s95, 0
  s_cselect_b32 s46, s46, 0
  s_waitcnt lgkmcnt(0)
  v_mfma_f32_16x16x32_bf16 v[192:195], v[56:59], a[144:147], v[192:195]
  s_waitcnt vmcnt(6)
  s_barrier
  v_mfma_f32_16x16x32_bf16 v[192:195], v[60:63], a[160:163], v[192:195]
  ds_read_b64_tr_b16 v[68:69], v11 offset:8192
  s_mul_i32 s36, s94, 129024
  v_mfma_f32_16x16x32_bf16 v[192:195], v[64:67], a[176:179], v[192:195]
  ds_read_b64_tr_b16 v[70:71], v11 offset:10240
  s_lshl_b32 s66, s92, 12
  v_mfma_f32_16x16x32_bf16 v[196:199], v[56:59], a[148:151], v[196:199]
  ds_read_b64_tr_b16 v[72:73], v11 offset:12288
  s_add_u32 s36, s36, s66
  v_mfma_f32_16x16x32_bf16 v[196:199], v[60:63], a[164:167], v[196:199]
  ds_read_b64_tr_b16 v[74:75], v11 offset:14336
  v_and_b32 v7, 63, v0
  v_mfma_f32_16x16x32_bf16 v[196:199], v[64:67], a[180:183], v[196:199]
  ds_read_b64_tr_b16 v[76:77], v12 offset:49152
  v_lshlrev_b32 v7, 4, v7
  v_mfma_f32_16x16x32_bf16 v[200:203], v[56:59], a[152:155], v[200:203]
  ds_read_b64_tr_b16 v[78:79], v12 offset:51200
  v_add_u32 v7, s36, v7
  v_mfma_f32_16x16x32_bf16 v[200:203], v[60:63], a[168:171], v[200:203]
  s_add_u32 m0, s33, 57344
  v_mfma_f32_16x16x32_bf16 v[200:203], v[64:67], a[184:187], v[200:203]
  s_mov_b32 s34, 4424064
  v_mfma_f32_16x16x32_bf16 v[204:207], v[56:59], a[156:159], v[204:207]
  buffer_load_dwordx4 v19, s[8:11], s34 offen lds
  v_mfma_f32_16x16x32_bf16 v[204:207], v[60:63], a[172:175], v[204:207]
  s_add_u32 m0, s33, 61440
  v_mfma_f32_16x16x32_bf16 v[204:207], v[64:67], a[188:191], v[204:207]
  s_mov_b32 s34, 4718976
  buffer_load_dwordx4 v19, s[8:11], s34 offen lds
  s_waitcnt lgkmcnt(0)
  v_mfma_f32_16x16x32_bf16 v[208:211], v[68:71], a[144:147], v[208:211]
  ds_read_b64_tr_b16 v[56:57], v9 offset:53248
  v_mfma_f32_16x16x32_bf16 v[208:211], v[72:75], a[160:163], v[208:211]
  ds_read_b64_tr_b16 v[58:59], v9 offset:55296
  v_mfma_f32_16x16x32_bf16 v[208:211], v[76:79], a[176:179], v[208:211]
  ds_read_b64_tr_b16 v[60:61], v9 offset:57344
  v_mfma_f32_16x16x32_bf16 v[212:215], v[68:71], a[148:151], v[212:215]
  ds_read_b64_tr_b16 v[62:63], v9 offset:59392
  v_mfma_f32_16x16x32_bf16 v[212:215], v[72:75], a[164:167], v[212:215]
  ds_read_b64_tr_b16 v[64:65], v8 offset:16384
  v_mfma_f32_16x16x32_bf16 v[212:215], v[76:79], a[180:183], v[212:215]
  ds_read_b64_tr_b16 v[66:67], v8 offset:18432
  v_mfma_f32_16x16x32_bf16 v[216:219], v[68:71], a[152:155], v[216:219]
  s_add_u32 m0, s33, 65536
  v_mfma_f32_16x16x32_bf16 v[216:219], v[72:75], a[168:171], v[216:219]
  s_mov_b32 s34, 5013888
  v_mfma_f32_16x16x32_bf16 v[216:219], v[76:79], a[184:187], v[216:219]
  buffer_load_dwordx4 v19, s[8:11], s34 offen lds
  v_mfma_f32_16x16x32_bf16 v[220:223], v[68:71], a[156:159], v[220:223]
  v_mfma_f32_16x16x32_bf16 v[220:223], v[72:75], a[172:175], v[220:223]
  v_mfma_f32_16x16x32_bf16 v[220:223], v[76:79], a[188:191], v[220:223]
  s_waitcnt lgkmcnt(0)
  v_mfma_f32_16x16x32_bf16 v[224:227], v[56:59], a[144:147], v[224:227]
  ds_read_b64_tr_b16 v[68:69], v12 offset:53248
  v_mfma_f32_16x16x32_bf16 v[224:227], v[60:63], a[160:163], v[224:227]
  ds_read_b64_tr_b16 v[70:71], v12 offset:55296
  v_mfma_f32_16x16x32_bf16 v[224:227], v[64:67], a[176:179], v[224:227]
  ds_read_b64_tr_b16 v[72:73], v12 offset:57344
  v_mfma_f32_16x16x32_bf16 v[228:231], v[56:59], a[148:151], v[228:231]
  ds_read_b64_tr_b16 v[74:75], v12 offset:59392
  v_mfma_f32_16x16x32_bf16 v[228:231], v[60:63], a[164:167], v[228:231]
  ds_read_b64_tr_b16 v[76:77], v11 offset:16384
  v_mfma_f32_16x16x32_bf16 v[228:231], v[64:67], a[180:183], v[228:231]
  ds_read_b64_tr_b16 v[78:79], v11 offset:18432
  v_mfma_f32_16x16x32_bf16 v[232:235], v[56:59], a[152:155], v[232:235]
  s_add_u32 m0, s33, 69632
  v_mfma_f32_16x16x32_bf16 v[232:235], v[60:63], a[168:171], v[232:235]
  s_mov_b32 s34, 0
  v_mfma_f32_16x16x32_bf16 v[232:235], v[64:67], a[184:187], v[232:235]
  buffer_load_dwordx4 v20, s[24:27], s34 offen lds
  v_mfma_f32_16x16x32_bf16 v[236:239], v[56:59], a[156:159], v[236:239]
  s_add_u32 m0, s33, 73728
  v_mfma_f32_16x16x32_bf16 v[236:239], v[60:63], a[172:175], v[236:239]
  s_mov_b32 s34, 294912
  v_mfma_f32_16x16x32_bf16 v[236:239], v[64:67], a[188:191], v[236:239]
  buffer_load_dwordx4 v20, s[24:27], s34 offen lds
  s_waitcnt lgkmcnt(0)
  v_mfma_f32_16x16x32_bf16 v[240:243], v[68:71], a[144:147], v[240:243]
  ds_read_b64_tr_b16 v[56:57], v8 offset:20480
  v_mfma_f32_16x16x32_bf16 v[240:243], v[72:75], a[160:163], v[240:243]
  ds_read_b64_tr_b16 v[58:59], v8 offset:22528
  v_mfma_f32_16x16x32_bf16 v[240:243], v[76:79], a[176:179], v[240:243]
  ds_read_b64_tr_b16 v[60:61], v8 offset:24576
  v_mfma_f32_16x16x32_bf16 v[244:247], v[68:71], a[148:151], v[244:247]
  ds_read_b64_tr_b16 v[62:63], v8 offset:26624
  v_mfma_f32_16x16x32_bf16 v[244:247], v[72:75], a[164:167], v[244:247]
  ds_read_b64_tr_b16 v[64:65], v8 offset:28672
  v_mfma_f32_16x16x32_bf16 v[244:247], v[76:79], a[180:183], v[244:247]
  ds_read_b64_tr_b16 v[66:67], v8 offset:30720
  v_mfma_f32_16x16x32_bf16 v[248:251], v[68:71], a[152:155], v[248:251]
  s_add_u32 m0, s33, 77824
  v_mfma_f32_16x16x32_bf16 v[248:251], v[72:75], a[168:171], v[248:251]
  s_mov_b32 s34, 589824
  v_mfma_f32_16x16x32_bf16 v[248:251], v[76:79], a[184:187], v[248:251]
  buffer_load_dwordx4 v20, s[24:27], s34 offen lds
  v_mfma_f32_16x16x32_bf16 v[252:255], v[68:71], a[156:159], v[252:255]
  v_mfma_f32_16x16x32_bf16 v[252:255], v[72:75], a[172:175], v[252:255]
  v_mfma_f32_16x16x32_bf16 v[252:255], v[76:79], a[188:191], v[252:255]
  s_waitcnt lgkmcnt(0)
  v_mfma_f32_16x16x32_bf16 v[192:195], v[56:59], a[192:195], v[192:195]
  s_waitcnt vmcnt(6)
  s_barrier
  s_mov_b32 s63, 131072
  v_mov_b32 v190, 1
  buffer_store_dword v190, v29, s[96:99], s63 offen sc1
  v_mfma_f32_16x16x32_bf16 v[192:195], v[60:63], a[208:211], v[192:195]
  ds_read_b64_tr_b16 v[68:69], v11 offset:20480
  v_mfma_f32_16x16x32_bf16 v[192:195], v[64:67], a[224:227], v[192:195]
  ds_read_b64_tr_b16 v[70:71], v11 offset:22528
  v_mfma_f32_16x16x32_bf16 v[196:199], v[56:59], a[196:199], v[196:199]
  ds_read_b64_tr_b16 v[72:73], v11 offset:24576
  v_mfma_f32_16x16x32_bf16 v[196:199], v[60:63], a[212:215], v[196:199]
  ds_read_b64_tr_b16 v[74:75], v11 offset:26624
  v_mfma_f32_16x16x32_bf16 v[196:199], v[64:67], a[228:231], v[196:199]
  ds_read_b64_tr_b16 v[76:77], v11 offset:28672
  v_mfma_f32_16x16x32_bf16 v[200:203], v[56:59], a[200:203], v[200:203]
  ds_read_b64_tr_b16 v[78:79], v11 offset:30720
  v_mfma_f32_16x16x32_bf16 v[200:203], v[60:63], a[216:219], v[200:203]
  s_add_u32 m0, s33, 0
  v_mfma_f32_16x16x32_bf16 v[200:203], v[64:67], a[232:235], v[200:203]
  s_mov_b32 s34, 884736
  v_mfma_f32_16x16x32_bf16 v[204:207], v[56:59], a[204:207], v[204:207]
  buffer_load_dwordx4 v20, s[24:27], s34 offen lds
  v_mfma_f32_16x16x32_bf16 v[204:207], v[60:63], a[220:223], v[204:207]
  s_add_u32 m0, s33, 4096
  v_mfma_f32_16x16x32_bf16 v[204:207], v[64:67], a[236:239], v[204:207]
  s_mov_b32 s34, 1179648
  buffer_load_dwordx4 v20, s[24:27], s34 offen lds
  s_waitcnt lgkmcnt(0)
  v_mfma_f32_16x16x32_bf16 v[208:211], v[68:71], a[192:195], v[208:211]
  ds_read_b64_tr_b16 v[56:57], v8 offset:32768
  v_mfma_f32_16x16x32_bf16 v[208:211], v[72:75], a[208:211], v[208:211]
  ds_read_b64_tr_b16 v[58:59], v8 offset:34816
  v_mfma_f32_16x16x32_bf16 v[208:211], v[76:79], a[224:227], v[208:211]
  ds_read_b64_tr_b16 v[60:61], v8 offset:36864
  v_mfma_f32_16x16x32_bf16 v[212:215], v[68:71], a[196:199], v[212:215]
  ds_read_b64_tr_b16 v[62:63], v8 offset:38912
  v_mfma_f32_16x16x32_bf16 v[212:215], v[72:75], a[212:215], v[212:215]
  ds_read_b64_tr_b16 v[64:65], v8 offset:40960
  v_mfma_f32_16x16x32_bf16 v[212:215], v[76:79], a[228:231], v[212:215]
  ds_read_b64_tr_b16 v[66:67], v8 offset:43008
  v_mfma_f32_16x16x32_bf16 v[216:219], v[68:71], a[200:203], v[216:219]
  s_add_u32 m0, s33, 81920
  v_mfma_f32_16x16x32_bf16 v[216:219], v[72:75], a[216:219], v[216:219]
  s_mov_b32 s34, 1474560
  v_mfma_f32_16x16x32_bf16 v[216:219], v[76:79], a[232:235], v[216:219]
  buffer_load_dwordx4 v20, s[24:27], s34 offen lds
  v_mfma_f32_16x16x32_bf16 v[220:223], v[68:71], a[204:207], v[220:223]
  v_mfma_f32_16x16x32_bf16 v[220:223], v[72:75], a[220:223], v[220:223]
  v_mfma_f32_16x16x32_bf16 v[220:223], v[76:79], a[236:239], v[220:223]
  s_waitcnt lgkmcnt(0)
  v_mfma_f32_16x16x32_bf16 v[224:227], v[56:59], a[192:195], v[224:227]
  ds_read_b64_tr_b16 v[68:69], v11 offset:32768
  v_mfma_f32_16x16x32_bf16 v[224:227], v[60:63], a[208:211], v[224:227]
  ds_read_b64_tr_b16 v[70:71], v11 offset:34816
  s_mov_b32 s63, 131072
  buffer_load_dword v31, v91, s[96:99], s63 offen sc1
  v_mfma_f32_16x16x32_bf16 v[224:227], v[64:67], a[224:227], v[224:227]
  ds_read_b64_tr_b16 v[72:73], v11 offset:36864
  v_mfma_f32_16x16x32_bf16 v[228:231], v[56:59], a[196:199], v[228:231]
  ds_read_b64_tr_b16 v[74:75], v11 offset:38912
  v_mfma_f32_16x16x32_bf16 v[228:231], v[60:63], a[212:215], v[228:231]
  ds_read_b64_tr_b16 v[76:77], v11 offset:40960
  v_mfma_f32_16x16x32_bf16 v[228:231], v[64:67], a[228:231], v[228:231]
  ds_read_b64_tr_b16 v[78:79], v11 offset:43008
  v_mfma_f32_16x16x32_bf16 v[232:235], v[56:59], a[200:203], v[232:235]
  s_add_u32 m0, s33, 86016
  v_mfma_f32_16x16x32_bf16 v[232:235], v[60:63], a[216:219], v[232:235]
  s_mov_b32 s34, 1769472
  v_mfma_f32_16x16x32_bf16 v[232:235], v[64:67], a[232:235], v[232:235]
  buffer_load_dwordx4 v20, s[24:27], s34 offen lds
  v_mfma_f32_16x16x32_bf16 v[236:239], v[56:59], a[204:207], v[236:239]
  s_add_u32 m0, s33, 159744
  v_mfma_f32_16x16x32_bf16 v[236:239], v[60:63], a[220:223], v[236:239]
  s_mov_b32 s34, 2064384
  v_mfma_f32_16x16x32_bf16 v[236:239], v[64:67], a[236:239], v[236:239]
  buffer_load_dwordx4 v20, s[24:27], s34 offen lds
  s_waitcnt lgkmcnt(0)
  v_mfma_f32_16x16x32_bf16 v[240:243], v[68:71], a[192:195], v[240:243]
  ds_read_b64_tr_b16 v[56:57], v8 offset:45056
  v_mfma_f32_16x16x32_bf16 v[240:243], v[72:75], a[208:211], v[240:243]
  ds_read_b64_tr_b16 v[58:59], v8 offset:47104
  v_mfma_f32_16x16x32_bf16 v[240:243], v[76:79], a[224:227], v[240:243]
  ds_read_b64_tr_b16 v[60:61], v8 offset:49152
  v_mfma_f32_16x16x32_bf16 v[244:247], v[68:71], a[196:199], v[244:247]
  ds_read_b64_tr_b16 v[62:63], v8 offset:51200
  v_mfma_f32_16x16x32_bf16 v[244:247], v[72:75], a[212:215], v[244:247]
  ds_read_b64_tr_b16 v[64:65], v8 offset:53248
  v_mfma_f32_16x16x32_bf16 v[244:247], v[76:79], a[228:231], v[244:247]
  ds_read_b64_tr_b16 v[66:67], v8 offset:55296
  v_mfma_f32_16x16x32_bf16 v[248:251], v[68:71], a[200:203], v[248:251]
  s_add_u32 m0, s33, 8192
  v_mfma_f32_16x16x32_bf16 v[248:251], v[72:75], a[216:219], v[248:251]
  s_mov_b32 s34, 2359296
  v_mfma_f32_16x16x32_bf16 v[248:251], v[76:79], a[232:235], v[248:251]
  buffer_load_dwordx4 v20, s[24:27], s34 offen lds
  v_mfma_f32_16x16x32_bf16 v[252:255], v[68:71], a[204:207], v[252:255]
  v_mfma_f32_16x16x32_bf16 v[252:255], v[72:75], a[220:223], v[252:255]
  v_mfma_f32_16x16x32_bf16 v[252:255], v[76:79], a[236:239], v[252:255]
  s_waitcnt lgkmcnt(0)
  v_mfma_f32_16x16x32_bf16 v[192:195], v[56:59], a[240:243], v[192:195]
  s_waitcnt vmcnt(8)
  s_barrier
  v_mfma_f32_16x16x32_bf16 v[192:195], v[60:63], v[96:99], v[192:195]
  ds_read_b64_tr_b16 v[68:69], v11 offset:45056
  s_add_u32 m0, s33, 12288
  v_mfma_f32_16x16x32_bf16 v[192:195], v[64:67], v[112:115], v[192:195]
  ds_read_b64_tr_b16 v[70:71], v11 offset:47104
  s_mov_b32 s34, 2654208
  v_mfma_f32_16x16x32_bf16 v[196:199], v[56:59], a[244:247], v[196:199]
  ds_read_b64_tr_b16 v[72:73], v11 offset:49152
  buffer_load_dwordx4 v20, s[24:27], s34 offen lds
  v_mfma_f32_16x16x32_bf16 v[196:199], v[60:63], v[100:103], v[196:199]
  ds_read_b64_tr_b16 v[74:75], v11 offset:51200
  s_add_u32 m0, s33, 122880
  v_mfma_f32_16x16x32_bf16 v[196:199], v[64:67], v[116:119], v[196:199]
  ds_read_b64_tr_b16 v[76:77], v11 offset:53248
  s_mov_b32 s34, 2949120
  v_mfma_f32_16x16x32_bf16 v[200:203], v[56:59], a[248:251], v[200:203]
  ds_read_b64_tr_b16 v[78:79], v11 offset:55296
  buffer_load_dwordx4 v20, s[24:27], s34 offen lds
  v_mfma_f32_16x16x32_bf16 v[200:203], v[60:63], v[104:107], v[200:203]
  s_add_u32 m0, s33, 16384
  v_mfma_f32_16x16x32_bf16 v[200:203], v[64:67], v[120:123], v[200:203]
  s_mov_b32 s34, 3244032
  v_mfma_f32_16x16x32_bf16 v[204:207], v[56:59], a[252:255], v[204:207]
  buffer_load_dwordx4 v20, s[24:27], s34 offen lds
  v_mfma_f32_16x16x32_bf16 v[204:207], v[60:63], v[108:111], v[204:207]
  v_mfma_f32_16x16x32_bf16 v[204:207], v[64:67], v[124:127], v[204:207]
  s_waitcnt lgkmcnt(0)
  v_mfma_f32_16x16x32_bf16 v[208:211], v[68:71], a[240:243], v[208:211]
  ds_read_b64_tr_b16 v[56:57], v8 offset:57344
  v_mfma_f32_16x16x32_bf16 v[208:211], v[72:75], v[96:99], v[208:211]
  ds_read_b64_tr_b16 v[58:59], v8 offset:59392
  s_waitcnt vmcnt(6)
  v_cmp_eq_u32 vcc, 0, v31
  s_cbranch_vccnz L_sp_11
L_bk_12:
  v_mfma_f32_16x16x32_bf16 v[208:211], v[76:79], v[112:115], v[208:211]
  ds_read_b64_tr_b16 v[60:61], v8 offset:61440
  v_mfma_f32_16x16x32_bf16 v[212:215], v[68:71], a[244:247], v[212:215]
  ds_read_b64_tr_b16 v[62:63], v8 offset:63488
  v_mfma_f32_16x16x32_bf16 v[212:215], v[72:75], v[100:103], v[212:215]
  ds_read_b64_tr_b16 v[64:65], v9
  v_mfma_f32_16x16x32_bf16 v[212:215], v[76:79], v[116:119], v[212:215]
  ds_read_b64_tr_b16 v[66:67], v9 offset:2048
  v_mfma_f32_16x16x32_bf16 v[216:219], v[68:71], a[248:251], v[216:219]
  v_mfma_f32_16x16x32_bf16 v[216:219], v[72:75], v[104:107], v[216:219]
  v_mfma_f32_16x16x32_bf16 v[216:219], v[76:79], v[120:123], v[216:219]
  v_mfma_f32_16x16x32_bf16 v[220:223], v[68:71], a[252:255], v[220:223]
  v_mfma_f32_16x16x32_bf16 v[220:223], v[72:75], v[108:111], v[220:223]
  v_mfma_f32_16x16x32_bf16 v[220:223], v[76:79], v[124:127], v[220:223]
  s_waitcnt lgkmcnt(0)
  v_mfma_f32_16x16x32_bf16 v[224:227], v[56:59], a[240:243], v[224:227]
  ds_read_b64_tr_b16 v[68:69], v11 offset:57344
  v_mfma_f32_16x16x32_bf16 v[224:227], v[60:63], v[96:99], v[224:227]
  ds_read_b64_tr_b16 v[70:71], v11 offset:59392
  v_mfma_f32_16x16x32_bf16 v[224:227], v[64:67], v[112:115], v[224:227]
  ds_read_b64_tr_b16 v[72:73], v11 offset:61440
  v_mfma_f32_16x16x32_bf16 v[228:231], v[56:59], a[244:247], v[228:231]
  ds_read_b64_tr_b16 v[74:75], v11 offset:63488
  v_mfma_f32_16x16x32_bf16 v[228:231], v[60:63], v[100:103], v[228:231]
  ds_read_b64_tr_b16 v[76:77], v12
  v_mfma_f32_16x16x32_bf16 v[228:231], v[64:67], v[116:119], v[228:231]
  ds_read_b64_tr_b16 v[78:79], v12 offset:2048
  v_mfma_f32_16x16x32_bf16 v[232:235], v[56:59], a[248:251], v[232:235]
  v_mfma_f32_16x16x32_bf16 v[232:235], v[60:63], v[104:107], v[232:235]
  v_mfma_f32_16x16x32_bf16 v[232:235], v[64:67], v[120:123], v[232:235]
  v_mfma_f32_16x16x32_bf16 v[236:239], v[56:59], a[252:255], v[236:239]
  v_mfma_f32_16x16x32_bf16 v[236:239], v[60:63], v[108:111], v[236:239]
  v_mfma_f32_16x16x32_bf16 v[236:239], v[64:67], v[124:127], v[236:239]
  s_waitcnt lgkmcnt(0)
  v_mfma_f32_16x16x32_bf16 v[240:243], v[68:71], a[240:243], v[240:243]
  ds_read_b64_tr_b16 v[56:57], v15 offset:4096
  v_mfma_f32_16x16x32_bf16 v[240:243], v[72:75], v[96:99], v[240:243]
  ds_read_b64_tr_b16 v[58:59], v15 offset:5120
  v_mfma_f32_16x16x32_bf16 v[240:243], v[76:79], v[112:115], v[240:243]
  ds_read_b64_tr_b16 v[60:61], v15 offset:8192
  v_mfma_f32_16x16x32_bf16 v[244:247], v[68:71], a[244:247], v[244:247]
  ds_read_b64_tr_b16 v[62:63], v15 offset:9216
  v_mfma_f32_16x16x32_bf16 v[244:247], v[72:75], v[100:103], v[244:247]
  ds_read_b64_tr_b16 v[64:65], v15 offset:12288
  v_mfma_f32_16x16x32_bf16 v[244:247], v[76:79], v[116:119], v[244:247]
  ds_read_b64_tr_b16 v[66:67], v15 offset:13312
  v_mfma_f32_16x16x32_bf16 v[248:251], v[68:71], a[248:251], v[248:251]
  s_add_u32 m0, s33, 20480
  v_mfma_f32_16x16x32_bf16 v[248:251], v[72:75], v[104:107], v[248:251]
  s_mov_b32 s34, 0
  v_mfma_f32_16x16x32_bf16 v[248:251], v[76:79], v[120:123], v[248:251]
  buffer_load_dwordx4 v88, s[68:71], s34 offen sc1 lds
  v_mfma_f32_16x16x32_bf16 v[252:255], v[68:71], a[252:255], v[252:255]
  s_add_u32 m0, s33, 24576
  v_mfma_f32_16x16x32_bf16 v[252:255], v[72:75], v[108:111], v[252:255]
  s_mov_b32 s34, 2048
  v_mfma_f32_16x16x32_bf16 v[252:255], v[76:79], v[124:127], v[252:255]
  buffer_load_dwordx4 v88, s[68:71], s34 offen sc1 lds
  s_waitcnt lgkmcnt(0)
  v_mfma_f32_16x16x32_bf16 v[128:131], v[56:59], a[0:3], 0
  s_barrier
  v_mfma_f32_16x16x32_bf16 v[128:131], v[60:63], a[16:19], v[128:131]
  ds_read_b64_tr_b16 v[68:69], v15 offset:6144
  v_mul_f32 v192, v192, v224
  v_mul_f32 v193, v193, v225
  v_mfma_f32_16x16x32_bf16 v[128:131], v[64:67], a[32:35], v[128:131]
  ds_read_b64_tr_b16 v[70:71], v15 offset:7168
  v_mul_f32 v194, v194, v226
  v_mul_f32 v195, v195, v227
  v_mfma_f32_16x16x32_bf16 v[132:135], v[56:59], a[4:7], 0
  ds_read_b64_tr_b16 v[72:73], v15 offset:10240
  v_cvt_pk_bf16_f32 v32, v192, v193
  v_cvt_pk_bf16_f32 v33, v194, v195
  v_mfma_f32_16x16x32_bf16 v[132:135], v[60:63], a[20:23], v[132:135]
  ds_read_b64_tr_b16 v[74:75], v15 offset:11264
  v_mul_f32 v208, v208, v240
  v_mul_f32 v209, v209, v241
  v_mfma_f32_16x16x32_bf16 v[132:135], v[64:67], a[36:39], v[132:135]
  ds_read_b64_tr_b16 v[76:77], v15 offset:14336
  v_mul_f32 v210, v210, v242
  v_mul_f32 v211, v211, v243
  v_mfma_f32_16x16x32_bf16 v[136:139], v[56:59], a[8:11], 0
  ds_read_b64_tr_b16 v[78:79], v15 offset:15360
  v_cvt_pk_bf16_f32 v34, v208, v209
  v_cvt_pk_bf16_f32 v35, v210, v211
  v_mfma_f32_16x16x32_bf16 v[136:139], v[60:63], a[24:27], v[136:139]
  s_add_u32 m0, s33, 28672
  ds_write_b128 v17, v[32:35] offset:24576
  s_mov_b32 s61, 24576
  v_mfma_f32_16x16x32_bf16 v[136:139], v[64:67], a[40:43], v[136:139]
  s_mov_b32 s34, 4096
  buffer_store_dwordx4 v[32:35], v80, s[28:31], s61 offen sc1
  v_mul_f32 v196, v196, v228
  v_mfma_f32_16x16x32_bf16 v[140:143], v[56:59], a[12:15], 0
  buffer_load_dwordx4 v88, s[68:71], s34 offen sc1 lds
  v_mul_f32 v197, v197, v229
  v_mul_f32 v198, v198, v230
  v_mfma_f32_16x16x32_bf16 v[140:143], v[60:63], a[28:31], v[140:143]
  s_add_u32 m0, s33, 32768
  v_mul_f32 v199, v199, v231
  v_cvt_pk_bf16_f32 v36, v196, v197
  v_mfma_f32_16x16x32_bf16 v[140:143], v[64:67], a[44:47], v[140:143]
  s_mov_b32 s34, 6144
  buffer_load_dwordx4 v88, s[68:71], s34 offen sc1 lds
  s_waitcnt lgkmcnt(1)
  v_mfma_f32_16x16x32_bf16 v[144:147], v[68:71], a[0:3], 0
  ds_read_b64_tr_b16 v[56:57], v14
  s_add_u32 m0, s33, 36864
  v_cvt_pk_bf16_f32 v37, v198, v199
  v_mfma_f32_16x16x32_bf16 v[144:147], v[72:75], a[16:19], v[144:147]
  ds_read_b64_tr_b16 v[58:59], v14 offset:1024
  s_mov_b32 s34, 8192
  v_mul_f32 v212, v212, v244
  v_mfma_f32_16x16x32_bf16 v[144:147], v[76:79], a[32:35], v[144:147]
  ds_read_b64_tr_b16 v[60:61], v14 offset:4096
  buffer_load_dwordx4 v88, s[68:71], s34 offen sc1 lds
  v_mul_f32 v213, v213, v245
  v_mfma_f32_16x16x32_bf16 v[148:151], v[68:71], a[4:7], 0
  ds_read_b64_tr_b16 v[62:63], v14 offset:5120
  s_add_u32 m0, s33, 40960
  v_mul_f32 v214, v214, v246
  v_mfma_f32_16x16x32_bf16 v[148:151], v[72:75], a[20:23], v[148:151]
  ds_read_b64_tr_b16 v[64:65], v15 offset:16384
  s_mov_b32 s34, 10240
  v_mul_f32 v215, v215, v247
  v_mfma_f32_16x16x32_bf16 v[148:151], v[76:79], a[36:39], v[148:151]
  ds_read_b64_tr_b16 v[66:67], v15 offset:17408
  buffer_load_dwordx4 v88, s[68:71], s34 offen sc1 lds
  v_cvt_pk_bf16_f32 v38, v212, v213
  v_mfma_f32_16x16x32_bf16 v[152:155], v[68:71], a[8:11], 0
  s_add_u32 m0, s33, 45056
  v_cvt_pk_bf16_f32 v39, v214, v215
  ds_write_b128 v17, v[36:39] offset:25600
  v_mfma_f32_16x16x32_bf16 v[152:155], v[72:75], a[24:27], v[152:155]
  s_mov_b32 s34, 3538944
  s_mov_b32 s61, 25600
  buffer_store_dwordx4 v[36:39], v80, s[28:31], s61 offen sc1
  v_mfma_f32_16x16x32_bf16 v[152:155], v[76:79], a[40:43], v[152:155]
  buffer_load_dwordx4 v20, s[24:27], s34 offen lds
  v_mul_f32 v200, v200, v232
  v_mul_f32 v201, v201, v233
  v_mfma_f32_16x16x32_bf16 v[156:159], v[68:71], a[12:15], 0
  v_mul_f32 v202, v202, v234
  v_mul_f32 v203, v203, v235
  v_mfma_f32_16x16x32_bf16 v[156:159], v[72:75], a[28:31], v[156:159]
  v_cvt_pk_bf16_f32 v32, v200, v201
  v_cvt_pk_bf16_f32 v33, v202, v203
  v_mfma_f32_16x16x32_bf16 v[156:159], v[76:79], a[44:47], v[156:159]
  v_mul_f32 v216, v216, v248
  v_mul_f32 v217, v217, v249
  s_waitcnt lgkmcnt(1)
  v_mfma_f32_16x16x32_bf16 v[128:131], v[56:59], a[48:51], v[128:131]
  ds_read_b64_tr_b16 v[68:69], v14 offset:2048
  s_add_u32 m0, s33, 49152
  v_mul_f32 v218, v218, v250
  v_mfma_f32_16x16x32_bf16 v[128:131], v[60:63], a[64:67], v[128:131]
  ds_read_b64_tr_b16 v[70:71], v14 offset:3072
  s_mov_b32 s34, 3833856
  v_mul_f32 v219, v219, v251
  v_mfma_f32_16x16x32_bf16 v[128:131], v[64:67], a[80:83], v[128:131]
  ds_read_b64_tr_b16 v[72:73], v14 offset:6144
  buffer_load_dwordx4 v20, s[24:27], s34 offen lds
  v_cvt_pk_bf16_f32 v34, v216, v217
  v_mfma_f32_16x16x32_bf16 v[132:135], v[56:59], a[52:55], v[132:135]
  ds_read_b64_tr_b16 v[74:75], v14 offset:7168
  s_add_u32 m0, s33, 53248
  v_cvt_pk_bf16_f32 v35, v218, v219
  v_mfma_f32_16x16x32_bf16 v[132:135], v[60:63], a[68:71], v[132:135]
  ds_read_b64_tr_b16 v[76:77], v15 offset:18432
  s_mov_b32 s34, 4128768
  ds_write_b128 v17, v[32:35] offset:26624
  v_mfma_f32_16x16x32_bf16 v[132:135], v[64:67], a[84:87], v[132:135]
  ds_read_b64_tr_b16 v[78:79], v15 offset:19456
  buffer_load_dwordx4 v20, s[24:27], s34 offen lds
  s_mov_b32 s61, 26624
  v_mfma_f32_16x16x32_bf16 v[136:139], v[56:59], a[56:59], v[136:139]
  ds_read_b128 a[0:3], v16
  s_add_u32 m0, s33, 57344
  buffer_store_dwordx4 v[32:35], v80, s[28:31], s61 offen sc1
  v_mfma_f32_16x16x32_bf16 v[136:139], v[60:63], a[72:75], v[136:139]
  ds_read_b128 a[4:7], v16 offset:1024
  s_mov_b32 s34, 12288
  v_mul_f32 v204, v204, v236
  v_mfma_f32_16x16x32_bf16 v[136:139], v[64:67], a[88:91], v[136:139]
  ds_read_b128 a[8:11], v16 offset:2048
  buffer_load_dwordx4 v88, s[68:71], s34 offen sc1 lds
  v_mul_f32 v205, v205, v237
  v_mfma_f32_16x16x32_bf16 v[140:143], v[56:59], a[60:63], v[140:143]
  ds_read_b128 a[12:15], v16 offset:3072
  v_mul_f32 v206, v206, v238
  v_mul_f32 v207, v207, v239
  v_mfma_f32_16x16x32_bf16 v[140:143], v[60:63], a[76:79], v[140:143]
  v_cvt_pk_bf16_f32 v36, v204, v205
  v_cvt_pk_bf16_f32 v37, v206, v207
  v_mfma_f32_16x16x32_bf16 v[140:143], v[64:67], a[92:95], v[140:143]
  v_mul_f32 v220, v220, v252
  v_mul_f32 v221, v221, v253
  s_waitcnt lgkmcnt(4)
  v_mfma_f32_16x16x32_bf16 v[144:147], v[68:71], a[48:51], v[144:147]
  s_waitcnt vmcnt(13)
  s_barrier
  v_mul_f32 v222, v222, v254
  v_mfma_f32_16x16x32_bf16 v[144:147], v[72:75], a[64:67], v[144:147]
  ds_read_b64_tr_b16 v[56:57], v15 offset:20480
  s_add_u32 m0, s33, 61440
  v_mul_f32 v223, v223, v255
  v_mfma_f32_16x16x32_bf16 v[144:147], v[76:79], a[80:83], v[144:147]
  ds_read_b64_tr_b16 v[58:59], v15 offset:21504
  s_mov_b32 s34, 14336
  v_cvt_pk_bf16_f32 v38, v220, v221
  v_mfma_f32_16x16x32_bf16 v[148:151], v[68:71], a[52:55], v[148:151]
  ds_read_b64_tr_b16 v[60:61], v25 offset:28672
  buffer_load_dwordx4 v88, s[68:71], s34 offen sc1 lds
  v_cvt_pk_bf16_f32 v39, v222, v223
  v_mfma_f32_16x16x32_bf16 v[148:151], v[72:75], a[68:71], v[148:151]
  ds_read_b64_tr_b16 v[62:63], v25 offset:29696
  s_add_u32 m0, s33, 65536
  ds_write_b128 v17, v[36:39] offset:27648
  v_mfma_f32_16x16x32_bf16 v[148:151], v[76:79], a[84:87], v[148:151]
  ds_read_b64_tr_b16 v[64:65], v14 offset:8192
  s_mov_b32 s34, 4423680
  s_mov_b32 s61, 27648
  v_mfma_f32_16x16x32_bf16 v[152:155], v[68:71], a[56:59], v[152:155]
  ds_read_b64_tr_b16 v[66:67], v14 offset:9216
  buffer_load_dwordx4 v20, s[24:27], s34 offen lds
  buffer_store_dwordx4 v[36:39], v80, s[28:31], s61 offen sc1
  v_mfma_f32_16x16x32_bf16 v[152:155], v[72:75], a[72:75], v[152:155]
  ds_read_b128 a[16:19], v16 offset:4096
  s_add_u32 m0, s33, 69632
  v_mfma_f32_16x16x32_bf16 v[152:155], v[76:79], a[88:91], v[152:155]
  ds_read_b128 a[20:23], v16 offset:5120
  s_mov_b32 s34, 4718592
  v_mfma_f32_16x16x32_bf16 v[156:159], v[68:71], a[60:63], v[156:159]
  ds_read_b128 a[24:27], v16 offset:6144
  buffer_load_dwordx4 v20, s[24:27], s34 offen lds
  v_mfma_f32_16x16x32_bf16 v[156:159], v[72:75], a[76:79], v[156:159]
  ds_read_b128 a[28:31], v16 offset:7168
  v_mfma_f32_16x16x32_bf16 v[156:159], v[76:79], a[92:95], v[156:159]
  s_waitcnt lgkmcnt(4)
  v_mfma_f32_16x16x32_bf16 v[128:131], v[56:59], a[96:99], v[128:131]
  ds_read_b64_tr_b16 v[68:69], v15 offset:22528
  s_add_u32 m0, s33, 73728
  v_mfma_f32_16x16x32_bf16 v[128:131], v[60:63], a[112:115], v[128:131]
  ds_read_b64_tr_b16 v[70:71], v15 offset:23552
  s_mov_b32 s34, 5013504
  v_mfma_f32_16x16x32_bf16 v[128:131], v[64:67], a[128:131], v[128:131]
  ds_read_b64_tr_b16 v[72:73], v25 offset:30720
  buffer_load_dwordx4 v20, s[24:27], s34 offen lds
  v_mfma_f32_16x16x32_bf16 v[132:135], v[56:59], a[100:103], v[132:135]
  ds_read_b64_tr_b16 v[74:75], v25 offset:31744
  s_add_u32 m0, s33, 77824
  v_mfma_f32_16x16x32_bf16 v[132:135], v[60:63], a[116:119], v[132:135]
  ds_read_b64_tr_b16 v[76:77], v14 offset:10240
  s_mov_b32 s34, 16384
  v_mfma_f32_16x16x32_bf16 v[132:135], v[64:67], a[132:135], v[132:135]
  ds_read_b64_tr_b16 v[78:79], v14 offset:11264
  buffer_load_dwordx4 v88, s[68:71], s34 offen sc1 lds
  v_mfma_f32_16x16x32_bf16 v[136:139], v[56:59], a[104:107], v[136:139]
  ds_read_b128 a[32:35], v16 offset:8192
  s_add_u32 m0, s33, 0
  v_mfma_f32_16x16x32_bf16 v[136:139], v[60:63], a[120:123], v[136:139]
  ds_read_b128 a[36:39], v16 offset:9216
  s_mov_b32 s34, 18432
  v_mfma_f32_16x16x32_bf16 v[136:139], v[64:67], a[136:139], v[136:139]
  ds_read_b128 a[40:43], v16 offset:10240
  buffer_load_dwordx4 v88, s[68:71], s34 offen sc1 lds
  v_mfma_f32_16x16x32_bf16 v[140:143], v[56:59], a[108:111], v[140:143]
  ds_read_b128 a[44:47], v16 offset:11264
  v_mfma_f32_16x16x32_bf16 v[140:143], v[60:63], a[124:127], v[140:143]
  v_mfma_f32_16x16x32_bf16 v[140:143], v[64:67], a[140:143], v[140:143]
  s_waitcnt lgkmcnt(4)
  v_mfma_f32_16x16x32_bf16 v[144:147], v[68:71], a[96:99], v[144:147]
  ds_read_b64_tr_b16 v[56:57], v14 offset:12288
  v_mfma_f32_16x16x32_bf16 v[144:147], v[72:75], a[112:115], v[144:147]
  ds_read_b64_tr_b16 v[58:59], v14 offset:13312
  v_mfma_f32_16x16x32_bf16 v[144:147], v[76:79], a[128:131], v[144:147]
  ds_read_b64_tr_b16 v[60:61], v15 offset:57344
  v_mfma_f32_16x16x32_bf16 v[148:151], v[68:71], a[100:103], v[148:151]
  ds_read_b64_tr_b16 v[62:63], v15 offset:58368
  v_mfma_f32_16x16x32_bf16 v[148:151], v[72:75], a[116:119], v[148:151]
  ds_read_b64_tr_b16 v[64:65], v14 offset:16384
  v_mfma_f32_16x16x32_bf16 v[148:151], v[76:79], a[132:135], v[148:151]
  ds_read_b64_tr_b16 v[66:67], v14 offset:17408
  v_mfma_f32_16x16x32_bf16 v[152:155], v[68:71], a[104:107], v[152:155]
  ds_read_b128 a[48:51], v16 offset:12288
  s_add_u32 m0, s33, 4096
  v_mfma_f32_16x16x32_bf16 v[152:155], v[72:75], a[120:123], v[152:155]
  ds_read_b128 a[52:55], v16 offset:13312
  s_mov_b32 s34, 20480
  v_mfma_f32_16x16x32_bf16 v[152:155], v[76:79], a[136:139], v[152:155]
  ds_read_b128 a[56:59], v16 offset:14336
  buffer_load_dwordx4 v88, s[68:71], s34 offen sc1 lds
  v_mfma_f32_16x16x32_bf16 v[156:159], v[68:71], a[108:111], v[156:159]
  ds_read_b128 a[60:63], v16 offset:15360
  s_add_u32 m0, s33, 81920
  v_mfma_f32_16x16x32_bf16 v[156:159], v[72:75], a[124:127], v[156:159]
  s_mov_b32 s34, 22528
  v_mfma_f32_16x16x32_bf16 v[156:159], v[76:79], a[140:143], v[156:159]
  buffer_load_dwordx4 v88, s[68:71], s34 offen sc1 lds
  s_waitcnt lgkmcnt(4)
  v_mfma_f32_16x16x32_bf16 v[128:131], v[56:59], a[144:147], v[128:131]
  s_waitcnt vmcnt(11)
  s_barrier
  v_mfma_f32_16x16x32_bf16 v[128:131], v[60:63], a[160:163], v[128:131]
  ds_read_b64_tr_b16 v[68:69], v14 offset:14336
  s_add_u32 m0, s33, 126976
  v_mfma_f32_16x16x32_bf16 v[128:131], v[64:67], a[176:179], v[128:131]
  ds_read_b64_tr_b16 v[70:71], v14 offset:15360
  s_mov_b32 s34, 0
  v_mfma_f32_16x16x32_bf16 v[132:135], v[56:59], a[148:151], v[132:135]
  ds_read_b64_tr_b16 v[72:73], v15 offset:59392
  buffer_load_dwordx4 v82, s[12:15], s34 offen lds
  v_mfma_f32_16x16x32_bf16 v[132:135], v[60:63], a[164:167], v[132:135]
  ds_read_b64_tr_b16 v[74:75], v15 offset:60416
  s_add_u32 m0, s33, 131072
  v_mfma_f32_16x16x32_bf16 v[132:135], v[64:67], a[180:183], v[132:135]
  ds_read_b64_tr_b16 v[76:77], v14 offset:18432
  s_mov_b32 s34, 36864
  v_mfma_f32_16x16x32_bf16 v[136:139], v[56:59], a[152:155], v[136:139]
  ds_read_b64_tr_b16 v[78:79], v14 offset:19456
  buffer_load_dwordx4 v82, s[12:15], s34 offen lds
  v_mfma_f32_16x16x32_bf16 v[136:139], v[60:63], a[168:171], v[136:139]
  ds_read_b128 a[64:67], v16 offset:16384
  s_add_u32 m0, s33, 90112
  v_mfma_f32_16x16x32_bf16 v[136:139], v[64:67], a[184:187], v[136:139]
  ds_read_b128 a[68:71], v16 offset:17408
  s_mov_b32 s34, 73728
  v_mfma_f32_16x16x32_bf16 v[140:143], v[56:59], a[156:159], v[140:143]
  ds_read_b128 a[72:75], v16 offset:18432
  buffer_load_dwordx4 v82, s[12:15], s34 offen lds
  v_mfma_f32_16x16x32_bf16 v[140:143], v[60:63], a[172:175], v[140:143]
  ds_read_b128 a[76:79], v16 offset:19456
  v_mfma_f32_16x16x32_bf16 v[140:143], v[64:67], a[188:191], v[140:143]
  s_waitcnt lgkmcnt(4)
  v_mfma_f32_16x16x32_bf16 v[144:147], v[68:71], a[144:147], v[144:147]
  s_waitcnt vmcnt(9)
  s_barrier
  s_mov_b32 s63, 163840
  v_mov_b32 v190, 1
  buffer_store_dword v190, v29, s[96:99], s63 offen sc1
  ds_read_b64_tr_b16 v[56:57], v14 offset:45056
  s_add_u32 m0, s33, 94208
  v_mfma_f32_16x16x32_bf16 v[144:147], v[72:75], a[160:163], v[144:147]
  ds_read_b64_tr_b16 v[58:59], v14 offset:46080
  s_mov_b32 s34, 110592
  v_mfma_f32_16x16x32_bf16 v[144:147], v[76:79], a[176:179], v[144:147]
  ds_read_b64_tr_b16 v[60:61], v14 offset:49152
  buffer_load_dwordx4 v82, s[12:15], s34 offen lds
  v_mfma_f32_16x16x32_bf16 v[148:151], v[68:71], a[148:151], v[148:151]
  ds_read_b64_tr_b16 v[62:63], v14 offset:50176
  s_add_u32 m0, s33, 135168
  v_mfma_f32_16x16x32_bf16 v[148:151], v[72:75], a[164:167], v[148:151]
  ds_read_b64_tr_b16 v[64:65], v14 offset:53248
  s_mov_b32 s34, 147456
  v_mfma_f32_16x16x32_bf16 v[148:151], v[76:79], a[180:183], v[148:151]
  ds_read_b64_tr_b16 v[66:67], v14 offset:54272
  buffer_load_dwordx4 v82, s[12:15], s34 offen lds
  v_mfma_f32_16x16x32_bf16 v[152:155], v[68:71], a[152:155], v[152:155]
  ds_read_b128 a[80:83], v16 offset:20480
  s_add_u32 m0, s33, 98304
  v_mfma_f32_16x16x32_bf16 v[152:155], v[72:75], a[168:171], v[152:155]
  ds_read_b128 a[84:87], v16 offset:21504
  s_mov_b32 s34, 184320
  v_mfma_f32_16x16x32_bf16 v[152:155], v[76:79], a[184:187], v[152:155]
  ds_read_b128 a[88:91], v16 offset:22528
  buffer_load_dwordx4 v82, s[12:15], s34 offen lds
  v_mfma_f32_16x16x32_bf16 v[156:159], v[68:71], a[156:159], v[156:159]
  ds_read_b128 a[92:95], v16 offset:23552
  v_mfma_f32_16x16x32_bf16 v[156:159], v[72:75], a[172:175], v[156:159]
  v_mfma_f32_16x16x32_bf16 v[156:159], v[76:79], a[188:191], v[156:159]
  s_waitcnt lgkmcnt(4)
  v_mfma_f32_16x16x32_bf16 v[128:131], v[56:59], a[192:195], v[128:131]
  ds_read_b64_tr_b16 v[68:69], v14 offset:47104
  v_mfma_f32_16x16x32_bf16 v[128:131], v[60:63], a[208:211], v[128:131]
  ds_read_b64_tr_b16 v[70:71], v14 offset:48128
  v_mfma_f32_16x16x32_bf16 v[128:131], v[64:67], a[224:227], v[128:131]
  ds_read_b64_tr_b16 v[72:73], v14 offset:51200
  v_mfma_f32_16x16x32_bf16 v[132:135], v[56:59], a[196:199], v[132:135]
  ds_read_b64_tr_b16 v[74:75], v14 offset:52224
  v_mfma_f32_16x16x32_bf16 v[132:135], v[60:63], a[212:215], v[132:135]
  ds_read_b64_tr_b16 v[76:77], v14 offset:55296
  v_mfma_f32_16x16x32_bf16 v[132:135], v[64:67], a[228:231], v[132:135]
  ds_read_b64_tr_b16 v[78:79], v14 offset:56320
  v_mfma_f32_16x16x32_bf16 v[136:139], v[56:59], a[200:203], v[136:139]
  ds_read_b128 a[144:147], v26 offset:20480
  s_add_u32 m0, s33, 86016
  v_mfma_f32_16x16x32_bf16 v[136:139], v[60:63], a[216:219], v[136:139]
  ds_read_b128 a[148:151], v26 offset:21504
  s_mov_b32 s34, 0
  v_mfma_f32_16x16x32_bf16 v[136:139], v[64:67], a[232:235], v[136:139]
  ds_read_b128 a[152:155], v26 offset:24576
  buffer_load_dwordx4 v84, s[12:15], s34 offen lds
  v_mfma_f32_16x16x32_bf16 v[140:143], v[56:59], a[204:207], v[140:143]
  ds_read_b128 a[156:159], v26 offset:25600
  s_add_u32 m0, s33, 8192
  v_mfma_f32_16x16x32_bf16 v[140:143], v[60:63], a[220:223], v[140:143]
  s_mov_b32 s34, 36864
  v_mfma_f32_16x16x32_bf16 v[140:143], v[64:67], a[236:239], v[140:143]
  buffer_load_dwordx4 v84, s[12:15], s34 offen lds
  s_waitcnt lgkmcnt(4)
  v_mfma_f32_16x16x32_bf16 v[144:147], v[68:71], a[192:195], v[144:147]
  s_waitcnt vmcnt(6)
  s_barrier
  v_mfma_f32_16x16x32_bf16 v[144:147], v[72:75], a[208:211], v[144:147]
  ds_read_b64_tr_b16 v[56:57], v15
  s_add_u32 m0, s33, 139264
  v_mfma_f32_16x16x32_bf16 v[144:147], v[76:79], a[224:227], v[144:147]
  ds_read_b64_tr_b16 v[58:59], v15 offset:1024
  s_mov_b32 s34, 73728
  v_mfma_f32_16x16x32_bf16 v[148:151], v[68:71], a[196:199], v[148:151]
  ds_read_b64_tr_b16 v[60:61], v15 offset:4096
  buffer_load_dwordx4 v84, s[12:15], s34 offen lds
  v_mfma_f32_16x16x32_bf16 v[148:151], v[72:75], a[212:215], v[148:151]
  ds_read_b64_tr_b16 v[62:63], v15 offset:5120
  s_add_u32 m0, s33, 102400
  v_mfma_f32_16x16x32_bf16 v[148:151], v[76:79], a[228:231], v[148:151]
  ds_read_b64_tr_b16 v[64:65], v15 offset:8192
  s_mov_b32 s34, 110592
  v_mfma_f32_16x16x32_bf16 v[152:155], v[68:71], a[200:203], v[152:155]
  ds_read_b64_tr_b16 v[66:67], v15 offset:9216
  buffer_load_dwordx4 v84, s[12:15], s34 offen lds
  v_mfma_f32_16x16x32_bf16 v[152:155], v[72:75], a[216:219], v[152:155]
  ds_read_b128 a[160:163], v26 offset:28672
  s_add_u32 m0, s33, 143360
  v_mfma_f32_16x16x32_bf16 v[152:155], v[76:79], a[232:235], v[152:155]
  ds_read_b128 a[164:167], v26 offset:29696
  s_mov_b32 s34, 147456
  v_mfma_f32_16x16x32_bf16 v[156:159], v[68:71], a[204:207], v[156:159]
  ds_read_b128 a[168:171], v26 offset:32768
  buffer_load_dwordx4 v84, s[12:15], s34 offen lds
  v_mfma_f32_16x16x32_bf16 v[156:159], v[72:75], a[220:223], v[156:159]
  ds_read_b128 a[172:175], v26 offset:33792
  s_mov_b32 s63, 163840
  buffer_load_dword v31, v91, s[96:99], s63 offen sc1
  v_mfma_f32_16x16x32_bf16 v[156:159], v[76:79], a[236:239], v[156:159]
  s_waitcnt lgkmcnt(4)
  v_mfma_f32_16x16x32_bf16 v[128:131], v[56:59], a[240:243], v[128:131]
  ds_read_b64_tr_b16 v[68:69], v15 offset:2048
  s_add_u32 m0, s33, 147456
  v_mfma_f32_16x16x32_bf16 v[128:131], v[60:63], v[96:99], v[128:131]
  ds_read_b64_tr_b16 v[70:71], v15 offset:3072
  s_mov_b32 s34, 184320
  v_mfma_f32_16x16x32_bf16 v[128:131], v[64:67], v[112:115], v[128:131]
  ds_read_b64_tr_b16 v[72:73], v15 offset:6144
  buffer_load_dwordx4 v84, s[12:15], s34 offen lds
  v_mfma_f32_16x16x32_bf16 v[132:135], v[56:59], a[244:247], v[132:135]
  ds_read_b64_tr_b16 v[74:75], v15 offset:7168
  s_add_u32 m0, s33, 106496
  v_mfma_f32_16x16x32_bf16 v[132:135], v[60:63], v[100:103], v[132:135]
  ds_read_b64_tr_b16 v[76:77], v15 offset:10240
  s_mov_b32 s34, 221184
  v_mfma_f32_16x16x32_bf16 v[132:135], v[64:67], v[116:119], v[132:135]
  ds_read_b64_tr_b16 v[78:79], v15 offset:11264
  buffer_load_dwordx4 v82, s[12:15], s34 offen lds
  v_mfma_f32_16x16x32_bf16 v[136:139], v[56:59], a[248:251], v[136:139]
  ds_read_b128 a[176:179], v26 offset:36864
  s_add_u32 m0, s33, 110592
  v_mfma_f32_16x16x32_bf16 v[136:139], v[60:63], v[104:107], v[136:139]
  ds_read_b128 a[180:183], v26 offset:37888
  s_mov_b32 s34, 258048
  v_mfma_f32_16x16x32_bf16 v[136:139], v[64:67], v[120:123], v[136:139]
  ds_read_b128 a[184:187], v26 offset:40960
  buffer_load_dwordx4 v82, s[12:15], s34 offen lds
  v_mfma_f32_16x16x32_bf16 v[140:143], v[56:59], a[252:255], v[140:143]
  ds_read_b128 a[188:191], v26 offset:41984
  v_mfma_f32_16x16x32_bf16 v[140:143], v[60:63], v[108:111], v[140:143]
  v_mfma_f32_16x16x32_bf16 v[140:143], v[64:67], v[124:127], v[140:143]
  s_waitcnt lgkmcnt(4)
  v_mfma_f32_16x16x32_bf16 v[144:147], v[68:71], a[240:243], v[144:147]
  ds_read_b64_tr_b16 v[56:57], v9 offset:61440
  v_mfma_f32_16x16x32_bf16 v[144:147], v[72:75], v[96:99], v[144:147]
  ds_read_b64_tr_b16 v[58:59], v9 offset:63488
  v_mfma_f32_16x16x32_bf16 v[144:147], v[76:79], v[112:115], v[144:147]
  ds_read_b64_tr_b16 v[60:61], v10
  v_mfma_f32_16x16x32_bf16 v[148:151], v[68:71], a[244:247], v[148:151]
  ds_read_b64_tr_b16 v[62:63], v10 offset:2048
  v_mfma_f32_16x16x32_bf16 v[148:151], v[72:75], v[100:103], v[148:151]
  ds_read_b64_tr_b16 v[64:65], v9 offset:24576
  v_mfma_f32_16x16x32_bf16 v[148:151], v[76:79], v[116:119], v[148:151]
  ds_read_b64_tr_b16 v[66:67], v9 offset:26624
  v_mfma_f32_16x16x32_bf16 v[152:155], v[68:71], a[248:251], v[152:155]
  ds_read_b128 a[192:195], v26 offset:57344
  s_add_u32 m0, s33, 12288
  v_mfma_f32_16x16x32_bf16 v[152:155], v[72:75], v[104:107], v[152:155]
  ds_read_b128 a[196:199], v26 offset:58368
  s_mov_b32 s34, 0
  v_mfma_f32_16x16x32_bf16 v[152:155], v[76:79], v[120:123], v[152:155]
  ds_read_b128 a[200:203], v26 offset:61440
  buffer_load_dwordx4 v83, s[12:15], s34 offen lds
  v_mfma_f32_16x16x32_bf16 v[156:159], v[68:71], a[252:255], v[156:159]
  ds_read_b128 a[204:207], v26 offset:62464
  v_mfma_f32_16x16x32_bf16 v[156:159], v[72:75], v[108:111], v[156:159]
  v_mfma_f32_16x16x32_bf16 v[156:159], v[76:79], v[124:127], v[156:159]
  s_waitcnt lgkmcnt(4)
  v_mfma_f32_16x16x32_bf16 v[192:195], v[56:59], a[0:3], 0
  s_waitcnt vmcnt(10)
  s_barrier
  v_mfma_f32_16x16x32_bf16 v[192:195], v[60:63], a[16:19], v[192:195]
  ds_read_b64_tr_b16 v[68:69], v12 offset:61440
  s_add_u32 m0, s33, 16384
  v_mul_f32 v128, v128, v144
  s_waitcnt vmcnt(4)
  v_cmp_eq_u32 vcc, 0, v31
  s_cbranch_vccnz L_sp_14
L_bk_15:
  v_mfma_f32_16x16x32_bf16 v[192:195], v[64:67], a[32:35], v[192:195]
  ds_read_b64_tr_b16 v[70:71], v12 offset:63488
  s_mov_b32 s34, 128
  v_mul_f32 v129, v129, v145
  v_mfma_f32_16x16x32_bf16 v[196:199], v[56:59], a[4:7], 0
  ds_read_b64_tr_b16 v[72:73], v13
  buffer_load_dwordx4 v82, s[12:15], s34 offen lds
  v_mul_f32 v130, v130, v146
  v_mfma_f32_16x16x32_bf16 v[196:199], v[60:63], a[20:23], v[196:199]
  ds_read_b64_tr_b16 v[74:75], v13 offset:2048
  s_add_u32 m0, s33, 45056
  v_mul_f32 v131, v131, v147
  v_mfma_f32_16x16x32_bf16 v[196:199], v[64:67], a[36:39], v[196:199]
  ds_read_b64_tr_b16 v[76:77], v12 offset:24576
  s_mov_b32 s34, 36992
  v_cvt_pk_bf16_f32 v32, v128, v129
  v_mfma_f32_16x16x32_bf16 v[200:203], v[56:59], a[8:11], 0
  ds_read_b64_tr_b16 v[78:79], v12 offset:26624
  buffer_load_dwordx4 v82, s[12:15], s34 offen lds
  v_cvt_pk_bf16_f32 v33, v130, v131
  v_mfma_f32_16x16x32_bf16 v[200:203], v[60:63], a[24:27], v[200:203]
  ds_read_b128 a[96:99], v16 offset:24576
  s_add_u32 m0, s33, 49152
  ds_write_b64 v18, v[32:33] offset:32768
  v_mfma_f32_16x16x32_bf16 v[200:203], v[64:67], a[40:43], v[200:203]
  ds_read_b128 a[100:103], v16 offset:25600
  s_mov_b32 s34, 73856
  s_mov_b32 s61, 32768
  v_mfma_f32_16x16x32_bf16 v[204:207], v[56:59], a[12:15], 0
  ds_read_b128 a[104:107], v16 offset:26624
  buffer_load_dwordx4 v82, s[12:15], s34 offen lds
  buffer_store_dwordx2 v[32:33], v81, s[28:31], s61 offen sc1
  v_mfma_f32_16x16x32_bf16 v[204:207], v[60:63], a[28:31], v[204:207]
  ds_read_b128 a[108:111], v16 offset:27648
  v_mul_f32 v132, v132, v148
  v_mul_f32 v133, v133, v149
  v_mfma_f32_16x16x32_bf16 v[204:207], v[64:67], a[44:47], v[204:207]
  v_mul_f32 v134, v134, v150
  v_mul_f32 v135, v135, v151
  s_waitcnt lgkmcnt(5)
  v_mfma_f32_16x16x32_bf16 v[208:211], v[68:71], a[0:3], 0
  ds_read_b64_tr_b16 v[56:57], v9 offset:28672
  v_cvt_pk_bf16_f32 v34, v132, v133
  v_cvt_pk_bf16_f32 v35, v134, v135
  v_mfma_f32_16x16x32_bf16 v[208:211], v[72:75], a[16:19], v[208:211]
  ds_read_b64_tr_b16 v[58:59], v9 offset:30720
  ds_write_b64 v18, v[34:35] offset:33792
  s_mov_b32 s61, 33792
  v_mfma_f32_16x16x32_bf16 v[208:211], v[76:79], a[32:35], v[208:211]
  ds_read_b64_tr_b16 v[60:61], v10 offset:4096
  buffer_store_dwordx2 v[34:35], v81, s[28:31], s61 offen sc1
  v_mul_f32 v136, v136, v152
  v_mfma_f32_16x16x32_bf16 v[212:215], v[68:71], a[4:7], 0
  ds_read_b64_tr_b16 v[62:63], v10 offset:6144
  v_mul_f32 v137, v137, v153
  v_mul_f32 v138, v138, v154
  v_mfma_f32_16x16x32_bf16 v[212:215], v[72:75], a[20:23], v[212:215]
  ds_read_b64_tr_b16 v[64:65], v9 offset:32768
  v_mul_f32 v139, v139, v155
  v_cvt_pk_bf16_f32 v36, v136, v137
  v_mfma_f32_16x16x32_bf16 v[212:215], v[76:79], a[36:39], v[212:215]
  ds_read_b64_tr_b16 v[66:67], v9 offset:34816
  v_cvt_pk_bf16_f32 v37, v138, v139
  ds_write_b64 v18, v[36:37] offset:34816
  v_mfma_f32_16x16x32_bf16 v[216:219], v[68:71], a[8:11], 0
  ds_read_b128 a[208:211], v27 offset:12288
  s_mov_b32 s61, 34816
  buffer_store_dwordx2 v[36:37], v81, s[28:31], s61 offen sc1
  v_mfma_f32_16x16x32_bf16 v[216:219], v[72:75], a[24:27], v[216:219]
  ds_read_b128 a[212:215], v27 offset:13312
  v_mul_f32 v140, v140, v156
  v_mul_f32 v141, v141, v157
  v_mfma_f32_16x16x32_bf16 v[216:219], v[76:79], a[40:43], v[216:219]
  ds_read_b128 a[216:219], v26
  v_mul_f32 v142, v142, v158
  v_mul_f32 v143, v143, v159
  v_mfma_f32_16x16x32_bf16 v[220:223], v[68:71], a[12:15], 0
  ds_read_b128 a[220:223], v26 offset:1024
  v_cvt_pk_bf16_f32 v38, v140, v141
  v_cvt_pk_bf16_f32 v39, v142, v143
  v_mfma_f32_16x16x32_bf16 v[220:223], v[72:75], a[28:31], v[220:223]
  ds_write_b64 v18, v[38:39] offset:35840
  s_mov_b32 s61, 35840
  v_mfma_f32_16x16x32_bf16 v[220:223], v[76:79], a[44:47], v[220:223]
  buffer_store_dwordx2 v[38:39], v81, s[28:31], s61 offen sc1
  s_waitcnt lgkmcnt(6)
  v_mfma_f32_16x16x32_bf16 v[192:195], v[56:59], a[48:51], v[192:195]
  ds_read_b64_tr_b16 v[68:69], v12 offset:28672
  s_add_u32 m0, s33, 53248
  v_mfma_f32_16x16x32_bf16 v[192:195], v[60:63], a[64:67], v[192:195]
  ds_read_b64_tr_b16 v[70:71], v12 offset:30720
  s_mov_b32 s34, 110720
  v_mfma_f32_16x16x32_bf16 v[192:195], v[64:67], a[80:83], v[192:195]
  ds_read_b64_tr_b16 v[72:73], v13 offset:4096
  buffer_load_dwordx4 v82, s[12:15], s34 offen lds
  v_mfma_f32_16x16x32_bf16 v[196:199], v[56:59], a[52:55], v[196:199]
  ds_read_b64_tr_b16 v[74:75], v13 offset:6144
  s_add_u32 m0, s33, 20480
  v_mfma_f32_16x16x32_bf16 v[196:199], v[60:63], a[68:71], v[196:199]
  ds_read_b64_tr_b16 v[76:77], v12 offset:32768
  s_mov_b32 s34, 147584
  v_mfma_f32_16x16x32_bf16 v[196:199], v[64:67], a[84:87], v[196:199]
  ds_read_b64_tr_b16 v[78:79], v12 offset:34816
  buffer_load_dwordx4 v82, s[12:15], s34 offen lds
  v_mfma_f32_16x16x32_bf16 v[200:203], v[56:59], a[56:59], v[200:203]
  ds_read_b128 a[224:227], v26 offset:4096
  s_add_u32 m0, s33, 24576
  v_mfma_f32_16x16x32_bf16 v[200:203], v[60:63], a[72:75], v[200:203]
  ds_read_b128 a[228:231], v26 offset:5120
  s_mov_b32 s34, 184448
  v_mfma_f32_16x16x32_bf16 v[200:203], v[64:67], a[88:91], v[200:203]
  ds_read_b128 a[232:235], v27 offset:16384
  buffer_load_dwordx4 v82, s[12:15], s34 offen lds
  v_mfma_f32_16x16x32_bf16 v[204:207], v[56:59], a[60:63], v[204:207]
  ds_read_b128 a[236:239], v27 offset:17408
  s_mov_b32 s65, 24576
  v_mfma_f32_16x16x32_bf16 v[204:207], v[60:63], a[76:79], v[204:207]
  buffer_load_dwordx4 a[240:243], v89, s[68:71], s65 offen sc1
  buffer_load_dwordx4 a[244:247], v89, s[68:71], s65 offen offset:1024 sc1
  v_mfma_f32_16x16x32_bf16 v[204:207], v[64:67], a[92:95], v[204:207]
  buffer_load_dwordx4 a[248:251], v89, s[68:71], s65 offen offset:2048 sc1
  s_waitcnt lgkmcnt(4)
  v_mfma_f32_16x16x32_bf16 v[208:211], v[68:71], a[48:51], v[208:211]
  s_waitcnt vmcnt(16)
  s_barrier
  v_mfma_f32_16x16x32_bf16 v[208:211], v[72:75], a[64:67], v[208:211]
  ds_read_b64_tr_b16 v[56:57], v9 offset:20480
  buffer_load_dwordx4 a[252:255], v89, s[68:71], s65 offen offset:3072 sc1
  v_mfma_f32_16x16x32_bf16 v[208:211], v[76:79], a[80:83], v[208:211]
  ds_read_b64_tr_b16 v[58:59], v9 offset:22528
  s_mov_b32 s65, 28672
  v_mfma_f32_16x16x32_bf16 v[212:215], v[68:71], a[52:55], v[212:215]
  ds_read_b64_tr_b16 v[60:61], v8 offset:8192
  buffer_load_dwordx4 v[96:99], v89, s[68:71], s65 offen sc1
  v_mfma_f32_16x16x32_bf16 v[212:215], v[72:75], a[68:71], v[212:215]
  ds_read_b64_tr_b16 v[62:63], v8 offset:10240
  buffer_load_dwordx4 v[100:103], v89, s[68:71], s65 offen offset:1024 sc1
  v_mfma_f32_16x16x32_bf16 v[212:215], v[76:79], a[84:87], v[212:215]
  ds_read_b64_tr_b16 v[64:65], v10 offset:8192
  buffer_load_dwordx4 v[104:107], v89, s[68:71], s65 offen offset:2048 sc1
  v_mfma_f32_16x16x32_bf16 v[216:219], v[68:71], a[56:59], v[216:219]
  ds_read_b64_tr_b16 v[66:67], v10 offset:10240
  buffer_load_dwordx4 v[108:111], v89, s[68:71], s65 offen offset:3072 sc1
  v_mfma_f32_16x16x32_bf16 v[216:219], v[72:75], a[72:75], v[216:219]
  ds_read_b128 a[112:115], v16 offset:28672
  v_mfma_f32_16x16x32_bf16 v[216:219], v[76:79], a[88:91], v[216:219]
  ds_read_b128 a[116:119], v16 offset:29696
  v_mfma_f32_16x16x32_bf16 v[220:223], v[68:71], a[60:63], v[220:223]
  ds_read_b128 a[120:123], v16 offset:30720
  v_mfma_f32_16x16x32_bf16 v[220:223], v[72:75], a[76:79], v[220:223]
  ds_read_b128 a[124:127], v16 offset:31744
  v_mfma_f32_16x16x32_bf16 v[220:223], v[76:79], a[92:95], v[220:223]
  s_waitcnt lgkmcnt(4)
  v_mfma_f32_16x16x32_bf16 v[192:195], v[56:59], a[144:147], v[192:195]
  ds_read_b64_tr_b16 v[68:69], v12 offset:20480
  v_mfma_f32_16x16x32_bf16 v[192:195], v[60:63], a[160:163], v[192:195]
  ds_read_b64_tr_b16 v[70:71], v12 offset:22528
  v_mfma_f32_16x16x32_bf16 v[192:195], v[64:67], a[176:179], v[192:195]
  ds_read_b64_tr_b16 v[72:73], v11 offset:8192
  v_mfma_f32_16x16x32_bf16 v[196:199], v[56:59], a[148:151], v[196:199]
  ds_read_b64_tr_b16 v[74:75], v11 offset:10240
  v_mfma_f32_16x16x32_bf16 v[196:199], v[60:63], a[164:167], v[196:199]
  ds_read_b64_tr_b16 v[76:77], v13 offset:8192
  v_mfma_f32_16x16x32_bf16 v[196:199], v[64:67], a[180:183], v[196:199]
  ds_read_b64_tr_b16 v[78:79], v13 offset:10240
  v_mfma_f32_16x16x32_bf16 v[200:203], v[56:59], a[152:155], v[200:203]
  ds_read_b128 a[128:131], v16 offset:32768
  s_add_u32 m0, s33, 151552
  v_mfma_f32_16x16x32_bf16 v[200:203], v[60:63], a[168:171], v[200:203]
  ds_read_b128 a[132:135], v16 offset:33792
  s_mov_b32 s34, 221184
  v_mfma_f32_16x16x32_bf16 v[200:203], v[64:67], a[184:187], v[200:203]
  ds_read_b128 a[136:139], v16 offset:34816
  buffer_load_dwordx4 v84, s[12:15], s34 offen lds
  v_mfma_f32_16x16x32_bf16 v[204:207], v[56:59], a[156:159], v[204:207]
  ds_read_b128 a[140:143], v16 offset:35840
  s_add_u32 m0, s33, 114688
  v_mfma_f32_16x16x32_bf16 v[204:207], v[60:63], a[172:175], v[204:207]
  s_mov_b32 s34, 258048
  v_mfma_f32_16x16x32_bf16 v[204:207], v[64:67], a[188:191], v[204:207]
  buffer_load_dwordx4 v84, s[12:15], s34 offen lds
  s_waitcnt lgkmcnt(4)
  v_mfma_f32_16x16x32_bf16 v[208:211], v[68:71], a[144:147], v[208:211]
  s_waitcnt vmcnt(13)
  s_barrier
  s_mov_b32 s63, 196608
  v_mov_b32 v190, 1
  buffer_store_dword v190, v29, s[96:99], s63 offen sc1
  ds_read_b64_tr_b16 v[56:57], v9 offset:36864
  v_mfma_f32_16x16x32_bf16 v[208:211], v[72:75], a[160:163], v[208:211]
  ds_read_b64_tr_b16 v[58:59], v9 offset:38912
  v_mfma_f32_16x16x32_bf16 v[208:211], v[76:79], a[176:179], v[208:211]
  ds_read_b64_tr_b16 v[60:61], v10 offset:12288
  v_mfma_f32_16x16x32_bf16 v[212:215], v[68:71], a[148:151], v[212:215]
  ds_read_b64_tr_b16 v[62:63], v10 offset:14336
  v_mfma_f32_16x16x32_bf16 v[212:215], v[72:75], a[164:167], v[212:215]
  ds_read_b64_tr_b16 v[64:65], v10 offset:16384
  v_mfma_f32_16x16x32_bf16 v[212:215], v[76:79], a[180:183], v[212:215]
  ds_read_b64_tr_b16 v[66:67], v10 offset:18432
  v_mfma_f32_16x16x32_bf16 v[216:219], v[68:71], a[152:155], v[216:219]
  s_add_u32 m0, s33, 28672
  v_mfma_f32_16x16x32_bf16 v[216:219], v[72:75], a[168:171], v[216:219]
  s_mov_b32 s34, 0
  v_mfma_f32_16x16x32_bf16 v[216:219], v[76:79], a[184:187], v[216:219]
  buffer_load_dwordx4 v85, s[12:15], s34 offen lds
  v_mfma_f32_16x16x32_bf16 v[220:223], v[68:71], a[156:159], v[220:223]
  v_mfma_f32_16x16x32_bf16 v[220:223], v[72:75], a[172:175], v[220:223]
  v_mfma_f32_16x16x32_bf16 v[220:223], v[76:79], a[188:191], v[220:223]
  s_waitcnt lgkmcnt(0)
  v_mfma_f32_16x16x32_bf16 v[192:195], v[56:59], a[192:195], v[192:195]
  s_barrier
  v_mfma_f32_16x16x32_bf16 v[192:195], v[60:63], a[208:211], v[192:195]
  ds_read_b64_tr_b16 v[68:69], v12 offset:36864
  v_mfma_f32_16x16x32_bf16 v[192:195], v[64:67], a[224:227], v[192:195]
  ds_read_b64_tr_b16 v[70:71], v12 offset:38912
  v_mfma_f32_16x16x32_bf16 v[196:199], v[56:59], a[196:199], v[196:199]
  ds_read_b64_tr_b16 v[72:73], v13 offset:12288
  v_mfma_f32_16x16x32_bf16 v[196:199], v[60:63], a[212:215], v[196:199]
  ds_read_b64_tr_b16 v[74:75], v13 offset:14336
  v_mfma_f32_16x16x32_bf16 v[196:199], v[64:67], a[228:231], v[196:199]
  ds_read_b64_tr_b16 v[76:77], v13 offset:16384
  v_mfma_f32_16x16x32_bf16 v[200:203], v[56:59], a[200:203], v[200:203]
  ds_read_b64_tr_b16 v[78:79], v13 offset:18432
  v_mfma_f32_16x16x32_bf16 v[200:203], v[60:63], a[216:219], v[200:203]
  s_add_u32 m0, s33, 155648
  v_mfma_f32_16x16x32_bf16 v[200:203], v[64:67], a[232:235], v[200:203]
  s_mov_b32 s34, 221312
  v_mfma_f32_16x16x32_bf16 v[204:207], v[56:59], a[204:207], v[204:207]
  buffer_load_dwordx4 v82, s[12:15], s34 offen lds
  v_mfma_f32_16x16x32_bf16 v[204:207], v[60:63], a[220:223], v[204:207]
  s_add_u32 m0, s33, 118784
  v_mfma_f32_16x16x32_bf16 v[204:207], v[64:67], a[236:239], v[204:207]
  s_mov_b32 s34, 258176
  buffer_load_dwordx4 v82, s[12:15], s34 offen lds
  s_waitcnt lgkmcnt(0)
  v_mfma_f32_16x16x32_bf16 v[208:211], v[68:71], a[192:195], v[208:211]
  ds_read_b64_tr_b16 v[56:57], v9 offset:40960
  v_mfma_f32_16x16x32_bf16 v[208:211], v[72:75], a[208:211], v[208:211]
  ds_read_b64_tr_b16 v[58:59], v9 offset:43008
  s_mov_b32 s63, 196608
  buffer_load_dword v31, v91, s[96:99], s63 offen sc1
  v_mfma_f32_16x16x32_bf16 v[208:211], v[76:79], a[224:227], v[208:211]
  ds_read_b64_tr_b16 v[60:61], v9 offset:45056
  v_mfma_f32_16x16x32_bf16 v[212:215], v[68:71], a[196:199], v[212:215]
  ds_read_b64_tr_b16 v[62:63], v9 offset:47104
  v_mfma_f32_16x16x32_bf16 v[212:215], v[72:75], a[212:215], v[212:215]
  ds_read_b64_tr_b16 v[64:65], v8 offset:12288
  v_mfma_f32_16x16x32_bf16 v[212:215], v[76:79], a[228:231], v[212:215]
  ds_read_b64_tr_b16 v[66:67], v8 offset:14336
  v_mfma_f32_16x16x32_bf16 v[216:219], v[68:71], a[200:203], v[216:219]
  s_add_u32 m0, s33, 159744
  v_mfma_f32_16x16x32_bf16 v[216:219], v[72:75], a[216:219], v[216:219]
  s_mov_b32 s34, 128
  v_mfma_f32_16x16x32_bf16 v[216:219], v[76:79], a[232:235], v[216:219]
  buffer_load_dwordx4 v83, s[12:15], s34 offen lds
  v_mfma_f32_16x16x32_bf16 v[220:223], v[68:71], a[204:207], v[220:223]
  s_add_u32 m0, s33, 122880
  v_mfma_f32_16x16x32_bf16 v[220:223], v[72:75], a[220:223], v[220:223]
  s_mov_b32 s34, 128
  v_mfma_f32_16x16x32_bf16 v[220:223], v[76:79], a[236:239], v[220:223]
  buffer_load_dwordx4 v84, s[12:15], s34 offen lds
  s_waitcnt lgkmcnt(0)
  v_mfma_f32_16x16x32_bf16 v[192:195], v[56:59], a[96:99], v[192:195]
  ds_read_b64_tr_b16 v[68:69], v12 offset:40960
  v_mfma_f32_16x16x32_bf16 v[192:195], v[60:63], a[112:115], v[192:195]
  ds_read_b64_tr_b16 v[70:71], v12 offset:43008
  v_mfma_f32_16x16x32_bf16 v[192:195], v[64:67], a[128:131], v[192:195]
  ds_read_b64_tr_b16 v[72:73], v12 offset:45056
  v_mfma_f32_16x16x32_bf16 v[196:199], v[56:59], a[100:103], v[196:199]
  ds_read_b64_tr_b16 v[74:75], v12 offset:47104
  v_mfma_f32_16x16x32_bf16 v[196:199], v[60:63], a[116:119], v[196:199]
  ds_read_b64_tr_b16 v[76:77], v11 offset:12288
  v_mfma_f32_16x16x32_bf16 v[196:199], v[64:67], a[132:135], v[196:199]
  ds_read_b64_tr_b16 v[78:79], v11 offset:14336
  v_mfma_f32_16x16x32_bf16 v[200:203], v[56:59], a[104:107], v[200:203]
  s_add_u32 m0, s33, 32768
  v_mfma_f32_16x16x32_bf16 v[200:203], v[60:63], a[120:123], v[200:203]
  s_mov_b32 s34, 36992
  v_mfma_f32_16x16x32_bf16 v[200:203], v[64:67], a[136:139], v[200:203]
  buffer_load_dwordx4 v84, s[12:15], s34 offen lds
  v_mfma_f32_16x16x32_bf16 v[204:207], v[56:59], a[108:111], v[204:207]
  s_add_u32 m0, s33, 36864
  v_mfma_f32_16x16x32_bf16 v[204:207], v[60:63], a[124:127], v[204:207]
  s_mov_b32 s34, 73856
  v_mfma_f32_16x16x32_bf16 v[204:207], v[64:67], a[140:143], v[204:207]
  buffer_load_dwordx4 v84, s[12:15], s34 offen lds
  s_waitcnt lgkmcnt(0)
  v_mfma_f32_16x16x32_bf16 v[208:211], v[68:71], a[96:99], v[208:211]
  s_waitcnt vmcnt(19)
  s_barrier
  v_mfma_f32_16x16x32_bf16 v[208:211], v[72:75], a[112:115], v[208:211]
  ds_read_b64_tr_b16 v[56:57], v8 offset:16384
  v_mfma_f32_16x16x32_bf16 v[208:211], v[76:79], a[128:131], v[208:211]
  ds_read_b64_tr_b16 v[58:59], v8 offset:18432
  v_mfma_f32_16x16x32_bf16 v[212:215], v[68:71], a[100:103], v[212:215]
  ds_read_b64_tr_b16 v[60:61], v8 offset:45056
  v_mfma_f32_16x16x32_bf16 v[212:215], v[72:75], a[116:119], v[212:215]
  ds_read_b64_tr_b16 v[62:63], v8 offset:47104
  v_mfma_f32_16x16x32_bf16 v[212:215], v[76:79], a[132:135], v[212:215]
  ds_read_b64_tr_b16 v[64:65], v8 offset:49152
  v_mfma_f32_16x16x32_bf16 v[216:219], v[68:71], a[104:107], v[216:219]
  ds_read_b64_tr_b16 v[66:67], v8 offset:51200
  v_mfma_f32_16x16x32_bf16 v[216:219], v[72:75], a[120:123], v[216:219]
  s_add_u32 m0, s33, 40960
  v_mfma_f32_16x16x32_bf16 v[216:219], v[76:79], a[136:139], v[216:219]
  s_mov_b32 s34, 110720
  v_mfma_f32_16x16x32_bf16 v[220:223], v[68:71], a[108:111], v[220:223]
  buffer_load_dwordx4 v84, s[12:15], s34 offen lds
  v_mfma_f32_16x16x32_bf16 v[220:223], v[72:75], a[124:127], v[220:223]
  s_add_u32 m0, s33, 65536
  v_mfma_f32_16x16x32_bf16 v[220:223], v[76:79], a[140:143], v[220:223]
  s_mov_b32 s34, 147584
  buffer_load_dwordx4 v84, s[12:15], s34 offen lds
  s_waitcnt lgkmcnt(0)
  v_mfma_f32_16x16x32_bf16 v[224:227], v[56:59], a[0:3], 0
  ds_read_b64_tr_b16 v[68:69], v11 offset:16384
  v_mfma_f32_16x16x32_bf16 v[224:227], v[60:63], a[16:19], v[224:227]
  ds_read_b64_tr_b16 v[70:71], v11 offset:18432
  s_waitcnt vmcnt(6)
  v_cmp_eq_u32 vcc, 0, v31
  s_cbranch_vccnz L_sp_17
L_bk_18:
  v_mfma_f32_16x16x32_bf16 v[224:227], v[64:67], a[32:35], v[224:227]
  ds_read_b64_tr_b16 v[72:73], v11 offset:45056
  s_mov_b32 s65, 32768
  v_mfma_f32_16x16x32_bf16 v[228:231], v[56:59], a[4:7], 0
  ds_read_b64_tr_b16 v[74:75], v11 offset:47104
  buffer_load_dwordx2 v[112:113], v90, s[68:71], s65 offen sc1
  v_mfma_f32_16x16x32_bf16 v[228:231], v[60:63], a[20:23], v[228:231]
  ds_read_b64_tr_b16 v[76:77], v11 offset:49152
  buffer_load_dwordx2 v[114:115], v90, s[68:71], s65 offen offset:512 sc1
  v_mfma_f32_16x16x32_bf16 v[228:231], v[64:67], a[36:39], v[228:231]
  ds_read_b64_tr_b16 v[78:79], v11 offset:51200
  buffer_load_dwordx2 v[116:117], v90, s[68:71], s65 offen offset:1024 sc1
  v_mfma_f32_16x16x32_bf16 v[232:235], v[56:59], a[8:11], 0
  s_add_u32 m0, s33, 69632
  buffer_load_dwordx2 v[118:119], v90, s[68:71], s65 offen offset:1536 sc1
  v_mfma_f32_16x16x32_bf16 v[232:235], v[60:63], a[24:27], v[232:235]
  s_mov_b32 s34, 184448
  buffer_load_dwordx2 v[120:121], v90, s[68:71], s65 offen offset:2048 sc1
  v_mfma_f32_16x16x32_bf16 v[232:235], v[64:67], a[40:43], v[232:235]
  buffer_load_dwordx4 v84, s[12:15], s34 offen lds
  buffer_load_dwordx2 v[122:123], v90, s[68:71], s65 offen offset:2560 sc1
  v_mfma_f32_16x16x32_bf16 v[236:239], v[56:59], a[12:15], 0
  s_add_u32 m0, s33, 73728
  buffer_load_dwordx2 v[124:125], v90, s[68:71], s65 offen offset:3072 sc1
  v_mfma_f32_16x16x32_bf16 v[236:239], v[60:63], a[28:31], v[236:239]
  s_mov_b32 s34, 221312
  buffer_load_dwordx2 v[126:127], v90, s[68:71], s65 offen offset:3584 sc1
  v_mfma_f32_16x16x32_bf16 v[236:239], v[64:67], a[44:47], v[236:239]
  buffer_load_dwordx4 v84, s[12:15], s34 offen lds
  s_waitcnt lgkmcnt(0)
  v_mfma_f32_16x16x32_bf16 v[240:243], v[68:71], a[0:3], 0
  ds_read_b64_tr_b16 v[56:57], v8 offset:53248
  v_mfma_f32_16x16x32_bf16 v[240:243], v[72:75], a[16:19], v[240:243]
  ds_read_b64_tr_b16 v[58:59], v8 offset:55296
  v_mfma_f32_16x16x32_bf16 v[240:243], v[76:79], a[32:35], v[240:243]
  ds_read_b64_tr_b16 v[60:61], v8 offset:20480
  v_mfma_f32_16x16x32_bf16 v[244:247], v[68:71], a[4:7], 0
  ds_read_b64_tr_b16 v[62:63], v8 offset:22528
  v_mfma_f32_16x16x32_bf16 v[244:247], v[72:75], a[20:23], v[244:247]
  ds_read_b64_tr_b16 v[64:65], v8 offset:24576
  v_mfma_f32_16x16x32_bf16 v[244:247], v[76:79], a[36:39], v[244:247]
  ds_read_b64_tr_b16 v[66:67], v8 offset:26624
  v_mfma_f32_16x16x32_bf16 v[248:251], v[68:71], a[8:11], 0
  s_add_u32 m0, s33, 57344
  v_mfma_f32_16x16x32_bf16 v[248:251], v[72:75], a[24:27], v[248:251]
  s_mov_b32 s34, 258176
  v_mfma_f32_16x16x32_bf16 v[248:251], v[76:79], a[40:43], v[248:251]
  buffer_load_dwordx4 v84, s[12:15], s34 offen lds
  v_mfma_f32_16x16x32_bf16 v[252:255], v[68:71], a[12:15], 0
  s_add_u32 m0, s33, 61440
  v_mfma_f32_16x16x32_bf16 v[252:255], v[72:75], a[28:31], v[252:255]
  s_mov_b32 s34, 128
  v_mfma_f32_16x16x32_bf16 v[252:255], v[76:79], a[44:47], v[252:255]
  buffer_load_dwordx4 v85, s[12:15], s34 offen lds
  s_waitcnt lgkmcnt(0)
  v_mfma_f32_16x16x32_bf16 v[224:227], v[56:59], a[48:51], v[224:227]
  s_barrier
  v_mfma_f32_16x16x32_bf16 v[224:227], v[60:63], a[64:67], v[224:227]
  ds_read_b64_tr_b16 v[68:69], v11 offset:53248
  v_mfma_f32_16x16x32_bf16 v[224:227], v[64:67], a[80:83], v[224:227]
  ds_read_b64_tr_b16 v[70:71], v11 offset:55296
  v_mfma_f32_16x16x32_bf16 v[228:231], v[56:59], a[52:55], v[228:231]
  ds_read_b64_tr_b16 v[72:73], v11 offset:20480
  v_mfma_f32_16x16x32_bf16 v[228:231], v[60:63], a[68:71], v[228:231]
  ds_read_b64_tr_b16 v[74:75], v11 offset:22528
  v_mfma_f32_16x16x32_bf16 v[228:231], v[64:67], a[84:87], v[228:231]
  ds_read_b64_tr_b16 v[76:77], v11 offset:24576
  v_mfma_f32_16x16x32_bf16 v[232:235], v[56:59], a[56:59], v[232:235]
  ds_read_b64_tr_b16 v[78:79], v11 offset:26624
  v_mfma_f32_16x16x32_bf16 v[232:235], v[60:63], a[72:75], v[232:235]
  s_add_u32 m0, s33, 77824
  v_mfma_f32_16x16x32_bf16 v[232:235], v[64:67], a[88:91], v[232:235]
  s_mov_b32 s34, 256
  v_mfma_f32_16x16x32_bf16 v[236:239], v[56:59], a[60:63], v[236:239]
  buffer_load_dwordx4 v82, s[12:15], s34 offen lds
  v_mfma_f32_16x16x32_bf16 v[236:239], v[60:63], a[76:79], v[236:239]
  s_add_u32 m0, s33, 0
  v_mfma_f32_16x16x32_bf16 v[236:239], v[64:67], a[92:95], v[236:239]
  s_mov_b32 s34, 37120
  buffer_load_dwordx4 v82, s[12:15], s34 offen lds
  s_waitcnt lgkmcnt(0)
  v_mfma_f32_16x16x32_bf16 v[240:243], v[68:71], a[48:51], v[240:243]
  ds_read_b64_tr_b16 v[56:57], v10 offset:20480
  v_mfma_f32_16x16x32_bf16 v[240:243], v[72:75], a[64:67], v[240:243]
  ds_read_b64_tr_b16 v[58:59], v10 offset:22528
  v_mfma_f32_16x16x32_bf16 v[240:243], v[76:79], a[80:83], v[240:243]
  ds_read_b64_tr_b16 v[60:61], v9 offset:49152
  v_mfma_f32_16x16x32_bf16 v[244:247], v[68:71], a[52:55], v[244:247]
  ds_read_b64_tr_b16 v[62:63], v9 offset:51200
  v_mfma_f32_16x16x32_bf16 v[244:247], v[72:75], a[68:71], v[244:247]
  ds_read_b64_tr_b16 v[64:65], v8 offset:28672
  v_mfma_f32_16x16x32_bf16 v[244:247], v[76:79], a[84:87], v[244:247]
  ds_read_b64_tr_b16 v[66:67], v8 offset:30720
  v_mfma_f32_16x16x32_bf16 v[248:251], v[68:71], a[56:59], v[248:251]
  s_add_u32 m0, s33, 126976
  v_mfma_f32_16x16x32_bf16 v[248:251], v[72:75], a[72:75], v[248:251]
  s_mov_b32 s34, 73984
  v_mfma_f32_16x16x32_bf16 v[248:251], v[76:79], a[88:91], v[248:251]
  buffer_load_dwordx4 v82, s[12:15], s34 offen lds
  v_mfma_f32_16x16x32_bf16 v[252:255], v[68:71], a[60:63], v[252:255]
  s_add_u32 m0, s33, 131072
  v_mfma_f32_16x16x32_bf16 v[252:255], v[72:75], a[76:79], v[252:255]
  s_mov_b32 s34, 110848
  v_mfma_f32_16x16x32_bf16 v[252:255], v[76:79], a[92:95], v[252:255]
  buffer_load_dwordx4 v82, s[12:15], s34 offen lds
  s_waitcnt lgkmcnt(0)
  v_mfma_f32_16x16x32_bf16 v[192:195], v[56:59], a[240:243], v[192:195]
  ds_read_b64_tr_b16 v[68:69], v13 offset:20480
  v_mfma_f32_16x16x32_bf16 v[192:195], v[60:63], v[96:99], v[192:195]
  ds_read_b64_tr_b16 v[70:71], v13 offset:22528
  s_waitcnt vmcnt(14)
  v_mfma_f32_16x16x32_bf16 v[192:195], v[64:67], v[112:115], v[192:195]
  ds_read_b64_tr_b16 v[72:73], v12 offset:49152
  v_mfma_f32_16x16x32_bf16 v[196:199], v[56:59], a[244:247], v[196:199]
  ds_read_b64_tr_b16 v[74:75], v12 offset:51200
  v_mfma_f32_16x16x32_bf16 v[196:199], v[60:63], v[100:103], v[196:199]
  ds_read_b64_tr_b16 v[76:77], v11 offset:28672
  s_waitcnt vmcnt(12)
  v_mfma_f32_16x16x32_bf16 v[196:199], v[64:67], v[116:119], v[196:199]
  ds_read_b64_tr_b16 v[78:79], v11 offset:30720
  v_mfma_f32_16x16x32_bf16 v[200:203], v[56:59], a[248:251], v[200:203]
  s_add_u32 m0, s33, 90112
  v_mfma_f32_16x16x32_bf16 v[200:203], v[60:63], v[104:107], v[200:203]
  s_mov_b32 s34, 147712
  s_waitcnt vmcnt(9)
  v_mfma_f32_16x16x32_bf16 v[200:203], v[64:67], v[120:123], v[200:203]
  buffer_load_dwordx4 v82, s[12:15], s34 offen lds
  v_mfma_f32_16x16x32_bf16 v[204:207], v[56:59], a[252:255], v[204:207]
  s_add_u32 m0, s33, 94208
  v_mfma_f32_16x16x32_bf16 v[204:207], v[60:63], v[108:111], v[204:207]
  s_mov_b32 s34, 184576
  s_waitcnt vmcnt(8)
  v_mfma_f32_16x16x32_bf16 v[204:207], v[64:67], v[124:127], v[204:207]
  buffer_load_dwordx4 v82, s[12:15], s34 offen lds
  s_waitcnt lgkmcnt(0)
  v_mfma_f32_16x16x32_bf16 v[208:211], v[68:71], a[240:243], v[208:211]
  s_barrier
  v_mfma_f32_16x16x32_bf16 v[208:211], v[72:75], v[96:99], v[208:211]
  ds_read_b64_tr_b16 v[56:57], v10 offset:24576
  v_mfma_f32_16x16x32_bf16 v[208:211], v[76:79], v[112:115], v[208:211]
  ds_read_b64_tr_b16 v[58:59], v10 offset:26624
  v_mfma_f32_16x16x32_bf16 v[212:215], v[68:71], a[244:247], v[212:215]
  ds_read_b64_tr_b16 v[60:61], v9 offset:53248
  v_mfma_f32_16x16x32_bf16 v[212:215], v[72:75], v[100:103], v[212:215]
  ds_read_b64_tr_b16 v[62:63], v9 offset:55296
  v_mfma_f32_16x16x32_bf16 v[212:215], v[76:79], v[116:119], v[212:215]
  ds_read_b64_tr_b16 v[64:65], v10 offset:28672
  v_mfma_f32_16x16x32_bf16 v[216:219], v[68:71], a[248:251], v[216:219]
  ds_read_b64_tr_b16 v[66:67], v10 offset:30720
  v_mfma_f32_16x16x32_bf16 v[216:219], v[72:75], v[104:107], v[216:219]
  s_add_u32 m0, s33, 135168
  v_mfma_f32_16x16x32_bf16 v[216:219], v[76:79], v[120:123], v[216:219]
  s_mov_b32 s34, 221440
  v_mfma_f32_16x16x32_bf16 v[220:223], v[68:71], a[252:255], v[220:223]
  buffer_load_dwordx4 v82, s[12:15], s34 offen lds
  v_mfma_f32_16x16x32_bf16 v[220:223], v[72:75], v[108:111], v[220:223]
  s_add_u32 m0, s33, 98304
  v_mfma_f32_16x16x32_bf16 v[220:223], v[76:79], v[124:127], v[220:223]
  s_mov_b32 s34, 258304
  buffer_load_dwordx4 v82, s[12:15], s34 offen lds
  s_waitcnt lgkmcnt(0)
  v_mfma_f32_16x16x32_bf16 v[224:227], v[56:59], a[96:99], v[224:227]
  ds_read_b64_tr_b16 v[68:69], v13 offset:24576
  v_mfma_f32_16x16x32_bf16 v[224:227], v[60:63], a[112:115], v[224:227]
  ds_read_b64_tr_b16 v[70:71], v13 offset:26624
  v_cvt_pk_bf16_f32 v40, v192, v193
  v_mfma_f32_16x16x32_bf16 v[224:227], v[64:67], a[128:131], v[224:227]
  ds_read_b64_tr_b16 v[72:73], v12 offset:53248
  v_cvt_pk_bf16_f32 v41, v194, v195
  v_mfma_f32_16x16x32_bf16 v[228:231], v[56:59], a[100:103], v[228:231]
  ds_read_b64_tr_b16 v[74:75], v12 offset:55296
  v_cvt_pk_bf16_f32 v42, v208, v209
  v_mfma_f32_16x16x32_bf16 v[228:231], v[60:63], a[116:119], v[228:231]
  ds_read_b64_tr_b16 v[76:77], v13 offset:28672
  v_cvt_pk_bf16_f32 v43, v210, v211
  v_mfma_f32_16x16x32_bf16 v[228:231], v[64:67], a[132:135], v[228:231]
  ds_read_b64_tr_b16 v[78:79], v13 offset:30720
  s_mov_b32 s35, 0
  v_mfma_f32_16x16x32_bf16 v[232:235], v[56:59], a[104:107], v[232:235]
  s_add_u32 m0, s33, 4096
  buffer_store_dwordx4 v[40:43], v191, s[20:23], s35 offen sc1
  v_mfma_f32_16x16x32_bf16 v[232:235], v[60:63], a[120:123], v[232:235]
  s_mov_b32 s34, 256
  v_cvt_pk_bf16_f32 v44, v196, v197
  v_mfma_f32_16x16x32_bf16 v[232:235], v[64:67], a[136:139], v[232:235]
  buffer_load_dwordx4 v83, s[12:15], s34 offen lds
  v_cvt_pk_bf16_f32 v45, v198, v199
  v_mfma_f32_16x16x32_bf16 v[236:239], v[56:59], a[108:111], v[236:239]
  s_add_u32 m0, s33, 81920
  v_cvt_pk_bf16_f32 v46, v212, v213
  v_mfma_f32_16x16x32_bf16 v[236:239], v[60:63], a[124:127], v[236:239]
  s_mov_b32 s34, 256
  v_cvt_pk_bf16_f32 v47, v214, v215
  v_mfma_f32_16x16x32_bf16 v[236:239], v[64:67], a[140:143], v[236:239]
  buffer_load_dwordx4 v84, s[12:15], s34 offen lds
  s_waitcnt lgkmcnt(0)
  v_mfma_f32_16x16x32_bf16 v[240:243], v[68:71], a[96:99], v[240:243]
  ds_read_b64_tr_b16 v[56:57], v9 offset:57344
  v_cvt_pk_bf16_f32 v48, v200, v201
  v_mfma_f32_16x16x32_bf16 v[240:243], v[72:75], a[112:115], v[240:243]
  ds_read_b64_tr_b16 v[58:59], v9 offset:59392
  v_cvt_pk_bf16_f32 v49, v202, v203
  v_mfma_f32_16x16x32_bf16 v[240:243], v[76:79], a[128:131], v[240:243]
  ds_read_b64_tr_b16 v[60:61], v8 offset:32768
  v_cvt_pk_bf16_f32 v50, v216, v217
  v_mfma_f32_16x16x32_bf16 v[244:247], v[68:71], a[100:103], v[244:247]
  ds_read_b64_tr_b16 v[62:63], v8 offset:34816
  v_cvt_pk_bf16_f32 v51, v218, v219
  v_mfma_f32_16x16x32_bf16 v[244:247], v[72:75], a[116:119], v[244:247]
  ds_read_b64_tr_b16 v[64:65], v8 offset:36864
  v_cvt_pk_bf16_f32 v52, v204, v205
  v_mfma_f32_16x16x32_bf16 v[244:247], v[76:79], a[132:135], v[244:247]
  ds_read_b64_tr_b16 v[66:67], v8 offset:38912
  v_cvt_pk_bf16_f32 v53, v206, v207
  v_mfma_f32_16x16x32_bf16 v[248:251], v[68:71], a[104:107], v[248:251]
  s_add_u32 m0, s33, 86016
  v_cvt_pk_bf16_f32 v54, v220, v221
  v_mfma_f32_16x16x32_bf16 v[248:251], v[72:75], a[120:123], v[248:251]
  s_mov_b32 s34, 37120
  v_cvt_pk_bf16_f32 v55, v222, v223
  v_mfma_f32_16x16x32_bf16 v[248:251], v[76:79], a[136:139], v[248:251]
  buffer_load_dwordx4 v84, s[12:15], s34 offen lds
  v_mfma_f32_16x16x32_bf16 v[252:255], v[68:71], a[108:111], v[252:255]
  s_add_u32 m0, s33, 8192
  v_mfma_f32_16x16x32_bf16 v[252:255], v[72:75], a[124:127], v[252:255]
  s_mov_b32 s34, 73984
  v_mfma_f32_16x16x32_bf16 v[252:255], v[76:79], a[140:143], v[252:255]
  buffer_load_dwordx4 v84, s[12:15], s34 offen lds
  s_waitcnt lgkmcnt(0)
  v_mfma_f32_16x16x32_bf16 v[224:227], v[56:59], a[144:147], v[224:227]
  s_barrier
  v_mfma_f32_16x16x32_bf16 v[224:227], v[60:63], a[160:163], v[224:227]
  ds_read_b64_tr_b16 v[68:69], v12 offset:57344
  v_mfma_f32_16x16x32_bf16 v[224:227], v[64:67], a[176:179], v[224:227]
  ds_read_b64_tr_b16 v[70:71], v12 offset:59392
  v_mfma_f32_16x16x32_bf16 v[228:231], v[56:59], a[148:151], v[228:231]
  ds_read_b64_tr_b16 v[72:73], v11 offset:32768
  v_mfma_f32_16x16x32_bf16 v[228:231], v[60:63], a[164:167], v[228:231]
  ds_read_b64_tr_b16 v[74:75], v11 offset:34816
  v_mfma_f32_16x16x32_bf16 v[228:231], v[64:67], a[180:183], v[228:231]
  ds_read_b64_tr_b16 v[76:77], v11 offset:36864
  v_mfma_f32_16x16x32_bf16 v[232:235], v[56:59], a[152:155], v[232:235]
  ds_read_b64_tr_b16 v[78:79], v11 offset:38912
  v_mfma_f32_16x16x32_bf16 v[232:235], v[60:63], a[168:171], v[232:235]
  s_add_u32 m0, s33, 139264
  s_mov_b32 s35, 18432
  v_mfma_f32_16x16x32_bf16 v[232:235], v[64:67], a[184:187], v[232:235]
  s_mov_b32 s34, 110848
  buffer_store_dwordx4 v[44:47], v191, s[20:23], s35 offen sc1
  v_mfma_f32_16x16x32_bf16 v[236:239], v[56:59], a[156:159], v[236:239]
  buffer_load_dwordx4 v84, s[12:15], s34 offen lds
  v_mfma_f32_16x16x32_bf16 v[236:239], v[60:63], a[172:175], v[236:239]
  s_add_u32 m0, s33, 102400
  v_mfma_f32_16x16x32_bf16 v[236:239], v[64:67], a[188:191], v[236:239]
  s_mov_b32 s34, 147712
  buffer_load_dwordx4 v84, s[12:15], s34 offen lds
  s_waitcnt lgkmcnt(0)
  v_mfma_f32_16x16x32_bf16 v[240:243], v[68:71], a[144:147], v[240:243]
  ds_read_b64_tr_b16 v[56:57], v8 offset:40960
  v_mfma_f32_16x16x32_bf16 v[240:243], v[72:75], a[160:163], v[240:243]
  ds_read_b64_tr_b16 v[58:59], v8 offset:43008
  v_mfma_f32_16x16x32_bf16 v[240:243], v[76:79], a[176:179], v[240:243]
  ds_read_b64_tr_b16 v[60:61], v9
  v_mfma_f32_16x16x32_bf16 v[244:247], v[68:71], a[148:151], v[244:247]
  ds_read_b64_tr_b16 v[62:63], v9 offset:2048
  v_mfma_f32_16x16x32_bf16 v[244:247], v[72:75], a[164:167], v[244:247]
  ds_read_b64_tr_b16 v[64:65], v9 offset:4096
  v_mfma_f32_16x16x32_bf16 v[244:247], v[76:79], a[180:183], v[244:247]
  ds_read_b64_tr_b16 v[66:67], v9 offset:6144
  v_mfma_f32_16x16x32_bf16 v[248:251], v[68:71], a[152:155], v[248:251]
  s_add_u32 m0, s33, 143360
  v_mfma_f32_16x16x32_bf16 v[248:251], v[72:75], a[168:171], v[248:251]
  s_mov_b32 s34, 184576
  v_mfma_f32_16x16x32_bf16 v[248:251], v[76:79], a[184:187], v[248:251]
  buffer_load_dwordx4 v84, s[12:15], s34 offen lds
  s_mov_b32 s35, 36864
  v_mfma_f32_16x16x32_bf16 v[252:255], v[68:71], a[156:159], v[252:255]
  s_add_u32 m0, s33, 147456
  buffer_store_dwordx4 v[48:51], v191, s[20:23], s35 offen sc1
  v_mfma_f32_16x16x32_bf16 v[252:255], v[72:75], a[172:175], v[252:255]
  s_mov_b32 s34, 221440
  v_mfma_f32_16x16x32_bf16 v[252:255], v[76:79], a[188:191], v[252:255]
  buffer_load_dwordx4 v84, s[12:15], s34 offen lds
  s_waitcnt lgkmcnt(0)
  v_mfma_f32_16x16x32_bf16 v[224:227], v[56:59], a[192:195], v[224:227]
  ds_read_b64_tr_b16 v[68:69], v11 offset:40960
  v_mfma_f32_16x16x32_bf16 v[224:227], v[60:63], a[208:211], v[224:227]
  ds_read_b64_tr_b16 v[70:71], v11 offset:43008
  v_mfma_f32_16x16x32_bf16 v[224:227], v[64:67], a[224:227], v[224:227]
  ds_read_b64_tr_b16 v[72:73], v12
  v_mfma_f32_16x16x32_bf16 v[228:231], v[56:59], a[196:199], v[228:231]
  ds_read_b64_tr_b16 v[74:75], v12 offset:2048
  v_mfma_f32_16x16x32_bf16 v[228:231], v[60:63], a[212:215], v[228:231]
  ds_read_b64_tr_b16 v[76:77], v12 offset:4096
  v_mfma_f32_16x16x32_bf16 v[228:231], v[64:67], a[228:231], v[228:231]
  ds_read_b64_tr_b16 v[78:79], v12 offset:6144
  v_mfma_f32_16x16x32_bf16 v[232:235], v[56:59], a[200:203], v[232:235]
  s_add_u32 m0, s33, 106496
  v_mfma_f32_16x16x32_bf16 v[232:235], v[60:63], a[216:219], v[232:235]
  s_mov_b32 s34, 258304
  v_mfma_f32_16x16x32_bf16 v[232:235], v[64:67], a[232:235], v[232:235]
  buffer_load_dwordx4 v84, s[12:15], s34 offen lds
  v_mfma_f32_16x16x32_bf16 v[236:239], v[56:59], a[204:207], v[236:239]
  s_add_u32 m0, s33, 110592
  s_mov_b32 s35, 55296
  v_mfma_f32_16x16x32_bf16 v[236:239], v[60:63], a[220:223], v[236:239]
  s_mov_b32 s34, 256
  buffer_store_dwordx4 v[52:55], v191, s[20:23], s35 offen sc1
  v_mfma_f32_16x16x32_bf16 v[236:239], v[64:67], a[236:239], v[236:239]
  buffer_load_dwordx4 v85, s[12:15], s34 offen lds
  s_waitcnt lgkmcnt(0)
  v_mfma_f32_16x16x32_bf16 v[240:243], v[68:71], a[192:195], v[240:243]
  s_waitcnt vmcnt(19)
  s_barrier
  v_mfma_f32_16x16x32_bf16 v[240:243], v[72:75], a[208:211], v[240:243]
  ds_read_b64_tr_b16 v[56:57], v9 offset:8192
  v_mfma_f32_16x16x32_bf16 v[240:243], v[76:79], a[224:227], v[240:243]
  ds_read_b64_tr_b16 v[58:59], v9 offset:10240
  v_mfma_f32_16x16x32_bf16 v[244:247], v[68:71], a[196:199], v[244:247]
  ds_read_b64_tr_b16 v[60:61], v8 offset:57344
  v_mfma_f32_16x16x32_bf16 v[244:247], v[72:75], a[212:215], v[244:247]
  ds_read_b64_tr_b16 v[62:63], v8 offset:59392
  v_mfma_f32_16x16x32_bf16 v[244:247], v[76:79], a[228:231], v[244:247]
  ds_read_b64_tr_b16 v[64:65], v8 offset:61440
  v_mfma_f32_16x16x32_bf16 v[248:251], v[68:71], a[200:203], v[248:251]
  ds_read_b64_tr_b16 v[66:67], v8 offset:63488
  v_mfma_f32_16x16x32_bf16 v[248:251], v[72:75], a[216:219], v[248:251]
  s_add_u32 m0, s33, 12288
  v_mfma_f32_16x16x32_bf16 v[248:251], v[76:79], a[232:235], v[248:251]
  s_mov_b32 s34, 384
  v_mfma_f32_16x16x32_bf16 v[252:255], v[68:71], a[204:207], v[252:255]
  buffer_load_dwordx4 v82, s[12:15], s34 offen lds
  v_mfma_f32_16x16x32_bf16 v[252:255], v[72:75], a[220:223], v[252:255]
  s_add_u32 m0, s33, 16384
  v_mfma_f32_16x16x32_bf16 v[252:255], v[76:79], a[236:239], v[252:255]
  s_mov_b32 s34, 37248
  buffer_load_dwordx4 v82, s[12:15], s34 offen lds
  s_waitcnt lgkmcnt(0)
  v_mfma_f32_16x16x32_bf16 v[224:227], v[56:59], a[240:243], v[224:227]
  ds_read_b64_tr_b16 v[68:69], v12 offset:8192
  v_mfma_f32_16x16x32_bf16 v[224:227], v[60:63], v[96:99], v[224:227]
  ds_read_b64_tr_b16 v[70:71], v12 offset:10240
  v_mfma_f32_16x16x32_bf16 v[224:227], v[64:67], v[112:115], v[224:227]
  ds_read_b64_tr_b16 v[72:73], v11 offset:57344
  v_mfma_f32_16x16x32_bf16 v[228:231], v[56:59], a[244:247], v[228:231]
  ds_read_b64_tr_b16 v[74:75], v11 offset:59392
  v_mfma_f32_16x16x32_bf16 v[228:231], v[60:63], v[100:103], v[228:231]
  ds_read_b64_tr_b16 v[76:77], v11 offset:61440
  v_mfma_f32_16x16x32_bf16 v[228:231], v[64:67], v[116:119], v[228:231]
  ds_read_b64_tr_b16 v[78:79], v11 offset:63488
  v_mfma_f32_16x16x32_bf16 v[232:235], v[56:59], a[248:251], v[232:235]
  s_add_u32 m0, s33, 45056
  v_mfma_f32_16x16x32_bf16 v[232:235], v[60:63], v[104:107], v[232:235]
  s_mov_b32 s34, 74112
  v_mfma_f32_16x16x32_bf16 v[232:235], v[64:67], v[120:123], v[232:235]
  buffer_load_dwordx4 v82, s[12:15], s34 offen lds
  v_mfma_f32_16x16x32_bf16 v[236:239], v[56:59], a[252:255], v[236:239]
  v_mfma_f32_16x16x32_bf16 v[236:239], v[60:63], v[108:111], v[236:239]
  v_mfma_f32_16x16x32_bf16 v[236:239], v[64:67], v[124:127], v[236:239]
  s_waitcnt lgkmcnt(0)
  v_mfma_f32_16x16x32_bf16 v[240:243], v[68:71], a[240:243], v[240:243]
  ds_read_b64_tr_b16 v[56:57], v9 offset:12288
  v_mfma_f32_16x16x32_bf16 v[240:243], v[72:75], v[96:99], v[240:243]
  ds_read_b64_tr_b16 v[58:59], v9 offset:14336
  v_mfma_f32_16x16x32_bf16 v[240:243], v[76:79], v[112:115], v[240:243]
  ds_read_b64_tr_b16 v[60:61], v8
  v_mfma_f32_16x16x32_bf16 v[244:247], v[68:71], a[244:247], v[244:247]
  ds_read_b64_tr_b16 v[62:63], v8 offset:2048
  v_mfma_f32_16x16x32_bf16 v[244:247], v[72:75], v[100:103], v[244:247]
  ds_read_b64_tr_b16 v[64:65], v9 offset:61440
  v_mfma_f32_16x16x32_bf16 v[244:247], v[76:79], v[116:119], v[244:247]
  ds_read_b64_tr_b16 v[66:67], v9 offset:63488
  v_mfma_f32_16x16x32_bf16 v[248:251], v[68:71], a[248:251], v[248:251]
  s_add_u32 m0, s33, 49152
  v_mfma_f32_16x16x32_bf16 v[248:251], v[72:75], v[104:107], v[248:251]
  s_mov_b32 s34, 110976
  v_mfma_f32_16x16x32_bf16 v[248:251], v[76:79], v[120:123], v[248:251]
  buffer_load_dwordx4 v82, s[12:15], s34 offen lds
  v_mfma_f32_16x16x32_bf16 v[252:255], v[68:71], a[252:255], v[252:255]
  s_add_u32 m0, s33, 53248
  v_mfma_f32_16x16x32_bf16 v[252:255], v[72:75], v[108:111], v[252:255]
  s_mov_b32 s34, 147840
  v_mfma_f32_16x16x32_bf16 v[252:255], v[76:79], v[124:127], v[252:255]
  buffer_load_dwordx4 v82, s[12:15], s34 offen lds
  s_waitcnt lgkmcnt(0)
  v_mfma_f32_16x16x32_bf16 v[192:195], v[56:59], a[0:3], 0
  s_waitcnt vmcnt(21)
  s_barrier
  v_mfma_f32_16x16x32_bf16 v[192:195], v[60:63], a[16:19], v[192:195]
  ds_read_b64_tr_b16 v[68:69], v12 offset:12288
  v_cvt_pk_bf16_f32 v40, v224, v225
  v_mfma_f32_16x16x32_bf16 v[192:195], v[64:67], a[32:35], v[192:195]
  ds_read_b64_tr_b16 v[70:71], v12 offset:14336
  v_cvt_pk_bf16_f32 v41, v226, v227
  v_mfma_f32_16x16x32_bf16 v[196:199], v[56:59], a[4:7], 0
  ds_read_b64_tr_b16 v[72:73], v11
  v_cvt_pk_bf16_f32 v42, v240, v241
  v_mfma_f32_16x16x32_bf16 v[196:199], v[60:63], a[20:23], v[196:199]
  ds_read_b64_tr_b16 v[74:75], v11 offset:2048
  v_cvt_pk_bf16_f32 v43, v242, v243
  v_mfma_f32_16x16x32_bf16 v[196:199], v[64:67], a[36:39], v[196:199]
  ds_read_b64_tr_b16 v[76:77], v12 offset:61440
  s_mov_b32 s35, 2048
  v_mfma_f32_16x16x32_bf16 v[200:203], v[56:59], a[8:11], 0
  ds_read_b64_tr_b16 v[78:79], v12 offset:63488
  buffer_store_dwordx4 v[40:43], v191, s[20:23], s35 offen sc1
  v_mfma_f32_16x16x32_bf16 v[200:203], v[60:63], a[24:27], v[200:203]
  s_add_u32 m0, s33, 20480
  v_cvt_pk_bf16_f32 v44, v228, v229
  v_mfma_f32_16x16x32_bf16 v[200:203], v[64:67], a[40:43], v[200:203]
  s_mov_b32 s34, 184704
  v_cvt_pk_bf16_f32 v45, v230, v231
  v_mfma_f32_16x16x32_bf16 v[204:207], v[56:59], a[12:15], 0
  buffer_load_dwordx4 v82, s[12:15], s34 offen lds
  v_cvt_pk_bf16_f32 v46, v244, v245
  v_mfma_f32_16x16x32_bf16 v[204:207], v[60:63], a[28:31], v[204:207]
  v_cvt_pk_bf16_f32 v47, v246, v247
  v_cvt_pk_bf16_f32 v48, v232, v233
  v_mfma_f32_16x16x32_bf16 v[204:207], v[64:67], a[44:47], v[204:207]
  v_cvt_pk_bf16_f32 v49, v234, v235
  s_waitcnt lgkmcnt(0)
  v_mfma_f32_16x16x32_bf16 v[208:211], v[68:71], a[0:3], 0
  s_waitcnt vmcnt(8)
  s_barrier
  s_mov_b32 s63, 262144
  v_mov_b32 v190, 1
  buffer_store_dword v190, v29, s[96:99], s63 offen sc1
  ds_read_b64_tr_b16 v[56:57], v10
  v_mfma_f32_16x16x32_bf16 v[208:211], v[72:75], a[16:19], v[208:211]
  ds_read_b64_tr_b16 v[58:59], v10 offset:2048
  v_cvt_pk_bf16_f32 v50, v248, v249
  v_mfma_f32_16x16x32_bf16 v[208:211], v[76:79], a[32:35], v[208:211]
  ds_read_b64_tr_b16 v[60:61], v9 offset:24576
  v_cvt_pk_bf16_f32 v51, v250, v251
  v_mfma_f32_16x16x32_bf16 v[212:215], v[68:71], a[4:7], 0
  ds_read_b64_tr_b16 v[62:63], v9 offset:26624
  v_cvt_pk_bf16_f32 v52, v236, v237
  v_mfma_f32_16x16x32_bf16 v[212:215], v[72:75], a[20:23], v[212:215]
  ds_read_b64_tr_b16 v[64:65], v9 offset:28672
  v_cvt_pk_bf16_f32 v53, v238, v239
  v_mfma_f32_16x16x32_bf16 v[212:215], v[76:79], a[36:39], v[212:215]
  ds_read_b64_tr_b16 v[66:67], v9 offset:30720
  v_cvt_pk_bf16_f32 v54, v252, v253
  v_mfma_f32_16x16x32_bf16 v[216:219], v[68:71], a[8:11], 0
  s_add_u32 m0, s33, 24576
  v_cvt_pk_bf16_f32 v55, v254, v255
  v_mfma_f32_16x16x32_bf16 v[216:219], v[72:75], a[24:27], v[216:219]
  s_mov_b32 s34, 221568
  v_mfma_f32_16x16x32_bf16 v[216:219], v[76:79], a[40:43], v[216:219]
  buffer_load_dwordx4 v82, s[12:15], s34 offen lds
  v_mfma_f32_16x16x32_bf16 v[220:223], v[68:71], a[12:15], 0
  s_add_u32 m0, s33, 151552
  v_mfma_f32_16x16x32_bf16 v[220:223], v[72:75], a[28:31], v[220:223]
  s_mov_b32 s34, 258432
  v_mfma_f32_16x16x32_bf16 v[220:223], v[76:79], a[44:47], v[220:223]
  buffer_load_dwordx4 v82, s[12:15], s34 offen lds
  s_waitcnt lgkmcnt(0)
  v_mfma_f32_16x16x32_bf16 v[192:195], v[56:59], a[48:51], v[192:195]
  ds_read_b64_tr_b16 v[68:69], v13
  v_mfma_f32_16x16x32_bf16 v[192:195], v[60:63], a[64:67], v[192:195]
  ds_read_b64_tr_b16 v[70:71], v13 offset:2048
  v_mfma_f32_16x16x32_bf16 v[192:195], v[64:67], a[80:83], v[192:195]
  ds_read_b64_tr_b16 v[72:73], v12 offset:24576
  v_mfma_f32_16x16x32_bf16 v[196:199], v[56:59], a[52:55], v[196:199]
  ds_read_b64_tr_b16 v[74:75], v12 offset:26624
  v_mfma_f32_16x16x32_bf16 v[196:199], v[60:63], a[68:71], v[196:199]
  ds_read_b64_tr_b16 v[76:77], v12 offset:28672
  v_mfma_f32_16x16x32_bf16 v[196:199], v[64:67], a[84:87], v[196:199]
  ds_read_b64_tr_b16 v[78:79], v12 offset:30720
  v_mfma_f32_16x16x32_bf16 v[200:203], v[56:59], a[56:59], v[200:203]
  s_add_u32 m0, s33, 114688
  s_mov_b32 s35, 20480
  v_mfma_f32_16x16x32_bf16 v[200:203], v[60:63], a[72:75], v[200:203]
  s_mov_b32 s34, 384
  buffer_store_dwordx4 v[44:47], v191, s[20:23], s35 offen sc1
  v_mfma_f32_16x16x32_bf16 v[200:203], v[64:67], a[88:91], v[200:203]
  buffer_load_dwordx4 v83, s[12:15], s34 offen lds
  v_mfma_f32_16x16x32_bf16 v[204:207], v[56:59], a[60:63], v[204:207]
  v_mfma_f32_16x16x32_bf16 v[204:207], v[60:63], a[76:79], v[204:207]
  v_mfma_f32_16x16x32_bf16 v[204:207], v[64:67], a[92:95], v[204:207]
  s_waitcnt lgkmcnt(0)
  v_mfma_f32_16x16x32_bf16 v[208:211], v[68:71], a[48:51], v[208:211]
  s_barrier
  v_mfma_f32_16x16x32_bf16 v[208:211], v[72:75], a[64:67], v[208:211]
  ds_read_b64_tr_b16 v[56:57], v10 offset:4096
  v_mfma_f32_16x16x32_bf16 v[208:211], v[76:79], a[80:83], v[208:211]
  ds_read_b64_tr_b16 v[58:59], v10 offset:6144
  v_mfma_f32_16x16x32_bf16 v[212:215], v[68:71], a[52:55], v[212:215]
  ds_read_b64_tr_b16 v[60:61], v9 offset:32768
  v_mfma_f32_16x16x32_bf16 v[212:215], v[72:75], a[68:71], v[212:215]
  ds_read_b64_tr_b16 v[62:63], v9 offset:34816
  v_mfma_f32_16x16x32_bf16 v[212:215], v[76:79], a[84:87], v[212:215]
  ds_read_b64_tr_b16 v[64:65], v8 offset:4096
  v_mfma_f32_16x16x32_bf16 v[216:219], v[68:71], a[56:59], v[216:219]
  ds_read_b64_tr_b16 v[66:67], v8 offset:6144
  v_mfma_f32_16x16x32_bf16 v[216:219], v[72:75], a[72:75], v[216:219]
  s_add_u32 m0, s33, 155648
  s_mov_b32 s35, 38912
  v_mfma_f32_16x16x32_bf16 v[216:219], v[76:79], a[88:91], v[216:219]
  s_mov_b32 s34, 384
  buffer_store_dwordx4 v[48:51], v191, s[20:23], s35 offen sc1
  v_mfma_f32_16x16x32_bf16 v[220:223], v[68:71], a[60:63], v[220:223]
  buffer_load_dwordx4 v84, s[12:15], s34 offen lds
  v_mfma_f32_16x16x32_bf16 v[220:223], v[72:75], a[76:79], v[220:223]
  s_add_u32 m0, s33, 118784
  v_mfma_f32_16x16x32_bf16 v[220:223], v[76:79], a[92:95], v[220:223]
  s_mov_b32 s34, 37248
  buffer_load_dwordx4 v84, s[12:15], s34 offen lds
  s_waitcnt lgkmcnt(0)
  v_mfma_f32_16x16x32_bf16 v[192:195], v[56:59], a[96:99], v[192:195]
  ds_read_b64_tr_b16 v[68:69], v13 offset:4096
  v_mfma_f32_16x16x32_bf16 v[192:195], v[60:63], a[112:115], v[192:195]
  ds_read_b64_tr_b16 v[70:71], v13 offset:6144
  v_mfma_f32_16x16x32_bf16 v[192:195], v[64:67], a[128:131], v[192:195]
  ds_read_b64_tr_b16 v[72:73], v12 offset:32768
  v_mfma_f32_16x16x32_bf16 v[196:199], v[56:59], a[100:103], v[196:199]
  ds_read_b64_tr_b16 v[74:75], v12 offset:34816
  v_mfma_f32_16x16x32_bf16 v[196:199], v[60:63], a[116:119], v[196:199]
  ds_read_b64_tr_b16 v[76:77], v11 offset:4096
  v_mfma_f32_16x16x32_bf16 v[196:199], v[64:67], a[132:135], v[196:199]
  ds_read_b64_tr_b16 v[78:79], v11 offset:6144
  v_mfma_f32_16x16x32_bf16 v[200:203], v[56:59], a[104:107], v[200:203]
  s_add_u32 m0, s33, 159744
  v_mfma_f32_16x16x32_bf16 v[200:203], v[60:63], a[120:123], v[200:203]
  s_mov_b32 s34, 74112
  v_mfma_f32_16x16x32_bf16 v[200:203], v[64:67], a[136:139], v[200:203]
  buffer_load_dwordx4 v84, s[12:15], s34 offen lds
  s_mov_b32 s35, 57344
  v_mfma_f32_16x16x32_bf16 v[204:207], v[56:59], a[108:111], v[204:207]
  buffer_store_dwordx4 v[52:55], v191, s[20:23], s35 offen sc1
  v_mfma_f32_16x16x32_bf16 v[204:207], v[60:63], a[124:127], v[204:207]
  v_mfma_f32_16x16x32_bf16 v[204:207], v[64:67], a[140:143], v[204:207]
  s_waitcnt lgkmcnt(0)
  v_mfma_f32_16x16x32_bf16 v[208:211], v[68:71], a[96:99], v[208:211]
  ds_read_b64_tr_b16 v[56:57], v9 offset:16384
  v_mfma_f32_16x16x32_bf16 v[208:211], v[72:75], a[112:115], v[208:211]
  ds_read_b64_tr_b16 v[58:59], v9 offset:18432
  s_mov_b32 s63, 262144
  buffer_load_dword v31, v30, s[96:99], s63 offen sc1
  v_mfma_f32_16x16x32_bf16 v[208:211], v[76:79], a[128:131], v[208:211]
  ds_read_b64_tr_b16 v[60:61], v9 offset:20480
  v_mfma_f32_16x16x32_bf16 v[212:215], v[68:71], a[100:103], v[212:215]
  ds_read_b64_tr_b16 v[62:63], v9 offset:22528
  v_mfma_f32_16x16x32_bf16 v[212:215], v[72:75], a[116:119], v[212:215]
  ds_read_b64_tr_b16 v[64:65], v8 offset:8192
  v_mfma_f32_16x16x32_bf16 v[212:215], v[76:79], a[132:135], v[212:215]
  ds_read_b64_tr_b16 v[66:67], v8 offset:10240
  v_mfma_f32_16x16x32_bf16 v[216:219], v[68:71], a[104:107], v[216:219]
  s_add_u32 m0, s33, 122880
  v_mfma_f32_16x16x32_bf16 v[216:219], v[72:75], a[120:123], v[216:219]
  s_mov_b32 s34, 110976
  v_mfma_f32_16x16x32_bf16 v[216:219], v[76:79], a[136:139], v[216:219]
  buffer_load_dwordx4 v84, s[12:15], s34 offen lds
  v_mfma_f32_16x16x32_bf16 v[220:223], v[68:71], a[108:111], v[220:223]
  s_add_u32 m0, s33, 32768
  v_mfma_f32_16x16x32_bf16 v[220:223], v[72:75], a[124:127], v[220:223]
  s_mov_b32 s34, 147840
  v_mfma_f32_16x16x32_bf16 v[220:223], v[76:79], a[140:143], v[220:223]
  buffer_load_dwordx4 v84, s[12:15], s34 offen lds
  s_waitcnt lgkmcnt(0)
  v_mfma_f32_16x16x32_bf16 v[192:195], v[56:59], a[144:147], v[192:195]
  s_barrier
  v_mfma_f32_16x16x32_bf16 v[192:195], v[60:63], a[160:163], v[192:195]
  ds_read_b64_tr_b16 v[68:69], v12 offset:16384
  v_mfma_f32_16x16x32_bf16 v[192:195], v[64:67], a[176:179], v[192:195]
  ds_read_b64_tr_b16 v[70:71], v12 offset:18432
  v_mfma_f32_16x16x32_bf16 v[196:199], v[56:59], a[148:151], v[196:199]
  ds_read_b64_tr_b16 v[72:73], v12 offset:20480
  v_mfma_f32_16x16x32_bf16 v[196:199], v[60:63], a[164:167], v[196:199]
  ds_read_b64_tr_b16 v[74:75], v12 offset:22528
  v_mfma_f32_16x16x32_bf16 v[196:199], v[64:67], a[180:183], v[196:199]
  ds_read_b64_tr_b16 v[76:77], v11 offset:8192
  v_mfma_f32_16x16x32_bf16 v[200:203], v[56:59], a[152:155], v[200:203]
  ds_read_b64_tr_b16 v[78:79], v11 offset:10240
  v_mfma_f32_16x16x32_bf16 v[200:203], v[60:63], a[168:171], v[200:203]
  s_add_u32 m0, s33, 36864
  v_mfma_f32_16x16x32_bf16 v[200:203], v[64:67], a[184:187], v[200:203]
  s_mov_b32 s34, 184704
  v_mfma_f32_16x16x32_bf16 v[204:207], v[56:59], a[156:159], v[204:207]
  buffer_load_dwordx4 v84, s[12:15], s34 offen lds
  v_mfma_f32_16x16x32_bf16 v[204:207], v[60:63], a[172:175], v[204:207]
  v_mfma_f32_16x16x32_bf16 v[204:207], v[64:67], a[188:191], v[204:207]
  s_waitcnt lgkmcnt(0)
  v_mfma_f32_16x16x32_bf16 v[208:211], v[68:71], a[144:147], v[208:211]
  ds_read_b64_tr_b16 v[56:57], v10 offset:8192
  v_mfma_f32_16x16x32_bf16 v[208:211], v[72:75], a[160:163], v[208:211]
  ds_read_b64_tr_b16 v[58:59], v10 offset:10240
  v_mfma_f32_16x16x32_bf16 v[208:211], v[76:79], a[176:179], v[208:211]
  ds_read_b64_tr_b16 v[60:61], v9 offset:36864
  v_mfma_f32_16x16x32_bf16 v[212:215], v[68:71], a[148:151], v[212:215]
  ds_read_b64_tr_b16 v[62:63], v9 offset:38912
  v_mfma_f32_16x16x32_bf16 v[212:215], v[72:75], a[164:167], v[212:215]
  ds_read_b64_tr_b16 v[64:65], v10 offset:12288
  v_mfma_f32_16x16x32_bf16 v[212:215], v[76:79], a[180:183], v[212:215]
  ds_read_b64_tr_b16 v[66:67], v10 offset:14336
  v_mfma_f32_16x16x32_bf16 v[216:219], v[68:71], a[152:155], v[216:219]
  s_add_u32 m0, s33, 65536
  v_mfma_f32_16x16x32_bf16 v[216:219], v[72:75], a[168:171], v[216:219]
  s_mov_b32 s34, 221568
  v_mfma_f32_16x16x32_bf16 v[216:219], v[76:79], a[184:187], v[216:219]
  buffer_load_dwordx4 v84, s[12:15], s34 offen lds
  v_mfma_f32_16x16x32_bf16 v[220:223], v[68:71], a[156:159], v[220:223]
  s_add_u32 m0, s33, 69632
  v_mfma_f32_16x16x32_bf16 v[220:223], v[72:75], a[172:175], v[220:223]
  s_mov_b32 s34, 258432
  v_mfma_f32_16x16x32_bf16 v[220:223], v[76:79], a[188:191], v[220:223]
  buffer_load_dwordx4 v84, s[12:15], s34 offen lds
  s_waitcnt lgkmcnt(0)
  v_mfma_f32_16x16x32_bf16 v[192:195], v[56:59], a[192:195], v[192:195]
  ds_read_b64_tr_b16 v[68:69], v13 offset:8192
  v_mfma_f32_16x16x32_bf16 v[192:195], v[60:63], a[208:211], v[192:195]
  ds_read_b64_tr_b16 v[70:71], v13 offset:10240
  v_mfma_f32_16x16x32_bf16 v[192:195], v[64:67], a[224:227], v[192:195]
  ds_read_b64_tr_b16 v[72:73], v12 offset:36864
  v_mfma_f32_16x16x32_bf16 v[196:199], v[56:59], a[196:199], v[196:199]
  ds_read_b64_tr_b16 v[74:75], v12 offset:38912
  v_mfma_f32_16x16x32_bf16 v[196:199], v[60:63], a[212:215], v[196:199]
  ds_read_b64_tr_b16 v[76:77], v13 offset:12288
  v_mfma_f32_16x16x32_bf16 v[196:199], v[64:67], a[228:231], v[196:199]
  ds_read_b64_tr_b16 v[78:79], v13 offset:14336
  v_mfma_f32_16x16x32_bf16 v[200:203], v[56:59], a[200:203], v[200:203]
  s_add_u32 m0, s33, 73728
  v_mfma_f32_16x16x32_bf16 v[200:203], v[60:63], a[216:219], v[200:203]
  s_mov_b32 s34, 384
  v_mfma_f32_16x16x32_bf16 v[200:203], v[64:67], a[232:235], v[200:203]
  buffer_load_dwordx4 v85, s[12:15], s34 offen lds
  v_mfma_f32_16x16x32_bf16 v[204:207], v[56:59], a[204:207], v[204:207]
  v_mfma_f32_16x16x32_bf16 v[204:207], v[60:63], a[220:223], v[204:207]
  v_mfma_f32_16x16x32_bf16 v[204:207], v[64:67], a[236:239], v[204:207]
  s_waitcnt lgkmcnt(0)
  v_mfma_f32_16x16x32_bf16 v[208:211], v[68:71], a[192:195], v[208:211]
  s_waitcnt vmcnt(7)
  s_barrier
  s_mov_b32 s63, 294912
  v_mov_b32 v190, 1
  buffer_store_dword v190, v29, s[96:99], s63 offen sc1
  v_mfma_f32_16x16x32_bf16 v[208:211], v[72:75], a[208:211], v[208:211]
  ds_read_b64_tr_b16 v[56:57], v10 offset:16384
  s_waitcnt vmcnt(7)
  v_cmp_eq_u32 vcc, 0, v31
  s_cbranch_vccnz L_sp_20
L_bk_21:
  v_mfma_f32_16x16x32_bf16 v[208:211], v[76:79], a[224:227], v[208:211]
  ds_read_b64_tr_b16 v[58:59], v10 offset:18432
  s_mov_b32 s65, 0
  v_mfma_f32_16x16x32_bf16 v[212:215], v[68:71], a[196:199], v[212:215]
  ds_read_b64_tr_b16 v[60:61], v9 offset:40960
  buffer_load_dwordx4 v[128:131], v188, s[72:75], s65 offen sc1
  v_mfma_f32_16x16x32_bf16 v[212:215], v[72:75], a[212:215], v[212:215]
  ds_read_b64_tr_b16 v[62:63], v9 offset:43008
  v_mfma_f32_16x16x32_bf16 v[212:215], v[76:79], a[228:231], v[212:215]
  ds_read_b64_tr_b16 v[64:65], v9 offset:45056
  v_mfma_f32_16x16x32_bf16 v[216:219], v[68:71], a[200:203], v[216:219]
  ds_read_b64_tr_b16 v[66:67], v9 offset:47104
  v_mfma_f32_16x16x32_bf16 v[216:219], v[72:75], a[216:219], v[216:219]
  s_add_u32 m0, s33, 77824
  v_mfma_f32_16x16x32_bf16 v[216:219], v[76:79], a[232:235], v[216:219]
  s_mov_b32 s34, 0
  v_mfma_f32_16x16x32_bf16 v[220:223], v[68:71], a[204:207], v[220:223]
  buffer_load_dwordx4 v86, s[12:15], s34 offen lds
  s_mov_b32 s65, 9437184
  v_mfma_f32_16x16x32_bf16 v[220:223], v[72:75], a[220:223], v[220:223]
  s_add_u32 m0, s33, 126976
  buffer_load_dwordx4 v[132:135], v188, s[72:75], s65 offen sc1
  v_mfma_f32_16x16x32_bf16 v[220:223], v[76:79], a[236:239], v[220:223]
  s_mov_b32 s34, 36864
  buffer_load_dwordx4 v86, s[12:15], s34 offen lds
  s_waitcnt lgkmcnt(0)
  v_mfma_f32_16x16x32_bf16 v[192:195], v[56:59], a[240:243], v[192:195]
  ds_read_b64_tr_b16 v[68:69], v13 offset:16384
  v_mfma_f32_16x16x32_bf16 v[192:195], v[60:63], v[96:99], v[192:195]
  ds_read_b64_tr_b16 v[70:71], v13 offset:18432
  v_mfma_f32_16x16x32_bf16 v[192:195], v[64:67], v[112:115], v[192:195]
  ds_read_b64_tr_b16 v[72:73], v12 offset:40960
  v_mfma_f32_16x16x32_bf16 v[196:199], v[56:59], a[244:247], v[196:199]
  ds_read_b64_tr_b16 v[74:75], v12 offset:43008
  v_mfma_f32_16x16x32_bf16 v[196:199], v[60:63], v[100:103], v[196:199]
  ds_read_b64_tr_b16 v[76:77], v12 offset:45056
  s_mov_b32 s65, 10240
  v_mfma_f32_16x16x32_bf16 v[196:199], v[64:67], v[116:119], v[196:199]
  ds_read_b64_tr_b16 v[78:79], v12 offset:47104
  buffer_load_dwordx4 v[136:139], v188, s[72:75], s65 offen sc1
  v_mfma_f32_16x16x32_bf16 v[200:203], v[56:59], a[248:251], v[200:203]
  s_add_u32 m0, s33, 131072
  v_mfma_f32_16x16x32_bf16 v[200:203], v[60:63], v[104:107], v[200:203]
  s_mov_b32 s34, 73728
  v_mfma_f32_16x16x32_bf16 v[200:203], v[64:67], v[120:123], v[200:203]
  buffer_load_dwordx4 v86, s[12:15], s34 offen lds
  v_mfma_f32_16x16x32_bf16 v[204:207], v[56:59], a[252:255], v[204:207]
  v_mfma_f32_16x16x32_bf16 v[204:207], v[60:63], v[108:111], v[204:207]
  v_mfma_f32_16x16x32_bf16 v[204:207], v[64:67], v[124:127], v[204:207]
  s_mov_b32 s65, 9447424
  s_waitcnt lgkmcnt(0)
  v_mfma_f32_16x16x32_bf16 v[208:211], v[68:71], a[240:243], v[208:211]
  ds_read_b64_tr_b16 v[56:57], v8 offset:12288
  buffer_load_dwordx4 v[140:143], v188, s[72:75], s65 offen sc1
  v_mfma_f32_16x16x32_bf16 v[208:211], v[72:75], v[96:99], v[208:211]
  ds_read_b64_tr_b16 v[58:59], v8 offset:14336
  v_mfma_f32_16x16x32_bf16 v[208:211], v[76:79], v[112:115], v[208:211]
  ds_read_b64_tr_b16 v[60:61], v8 offset:16384
  v_mfma_f32_16x16x32_bf16 v[212:215], v[68:71], a[244:247], v[212:215]
  ds_read_b64_tr_b16 v[62:63], v8 offset:18432
  v_mfma_f32_16x16x32_bf16 v[212:215], v[72:75], v[100:103], v[212:215]
  ds_read_b64_tr_b16 v[64:65], v8 offset:45056
  v_mfma_f32_16x16x32_bf16 v[212:215], v[76:79], v[116:119], v[212:215]
  ds_read_b64_tr_b16 v[66:67], v8 offset:47104
  v_mfma_f32_16x16x32_bf16 v[216:219], v[68:71], a[248:251], v[216:219]
  s_add_u32 m0, s33, 90112
  v_mfma_f32_16x16x32_bf16 v[216:219], v[72:75], v[104:107], v[216:219]
  s_mov_b32 s34, 110592
  v_mfma_f32_16x16x32_bf16 v[216:219], v[76:79], v[120:123], v[216:219]
  buffer_load_dwordx4 v86, s[12:15], s34 offen lds
  v_mfma_f32_16x16x32_bf16 v[220:223], v[68:71], a[252:255], v[220:223]
  s_add_u32 m0, s33, 94208
  v_mfma_f32_16x16x32_bf16 v[220:223], v[72:75], v[108:111], v[220:223]
  s_mov_b32 s34, 147456
  v_mfma_f32_16x16x32_bf16 v[220:223], v[76:79], v[124:127], v[220:223]
  buffer_load_dwordx4 v86, s[12:15], s34 offen lds
  s_waitcnt lgkmcnt(0)
  v_mfma_f32_16x16x32_bf16 v[224:227], v[56:59], a[0:3], 0
  s_barrier
  v_mfma_f32_16x16x32_bf16 v[224:227], v[60:63], a[16:19], v[224:227]
  ds_read_b64_tr_b16 v[68:69], v11 offset:12288
  v_cvt_pk_bf16_f32 v40, v192, v193
  v_mfma_f32_16x16x32_bf16 v[224:227], v[64:67], a[32:35], v[224:227]
  ds_read_b64_tr_b16 v[70:71], v11 offset:14336
  v_cvt_pk_bf16_f32 v41, v194, v195
  v_mfma_f32_16x16x32_bf16 v[228:231], v[56:59], a[4:7], 0
  ds_read_b64_tr_b16 v[72:73], v11 offset:16384
  v_cvt_pk_bf16_f32 v42, v208, v209
  v_mfma_f32_16x16x32_bf16 v[228:231], v[60:63], a[20:23], v[228:231]
  ds_read_b64_tr_b16 v[74:75], v11 offset:18432
  v_cvt_pk_bf16_f32 v43, v210, v211
  v_mfma_f32_16x16x32_bf16 v[228:231], v[64:67], a[36:39], v[228:231]
  ds_read_b64_tr_b16 v[76:77], v11 offset:45056
  s_mov_b32 s35, 4096
  v_mfma_f32_16x16x32_bf16 v[232:235], v[56:59], a[8:11], 0
  ds_read_b64_tr_b16 v[78:79], v11 offset:47104
  buffer_store_dwordx4 v[40:43], v191, s[20:23], s35 offen sc1
  v_mfma_f32_16x16x32_bf16 v[232:235], v[60:63], a[24:27], v[232:235]
  s_add_u32 m0, s33, 135168
  v_cvt_pk_bf16_f32 v44, v196, v197
  v_mfma_f32_16x16x32_bf16 v[232:235], v[64:67], a[40:43], v[232:235]
  s_mov_b32 s34, 184320
  v_cvt_pk_bf16_f32 v45, v198, v199
  v_mfma_f32_16x16x32_bf16 v[236:239], v[56:59], a[12:15], 0
  buffer_load_dwordx4 v86, s[12:15], s34 offen lds
  v_cvt_pk_bf16_f32 v46, v212, v213
  v_mfma_f32_16x16x32_bf16 v[236:239], v[60:63], a[28:31], v[236:239]
  v_cvt_pk_bf16_f32 v47, v214, v215
  v_cvt_pk_bf16_f32 v48, v200, v201
  v_mfma_f32_16x16x32_bf16 v[236:239], v[64:67], a[44:47], v[236:239]
  v_cvt_pk_bf16_f32 v49, v202, v203
  s_waitcnt lgkmcnt(0)
  v_mfma_f32_16x16x32_bf16 v[240:243], v[68:71], a[0:3], 0
  ds_read_b64_tr_b16 v[56:57], v8 offset:49152
  v_cvt_pk_bf16_f32 v50, v216, v217
  v_mfma_f32_16x16x32_bf16 v[240:243], v[72:75], a[16:19], v[240:243]
  ds_read_b64_tr_b16 v[58:59], v8 offset:51200
  s_mov_b32 s63, 294912
  buffer_load_dword v31, v30, s[96:99], s63 offen sc1
  v_mfma_f32_16x16x32_bf16 v[240:243], v[76:79], a[32:35], v[240:243]
  ds_read_b64_tr_b16 v[60:61], v8 offset:53248
  v_cvt_pk_bf16_f32 v51, v218, v219
  v_mfma_f32_16x16x32_bf16 v[244:247], v[68:71], a[4:7], 0
  ds_read_b64_tr_b16 v[62:63], v8 offset:55296
  v_cvt_pk_bf16_f32 v52, v204, v205
  v_mfma_f32_16x16x32_bf16 v[244:247], v[72:75], a[20:23], v[244:247]
  ds_read_b64_tr_b16 v[64:65], v8 offset:20480
  v_cvt_pk_bf16_f32 v53, v206, v207
  v_mfma_f32_16x16x32_bf16 v[244:247], v[76:79], a[36:39], v[244:247]
  ds_read_b64_tr_b16 v[66:67], v8 offset:22528
  v_cvt_pk_bf16_f32 v54, v220, v221
  v_mfma_f32_16x16x32_bf16 v[248:251], v[68:71], a[8:11], 0
  s_add_u32 m0, s33, 98304
  v_cvt_pk_bf16_f32 v55, v222, v223
  v_mfma_f32_16x16x32_bf16 v[248:251], v[72:75], a[24:27], v[248:251]
  s_mov_b32 s34, 221184
  v_mfma_f32_16x16x32_bf16 v[248:251], v[76:79], a[40:43], v[248:251]
  buffer_load_dwordx4 v86, s[12:15], s34 offen lds
  v_mfma_f32_16x16x32_bf16 v[252:255], v[68:71], a[12:15], 0
  s_add_u32 m0, s33, 81920
  v_mfma_f32_16x16x32_bf16 v[252:255], v[72:75], a[28:31], v[252:255]
  s_mov_b32 s34, 258048
  v_mfma_f32_16x16x32_bf16 v[252:255], v[76:79], a[44:47], v[252:255]
  buffer_load_dwordx4 v86, s[12:15], s34 offen lds
  s_waitcnt lgkmcnt(0)
  v_mfma_f32_16x16x32_bf16 v[224:227], v[56:59], a[48:51], v[224:227]
  ds_read_b64_tr_b16 v[68:69], v11 offset:49152
  v_mfma_f32_16x16x32_bf16 v[224:227], v[60:63], a[64:67], v[224:227]
  ds_read_b64_tr_b16 v[70:71], v11 offset:51200
  v_mfma_f32_16x16x32_bf16 v[224:227], v[64:67], a[80:83], v[224:227]
  ds_read_b64_tr_b16 v[72:73], v11 offset:53248
  v_mfma_f32_16x16x32_bf16 v[228:231], v[56:59], a[52:55], v[228:231]
  ds_read_b64_tr_b16 v[74:75], v11 offset:55296
  v_mfma_f32_16x16x32_bf16 v[228:231], v[60:63], a[68:71], v[228:231]
  ds_read_b64_tr_b16 v[76:77], v11 offset:20480
  v_mfma_f32_16x16x32_bf16 v[228:231], v[64:67], a[84:87], v[228:231]
  ds_read_b64_tr_b16 v[78:79], v11 offset:22528
  v_mfma_f32_16x16x32_bf16 v[232:235], v[56:59], a[56:59], v[232:235]
  s_add_u32 m0, s33, 86016
  s_mov_b32 s35, 22528
  v_mfma_f32_16x16x32_bf16 v[232:235], v[60:63], a[72:75], v[232:235]
  s_mov_b32 s34, 0
  buffer_store_dwordx4 v[44:47], v191, s[20:23], s35 offen sc1
  v_mfma_f32_16x16x32_bf16 v[232:235], v[64:67], a[88:91], v[232:235]
  buffer_load_dwordx4 v87, s[12:15], s34 offen lds
  v_mfma_f32_16x16x32_bf16 v[236:239], v[56:59], a[60:63], v[236:239]
  v_mfma_f32_16x16x32_bf16 v[236:239], v[60:63], a[76:79], v[236:239]
  v_mfma_f32_16x16x32_bf16 v[236:239], v[64:67], a[92:95], v[236:239]
  s_waitcnt lgkmcnt(0)
  v_mfma_f32_16x16x32_bf16 v[240:243], v[68:71], a[48:51], v[240:243]
  s_barrier
  v_mfma_f32_16x16x32_bf16 v[240:243], v[72:75], a[64:67], v[240:243]
  ds_read_b64_tr_b16 v[56:57], v8 offset:24576
  s_add_u32 m0, s66, 0
  v_mfma_f32_16x16x32_bf16 v[240:243], v[76:79], a[80:83], v[240:243]
  ds_read_b64_tr_b16 v[58:59], v8 offset:26624
  s_mov_b32 s64, 0
  v_mfma_f32_16x16x32_bf16 v[244:247], v[68:71], a[52:55], v[244:247]
  ds_read_b64_tr_b16 v[60:61], v10 offset:20480
  buffer_load_dwordx4 v7, s[44:47], s64 offen lds
  v_mfma_f32_16x16x32_bf16 v[244:247], v[72:75], a[68:71], v[244:247]
  ds_read_b64_tr_b16 v[62:63], v10 offset:22528
  s_add_u32 m0, s66, 0
  v_mfma_f32_16x16x32_bf16 v[244:247], v[76:79], a[84:87], v[244:247]
  ds_read_b64_tr_b16 v[64:65], v9 offset:49152
  s_mov_b32 s64, 0
  v_mfma_f32_16x16x32_bf16 v[248:251], v[68:71], a[56:59], v[248:251]
  ds_read_b64_tr_b16 v[66:67], v9 offset:51200
  buffer_load_dwordx4 v7, s[44:47], s64 offen offset:1024 lds
  v_mfma_f32_16x16x32_bf16 v[248:251], v[72:75], a[72:75], v[248:251]
  s_add_u32 m0, s66, 0
  s_waitcnt vmcnt(17)
  v_mfma_f32_16x16x32_bf16 v[160:163], v[180:183], v[128:131], 0
  v_mfma_f32_16x16x32_bf16 v[248:251], v[76:79], a[88:91], v[248:251]
  s_mov_b32 s64, 0
  s_waitcnt vmcnt(15)
  v_mfma_f32_16x16x32_bf16 v[160:163], v[180:183], v[132:135], v[160:163]
  v_mfma_f32_16x16x32_bf16 v[252:255], v[68:71], a[60:63], v[252:255]
  buffer_load_dwordx4 v7, s[44:47], s64 offen offset:2048 lds
  s_waitcnt vmcnt(14)
  v_mfma_f32_16x16x32_bf16 v[160:163], v[184:187], v[136:139], v[160:163]
  v_mfma_f32_16x16x32_bf16 v[252:255], v[72:75], a[76:79], v[252:255]
  s_waitcnt vmcnt(12)
  v_mfma_f32_16x16x32_bf16 v[160:163], v[184:187], v[140:143], v[160:163]
  v_mfma_f32_16x16x32_bf16 v[252:255], v[76:79], a[92:95], v[252:255]
  s_mov_b32 s35, 40960
  s_waitcnt lgkmcnt(0)
  v_mfma_f32_16x16x32_bf16 v[224:227], v[56:59], a[96:99], v[224:227]
  ds_read_b64_tr_b16 v[68:69], v11 offset:24576
  buffer_store_dwordx4 v[48:51], v191, s[20:23], s35 offen sc1
  v_mfma_f32_16x16x32_bf16 v[224:227], v[60:63], a[112:115], v[224:227]
  ds_read_b64_tr_b16 v[70:71], v11 offset:26624
  v_mfma_f32_16x16x32_bf16 v[224:227], v[64:67], a[128:131], v[224:227]
  ds_read_b64_tr_b16 v[72:73], v13 offset:20480
  v_mfma_f32_16x16x32_bf16 v[228:231], v[56:59], a[100:103], v[228:231]
  ds_read_b64_tr_b16 v[74:75], v13 offset:22528
  v_mfma_f32_16x16x32_bf16 v[228:231], v[60:63], a[116:119], v[228:231]
  ds_read_b64_tr_b16 v[76:77], v12 offset:49152
  v_mfma_f32_16x16x32_bf16 v[228:231], v[64:67], a[132:135], v[228:231]
  ds_read_b64_tr_b16 v[78:79], v12 offset:51200
  v_mfma_f32_16x16x32_bf16 v[232:235], v[56:59], a[104:107], v[232:235]
  s_add_u32 m0, s66, 0
  v_mfma_f32_16x16x32_bf16 v[232:235], v[60:63], a[120:123], v[232:235]
  s_mov_b32 s64, 0
  v_mfma_f32_16x16x32_bf16 v[232:235], v[64:67], a[136:139], v[232:235]
  buffer_load_dwordx4 v7, s[44:47], s64 offen offset:3072 lds
  v_mfma_f32_16x16x32_bf16 v[236:239], v[56:59], a[108:111], v[236:239]
  v_mfma_f32_16x16x32_bf16 v[236:239], v[60:63], a[124:127], v[236:239]
  v_mfma_f32_16x16x32_bf16 v[236:239], v[64:67], a[140:143], v[236:239]
  s_waitcnt lgkmcnt(0)
  v_mfma_f32_16x16x32_bf16 v[240:243], v[68:71], a[96:99], v[240:243]
  ds_read_b64_tr_b16 v[56:57], v10 offset:24576
  s_mov_b32 s35, 59392
  v_mfma_f32_16x16x32_bf16 v[240:243], v[72:75], a[112:115], v[240:243]
  ds_read_b64_tr_b16 v[58:59], v10 offset:26624
  s_waitcnt vmcnt(9)
  v_cmp_eq_u32 vcc, 0, v31
  s_cbranch_vccnz L_sp_23
L_bk_24:
  v_mfma_f32_16x16x32_bf16 v[240:243], v[76:79], a[128:131], v[240:243]
  ds_read_b64_tr_b16 v[60:61], v9 offset:53248
  s_mov_b32 s65, 2048
  v_mfma_f32_16x16x32_bf16 v[244:247], v[68:71], a[100:103], v[244:247]
  ds_read_b64_tr_b16 v[62:63], v9 offset:55296
  buffer_load_dwordx4 v[144:147], v188, s[72:75], s65 offen sc1
  v_mfma_f32_16x16x32_bf16 v[244:247], v[72:75], a[116:119], v[244:247]
  ds_read_b64_tr_b16 v[64:65], v10 offset:28672
  buffer_store_dwordx4 v[52:55], v191, s[20:23], s35 offen sc1
  v_mfma_f32_16x16x32_bf16 v[244:247], v[76:79], a[132:135], v[244:247]
  ds_read_b64_tr_b16 v[66:67], v10 offset:30720
  v_mfma_f32_16x16x32_bf16 v[248:251], v[68:71], a[104:107], v[248:251]
  v_mfma_f32_16x16x32_bf16 v[248:251], v[72:75], a[120:123], v[248:251]
  v_mfma_f32_16x16x32_bf16 v[248:251], v[76:79], a[136:139], v[248:251]
  v_mfma_f32_16x16x32_bf16 v[252:255], v[68:71], a[108:111], v[252:255]
  s_mov_b32 s65, 9439232
  buffer_load_dwordx4 v[148:151], v188, s[72:75], s65 offen sc1
  v_mfma_f32_16x16x32_bf16 v[252:255], v[72:75], a[124:127], v[252:255]
  v_mfma_f32_16x16x32_bf16 v[252:255], v[76:79], a[140:143], v[252:255]
  s_waitcnt lgkmcnt(0)
  v_mfma_f32_16x16x32_bf16 v[224:227], v[56:59], a[144:147], v[224:227]
  s_barrier
  v_mfma_f32_16x16x32_bf16 v[224:227], v[60:63], a[160:163], v[224:227]
  ds_read_b64_tr_b16 v[68:69], v13 offset:24576
  s_add_u32 m0, s66, 16384
  v_mfma_f32_16x16x32_bf16 v[224:227], v[64:67], a[176:179], v[224:227]
  ds_read_b64_tr_b16 v[70:71], v13 offset:26624
  s_mov_b32 s64, 16384
  v_mfma_f32_16x16x32_bf16 v[228:231], v[56:59], a[148:151], v[228:231]
  ds_read_b64_tr_b16 v[72:73], v12 offset:53248
  buffer_load_dwordx4 v7, s[44:47], s64 offen lds
  v_mfma_f32_16x16x32_bf16 v[228:231], v[60:63], a[164:167], v[228:231]
  ds_read_b64_tr_b16 v[74:75], v12 offset:55296
  s_add_u32 m0, s66, 16384
  v_mfma_f32_16x16x32_bf16 v[228:231], v[64:67], a[180:183], v[228:231]
  ds_read_b64_tr_b16 v[76:77], v13 offset:28672
  s_mov_b32 s64, 16384
  v_mfma_f32_16x16x32_bf16 v[232:235], v[56:59], a[152:155], v[232:235]
  ds_read_b64_tr_b16 v[78:79], v13 offset:30720
  buffer_load_dwordx4 v7, s[44:47], s64 offen offset:1024 lds
  v_mfma_f32_16x16x32_bf16 v[232:235], v[60:63], a[168:171], v[232:235]
  s_add_u32 m0, s66, 16384
  s_mov_b32 s65, 12288
  v_mfma_f32_16x16x32_bf16 v[232:235], v[64:67], a[184:187], v[232:235]
  s_mov_b32 s64, 16384
  buffer_load_dwordx4 v[152:155], v188, s[72:75], s65 offen sc1
  v_mfma_f32_16x16x32_bf16 v[236:239], v[56:59], a[156:159], v[236:239]
  buffer_load_dwordx4 v7, s[44:47], s64 offen offset:2048 lds
  v_mfma_f32_16x16x32_bf16 v[236:239], v[60:63], a[172:175], v[236:239]
  v_mfma_f32_16x16x32_bf16 v[236:239], v[64:67], a[188:191], v[236:239]
  s_waitcnt lgkmcnt(0)
  v_mfma_f32_16x16x32_bf16 v[240:243], v[68:71], a[144:147], v[240:243]
  ds_read_b64_tr_b16 v[56:57], v9 offset:57344
  v_mfma_f32_16x16x32_bf16 v[240:243], v[72:75], a[160:163], v[240:243]
  ds_read_b64_tr_b16 v[58:59], v9 offset:59392
  v_mfma_f32_16x16x32_bf16 v[240:243], v[76:79], a[176:179], v[240:243]
  ds_read_b64_tr_b16 v[60:61], v8 offset:32768
  s_mov_b32 s65, 9449472
  v_mfma_f32_16x16x32_bf16 v[244:247], v[68:71], a[148:151], v[244:247]
  ds_read_b64_tr_b16 v[62:63], v8 offset:34816
  buffer_load_dwordx4 v[156:159], v188, s[72:75], s65 offen sc1
  v_mfma_f32_16x16x32_bf16 v[244:247], v[72:75], a[164:167], v[244:247]
  ds_read_b64_tr_b16 v[64:65], v8 offset:36864
  v_mfma_f32_16x16x32_bf16 v[244:247], v[76:79], a[180:183], v[244:247]
  ds_read_b64_tr_b16 v[66:67], v8 offset:38912
  v_mfma_f32_16x16x32_bf16 v[248:251], v[68:71], a[152:155], v[248:251]
  s_add_u32 m0, s66, 16384
  v_mfma_f32_16x16x32_bf16 v[248:251], v[72:75], a[168:171], v[248:251]
  s_mov_b32 s64, 16384
  v_mfma_f32_16x16x32_bf16 v[248:251], v[76:79], a[184:187], v[248:251]
  buffer_load_dwordx4 v7, s[44:47], s64 offen offset:3072 lds
  v_mfma_f32_16x16x32_bf16 v[252:255], v[68:71], a[156:159], v[252:255]
  v_mfma_f32_16x16x32_bf16 v[252:255], v[72:75], a[172:175], v[252:255]
  v_mfma_f32_16x16x32_bf16 v[252:255], v[76:79], a[188:191], v[252:255]
  s_waitcnt lgkmcnt(0)
  v_mfma_f32_16x16x32_bf16 v[224:227], v[56:59], a[192:195], v[224:227]
  ds_read_b64_tr_b16 v[68:69], v12 offset:57344
  v_mfma_f32_16x16x32_bf16 v[224:227], v[60:63], a[208:211], v[224:227]
  ds_read_b64_tr_b16 v[70:71], v12 offset:59392
  v_mfma_f32_16x16x32_bf16 v[224:227], v[64:67], a[224:227], v[224:227]
  ds_read_b64_tr_b16 v[72:73], v11 offset:32768
  v_mfma_f32_16x16x32_bf16 v[228:231], v[56:59], a[196:199], v[228:231]
  ds_read_b64_tr_b16 v[74:75], v11 offset:34816
  v_mfma_f32_16x16x32_bf16 v[228:231], v[60:63], a[212:215], v[228:231]
  ds_read_b64_tr_b16 v[76:77], v11 offset:36864
  v_mfma_f32_16x16x32_bf16 v[228:231], v[64:67], a[228:231], v[228:231]
  ds_read_b64_tr_b16 v[78:79], v11 offset:38912
  v_mfma_f32_16x16x32_bf16 v[232:235], v[56:59], a[200:203], v[232:235]
  v_mfma_f32_16x16x32_bf16 v[232:235], v[60:63], a[216:219], v[232:235]
  v_mfma_f32_16x16x32_bf16 v[232:235], v[64:67], a[232:235], v[232:235]
  v_mfma_f32_16x16x32_bf16 v[236:239], v[56:59], a[204:207], v[236:239]
  v_mfma_f32_16x16x32_bf16 v[236:239], v[60:63], a[220:223], v[236:239]
  v_mfma_f32_16x16x32_bf16 v[236:239], v[64:67], a[236:239], v[236:239]
  s_waitcnt lgkmcnt(0)
  v_mfma_f32_16x16x32_bf16 v[240:243], v[68:71], a[192:195], v[240:243]
  s_barrier
  v_mfma_f32_16x16x32_bf16 v[240:243], v[72:75], a[208:211], v[240:243]
  ds_read_b64_tr_b16 v[56:57], v9
  s_add_u32 m0, s66, 32768
  v_mfma_f32_16x16x32_bf16 v[240:243], v[76:79], a[224:227], v[240:243]
  ds_read_b64_tr_b16 v[58:59], v9 offset:2048
  s_mov_b32 s64, 32768
  v_mfma_f32_16x16x32_bf16 v[244:247], v[68:71], a[196:199], v[244:247]
  ds_read_b64_tr_b16 v[60:61], v9 offset:4096
  buffer_load_dwordx4 v7, s[44:47], s64 offen lds
  v_mfma_f32_16x16x32_bf16 v[244:247], v[72:75], a[212:215], v[244:247]
  ds_read_b64_tr_b16 v[62:63], v9 offset:6144
  s_add_u32 m0, s66, 32768
  v_mfma_f32_16x16x32_bf16 v[244:247], v[76:79], a[228:231], v[244:247]
  ds_read_b64_tr_b16 v[64:65], v9 offset:8192
  s_mov_b32 s64, 32768
  v_mfma_f32_16x16x32_bf16 v[248:251], v[68:71], a[200:203], v[248:251]
  ds_read_b64_tr_b16 v[66:67], v9 offset:10240
  buffer_load_dwordx4 v7, s[44:47], s64 offen offset:1024 lds
  v_mfma_f32_16x16x32_bf16 v[248:251], v[72:75], a[216:219], v[248:251]
  s_add_u32 m0, s66, 32768
  v_mfma_f32_16x16x32_bf16 v[248:251], v[76:79], a[232:235], v[248:251]
  s_mov_b32 s64, 32768
  v_mfma_f32_16x16x32_bf16 v[252:255], v[68:71], a[204:207], v[252:255]
  buffer_load_dwordx4 v7, s[44:47], s64 offen offset:2048 lds
  v_mfma_f32_16x16x32_bf16 v[252:255], v[72:75], a[220:223], v[252:255]
  v_mfma_f32_16x16x32_bf16 v[252:255], v[76:79], a[236:239], v[252:255]
  s_waitcnt lgkmcnt(0)
  v_mfma_f32_16x16x32_bf16 v[224:227], v[56:59], a[240:243], v[224:227]
  s_waitcnt vmcnt(10)
  s_barrier
  s_mov_b32 s63, 327680
  v_mov_b32 v190, 1
  buffer_store_dword v190, v29, s[96:99], s63 offen sc1
  ds_read_b64_tr_b16 v[68:69], v12
  v_mfma_f32_16x16x32_bf16 v[224:227], v[60:63], v[96:99], v[224:227]
  ds_read_b64_tr_b16 v[70:71], v12 offset:2048
  v_mfma_f32_16x16x32_bf16 v[224:227], v[64:67], v[112:115], v[224:227]
  ds_read_b64_tr_b16 v[72:73], v12 offset:4096
  v_mfma_f32_16x16x32_bf16 v[228:231], v[56:59], a[244:247], v[228:231]
  ds_read_b64_tr_b16 v[74:75], v12 offset:6144
  v_mfma_f32_16x16x32_bf16 v[228:231], v[60:63], v[100:103], v[228:231]
  ds_read_b64_tr_b16 v[76:77], v12 offset:8192
  v_mfma_f32_16x16x32_bf16 v[228:231], v[64:67], v[116:119], v[228:231]
  ds_read_b64_tr_b16 v[78:79], v12 offset:10240
  v_mfma_f32_16x16x32_bf16 v[232:235], v[56:59], a[248:251], v[232:235]
  s_add_u32 m0, s66, 32768
  v_mfma_f32_16x16x32_bf16 v[232:235], v[60:63], v[104:107], v[232:235]
  s_mov_b32 s64, 32768
  v_mfma_f32_16x16x32_bf16 v[232:235], v[64:67], v[120:123], v[232:235]
  buffer_load_dwordx4 v7, s[44:47], s64 offen offset:3072 lds
  v_mfma_f32_16x16x32_bf16 v[236:239], v[56:59], a[252:255], v[236:239]
  v_mfma_f32_16x16x32_bf16 v[236:239], v[60:63], v[108:111], v[236:239]
  v_mfma_f32_16x16x32_bf16 v[236:239], v[64:67], v[124:127], v[236:239]
  s_waitcnt lgkmcnt(0)
  v_mfma_f32_16x16x32_bf16 v[240:243], v[68:71], a[240:243], v[240:243]
  ds_read_b64_tr_b16 v[56:57], v15 offset:12288
  v_mfma_f32_16x16x32_bf16 v[164:167], v[180:183], v[144:147], 0
  v_mfma_f32_16x16x32_bf16 v[240:243], v[72:75], v[96:99], v[240:243]
  ds_read_b64_tr_b16 v[58:59], v15 offset:13312
  s_waitcnt vmcnt(11)
  v_mfma_f32_16x16x32_bf16 v[164:167], v[180:183], v[148:151], v[164:167]
  v_mfma_f32_16x16x32_bf16 v[240:243], v[76:79], v[112:115], v[240:243]
  ds_read_b64_tr_b16 v[60:61], v15 offset:61440
  s_waitcnt vmcnt(8)
  v_mfma_f32_16x16x32_bf16 v[164:167], v[184:187], v[152:155], v[164:167]
  v_mfma_f32_16x16x32_bf16 v[244:247], v[68:71], a[244:247], v[244:247]
  ds_read_b64_tr_b16 v[62:63], v15 offset:62464
  s_waitcnt vmcnt(6)
  v_mfma_f32_16x16x32_bf16 v[164:167], v[184:187], v[156:159], v[164:167]
  v_mfma_f32_16x16x32_bf16 v[244:247], v[72:75], v[100:103], v[244:247]
  ds_read_b64_tr_b16 v[64:65], v25
  v_mfma_f32_16x16x32_bf16 v[244:247], v[76:79], v[116:119], v[244:247]
  ds_read_b64_tr_b16 v[66:67], v25 offset:1024
  v_mfma_f32_16x16x32_bf16 v[248:251], v[68:71], a[248:251], v[248:251]
  v_mfma_f32_16x16x32_bf16 v[248:251], v[72:75], v[104:107], v[248:251]
  v_mfma_f32_16x16x32_bf16 v[248:251], v[76:79], v[120:123], v[248:251]
  v_mfma_f32_16x16x32_bf16 v[252:255], v[68:71], a[252:255], v[252:255]
  v_mfma_f32_16x16x32_bf16 v[252:255], v[72:75], v[108:111], v[252:255]
  v_mfma_f32_16x16x32_bf16 v[252:255], v[76:79], v[124:127], v[252:255]
  s_waitcnt lgkmcnt(0)
  v_mfma_f32_16x16x32_bf16 v[192:195], v[56:59], a[0:3], 0
  s_barrier
  v_mfma_f32_16x16x32_bf16 v[192:195], v[60:63], a[16:19], v[192:195]
  ds_read_b64_tr_b16 v[68:69], v15 offset:14336
  s_add_u32 m0, s66, 49152
  v_mfma_f32_16x16x32_bf16 v[192:195], v[64:67], a[32:35], v[192:195]
  ds_read_b64_tr_b16 v[70:71], v15 offset:15360
  s_mov_b32 s64, 49152
  v_mfma_f32_16x16x32_bf16 v[196:199], v[56:59], a[4:7], 0
  ds_read_b64_tr_b16 v[72:73], v15 offset:63488
  buffer_load_dwordx4 v7, s[44:47], s64 offen lds
  v_mfma_f32_16x16x32_bf16 v[196:199], v[60:63], a[20:23], v[196:199]
  ds_read_b64_tr_b16 v[74:75], v15 offset:64512
  s_add_u32 m0, s66, 49152
  v_mfma_f32_16x16x32_bf16 v[196:199], v[64:67], a[36:39], v[196:199]
  ds_read_b64_tr_b16 v[76:77], v25 offset:2048
  s_mov_b32 s64, 49152
  v_mfma_f32_16x16x32_bf16 v[200:203], v[56:59], a[8:11], 0
  ds_read_b64_tr_b16 v[78:79], v25 offset:3072
  buffer_load_dwordx4 v7, s[44:47], s64 offen offset:1024 lds
  v_mfma_f32_16x16x32_bf16 v[200:203], v[60:63], a[24:27], v[200:203]
  s_add_u32 m0, s66, 49152
  v_cvt_pk_bf16_f32 v40, v224, v225
  v_mfma_f32_16x16x32_bf16 v[200:203], v[64:67], a[40:43], v[200:203]
  s_mov_b32 s64, 49152
  v_cvt_pk_bf16_f32 v41, v226, v227
  v_mfma_f32_16x16x32_bf16 v[204:207], v[56:59], a[12:15], 0
  buffer_load_dwordx4 v7, s[44:47], s64 offen offset:2048 lds
  v_cvt_pk_bf16_f32 v42, v240, v241
  v_mfma_f32_16x16x32_bf16 v[204:207], v[60:63], a[28:31], v[204:207]
  v_cvt_pk_bf16_f32 v43, v242, v243
  s_mov_b32 s35, 6144
  v_mfma_f32_16x16x32_bf16 v[204:207], v[64:67], a[44:47], v[204:207]
  buffer_store_dwordx4 v[40:43], v191, s[20:23], s35 offen sc1
  s_waitcnt lgkmcnt(0)
  v_mfma_f32_16x16x32_bf16 v[192:195], v[68:71], a[144:147], v[192:195]
  ds_read_b64_tr_b16 v[56:57], v15 offset:24576
  v_cvt_pk_bf16_f32 v44, v228, v229
  v_mfma_f32_16x16x32_bf16 v[192:195], v[72:75], a[160:163], v[192:195]
  ds_read_b64_tr_b16 v[58:59], v15 offset:25600
  v_cvt_pk_bf16_f32 v45, v230, v231
  v_mfma_f32_16x16x32_bf16 v[192:195], v[76:79], a[176:179], v[192:195]
  ds_read_b64_tr_b16 v[60:61], v15 offset:28672
  v_cvt_pk_bf16_f32 v46, v244, v245
  v_mfma_f32_16x16x32_bf16 v[196:199], v[68:71], a[148:151], v[196:199]
  ds_read_b64_tr_b16 v[62:63], v15 offset:29696
  v_cvt_pk_bf16_f32 v47, v246, v247
  v_mfma_f32_16x16x32_bf16 v[196:199], v[72:75], a[164:167], v[196:199]
  ds_read_b64_tr_b16 v[64:65], v25 offset:4096
  s_mov_b32 s35, 24576
  v_mfma_f32_16x16x32_bf16 v[196:199], v[76:79], a[180:183], v[196:199]
  ds_read_b64_tr_b16 v[66:67], v25 offset:5120
  buffer_store_dwordx4 v[44:47], v191, s[20:23], s35 offen sc1
  v_mfma_f32_16x16x32_bf16 v[200:203], v[68:71], a[152:155], v[200:203]
  s_add_u32 m0, s66, 49152
  v_cvt_pk_bf16_f32 v48, v232, v233
  v_mfma_f32_16x16x32_bf16 v[200:203], v[72:75], a[168:171], v[200:203]
  s_mov_b32 s64, 49152
  v_cvt_pk_bf16_f32 v49, v234, v235
  v_mfma_f32_16x16x32_bf16 v[200:203], v[76:79], a[184:187], v[200:203]
  buffer_load_dwordx4 v7, s[44:47], s64 offen offset:3072 lds
  v_cvt_pk_bf16_f32 v50, v248, v249
  v_mfma_f32_16x16x32_bf16 v[204:207], v[68:71], a[156:159], v[204:207]
  v_cvt_pk_bf16_f32 v51, v250, v251
  s_mov_b32 s35, 43008
  v_mfma_f32_16x16x32_bf16 v[204:207], v[72:75], a[172:175], v[204:207]
  buffer_store_dwordx4 v[48:51], v191, s[20:23], s35 offen sc1
  v_cvt_pk_bf16_f32 v52, v236, v237
  v_mfma_f32_16x16x32_bf16 v[204:207], v[76:79], a[188:191], v[204:207]
  v_cvt_pk_bf16_f32 v53, v238, v239
  s_waitcnt lgkmcnt(0)
  v_mfma_f32_16x16x32_bf16 v[192:195], v[56:59], a[48:51], v[192:195]
  ds_read_b64_tr_b16 v[68:69], v15 offset:26624
  v_cvt_pk_bf16_f32 v54, v252, v253
  v_mfma_f32_16x16x32_bf16 v[192:195], v[60:63], a[64:67], v[192:195]
  ds_read_b64_tr_b16 v[70:71], v15 offset:27648
  s_mov_b32 s63, 327680
  buffer_load_dword v31, v30, s[96:99], s63 offen sc1
  v_mfma_f32_16x16x32_bf16 v[192:195], v[64:67], a[80:83], v[192:195]
  ds_read_b64_tr_b16 v[72:73], v15 offset:30720
  v_cvt_pk_bf16_f32 v55, v254, v255
  v_mfma_f32_16x16x32_bf16 v[196:199], v[56:59], a[52:55], v[196:199]
  ds_read_b64_tr_b16 v[74:75], v15 offset:31744
  s_mov_b32 s35, 61440
  v_mfma_f32_16x16x32_bf16 v[196:199], v[60:63], a[68:71], v[196:199]
  ds_read_b64_tr_b16 v[76:77], v25 offset:6144
  buffer_store_dwordx4 v[52:55], v191, s[20:23], s35 offen sc1
  v_mfma_f32_16x16x32_bf16 v[196:199], v[64:67], a[84:87], v[196:199]
  ds_read_b64_tr_b16 v[78:79], v25 offset:7168
  v_mfma_f32_16x16x32_bf16 v[200:203], v[56:59], a[56:59], v[200:203]
  v_mfma_f32_16x16x32_bf16 v[200:203], v[60:63], a[72:75], v[200:203]
  v_mfma_f32_16x16x32_bf16 v[200:203], v[64:67], a[88:91], v[200:203]
  v_mfma_f32_16x16x32_bf16 v[204:207], v[56:59], a[60:63], v[204:207]
  v_mfma_f32_16x16x32_bf16 v[204:207], v[60:63], a[76:79], v[204:207]
  v_mfma_f32_16x16x32_bf16 v[204:207], v[64:67], a[92:95], v[204:207]
  s_waitcnt lgkmcnt(0)
  v_mfma_f32_16x16x32_bf16 v[192:195], v[68:71], a[192:195], v[192:195]
  s_barrier
  v_mfma_f32_16x16x32_bf16 v[192:195], v[72:75], a[208:211], v[192:195]
  ds_read_b64_tr_b16 v[56:57], v15 offset:32768
  v_mfma_f32_16x16x32_bf16 v[192:195], v[76:79], a[224:227], v[192:195]
  ds_read_b64_tr_b16 v[58:59], v15 offset:33792
  v_mfma_f32_16x16x32_bf16 v[196:199], v[68:71], a[196:199], v[196:199]
  ds_read_b64_tr_b16 v[60:61], v15 offset:16384
  v_mfma_f32_16x16x32_bf16 v[196:199], v[72:75], a[212:215], v[196:199]
  ds_read_b64_tr_b16 v[62:63], v15 offset:17408
  v_mfma_f32_16x16x32_bf16 v[196:199], v[76:79], a[228:231], v[196:199]
  ds_read_b64_tr_b16 v[64:65], v15 offset:20480
  v_mfma_f32_16x16x32_bf16 v[200:203], v[68:71], a[200:203], v[200:203]
  ds_read_b64_tr_b16 v[66:67], v15 offset:21504
  v_mfma_f32_16x16x32_bf16 v[200:203], v[72:75], a[216:219], v[200:203]
  v_mfma_f32_16x16x32_bf16 v[200:203], v[76:79], a[232:235], v[200:203]
  v_mfma_f32_16x16x32_bf16 v[204:207], v[68:71], a[204:207], v[204:207]
  v_mfma_f32_16x16x32_bf16 v[204:207], v[72:75], a[220:223], v[204:207]
  v_mfma_f32_16x16x32_bf16 v[204:207], v[76:79], a[236:239], v[204:207]
  s_waitcnt lgkmcnt(0)
  v_mfma_f32_16x16x32_bf16 v[192:195], v[56:59], a[96:99], v[192:195]
  ds_read_b64_tr_b16 v[68:69], v15 offset:34816
  v_mfma_f32_16x16x32_bf16 v[192:195], v[60:63], a[112:115], v[192:195]
  ds_read_b64_tr_b16 v[70:71], v15 offset:35840
  v_mfma_f32_16x16x32_bf16 v[192:195], v[64:67], a[128:131], v[192:195]
  ds_read_b64_tr_b16 v[72:73], v15 offset:18432
  v_mfma_f32_16x16x32_bf16 v[196:199], v[56:59], a[100:103], v[196:199]
  ds_read_b64_tr_b16 v[74:75], v15 offset:19456
  v_mfma_f32_16x16x32_bf16 v[196:199], v[60:63], a[116:119], v[196:199]
  ds_read_b64_tr_b16 v[76:77], v15 offset:22528
  v_mfma_f32_16x16x32_bf16 v[196:199], v[64:67], a[132:135], v[196:199]
  ds_read_b64_tr_b16 v[78:79], v15 offset:23552
  v_mfma_f32_16x16x32_bf16 v[200:203], v[56:59], a[104:107], v[200:203]
  v_mfma_f32_16x16x32_bf16 v[200:203], v[60:63], a[120:123], v[200:203]
  v_mfma_f32_16x16x32_bf16 v[200:203], v[64:67], a[136:139], v[200:203]
  v_mfma_f32_16x16x32_bf16 v[204:207], v[56:59], a[108:111], v[204:207]
  v_mfma_f32_16x16x32_bf16 v[204:207], v[60:63], a[124:127], v[204:207]
  v_mfma_f32_16x16x32_bf16 v[204:207], v[64:67], a[140:143], v[204:207]
  s_waitcnt lgkmcnt(0)
  v_mfma_f32_16x16x32_bf16 v[192:195], v[68:71], a[240:243], v[192:195]
  v_mfma_f32_16x16x32_bf16 v[192:195], v[72:75], v[96:99], v[192:195]
  v_mfma_f32_16x16x32_bf16 v[192:195], v[76:79], v[112:115], v[192:195]
  v_mfma_f32_16x16x32_bf16 v[196:199], v[68:71], a[244:247], v[196:199]
  v_mfma_f32_16x16x32_bf16 v[196:199], v[72:75], v[100:103], v[196:199]
  v_mfma_f32_16x16x32_bf16 v[196:199], v[76:79], v[116:119], v[196:199]
  v_mfma_f32_16x16x32_bf16 v[200:203], v[68:71], a[248:251], v[200:203]
  v_mfma_f32_16x16x32_bf16 v[200:203], v[72:75], v[104:107], v[200:203]
  v_mfma_f32_16x16x32_bf16 v[200:203], v[76:79], v[120:123], v[200:203]
  v_mfma_f32_16x16x32_bf16 v[204:207], v[68:71], a[252:255], v[204:207]
  v_mfma_f32_16x16x32_bf16 v[204:207], v[72:75], v[108:111], v[204:207]
  v_mfma_f32_16x16x32_bf16 v[204:207], v[76:79], v[124:127], v[204:207]
  v_cvt_pk_bf16_f32 v40, v192, v193
  v_cvt_pk_bf16_f32 v41, v194, v195
  s_mov_b32 s35, 0
  buffer_store_dwordx2 v[40:41], v3, s[20:23], s35 offen sc1
  v_cvt_pk_bf16_f32 v44, v196, v197
  v_cvt_pk_bf16_f32 v45, v198, v199
  s_mov_b32 s35, 18432
  buffer_store_dwordx2 v[44:45], v3, s[20:23], s35 offen sc1
  v_cvt_pk_bf16_f32 v48, v200, v201
  v_cvt_pk_bf16_f32 v49, v202, v203
  s_mov_b32 s35, 36864
  buffer_store_dwordx2 v[48:49], v3, s[20:23], s35 offen sc1
  v_cvt_pk_bf16_f32 v52, v204, v205
  v_cvt_pk_bf16_f32 v53, v206, v207
  s_mov_b32 s35, 55296
  buffer_store_dwordx2 v[52:53], v3, s[20:23], s35 offen sc1
  s_waitcnt vmcnt(5)
  v_cmp_eq_u32 vcc, 0, v31
  s_cbranch_vccnz L_sp_26
L_bk_27:
  s_mov_b32 s65, 4096
  buffer_load_dwordx4 v[128:131], v188, s[72:75], s65 offen sc1
  s_mov_b32 s65, 9441280
  buffer_load_dwordx4 v[132:135], v188, s[72:75], s65 offen sc1
  s_mov_b32 s65, 14336
  buffer_load_dwordx4 v[136:139], v188, s[72:75], s65 offen sc1
  s_mov_b32 s65, 9451520
  buffer_load_dwordx4 v[140:143], v188, s[72:75], s65 offen sc1
  s_add_u32 s48, s90, 7118848
  s_addc_u32 s49, s91, 0
  s_and_b32 s49, s49, 0xffff
  s_mov_b32 s50, 131072
  s_mov_b32 s51, 0x20000
  s_add_u32 s52, s90, 7077888
  s_addc_u32 s53, s91, 0
  s_and_b32 s53, s53, 0xffff
  s_mov_b32 s54, 32768
  s_mov_b32 s55, 0x20000
  s_add_u32 s56, s90, 7110656
  s_addc_u32 s57, s91, 0
  s_and_b32 s57, s57, 0xffff
  s_mov_b32 s58, 8192
  s_mov_b32 s59, 0x20000
  s_lshl_b32 s36, s93, 4
  s_add_u32 s36, s36, s94
  s_lshr_b32 s37, s36, 1
  s_mul_i32 s37, s37, 18432
  s_and_b32 s38, s36, 1
  s_lshl_b32 s38, s38, 7
  s_add_u32 s39, s37, s38
  s_lshl_b32 s38, s92, 9
  s_add_u32 s39, s39, s38
  v_and_b32 v4, 7, v0
  v_bfe_u32 v6, v0, 3, 1
  v_lshlrev_b32 v4, 4, v4
  v_lshl_add_u32 v4, v6, 8, v4
  v_add_u32 v4, s39, v4
  v_subrev_u32 v18, s37, v4
  v_and_b32 v18, 1023, v18
  v_lshrrev_b32 v18, 1, v18
  s_lshr_b32 s38, s92, 1
  s_lshl_b32 s38, s38, 10
  s_add_u32 s38, s38, s37
  v_add_u32 v18, s38, v18
  v_bfe_u32 v2, v0, 4, 2
  v_lshl_add_u32 v8, v2, 2, v4
  v_lshl_add_u32 v9, v2, 11, v4
  v_lshrrev_b32 v5, 1, v2
  v_lshl_add_u32 v18, v5, 9, v18
  v_and_b32 v4, 1, v2
  v_lshl_add_u32 v18, v4, 2, v18
  s_cmp_lt_u32 s92, 2
  s_cselect_b64 vcc, -1, 0
  v_cndmask_b32 v19, v18, v8, vcc
  v_cndmask_b32 v18, v8, v18, vcc
  s_mov_b32 s65, 0
  buffer_load_dword v56, v8, s[16:19], s65 offen sc1
  buffer_load_dword v57, v8, s[16:19], s65 offen offset:2048 sc1
  s_mov_b32 s65, 4096
  buffer_load_dword v58, v18, s[16:19], s65 offen sc1
  buffer_load_dword v59, v8, s[16:19], s65 offen offset:2048 sc1
  s_mov_b32 s65, 8192
  buffer_load_dword v60, v8, s[16:19], s65 offen sc1
  buffer_load_dword v61, v8, s[16:19], s65 offen offset:2048 sc1
  s_mov_b32 s65, 12288
  buffer_load_dword v62, v19, s[16:19], s65 offen sc1
  buffer_load_dword v63, v8, s[16:19], s65 offen offset:2048 sc1
  s_mov_b32 s65, 16384
  buffer_load_dword v64, v8, s[16:19], s65 offen sc1
  s_lshl_b32 s37, s36, 3
  v_and_b32 v15, 7, v0
  v_add_u32 v10, s37, v15
  v_lshlrev_b32 v12, 2, v10
  v_bfe_u32 v13, v0, 3, 3
  v_lshl_add_u32 v13, v13, 14, v12
  s_mov_b32 s65, 8192
  buffer_load_dword v68, v13, s[48:51], 0 offen sc1
  buffer_load_dword v69, v13, s[48:51], s65 offen sc1
  s_lshl_b32 s37, s36, 7
  v_lshl_add_u32 v17, v15, 2, s37
  buffer_load_dword v67, v17, s[52:55], 0 offen offset:32 sc1
  buffer_load_dword v66, v12, s[56:59], 0 offen sc1
  v_lshl_add_u32 v17, v0, 2, s37
  v_mov_b32 v16, 0x7ffffff0
  v_cmp_gt_u32 vcc, 32, v0
  s_nop 1
  v_cndmask_b32 v17, v16, v17, vcc
  v_lshlrev_b32 v15, 4, v15
  v_add_u32 v15, 163328, v15
  s_lshl_b32 s37, s92, 2
  v_add_u32 v14, s37, v15
  v_mul_u32_u24 v10, 1152, v10
  v_lshl_add_u32 v10, v6, 3, v10
  s_lshr_b32 s37, s92, 1
  s_lshl_b32 s37, s37, 6
  s_and_b32 s38, s92, 1
  s_lshl_b32 s38, s38, 4
  s_add_u32 s37, s37, s38
  v_add_u32 v10, s37, v10
  v_lshl_add_u32 v11, v5, 5, v10
  v_lshl_add_u32 v11, v4, 2, v11
  v_lshl_add_u32 v10, v2, 7, v10
  s_waitcnt vmcnt(17)
  s_barrier
  s_mov_b32 s63, 393216
  v_mov_b32 v190, 1
  buffer_store_dword v190, v29, s[96:99], s63 offen sc1
  s_mov_b32 s63, 393216
  buffer_load_dword v31, v30, s[96:99], s63 offen sc1
  s_waitcnt vmcnt(18)
  v_mfma_f32_16x16x32_bf16 v[168:171], v[180:183], v[128:131], 0
  s_waitcnt vmcnt(17)
  v_mfma_f32_16x16x32_bf16 v[168:171], v[180:183], v[132:135], v[168:171]
  s_waitcnt vmcnt(16)
  v_mfma_f32_16x16x32_bf16 v[168:171], v[184:187], v[136:139], v[168:171]
  s_waitcnt vmcnt(15)
  v_mfma_f32_16x16x32_bf16 v[168:171], v[184:187], v[140:143], v[168:171]
  s_waitcnt vmcnt(2)
  v_add_f32 v67, v67, v66
  v_add_f32 v68, v68, v69
  s_nop 1
  v_add_f32_dpp v68, v68, v68 row_ror:8 row_mask:0xf bank_mask:0xf
  v_mov_b32 v69, v68
  s_nop 1
  v_permlane16_swap_b32 v68, v69
  v_add_f32 v68, v68, v69
  v_mov_b32 v69, v68
  s_nop 1
  v_permlane32_swap_b32 v68, v69
  v_add_f32 v68, v68, v69
  v_mov_b32 v69, 0x3727c5ac
  v_fmac_f32 v69, 0x3ae38e39, v68
  v_rcp_f32 v66, v69
  s_waitcnt vmcnt(0)
  v_cmp_eq_u32 vcc, 0, v31
  s_cbranch_vccnz L_sp_29
L_bk_30:
  s_mov_b32 s65, 6144
  buffer_load_dwordx4 v[144:147], v188, s[72:75], s65 offen sc1
  s_mov_b32 s65, 9443328
  buffer_load_dwordx4 v[148:151], v188, s[72:75], s65 offen sc1
  s_mov_b32 s65, 16384
  buffer_load_dwordx4 v[152:155], v188, s[72:75], s65 offen sc1
  s_mov_b32 s65, 9453568
  buffer_load_dwordx4 v[156:159], v188, s[72:75], s65 offen sc1
  s_mov_b32 s65, 8192
  buffer_load_dwordx2 v[224:225], v189, s[72:75], s65 offen sc1
  buffer_load_dwordx2 v[226:227], v189, s[72:75], s65 offen offset:512 sc1
  s_mov_b32 s65, 9445376
  buffer_load_dwordx2 v[228:229], v189, s[72:75], s65 offen sc1
  buffer_load_dwordx2 v[230:231], v189, s[72:75], s65 offen offset:512 sc1
  s_add_u32 m0, s66, 65536
  s_mov_b32 s64, 65536
  buffer_load_dwordx4 v7, s[44:47], s64 offen lds
  s_add_u32 m0, s66, 65536
  s_mov_b32 s64, 65536
  buffer_load_dwordx4 v7, s[44:47], s64 offen offset:1024 lds
  s_add_u32 m0, s66, 65536
  s_mov_b32 s64, 65536
  buffer_load_dwordx4 v7, s[44:47], s64 offen offset:2048 lds
  s_add_u32 m0, s66, 65536
  s_mov_b32 s64, 65536
  buffer_load_dwordx4 v7, s[44:47], s64 offen offset:3072 lds
  s_add_u32 m0, s66, 81920
  s_mov_b32 s64, 81920
  buffer_load_dwordx4 v7, s[44:47], s64 offen lds
  s_add_u32 m0, s66, 81920
  s_mov_b32 s64, 81920
  buffer_load_dwordx4 v7, s[44:47], s64 offen offset:1024 lds
  s_add_u32 m0, s66, 81920
  s_mov_b32 s64, 81920
  buffer_load_dwordx4 v7, s[44:47], s64 offen offset:2048 lds
  s_add_u32 m0, s66, 81920
  s_mov_b32 s64, 81920
  buffer_load_dwordx4 v7, s[44:47], s64 offen offset:3072 lds
  s_add_u32 m0, s66, 98304
  s_mov_b32 s64, 98304
  buffer_load_dwordx4 v7, s[44:47], s64 offen lds
  s_add_u32 m0, s66, 98304
  s_mov_b32 s64, 98304
  buffer_load_dwordx4 v7, s[44:47], s64 offen offset:1024 lds
  s_add_u32 m0, s66, 98304
  s_mov_b32 s64, 98304
  buffer_load_dwordx4 v7, s[44:47], s64 offen offset:2048 lds
  s_add_u32 m0, s66, 98304
  s_mov_b32 s64, 98304
  buffer_load_dwordx4 v7, s[44:47], s64 offen offset:3072 lds
  s_add_u32 m0, s66, 114688
  s_mov_b32 s64, 114688
  buffer_load_dwordx4 v7, s[44:47], s64 offen lds
  s_add_u32 m0, s66, 114688
  s_mov_b32 s64, 114688
  buffer_load_dwordx4 v7, s[44:47], s64 offen offset:1024 lds
  s_add_u32 m0, s66, 114688
  s_mov_b32 s64, 114688
  buffer_load_dwordx4 v7, s[44:47], s64 offen offset:2048 lds
  s_add_u32 m0, s66, 114688
  s_mov_b32 s64, 114688
  buffer_load_dwordx4 v7, s[44:47], s64 offen offset:3072 lds
  s_waitcnt vmcnt(23)
  v_mfma_f32_16x16x32_bf16 v[172:175], v[180:183], v[144:147], 0
  s_waitcnt vmcnt(22)
  v_mfma_f32_16x16x32_bf16 v[172:175], v[180:183], v[148:151], v[172:175]
  s_waitcnt vmcnt(21)
  v_mfma_f32_16x16x32_bf16 v[172:175], v[184:187], v[152:155], v[172:175]
  s_waitcnt vmcnt(20)
  v_mfma_f32_16x16x32_bf16 v[172:175], v[184:187], v[156:159], v[172:175]
  s_waitcnt vmcnt(18)
  v_mfma_f32_16x16x32_bf16 v[176:179], v[180:183], v[224:227], 0
  s_waitcnt vmcnt(16)
  v_mfma_f32_16x16x32_bf16 v[176:179], v[180:183], v[228:231], v[176:179]
  s_cmp_lg_u32 s95, 0
  s_cbranch_scc1 L_last
  s_add_u32 s48, s90, 45522944
  s_addc_u32 s49, s91, 0
  s_and_b32 s49, s49, 0xffff
  s_mov_b32 s50, 2359296
  s_mov_b32 s51, 0x20000
  s_add_u32 s52, s90, 52600832
  s_addc_u32 s53, s91, 0
  s_and_b32 s53, s53, 0xffff
  s_mov_b32 s54, 32768
  s_mov_b32 s55, 0x20000
  v_lshlrev_b32 v68, 16, v56
  v_and_b32 v69, 0xffff0000, v56
  v_fma_f32 v160, v160, v66, v68
  v_fma_f32 v161, v161, v66, v69
  v_lshlrev_b32 v68, 16, v57
  v_and_b32 v69, 0xffff0000, v57
  v_fma_f32 v164, v164, v66, v68
  v_fma_f32 v165, v165, v66, v69
  v_lshlrev_b32 v68, 16, v58
  v_and_b32 v69, 0xffff0000, v58
  v_fma_f32 v168, v168, v66, v68
  v_fma_f32 v169, v169, v66, v69
  v_lshlrev_b32 v68, 16, v59
  v_and_b32 v69, 0xffff0000, v59
  v_fma_f32 v172, v172, v66, v68
  v_fma_f32 v173, v173, v66, v69
  v_lshlrev_b32 v68, 16, v60
  v_and_b32 v69, 0xffff0000, v60
  v_fma_f32 v176, v176, v66, v68
  v_fma_f32 v177, v177, v66, v69
  v_lshlrev_b32 v68, 16, v61
  v_and_b32 v69, 0xffff0000, v61
  v_fma_f32 v162, v162, v66, v68
  v_fma_f32 v163, v163, v66, v69
  v_lshlrev_b32 v68, 16, v62
  v_and_b32 v69, 0xffff0000, v62
  v_fma_f32 v166, v166, v66, v68
  v_fma_f32 v167, v167, v66, v69
  v_lshlrev_b32 v68, 16, v63
  v_and_b32 v69, 0xffff0000, v63
  v_fma_f32 v170, v170, v66, v68
  v_fma_f32 v171, v171, v66, v69
  v_lshlrev_b32 v68, 16, v64
  v_and_b32 v69, 0xffff0000, v64
  v_fma_f32 v174, v174, v66, v68
  v_fma_f32 v175, v175, v66, v69
  v_add_f32 v32, v160, v161
  v_add_f32 v33, v164, v165
  v_add_f32 v32, v32, v168
  v_add_f32 v33, v33, v169
  v_add_f32 v32, v32, v172
  v_add_f32 v33, v33, v173
  v_add_f32 v32, v32, v176
  v_add_f32 v33, v33, v177
  v_add_f32 v32, v32, v162
  v_add_f32 v33, v33, v163
  v_add_f32 v32, v32, v166
  v_add_f32 v33, v33, v167
  v_add_f32 v32, v32, v170
  v_add_f32 v33, v33, v171
  v_add_f32 v32, v32, v174
  v_add_f32 v33, v33, v175
  v_add_f32 v32, v32, v33
  s_nop 1
  v_add_f32_dpp v32, v32, v32 row_ror:8 row_mask:0xf bank_mask:0xf
  v_mov_b32 v33, v32
  s_nop 1
  v_permlane16_swap_b32 v32, v33
  v_add_f32 v32, v32, v33
  v_mov_b32 v33, v32
  s_nop 1
  v_permlane32_swap_b32 v32, v33
  v_add_f32 v32, v32, v33
  ds_write_b32 v14, v32
  s_waitcnt lgkmcnt(0)
  s_barrier
  ds_read_b128 v[36:39], v15
  s_waitcnt lgkmcnt(0)
  v_add_f32 v36, v36, v37
  v_add_f32 v38, v38, v39
  v_add_f32 v32, v36, v38
  v_mul_f32 v32, 0x3ae38e39, v32
  v_sub_f32 v160, v160, v32
  v_sub_f32 v161, v161, v32
  v_sub_f32 v164, v164, v32
  v_sub_f32 v165, v165, v32
  v_sub_f32 v168, v168, v32
  v_sub_f32 v169, v169, v32
  v_sub_f32 v172, v172, v32
  v_sub_f32 v173, v173, v32
  v_sub_f32 v176, v176, v32
  v_sub_f32 v177, v177, v32
  v_sub_f32 v162, v162, v32
  v_sub_f32 v163, v163, v32
  v_sub_f32 v166, v166, v32
  v_sub_f32 v167, v167, v32
  v_sub_f32 v170, v170, v32
  v_sub_f32 v171, v171, v32
  v_sub_f32 v174, v174, v32
  v_sub_f32 v175, v175, v32
  v_cvt_pk_bf16_f32 v40, v160, v161
  v_cvt_pk_bf16_f32 v41, v164, v165
  v_cvt_pk_bf16_f32 v42, v168, v169
  v_cvt_pk_bf16_f32 v43, v172, v173
  v_cvt_pk_bf16_f32 v44, v176, v177
  v_cvt_pk_bf16_f32 v45, v162, v163
  v_cvt_pk_bf16_f32 v46, v166, v167
  v_cvt_pk_bf16_f32 v47, v170, v171
  v_cvt_pk_bf16_f32 v48, v174, v175
  v_permlane32_swap_b32 v40, v42
  v_permlane32_swap_b32 v41, v43
  v_permlane32_swap_b32 v44, v46
  v_permlane32_swap_b32 v45, v47
  v_permlane16_swap_b32 v40, v41
  v_permlane16_swap_b32 v42, v43
  v_permlane16_swap_b32 v44, v45
  v_permlane16_swap_b32 v46, v47
  s_mov_b32 s34, 8192
  s_mov_b32 s35, 16384
  buffer_store_dwordx4 v[40:43], v9, s[48:51], 0 offen sc1
  buffer_store_dwordx4 v[44:47], v9, s[48:51], s34 offen sc1
  buffer_store_dword v48, v8, s[48:51], s35 offen sc1
  v_mul_f32 v34, v160, v160
  v_mul_f32 v35, v161, v161
  v_fmac_f32 v34, v164, v164
  v_fmac_f32 v35, v165, v165
  v_fmac_f32 v34, v168, v168
  v_fmac_f32 v35, v169, v169
  v_fmac_f32 v34, v172, v172
  v_fmac_f32 v35, v173, v173
  v_fmac_f32 v34, v176, v176
  v_fmac_f32 v35, v177, v177
  v_fmac_f32 v34, v162, v162
  v_fmac_f32 v35, v163, v163
  v_fmac_f32 v34, v166, v166
  v_fmac_f32 v35, v167, v167
  v_fmac_f32 v34, v170, v170
  v_fmac_f32 v35, v171, v171
  v_fmac_f32 v34, v174, v174
  v_fmac_f32 v35, v175, v175
  v_add_f32 v34, v34, v35
  s_nop 1
  v_add_f32_dpp v34, v34, v34 row_ror:8 row_mask:0xf bank_mask:0xf
  v_mov_b32 v33, v34
  s_nop 1
  v_permlane16_swap_b32 v34, v33
  v_add_f32 v34, v34, v33
  v_mov_b32 v33, v34
  s_nop 1
  v_permlane32_swap_b32 v34, v33
  v_add_f32 v34, v34, v33
  ds_write_b32 v14, v34 offset:128
  s_waitcnt lgkmcnt(0)
  s_barrier
  ds_read_b128 v[36:39], v15 offset:128
  s_waitcnt lgkmcnt(0)
  v_add_f32 v36, v36, v37
  v_add_f32 v38, v38, v39
  v_add_f32 v34, v36, v38
  v_mov_b32 v33, 0x3727c5ac
  v_fmac_f32 v33, 0x3ae38e39, v34
  v_rsq_f32 v33, v33
  v_add_f32 v32, v32, v67
  v_and_b32 v35, 8, v0
  v_cmp_eq_u32 vcc, 0, v35
  s_nop 1
  v_cndmask_b32 v32, v32, v33, vcc
  buffer_store_dword v32, v17, s[52:55], 0 offen sc1
  s_waitcnt vmcnt(0)
  s_barrier
  s_mov_b32 s36, 45522944
  v_mov_b32 v1, 1
  buffer_store_dword v1, v29, s[96:99], s36 offen sc1
  s_mov_b32 s95, 1
  s_add_u32 s90, s90, 45522944
  s_addc_u32 s91, s91, 0
  s_add_u32 s96, s90, 7249920
  s_addc_u32 s97, s91, 0
  s_and_b32 s97, s97, 0xffff
  s_mov_b32 s98, 46047232
  s_mov_b32 s99, 0x20000
  s_branch L_layer
L_last:
  s_mov_b32 s48, s88
  s_and_b32 s49, s89, 0xffff
  s_mov_b32 s50, 2359296
  s_mov_b32 s51, 0x20000
  v_lshlrev_b32 v68, 16, v56
  v_and_b32 v69, 0xffff0000, v56
  v_fma_f32 v160, v160, v66, v68
  v_fma_f32 v161, v161, v66, v69
  v_lshlrev_b32 v68, 16, v57
  v_and_b32 v69, 0xffff0000, v57
  v_fma_f32 v164, v164, v66, v68
  v_fma_f32 v165, v165, v66, v69
  v_lshlrev_b32 v68, 16, v58
  v_and_b32 v69, 0xffff0000, v58
  v_fma_f32 v168, v168, v66, v68
  v_fma_f32 v169, v169, v66, v69
  v_lshlrev_b32 v68, 16, v59
  v_and_b32 v69, 0xffff0000, v59
  v_fma_f32 v172, v172, v66, v68
  v_fma_f32 v173, v173, v66, v69
  v_lshlrev_b32 v68, 16, v60
  v_and_b32 v69, 0xffff0000, v60
  v_fma_f32 v176, v176, v66, v68
  v_fma_f32 v177, v177, v66, v69
  v_lshlrev_b32 v68, 16, v61
  v_and_b32 v69, 0xffff0000, v61
  v_fma_f32 v162, v162, v66, v68
  v_fma_f32 v163, v163, v66, v69
  v_lshlrev_b32 v68, 16, v62
  v_and_b32 v69, 0xffff0000, v62
  v_fma_f32 v166, v166, v66, v68
  v_fma_f32 v167, v167, v66, v69
  v_lshlrev_b32 v68, 16, v63
  v_and_b32 v69, 0xffff0000, v63
  v_fma_f32 v170, v170, v66, v68
  v_fma_f32 v171, v171, v66, v69
  v_lshlrev_b32 v68, 16, v64
  v_and_b32 v69, 0xffff0000, v64
  v_fma_f32 v174, v174, v66, v68
  v_fma_f32 v175, v175, v66, v69
  v_add_f32 v160, v160, v67
  v_add_f32 v161, v161, v67
  v_add_f32 v164, v164, v67
  v_add_f32 v165, v165, v67
  v_add_f32 v168, v168, v67
  v_add_f32 v169, v169, v67
  v_add_f32 v172, v172, v67
  v_add_f32 v173, v173, v67
  v_add_f32 v176, v176, v67
  v_add_f32 v177, v177, v67
  v_add_f32 v162, v162, v67
  v_add_f32 v163, v163, v67
  v_add_f32 v166, v166, v67
  v_add_f32 v167, v167, v67
  v_add_f32 v170, v170, v67
  v_add_f32 v171, v171, v67
  v_add_f32 v174, v174, v67
  v_add_f32 v175, v175, v67
  v_cvt_pk_bf16_f32 v40, v160, v161
  v_cvt_pk_bf16_f32 v41, v164, v165
  v_cvt_pk_bf16_f32 v42, v168, v169
  v_cvt_pk_bf16_f32 v43, v172, v173
  v_cvt_pk_bf16_f32 v44, v176, v177
  v_cvt_pk_bf16_f32 v45, v162, v163
  v_cvt_pk_bf16_f32 v46, v166, v167
  v_cvt_pk_bf16_f32 v47, v170, v171
  v_cvt_pk_bf16_f32 v48, v174, v175
  v_permlane32_swap_b32 v40, v42
  v_permlane32_swap_b32 v41, v43
  v_permlane32_swap_b32 v44, v46
  v_permlane32_swap_b32 v45, v47
  v_permlane16_swap_b32 v40, v41
  v_permlane16_swap_b32 v42, v43
  v_permlane16_swap_b32 v44, v45
  v_permlane16_swap_b32 v46, v47
  buffer_store_dwordx2 v[40:41], v10, s[48:51], 0 offen
  buffer_store_dwordx2 v[42:43], v10, s[48:51], 0 offen offset:32
  buffer_store_dwordx2 v[44:45], v10, s[48:51], 0 offen offset:512
  buffer_store_dwordx2 v[46:47], v10, s[48:51], 0 offen offset:544
  buffer_store_dword v48, v11, s[48:51], 0 offen offset:1024
L_main_end:
  s_endpgm
L_sp_2:
  s_mov_b32 s100, 0
  s_mov_b32 s36, 0
L_sp_2_l:
  buffer_load_dword v31, v25, s[96:99], s36 offen sc1
  s_add_u32 s100, s100, 1
  s_cmp_gt_u32 s100, 65536
  s_cbranch_scc1 L_bk_3
  s_waitcnt vmcnt(0)
  v_cmp_eq_u32 vcc, 0, v31
  s_cbranch_vccnz L_sp_2_l
  s_branch L_bk_3
L_sp_5:
  s_mov_b32 s100, 0
  s_mov_b32 s36, 32768
L_sp_5_l:
  buffer_load_dword v31, v30, s[96:99], s36 offen sc1
  s_add_u32 s100, s100, 1
  s_cmp_gt_u32 s100, 65536
  s_cbranch_scc1 L_bk_6
  s_waitcnt vmcnt(0)
  v_cmp_eq_u32 vcc, 0, v31
  s_cbranch_vccnz L_sp_5_l
  s_branch L_bk_6
L_sp_8:
  s_mov_b32 s100, 0
  s_mov_b32 s36, 65536
L_sp_8_l:
  buffer_load_dword v31, v30, s[96:99], s36 offen sc1
  s_add_u32 s100, s100, 1
  s_cmp_gt_u32 s100, 65536
  s_cbranch_scc1 L_bk_9
  s_waitcnt vmcnt(0)
  v_cmp_eq_u32 vcc, 0, v31
  s_cbranch_vccnz L_sp_8_l
  s_branch L_bk_9
L_sp_11:
  s_mov_b32 s100, 0
  s_mov_b32 s63, 131072
L_sp_11_l:
  buffer_load_dword v31, v91, s[96:99], s63 offen sc1
  s_add_u32 s100, s100, 1
  s_cmp_gt_u32 s100, 65536
  s_cbranch_scc1 L_bk_12
  s_waitcnt vmcnt(0)
  v_cmp_eq_u32 vcc, 0, v31
  s_cbranch_vccnz L_sp_11_l
  s_branch L_bk_12
L_sp_14:
  s_mov_b32 s100, 0
  s_mov_b32 s63, 163840
L_sp_14_l:
  buffer_load_dword v31, v91, s[96:99], s63 offen sc1
  s_add_u32 s100, s100, 1
  s_cmp_gt_u32 s100, 65536
  s_cbranch_scc1 L_bk_15
  s_waitcnt vmcnt(0)
  v_cmp_eq_u32 vcc, 0, v31
  s_cbranch_vccnz L_sp_14_l
  s_branch L_bk_15
L_sp_17:
  s_mov_b32 s100, 0
  s_mov_b32 s63, 196608
L_sp_17_l:
  buffer_load_dword v31, v91, s[96:99], s63 offen sc1
  s_add_u32 s100, s100, 1
  s_cmp_gt_u32 s100, 65536
  s_cbranch_scc1 L_bk_18
  s_waitcnt vmcnt(0)
  v_cmp_eq_u32 vcc, 0, v31
  s_cbranch_vccnz L_sp_17_l
  s_branch L_bk_18
L_sp_20:
  s_mov_b32 s100, 0
  s_mov_b32 s63, 262144
L_sp_20_l:
  buffer_load_dword v31, v30, s[96:99], s63 offen sc1
  s_add_u32 s100, s100, 1
  s_cmp_gt_u32 s100, 65536
  s_cbranch_scc1 L_bk_21
  s_waitcnt vmcnt(0)
  v_cmp_eq_u32 vcc, 0, v31
  s_cbranch_vccnz L_sp_20_l
  s_branch L_bk_21
L_sp_23:
  s_mov_b32 s100, 0
  s_mov_b32 s63, 294912
L_sp_23_l:
  buffer_load_dword v31, v30, s[96:99], s63 offen sc1
  s_add_u32 s100, s100, 1
  s_cmp_gt_u32 s100, 65536
  s_cbranch_scc1 L_bk_24
  s_waitcnt vmcnt(0)
  v_cmp_eq_u32 vcc, 0, v31
  s_cbranch_vccnz L_sp_23_l
  s_branch L_bk_24
L_sp_26:
  s_mov_b32 s100, 0
  s_mov_b32 s63, 327680
L_sp_26_l:
  buffer_load_dword v31, v30, s[96:99], s63 offen sc1
  s_add_u32 s100, s100, 1
  s_cmp_gt_u32 s100, 65536
  s_cbranch_scc1 L_bk_27
  s_waitcnt vmcnt(0)
  v_cmp_eq_u32 vcc, 0, v31
  s_cbranch_vccnz L_sp_26_l
  s_branch L_bk_27
L_sp_29:
  s_mov_b32 s100, 0
  s_mov_b32 s63, 393216
L_sp_29_l:
  buffer_load_dword v31, v30, s[96:99], s63 offen sc1
  s_add_u32 s100, s100, 1
  s_cmp_gt_u32 s100, 65536
  s_cbranch_scc1 L_bk_30
  s_waitcnt vmcnt(0)
  v_cmp_eq_u32 vcc, 0, v31
  s_cbranch_vccnz L_sp_29_l
  s_branch L_bk_30
L_code_end:
.section .rodata,"a"
.p2align 6
.amdhsa_kernel interleave_layers__sliding_local_dilated__glu_gated_bilinear__prompt_kernel
  .amdhsa_next_free_vgpr 128
  .amdhsa_next_free_sgpr 102
  .amdhsa_accum_offset 128
  .amdhsa_group_segment_fixed_size 0
  .amdhsa_kernarg_size 80
  .amdhsa_user_sgpr_count 2
  .amdhsa_user_sgpr_kernarg_segment_ptr 1
  .amdhsa_system_sgpr_workgroup_id_x 1
  .amdhsa_float_denorm_mode_32 3
.end_amdhsa_kernel
.p2align 6
.amdhsa_kernel main_kernel
  .amdhsa_next_free_vgpr 512
  .amdhsa_next_free_sgpr 102
  .amdhsa_accum_offset 256
  .amdhsa_group_segment_fixed_size 0
  .amdhsa_kernarg_size 80
  .amdhsa_user_sgpr_count 2
  .amdhsa_user_sgpr_kernarg_segment_ptr 1
  .amdhsa_system_sgpr_workgroup_id_x 1
  .amdhsa_float_denorm_mode_32 3
.end_amdhsa_kernel
```

```asm
; @launch grid=(256,1,1) block=(256,1,1) lds=163840
.amdgcn_target "amdgcn-amd-amdhsa--gfx950"
.text
.globl interleave_layers__sliding_local_dilated__glu_gated_bilinear__prompt_kernel
.p2align 8
.type interleave_layers__sliding_local_dilated__glu_gated_bilinear__prompt_kernel,@function
interleave_layers__sliding_local_dilated__glu_gated_bilinear__prompt_kernel:
  s_cmp_ge_u32 s2, 256
  s_cbranch_scc1 L_main_end
  s_load_dwordx4 s[44:47], s[0:1], 0
  s_load_dwordx2 s[48:49], s[0:1], 16
  s_load_dwordx2 s[86:87], s[0:1], 72
  s_load_dwordx4 s[80:83], s[0:1], 32
  s_load_dwordx2 s[84:85], s[0:1], 48
  s_load_dwordx4 s[76:79], s[0:1], 56
  s_getpc_b64 s[74:75]
L_pc:
  s_lshr_b32 s36, s2, 3
  s_lshl_b32 s36, s36, 11
  v_and_b32 v113, 15, v0
  v_lshl_add_u32 v113, v113, 7, s36
  v_min_u32 v113, L_code_end-L_pc-4, v113
  global_load_dword v114, v113, s[74:75]
  v_lshrrev_b32 v1, 6, v0
  s_mov_b32 s95, 0
  v_readfirstlane_b32 s92, v1
  s_and_b32 s36, s2, 7
  s_lshr_b32 s37, s2, 3
  s_and_b32 s94, s36, 3
  s_lshl_b32 s94, s94, 2
  s_and_b32 s38, s37, 3
  s_add_u32 s94, s94, s38
  s_lshr_b32 s93, s36, 2
  s_lshl_b32 s93, s93, 3
  s_lshr_b32 s38, s37, 2
  s_add_u32 s93, s93, s38
  v_and_b32 v112, 1, v0
  v_lshlrev_b32 v112, 2, v112
  v_and_b32 v1, 63, v0
  v_lshrrev_b32 v2, 3, v1
  v_and_b32 v3, 7, v1
  s_lshl_b32 s36, s93, 4
  s_add_u32 s33, s36, s94
  s_lshl_b32 s36, s33, 3
  v_add_u32 v13, s36, v3
  v_mul_u32_u24 v13, 1152, v13
  v_lshrrev_b32 v12, 2, v2
  v_lshl_add_u32 v13, v12, 6, v13
  v_and_b32 v12, 3, v2
  v_lshl_add_u32 v13, v12, 3, v13
  s_lshl_b32 s37, s92, 8
  v_add_u32 v6, s37, v13
  s_lshr_b32 s37, s92, 1
  s_lshl_b32 s37, s37, 5
  s_and_b32 s38, s92, 1
  s_lshl_b32 s38, s38, 2
  s_add_u32 s37, s37, s38
  s_add_u32 s37, s37, 1024
  v_add_u32 v7, s37, v13
  v_mov_b32 v11, 0x7ffffff0
  s_waitcnt lgkmcnt(0)
  s_mov_b32 s4, s44
  s_and_b32 s5, s45, 0xffff
  s_mov_b32 s6, 2359296
  s_mov_b32 s7, 0x20000
  buffer_load_dwordx2 v[24:25], v6, s[4:7], 0 offen
  buffer_load_dwordx2 v[26:27], v6, s[4:7], 0 offen offset:32
  buffer_load_dwordx2 v[28:29], v6, s[4:7], 0 offen offset:128
  buffer_load_dwordx2 v[30:31], v6, s[4:7], 0 offen offset:160
  buffer_load_dword v32, v7, s[4:7], 0 offen
  s_mov_b32 s8, s46
  s_and_b32 s9, s47, 0xffff
  s_mov_b32 s10, 1990656
  s_mov_b32 s11, 0x20000
  s_lshl_b32 s53, s93, 2
  s_add_u32 s53, s53, s92
  v_and_b32 v34, 15, v1
  v_lshrrev_b32 v35, 4, v1
  s_mul_hi_u32 s55, s53, 613566757
  s_mul_i32 s37, s55, 7
  s_sub_u32 s54, s53, s37
  s_lshl_b32 s37, s54, 4
  v_add_u32 v36, s37, v34
  v_cmp_le_u32 vcc, 40, v36
  v_subrev_u32 v38, 40, v36
  s_nop 0
  v_cndmask_b32 v39, v36, v38, vcc
  v_cndmask_b32 v37, 0, 18, vcc
  v_cmp_le_u32 vcc, 18, v39
  v_add_u32 v37, v37, v39
  v_add_u32 v38, 558, v37
  v_cndmask_b32 v37, v37, v38, vcc
  v_cmp_le_u32 vcc, 76, v36
  v_add_u32 v37, 576, v37
  v_subrev_u32 v38, 76, v36
  v_cndmask_b32 v37, v37, v38, vcc
  s_mul_i32 s37, s94, 72
  s_mul_i32 s38, s55, 221184
  s_add_u32 s37, s37, s38
  v_mul_u32_u24 v38, 13824, v35
  v_lshl_add_u32 v38, v37, 1, v38
  v_add_u32 v52, s37, v38
  v_subrev_u32 v38, 36, v36
  v_cmp_gt_u32 vcc, 4, v38
  s_cmp_lt_u32 s53, 63
  s_cselect_b32 s39, 0, 0x7ffffff0
  v_cndmask_b32 v52, v52, v11, vcc
  v_or_b32 v52, s39, v52
  s_mov_b32 s37, 0
  buffer_load_ushort v40, v52, s[8:11], s37 offen
  buffer_load_ushort v100, v52, s[8:11], s37 offen offset:3456
  s_mov_b32 s37, 6912
  buffer_load_ushort v41, v52, s[8:11], s37 offen
  buffer_load_ushort v101, v52, s[8:11], s37 offen offset:3456
  s_mov_b32 s37, 55296
  buffer_load_ushort v42, v52, s[8:11], s37 offen
  buffer_load_ushort v102, v52, s[8:11], s37 offen offset:3456
  s_mov_b32 s37, 62208
  buffer_load_ushort v43, v52, s[8:11], s37 offen
  buffer_load_ushort v103, v52, s[8:11], s37 offen offset:3456
  s_mov_b32 s37, 110592
  buffer_load_ushort v44, v52, s[8:11], s37 offen
  buffer_load_ushort v104, v52, s[8:11], s37 offen offset:3456
  s_mov_b32 s37, 117504
  buffer_load_ushort v45, v52, s[8:11], s37 offen
  buffer_load_ushort v105, v52, s[8:11], s37 offen offset:3456
  s_mov_b32 s37, 165888
  buffer_load_ushort v46, v52, s[8:11], s37 offen
  buffer_load_ushort v106, v52, s[8:11], s37 offen offset:3456
  s_mov_b32 s37, 172800
  buffer_load_ushort v47, v52, s[8:11], s37 offen
  buffer_load_ushort v107, v52, s[8:11], s37 offen offset:3456
  s_mov_b32 s12, s48
  s_and_b32 s13, s49, 0xffff
  s_mov_b32 s14, 663552
  s_mov_b32 s15, 0x20000
  s_mul_i32 s37, s94, 126
  s_mul_i32 s38, s55, 14
  s_add_u32 s37, s37, s38
  s_add_u32 s37, s37, s54
  s_lshl_b32 s37, s37, 10
  v_lshl_add_u32 v56, v1, 4, s37
  v_or_b32 v56, s39, v56
  s_lshl_b32 s52, s2, 2
  s_add_u32 s52, s52, s92
  s_mul_hi_u32 s54, s52, 238609295
  s_mul_i32 s37, s54, 18
  s_sub_u32 s55, s52, s37
  v_lshrrev_b32 v36, 1, v35
  v_mul_u32_u24 v36, 18, v36
  v_and_b32 v37, 1, v35
  v_lshl_add_u32 v36, v37, 3, v36
  s_mul_i32 s37, s55, 36
  v_add_u32 v36, s37, v36
  v_mul_u32_u24 v37, 72, v35
  s_mul_i32 s37, s55, 288
  s_sub_u32 s37, s37, 4592
  v_add_u32 v37, s37, v37
  s_cmp_lt_u32 s55, 16
  s_cselect_b64 vcc, -1, 0
  v_cndmask_b32 v38, v37, v36, vcc
  s_cselect_b32 s60, 2, 18
  s_mul_i32 s60, s60, 1152
  s_mul_i32 s61, s60, 2
  s_mul_i32 s62, s60, 3
  v_mul_u32_u24 v38, 1152, v38
  s_lshl_b32 s37, s54, 5
  v_lshl_add_u32 v36, v34, 1, s37
  v_add_u32 v54, v38, v36
  s_lshl_b32 s37, s52, 10
  v_lshl_add_u32 v58, v1, 4, s37
  s_cmp_lt_u32 s52, 648
  s_cselect_b32 s37, 0, 0x7ffffff0
  v_or_b32 v54, s37, v54
  v_or_b32 v58, s37, v58
  buffer_load_ushort v48, v54, s[12:15], 0 offen
  buffer_load_ushort v108, v54, s[12:15], 0 offen offset:1152
  buffer_load_ushort v49, v54, s[12:15], s60 offen
  buffer_load_ushort v109, v54, s[12:15], s60 offen offset:1152
  buffer_load_ushort v50, v54, s[12:15], s61 offen
  buffer_load_ushort v110, v54, s[12:15], s61 offen offset:1152
  buffer_load_ushort v51, v54, s[12:15], s62 offen
  buffer_load_ushort v111, v54, s[12:15], s62 offen offset:1152
  s_cmp_lt_u32 s2, 238
  s_cbranch_scc1 L_wb_a
  s_sub_u32 s55, s2, 238
  v_mov_b32 v35, s92
  v_lshrrev_b32 v36, 1, v35
  v_mul_u32_u24 v36, 18, v36
  v_and_b32 v37, 1, v35
  v_lshl_add_u32 v36, v37, 3, v36
  s_mul_i32 s37, s55, 36
  v_add_u32 v36, s37, v36
  v_mul_u32_u24 v37, 72, v35
  s_mul_i32 s37, s55, 288
  s_sub_u32 s37, s37, 4592
  v_add_u32 v37, s37, v37
  s_cmp_lt_u32 s55, 16
  s_cselect_b64 vcc, -1, 0
  v_cndmask_b32 v38, v37, v36, vcc
  v_lshrrev_b32 v36, 1, v2
  v_mul_u32_u24 v36, 18, v36
  v_and_b32 v37, 1, v2
  v_add_u32 v36, v36, v37
  v_cndmask_b32 v36, v36, v2, vcc
  v_add_u32 v38, v38, v36
  v_mul_u32_u24 v38, 1152, v38
  v_lshl_add_u32 v59, v3, 4, v38
  buffer_load_dwordx4 v[128:131], v59, s[12:15], 0 offen
  buffer_load_dwordx4 v[132:135], v59, s[12:15], 0 offen offset:128
  buffer_load_dwordx4 v[136:139], v59, s[12:15], 0 offen offset:256
  buffer_load_dwordx4 v[140:143], v59, s[12:15], 0 offen offset:384
  buffer_load_dwordx4 v[144:147], v59, s[12:15], 0 offen offset:512
  buffer_load_dwordx4 v[148:151], v59, s[12:15], 0 offen offset:640
  buffer_load_dwordx4 v[152:155], v59, s[12:15], 0 offen offset:768
  buffer_load_dwordx4 v[156:159], v59, s[12:15], 0 offen offset:896
  buffer_load_dwordx4 v[160:163], v59, s[12:15], 0 offen offset:1024
L_wb_a:
  s_mov_b32 s72, s78
  s_and_b32 s73, s79, 0xffff
  s_mov_b32 s74, 8
  s_mov_b32 s75, 0x20000
  s_cmp_lg_u32 s2, 0
  s_cbranch_scc1 L_tg_1
  s_memrealtime s[36:37]
  s_waitcnt lgkmcnt(0)
  s_or_b32 s36, s36, 1
  s_or_b32 s37, s37, 0x80000000
  v_mov_b32 v12, s36
  v_mov_b32 v13, s37
  v_cmp_eq_u32 vcc, 0, v112
  s_nop 1
  v_cndmask_b32 v12, v13, v12, vcc
  v_lshlrev_b32 v13, 2, v0
  buffer_store_dword v12, v13, s[72:75], 0 offen sc1
L_tg_1:
  s_mov_b32 s88, s76
  s_mov_b32 s89, s77
  s_add_u32 s90, s86, 3796992
  s_addc_u32 s91, s87, 0
  s_add_u32 s96, s90, 7249920
  s_addc_u32 s97, s91, 0
  s_and_b32 s97, s97, 0xffff
  s_mov_b32 s98, 46047232
  s_mov_b32 s99, 0x20000
  v_lshrrev_b32 v113, 3, v0
  v_and_b32 v120, 15, v113
  v_lshlrev_b32 v120, 15, v120
  v_lshrrev_b32 v113, 4, v113
  s_mov_b32 s36, 45522944
  v_mul_lo_u32 v113, v113, s36
  v_add_u32 v113, v113, v120
  v_and_b32 v120, 7, v0
  v_lshl_add_u32 v113, v120, 4, v113
  s_lshl_b32 s36, s93, 11
  s_lshl_b32 s37, s94, 7
  s_add_u32 s36, s36, s37
  v_mov_b32 v120, 0
  v_mov_b32 v121, 0
  v_mov_b32 v122, 0
  v_mov_b32 v123, 0
  buffer_store_dwordx4 v[120:123], v113, s[96:99], s36 offen sc1
  s_mov_b32 s64, s80
  s_and_b32 s65, s81, 0xffff
  s_mov_b32 s66, 5308416
  s_mov_b32 s67, 0x20000
  s_mov_b32 s68, s82
  s_and_b32 s69, s83, 0xffff
  s_mov_b32 s70, 5308416
  s_mov_b32 s71, 0x20000
  s_mul_i32 s36, s93, 36
  v_add_u32 v113, s36, v0
  v_mul_u32_u24 v113, 9216, v113
  s_mul_i32 s36, s94, 576
  s_and_b32 s36, s36, 0xffffff80
  v_add_u32 v113, s36, v113
  v_mov_b32 v115, 0x7ffffff0
  v_cmp_gt_u32 vcc, 36, v0
  s_nop 1
  v_cndmask_b32 v116, v115, v113, vcc
  s_lshl_b32 s36, s94, 4
  s_add_u32 s36, s36, s93
  s_mul_i32 s36, s36, 20736
  v_lshl_add_u32 v113, v0, 7, s36
  v_cmp_gt_u32 vcc, 54, v0
  s_nop 1
  v_cndmask_b32 v117, v115, v113, vcc
  s_cmp_eq_u32 s95, 0
  s_cselect_b32 s36, 0, 0x7ffffff0
  v_or_b32 v116, s36, v116
  v_or_b32 v117, s36, v117
  s_and_b32 s38, s94, 1
  s_add_u32 s38, s38, 0
  s_cmp_eq_u32 s38, 5
  s_cselect_b32 s38, 0, s38
  s_lshl_b32 s38, s38, 7
  buffer_load_dword v118, v116, s[64:67], s38 offen
  buffer_load_dword v118, v116, s[68:71], s38 offen
  s_lshr_b32 s36, s33, 1
  s_mul_i32 s36, s36, 18432
  s_and_b32 s37, s33, 1
  s_lshl_b32 s37, s37, 7
  s_add_u32 s36, s36, s37
  v_lshlrev_b32 v12, 8, v2
  v_lshl_add_u32 v12, v3, 4, v12
  s_lshl_b32 s37, s92, 12
  s_add_u32 s37, s37, s36
  v_add_u32 v4, s37, v12
  s_lshl_b32 s37, s92, 2
  s_add_u32 s37, s37, s36
  s_add_u32 s37, s37, 16384
  v_add_u32 v5, s37, v12
  v_lshlrev_b32 v10, 4, v3
  s_lshl_b32 s37, s92, 2
  v_add_u32 v9, s37, v10
  s_add_u32 s16, s86, 3796992
  s_addc_u32 s17, s87, 0
  s_and_b32 s17, s17, 0xffff
  s_mov_b32 s18, 2359296
  s_mov_b32 s19, 0x20000
  s_add_u32 s20, s86, 10874880
  s_addc_u32 s21, s87, 0
  s_and_b32 s21, s21, 0xffff
  s_mov_b32 s22, 32768
  s_mov_b32 s23, 0x20000
  s_add_u32 s28, s86, 0
  s_addc_u32 s29, s87, 0
  s_and_b32 s29, s29, 0xffff
  s_mov_b32 s30, 2064384
  s_mov_b32 s31, 0x20000
  s_add_u32 s40, s86, 2064384
  s_addc_u32 s41, s87, 0
  s_and_b32 s41, s41, 0xffff
  s_mov_b32 s42, 681984
  s_mov_b32 s43, 0x20000
  s_mov_b32 s56, 7168
  s_waitcnt vmcnt(31)
  v_lshlrev_b32 v64, 16, v24
  v_and_b32 v65, 0xffff0000, v24
  v_lshlrev_b32 v66, 16, v25
  v_and_b32 v67, 0xffff0000, v25
  s_waitcnt vmcnt(30)
  v_lshlrev_b32 v68, 16, v26
  v_and_b32 v69, 0xffff0000, v26
  v_lshlrev_b32 v70, 16, v27
  v_and_b32 v71, 0xffff0000, v27
  s_waitcnt vmcnt(29)
  v_lshlrev_b32 v72, 16, v28
  v_and_b32 v73, 0xffff0000, v28
  v_lshlrev_b32 v74, 16, v29
  v_and_b32 v75, 0xffff0000, v29
  s_waitcnt vmcnt(28)
  v_lshlrev_b32 v76, 16, v30
  v_and_b32 v77, 0xffff0000, v30
  v_lshlrev_b32 v78, 16, v31
  v_and_b32 v79, 0xffff0000, v31
  s_waitcnt vmcnt(27)
  v_lshlrev_b32 v80, 16, v32
  v_and_b32 v81, 0xffff0000, v32
  v_add_f32 v14, v64, v65
  v_add_f32 v15, v66, v67
  v_add_f32 v14, v14, v68
  v_add_f32 v15, v15, v69
  v_add_f32 v14, v14, v70
  v_add_f32 v15, v15, v71
  v_add_f32 v14, v14, v72
  v_add_f32 v15, v15, v73
  v_add_f32 v14, v14, v74
  v_add_f32 v15, v15, v75
  v_add_f32 v14, v14, v76
  v_add_f32 v15, v15, v77
  v_add_f32 v14, v14, v78
  v_add_f32 v15, v15, v79
  v_add_f32 v14, v14, v80
  v_add_f32 v15, v15, v81
  v_add_f32 v14, v14, v15
  s_nop 1
  v_add_f32_dpp v14, v14, v14 row_ror:8 row_mask:0xf bank_mask:0xf
  v_mov_b32 v15, v14
  s_nop 1
  v_permlane16_swap_b32 v14, v15
  v_add_f32 v14, v14, v15
  v_mov_b32 v15, v14
  s_nop 1
  v_permlane32_swap_b32 v14, v15
  v_add_f32 v14, v14, v15
  ds_write_b32 v9, v14
  s_waitcnt lgkmcnt(0)
  s_barrier
  ds_read_b128 v[16:19], v10
  s_waitcnt lgkmcnt(0)
  v_add_f32 v16, v16, v17
  v_add_f32 v18, v18, v19
  v_add_f32 v14, v16, v18
  v_mul_f32 v14, 0x3ae38e39, v14
  v_sub_f32 v64, v64, v14
  v_sub_f32 v65, v65, v14
  v_sub_f32 v66, v66, v14
  v_sub_f32 v67, v67, v14
  v_sub_f32 v68, v68, v14
  v_sub_f32 v69, v69, v14
  v_sub_f32 v70, v70, v14
  v_sub_f32 v71, v71, v14
  v_sub_f32 v72, v72, v14
  v_sub_f32 v73, v73, v14
  v_sub_f32 v74, v74, v14
  v_sub_f32 v75, v75, v14
  v_sub_f32 v76, v76, v14
  v_sub_f32 v77, v77, v14
  v_sub_f32 v78, v78, v14
  v_sub_f32 v79, v79, v14
  v_sub_f32 v80, v80, v14
  v_sub_f32 v81, v81, v14
  v_mul_f32 v20, v64, v64
  v_mul_f32 v21, v65, v65
  v_fmac_f32 v20, v66, v66
  v_fmac_f32 v21, v67, v67
  v_fmac_f32 v20, v68, v68
  v_fmac_f32 v21, v69, v69
  v_fmac_f32 v20, v70, v70
  v_fmac_f32 v21, v71, v71
  v_fmac_f32 v20, v72, v72
  v_fmac_f32 v21, v73, v73
  v_fmac_f32 v20, v74, v74
  v_fmac_f32 v21, v75, v75
  v_fmac_f32 v20, v76, v76
  v_fmac_f32 v21, v77, v77
  v_fmac_f32 v20, v78, v78
  v_fmac_f32 v21, v79, v79
  v_fmac_f32 v20, v80, v80
  v_fmac_f32 v21, v81, v81
  v_add_f32 v20, v20, v21
  v_cvt_pk_bf16_f32 v24, v64, v65
  v_cvt_pk_bf16_f32 v25, v66, v67
  v_cvt_pk_bf16_f32 v26, v68, v69
  v_cvt_pk_bf16_f32 v27, v70, v71
  v_cvt_pk_bf16_f32 v28, v72, v73
  v_cvt_pk_bf16_f32 v29, v74, v75
  v_cvt_pk_bf16_f32 v30, v76, v77
  v_cvt_pk_bf16_f32 v31, v78, v79
  v_cvt_pk_bf16_f32 v32, v80, v81
  buffer_store_dwordx4 v[24:27], v4, s[16:19], 0 offen sc1
  buffer_store_dwordx4 v[28:31], v4, s[16:19], 0 offen offset:2048 sc1
  buffer_store_dword v32, v5, s[16:19], 0 offen sc1
  v_add_f32_dpp v20, v20, v20 row_ror:8 row_mask:0xf bank_mask:0xf
  v_mov_b32 v15, v20
  s_nop 1
  v_permlane16_swap_b32 v20, v15
  v_add_f32 v20, v20, v15
  v_mov_b32 v15, v20
  s_nop 1
  v_permlane32_swap_b32 v20, v15
  v_add_f32 v20, v20, v15
  ds_write_b32 v9, v20 offset:128
  s_waitcnt lgkmcnt(0)
  s_barrier
  ds_read_b128 v[16:19], v10 offset:128
  s_waitcnt lgkmcnt(0)
  v_add_f32 v16, v16, v17
  v_add_f32 v18, v18, v19
  v_add_f32 v20, v16, v18
  v_mov_b32 v15, 0x3727c5ac
  v_fmac_f32 v15, 0x3ae38e39, v20
  v_rsq_f32 v15, v15
  v_and_b32 v22, 8, v0
  v_cmp_eq_u32 vcc, 0, v22
  s_nop 1
  v_cndmask_b32 v14, v14, v15, vcc
  s_lshl_b32 s36, s33, 7
  v_lshl_add_u32 v22, v0, 2, s36
  v_cmp_gt_u32 vcc, 32, v0
  s_nop 1
  v_cndmask_b32 v22, v11, v22, vcc
  buffer_store_dword v14, v22, s[20:23], 0 offen sc1
  s_waitcnt vmcnt(29)
  v_lshl_or_b32 v40, v100, 16, v40
  s_waitcnt vmcnt(27)
  v_lshl_or_b32 v41, v101, 16, v41
  s_waitcnt vmcnt(25)
  v_lshl_or_b32 v42, v102, 16, v42
  s_waitcnt vmcnt(23)
  v_lshl_or_b32 v43, v103, 16, v43
  s_waitcnt vmcnt(21)
  v_lshl_or_b32 v44, v104, 16, v44
  s_waitcnt vmcnt(19)
  v_lshl_or_b32 v45, v105, 16, v45
  s_waitcnt vmcnt(17)
  v_lshl_or_b32 v46, v106, 16, v46
  s_waitcnt vmcnt(15)
  v_lshl_or_b32 v47, v107, 16, v47
  s_waitcnt vmcnt(13)
  v_lshl_or_b32 v48, v108, 16, v48
  s_waitcnt vmcnt(11)
  v_lshl_or_b32 v49, v109, 16, v49
  s_waitcnt vmcnt(9)
  v_lshl_or_b32 v50, v110, 16, v50
  s_waitcnt vmcnt(7)
  v_lshl_or_b32 v51, v111, 16, v51
  buffer_store_dwordx4 v[40:43], v56, s[28:31], 0 offen sc1
  buffer_store_dwordx4 v[44:47], v56, s[28:31], s56 offen sc1
  buffer_store_dwordx4 v[48:51], v58, s[40:43], 0 offen sc1
  s_cmp_lt_u32 s2, 238
  s_cbranch_scc1 L_wb_b
  s_waitcnt vmcnt(10)
  v_mov_b32 v36, 0
  v_mov_b32 v37, 0
  s_mov_b32 s37, 0x3f803f80
  v_dot2c_f32_bf16 v36, s37, v128
  v_dot2c_f32_bf16 v37, s37, v129
  v_dot2c_f32_bf16 v36, s37, v130
  v_dot2c_f32_bf16 v37, s37, v131
  v_dot2c_f32_bf16 v36, s37, v132
  v_dot2c_f32_bf16 v37, s37, v133
  v_dot2c_f32_bf16 v36, s37, v134
  v_dot2c_f32_bf16 v37, s37, v135
  v_dot2c_f32_bf16 v36, s37, v136
  v_dot2c_f32_bf16 v37, s37, v137
  v_dot2c_f32_bf16 v36, s37, v138
  v_dot2c_f32_bf16 v37, s37, v139
  v_dot2c_f32_bf16 v36, s37, v140
  v_dot2c_f32_bf16 v37, s37, v141
  v_dot2c_f32_bf16 v36, s37, v142
  v_dot2c_f32_bf16 v37, s37, v143
  v_dot2c_f32_bf16 v36, s37, v144
  v_dot2c_f32_bf16 v37, s37, v145
  v_dot2c_f32_bf16 v36, s37, v146
  v_dot2c_f32_bf16 v37, s37, v147
  v_dot2c_f32_bf16 v36, s37, v148
  v_dot2c_f32_bf16 v37, s37, v149
  v_dot2c_f32_bf16 v36, s37, v150
  v_dot2c_f32_bf16 v37, s37, v151
  v_dot2c_f32_bf16 v36, s37, v152
  v_dot2c_f32_bf16 v37, s37, v153
  v_dot2c_f32_bf16 v36, s37, v154
  v_dot2c_f32_bf16 v37, s37, v155
  v_dot2c_f32_bf16 v36, s37, v156
  v_dot2c_f32_bf16 v37, s37, v157
  v_dot2c_f32_bf16 v36, s37, v158
  v_dot2c_f32_bf16 v37, s37, v159
  v_dot2c_f32_bf16 v36, s37, v160
  v_dot2c_f32_bf16 v37, s37, v161
  v_dot2c_f32_bf16 v36, s37, v162
  v_dot2c_f32_bf16 v37, s37, v163
  s_nop 2
  v_add_f32 v36, v36, v37
  s_nop 1
  v_add_f32_dpp v36, v36, v36 quad_perm:[1,0,3,2] row_mask:0xf bank_mask:0xf
  s_nop 1
  v_add_f32_dpp v36, v36, v36 quad_perm:[2,3,0,1] row_mask:0xf bank_mask:0xf
  s_nop 1
  v_add_f32_dpp v36, v36, v36 row_half_mirror row_mask:0xf bank_mask:0xf
  v_mul_f32 v36, 0x3ae38e39, v36
  v_cvt_pk_bf16_f32 v37, v36, v36
  v_and_b32 v37, 0xffff0000, v37
  v_sub_f32 v36, v36, v37
  v_cvt_pk_bf16_f32 v36, v36, v36
  v_and_b32 v36, 0xffff, v36
  v_lshrrev_b32 v37, 16, v37
  s_nop 0
  v_readlane_b32 s64, v37, 0
  v_readlane_b32 s65, v37, 8
  v_readlane_b32 s66, v36, 0
  v_readlane_b32 s67, v36, 8
  s_nop 3
  s_lshl_b32 s65, s65, 16
  s_or_b32 s64, s64, s65
  s_lshl_b32 s67, s67, 16
  s_or_b32 s66, s66, s67
  v_mov_b32 v164, 0
  v_writelane_b32 v164, s64, 0
  v_writelane_b32 v164, s66, 1
  v_readlane_b32 s64, v37, 16
  v_readlane_b32 s65, v37, 24
  v_readlane_b32 s66, v36, 16
  v_readlane_b32 s67, v36, 24
  s_nop 3
  s_lshl_b32 s65, s65, 16
  s_or_b32 s64, s64, s65
  s_lshl_b32 s67, s67, 16
  s_or_b32 s66, s66, s67
  v_mov_b32 v165, 0
  v_writelane_b32 v165, s64, 0
  v_writelane_b32 v165, s66, 1
  v_readlane_b32 s64, v37, 32
  v_readlane_b32 s65, v37, 40
  v_readlane_b32 s66, v36, 32
  v_readlane_b32 s67, v36, 40
  s_nop 3
  s_lshl_b32 s65, s65, 16
  s_or_b32 s64, s64, s65
  s_lshl_b32 s67, s67, 16
  s_or_b32 s66, s66, s67
  v_mov_b32 v166, 0
  v_writelane_b32 v166, s64, 0
  v_writelane_b32 v166, s66, 1
  v_readlane_b32 s64, v37, 48
  v_readlane_b32 s65, v37, 56
  v_readlane_b32 s66, v36, 48
  v_readlane_b32 s67, v36, 56
  s_nop 3
  s_lshl_b32 s65, s65, 16
  s_or_b32 s64, s64, s65
  s_lshl_b32 s67, s67, 16
  s_or_b32 s66, s66, s67
  v_mov_b32 v167, 0
  v_writelane_b32 v167, s64, 0
  v_writelane_b32 v167, s66, 1
  s_add_u32 s37, s55, 648
  s_lshl_b32 s37, s37, 10
  s_lshl_b32 s38, s92, 8
  s_add_u32 s37, s37, s38
  v_lshl_add_u32 v38, v1, 4, s37
  v_cmp_gt_u32 vcc, 16, v1
  s_nop 1
  v_cndmask_b32 v38, v11, v38, vcc
  buffer_store_dwordx4 v[164:167], v38, s[40:43], 0 offen sc1
L_wb_b:
  buffer_load_dword v7, v112, s[72:75], 0 offen sc1
  s_lshl_b32 s36, s93, 11
  s_lshl_b32 s37, s94, 7
  s_add_u32 s37, s37, s36
  v_mov_b32 v31, 0x7ffffff0
  v_lshl_add_u32 v29, v0, 2, s37
  v_cmp_gt_u32 vcc, 32, v0
  s_nop 1
  v_cndmask_b32 v29, v31, v29, vcc
  v_bfe_u32 v30, v0, 1, 4
  v_lshlrev_b32 v30, 7, v30
  v_and_b32 v31, 1, v0
  v_lshl_add_u32 v30, v31, 2, v30
  v_add_u32 v30, s36, v30
  s_add_u32 s44, s86, 0
  s_addc_u32 s45, s87, 0
  s_and_b32 s45, s45, 0xffff
  s_mov_b32 s46, 2064384
  s_mov_b32 s47, 0x20000
  s_mul_i32 s36, s94, 129024
  s_lshl_b32 s101, s92, 12
  s_add_u32 s36, s36, s101
  v_and_b32 v94, 63, v0
  v_lshlrev_b32 v94, 4, v94
  v_add_u32 v94, s36, v94
  v_bfe_u32 v1, v0, 1, 4
  s_lshl_b32 s36, s94, 7
  v_lshl_add_u32 v1, v1, 11, s36
  v_add_u32 v1, v1, v112
  s_waitcnt vmcnt(0)
  v_cmp_eq_u32 vcc, 0, v7
  s_cbranch_vccnz L_sp_2
L_bk_3:
  s_barrier
  s_mov_b32 s36, 0
  buffer_store_dword v7, v29, s[96:99], s36 offen sc1
  s_mov_b32 s36, 0
  buffer_load_dword v31, v1, s[96:99], s36 offen sc1
  s_waitcnt vmcnt(0)
  v_cmp_ne_u32 vcc, v7, v31
  s_cbranch_vccnz L_sp_4
L_bk_5:
  s_add_u32 m0, s101, 0
  s_mov_b32 s38, 0
  buffer_load_dwordx4 v94, s[44:47], s38 offen lds
  buffer_load_dwordx4 v94, s[44:47], s38 offen offset:1024 lds
  buffer_load_dwordx4 v94, s[44:47], s38 offen offset:2048 lds
  buffer_load_dwordx4 v94, s[44:47], s38 offen offset:3072 lds
  s_add_u32 m0, s101, 16384
  s_mov_b32 s38, 16384
  buffer_load_dwordx4 v94, s[44:47], s38 offen lds
  buffer_load_dwordx4 v94, s[44:47], s38 offen offset:1024 lds
  buffer_load_dwordx4 v94, s[44:47], s38 offen offset:2048 lds
  buffer_load_dwordx4 v94, s[44:47], s38 offen offset:3072 lds
  s_add_u32 m0, s101, 32768
  s_mov_b32 s38, 32768
  buffer_load_dwordx4 v94, s[44:47], s38 offen lds
  buffer_load_dwordx4 v94, s[44:47], s38 offen offset:1024 lds
  buffer_load_dwordx4 v94, s[44:47], s38 offen offset:2048 lds
  buffer_load_dwordx4 v94, s[44:47], s38 offen offset:3072 lds
L_layer:
  v_and_b32 v20, 63, v0
  v_and_b32 v21, 15, v20
  v_lshrrev_b32 v22, 4, v20
  v_lshlrev_b32 v1, 4, v20
  v_add_u32 v2, 65536, v1
  v_add_u32 v19, 131072, v1
  s_lshl_b32 s36, s92, 10
  v_add_u32 v3, s36, v1
  v_add_u32 v4, 65536, v3
  s_lshl_b32 s36, s93, 3
  s_max_u32 s37, s36, 1
  s_sub_u32 s37, s37, 1
  s_lshl_b32 s38, s92, 1
  s_add_u32 s36, s36, s38
  v_lshrrev_b32 v23, 3, v21
  v_lshlrev_b32 v23, 7, v23
  v_and_b32 v24, 7, v21
  v_lshl_add_u32 v23, v24, 2, v23
  s_lshl_b32 s38, s37, 8
  v_add_u32 v8, s38, v23
  s_lshl_b32 s38, s36, 8
  v_add_u32 v9, s38, v23
  s_mul_i32 s37, s37, 18432
  s_mul_i32 s35, s92, 5120
  s_add_u32 s37, s37, s35
  v_add_u32 v5, s37, v1
  s_add_u32 s35, s35, 131072
  s_mul_i32 s36, s36, 18432
  v_add_u32 v6, s36, v1
  s_max_u32 s36, s93, 1
  s_sub_u32 s36, s36, 1
  s_lshl_b32 s36, s36, 11
  s_add_u32 s36, s36, 1792
  v_and_b32 v23, 135, v30
  v_add_u32 v23, s36, v23
  v_cmp_gt_u32 vcc, 32, v20
  s_nop 1
  v_cndmask_b32 v25, v23, v30, vcc
  s_mov_b32 s48, 0
  s_mov_b32 s53, 18432
  s_mov_b32 s49, 4096
  s_mov_b32 s54, 22528
  s_mov_b32 s50, 8192
  s_mov_b32 s55, 26624
  s_mov_b32 s51, 12288
  s_mov_b32 s56, 30720
  s_mov_b32 s52, 16384
  s_mov_b32 s57, 34816
  s_add_u32 s4, s90, 0
  s_addc_u32 s5, s91, 0
  s_and_b32 s5, s5, 0xffff
  s_mov_b32 s6, 2359296
  s_mov_b32 s7, 0x20000
  s_add_u32 s8, s90, 7077888
  s_addc_u32 s9, s91, 0
  s_and_b32 s9, s9, 0xffff
  s_mov_b32 s10, 32768
  s_mov_b32 s11, 0x20000
  s_add_u32 s12, s90, 4718592
  s_addc_u32 s13, s91, 0
  s_and_b32 s13, s13, 0xffff
  s_mov_b32 s14, 2359296
  s_mov_b32 s15, 0x20000
  v_mul_u32_u24 v23, 240, v21
  v_lshl_add_u32 v23, v22, 3, v23
  v_add_u32 v12, 129152, v23
  s_lshl_b32 s36, s92, 5
  s_add_u32 s37, s36, 129024
  v_add_u32 v11, s37, v23
  s_mul_i32 s36, s36, 240
  s_add_u32 s36, s36, 132864
  v_add_u32 v13, s36, v23
  v_lshrrev_b32 v26, 5, v20
  v_and_b32 v23, 31, v20
  s_lshl_b32 s36, s92, 5
  v_add_u32 v23, s36, v23
  v_mul_u32_u24 v24, 240, v23
  v_mul_u32_u24 v14, 80, v26
  v_add_u32 v14, v14, v24
  v_add_u32 v14, 129504, v14
  v_mul_u32_u24 v15, 36, v26
  v_add_u32 v15, v15, v24
  v_add_u32 v15, 133016, v15
  s_lshl_b32 s37, s93, 7
  v_add_u32 v23, s37, v23
  v_cmp_le_u32 s[64:65], 2, v23
  v_cmp_le_u32 s[66:67], 4, v23
  v_cmp_le_u32 s[68:69], 6, v23
  v_cmp_le_u32 s[70:71], 8, v23
  v_cmp_le_u32 s[72:73], 10, v23
  v_cmp_le_u32 s[74:75], 12, v23
  v_cmp_le_u32 s[76:77], 14, v23
  v_lshrrev_b32 v24, 4, v23
  v_mul_u32_u24 v24, 18432, v24
  v_lshl_add_u32 v16, v21, 4, v24
  v_lshl_add_u32 v16, v26, 9, v16
  s_lshl_b32 s37, s94, 10
  v_add_u32 v16, s37, v16
  v_lshl_add_u32 v17, v21, 2, v24
  v_lshl_add_u32 v17, v26, 6, v17
  s_lshl_b32 s37, s94, 7
  s_add_u32 s37, s37, 16384
  v_add_u32 v17, s37, v17
  v_mov_b32 v18, 0xceabfb8f
  s_mov_b32 s32, 0x05040100
  s_mov_b32 s33, 0x07060302
  s_mov_b32 s34, 0x3f803f80
  s_add_u32 s60, s86, 2064384
  s_addc_u32 s61, s87, 0
  s_and_b32 s61, s61, 0xffff
  s_mov_b32 s62, 681984
  s_mov_b32 s63, 0x20000
  s_and_b32 s36, s94, 3
  s_and_b32 s37, s36, 1
  s_mul_i32 s36, s36, 9
  s_add_u32 s38, s36, s37
  s_xor_b32 s37, s37, 1
  s_lshl_b32 s37, s37, 3
  s_add_u32 s36, s36, s37
  s_lshl_b32 s37, s92, 1
  s_add_u32 s38, s38, s37
  s_mul_i32 s38, s38, 18432
  v_add_u32 v250, s38, v1
  s_cmp_lt_u32 s92, 2
  s_cselect_b32 s36, s36, 36
  s_mul_i32 s36, s36, 18432
  v_add_u32 v251, s36, v1
  s_mov_b32 s36, 0
  buffer_load_dword v31, v25, s[96:99], s36 offen sc1
  s_waitcnt vmcnt(0)
  v_cmp_ne_u32 vcc, v7, v31
  s_cbranch_vccnz L_sp_10
L_bk_11:
  buffer_load_dwordx4 a[0:3], v6, s[4:7], s48 offen sc1
  buffer_load_dwordx4 a[72:75], v6, s[4:7], s53 offen sc1
  buffer_load_dwordx4 a[4:7], v6, s[4:7], s48 offen offset:1024 sc1
  buffer_load_dwordx4 a[76:79], v6, s[4:7], s53 offen offset:1024 sc1
  s_mov_b32 m0, s35
  s_nop 0
  buffer_load_dwordx4 v5, s[4:7], 0 offen sc1 lds
  buffer_load_dwordx4 v5, s[4:7], 0 offen offset:1024 sc1 lds
  buffer_load_dwordx4 v5, s[4:7], 0 offen offset:2048 sc1 lds
  buffer_load_dwordx4 v5, s[4:7], 0 offen offset:3072 sc1 lds
  s_add_u32 m0, s35, 4096
  s_nop 0
  buffer_load_dwordx4 v5, s[4:7], s49 offen sc1 lds
  buffer_load_dwordx4 a[8:11], v6, s[4:7], s48 offen offset:2048 sc1
  buffer_load_dwordx4 a[80:83], v6, s[4:7], s53 offen offset:2048 sc1
  buffer_load_dwordx4 a[12:15], v6, s[4:7], s48 offen offset:3072 sc1
  buffer_load_dwordx4 a[84:87], v6, s[4:7], s53 offen offset:3072 sc1
  s_waitcnt vmcnt(11)
  s_barrier
  ds_read_b128 v[176:179], v1
  ds_read_b128 v[180:183], v1 offset:1024
  ds_read_b128 v[184:187], v1 offset:2048
  ds_read_b128 v[188:191], v1 offset:3072
  ds_read_b128 v[192:195], v1 offset:4096
  ds_read_b128 v[196:199], v1 offset:5120
  ds_read_b128 v[200:203], v1 offset:6144
  s_waitcnt lgkmcnt(0)
  v_mfma_f32_16x16x32_bf16 v[112:115], v[176:179], a[0:3], 0
  ds_read_b128 v[204:207], v1 offset:7168
  v_mfma_f32_16x16x32_bf16 v[140:143], v[176:179], a[72:75], 0
  ds_read_b128 v[208:211], v1 offset:8192
  v_mfma_f32_16x16x32_bf16 v[116:119], v[180:183], a[0:3], 0
  ds_read_b128 v[212:215], v1 offset:9216
  v_mfma_f32_16x16x32_bf16 v[144:147], v[180:183], a[72:75], 0
  ds_read_b128 v[216:219], v1 offset:10240
  v_mfma_f32_16x16x32_bf16 v[120:123], v[184:187], a[0:3], 0
  ds_read_b128 v[220:223], v1 offset:11264
  v_mfma_f32_16x16x32_bf16 v[148:151], v[184:187], a[72:75], 0
  ds_read_b128 v[224:227], v1 offset:12288
  v_mfma_f32_16x16x32_bf16 v[124:127], v[188:191], a[0:3], 0
  ds_read_b128 v[228:231], v1 offset:13312
  v_mfma_f32_16x16x32_bf16 v[152:155], v[188:191], a[72:75], 0
  buffer_load_dwordx4 a[16:19], v6, s[4:7], s49 offen sc1
  v_mfma_f32_16x16x32_bf16 v[128:131], v[192:195], a[0:3], 0
  buffer_load_dwordx4 a[88:91], v6, s[4:7], s54 offen sc1
  v_mfma_f32_16x16x32_bf16 v[156:159], v[192:195], a[72:75], 0
  s_cmp_lg_u32 s95, 0
  s_cbranch_scc1 L_l0_12
  s_add_u32 m0, s101, 49152
  s_mov_b32 s36, 49152
  buffer_load_dwordx4 v94, s[44:47], s36 offen lds
  buffer_load_dwordx4 v94, s[44:47], s36 offen offset:1024 lds
  buffer_load_dwordx4 v94, s[44:47], s36 offen offset:2048 lds
  buffer_load_dwordx4 v94, s[44:47], s36 offen offset:3072 lds
L_l0_12:
  v_mfma_f32_16x16x32_bf16 v[132:135], v[196:199], a[0:3], 0
  v_mfma_f32_16x16x32_bf16 v[160:163], v[196:199], a[72:75], 0
  v_mfma_f32_16x16x32_bf16 v[136:139], v[200:203], a[0:3], 0
  v_mfma_f32_16x16x32_bf16 v[164:167], v[200:203], a[72:75], 0
  s_waitcnt vmcnt(11) lgkmcnt(0)
  v_mfma_f32_16x16x32_bf16 v[112:115], v[204:207], a[4:7], v[112:115]
  s_barrier
  v_mfma_f32_16x16x32_bf16 v[140:143], v[204:207], a[76:79], v[140:143]
  ds_read_b128 v[176:179], v1 offset:14336
  v_mfma_f32_16x16x32_bf16 v[116:119], v[208:211], a[4:7], v[116:119]
  ds_read_b128 v[180:183], v1 offset:15360
  v_mfma_f32_16x16x32_bf16 v[144:147], v[208:211], a[76:79], v[144:147]
  ds_read_b128 v[184:187], v1 offset:16384
  v_mfma_f32_16x16x32_bf16 v[120:123], v[212:215], a[4:7], v[120:123]
  ds_read_b128 v[188:191], v1 offset:17408
  v_mfma_f32_16x16x32_bf16 v[148:151], v[212:215], a[76:79], v[148:151]
  ds_read_b128 v[192:195], v1 offset:18432
  v_mfma_f32_16x16x32_bf16 v[124:127], v[216:219], a[4:7], v[124:127]
  ds_read_b128 v[196:199], v1 offset:19456
  v_mfma_f32_16x16x32_bf16 v[152:155], v[216:219], a[76:79], v[152:155]
  ds_read_b128 v[200:203], v1 offset:20480
  v_mfma_f32_16x16x32_bf16 v[128:131], v[220:223], a[4:7], v[128:131]
  buffer_load_dwordx4 a[20:23], v6, s[4:7], s49 offen offset:1024 sc1
  v_mfma_f32_16x16x32_bf16 v[156:159], v[220:223], a[76:79], v[156:159]
  buffer_load_dwordx4 a[92:95], v6, s[4:7], s54 offen offset:1024 sc1
  v_mfma_f32_16x16x32_bf16 v[132:135], v[224:227], a[4:7], v[132:135]
  v_mfma_f32_16x16x32_bf16 v[160:163], v[224:227], a[76:79], v[160:163]
  v_mfma_f32_16x16x32_bf16 v[136:139], v[228:231], a[4:7], v[136:139]
  v_mfma_f32_16x16x32_bf16 v[164:167], v[228:231], a[76:79], v[164:167]
  s_waitcnt vmcnt(6) lgkmcnt(0)
  v_mfma_f32_16x16x32_bf16 v[112:115], v[176:179], a[8:11], v[112:115]
  s_barrier
  v_mfma_f32_16x16x32_bf16 v[140:143], v[176:179], a[80:83], v[140:143]
  ds_read_b128 v[204:207], v1 offset:21504
  v_mfma_f32_16x16x32_bf16 v[116:119], v[180:183], a[8:11], v[116:119]
  ds_read_b128 v[208:211], v1 offset:22528
  v_mfma_f32_16x16x32_bf16 v[144:147], v[180:183], a[80:83], v[144:147]
  ds_read_b128 v[212:215], v1 offset:23552
  v_mfma_f32_16x16x32_bf16 v[120:123], v[184:187], a[8:11], v[120:123]
  ds_read_b128 v[216:219], v1 offset:24576
  v_mfma_f32_16x16x32_bf16 v[148:151], v[184:187], a[80:83], v[148:151]
  ds_read_b128 v[220:223], v1 offset:25600
  v_mfma_f32_16x16x32_bf16 v[124:127], v[188:191], a[8:11], v[124:127]
  ds_read_b128 v[224:227], v1 offset:26624
  v_mfma_f32_16x16x32_bf16 v[152:155], v[188:191], a[80:83], v[152:155]
  ds_read_b128 v[228:231], v1 offset:27648
  v_mfma_f32_16x16x32_bf16 v[128:131], v[192:195], a[8:11], v[128:131]
  ds_read_b128 v[32:35], v3
  v_mfma_f32_16x16x32_bf16 v[156:159], v[192:195], a[80:83], v[156:159]
  s_cmp_lg_u32 s95, 0
  s_cbranch_scc1 L_l0_13
  s_add_u32 m0, s101, 65536
  s_mov_b32 s36, 65536
  buffer_load_dwordx4 v94, s[44:47], s36 offen lds
  buffer_load_dwordx4 v94, s[44:47], s36 offen offset:1024 lds
  buffer_load_dwordx4 v94, s[44:47], s36 offen offset:2048 lds
  buffer_load_dwordx4 v94, s[44:47], s36 offen offset:3072 lds
L_l0_13:
  v_mfma_f32_16x16x32_bf16 v[132:135], v[196:199], a[8:11], v[132:135]
  ds_read_b128 v[36:39], v1 offset:4096
  v_mfma_f32_16x16x32_bf16 v[160:163], v[196:199], a[80:83], v[160:163]
  ds_read_b128 v[40:43], v19
  v_mfma_f32_16x16x32_bf16 v[136:139], v[200:203], a[8:11], v[136:139]
  buffer_load_dwordx4 a[24:27], v6, s[4:7], s49 offen offset:2048 sc1
  v_mfma_f32_16x16x32_bf16 v[164:167], v[200:203], a[80:83], v[164:167]
  buffer_load_dwordx4 a[96:99], v6, s[4:7], s54 offen offset:2048 sc1
  s_waitcnt vmcnt(6) lgkmcnt(0)
  v_mfma_f32_16x16x32_bf16 v[112:115], v[204:207], a[12:15], v[112:115]
  s_barrier
  v_mfma_f32_16x16x32_bf16 v[140:143], v[204:207], a[84:87], v[140:143]
  ds_read_b128 v[176:179], v1 offset:28672
  v_mfma_f32_16x16x32_bf16 v[116:119], v[208:211], a[12:15], v[116:119]
  ds_read_b128 v[180:183], v1 offset:29696
  v_mfma_f32_16x16x32_bf16 v[144:147], v[208:211], a[84:87], v[144:147]
  ds_read_b128 v[184:187], v1 offset:30720
  v_mfma_f32_16x16x32_bf16 v[120:123], v[212:215], a[12:15], v[120:123]
  ds_read_b128 v[188:191], v1 offset:31744
  v_mfma_f32_16x16x32_bf16 v[148:151], v[212:215], a[84:87], v[148:151]
  ds_read_b128 v[192:195], v1 offset:32768
  v_mfma_f32_16x16x32_bf16 v[124:127], v[216:219], a[12:15], v[124:127]
  ds_read_b128 v[196:199], v1 offset:33792
  v_mfma_f32_16x16x32_bf16 v[152:155], v[216:219], a[84:87], v[152:155]
  ds_read_b128 v[200:203], v1 offset:34816
  v_mfma_f32_16x16x32_bf16 v[128:131], v[220:223], a[12:15], v[128:131]
  ds_read_b128 v[44:47], v3 offset:7168
  v_mfma_f32_16x16x32_bf16 v[156:159], v[220:223], a[84:87], v[156:159]
  ds_read_b128 v[48:51], v1 offset:11264
  v_mfma_f32_16x16x32_bf16 v[132:135], v[224:227], a[12:15], v[132:135]
  ds_read_b128 v[52:55], v19 offset:1024
  v_mfma_f32_16x16x32_bf16 v[160:163], v[224:227], a[84:87], v[160:163]
  buffer_load_dwordx4 a[28:31], v6, s[4:7], s49 offen offset:3072 sc1
  v_mfma_f32_16x16x32_bf16 v[136:139], v[228:231], a[12:15], v[136:139]
  buffer_load_dwordx4 a[100:103], v6, s[4:7], s54 offen offset:3072 sc1
  v_mfma_f32_16x16x32_bf16 v[164:167], v[228:231], a[84:87], v[164:167]
  v_mfma_f32_16x16x32_bf16 v[168:171], v[32:35], v[40:43], 0
  v_mfma_f32_16x16x32_bf16 v[172:175], v[36:39], v[40:43], 0
  s_waitcnt vmcnt(6) lgkmcnt(0)
  v_mfma_f32_16x16x32_bf16 v[112:115], v[176:179], a[16:19], v[112:115]
  ds_read_b128 v[204:207], v1 offset:35840
  v_mfma_f32_16x16x32_bf16 v[140:143], v[176:179], a[88:91], v[140:143]
  ds_read_b128 v[208:211], v1 offset:36864
  v_mfma_f32_16x16x32_bf16 v[116:119], v[180:183], a[16:19], v[116:119]
  ds_read_b128 v[212:215], v1 offset:37888
  v_mfma_f32_16x16x32_bf16 v[144:147], v[180:183], a[88:91], v[144:147]
  ds_read_b128 v[216:219], v1 offset:38912
  v_mfma_f32_16x16x32_bf16 v[120:123], v[184:187], a[16:19], v[120:123]
  ds_read_b128 v[220:223], v1 offset:39936
  v_mfma_f32_16x16x32_bf16 v[148:151], v[184:187], a[88:91], v[148:151]
  ds_read_b128 v[224:227], v1 offset:40960
  v_mfma_f32_16x16x32_bf16 v[124:127], v[188:191], a[16:19], v[124:127]
  ds_read_b128 v[228:231], v1 offset:41984
  v_mfma_f32_16x16x32_bf16 v[152:155], v[188:191], a[88:91], v[152:155]
  ds_read_b128 v[32:35], v3 offset:14336
  v_mfma_f32_16x16x32_bf16 v[128:131], v[192:195], a[16:19], v[128:131]
  ds_read_b128 v[36:39], v1 offset:18432
  v_mfma_f32_16x16x32_bf16 v[156:159], v[192:195], a[88:91], v[156:159]
  s_cmp_lg_u32 s95, 0
  s_cbranch_scc1 L_l0_14
  s_add_u32 m0, s101, 81920
  s_mov_b32 s36, 81920
  buffer_load_dwordx4 v94, s[44:47], s36 offen lds
  buffer_load_dwordx4 v94, s[44:47], s36 offen offset:1024 lds
  buffer_load_dwordx4 v94, s[44:47], s36 offen offset:2048 lds
  buffer_load_dwordx4 v94, s[44:47], s36 offen offset:3072 lds
L_l0_14:
  v_mfma_f32_16x16x32_bf16 v[132:135], v[196:199], a[16:19], v[132:135]
  ds_read_b128 v[40:43], v19 offset:2048
  v_mfma_f32_16x16x32_bf16 v[160:163], v[196:199], a[88:91], v[160:163]
  buffer_load_dwordx4 a[32:35], v6, s[4:7], s50 offen sc1
  v_mfma_f32_16x16x32_bf16 v[136:139], v[200:203], a[16:19], v[136:139]
  buffer_load_dwordx4 a[104:107], v6, s[4:7], s55 offen sc1
  v_mfma_f32_16x16x32_bf16 v[164:167], v[200:203], a[88:91], v[164:167]
  v_mfma_f32_16x16x32_bf16 v[168:171], v[44:47], v[52:55], v[168:171]
  v_mfma_f32_16x16x32_bf16 v[172:175], v[48:51], v[52:55], v[172:175]
  s_waitcnt vmcnt(6) lgkmcnt(0)
  v_mfma_f32_16x16x32_bf16 v[112:115], v[204:207], a[20:23], v[112:115]
  s_barrier
  v_mfma_f32_16x16x32_bf16 v[140:143], v[204:207], a[92:95], v[140:143]
  ds_read_b128 v[176:179], v1 offset:43008
  v_mfma_f32_16x16x32_bf16 v[116:119], v[208:211], a[20:23], v[116:119]
  ds_read_b128 v[180:183], v1 offset:44032
  v_mfma_f32_16x16x32_bf16 v[144:147], v[208:211], a[92:95], v[144:147]
  ds_read_b128 v[184:187], v1 offset:45056
  v_mfma_f32_16x16x32_bf16 v[120:123], v[212:215], a[20:23], v[120:123]
  ds_read_b128 v[188:191], v1 offset:46080
  v_mfma_f32_16x16x32_bf16 v[148:151], v[212:215], a[92:95], v[148:151]
  ds_read_b128 v[192:195], v1 offset:47104
  v_mfma_f32_16x16x32_bf16 v[124:127], v[216:219], a[20:23], v[124:127]
  ds_read_b128 v[196:199], v1 offset:48128
  v_mfma_f32_16x16x32_bf16 v[152:155], v[216:219], a[92:95], v[152:155]
  ds_read_b128 v[200:203], v1 offset:49152
  v_mfma_f32_16x16x32_bf16 v[128:131], v[220:223], a[20:23], v[128:131]
  ds_read_b128 v[44:47], v3 offset:21504
  v_mfma_f32_16x16x32_bf16 v[156:159], v[220:223], a[92:95], v[156:159]
  ds_read_b128 v[48:51], v1 offset:25600
  v_mfma_f32_16x16x32_bf16 v[132:135], v[224:227], a[20:23], v[132:135]
  ds_read_b128 v[52:55], v19 offset:3072
  v_mfma_f32_16x16x32_bf16 v[160:163], v[224:227], a[92:95], v[160:163]
  buffer_load_dwordx4 a[36:39], v6, s[4:7], s50 offen offset:1024 sc1
  v_mfma_f32_16x16x32_bf16 v[136:139], v[228:231], a[20:23], v[136:139]
  buffer_load_dwordx4 a[108:111], v6, s[4:7], s55 offen offset:1024 sc1
  v_mfma_f32_16x16x32_bf16 v[164:167], v[228:231], a[92:95], v[164:167]
  v_mfma_f32_16x16x32_bf16 v[168:171], v[32:35], v[40:43], v[168:171]
  v_mfma_f32_16x16x32_bf16 v[172:175], v[36:39], v[40:43], v[172:175]
  s_waitcnt vmcnt(6) lgkmcnt(0)
  v_mfma_f32_16x16x32_bf16 v[112:115], v[176:179], a[24:27], v[112:115]
  ds_read_b128 v[204:207], v1 offset:50176
  v_mfma_f32_16x16x32_bf16 v[140:143], v[176:179], a[96:99], v[140:143]
  ds_read_b128 v[208:211], v1 offset:51200
  v_mfma_f32_16x16x32_bf16 v[116:119], v[180:183], a[24:27], v[116:119]
  ds_read_b128 v[212:215], v1 offset:52224
  v_mfma_f32_16x16x32_bf16 v[144:147], v[180:183], a[96:99], v[144:147]
  ds_read_b128 v[216:219], v1 offset:53248
  v_mfma_f32_16x16x32_bf16 v[120:123], v[184:187], a[24:27], v[120:123]
  ds_read_b128 v[220:223], v1 offset:54272
  v_mfma_f32_16x16x32_bf16 v[148:151], v[184:187], a[96:99], v[148:151]
  ds_read_b128 v[224:227], v1 offset:55296
  v_mfma_f32_16x16x32_bf16 v[124:127], v[188:191], a[24:27], v[124:127]
  ds_read_b128 v[228:231], v1 offset:56320
  v_mfma_f32_16x16x32_bf16 v[152:155], v[188:191], a[96:99], v[152:155]
  ds_read_b128 v[32:35], v3 offset:28672
  v_mfma_f32_16x16x32_bf16 v[128:131], v[192:195], a[24:27], v[128:131]
  ds_read_b128 v[36:39], v1 offset:32768
  v_mfma_f32_16x16x32_bf16 v[156:159], v[192:195], a[96:99], v[156:159]
  s_cmp_lg_u32 s95, 0
  s_cbranch_scc1 L_l0_15
  s_add_u32 m0, s101, 98304
  s_mov_b32 s36, 98304
  buffer_load_dwordx4 v94, s[44:47], s36 offen lds
  buffer_load_dwordx4 v94, s[44:47], s36 offen offset:1024 lds
  buffer_load_dwordx4 v94, s[44:47], s36 offen offset:2048 lds
  buffer_load_dwordx4 v94, s[44:47], s36 offen offset:3072 lds
L_l0_15:
  v_mfma_f32_16x16x32_bf16 v[132:135], v[196:199], a[24:27], v[132:135]
  ds_read_b128 v[40:43], v19 offset:4096
  v_mfma_f32_16x16x32_bf16 v[160:163], v[196:199], a[96:99], v[160:163]
  buffer_load_dwordx4 a[40:43], v6, s[4:7], s50 offen offset:2048 sc1
  v_mfma_f32_16x16x32_bf16 v[136:139], v[200:203], a[24:27], v[136:139]
  buffer_load_dwordx4 a[112:115], v6, s[4:7], s55 offen offset:2048 sc1
  v_mfma_f32_16x16x32_bf16 v[164:167], v[200:203], a[96:99], v[164:167]
  v_mfma_f32_16x16x32_bf16 v[168:171], v[44:47], v[52:55], v[168:171]
  v_mfma_f32_16x16x32_bf16 v[172:175], v[48:51], v[52:55], v[172:175]
  s_waitcnt vmcnt(6) lgkmcnt(0)
  v_mfma_f32_16x16x32_bf16 v[112:115], v[204:207], a[28:31], v[112:115]
  ds_read_b128 v[176:179], v1 offset:57344
  v_mfma_f32_16x16x32_bf16 v[140:143], v[204:207], a[100:103], v[140:143]
  ds_read_b128 v[180:183], v1 offset:58368
  v_mfma_f32_16x16x32_bf16 v[116:119], v[208:211], a[28:31], v[116:119]
  ds_read_b128 v[184:187], v1 offset:59392
  v_mfma_f32_16x16x32_bf16 v[144:147], v[208:211], a[100:103], v[144:147]
  ds_read_b128 v[188:191], v1 offset:60416
  v_mfma_f32_16x16x32_bf16 v[120:123], v[212:215], a[28:31], v[120:123]
  ds_read_b128 v[192:195], v1 offset:61440
  v_mfma_f32_16x16x32_bf16 v[148:151], v[212:215], a[100:103], v[148:151]
  ds_read_b128 v[196:199], v1 offset:62464
  v_mfma_f32_16x16x32_bf16 v[124:127], v[216:219], a[28:31], v[124:127]
  ds_read_b128 v[200:203], v1 offset:63488
  v_mfma_f32_16x16x32_bf16 v[152:155], v[216:219], a[100:103], v[152:155]
  ds_read_b128 v[44:47], v3 offset:35840
  v_mfma_f32_16x16x32_bf16 v[128:131], v[220:223], a[28:31], v[128:131]
  ds_read_b128 v[48:51], v1 offset:39936
  v_mfma_f32_16x16x32_bf16 v[156:159], v[220:223], a[100:103], v[156:159]
  s_cmp_lg_u32 s95, 0
  s_cbranch_scc1 L_l0_16
  v_lshrrev_b32 v27, 1, v0
  v_lshlrev_b32 v27, 7, v27
  v_and_b32 v28, 4, v30
  v_add_u32 v27, v27, v28
  v_add_u32 v28, 16384, v27
  s_mov_b32 s37, 0
  buffer_load_dword v31, v27, s[96:99], s37 offen sc1
  s_mov_b32 s37, 0
  buffer_load_dword v26, v28, s[96:99], s37 offen sc1
  s_waitcnt vmcnt(1)
  v_cmp_ne_u32 vcc, v7, v31
  s_cbranch_vccnz L_sp_6
L_bk_7:
  s_waitcnt vmcnt(0)
  v_cmp_ne_u32 vcc, v7, v26
  s_cbranch_vccnz L_sp_8
L_bk_9:
L_l0_16:
  v_mfma_f32_16x16x32_bf16 v[132:135], v[224:227], a[28:31], v[132:135]
  ds_read_b128 v[52:55], v19 offset:5120
  v_mfma_f32_16x16x32_bf16 v[160:163], v[224:227], a[100:103], v[160:163]
  buffer_load_dwordx4 a[44:47], v6, s[4:7], s50 offen offset:3072 sc1
  v_mfma_f32_16x16x32_bf16 v[136:139], v[228:231], a[28:31], v[136:139]
  buffer_load_dwordx4 a[116:119], v6, s[4:7], s55 offen offset:3072 sc1
  v_mfma_f32_16x16x32_bf16 v[164:167], v[228:231], a[100:103], v[164:167]
  v_mfma_f32_16x16x32_bf16 v[168:171], v[32:35], v[40:43], v[168:171]
  v_mfma_f32_16x16x32_bf16 v[172:175], v[36:39], v[40:43], v[172:175]
  s_waitcnt vmcnt(6) lgkmcnt(0)
  v_mfma_f32_16x16x32_bf16 v[112:115], v[176:179], a[32:35], v[112:115]
  s_barrier
  v_mfma_f32_16x16x32_bf16 v[140:143], v[176:179], a[104:107], v[140:143]
  ds_read_b128 v[204:207], v1 offset:64512
  v_mfma_f32_16x16x32_bf16 v[116:119], v[180:183], a[32:35], v[116:119]
  ds_read_b128 v[208:211], v2
  v_mfma_f32_16x16x32_bf16 v[144:147], v[180:183], a[104:107], v[144:147]
  ds_read_b128 v[212:215], v2 offset:1024
  v_mfma_f32_16x16x32_bf16 v[120:123], v[184:187], a[32:35], v[120:123]
  ds_read_b128 v[216:219], v2 offset:2048
  v_mfma_f32_16x16x32_bf16 v[148:151], v[184:187], a[104:107], v[148:151]
  ds_read_b128 v[220:223], v2 offset:3072
  v_mfma_f32_16x16x32_bf16 v[124:127], v[188:191], a[32:35], v[124:127]
  ds_read_b128 v[224:227], v2 offset:4096
  v_mfma_f32_16x16x32_bf16 v[152:155], v[188:191], a[104:107], v[152:155]
  ds_read_b128 v[228:231], v2 offset:5120
  v_mfma_f32_16x16x32_bf16 v[128:131], v[192:195], a[32:35], v[128:131]
  ds_read_b128 v[32:35], v3 offset:43008
  v_mfma_f32_16x16x32_bf16 v[156:159], v[192:195], a[104:107], v[156:159]
  s_cmp_lg_u32 s95, 0
  s_cbranch_scc1 L_l0_17
  s_add_u32 m0, s101, 114688
  s_mov_b32 s36, 114688
  buffer_load_dwordx4 v94, s[44:47], s36 offen lds
  buffer_load_dwordx4 v94, s[44:47], s36 offen offset:1024 lds
  buffer_load_dwordx4 v94, s[44:47], s36 offen offset:2048 lds
  buffer_load_dwordx4 v94, s[44:47], s36 offen offset:3072 lds
L_l0_17:
  v_mfma_f32_16x16x32_bf16 v[132:135], v[196:199], a[32:35], v[132:135]
  ds_read_b128 v[36:39], v1 offset:47104
  v_mfma_f32_16x16x32_bf16 v[160:163], v[196:199], a[104:107], v[160:163]
  ds_read_b128 v[40:43], v19 offset:6144
  v_mfma_f32_16x16x32_bf16 v[136:139], v[200:203], a[32:35], v[136:139]
  buffer_load_dwordx4 a[48:51], v6, s[4:7], s51 offen sc1
  v_mfma_f32_16x16x32_bf16 v[164:167], v[200:203], a[104:107], v[164:167]
  buffer_load_dwordx4 a[120:123], v6, s[4:7], s56 offen sc1
  v_mfma_f32_16x16x32_bf16 v[168:171], v[44:47], v[52:55], v[168:171]
  v_mfma_f32_16x16x32_bf16 v[172:175], v[48:51], v[52:55], v[172:175]
  s_waitcnt vmcnt(6) lgkmcnt(0)
  v_mfma_f32_16x16x32_bf16 v[112:115], v[204:207], a[36:39], v[112:115]
  ds_read_b128 v[176:179], v2 offset:6144
  v_mfma_f32_16x16x32_bf16 v[140:143], v[204:207], a[108:111], v[140:143]
  ds_read_b128 v[180:183], v2 offset:7168
  v_mfma_f32_16x16x32_bf16 v[116:119], v[208:211], a[36:39], v[116:119]
  ds_read_b128 v[184:187], v2 offset:8192
  v_mfma_f32_16x16x32_bf16 v[144:147], v[208:211], a[108:111], v[144:147]
  ds_read_b128 v[188:191], v2 offset:9216
  v_mfma_f32_16x16x32_bf16 v[120:123], v[212:215], a[36:39], v[120:123]
  ds_read_b128 v[192:195], v2 offset:10240
  v_mfma_f32_16x16x32_bf16 v[148:151], v[212:215], a[108:111], v[148:151]
  ds_read_b128 v[196:199], v2 offset:11264
  v_mfma_f32_16x16x32_bf16 v[124:127], v[216:219], a[36:39], v[124:127]
  ds_read_b128 v[200:203], v2 offset:12288
  v_mfma_f32_16x16x32_bf16 v[152:155], v[216:219], a[108:111], v[152:155]
  ds_read_b128 v[44:47], v3 offset:50176
  v_mfma_f32_16x16x32_bf16 v[128:131], v[220:223], a[36:39], v[128:131]
  ds_read_b128 v[48:51], v1 offset:54272
  v_mfma_f32_16x16x32_bf16 v[156:159], v[220:223], a[108:111], v[156:159]
  ds_read_b128 v[52:55], v19 offset:7168
  v_mfma_f32_16x16x32_bf16 v[132:135], v[224:227], a[36:39], v[132:135]
  buffer_load_dwordx4 a[52:55], v6, s[4:7], s51 offen offset:1024 sc1
  v_mfma_f32_16x16x32_bf16 v[160:163], v[224:227], a[108:111], v[160:163]
  buffer_load_dwordx4 a[124:127], v6, s[4:7], s56 offen offset:1024 sc1
  v_mfma_f32_16x16x32_bf16 v[136:139], v[228:231], a[36:39], v[136:139]
  buffer_load_dwordx4 a[144:147], v251, s[60:63], s48 offen
  v_mfma_f32_16x16x32_bf16 v[164:167], v[228:231], a[108:111], v[164:167]
  buffer_load_dwordx4 a[148:151], v251, s[60:63], s48 offen offset:1024
  v_mfma_f32_16x16x32_bf16 v[168:171], v[32:35], v[40:43], v[168:171]
  v_mfma_f32_16x16x32_bf16 v[172:175], v[36:39], v[40:43], v[172:175]
  s_waitcnt vmcnt(8) lgkmcnt(0)
  v_mfma_f32_16x16x32_bf16 v[112:115], v[176:179], a[40:43], v[112:115]
  s_barrier
  v_mfma_f32_16x16x32_bf16 v[140:143], v[176:179], a[112:115], v[140:143]
  ds_read_b128 v[204:207], v2 offset:13312
  v_mfma_f32_16x16x32_bf16 v[116:119], v[180:183], a[40:43], v[116:119]
  ds_read_b128 v[208:211], v2 offset:14336
  v_mfma_f32_16x16x32_bf16 v[144:147], v[180:183], a[112:115], v[144:147]
  ds_read_b128 v[212:215], v2 offset:15360
  v_mfma_f32_16x16x32_bf16 v[120:123], v[184:187], a[40:43], v[120:123]
  ds_read_b128 v[216:219], v2 offset:16384
  v_mfma_f32_16x16x32_bf16 v[148:151], v[184:187], a[112:115], v[148:151]
  ds_read_b128 v[220:223], v2 offset:17408
  v_mfma_f32_16x16x32_bf16 v[124:127], v[188:191], a[40:43], v[124:127]
  ds_read_b128 v[224:227], v2 offset:18432
  v_mfma_f32_16x16x32_bf16 v[152:155], v[188:191], a[112:115], v[152:155]
  ds_read_b128 v[228:231], v2 offset:19456
  v_mfma_f32_16x16x32_bf16 v[128:131], v[192:195], a[40:43], v[128:131]
  ds_read_b128 v[32:35], v3 offset:57344
  v_mfma_f32_16x16x32_bf16 v[156:159], v[192:195], a[112:115], v[156:159]
  ds_read_b128 v[36:39], v1 offset:61440
  v_mfma_f32_16x16x32_bf16 v[132:135], v[196:199], a[40:43], v[132:135]
  ds_read_b128 v[40:43], v19 offset:8192
  v_mfma_f32_16x16x32_bf16 v[160:163], v[196:199], a[112:115], v[160:163]
  buffer_load_dwordx4 a[56:59], v6, s[4:7], s51 offen offset:2048 sc1
  v_mfma_f32_16x16x32_bf16 v[136:139], v[200:203], a[40:43], v[136:139]
  buffer_load_dwordx4 a[128:131], v6, s[4:7], s56 offen offset:2048 sc1
  v_mfma_f32_16x16x32_bf16 v[164:167], v[200:203], a[112:115], v[164:167]
  buffer_load_dwordx4 a[152:155], v251, s[60:63], s48 offen offset:2048
  v_mfma_f32_16x16x32_bf16 v[168:171], v[44:47], v[52:55], v[168:171]
  buffer_load_dwordx4 a[156:159], v251, s[60:63], s48 offen offset:3072
  v_mfma_f32_16x16x32_bf16 v[172:175], v[48:51], v[52:55], v[172:175]
  s_waitcnt vmcnt(10) lgkmcnt(0)
  v_mfma_f32_16x16x32_bf16 v[112:115], v[204:207], a[44:47], v[112:115]
  ds_read_b128 v[176:179], v2 offset:20480
  v_mfma_f32_16x16x32_bf16 v[140:143], v[204:207], a[116:119], v[140:143]
  ds_read_b128 v[180:183], v2 offset:21504
  v_mfma_f32_16x16x32_bf16 v[116:119], v[208:211], a[44:47], v[116:119]
  ds_read_b128 v[184:187], v2 offset:22528
  v_mfma_f32_16x16x32_bf16 v[144:147], v[208:211], a[116:119], v[144:147]
  ds_read_b128 v[188:191], v2 offset:23552
  v_mfma_f32_16x16x32_bf16 v[120:123], v[212:215], a[44:47], v[120:123]
  ds_read_b128 v[192:195], v2 offset:24576
  v_mfma_f32_16x16x32_bf16 v[148:151], v[212:215], a[116:119], v[148:151]
  ds_read_b128 v[196:199], v2 offset:25600
  v_mfma_f32_16x16x32_bf16 v[124:127], v[216:219], a[44:47], v[124:127]
  ds_read_b128 v[200:203], v2 offset:26624
  v_mfma_f32_16x16x32_bf16 v[152:155], v[216:219], a[116:119], v[152:155]
  ds_read_b128 v[44:47], v3 offset:64512
  v_mfma_f32_16x16x32_bf16 v[128:131], v[220:223], a[44:47], v[128:131]
  ds_read_b128 v[48:51], v2 offset:3072
  v_mfma_f32_16x16x32_bf16 v[156:159], v[220:223], a[116:119], v[156:159]
  ds_read_b128 v[52:55], v19 offset:9216
  v_mfma_f32_16x16x32_bf16 v[132:135], v[224:227], a[44:47], v[132:135]
  buffer_load_dwordx4 a[60:63], v6, s[4:7], s51 offen offset:3072 sc1
  v_mfma_f32_16x16x32_bf16 v[160:163], v[224:227], a[116:119], v[160:163]
  buffer_load_dwordx4 a[132:135], v6, s[4:7], s56 offen offset:3072 sc1
  v_mfma_f32_16x16x32_bf16 v[136:139], v[228:231], a[44:47], v[136:139]
  buffer_load_dwordx4 a[160:163], v251, s[60:63], s49 offen
  v_mfma_f32_16x16x32_bf16 v[164:167], v[228:231], a[116:119], v[164:167]
  buffer_load_dwordx4 a[164:167], v251, s[60:63], s49 offen offset:1024
  v_mfma_f32_16x16x32_bf16 v[168:171], v[32:35], v[40:43], v[168:171]
  v_mfma_f32_16x16x32_bf16 v[172:175], v[36:39], v[40:43], v[172:175]
  s_waitcnt vmcnt(12) lgkmcnt(0)
  v_mfma_f32_16x16x32_bf16 v[112:115], v[176:179], a[48:51], v[112:115]
  s_barrier
  v_mfma_f32_16x16x32_bf16 v[140:143], v[176:179], a[120:123], v[140:143]
  ds_read_b128 v[204:207], v2 offset:27648
  v_mfma_f32_16x16x32_bf16 v[116:119], v[180:183], a[48:51], v[116:119]
  ds_read_b128 v[208:211], v2 offset:28672
  v_mfma_f32_16x16x32_bf16 v[144:147], v[180:183], a[120:123], v[144:147]
  ds_read_b128 v[212:215], v2 offset:29696
  v_mfma_f32_16x16x32_bf16 v[120:123], v[184:187], a[48:51], v[120:123]
  ds_read_b128 v[216:219], v2 offset:30720
  v_mfma_f32_16x16x32_bf16 v[148:151], v[184:187], a[120:123], v[148:151]
  ds_read_b128 v[220:223], v2 offset:31744
  v_mfma_f32_16x16x32_bf16 v[124:127], v[188:191], a[48:51], v[124:127]
  ds_read_b128 v[224:227], v2 offset:32768
  v_mfma_f32_16x16x32_bf16 v[152:155], v[188:191], a[120:123], v[152:155]
  ds_read_b128 v[228:231], v2 offset:33792
  v_mfma_f32_16x16x32_bf16 v[128:131], v[192:195], a[48:51], v[128:131]
  ds_read_b128 v[32:35], v4 offset:6144
  v_mfma_f32_16x16x32_bf16 v[156:159], v[192:195], a[120:123], v[156:159]
  ds_read_b128 v[36:39], v2 offset:10240
  v_mfma_f32_16x16x32_bf16 v[132:135], v[196:199], a[48:51], v[132:135]
  ds_read_b128 v[40:43], v19 offset:10240
  v_mfma_f32_16x16x32_bf16 v[160:163], v[196:199], a[120:123], v[160:163]
  buffer_load_dwordx4 a[64:67], v6, s[4:7], s52 offen sc1
  v_mfma_f32_16x16x32_bf16 v[136:139], v[200:203], a[48:51], v[136:139]
  buffer_load_dwordx4 a[136:139], v6, s[4:7], s57 offen sc1
  v_mfma_f32_16x16x32_bf16 v[164:167], v[200:203], a[120:123], v[164:167]
  buffer_load_dwordx4 a[168:171], v251, s[60:63], s49 offen offset:2048
  v_mfma_f32_16x16x32_bf16 v[168:171], v[44:47], v[52:55], v[168:171]
  buffer_load_dwordx4 a[172:175], v251, s[60:63], s49 offen offset:3072
  v_mfma_f32_16x16x32_bf16 v[172:175], v[48:51], v[52:55], v[172:175]
  s_waitcnt vmcnt(14) lgkmcnt(0)
  v_mfma_f32_16x16x32_bf16 v[112:115], v[204:207], a[52:55], v[112:115]
  ds_read_b128 v[176:179], v2 offset:34816
  v_mfma_f32_16x16x32_bf16 v[140:143], v[204:207], a[124:127], v[140:143]
  ds_read_b128 v[180:183], v2 offset:35840
  v_mfma_f32_16x16x32_bf16 v[116:119], v[208:211], a[52:55], v[116:119]
  ds_read_b128 v[184:187], v2 offset:36864
  v_mfma_f32_16x16x32_bf16 v[144:147], v[208:211], a[124:127], v[144:147]
  ds_read_b128 v[188:191], v2 offset:37888
  v_mfma_f32_16x16x32_bf16 v[120:123], v[212:215], a[52:55], v[120:123]
  ds_read_b128 v[192:195], v2 offset:38912
  v_mfma_f32_16x16x32_bf16 v[148:151], v[212:215], a[124:127], v[148:151]
  ds_read_b128 v[196:199], v2 offset:39936
  v_mfma_f32_16x16x32_bf16 v[124:127], v[216:219], a[52:55], v[124:127]
  ds_read_b128 v[200:203], v2 offset:40960
  v_mfma_f32_16x16x32_bf16 v[152:155], v[216:219], a[124:127], v[152:155]
  ds_read_b128 v[44:47], v4 offset:13312
  v_mfma_f32_16x16x32_bf16 v[128:131], v[220:223], a[52:55], v[128:131]
  ds_read_b128 v[48:51], v2 offset:17408
  v_mfma_f32_16x16x32_bf16 v[156:159], v[220:223], a[124:127], v[156:159]
  ds_read_b128 v[52:55], v19 offset:11264
  v_mfma_f32_16x16x32_bf16 v[132:135], v[224:227], a[52:55], v[132:135]
  buffer_load_dwordx4 a[68:71], v6, s[4:7], s52 offen offset:1024 sc1
  v_mfma_f32_16x16x32_bf16 v[160:163], v[224:227], a[124:127], v[160:163]
  buffer_load_dwordx4 a[140:143], v6, s[4:7], s57 offen offset:1024 sc1
  v_mfma_f32_16x16x32_bf16 v[136:139], v[228:231], a[52:55], v[136:139]
  buffer_load_dwordx4 a[176:179], v251, s[60:63], s50 offen
  v_mfma_f32_16x16x32_bf16 v[164:167], v[228:231], a[124:127], v[164:167]
  buffer_load_dwordx4 a[180:183], v251, s[60:63], s50 offen offset:1024
  v_mfma_f32_16x16x32_bf16 v[168:171], v[32:35], v[40:43], v[168:171]
  v_mfma_f32_16x16x32_bf16 v[172:175], v[36:39], v[40:43], v[172:175]
  s_waitcnt vmcnt(14) lgkmcnt(0)
  v_mfma_f32_16x16x32_bf16 v[112:115], v[176:179], a[56:59], v[112:115]
  ds_read_b128 v[204:207], v2 offset:41984
  v_mfma_f32_16x16x32_bf16 v[140:143], v[176:179], a[128:131], v[140:143]
  ds_read_b128 v[208:211], v2 offset:43008
  v_mfma_f32_16x16x32_bf16 v[116:119], v[180:183], a[56:59], v[116:119]
  ds_read_b128 v[212:215], v2 offset:44032
  v_mfma_f32_16x16x32_bf16 v[144:147], v[180:183], a[128:131], v[144:147]
  ds_read_b128 v[216:219], v2 offset:45056
  v_mfma_f32_16x16x32_bf16 v[120:123], v[184:187], a[56:59], v[120:123]
  ds_read_b128 v[220:223], v2 offset:46080
  v_mfma_f32_16x16x32_bf16 v[148:151], v[184:187], a[128:131], v[148:151]
  ds_read_b128 v[224:227], v2 offset:47104
  v_mfma_f32_16x16x32_bf16 v[124:127], v[188:191], a[56:59], v[124:127]
  ds_read_b128 v[228:231], v2 offset:48128
  v_mfma_f32_16x16x32_bf16 v[152:155], v[188:191], a[128:131], v[152:155]
  ds_read_b128 v[32:35], v4 offset:20480
  v_mfma_f32_16x16x32_bf16 v[128:131], v[192:195], a[56:59], v[128:131]
  ds_read_b128 v[36:39], v2 offset:24576
  v_mfma_f32_16x16x32_bf16 v[156:159], v[192:195], a[128:131], v[156:159]
  ds_read_b128 v[40:43], v19 offset:12288
  v_mfma_f32_16x16x32_bf16 v[132:135], v[196:199], a[56:59], v[132:135]
  buffer_load_dword v10, v9, s[8:11], 0 offen offset:256 sc1
  v_mfma_f32_16x16x32_bf16 v[160:163], v[196:199], a[128:131], v[160:163]
  buffer_load_dword v8, v8, s[8:11], 0 offen sc1
  v_mfma_f32_16x16x32_bf16 v[136:139], v[200:203], a[56:59], v[136:139]
  buffer_load_dword v9, v9, s[8:11], 0 offen sc1
  v_mfma_f32_16x16x32_bf16 v[164:167], v[200:203], a[128:131], v[164:167]
  buffer_load_dwordx4 a[184:187], v251, s[60:63], s50 offen offset:2048
  v_mfma_f32_16x16x32_bf16 v[168:171], v[44:47], v[52:55], v[168:171]
  buffer_load_dwordx4 a[188:191], v251, s[60:63], s50 offen offset:3072
  v_mfma_f32_16x16x32_bf16 v[172:175], v[48:51], v[52:55], v[172:175]
  s_waitcnt vmcnt(15) lgkmcnt(0)
  v_mfma_f32_16x16x32_bf16 v[112:115], v[204:207], a[60:63], v[112:115]
  s_barrier
  v_mfma_f32_16x16x32_bf16 v[140:143], v[204:207], a[132:135], v[140:143]
  ds_read_b128 v[176:179], v2 offset:49152
  v_mfma_f32_16x16x32_bf16 v[116:119], v[208:211], a[60:63], v[116:119]
  ds_read_b128 v[180:183], v2 offset:50176
  v_mfma_f32_16x16x32_bf16 v[144:147], v[208:211], a[132:135], v[144:147]
  ds_read_b128 v[184:187], v2 offset:51200
  v_mfma_f32_16x16x32_bf16 v[120:123], v[212:215], a[60:63], v[120:123]
  ds_read_b128 v[188:191], v2 offset:52224
  v_mfma_f32_16x16x32_bf16 v[148:151], v[212:215], a[132:135], v[148:151]
  ds_read_b128 v[192:195], v2 offset:53248
  v_mfma_f32_16x16x32_bf16 v[124:127], v[216:219], a[60:63], v[124:127]
  ds_read_b128 v[196:199], v2 offset:54272
  v_mfma_f32_16x16x32_bf16 v[152:155], v[216:219], a[132:135], v[152:155]
  ds_read_b128 v[200:203], v2 offset:55296
  v_mfma_f32_16x16x32_bf16 v[128:131], v[220:223], a[60:63], v[128:131]
  ds_read_b128 v[44:47], v4 offset:27648
  v_mfma_f32_16x16x32_bf16 v[156:159], v[220:223], a[132:135], v[156:159]
  ds_read_b128 v[48:51], v2 offset:31744
  v_mfma_f32_16x16x32_bf16 v[132:135], v[224:227], a[60:63], v[132:135]
  ds_read_b128 v[52:55], v19 offset:13312
  v_mfma_f32_16x16x32_bf16 v[160:163], v[224:227], a[132:135], v[160:163]
  buffer_load_dwordx4 a[192:195], v251, s[60:63], s51 offen
  v_mfma_f32_16x16x32_bf16 v[136:139], v[228:231], a[60:63], v[136:139]
  buffer_load_dwordx4 a[196:199], v251, s[60:63], s51 offen offset:1024
  v_mfma_f32_16x16x32_bf16 v[164:167], v[228:231], a[132:135], v[164:167]
  buffer_load_dwordx4 a[0:3], v250, s[60:63], s48 offen
  v_mfma_f32_16x16x32_bf16 v[168:171], v[32:35], v[40:43], v[168:171]
  buffer_load_dwordx4 a[72:75], v250, s[60:63], s53 offen
  v_mfma_f32_16x16x32_bf16 v[172:175], v[36:39], v[40:43], v[172:175]
  s_waitcnt vmcnt(15) lgkmcnt(0)
  v_mfma_f32_16x16x32_bf16 v[112:115], v[176:179], a[64:67], v[112:115]
  ds_read_b128 v[204:207], v2 offset:56320
  v_mfma_f32_16x16x32_bf16 v[140:143], v[176:179], a[136:139], v[140:143]
  ds_read_b128 v[208:211], v2 offset:57344
  v_mfma_f32_16x16x32_bf16 v[116:119], v[180:183], a[64:67], v[116:119]
  ds_read_b128 v[212:215], v2 offset:58368
  v_mfma_f32_16x16x32_bf16 v[144:147], v[180:183], a[136:139], v[144:147]
  ds_read_b128 v[216:219], v2 offset:59392
  v_mfma_f32_16x16x32_bf16 v[120:123], v[184:187], a[64:67], v[120:123]
  ds_read_b128 v[220:223], v2 offset:60416
  v_mfma_f32_16x16x32_bf16 v[148:151], v[184:187], a[136:139], v[148:151]
  ds_read_b128 v[224:227], v2 offset:61440
  v_mfma_f32_16x16x32_bf16 v[124:127], v[188:191], a[64:67], v[124:127]
  ds_read_b128 v[228:231], v2 offset:62464
  v_mfma_f32_16x16x32_bf16 v[152:155], v[188:191], a[136:139], v[152:155]
  ds_read_b128 v[32:35], v4 offset:34816
  v_mfma_f32_16x16x32_bf16 v[128:131], v[192:195], a[64:67], v[128:131]
  ds_read_b128 v[36:39], v2 offset:38912
  v_mfma_f32_16x16x32_bf16 v[156:159], v[192:195], a[136:139], v[156:159]
  ds_read_b128 v[40:43], v19 offset:14336
  v_mfma_f32_16x16x32_bf16 v[132:135], v[196:199], a[64:67], v[132:135]
  buffer_load_dwordx4 a[200:203], v251, s[60:63], s51 offen offset:2048
  v_mfma_f32_16x16x32_bf16 v[160:163], v[196:199], a[136:139], v[160:163]
  buffer_load_dwordx4 a[204:207], v251, s[60:63], s51 offen offset:3072
  v_mfma_f32_16x16x32_bf16 v[136:139], v[200:203], a[64:67], v[136:139]
  buffer_load_dwordx4 a[4:7], v250, s[60:63], s48 offen offset:1024
  v_mfma_f32_16x16x32_bf16 v[164:167], v[200:203], a[136:139], v[164:167]
  buffer_load_dwordx4 a[76:79], v250, s[60:63], s53 offen offset:1024
  v_mfma_f32_16x16x32_bf16 v[168:171], v[44:47], v[52:55], v[168:171]
  v_mfma_f32_16x16x32_bf16 v[172:175], v[48:51], v[52:55], v[172:175]
  s_waitcnt vmcnt(15) lgkmcnt(0)
  v_mfma_f32_16x16x32_bf16 v[112:115], v[204:207], a[68:71], v[112:115]
  ds_read_b128 v[44:47], v4 offset:41984
  v_mfma_f32_16x16x32_bf16 v[140:143], v[204:207], a[140:143], v[140:143]
  ds_read_b128 v[48:51], v2 offset:46080
  v_mfma_f32_16x16x32_bf16 v[116:119], v[208:211], a[68:71], v[116:119]
  ds_read_b128 v[52:55], v19 offset:15360
  v_mfma_f32_16x16x32_bf16 v[144:147], v[208:211], a[140:143], v[144:147]
  buffer_load_dwordx4 a[208:211], v251, s[60:63], s52 offen
  v_mfma_f32_16x16x32_bf16 v[120:123], v[212:215], a[68:71], v[120:123]
  buffer_load_dwordx4 a[212:215], v251, s[60:63], s52 offen offset:1024
  v_mfma_f32_16x16x32_bf16 v[148:151], v[212:215], a[140:143], v[148:151]
  buffer_load_dwordx4 a[8:11], v250, s[60:63], s48 offen offset:2048
  v_mfma_f32_16x16x32_bf16 v[124:127], v[216:219], a[68:71], v[124:127]
  buffer_load_dwordx4 a[80:83], v250, s[60:63], s53 offen offset:2048
  v_mfma_f32_16x16x32_bf16 v[152:155], v[216:219], a[140:143], v[152:155]
  v_mfma_f32_16x16x32_bf16 v[128:131], v[220:223], a[68:71], v[128:131]
  v_mfma_f32_16x16x32_bf16 v[156:159], v[220:223], a[140:143], v[156:159]
  v_mfma_f32_16x16x32_bf16 v[132:135], v[224:227], a[68:71], v[132:135]
  v_mfma_f32_16x16x32_bf16 v[160:163], v[224:227], a[140:143], v[160:163]
  v_mfma_f32_16x16x32_bf16 v[136:139], v[228:231], a[68:71], v[136:139]
  v_mfma_f32_16x16x32_bf16 v[164:167], v[228:231], a[140:143], v[164:167]
  v_mfma_f32_16x16x32_bf16 v[168:171], v[32:35], v[40:43], v[168:171]
  v_mfma_f32_16x16x32_bf16 v[172:175], v[36:39], v[40:43], v[172:175]
  s_waitcnt lgkmcnt(0)
  v_mfma_f32_16x16x32_bf16 v[168:171], v[44:47], v[52:55], v[168:171]
  ds_read_b128 v[32:35], v4 offset:49152
  v_mfma_f32_16x16x32_bf16 v[172:175], v[48:51], v[52:55], v[172:175]
  ds_read_b128 v[36:39], v2 offset:53248
  ds_read_b128 v[40:43], v19 offset:16384
  s_waitcnt lgkmcnt(0)
  v_mfma_f32_16x16x32_bf16 v[168:171], v[32:35], v[40:43], v[168:171]
  ds_read_b128 v[44:47], v4 offset:56320
  v_mfma_f32_16x16x32_bf16 v[172:175], v[36:39], v[40:43], v[172:175]
  ds_read_b128 v[48:51], v2 offset:60416
  ds_read_b128 v[52:55], v19 offset:17408
  s_waitcnt lgkmcnt(0)
  v_mfma_f32_16x16x32_bf16 v[168:171], v[44:47], v[52:55], v[168:171]
  v_mfma_f32_16x16x32_bf16 v[172:175], v[48:51], v[52:55], v[172:175]
  s_barrier
  s_waitcnt vmcnt(14)
  v_mul_f32 v112, v112, v9
  v_mul_f32 v113, v113, v9
  v_mul_f32 v114, v114, v9
  v_mul_f32 v115, v115, v9
  v_cvt_pk_bf16_f32 v176, v112, v113
  v_cvt_pk_bf16_f32 v177, v114, v115
  ds_write_b64 v13, v[176:177]
  v_mul_f32 v140, v140, v10
  v_mul_f32 v141, v141, v10
  v_mul_f32 v142, v142, v10
  v_mul_f32 v143, v143, v10
  buffer_load_dwordx4 a[12:15], v250, s[60:63], s48 offen offset:3072
  v_cvt_pk_bf16_f32 v178, v140, v141
  v_cvt_pk_bf16_f32 v179, v142, v143
  ds_write_b64 v13, v[178:179] offset:3840
  v_mul_f32 v116, v116, v9
  v_mul_f32 v117, v117, v9
  v_mul_f32 v118, v118, v9
  v_mul_f32 v119, v119, v9
  v_cvt_pk_bf16_f32 v180, v116, v117
  v_cvt_pk_bf16_f32 v181, v118, v119
  ds_write_b64 v13, v[180:181] offset:32
  v_mul_f32 v144, v144, v10
  buffer_load_dwordx4 a[84:87], v250, s[60:63], s53 offen offset:3072
  v_mul_f32 v145, v145, v10
  v_mul_f32 v146, v146, v10
  v_mul_f32 v147, v147, v10
  v_cvt_pk_bf16_f32 v182, v144, v145
  v_cvt_pk_bf16_f32 v183, v146, v147
  ds_write_b64 v13, v[182:183] offset:3872
  v_mul_f32 v120, v120, v9
  v_mul_f32 v121, v121, v9
  v_mul_f32 v122, v122, v9
  v_mul_f32 v123, v123, v9
  v_cvt_pk_bf16_f32 v176, v120, v121
  buffer_load_dwordx4 a[16:19], v250, s[60:63], s49 offen
  v_cvt_pk_bf16_f32 v177, v122, v123
  ds_write_b64 v13, v[176:177] offset:64
  v_mul_f32 v148, v148, v10
  v_mul_f32 v149, v149, v10
  v_mul_f32 v150, v150, v10
  v_mul_f32 v151, v151, v10
  v_cvt_pk_bf16_f32 v178, v148, v149
  v_cvt_pk_bf16_f32 v179, v150, v151
  ds_write_b64 v13, v[178:179] offset:3904
  v_mul_f32 v124, v124, v9
  v_mul_f32 v125, v125, v9
  buffer_load_dwordx4 a[88:91], v250, s[60:63], s54 offen
  v_mul_f32 v126, v126, v9
  v_mul_f32 v127, v127, v9
  v_cvt_pk_bf16_f32 v180, v124, v125
  v_cvt_pk_bf16_f32 v181, v126, v127
  ds_write_b64 v13, v[180:181] offset:96
  v_mul_f32 v152, v152, v10
  v_mul_f32 v153, v153, v10
  v_mul_f32 v154, v154, v10
  v_mul_f32 v155, v155, v10
  v_cvt_pk_bf16_f32 v182, v152, v153
  v_cvt_pk_bf16_f32 v183, v154, v155
  buffer_load_dwordx4 a[20:23], v250, s[60:63], s49 offen offset:1024
  ds_write_b64 v13, v[182:183] offset:3936
  v_mul_f32 v128, v128, v9
  v_mul_f32 v129, v129, v9
  v_mul_f32 v130, v130, v9
  v_mul_f32 v131, v131, v9
  v_cvt_pk_bf16_f32 v176, v128, v129
  v_cvt_pk_bf16_f32 v177, v130, v131
  ds_write_b64 v13, v[176:177] offset:128
  v_mul_f32 v156, v156, v10
  v_mul_f32 v157, v157, v10
  v_mul_f32 v158, v158, v10
  buffer_load_dwordx4 a[92:95], v250, s[60:63], s54 offen offset:1024
  v_mul_f32 v159, v159, v10
  v_cvt_pk_bf16_f32 v178, v156, v157
  v_cvt_pk_bf16_f32 v179, v158, v159
  ds_write_b64 v13, v[178:179] offset:3968
  v_mul_f32 v132, v132, v9
  v_mul_f32 v133, v133, v9
  v_mul_f32 v134, v134, v9
  v_mul_f32 v135, v135, v9
  v_cvt_pk_bf16_f32 v180, v132, v133
  v_cvt_pk_bf16_f32 v181, v134, v135
  ds_write_b64 v13, v[180:181] offset:160
  buffer_load_dwordx4 a[24:27], v250, s[60:63], s49 offen offset:2048
  v_mul_f32 v160, v160, v10
  v_mul_f32 v161, v161, v10
  v_mul_f32 v162, v162, v10
  v_mul_f32 v163, v163, v10
  v_cvt_pk_bf16_f32 v182, v160, v161
  v_cvt_pk_bf16_f32 v183, v162, v163
  ds_write_b64 v13, v[182:183] offset:4000
  v_mul_f32 v136, v136, v9
  v_mul_f32 v137, v137, v9
  v_mul_f32 v138, v138, v9
  v_mul_f32 v139, v139, v9
  buffer_load_dwordx4 a[96:99], v250, s[60:63], s54 offen offset:2048
  v_cvt_pk_bf16_f32 v176, v136, v137
  v_cvt_pk_bf16_f32 v177, v138, v139
  ds_write_b64 v13, v[176:177] offset:192
  v_mul_f32 v164, v164, v10
  v_mul_f32 v165, v165, v10
  v_mul_f32 v166, v166, v10
  v_mul_f32 v167, v167, v10
  v_cvt_pk_bf16_f32 v178, v164, v165
  v_cvt_pk_bf16_f32 v179, v166, v167
  ds_write_b64 v13, v[178:179] offset:4032
  v_mul_f32 v168, v168, v8
  buffer_load_dwordx4 a[28:31], v250, s[60:63], s49 offen offset:3072
  v_mul_f32 v169, v169, v8
  v_mul_f32 v170, v170, v8
  v_mul_f32 v171, v171, v8
  v_cvt_pk_bf16_f32 v180, v168, v169
  v_cvt_pk_bf16_f32 v181, v170, v171
  ds_write_b64 v11, v[180:181]
  v_mul_f32 v172, v172, v8
  v_mul_f32 v173, v173, v8
  v_mul_f32 v174, v174, v8
  v_mul_f32 v175, v175, v8
  v_cvt_pk_bf16_f32 v182, v172, v173
  buffer_load_dwordx4 a[100:103], v250, s[60:63], s54 offen offset:3072
  v_cvt_pk_bf16_f32 v183, v174, v175
  ds_write_b64 v12, v[182:183]
  s_waitcnt lgkmcnt(0)
  s_barrier
  ds_read2_b32 v[196:197], v15 offset0:0 offset1:1
  ds_read2_b32 v[198:199], v15 offset0:2 offset1:3
  ds_read2_b32 v[200:201], v15 offset0:4 offset1:5
  ds_read2_b32 v[202:203], v15 offset0:6 offset1:7
  ds_read_b32 v204, v15 offset:32
  ds_read_b128 v[36:39], v14 offset:3360
  ds_read_b128 v[40:43], v14 offset:3376
  buffer_load_dwordx4 a[32:35], v250, s[60:63], s50 offen
  ds_read_b128 v[44:47], v14 offset:3392
  ds_read_b128 v[56:59], v14 offset:2880
  ds_read_b128 v[60:63], v14 offset:2896
  ds_read_b128 v[64:67], v14 offset:2912
  ds_read_b128 v[76:79], v14 offset:2400
  ds_read_b128 v[80:83], v14 offset:2416
  ds_read_b128 v[84:87], v14 offset:2432
  ds_read_b128 v[96:99], v14 offset:1920
  ds_read_b128 v[100:103], v14 offset:1936
  ds_read_b128 v[104:107], v14 offset:1952
  ds_read_b128 v[116:119], v14 offset:1440
  buffer_load_dwordx4 a[104:107], v250, s[60:63], s55 offen
  ds_read_b128 v[120:123], v14 offset:1456
  ds_read_b128 v[124:127], v14 offset:1472
  ds_read_b128 v[136:139], v14 offset:960
  ds_read_b128 v[140:143], v14 offset:976
  ds_read_b128 v[144:147], v14 offset:992
  ds_read_b128 v[156:159], v14 offset:480
  ds_read_b128 v[160:163], v14 offset:496
  ds_read_b128 v[164:167], v14 offset:512
  ds_read_b128 v[176:179], v14
  ds_read_b128 v[180:183], v14 offset:16
  ds_read_b128 v[184:187], v14 offset:32
  buffer_load_dwordx4 a[36:39], v250, s[60:63], s50 offen offset:1024
  s_waitcnt lgkmcnt(15)
  v_dot2_f32_bf16 v208, v196, v36, 0
  v_dot2_f32_bf16 v209, v196, v56, 0
  v_dot2_f32_bf16 v210, v196, v76, 0
  s_waitcnt lgkmcnt(14)
  v_dot2_f32_bf16 v211, v196, v96, 0
  ds_read_b128 v[48:51], v14 offset:3408
  ds_read_b64 v[52:53], v14 offset:3424
  v_dot2_f32_bf16 v208, v197, v37, v208
  v_dot2_f32_bf16 v209, v197, v57, v209
  v_dot2_f32_bf16 v210, v197, v77, v210
  v_dot2_f32_bf16 v211, v197, v97, v211
  ds_read_b128 v[68:71], v14 offset:2928
  buffer_load_dwordx4 a[108:111], v250, s[60:63], s55 offen offset:1024
  ds_read_b64 v[72:73], v14 offset:2944
  v_dot2_f32_bf16 v208, v198, v38, v208
  v_dot2_f32_bf16 v209, v198, v58, v209
  v_dot2_f32_bf16 v210, v198, v78, v210
  v_dot2_f32_bf16 v211, v198, v98, v211
  ds_read_b128 v[88:91], v14 offset:2448
  ds_read_b64 v[92:93], v14 offset:2464
  v_dot2_f32_bf16 v208, v199, v39, v208
  v_dot2_f32_bf16 v209, v199, v59, v209
  v_dot2_f32_bf16 v210, v199, v79, v210
  v_dot2_f32_bf16 v211, v199, v99, v211
  buffer_load_dwordx4 a[40:43], v250, s[60:63], s50 offen offset:2048
  ds_read_b128 v[108:111], v14 offset:1968
  ds_read_b64 v[112:113], v14 offset:1984
  v_dot2_f32_bf16 v208, v200, v40, v208
  v_dot2_f32_bf16 v209, v200, v60, v209
  v_dot2_f32_bf16 v210, v200, v80, v210
  s_waitcnt lgkmcnt(15)
  v_dot2_f32_bf16 v211, v200, v100, v211
  ds_read_b128 v[128:131], v14 offset:1488
  ds_read_b64 v[132:133], v14 offset:1504
  v_dot2_f32_bf16 v208, v201, v41, v208
  v_dot2_f32_bf16 v209, v201, v61, v209
  v_dot2_f32_bf16 v210, v201, v81, v210
  buffer_load_dwordx4 a[112:115], v250, s[60:63], s55 offen offset:2048
  v_dot2_f32_bf16 v211, v201, v101, v211
  ds_read_b128 v[148:151], v14 offset:1008
  ds_read_b64 v[152:153], v14 offset:1024
  v_dot2_f32_bf16 v208, v202, v42, v208
  v_dot2_f32_bf16 v209, v202, v62, v209
  v_dot2_f32_bf16 v210, v202, v82, v210
  v_dot2_f32_bf16 v211, v202, v102, v211
  ds_read_b128 v[168:171], v14 offset:528
  ds_read_b64 v[172:173], v14 offset:544
  v_dot2_f32_bf16 v208, v203, v43, v208
  v_dot2_f32_bf16 v209, v203, v63, v209
  buffer_load_dwordx4 a[44:47], v250, s[60:63], s50 offen offset:3072
  v_dot2_f32_bf16 v210, v203, v83, v210
  v_dot2_f32_bf16 v211, v203, v103, v211
  ds_read_b128 v[188:191], v14 offset:48
  ds_read_b64 v[192:193], v14 offset:64
  v_dot2_f32_bf16 v208, v204, v44, v208
  v_dot2_f32_bf16 v209, v204, v64, v209
  v_dot2_f32_bf16 v210, v204, v84, v210
  v_dot2_f32_bf16 v211, v204, v104, v211
  v_dot2_f32_bf16 v212, v196, v116, 0
  v_dot2_f32_bf16 v213, v196, v136, 0
  s_waitcnt lgkmcnt(15)
  v_dot2_f32_bf16 v214, v196, v156, 0
  buffer_load_dwordx4 a[116:119], v250, s[60:63], s55 offen offset:3072
  v_dot2_f32_bf16 v215, v196, v176, 0
  v_dot2_f32_bf16 v212, v197, v117, v212
  v_dot2_f32_bf16 v213, v197, v137, v213
  v_dot2_f32_bf16 v214, v197, v157, v214
  v_dot2_f32_bf16 v215, v197, v177, v215
  v_dot2_f32_bf16 v212, v198, v118, v212
  v_dot2_f32_bf16 v213, v198, v138, v213
  v_dot2_f32_bf16 v214, v198, v158, v214
  v_dot2_f32_bf16 v215, v198, v178, v215
  v_dot2_f32_bf16 v212, v199, v119, v212
  v_dot2_f32_bf16 v213, v199, v139, v213
  buffer_load_dwordx4 a[48:51], v250, s[60:63], s51 offen
  v_dot2_f32_bf16 v214, v199, v159, v214
  v_dot2_f32_bf16 v215, v199, v179, v215
  v_dot2_f32_bf16 v212, v200, v120, v212
  v_dot2_f32_bf16 v213, v200, v140, v213
  v_dot2_f32_bf16 v214, v200, v160, v214
  v_dot2_f32_bf16 v215, v200, v180, v215
  v_dot2_f32_bf16 v212, v201, v121, v212
  v_dot2_f32_bf16 v213, v201, v141, v213
  v_dot2_f32_bf16 v214, v201, v161, v214
  v_dot2_f32_bf16 v215, v201, v181, v215
  v_dot2_f32_bf16 v212, v202, v122, v212
  buffer_load_dwordx4 a[120:123], v250, s[60:63], s56 offen
  v_dot2_f32_bf16 v213, v202, v142, v213
  v_dot2_f32_bf16 v214, v202, v162, v214
  v_dot2_f32_bf16 v215, v202, v182, v215
  v_dot2_f32_bf16 v212, v203, v123, v212
  v_dot2_f32_bf16 v213, v203, v143, v213
  v_dot2_f32_bf16 v214, v203, v163, v214
  v_dot2_f32_bf16 v215, v203, v183, v215
  v_dot2_f32_bf16 v212, v204, v124, v212
  v_dot2_f32_bf16 v213, v204, v144, v213
  v_dot2_f32_bf16 v214, v204, v164, v214
  v_dot2_f32_bf16 v215, v204, v184, v215
  buffer_load_dwordx4 a[52:55], v250, s[60:63], s51 offen offset:1024
  v_mul_f32 v208, 0x3eae1a93, v208
  v_mul_f32 v209, 0x3eae1a93, v209
  v_mul_f32 v210, 0x3eae1a93, v210
  v_mul_f32 v211, 0x3eae1a93, v211
  v_mul_f32 v212, 0x3eae1a93, v212
  v_mul_f32 v213, 0x3eae1a93, v213
  v_mul_f32 v214, 0x3eae1a93, v214
  v_mul_f32 v215, 0x3eae1a93, v215
  v_cndmask_b32 v209, v18, v209, s[64:65]
  v_cndmask_b32 v210, v18, v210, s[66:67]
  v_cndmask_b32 v211, v18, v211, s[68:69]
  buffer_load_dwordx4 a[124:127], v250, s[60:63], s56 offen offset:1024
  v_cndmask_b32 v212, v18, v212, s[70:71]
  v_cndmask_b32 v213, v18, v213, s[72:73]
  v_cndmask_b32 v214, v18, v214, s[74:75]
  v_cndmask_b32 v215, v18, v215, s[76:77]
  v_max3_f32 v246, v208, v209, v210
  v_max3_f32 v247, v211, v212, v213
  v_max3_f32 v246, v246, v214, v215
  v_max_f32 v246, v246, v247
  v_sub_f32 v208, v208, v246
  v_sub_f32 v209, v209, v246
  v_sub_f32 v210, v210, v246
  buffer_load_dwordx4 a[56:59], v250, s[60:63], s51 offen offset:2048
  v_sub_f32 v211, v211, v246
  v_sub_f32 v212, v212, v246
  v_sub_f32 v213, v213, v246
  v_sub_f32 v214, v214, v246
  v_sub_f32 v215, v215, v246
  v_exp_f32 v208, v208
  v_exp_f32 v209, v209
  v_exp_f32 v210, v210
  v_exp_f32 v211, v211
  v_exp_f32 v212, v212
  v_exp_f32 v213, v213
  buffer_load_dwordx4 a[128:131], v250, s[60:63], s56 offen offset:2048
  v_exp_f32 v214, v214
  v_exp_f32 v215, v215
  v_cvt_pk_bf16_f32 v216, v208, v209
  v_cvt_pk_bf16_f32 v217, v210, v211
  v_cvt_pk_bf16_f32 v218, v212, v213
  v_cvt_pk_bf16_f32 v219, v214, v215
  v_dot2_f32_bf16 v248, v216, s34, 0
  v_dot2_f32_bf16 v248, v217, s34, v248
  v_dot2_f32_bf16 v248, v218, s34, v248
  v_dot2_f32_bf16 v248, v219, s34, v248
  v_perm_b32 v238, v65, v45, s32
  buffer_load_dwordx4 a[60:63], v250, s[60:63], s51 offen offset:3072
  v_perm_b32 v239, v65, v45, s33
  v_perm_b32 v240, v66, v46, s32
  v_perm_b32 v241, v66, v46, s33
  v_dot2_f32_bf16 v220, v216, v238, 0
  v_dot2_f32_bf16 v221, v216, v239, 0
  v_perm_b32 v242, v67, v47, s32
  v_perm_b32 v243, v67, v47, s33
  v_dot2_f32_bf16 v222, v216, v240, 0
  v_dot2_f32_bf16 v223, v216, v241, 0
  s_waitcnt lgkmcnt(13)
  v_perm_b32 v244, v68, v48, s32
  v_perm_b32 v245, v68, v48, s33
  buffer_load_dwordx4 a[132:135], v250, s[60:63], s56 offen offset:3072
  v_dot2_f32_bf16 v224, v216, v242, 0
  v_dot2_f32_bf16 v225, v216, v243, 0
  v_perm_b32 v238, v69, v49, s32
  v_perm_b32 v239, v69, v49, s33
  v_dot2_f32_bf16 v226, v216, v244, 0
  v_dot2_f32_bf16 v227, v216, v245, 0
  v_perm_b32 v240, v70, v50, s32
  v_perm_b32 v241, v70, v50, s33
  v_dot2_f32_bf16 v228, v216, v238, 0
  v_dot2_f32_bf16 v229, v216, v239, 0
  v_perm_b32 v242, v71, v51, s32
  buffer_load_dwordx4 a[64:67], v250, s[60:63], s52 offen
  v_perm_b32 v243, v71, v51, s33
  v_dot2_f32_bf16 v230, v216, v240, 0
  v_dot2_f32_bf16 v231, v216, v241, 0
  s_waitcnt lgkmcnt(12)
  v_perm_b32 v244, v72, v52, s32
  v_perm_b32 v245, v72, v52, s33
  v_dot2_f32_bf16 v232, v216, v242, 0
  v_dot2_f32_bf16 v233, v216, v243, 0
  v_perm_b32 v238, v73, v53, s32
  v_perm_b32 v239, v73, v53, s33
  v_dot2_f32_bf16 v234, v216, v244, 0
  v_dot2_f32_bf16 v235, v216, v245, 0
  buffer_load_dwordx4 a[136:139], v250, s[60:63], s57 offen
  v_perm_b32 v240, v105, v85, s32
  v_perm_b32 v241, v105, v85, s33
  v_dot2_f32_bf16 v236, v216, v238, 0
  v_dot2_f32_bf16 v237, v216, v239, 0
  v_rcp_f32 v248, v248
  v_perm_b32 v242, v106, v86, s32
  v_perm_b32 v243, v106, v86, s33
  v_dot2_f32_bf16 v220, v217, v240, v220
  v_dot2_f32_bf16 v221, v217, v241, v221
  v_perm_b32 v244, v107, v87, s32
  v_perm_b32 v245, v107, v87, s33
  buffer_load_dwordx4 a[68:71], v250, s[60:63], s52 offen offset:1024
  v_dot2_f32_bf16 v222, v217, v242, v222
  v_dot2_f32_bf16 v223, v217, v243, v223
  s_waitcnt lgkmcnt(9)
  v_perm_b32 v238, v108, v88, s32
  v_perm_b32 v239, v108, v88, s33
  v_dot2_f32_bf16 v224, v217, v244, v224
  v_dot2_f32_bf16 v225, v217, v245, v225
  v_perm_b32 v240, v109, v89, s32
  v_perm_b32 v241, v109, v89, s33
  v_dot2_f32_bf16 v226, v217, v238, v226
  v_dot2_f32_bf16 v227, v217, v239, v227
  v_perm_b32 v242, v110, v90, s32
  buffer_load_dwordx4 a[140:143], v250, s[60:63], s57 offen offset:1024
  v_perm_b32 v243, v110, v90, s33
  v_dot2_f32_bf16 v228, v217, v240, v228
  v_dot2_f32_bf16 v229, v217, v241, v229
  v_perm_b32 v244, v111, v91, s32
  v_perm_b32 v245, v111, v91, s33
  v_dot2_f32_bf16 v230, v217, v242, v230
  v_dot2_f32_bf16 v231, v217, v243, v231
  s_waitcnt lgkmcnt(8)
  v_perm_b32 v238, v112, v92, s32
  v_perm_b32 v239, v112, v92, s33
  v_dot2_f32_bf16 v232, v217, v244, v232
  v_dot2_f32_bf16 v233, v217, v245, v233
  v_perm_b32 v240, v113, v93, s32
  v_perm_b32 v241, v113, v93, s33
  v_dot2_f32_bf16 v234, v217, v238, v234
  v_dot2_f32_bf16 v235, v217, v239, v235
  v_perm_b32 v242, v145, v125, s32
  v_perm_b32 v243, v145, v125, s33
  v_dot2_f32_bf16 v236, v217, v240, v236
  v_dot2_f32_bf16 v237, v217, v241, v237
  v_perm_b32 v244, v146, v126, s32
  v_perm_b32 v245, v146, v126, s33
  v_dot2_f32_bf16 v220, v218, v242, v220
  v_dot2_f32_bf16 v221, v218, v243, v221
  v_perm_b32 v238, v147, v127, s32
  v_perm_b32 v239, v147, v127, s33
  v_dot2_f32_bf16 v222, v218, v244, v222
  v_dot2_f32_bf16 v223, v218, v245, v223
  s_waitcnt lgkmcnt(5)
  v_perm_b32 v240, v148, v128, s32
  v_perm_b32 v241, v148, v128, s33
  v_dot2_f32_bf16 v224, v218, v238, v224
  v_dot2_f32_bf16 v225, v218, v239, v225
  v_perm_b32 v242, v149, v129, s32
  v_perm_b32 v243, v149, v129, s33
  v_dot2_f32_bf16 v226, v218, v240, v226
  v_dot2_f32_bf16 v227, v218, v241, v227
  v_perm_b32 v244, v150, v130, s32
  v_perm_b32 v245, v150, v130, s33
  v_dot2_f32_bf16 v228, v218, v242, v228
  v_dot2_f32_bf16 v229, v218, v243, v229
  v_perm_b32 v238, v151, v131, s32
  v_perm_b32 v239, v151, v131, s33
  v_dot2_f32_bf16 v230, v218, v244, v230
  v_dot2_f32_bf16 v231, v218, v245, v231
  s_waitcnt lgkmcnt(4)
  v_perm_b32 v240, v152, v132, s32
  v_perm_b32 v241, v152, v132, s33
  v_dot2_f32_bf16 v232, v218, v238, v232
  v_dot2_f32_bf16 v233, v218, v239, v233
  v_perm_b32 v242, v153, v133, s32
  v_perm_b32 v243, v153, v133, s33
  v_dot2_f32_bf16 v234, v218, v240, v234
  v_dot2_f32_bf16 v235, v218, v241, v235
  v_perm_b32 v244, v185, v165, s32
  v_perm_b32 v245, v185, v165, s33
  v_dot2_f32_bf16 v236, v218, v242, v236
  v_dot2_f32_bf16 v237, v218, v243, v237
  v_perm_b32 v238, v186, v166, s32
  v_perm_b32 v239, v186, v166, s33
  v_dot2_f32_bf16 v220, v219, v244, v220
  v_dot2_f32_bf16 v221, v219, v245, v221
  v_perm_b32 v240, v187, v167, s32
  v_perm_b32 v241, v187, v167, s33
  v_dot2_f32_bf16 v222, v219, v238, v222
  v_dot2_f32_bf16 v223, v219, v239, v223
  s_waitcnt lgkmcnt(1)
  v_perm_b32 v242, v188, v168, s32
  v_perm_b32 v243, v188, v168, s33
  v_dot2_f32_bf16 v224, v219, v240, v224
  v_dot2_f32_bf16 v225, v219, v241, v225
  v_perm_b32 v244, v189, v169, s32
  v_perm_b32 v245, v189, v169, s33
  v_dot2_f32_bf16 v226, v219, v242, v226
  v_dot2_f32_bf16 v227, v219, v243, v227
  v_perm_b32 v238, v190, v170, s32
  v_perm_b32 v239, v190, v170, s33
  v_dot2_f32_bf16 v228, v219, v244, v228
  v_dot2_f32_bf16 v229, v219, v245, v229
  v_perm_b32 v240, v191, v171, s32
  v_perm_b32 v241, v191, v171, s33
  v_dot2_f32_bf16 v230, v219, v238, v230
  v_dot2_f32_bf16 v231, v219, v239, v231
  s_waitcnt lgkmcnt(0)
  v_perm_b32 v242, v192, v172, s32
  v_perm_b32 v243, v192, v172, s33
  v_dot2_f32_bf16 v232, v219, v240, v232
  v_dot2_f32_bf16 v233, v219, v241, v233
  v_perm_b32 v244, v193, v173, s32
  v_perm_b32 v245, v193, v173, s33
  v_dot2_f32_bf16 v234, v219, v242, v234
  v_dot2_f32_bf16 v235, v219, v243, v235
  v_dot2_f32_bf16 v236, v219, v244, v236
  v_dot2_f32_bf16 v237, v219, v245, v237
  v_mul_f32 v220, v220, v248
  v_mul_f32 v221, v221, v248
  v_mul_f32 v222, v222, v248
  v_mul_f32 v223, v223, v248
  v_mul_f32 v224, v224, v248
  v_mul_f32 v225, v225, v248
  v_mul_f32 v226, v226, v248
  v_mul_f32 v227, v227, v248
  v_mul_f32 v228, v228, v248
  v_mul_f32 v229, v229, v248
  v_mul_f32 v230, v230, v248
  v_mul_f32 v231, v231, v248
  v_mul_f32 v232, v232, v248
  v_mul_f32 v233, v233, v248
  v_mul_f32 v234, v234, v248
  v_mul_f32 v235, v235, v248
  v_mul_f32 v236, v236, v248
  v_mul_f32 v237, v237, v248
  v_cvt_pk_bf16_f32 v196, v220, v221
  v_cvt_pk_bf16_f32 v197, v222, v223
  v_cvt_pk_bf16_f32 v198, v224, v225
  v_cvt_pk_bf16_f32 v199, v226, v227
  v_cvt_pk_bf16_f32 v200, v228, v229
  v_cvt_pk_bf16_f32 v201, v230, v231
  v_cvt_pk_bf16_f32 v202, v232, v233
  v_cvt_pk_bf16_f32 v203, v234, v235
  v_cvt_pk_bf16_f32 v204, v236, v237
  buffer_store_dwordx4 v[196:199], v16, s[12:15], 0 offen sc1
  buffer_store_dwordx4 v[200:203], v16, s[12:15], 0 offen offset:256 sc1
  buffer_store_dword v204, v17, s[12:15], 0 offen sc1
  s_waitcnt vmcnt(0)
  s_barrier
  s_mov_b32 s36, 32768
  buffer_store_dword v7, v29, s[96:99], s36 offen sc1
  v_and_b32 v170, 63, v0
  v_and_b32 v171, 15, v170
  v_lshlrev_b32 v160, 4, v170
  v_mov_b32 v175, 0x7ffffff0
  s_lshl_b32 s35, s93, 2
  s_lshr_b32 s36, s94, 2
  s_add_u32 s35, s35, s36
  s_and_b32 s40, s94, 3
  s_mul_i32 s3, s92, 9216
  s_and_b32 s34, s92, 1
  s_mul_i32 s39, s35, 36864
  s_add_u32 s36, s39, s3
  v_add_u32 v162, s36, v160
  s_add_u32 s64, s90, 4718592
  s_addc_u32 s65, s91, 0
  s_and_b32 s65, s65, 0xffff
  s_mov_b32 s66, 2359296
  s_mov_b32 s67, 0x20000
  s_mov_b32 s36, 32768
  buffer_load_dword v31, v30, s[96:99], s36 offen sc1
  s_waitcnt vmcnt(0)
  v_cmp_ne_u32 vcc, v7, v31
  s_cbranch_vccnz L_sp_18
L_bk_19:
  s_add_u32 m0, s3, 0
  s_nop 0
  buffer_load_dwordx4 v162, s[64:67], s48 offen sc1 lds
  buffer_load_dwordx4 v162, s[64:67], s48 offen offset:1024 sc1 lds
  buffer_load_dwordx4 v162, s[64:67], s48 offen offset:2048 sc1 lds
  buffer_load_dwordx4 v162, s[64:67], s48 offen offset:3072 sc1 lds
  s_add_u32 m0, s3, 4096
  s_nop 0
  buffer_load_dwordx4 v162, s[64:67], s49 offen sc1 lds
  buffer_load_dwordx4 v162, s[64:67], s49 offen offset:1024 sc1 lds
  buffer_load_dwordx4 v162, s[64:67], s49 offen offset:2048 sc1 lds
  buffer_load_dwordx4 v162, s[64:67], s49 offen offset:3072 sc1 lds
  s_add_u32 m0, s3, 8192
  s_nop 0
  buffer_load_dwordx4 v162, s[64:67], s50 offen sc1 lds
  s_mul_i32 s36, s40, 9
  s_and_b32 s37, s40, 1
  s_add_u32 s32, s36, s37
  s_xor_b32 s37, s37, 1
  s_lshl_b32 s37, s37, 3
  s_add_u32 s33, s36, s37
  s_lshl_b32 s36, s92, 1
  s_add_u32 s32, s32, s36
  s_cmp_lt_u32 s92, 2
  s_cselect_b32 s38, 0, 0x7ffffff0
  s_lshl_b32 s36, s32, 9
  s_add_u32 s36, s36, s39
  v_add_u32 v163, s36, v160
  s_lshr_b32 s36, s33, 1
  s_lshl_b32 s36, s36, 10
  s_and_b32 s37, s33, 1
  s_lshl_b32 s37, s37, 3
  s_add_u32 s36, s36, s37
  s_mul_i32 s37, s34, 18432
  v_add_u32 v161, s37, v160
  s_add_u32 s36, s36, s39
  v_add_u32 v164, s36, v161
  v_or_b32 v164, s38, v164
  s_lshl_b32 s36, s33, 9
  s_add_u32 s36, s36, s39
  s_add_u32 s36, s36, s37
  v_lshl_add_u32 v180, v170, 3, s36
  v_or_b32 v180, s38, v180
  v_lshrrev_b32 v173, 4, v170
  v_lshlrev_b32 v173, 8, v173
  v_lshl_add_u32 v181, v171, 2, v173
  v_add_u32 v181, 16384, v181
  v_add_u32 v182, s37, v181
  s_add_u32 s68, s90, 0
  s_addc_u32 s69, s91, 0
  s_and_b32 s69, s69, 0xffff
  s_mov_b32 s70, 2359296
  s_mov_b32 s71, 0x20000
  buffer_load_dwordx4 v[84:87], v163, s[68:71], 0 offen sc1
  buffer_load_dwordx4 v[88:91], v163, s[68:71], s53 offen sc1
  buffer_load_dwordx2 v[92:93], v164, s[68:71], 0 offen sc1
  s_add_u32 s72, s90, 2359296
  s_addc_u32 s73, s91, 0
  s_and_b32 s73, s73, 0xffff
  s_mov_b32 s74, 2359296
  s_mov_b32 s75, 0x20000
  s_add_u32 s60, s90, 7118848
  s_addc_u32 s61, s91, 0
  s_and_b32 s61, s61, 0xffff
  s_mov_b32 s62, 131072
  s_mov_b32 s63, 0x20000
  s_add_u32 s44, s90, 7110656
  s_addc_u32 s45, s91, 0
  s_and_b32 s45, s45, 0xffff
  s_mov_b32 s46, 8192
  s_mov_b32 s47, 0x20000
  v_lshlrev_b32 v173, 2, v171
  v_add_u32 v166, 36864, v173
  s_lshl_b32 s36, s34, 6
  v_add_u32 v167, s36, v166
  v_lshlrev_b32 v174, 2, v0
  v_add_u32 v174, 36992, v174
  v_and_b32 v173, 176, v0
  v_cmp_eq_u32 vcc, 128, v173
  s_nop 1
  v_cndmask_b32 v165, v174, v167, vcc
  v_lshrrev_b32 v173, 5, v170
  v_lshl_add_u32 v173, v173, 4, v171
  v_lshlrev_b32 v173, 2, v173
  s_lshl_b32 s36, s35, 7
  v_add_u32 v173, s36, v173
  s_lshl_b32 s37, s40, 2
  s_add_u32 s37, s37, s92
  s_lshl_b32 s38, s37, 13
  v_add_u32 v174, s38, v173
  v_and_b32 v169, 16, v170
  v_cmp_eq_u32 vcc, 0, v169
  s_nop 1
  v_cndmask_b32 v169, v175, v174, vcc
  v_cndmask_b32 v168, v175, v173, vcc
  s_cmp_eq_u32 s37, 0
  s_cselect_b32 s37, 0, 0x7ffffff0
  v_or_b32 v168, s37, v168
  v_cmp_gt_u32 s[78:79], 32, v170
  s_cmp_eq_u32 s92, 0
  s_cselect_b32 s58, 1.0, 0
  s_cmp_eq_u32 s92, 1
  s_cselect_b32 s59, 1.0, 0
  v_and_b32 v1, 63, v0
  v_and_b32 v2, 15, v1
  v_lshrrev_b32 v3, 4, v1
  v_lshlrev_b32 v24, 4, v1
  s_lshl_b32 s33, s92, 10
  s_and_b32 s41, s92, 1
  s_lshr_b32 s42, s92, 1
  s_and_b32 s43, s94, 1
  v_lshrrev_b32 v4, 2, v2
  v_lshl_add_u32 v4, v3, 2, v4
  v_and_b32 v5, 3, v2
  v_lshlrev_b32 v5, 3, v5
  v_lshrrev_b32 v6, 1, v4
  v_and_b32 v6, 3, v6
  s_lshl_b32 s36, s41, 1
  s_add_u32 s37, s36, 0
  v_xor_b32 v8, s37, v6
  v_lshlrev_b32 v8, 5, v8
  v_lshl_add_u32 v8, v4, 7, v8
  v_add_u32 v8, v8, v5
  v_add_u32 v9, 65536, v8
  v_add_u32 v10, 131072, v8
  s_add_u32 s37, s36, 1
  v_xor_b32 v11, s37, v6
  v_lshlrev_b32 v11, 5, v11
  v_lshl_add_u32 v11, v4, 7, v11
  v_add_u32 v11, v11, v5
  v_add_u32 v12, 65536, v11
  v_add_u32 v13, 131072, v11
  v_and_b32 v6, 1, v3
  v_xor_b32 v6, s41, v6
  v_lshlrev_b32 v6, 5, v6
  v_lshl_add_u32 v14, v4, 6, v6
  v_add_u32 v14, v14, v5
  v_add_u32 v15, 65536, v14
  v_add_u32 v25, 131072, v14
  s_lshl_b32 s36, s42, 11
  v_add_u32 v26, s36, v24
  v_add_u32 v27, 65536, v26
  v_add_u32 v28, 131072, v26
  s_mul_i32 s36, s42, 36864
  s_add_u32 s36, s36, 90112
  v_add_u32 v16, s36, v24
  s_lshl_b32 s37, s41, 12
  v_add_u32 v17, s37, v16
  s_lshl_b32 s37, s41, 3
  v_add_u32 v18, s37, v16
  v_bfe_u32 v4, v1, 1, 2
  v_xor_b32 v4, v4, v3
  v_lshlrev_b32 v4, 5, v4
  v_and_b32 v5, 1, v1
  v_lshl_add_u32 v4, v5, 4, v4
  v_lshrrev_b32 v5, 3, v1
  s_lshl_b32 s36, s92, 3
  v_add_u32 v5, s36, v5
  s_mul_i32 s36, s94, 576
  s_lshl_b32 s37, s43, 6
  s_add_u32 s37, s36, s37
  v_mul_u32_u24 v6, 9216, v5
  v_add3_u32 v19, v6, v4, s37
  v_mul_u32_u24 v6, 1152, v5
  v_add_u32 v21, v6, v4
  v_lshlrev_b32 v6, 3, v1
  s_lshl_b32 s37, s42, 11
  v_add_u32 v22, s37, v6
  v_bfe_u32 v4, v1, 1, 1
  v_and_b32 v5, 1, v3
  v_xor_b32 v4, v4, v5
  v_lshlrev_b32 v4, 5, v4
  v_and_b32 v5, 1, v1
  v_lshl_add_u32 v4, v5, 4, v4
  v_lshrrev_b32 v5, 2, v1
  s_lshl_b32 s37, s41, 4
  v_add_u32 v5, s37, v5
  v_mul_u32_u24 v5, 9216, v5
  s_xor_b32 s38, s43, 1
  s_lshl_b32 s38, s38, 9
  s_add_u32 s38, s38, s36
  v_add3_u32 v20, v5, v4, s38
  s_lshl_b32 s37, s93, 1
  s_add_u32 s37, s37, s42
  s_lshl_b32 s37, s37, 2
  s_add_u32 s37, s37, s41
  s_mul_i32 s37, s37, 18432
  v_add_u32 v23, s37, v24
  s_mov_b32 s4, s80
  s_and_b32 s5, s81, 0xffff
  s_mov_b32 s6, 5308416
  s_mov_b32 s7, 0x20000
  s_mov_b32 s8, s82
  s_and_b32 s9, s83, 0xffff
  s_mov_b32 s10, 5308416
  s_mov_b32 s11, 0x20000
  s_mov_b32 s12, s84
  s_and_b32 s13, s85, 0xffff
  s_mov_b32 s14, 5308416
  s_mov_b32 s15, 0x20000
  s_cmp_eq_u32 s42, 0
  s_cselect_b32 s24, s80, s82
  s_cselect_b32 s25, s5, s9
  s_mov_b32 s26, 5308416
  s_mov_b32 s27, 0x20000
  s_add_u32 s16, s90, 2359296
  s_addc_u32 s17, s91, 0
  s_and_b32 s17, s17, 0xffff
  s_mov_b32 s18, 2359296
  s_mov_b32 s19, 0x20000
  s_lshr_b32 s36, s94, 1
  s_mul_i32 s36, s36, 2359296
  s_lshl_b32 s37, s93, 1
  s_add_u32 s37, s37, s42
  s_mul_i32 s37, s37, 73728
  s_add_u32 s36, s36, s37
  s_add_u32 s36, s36, 26648576
  s_add_u32 s20, s90, s36
  s_addc_u32 s21, s91, 0
  s_and_b32 s21, s21, 0xffff
  s_mov_b32 s22, 73728
  s_mov_b32 s23, 0x20000
  s_lshl_b32 s36, s93, 4
  s_add_u32 s36, s36, s94
  s_lshl_b32 s36, s36, 1
  s_add_u32 s36, s36, s42
  s_mul_i32 s36, s36, 36864
  s_add_u32 s36, s36, 7774208
  s_add_u32 s28, s90, s36
  s_addc_u32 s29, s91, 0
  s_and_b32 s29, s29, 0xffff
  s_mov_b32 s30, 36864
  s_mov_b32 s31, 0x20000
  s_waitcnt vmcnt(3)
  s_barrier
  ds_read_b128 v[96:99], v160
  ds_read_b128 v[100:103], v160 offset:18432
  ds_read_b128 v[104:107], v161
  ds_read_b128 v[108:111], v160 offset:1024
  ds_read_b128 v[112:115], v160 offset:19456
  ds_read_b128 v[116:119], v161 offset:1024
  s_waitcnt lgkmcnt(3)
  v_mfma_f32_16x16x32_bf16 v[80:83], a[144:147], v[104:107], 0
  ds_read_b128 v[120:123], v160 offset:2048
  v_mfma_f32_16x16x32_bf16 v[64:67], a[0:3], v[96:99], 0
  ds_read_b128 v[124:127], v160 offset:20480
  v_mfma_f32_16x16x32_bf16 v[68:71], a[0:3], v[100:103], 0
  ds_read_b128 v[128:131], v161 offset:2048
  s_add_u32 m0, s33, 65536
  v_mfma_f32_16x16x32_bf16 v[72:75], a[72:75], v[96:99], 0
  s_mov_b32 s34, 0
  v_mfma_f32_16x16x32_bf16 v[76:79], a[72:75], v[100:103], 0
  buffer_load_dwordx4 v19, s[4:7], s34 offen lds
  s_waitcnt lgkmcnt(3)
  v_mfma_f32_16x16x32_bf16 v[80:83], a[148:151], v[116:119], v[80:83]
  ds_read_b128 v[96:99], v160 offset:3072
  v_mfma_f32_16x16x32_bf16 v[64:67], a[4:7], v[108:111], v[64:67]
  ds_read_b128 v[100:103], v160 offset:21504
  v_mfma_f32_16x16x32_bf16 v[68:71], a[4:7], v[112:115], v[68:71]
  ds_read_b128 v[104:107], v161 offset:3072
  s_add_u32 m0, s33, 69632
  v_mfma_f32_16x16x32_bf16 v[72:75], a[76:79], v[108:111], v[72:75]
  s_mov_b32 s34, 294912
  v_mfma_f32_16x16x32_bf16 v[76:79], a[76:79], v[112:115], v[76:79]
  buffer_load_dwordx4 v19, s[4:7], s34 offen lds
  s_waitcnt lgkmcnt(3)
  v_mfma_f32_16x16x32_bf16 v[80:83], a[152:155], v[128:131], v[80:83]
  ds_read_b128 v[108:111], v160 offset:4096
  v_mfma_f32_16x16x32_bf16 v[64:67], a[8:11], v[120:123], v[64:67]
  ds_read_b128 v[112:115], v160 offset:22528
  v_mfma_f32_16x16x32_bf16 v[68:71], a[8:11], v[124:127], v[68:71]
  ds_read_b128 v[116:119], v161 offset:4096
  s_add_u32 m0, s33, 73728
  v_mfma_f32_16x16x32_bf16 v[72:75], a[80:83], v[120:123], v[72:75]
  s_mov_b32 s34, 589824
  v_mfma_f32_16x16x32_bf16 v[76:79], a[80:83], v[124:127], v[76:79]
  buffer_load_dwordx4 v19, s[4:7], s34 offen lds
  s_waitcnt lgkmcnt(3)
  v_mfma_f32_16x16x32_bf16 v[80:83], a[156:159], v[104:107], v[80:83]
  ds_read_b128 v[120:123], v160 offset:5120
  v_mfma_f32_16x16x32_bf16 v[64:67], a[12:15], v[96:99], v[64:67]
  ds_read_b128 v[124:127], v160 offset:23552
  v_mfma_f32_16x16x32_bf16 v[68:71], a[12:15], v[100:103], v[68:71]
  ds_read_b128 v[128:131], v161 offset:5120
  s_add_u32 m0, s33, 77824
  v_mfma_f32_16x16x32_bf16 v[72:75], a[84:87], v[96:99], v[72:75]
  s_mov_b32 s34, 0
  v_mfma_f32_16x16x32_bf16 v[76:79], a[84:87], v[100:103], v[76:79]
  buffer_load_dwordx4 v19, s[8:11], s34 offen lds
  s_waitcnt lgkmcnt(3)
  v_mfma_f32_16x16x32_bf16 v[80:83], a[160:163], v[116:119], v[80:83]
  ds_read_b128 v[96:99], v160 offset:6144
  v_mfma_f32_16x16x32_bf16 v[64:67], a[16:19], v[108:111], v[64:67]
  ds_read_b128 v[100:103], v160 offset:24576
  v_mfma_f32_16x16x32_bf16 v[68:71], a[16:19], v[112:115], v[68:71]
  ds_read_b128 v[104:107], v161 offset:6144
  s_add_u32 m0, s33, 81920
  v_mfma_f32_16x16x32_bf16 v[72:75], a[88:91], v[108:111], v[72:75]
  s_mov_b32 s34, 294912
  v_mfma_f32_16x16x32_bf16 v[76:79], a[88:91], v[112:115], v[76:79]
  buffer_load_dwordx4 v19, s[8:11], s34 offen lds
  s_waitcnt lgkmcnt(3)
  v_mfma_f32_16x16x32_bf16 v[80:83], a[164:167], v[128:131], v[80:83]
  ds_read_b128 v[108:111], v160 offset:7168
  v_mfma_f32_16x16x32_bf16 v[64:67], a[20:23], v[120:123], v[64:67]
  ds_read_b128 v[112:115], v160 offset:25600
  v_mfma_f32_16x16x32_bf16 v[68:71], a[20:23], v[124:127], v[68:71]
  ds_read_b128 v[116:119], v161 offset:7168
  s_add_u32 m0, s33, 86016
  v_mfma_f32_16x16x32_bf16 v[72:75], a[92:95], v[120:123], v[72:75]
  s_mov_b32 s34, 589824
  v_mfma_f32_16x16x32_bf16 v[76:79], a[92:95], v[124:127], v[76:79]
  buffer_load_dwordx4 v19, s[8:11], s34 offen lds
  s_waitcnt lgkmcnt(3)
  v_mfma_f32_16x16x32_bf16 v[80:83], a[168:171], v[104:107], v[80:83]
  ds_read_b128 v[120:123], v160 offset:8192
  v_mfma_f32_16x16x32_bf16 v[64:67], a[24:27], v[96:99], v[64:67]
  ds_read_b128 v[124:127], v160 offset:26624
  v_mfma_f32_16x16x32_bf16 v[68:71], a[24:27], v[100:103], v[68:71]
  ds_read_b128 v[128:131], v161 offset:8192
  s_add_u32 m0, s33, 90112
  v_mfma_f32_16x16x32_bf16 v[72:75], a[96:99], v[96:99], v[72:75]
  s_mov_b32 s34, 884736
  v_mfma_f32_16x16x32_bf16 v[76:79], a[96:99], v[100:103], v[76:79]
  buffer_load_dwordx4 v19, s[4:7], s34 offen lds
  s_waitcnt lgkmcnt(3)
  v_mfma_f32_16x16x32_bf16 v[80:83], a[172:175], v[116:119], v[80:83]
  ds_read_b128 v[96:99], v160 offset:9216
  v_mfma_f32_16x16x32_bf16 v[64:67], a[28:31], v[108:111], v[64:67]
  ds_read_b128 v[100:103], v160 offset:27648
  v_mfma_f32_16x16x32_bf16 v[68:71], a[28:31], v[112:115], v[68:71]
  ds_read_b128 v[104:107], v161 offset:9216
  s_add_u32 m0, s33, 94208
  v_mfma_f32_16x16x32_bf16 v[72:75], a[100:103], v[108:111], v[72:75]
  s_mov_b32 s34, 1179648
  v_mfma_f32_16x16x32_bf16 v[76:79], a[100:103], v[112:115], v[76:79]
  buffer_load_dwordx4 v19, s[4:7], s34 offen lds
  s_waitcnt lgkmcnt(3)
  v_mfma_f32_16x16x32_bf16 v[80:83], a[176:179], v[128:131], v[80:83]
  ds_read_b128 v[108:111], v160 offset:10240
  v_mfma_f32_16x16x32_bf16 v[64:67], a[32:35], v[120:123], v[64:67]
  ds_read_b128 v[112:115], v160 offset:28672
  v_mfma_f32_16x16x32_bf16 v[68:71], a[32:35], v[124:127], v[68:71]
  ds_read_b128 v[116:119], v161 offset:10240
  s_add_u32 m0, s33, 98304
  v_mfma_f32_16x16x32_bf16 v[72:75], a[104:107], v[120:123], v[72:75]
  s_mov_b32 s34, 1474560
  v_mfma_f32_16x16x32_bf16 v[76:79], a[104:107], v[124:127], v[76:79]
  buffer_load_dwordx4 v19, s[4:7], s34 offen lds
  s_waitcnt lgkmcnt(3)
  v_mfma_f32_16x16x32_bf16 v[80:83], a[180:183], v[104:107], v[80:83]
  ds_read_b128 v[120:123], v160 offset:11264
  v_mfma_f32_16x16x32_bf16 v[64:67], a[36:39], v[96:99], v[64:67]
  ds_read_b128 v[124:127], v160 offset:29696
  v_mfma_f32_16x16x32_bf16 v[68:71], a[36:39], v[100:103], v[68:71]
  ds_read_b128 v[128:131], v161 offset:11264
  s_add_u32 m0, s33, 102400
  v_mfma_f32_16x16x32_bf16 v[72:75], a[108:111], v[96:99], v[72:75]
  s_mov_b32 s34, 884736
  v_mfma_f32_16x16x32_bf16 v[76:79], a[108:111], v[100:103], v[76:79]
  buffer_load_dwordx4 v19, s[8:11], s34 offen lds
  s_waitcnt lgkmcnt(3)
  v_mfma_f32_16x16x32_bf16 v[80:83], a[184:187], v[116:119], v[80:83]
  ds_read_b128 v[96:99], v160 offset:12288
  v_mfma_f32_16x16x32_bf16 v[64:67], a[40:43], v[108:111], v[64:67]
  ds_read_b128 v[100:103], v160 offset:30720
  v_mfma_f32_16x16x32_bf16 v[68:71], a[40:43], v[112:115], v[68:71]
  ds_read_b128 v[104:107], v161 offset:12288
  s_add_u32 m0, s33, 106496
  v_mfma_f32_16x16x32_bf16 v[72:75], a[112:115], v[108:111], v[72:75]
  s_mov_b32 s34, 1179648
  v_mfma_f32_16x16x32_bf16 v[76:79], a[112:115], v[112:115], v[76:79]
  buffer_load_dwordx4 v19, s[8:11], s34 offen lds
  s_waitcnt lgkmcnt(3)
  v_mfma_f32_16x16x32_bf16 v[80:83], a[188:191], v[128:131], v[80:83]
  ds_read_b128 v[108:111], v160 offset:13312
  v_mfma_f32_16x16x32_bf16 v[64:67], a[44:47], v[120:123], v[64:67]
  ds_read_b128 v[112:115], v160 offset:31744
  v_mfma_f32_16x16x32_bf16 v[68:71], a[44:47], v[124:127], v[68:71]
  ds_read_b128 v[116:119], v161 offset:13312
  s_add_u32 m0, s33, 110592
  v_mfma_f32_16x16x32_bf16 v[72:75], a[116:119], v[120:123], v[72:75]
  s_mov_b32 s34, 1474560
  v_mfma_f32_16x16x32_bf16 v[76:79], a[116:119], v[124:127], v[76:79]
  buffer_load_dwordx4 v19, s[8:11], s34 offen lds
  s_waitcnt lgkmcnt(3)
  v_mfma_f32_16x16x32_bf16 v[80:83], a[192:195], v[104:107], v[80:83]
  ds_read_b128 v[120:123], v160 offset:14336
  v_mfma_f32_16x16x32_bf16 v[64:67], a[48:51], v[96:99], v[64:67]
  ds_read_b128 v[124:127], v160 offset:32768
  v_mfma_f32_16x16x32_bf16 v[68:71], a[48:51], v[100:103], v[68:71]
  ds_read_b128 v[128:131], v161 offset:14336
  v_mfma_f32_16x16x32_bf16 v[72:75], a[120:123], v[96:99], v[72:75]
  v_mfma_f32_16x16x32_bf16 v[76:79], a[120:123], v[100:103], v[76:79]
  s_waitcnt lgkmcnt(3)
  v_mfma_f32_16x16x32_bf16 v[80:83], a[196:199], v[116:119], v[80:83]
  ds_read_b128 v[96:99], v160 offset:15360
  v_mfma_f32_16x16x32_bf16 v[64:67], a[52:55], v[108:111], v[64:67]
  ds_read_b128 v[100:103], v160 offset:33792
  v_mfma_f32_16x16x32_bf16 v[68:71], a[52:55], v[112:115], v[68:71]
  ds_read_b128 v[104:107], v161 offset:15360
  v_mfma_f32_16x16x32_bf16 v[72:75], a[124:127], v[108:111], v[72:75]
  v_mfma_f32_16x16x32_bf16 v[76:79], a[124:127], v[112:115], v[76:79]
  s_waitcnt lgkmcnt(3)
  v_mfma_f32_16x16x32_bf16 v[80:83], a[200:203], v[128:131], v[80:83]
  ds_read_b32 v108, v181
  ds_read_b32 v109, v181 offset:64
  ds_read_b32 v110, v181 offset:128
  v_mfma_f32_16x16x32_bf16 v[64:67], a[56:59], v[120:123], v[64:67]
  ds_read_b32 v111, v181 offset:192
  ds_read_b32 v112, v181 offset:18432
  ds_read_b32 v113, v181 offset:18496
  v_mfma_f32_16x16x32_bf16 v[68:71], a[56:59], v[124:127], v[68:71]
  ds_read_b32 v114, v181 offset:18560
  ds_read_b32 v115, v181 offset:18624
  ds_read_b32 v116, v182
  v_mfma_f32_16x16x32_bf16 v[72:75], a[128:131], v[120:123], v[72:75]
  ds_read_b32 v117, v182 offset:64
  ds_read_b32 v118, v182 offset:128
  ds_read_b32 v119, v182 offset:192
  v_mfma_f32_16x16x32_bf16 v[76:79], a[128:131], v[124:127], v[76:79]
  s_waitcnt lgkmcnt(12)
  v_mfma_f32_16x16x32_bf16 v[80:83], a[204:207], v[104:107], v[80:83]
  ds_read_b32 v120, v181 offset:1024
  ds_read_b32 v121, v181 offset:1088
  ds_read_b32 v122, v181 offset:1152
  v_mfma_f32_16x16x32_bf16 v[64:67], a[60:63], v[96:99], v[64:67]
  ds_read_b32 v123, v181 offset:1216
  ds_read_b32 v124, v181 offset:19456
  ds_read_b32 v125, v181 offset:19520
  v_mfma_f32_16x16x32_bf16 v[68:71], a[60:63], v[100:103], v[68:71]
  ds_read_b32 v126, v181 offset:19584
  ds_read_b32 v127, v181 offset:19648
  ds_read_b32 v128, v182 offset:1024
  v_mfma_f32_16x16x32_bf16 v[72:75], a[132:135], v[96:99], v[72:75]
  ds_read_b32 v129, v182 offset:1088
  ds_read_b32 v130, v182 offset:1152
  ds_read_b32 v131, v182 offset:1216
  v_mfma_f32_16x16x32_bf16 v[76:79], a[132:135], v[100:103], v[76:79]
  s_waitcnt lgkmcnt(12)
  v_mfma_f32_16x16x32_bf16 v[80:83], a[208:211], v[116:119], v[80:83]
  v_mfma_f32_16x16x32_bf16 v[64:67], a[64:67], v[108:111], v[64:67]
  v_mfma_f32_16x16x32_bf16 v[68:71], a[64:67], v[112:115], v[68:71]
  v_mfma_f32_16x16x32_bf16 v[72:75], a[136:139], v[108:111], v[72:75]
  v_mfma_f32_16x16x32_bf16 v[76:79], a[136:139], v[112:115], v[76:79]
  s_waitcnt lgkmcnt(0)
  v_mfma_f32_16x16x32_bf16 v[80:83], a[212:215], v[128:131], v[80:83]
  v_mfma_f32_16x16x32_bf16 v[64:67], a[68:71], v[120:123], v[64:67]
  v_mfma_f32_16x16x32_bf16 v[68:71], a[68:71], v[124:127], v[68:71]
  v_mfma_f32_16x16x32_bf16 v[72:75], a[140:143], v[120:123], v[72:75]
  v_mfma_f32_16x16x32_bf16 v[76:79], a[140:143], v[124:127], v[76:79]
  s_nop 3
  v_add_f32 v176, v80, v81
  ds_write_b32 v165, v176
  s_waitcnt lgkmcnt(0)
  s_barrier
  ds_read_b32 v177, v166
  ds_read_b32 v178, v166 offset:64
  ds_read_b32 v179, v167
  s_waitcnt vmcnt(14)
  v_lshlrev_b32 v32, 16, v84
  v_and_b32 v33, 0xffff0000, v84
  v_add_f32 v64, v64, v32
  v_add_f32 v65, v65, v33
  v_lshlrev_b32 v32, 16, v85
  v_and_b32 v33, 0xffff0000, v85
  v_add_f32 v66, v66, v32
  v_add_f32 v67, v67, v33
  s_waitcnt vmcnt(13)
  v_lshlrev_b32 v32, 16, v88
  v_and_b32 v33, 0xffff0000, v88
  v_add_f32 v68, v68, v32
  v_add_f32 v69, v69, v33
  v_lshlrev_b32 v32, 16, v89
  v_and_b32 v33, 0xffff0000, v89
  v_add_f32 v70, v70, v32
  v_add_f32 v71, v71, v33
  v_lshlrev_b32 v32, 16, v86
  v_and_b32 v33, 0xffff0000, v86
  v_add_f32 v72, v72, v32
  v_add_f32 v73, v73, v33
  v_lshlrev_b32 v32, 16, v87
  v_and_b32 v33, 0xffff0000, v87
  v_add_f32 v74, v74, v32
  v_add_f32 v75, v75, v33
  v_lshlrev_b32 v32, 16, v90
  v_and_b32 v33, 0xffff0000, v90
  v_add_f32 v76, v76, v32
  v_add_f32 v77, v77, v33
  v_lshlrev_b32 v32, 16, v91
  v_and_b32 v33, 0xffff0000, v91
  v_add_f32 v78, v78, v32
  v_add_f32 v79, v79, v33
  s_waitcnt vmcnt(12)
  v_lshlrev_b32 v32, 16, v92
  v_and_b32 v33, 0xffff0000, v92
  v_add_f32 v80, v80, v32
  v_add_f32 v81, v81, v33
  v_lshlrev_b32 v32, 16, v93
  v_and_b32 v33, 0xffff0000, v93
  v_add_f32 v82, v82, v32
  v_add_f32 v83, v83, v33
  s_waitcnt lgkmcnt(1)
  v_cndmask_b32 v176, v178, v177, s[78:79]
  buffer_store_dword v176, v168, s[44:47], 0 offen sc1
  v_sub_f32 v64, v64, v177
  v_sub_f32 v65, v65, v177
  v_sub_f32 v66, v66, v177
  v_sub_f32 v67, v67, v177
  v_sub_f32 v68, v68, v178
  v_sub_f32 v69, v69, v178
  v_sub_f32 v70, v70, v178
  v_sub_f32 v71, v71, v178
  v_sub_f32 v72, v72, v177
  v_sub_f32 v73, v73, v177
  v_sub_f32 v74, v74, v177
  v_sub_f32 v75, v75, v177
  v_sub_f32 v76, v76, v178
  v_sub_f32 v77, v77, v178
  v_sub_f32 v78, v78, v178
  v_sub_f32 v79, v79, v178
  s_waitcnt lgkmcnt(0)
  v_sub_f32 v80, v80, v179
  v_sub_f32 v81, v81, v179
  v_sub_f32 v82, v82, v179
  v_sub_f32 v83, v83, v179
  v_cvt_pk_bf16_f32 v36, v64, v65
  v_cvt_pk_bf16_f32 v37, v66, v67
  v_cvt_pk_bf16_f32 v38, v72, v73
  v_cvt_pk_bf16_f32 v39, v74, v75
  v_cvt_pk_bf16_f32 v40, v68, v69
  v_cvt_pk_bf16_f32 v41, v70, v71
  v_cvt_pk_bf16_f32 v42, v76, v77
  v_cvt_pk_bf16_f32 v43, v78, v79
  v_cvt_pk_bf16_f32 v44, v80, v81
  v_cvt_pk_bf16_f32 v45, v82, v83
  buffer_store_dwordx4 v[36:39], v163, s[72:75], 0 offen sc1
  buffer_store_dwordx4 v[40:43], v163, s[72:75], s53 offen sc1
  buffer_store_dwordx2 v[44:45], v180, s[72:75], 0 offen sc1
  v_mul_f32 v48, v64, v64
  v_mul_f32 v49, v68, v68
  v_mul_f32 v50, v80, v80
  v_fmac_f32 v48, v72, v72
  v_fmac_f32 v49, v76, v76
  v_fmac_f32 v48, v65, v65
  v_fmac_f32 v49, v69, v69
  v_fmac_f32 v50, v81, v81
  v_fmac_f32 v48, v73, v73
  v_fmac_f32 v49, v77, v77
  v_fmac_f32 v48, v66, v66
  v_fmac_f32 v49, v70, v70
  v_fmac_f32 v50, v82, v82
  v_fmac_f32 v48, v74, v74
  v_fmac_f32 v49, v78, v78
  v_fmac_f32 v48, v67, v67
  v_fmac_f32 v49, v71, v71
  v_fmac_f32 v50, v83, v83
  v_fmac_f32 v48, v75, v75
  v_fmac_f32 v49, v79, v79
  v_fmac_f32 v48, s58, v50
  v_fmac_f32 v49, s59, v50
  s_nop 1
  v_permlane32_swap_b32 v48, v49
  v_add_f32 v48, v48, v49
  v_mov_b32 v49, v48
  s_nop 1
  v_permlane16_swap_b32 v48, v49
  v_add_f32 v48, v48, v49
  buffer_store_dword v48, v169, s[60:63], 0 offen sc1
  s_waitcnt vmcnt(0)
  s_barrier
  s_mov_b32 s36, 65536
  buffer_store_dword v7, v29, s[96:99], s36 offen sc1
  s_add_u32 m0, s33, 114688
  s_mov_b32 s34, 1769472
  buffer_load_dwordx4 v19, s[4:7], s34 offen lds
  s_add_u32 m0, s33, 118784
  s_mov_b32 s34, 2064384
  buffer_load_dwordx4 v19, s[4:7], s34 offen lds
  s_add_u32 m0, s33, 122880
  s_mov_b32 s34, 2359296
  buffer_load_dwordx4 v19, s[4:7], s34 offen lds
  s_add_u32 m0, s33, 126976
  s_mov_b32 s34, 1769472
  buffer_load_dwordx4 v19, s[8:11], s34 offen lds
  s_add_u32 m0, s33, 131072
  s_mov_b32 s34, 2064384
  buffer_load_dwordx4 v19, s[8:11], s34 offen lds
  s_add_u32 m0, s33, 135168
  s_mov_b32 s34, 2359296
  buffer_load_dwordx4 v19, s[8:11], s34 offen lds
  s_mov_b32 s36, 65536
  buffer_load_dword v31, v30, s[96:99], s36 offen sc1
  s_waitcnt vmcnt(0)
  v_cmp_ne_u32 vcc, v7, v31
  s_cbranch_vccnz L_sp_20
L_bk_21:
  s_add_u32 m0, s33, 40960
  s_mov_b32 s34, 0
  buffer_load_dwordx4 v23, s[16:19], s34 offen sc1 lds
  s_add_u32 m0, s33, 45056
  s_mov_b32 s34, 36864
  buffer_load_dwordx4 v23, s[16:19], s34 offen sc1 lds
  s_add_u32 m0, s33, 49152
  s_mov_b32 s34, 1024
  buffer_load_dwordx4 v23, s[16:19], s34 offen sc1 lds
  s_add_u32 m0, s33, 53248
  s_mov_b32 s34, 37888
  buffer_load_dwordx4 v23, s[16:19], s34 offen sc1 lds
  s_add_u32 m0, s33, 57344
  s_mov_b32 s34, 2048
  buffer_load_dwordx4 v23, s[16:19], s34 offen sc1 lds
  s_add_u32 m0, s33, 61440
  s_mov_b32 s34, 38912
  buffer_load_dwordx4 v23, s[16:19], s34 offen sc1 lds
  s_add_u32 m0, s33, 139264
  s_mov_b32 s34, 3072
  buffer_load_dwordx4 v23, s[16:19], s34 offen sc1 lds
  s_add_u32 m0, s33, 143360
  s_mov_b32 s34, 39936
  buffer_load_dwordx4 v23, s[16:19], s34 offen sc1 lds
  s_add_u32 m0, s33, 0
  s_mov_b32 s34, 4096
  buffer_load_dwordx4 v23, s[16:19], s34 offen sc1 lds
  s_add_u32 m0, s33, 4096
  s_mov_b32 s34, 40960
  buffer_load_dwordx4 v23, s[16:19], s34 offen sc1 lds
  s_add_u32 m0, s33, 147456
  s_mov_b32 s34, 5120
  buffer_load_dwordx4 v23, s[16:19], s34 offen sc1 lds
  s_add_u32 m0, s33, 151552
  s_mov_b32 s34, 41984
  buffer_load_dwordx4 v23, s[16:19], s34 offen sc1 lds
  s_waitcnt vmcnt(6)
  s_barrier
  ds_read_b64_tr_b16 v[56:57], v9
  ds_read_b64_tr_b16 v[58:59], v9 offset:2048
  ds_read_b64_tr_b16 v[60:61], v9 offset:4096
  ds_read_b64_tr_b16 v[62:63], v9 offset:6144
  ds_read_b64_tr_b16 v[64:65], v9 offset:8192
  ds_read_b64_tr_b16 v[66:67], v9 offset:10240
  ds_read_b128 a[0:3], v26 offset:40960
  ds_read_b128 a[4:7], v26 offset:41984
  ds_read_b128 a[8:11], v26 offset:45056
  ds_read_b128 a[12:15], v26 offset:46080
  ds_read_b128 a[16:19], v26 offset:49152
  ds_read_b128 a[20:23], v26 offset:50176
  ds_read_b128 a[24:27], v26 offset:53248
  ds_read_b128 a[28:31], v26 offset:54272
  ds_read_b128 a[32:35], v26 offset:57344
  ds_read_b128 a[36:39], v26 offset:58368
  ds_read_b128 a[40:43], v26 offset:61440
  ds_read_b128 a[44:47], v26 offset:62464
  s_waitcnt lgkmcnt(12)
  s_waitcnt lgkmcnt(11)
  v_mfma_f32_16x16x32_bf16 v[128:131], v[56:59], a[0:3], 0
  s_waitcnt vmcnt(4)
  s_barrier
  s_waitcnt lgkmcnt(7)
  v_mfma_f32_16x16x32_bf16 v[128:131], v[60:63], a[16:19], v[128:131]
  ds_read_b64_tr_b16 v[68:69], v12
  s_add_u32 m0, s33, 155648
  s_waitcnt lgkmcnt(4)
  v_mfma_f32_16x16x32_bf16 v[128:131], v[64:67], a[32:35], v[128:131]
  ds_read_b64_tr_b16 v[70:71], v12 offset:2048
  s_mov_b32 s34, 6144
  v_mfma_f32_16x16x32_bf16 v[132:135], v[56:59], a[4:7], 0
  ds_read_b64_tr_b16 v[72:73], v12 offset:4096
  buffer_load_dwordx4 v23, s[16:19], s34 offen sc1 lds
  v_mfma_f32_16x16x32_bf16 v[132:135], v[60:63], a[20:23], v[132:135]
  ds_read_b64_tr_b16 v[74:75], v12 offset:6144
  s_add_u32 m0, s33, 159744
  s_waitcnt lgkmcnt(6)
  v_mfma_f32_16x16x32_bf16 v[132:135], v[64:67], a[36:39], v[132:135]
  ds_read_b64_tr_b16 v[76:77], v12 offset:8192
  s_mov_b32 s34, 43008
  v_mfma_f32_16x16x32_bf16 v[136:139], v[56:59], a[8:11], 0
  ds_read_b64_tr_b16 v[78:79], v12 offset:10240
  buffer_load_dwordx4 v23, s[16:19], s34 offen sc1 lds
  v_mfma_f32_16x16x32_bf16 v[136:139], v[60:63], a[24:27], v[136:139]
  s_add_u32 m0, s33, 8192
  s_waitcnt lgkmcnt(7)
  v_mfma_f32_16x16x32_bf16 v[136:139], v[64:67], a[40:43], v[136:139]
  s_mov_b32 s34, 7168
  v_mfma_f32_16x16x32_bf16 v[140:143], v[56:59], a[12:15], 0
  buffer_load_dwordx4 v23, s[16:19], s34 offen sc1 lds
  v_mfma_f32_16x16x32_bf16 v[140:143], v[60:63], a[28:31], v[140:143]
  s_waitcnt lgkmcnt(6)
  v_mfma_f32_16x16x32_bf16 v[140:143], v[64:67], a[44:47], v[140:143]
  s_waitcnt lgkmcnt(0)
  v_mfma_f32_16x16x32_bf16 v[144:147], v[68:71], a[0:3], 0
  ds_read_b64_tr_b16 v[56:57], v9 offset:12288
  s_add_u32 m0, s33, 12288
  v_mfma_f32_16x16x32_bf16 v[144:147], v[72:75], a[16:19], v[144:147]
  ds_read_b64_tr_b16 v[58:59], v9 offset:14336
  s_mov_b32 s34, 44032
  v_mfma_f32_16x16x32_bf16 v[144:147], v[76:79], a[32:35], v[144:147]
  ds_read_b64_tr_b16 v[60:61], v9 offset:16384
  buffer_load_dwordx4 v23, s[16:19], s34 offen sc1 lds
  v_mfma_f32_16x16x32_bf16 v[148:151], v[68:71], a[4:7], 0
  ds_read_b64_tr_b16 v[62:63], v9 offset:18432
  s_add_u32 m0, s33, 16384
  v_mfma_f32_16x16x32_bf16 v[148:151], v[72:75], a[20:23], v[148:151]
  ds_read_b64_tr_b16 v[64:65], v9 offset:20480
  s_mov_b32 s34, 8192
  v_mfma_f32_16x16x32_bf16 v[148:151], v[76:79], a[36:39], v[148:151]
  ds_read_b64_tr_b16 v[66:67], v9 offset:22528
  buffer_load_dwordx4 v23, s[16:19], s34 offen sc1 lds
  v_mfma_f32_16x16x32_bf16 v[152:155], v[68:71], a[8:11], 0
  ds_read_b128 a[48:51], v28 offset:8192
  s_add_u32 m0, s33, 20480
  v_mfma_f32_16x16x32_bf16 v[152:155], v[72:75], a[24:27], v[152:155]
  ds_read_b128 a[52:55], v28 offset:9216
  s_mov_b32 s34, 45056
  v_mfma_f32_16x16x32_bf16 v[152:155], v[76:79], a[40:43], v[152:155]
  ds_read_b128 a[56:59], v28 offset:12288
  buffer_load_dwordx4 v23, s[16:19], s34 offen sc1 lds
  v_mfma_f32_16x16x32_bf16 v[156:159], v[68:71], a[12:15], 0
  ds_read_b128 a[60:63], v28 offset:13312
  v_mfma_f32_16x16x32_bf16 v[156:159], v[72:75], a[28:31], v[156:159]
  v_mfma_f32_16x16x32_bf16 v[156:159], v[76:79], a[44:47], v[156:159]
  s_waitcnt lgkmcnt(4)
  v_mfma_f32_16x16x32_bf16 v[160:163], v[56:59], a[0:3], 0
  s_waitcnt vmcnt(6)
  s_barrier
  v_mfma_f32_16x16x32_bf16 v[160:163], v[60:63], a[16:19], v[160:163]
  ds_read_b64_tr_b16 v[68:69], v12 offset:12288
  s_add_u32 m0, s33, 24576
  v_mfma_f32_16x16x32_bf16 v[160:163], v[64:67], a[32:35], v[160:163]
  ds_read_b64_tr_b16 v[70:71], v12 offset:14336
  s_mov_b32 s34, 9216
  v_mfma_f32_16x16x32_bf16 v[164:167], v[56:59], a[4:7], 0
  ds_read_b64_tr_b16 v[72:73], v12 offset:16384
  buffer_load_dwordx4 v23, s[16:19], s34 offen sc1 lds
  v_mfma_f32_16x16x32_bf16 v[164:167], v[60:63], a[20:23], v[164:167]
  ds_read_b64_tr_b16 v[74:75], v12 offset:18432
  s_add_u32 m0, s33, 28672
  v_mfma_f32_16x16x32_bf16 v[164:167], v[64:67], a[36:39], v[164:167]
  ds_read_b64_tr_b16 v[76:77], v12 offset:20480
  s_mov_b32 s34, 46080
  v_mfma_f32_16x16x32_bf16 v[168:171], v[56:59], a[8:11], 0
  ds_read_b64_tr_b16 v[78:79], v12 offset:22528
  ds_read_b64 a[64:65], v22
  buffer_load_dwordx4 v23, s[16:19], s34 offen sc1 lds
  v_mfma_f32_16x16x32_bf16 v[168:171], v[60:63], a[24:27], v[168:171]
  ds_read_b64 a[66:67], v22 offset:512
  ds_read_b64 a[68:69], v22 offset:1024
  s_add_u32 m0, s33, 32768
  v_mfma_f32_16x16x32_bf16 v[168:171], v[64:67], a[40:43], v[168:171]
  ds_read_b64 a[70:71], v22 offset:1536
  ds_read_b64 a[72:73], v22 offset:4096
  s_mov_b32 s34, 10240
  v_mfma_f32_16x16x32_bf16 v[172:175], v[56:59], a[12:15], 0
  ds_read_b64 a[74:75], v22 offset:4608
  ds_read_b64 a[76:77], v22 offset:5120
  buffer_load_dwordx4 v23, s[16:19], s34 offen sc1 lds
  v_mfma_f32_16x16x32_bf16 v[172:175], v[60:63], a[28:31], v[172:175]
  ds_read_b64 a[78:79], v22 offset:5632
  v_mfma_f32_16x16x32_bf16 v[172:175], v[64:67], a[44:47], v[172:175]
  s_waitcnt lgkmcnt(8)
  v_mfma_f32_16x16x32_bf16 v[176:179], v[68:71], a[0:3], 0
  ds_read_b64_tr_b16 v[56:57], v9 offset:24576
  s_add_u32 m0, s33, 36864
  v_mfma_f32_16x16x32_bf16 v[176:179], v[72:75], a[16:19], v[176:179]
  ds_read_b64_tr_b16 v[58:59], v9 offset:26624
  s_mov_b32 s34, 47104
  v_mfma_f32_16x16x32_bf16 v[176:179], v[76:79], a[32:35], v[176:179]
  ds_read_b64_tr_b16 v[60:61], v9 offset:28672
  buffer_load_dwordx4 v23, s[16:19], s34 offen sc1 lds
  v_mfma_f32_16x16x32_bf16 v[180:183], v[68:71], a[4:7], 0
  ds_read_b64_tr_b16 v[62:63], v9 offset:30720
  s_add_u32 m0, s33, 40960
  v_mfma_f32_16x16x32_bf16 v[180:183], v[72:75], a[20:23], v[180:183]
  ds_read_b64_tr_b16 v[64:65], v9 offset:32768
  s_mov_b32 s34, 11264
  v_mfma_f32_16x16x32_bf16 v[180:183], v[76:79], a[36:39], v[180:183]
  ds_read_b64_tr_b16 v[66:67], v9 offset:34816
  buffer_load_dwordx4 v23, s[16:19], s34 offen sc1 lds
  v_mfma_f32_16x16x32_bf16 v[184:187], v[68:71], a[8:11], 0
  ds_read_b128 a[80:83], v28 offset:16384
  s_add_u32 m0, s33, 45056
  v_mfma_f32_16x16x32_bf16 v[184:187], v[72:75], a[24:27], v[184:187]
  ds_read_b128 a[84:87], v28 offset:17408
  s_mov_b32 s34, 48128
  v_mfma_f32_16x16x32_bf16 v[184:187], v[76:79], a[40:43], v[184:187]
  ds_read_b128 a[88:91], v28 offset:20480
  buffer_load_dwordx4 v23, s[16:19], s34 offen sc1 lds
  v_mfma_f32_16x16x32_bf16 v[188:191], v[68:71], a[12:15], 0
  ds_read_b128 a[92:95], v28 offset:21504
  v_mfma_f32_16x16x32_bf16 v[188:191], v[72:75], a[28:31], v[188:191]
  v_mfma_f32_16x16x32_bf16 v[188:191], v[76:79], a[44:47], v[188:191]
  s_waitcnt lgkmcnt(4)
  v_mfma_f32_16x16x32_bf16 v[128:131], v[56:59], a[48:51], v[128:131]
  s_waitcnt vmcnt(10)
  s_barrier
  v_mfma_f32_16x16x32_bf16 v[128:131], v[60:63], a[64:67], v[128:131]
  ds_read_b64_tr_b16 v[68:69], v12 offset:24576
  s_add_u32 m0, s33, 49152
  s_waitcnt lgkmcnt(4)
  v_mfma_f32_16x16x32_bf16 v[128:131], v[64:67], a[80:83], v[128:131]
  ds_read_b64_tr_b16 v[70:71], v12 offset:26624
  s_mov_b32 s34, 2654208
  v_mfma_f32_16x16x32_bf16 v[132:135], v[56:59], a[52:55], v[132:135]
  ds_read_b64_tr_b16 v[72:73], v12 offset:28672
  buffer_load_dwordx4 v19, s[4:7], s34 offen lds
  v_mfma_f32_16x16x32_bf16 v[132:135], v[60:63], a[68:71], v[132:135]
  ds_read_b64_tr_b16 v[74:75], v12 offset:30720
  s_add_u32 m0, s33, 53248
  s_waitcnt lgkmcnt(6)
  v_mfma_f32_16x16x32_bf16 v[132:135], v[64:67], a[84:87], v[132:135]
  ds_read_b64_tr_b16 v[76:77], v12 offset:32768
  s_mov_b32 s34, 2949120
  v_mfma_f32_16x16x32_bf16 v[136:139], v[56:59], a[56:59], v[136:139]
  ds_read_b64_tr_b16 v[78:79], v12 offset:34816
  buffer_load_dwordx4 v19, s[4:7], s34 offen lds
  v_mfma_f32_16x16x32_bf16 v[136:139], v[60:63], a[72:75], v[136:139]
  s_add_u32 m0, s33, 57344
  s_waitcnt lgkmcnt(7)
  v_mfma_f32_16x16x32_bf16 v[136:139], v[64:67], a[88:91], v[136:139]
  s_mov_b32 s34, 3244032
  v_mfma_f32_16x16x32_bf16 v[140:143], v[56:59], a[60:63], v[140:143]
  buffer_load_dwordx4 v19, s[4:7], s34 offen lds
  v_mfma_f32_16x16x32_bf16 v[140:143], v[60:63], a[76:79], v[140:143]
  s_waitcnt lgkmcnt(6)
  v_mfma_f32_16x16x32_bf16 v[140:143], v[64:67], a[92:95], v[140:143]
  s_waitcnt lgkmcnt(0)
  v_mfma_f32_16x16x32_bf16 v[144:147], v[68:71], a[48:51], v[144:147]
  ds_read_b64_tr_b16 v[56:57], v9 offset:36864
  s_add_u32 m0, s33, 61440
  v_mfma_f32_16x16x32_bf16 v[144:147], v[72:75], a[64:67], v[144:147]
  ds_read_b64_tr_b16 v[58:59], v9 offset:38912
  s_mov_b32 s34, 2654208
  v_mfma_f32_16x16x32_bf16 v[144:147], v[76:79], a[80:83], v[144:147]
  ds_read_b64_tr_b16 v[60:61], v9 offset:40960
  buffer_load_dwordx4 v19, s[8:11], s34 offen lds
  v_mfma_f32_16x16x32_bf16 v[148:151], v[68:71], a[52:55], v[148:151]
  ds_read_b64_tr_b16 v[62:63], v9 offset:43008
  s_add_u32 m0, s33, 65536
  v_mfma_f32_16x16x32_bf16 v[148:151], v[72:75], a[68:71], v[148:151]
  ds_read_b64_tr_b16 v[64:65], v9 offset:45056
  s_mov_b32 s34, 2949120
  v_mfma_f32_16x16x32_bf16 v[148:151], v[76:79], a[84:87], v[148:151]
  ds_read_b64_tr_b16 v[66:67], v9 offset:47104
  buffer_load_dwordx4 v19, s[8:11], s34 offen lds
  v_mfma_f32_16x16x32_bf16 v[152:155], v[68:71], a[56:59], v[152:155]
  ds_read_b128 a[96:99], v28 offset:24576
  s_add_u32 m0, s33, 69632
  v_mfma_f32_16x16x32_bf16 v[152:155], v[72:75], a[72:75], v[152:155]
  ds_read_b128 a[100:103], v28 offset:25600
  s_mov_b32 s34, 3244032
  v_mfma_f32_16x16x32_bf16 v[152:155], v[76:79], a[88:91], v[152:155]
  ds_read_b128 a[104:107], v28 offset:28672
  buffer_load_dwordx4 v19, s[8:11], s34 offen lds
  v_mfma_f32_16x16x32_bf16 v[156:159], v[68:71], a[60:63], v[156:159]
  ds_read_b128 a[108:111], v28 offset:29696
  v_mfma_f32_16x16x32_bf16 v[156:159], v[72:75], a[76:79], v[156:159]
  v_mfma_f32_16x16x32_bf16 v[156:159], v[76:79], a[92:95], v[156:159]
  s_waitcnt lgkmcnt(4)
  v_mfma_f32_16x16x32_bf16 v[160:163], v[56:59], a[48:51], v[160:163]
  s_waitcnt vmcnt(12)
  s_barrier
  v_mfma_f32_16x16x32_bf16 v[160:163], v[60:63], a[64:67], v[160:163]
  ds_read_b64_tr_b16 v[68:69], v12 offset:36864
  s_add_u32 m0, s33, 73728
  v_mfma_f32_16x16x32_bf16 v[160:163], v[64:67], a[80:83], v[160:163]
  ds_read_b64_tr_b16 v[70:71], v12 offset:38912
  s_mov_b32 s34, 12288
  v_mfma_f32_16x16x32_bf16 v[164:167], v[56:59], a[52:55], v[164:167]
  ds_read_b64_tr_b16 v[72:73], v12 offset:40960
  buffer_load_dwordx4 v23, s[16:19], s34 offen sc1 lds
  v_mfma_f32_16x16x32_bf16 v[164:167], v[60:63], a[68:71], v[164:167]
  ds_read_b64_tr_b16 v[74:75], v12 offset:43008
  s_add_u32 m0, s33, 77824
  v_mfma_f32_16x16x32_bf16 v[164:167], v[64:67], a[84:87], v[164:167]
  ds_read_b64_tr_b16 v[76:77], v12 offset:45056
  s_mov_b32 s34, 49152
  v_mfma_f32_16x16x32_bf16 v[168:171], v[56:59], a[56:59], v[168:171]
  ds_read_b64_tr_b16 v[78:79], v12 offset:47104
  buffer_load_dwordx4 v23, s[16:19], s34 offen sc1 lds
  v_mfma_f32_16x16x32_bf16 v[168:171], v[60:63], a[72:75], v[168:171]
  ds_read_b128 a[112:115], v26 offset:8192
  s_add_u32 m0, s33, 0
  v_mfma_f32_16x16x32_bf16 v[168:171], v[64:67], a[88:91], v[168:171]
  ds_read_b128 a[116:119], v26 offset:9216
  s_mov_b32 s34, 13312
  v_mfma_f32_16x16x32_bf16 v[172:175], v[56:59], a[60:63], v[172:175]
  ds_read_b128 a[120:123], v26 offset:12288
  buffer_load_dwordx4 v23, s[16:19], s34 offen sc1 lds
  v_mfma_f32_16x16x32_bf16 v[172:175], v[60:63], a[76:79], v[172:175]
  ds_read_b128 a[124:127], v26 offset:13312
  v_mfma_f32_16x16x32_bf16 v[172:175], v[64:67], a[92:95], v[172:175]
  s_waitcnt lgkmcnt(4)
  v_mfma_f32_16x16x32_bf16 v[176:179], v[68:71], a[48:51], v[176:179]
  ds_read_b64_tr_b16 v[56:57], v9 offset:49152
  s_add_u32 m0, s33, 4096
  v_mfma_f32_16x16x32_bf16 v[176:179], v[72:75], a[64:67], v[176:179]
  ds_read_b64_tr_b16 v[58:59], v9 offset:51200
  s_mov_b32 s34, 50176
  v_mfma_f32_16x16x32_bf16 v[176:179], v[76:79], a[80:83], v[176:179]
  ds_read_b64_tr_b16 v[60:61], v9 offset:53248
  buffer_load_dwordx4 v23, s[16:19], s34 offen sc1 lds
  v_mfma_f32_16x16x32_bf16 v[180:183], v[68:71], a[52:55], v[180:183]
  ds_read_b64_tr_b16 v[62:63], v9 offset:55296
  s_add_u32 m0, s33, 81920
  v_mfma_f32_16x16x32_bf16 v[180:183], v[72:75], a[68:71], v[180:183]
  ds_read_b64_tr_b16 v[64:65], v9 offset:57344
  s_mov_b32 s34, 14336
  v_mfma_f32_16x16x32_bf16 v[180:183], v[76:79], a[84:87], v[180:183]
  ds_read_b64_tr_b16 v[66:67], v9 offset:59392
  buffer_load_dwordx4 v23, s[16:19], s34 offen sc1 lds
  v_mfma_f32_16x16x32_bf16 v[184:187], v[68:71], a[56:59], v[184:187]
  ds_read_b128 a[128:131], v26 offset:16384
  s_add_u32 m0, s33, 86016
  v_mfma_f32_16x16x32_bf16 v[184:187], v[72:75], a[72:75], v[184:187]
  ds_read_b128 a[132:135], v26 offset:17408
  s_mov_b32 s34, 51200
  v_mfma_f32_16x16x32_bf16 v[184:187], v[76:79], a[88:91], v[184:187]
  ds_read_b128 a[136:139], v26 offset:20480
  buffer_load_dwordx4 v23, s[16:19], s34 offen sc1 lds
  v_mfma_f32_16x16x32_bf16 v[188:191], v[68:71], a[60:63], v[188:191]
  ds_read_b128 a[140:143], v26 offset:21504
  v_mfma_f32_16x16x32_bf16 v[188:191], v[72:75], a[76:79], v[188:191]
  v_mfma_f32_16x16x32_bf16 v[188:191], v[76:79], a[92:95], v[188:191]
  s_waitcnt lgkmcnt(4)
  v_mfma_f32_16x16x32_bf16 v[128:131], v[56:59], a[96:99], v[128:131]
  s_waitcnt vmcnt(16)
  s_barrier
  v_mfma_f32_16x16x32_bf16 v[128:131], v[60:63], a[112:115], v[128:131]
  ds_read_b64_tr_b16 v[68:69], v12 offset:49152
  s_add_u32 m0, s33, 139264
  s_waitcnt lgkmcnt(4)
  v_mfma_f32_16x16x32_bf16 v[128:131], v[64:67], a[128:131], v[128:131]
  ds_read_b64_tr_b16 v[70:71], v12 offset:51200
  s_mov_b32 s34, 3538944
  v_mfma_f32_16x16x32_bf16 v[132:135], v[56:59], a[100:103], v[132:135]
  ds_read_b64_tr_b16 v[72:73], v12 offset:53248
  buffer_load_dwordx4 v19, s[4:7], s34 offen lds
  v_mfma_f32_16x16x32_bf16 v[132:135], v[60:63], a[116:119], v[132:135]
  ds_read_b64_tr_b16 v[74:75], v12 offset:55296
  s_add_u32 m0, s33, 143360
  s_waitcnt lgkmcnt(6)
  v_mfma_f32_16x16x32_bf16 v[132:135], v[64:67], a[132:135], v[132:135]
  ds_read_b64_tr_b16 v[76:77], v12 offset:57344
  s_mov_b32 s34, 3833856
  v_mfma_f32_16x16x32_bf16 v[136:139], v[56:59], a[104:107], v[136:139]
  ds_read_b64_tr_b16 v[78:79], v12 offset:59392
  buffer_load_dwordx4 v19, s[4:7], s34 offen lds
  v_mfma_f32_16x16x32_bf16 v[136:139], v[60:63], a[120:123], v[136:139]
  s_add_u32 m0, s33, 90112
  s_waitcnt lgkmcnt(7)
  v_mfma_f32_16x16x32_bf16 v[136:139], v[64:67], a[136:139], v[136:139]
  s_mov_b32 s34, 4128768
  v_mfma_f32_16x16x32_bf16 v[140:143], v[56:59], a[108:111], v[140:143]
  buffer_load_dwordx4 v19, s[4:7], s34 offen lds
  v_mfma_f32_16x16x32_bf16 v[140:143], v[60:63], a[124:127], v[140:143]
  s_waitcnt lgkmcnt(6)
  v_mfma_f32_16x16x32_bf16 v[140:143], v[64:67], a[140:143], v[140:143]
  s_waitcnt lgkmcnt(0)
  v_mfma_f32_16x16x32_bf16 v[144:147], v[68:71], a[96:99], v[144:147]
  ds_read_b64_tr_b16 v[56:57], v9 offset:61440
  s_add_u32 m0, s33, 94208
  v_mfma_f32_16x16x32_bf16 v[144:147], v[72:75], a[112:115], v[144:147]
  ds_read_b64_tr_b16 v[58:59], v9 offset:63488
  s_mov_b32 s34, 3538944
  v_mfma_f32_16x16x32_bf16 v[144:147], v[76:79], a[128:131], v[144:147]
  ds_read_b64_tr_b16 v[60:61], v10
  buffer_load_dwordx4 v19, s[8:11], s34 offen lds
  v_mfma_f32_16x16x32_bf16 v[148:151], v[68:71], a[100:103], v[148:151]
  ds_read_b64_tr_b16 v[62:63], v10 offset:2048
  s_add_u32 m0, s33, 98304
  v_mfma_f32_16x16x32_bf16 v[148:151], v[72:75], a[116:119], v[148:151]
  ds_read_b64_tr_b16 v[64:65], v10 offset:4096
  s_mov_b32 s34, 3833856
  v_mfma_f32_16x16x32_bf16 v[148:151], v[76:79], a[132:135], v[148:151]
  ds_read_b64_tr_b16 v[66:67], v10 offset:6144
  buffer_load_dwordx4 v19, s[8:11], s34 offen lds
  v_mfma_f32_16x16x32_bf16 v[152:155], v[68:71], a[104:107], v[152:155]
  ds_read_b128 a[144:147], v26 offset:24576
  s_add_u32 m0, s33, 147456
  v_mfma_f32_16x16x32_bf16 v[152:155], v[72:75], a[120:123], v[152:155]
  ds_read_b128 a[148:151], v26 offset:25600
  s_mov_b32 s34, 4128768
  v_mfma_f32_16x16x32_bf16 v[152:155], v[76:79], a[136:139], v[152:155]
  ds_read_b128 a[152:155], v26 offset:28672
  buffer_load_dwordx4 v19, s[8:11], s34 offen lds
  v_mfma_f32_16x16x32_bf16 v[156:159], v[68:71], a[108:111], v[156:159]
  ds_read_b128 a[156:159], v26 offset:29696
  v_mfma_f32_16x16x32_bf16 v[156:159], v[72:75], a[124:127], v[156:159]
  v_mfma_f32_16x16x32_bf16 v[156:159], v[76:79], a[140:143], v[156:159]
  s_waitcnt lgkmcnt(4)
  v_mfma_f32_16x16x32_bf16 v[160:163], v[56:59], a[96:99], v[160:163]
  s_waitcnt vmcnt(15)
  s_barrier
  v_mfma_f32_16x16x32_bf16 v[160:163], v[60:63], a[112:115], v[160:163]
  ds_read_b64_tr_b16 v[68:69], v12 offset:61440
  s_add_u32 m0, s33, 151552
  v_mfma_f32_16x16x32_bf16 v[160:163], v[64:67], a[128:131], v[160:163]
  ds_read_b64_tr_b16 v[70:71], v12 offset:63488
  s_mov_b32 s34, 15360
  v_mfma_f32_16x16x32_bf16 v[164:167], v[56:59], a[100:103], v[164:167]
  ds_read_b64_tr_b16 v[72:73], v13
  buffer_load_dwordx4 v23, s[16:19], s34 offen sc1 lds
  v_mfma_f32_16x16x32_bf16 v[164:167], v[60:63], a[116:119], v[164:167]
  ds_read_b64_tr_b16 v[74:75], v13 offset:2048
  s_add_u32 m0, s33, 102400
  v_mfma_f32_16x16x32_bf16 v[164:167], v[64:67], a[132:135], v[164:167]
  ds_read_b64_tr_b16 v[76:77], v13 offset:4096
  s_mov_b32 s34, 52224
  v_mfma_f32_16x16x32_bf16 v[168:171], v[56:59], a[104:107], v[168:171]
  ds_read_b64_tr_b16 v[78:79], v13 offset:6144
  buffer_load_dwordx4 v23, s[16:19], s34 offen sc1 lds
  v_mfma_f32_16x16x32_bf16 v[168:171], v[60:63], a[120:123], v[168:171]
  ds_read_b128 a[160:163], v26 offset:32768
  s_add_u32 m0, s33, 106496
  v_mfma_f32_16x16x32_bf16 v[168:171], v[64:67], a[136:139], v[168:171]
  ds_read_b128 a[164:167], v26 offset:33792
  s_mov_b32 s34, 16384
  v_mfma_f32_16x16x32_bf16 v[172:175], v[56:59], a[108:111], v[172:175]
  ds_read_b128 a[168:171], v26 offset:36864
  buffer_load_dwordx4 v23, s[16:19], s34 offen sc1 lds
  v_mfma_f32_16x16x32_bf16 v[172:175], v[60:63], a[124:127], v[172:175]
  ds_read_b128 a[172:175], v26 offset:37888
  v_mfma_f32_16x16x32_bf16 v[172:175], v[64:67], a[140:143], v[172:175]
  s_waitcnt lgkmcnt(4)
  v_mfma_f32_16x16x32_bf16 v[176:179], v[68:71], a[96:99], v[176:179]
  ds_read_b64_tr_b16 v[56:57], v8 offset:49152
  s_add_u32 m0, s33, 110592
  v_mfma_f32_16x16x32_bf16 v[176:179], v[72:75], a[112:115], v[176:179]
  ds_read_b64_tr_b16 v[58:59], v8 offset:51200
  s_mov_b32 s34, 53248
  v_mfma_f32_16x16x32_bf16 v[176:179], v[76:79], a[128:131], v[176:179]
  ds_read_b64_tr_b16 v[60:61], v8 offset:53248
  buffer_load_dwordx4 v23, s[16:19], s34 offen sc1 lds
  v_mfma_f32_16x16x32_bf16 v[180:183], v[68:71], a[100:103], v[180:183]
  ds_read_b64_tr_b16 v[62:63], v8 offset:55296
  s_add_u32 m0, s33, 155648
  v_mfma_f32_16x16x32_bf16 v[180:183], v[72:75], a[116:119], v[180:183]
  ds_read_b64_tr_b16 v[64:65], v8 offset:57344
  s_mov_b32 s34, 17408
  v_mfma_f32_16x16x32_bf16 v[180:183], v[76:79], a[132:135], v[180:183]
  ds_read_b64_tr_b16 v[66:67], v8 offset:59392
  buffer_load_dwordx4 v23, s[16:19], s34 offen sc1 lds
  v_mfma_f32_16x16x32_bf16 v[184:187], v[68:71], a[104:107], v[184:187]
  ds_read_b128 a[176:179], v26 offset:40960
  s_add_u32 m0, s33, 159744
  v_mfma_f32_16x16x32_bf16 v[184:187], v[72:75], a[120:123], v[184:187]
  ds_read_b128 a[180:183], v26 offset:41984
  s_mov_b32 s34, 54272
  v_mfma_f32_16x16x32_bf16 v[184:187], v[76:79], a[136:139], v[184:187]
  ds_read_b128 a[184:187], v26 offset:45056
  buffer_load_dwordx4 v23, s[16:19], s34 offen sc1 lds
  v_mfma_f32_16x16x32_bf16 v[188:191], v[68:71], a[108:111], v[188:191]
  ds_read_b128 a[188:191], v26 offset:46080
  v_mfma_f32_16x16x32_bf16 v[188:191], v[72:75], a[124:127], v[188:191]
  v_mfma_f32_16x16x32_bf16 v[188:191], v[76:79], a[140:143], v[188:191]
  s_waitcnt lgkmcnt(4)
  v_mfma_f32_16x16x32_bf16 v[128:131], v[56:59], a[144:147], v[128:131]
  s_waitcnt vmcnt(16)
  s_barrier
  v_mfma_f32_16x16x32_bf16 v[128:131], v[60:63], a[160:163], v[128:131]
  ds_read_b64_tr_b16 v[68:69], v11 offset:49152
  s_add_u32 m0, s33, 8192
  s_waitcnt lgkmcnt(4)
  v_mfma_f32_16x16x32_bf16 v[128:131], v[64:67], a[176:179], v[128:131]
  ds_read_b64_tr_b16 v[70:71], v11 offset:51200
  s_mov_b32 s34, 4423680
  v_mfma_f32_16x16x32_bf16 v[132:135], v[56:59], a[148:151], v[132:135]
  ds_read_b64_tr_b16 v[72:73], v11 offset:53248
  buffer_load_dwordx4 v19, s[4:7], s34 offen lds
  v_mfma_f32_16x16x32_bf16 v[132:135], v[60:63], a[164:167], v[132:135]
  ds_read_b64_tr_b16 v[74:75], v11 offset:55296
  s_add_u32 m0, s33, 12288
  s_waitcnt lgkmcnt(6)
  v_mfma_f32_16x16x32_bf16 v[132:135], v[64:67], a[180:183], v[132:135]
  ds_read_b64_tr_b16 v[76:77], v11 offset:57344
  s_mov_b32 s34, 4718592
  v_mfma_f32_16x16x32_bf16 v[136:139], v[56:59], a[152:155], v[136:139]
  ds_read_b64_tr_b16 v[78:79], v11 offset:59392
  buffer_load_dwordx4 v19, s[4:7], s34 offen lds
  v_mfma_f32_16x16x32_bf16 v[136:139], v[60:63], a[168:171], v[136:139]
  s_add_u32 m0, s33, 114688
  s_and_b32 s36, s92, 1
  s_waitcnt lgkmcnt(7)
  v_mfma_f32_16x16x32_bf16 v[136:139], v[64:67], a[184:187], v[136:139]
  s_mov_b32 s34, 5013504
  s_lshl_b32 s37, s36, 12
  v_mfma_f32_16x16x32_bf16 v[140:143], v[56:59], a[156:159], v[140:143]
  buffer_load_dwordx4 v19, s[4:7], s34 offen lds
  v_add_u32 v80, s37, v24
  v_mfma_f32_16x16x32_bf16 v[140:143], v[60:63], a[172:175], v[140:143]
  s_lshl_b32 s37, s36, 9
  v_lshrrev_b32 v81, 1, v24
  s_waitcnt lgkmcnt(6)
  v_mfma_f32_16x16x32_bf16 v[140:143], v[64:67], a[188:191], v[140:143]
  v_add_u32 v81, s37, v81
  s_waitcnt lgkmcnt(0)
  v_mfma_f32_16x16x32_bf16 v[144:147], v[68:71], a[144:147], v[144:147]
  ds_read_b64_tr_b16 v[56:57], v8 offset:61440
  s_add_u32 m0, s33, 118784
  v_mfma_f32_16x16x32_bf16 v[144:147], v[72:75], a[160:163], v[144:147]
  ds_read_b64_tr_b16 v[58:59], v8 offset:63488
  s_mov_b32 s34, 4423680
  v_mfma_f32_16x16x32_bf16 v[144:147], v[76:79], a[176:179], v[144:147]
  ds_read_b64_tr_b16 v[60:61], v9
  buffer_load_dwordx4 v19, s[8:11], s34 offen lds
  v_mfma_f32_16x16x32_bf16 v[148:151], v[68:71], a[148:151], v[148:151]
  ds_read_b64_tr_b16 v[62:63], v9 offset:2048
  s_add_u32 m0, s33, 122880
  v_mfma_f32_16x16x32_bf16 v[148:151], v[72:75], a[164:167], v[148:151]
  ds_read_b64_tr_b16 v[64:65], v9 offset:4096
  s_mov_b32 s34, 4718592
  v_mfma_f32_16x16x32_bf16 v[148:151], v[76:79], a[180:183], v[148:151]
  ds_read_b64_tr_b16 v[66:67], v9 offset:6144
  buffer_load_dwordx4 v19, s[8:11], s34 offen lds
  v_mfma_f32_16x16x32_bf16 v[152:155], v[68:71], a[152:155], v[152:155]
  ds_read_b128 a[192:195], v27 offset:8192
  s_add_u32 m0, s33, 16384
  v_mfma_f32_16x16x32_bf16 v[152:155], v[72:75], a[168:171], v[152:155]
  ds_read_b128 a[196:199], v27 offset:9216
  s_mov_b32 s34, 5013504
  v_mfma_f32_16x16x32_bf16 v[152:155], v[76:79], a[184:187], v[152:155]
  ds_read_b128 a[200:203], v27 offset:12288
  buffer_load_dwordx4 v19, s[8:11], s34 offen lds
  v_mfma_f32_16x16x32_bf16 v[156:159], v[68:71], a[156:159], v[156:159]
  ds_read_b128 a[204:207], v27 offset:13312
  s_mul_i32 s36, s93, 36
  v_mfma_f32_16x16x32_bf16 v[156:159], v[72:75], a[172:175], v[156:159]
  v_add_u32 v4, s36, v0
  v_mul_u32_u24 v4, 9216, v4
  v_mfma_f32_16x16x32_bf16 v[156:159], v[76:79], a[188:191], v[156:159]
  s_mul_i32 s36, s94, 576
  s_waitcnt lgkmcnt(4)
  v_mfma_f32_16x16x32_bf16 v[160:163], v[56:59], a[144:147], v[160:163]
  s_waitcnt vmcnt(15)
  s_barrier
  v_mfma_f32_16x16x32_bf16 v[160:163], v[60:63], a[160:163], v[160:163]
  ds_read_b64_tr_b16 v[68:69], v11 offset:61440
  s_add_u32 m0, s33, 20480
  v_mfma_f32_16x16x32_bf16 v[160:163], v[64:67], a[176:179], v[160:163]
  ds_read_b64_tr_b16 v[70:71], v11 offset:63488
  s_mov_b32 s34, 128
  v_mfma_f32_16x16x32_bf16 v[164:167], v[56:59], a[148:151], v[164:167]
  ds_read_b64_tr_b16 v[72:73], v12
  buffer_load_dwordx4 v19, s[4:7], s34 offen lds
  v_mfma_f32_16x16x32_bf16 v[164:167], v[60:63], a[164:167], v[164:167]
  ds_read_b64_tr_b16 v[74:75], v12 offset:2048
  s_add_u32 m0, s33, 135168
  v_mfma_f32_16x16x32_bf16 v[164:167], v[64:67], a[180:183], v[164:167]
  ds_read_b64_tr_b16 v[76:77], v12 offset:4096
  s_mov_b32 s34, 295040
  v_mfma_f32_16x16x32_bf16 v[168:171], v[56:59], a[152:155], v[168:171]
  ds_read_b64_tr_b16 v[78:79], v12 offset:6144
  ds_read_b64 a[208:209], v22
  buffer_load_dwordx4 v19, s[4:7], s34 offen lds
  v_mfma_f32_16x16x32_bf16 v[168:171], v[60:63], a[168:171], v[168:171]
  ds_read_b64 a[210:211], v22 offset:512
  ds_read_b64 a[212:213], v22 offset:1024
  s_add_u32 m0, s33, 24576
  v_mfma_f32_16x16x32_bf16 v[168:171], v[64:67], a[184:187], v[168:171]
  ds_read_b64 a[214:215], v22 offset:1536
  ds_read_b64 a[216:217], v22 offset:4096
  s_mov_b32 s34, 589952
  v_mfma_f32_16x16x32_bf16 v[172:175], v[56:59], a[156:159], v[172:175]
  ds_read_b64 a[218:219], v22 offset:4608
  ds_read_b64 a[220:221], v22 offset:5120
  buffer_load_dwordx4 v19, s[4:7], s34 offen lds
  v_mfma_f32_16x16x32_bf16 v[172:175], v[60:63], a[172:175], v[172:175]
  ds_read_b64 a[222:223], v22 offset:5632
  s_and_b32 s36, s36, 0xffffff80
  v_mfma_f32_16x16x32_bf16 v[172:175], v[64:67], a[188:191], v[172:175]
  v_add_u32 v4, s36, v4
  s_waitcnt lgkmcnt(8)
  v_mfma_f32_16x16x32_bf16 v[176:179], v[68:71], a[144:147], v[176:179]
  ds_read_b64_tr_b16 v[56:57], v10 offset:8192
  v_mov_b32 v6, 0x7ffffff0
  v_mfma_f32_16x16x32_bf16 v[176:179], v[72:75], a[160:163], v[176:179]
  ds_read_b64_tr_b16 v[58:59], v10 offset:10240
  v_cmp_gt_u32 vcc, 36, v0
  v_mfma_f32_16x16x32_bf16 v[176:179], v[76:79], a[176:179], v[176:179]
  ds_read_b64_tr_b16 v[60:61], v10 offset:12288
  v_cndmask_b32 v92, v6, v4, vcc
  v_mfma_f32_16x16x32_bf16 v[180:183], v[68:71], a[148:151], v[180:183]
  ds_read_b64_tr_b16 v[62:63], v10 offset:14336
  s_lshl_b32 s36, s94, 4
  v_mfma_f32_16x16x32_bf16 v[180:183], v[72:75], a[164:167], v[180:183]
  ds_read_b64_tr_b16 v[64:65], v9 offset:24576
  s_add_u32 s36, s36, s93
  v_mfma_f32_16x16x32_bf16 v[180:183], v[76:79], a[180:183], v[180:183]
  ds_read_b64_tr_b16 v[66:67], v9 offset:26624
  s_mul_i32 s36, s36, 20736
  v_mfma_f32_16x16x32_bf16 v[184:187], v[68:71], a[152:155], v[184:187]
  ds_read_b128 a[224:227], v27 offset:16384
  v_lshl_add_u32 v4, v0, 7, s36
  v_mfma_f32_16x16x32_bf16 v[184:187], v[72:75], a[168:171], v[184:187]
  ds_read_b128 a[228:231], v27 offset:17408
  v_cmp_gt_u32 vcc, 54, v0
  v_mfma_f32_16x16x32_bf16 v[184:187], v[76:79], a[184:187], v[184:187]
  ds_read_b128 a[232:235], v27 offset:20480
  v_cndmask_b32 v93, v6, v4, vcc
  v_mfma_f32_16x16x32_bf16 v[188:191], v[68:71], a[156:159], v[188:191]
  ds_read_b128 a[236:239], v27 offset:21504
  s_cmp_eq_u32 s95, 0
  s_cselect_b32 s36, 0, 0x7ffffff0
  v_mfma_f32_16x16x32_bf16 v[188:191], v[72:75], a[172:175], v[188:191]
  v_or_b32 v92, s36, v92
  v_or_b32 v93, s36, v93
  v_mfma_f32_16x16x32_bf16 v[188:191], v[76:79], a[188:191], v[188:191]
  s_and_b32 s65, s94, 1
  s_waitcnt lgkmcnt(4)
  v_mfma_f32_16x16x32_bf16 v[128:131], v[56:59], a[192:195], v[128:131]
  s_waitcnt vmcnt(13)
  s_barrier
  v_mfma_f32_16x16x32_bf16 v[128:131], v[60:63], a[208:211], v[128:131]
  ds_read_b64_tr_b16 v[68:69], v13 offset:8192
  s_add_u32 m0, s33, 28672
  s_waitcnt lgkmcnt(4)
  v_mfma_f32_16x16x32_bf16 v[128:131], v[64:67], a[224:227], v[128:131]
  ds_read_b64_tr_b16 v[70:71], v13 offset:10240
  s_mov_b32 s34, 128
  v_mfma_f32_16x16x32_bf16 v[132:135], v[56:59], a[196:199], v[132:135]
  ds_read_b64_tr_b16 v[72:73], v13 offset:12288
  buffer_load_dwordx4 v19, s[8:11], s34 offen lds
  v_mfma_f32_16x16x32_bf16 v[132:135], v[60:63], a[212:215], v[132:135]
  ds_read_b64_tr_b16 v[74:75], v13 offset:14336
  s_add_u32 m0, s33, 32768
  s_waitcnt lgkmcnt(6)
  v_mfma_f32_16x16x32_bf16 v[132:135], v[64:67], a[228:231], v[132:135]
  ds_read_b64_tr_b16 v[76:77], v12 offset:24576
  s_mov_b32 s34, 295040
  v_mfma_f32_16x16x32_bf16 v[136:139], v[56:59], a[200:203], v[136:139]
  ds_read_b64_tr_b16 v[78:79], v12 offset:26624
  buffer_load_dwordx4 v19, s[8:11], s34 offen lds
  v_mfma_f32_16x16x32_bf16 v[136:139], v[60:63], a[216:219], v[136:139]
  s_add_u32 m0, s33, 36864
  s_add_u32 s65, s65, 1
  s_waitcnt lgkmcnt(7)
  v_mfma_f32_16x16x32_bf16 v[136:139], v[64:67], a[232:235], v[136:139]
  s_mov_b32 s34, 589952
  s_cmp_eq_u32 s65, 5
  s_cselect_b32 s65, 0, s65
  v_mfma_f32_16x16x32_bf16 v[140:143], v[56:59], a[204:207], v[140:143]
  buffer_load_dwordx4 v19, s[8:11], s34 offen lds
  s_lshl_b32 s65, s65, 7
  v_mfma_f32_16x16x32_bf16 v[140:143], v[60:63], a[220:223], v[140:143]
  buffer_load_dword v31, v92, s[4:7], s65 offen
  s_waitcnt lgkmcnt(6)
  v_mfma_f32_16x16x32_bf16 v[140:143], v[64:67], a[236:239], v[140:143]
  buffer_load_dword v31, v92, s[8:11], s65 offen
  s_waitcnt lgkmcnt(0)
  v_mfma_f32_16x16x32_bf16 v[144:147], v[68:71], a[192:195], v[144:147]
  ds_read_b64_tr_b16 v[56:57], v9 offset:28672
  v_mfma_f32_16x16x32_bf16 v[144:147], v[72:75], a[208:211], v[144:147]
  ds_read_b64_tr_b16 v[58:59], v9 offset:30720
  v_mfma_f32_16x16x32_bf16 v[144:147], v[76:79], a[224:227], v[144:147]
  ds_read_b64_tr_b16 v[60:61], v9 offset:32768
  v_mfma_f32_16x16x32_bf16 v[148:151], v[68:71], a[196:199], v[148:151]
  ds_read_b64_tr_b16 v[62:63], v9 offset:34816
  v_mfma_f32_16x16x32_bf16 v[148:151], v[72:75], a[212:215], v[148:151]
  ds_read_b64_tr_b16 v[64:65], v10 offset:16384
  v_mfma_f32_16x16x32_bf16 v[148:151], v[76:79], a[228:231], v[148:151]
  ds_read_b64_tr_b16 v[66:67], v10 offset:18432
  v_mfma_f32_16x16x32_bf16 v[152:155], v[68:71], a[200:203], v[152:155]
  ds_read_b128 a[240:243], v28 offset:20480
  v_mfma_f32_16x16x32_bf16 v[152:155], v[72:75], a[216:219], v[152:155]
  ds_read_b128 a[244:247], v28 offset:21504
  v_mfma_f32_16x16x32_bf16 v[152:155], v[76:79], a[232:235], v[152:155]
  ds_read_b128 a[248:251], v27 offset:36864
  v_mfma_f32_16x16x32_bf16 v[156:159], v[68:71], a[204:207], v[156:159]
  ds_read_b128 a[252:255], v27 offset:37888
  v_mfma_f32_16x16x32_bf16 v[156:159], v[72:75], a[220:223], v[156:159]
  v_mfma_f32_16x16x32_bf16 v[156:159], v[76:79], a[236:239], v[156:159]
  s_waitcnt lgkmcnt(4)
  v_mfma_f32_16x16x32_bf16 v[160:163], v[56:59], a[192:195], v[160:163]
  s_waitcnt vmcnt(11)
  s_barrier
  v_mfma_f32_16x16x32_bf16 v[160:163], v[60:63], a[208:211], v[160:163]
  ds_read_b64_tr_b16 v[68:69], v12 offset:28672
  s_add_u32 m0, s33, 40960
  v_mfma_f32_16x16x32_bf16 v[160:163], v[64:67], a[224:227], v[160:163]
  ds_read_b64_tr_b16 v[70:71], v12 offset:30720
  s_mov_b32 s34, 884864
  v_mfma_f32_16x16x32_bf16 v[164:167], v[56:59], a[196:199], v[164:167]
  ds_read_b64_tr_b16 v[72:73], v12 offset:32768
  buffer_load_dwordx4 v19, s[4:7], s34 offen lds
  v_mfma_f32_16x16x32_bf16 v[164:167], v[60:63], a[212:215], v[164:167]
  ds_read_b64_tr_b16 v[74:75], v12 offset:34816
  s_add_u32 m0, s33, 45056
  v_mfma_f32_16x16x32_bf16 v[164:167], v[64:67], a[228:231], v[164:167]
  ds_read_b64_tr_b16 v[76:77], v13 offset:16384
  s_mov_b32 s34, 1179776
  v_mfma_f32_16x16x32_bf16 v[168:171], v[56:59], a[200:203], v[168:171]
  ds_read_b64_tr_b16 v[78:79], v13 offset:18432
  buffer_load_dwordx4 v19, s[4:7], s34 offen lds
  v_mfma_f32_16x16x32_bf16 v[168:171], v[60:63], a[216:219], v[168:171]
  ds_read_b128 v[96:99], v27 offset:40960
  s_add_u32 m0, s33, 49152
  v_mfma_f32_16x16x32_bf16 v[168:171], v[64:67], a[232:235], v[168:171]
  ds_read_b128 v[100:103], v27 offset:41984
  s_mov_b32 s34, 1474688
  v_mfma_f32_16x16x32_bf16 v[172:175], v[56:59], a[204:207], v[172:175]
  ds_read_b128 v[104:107], v27 offset:45056
  buffer_load_dwordx4 v19, s[4:7], s34 offen lds
  v_mfma_f32_16x16x32_bf16 v[172:175], v[60:63], a[220:223], v[172:175]
  ds_read_b128 v[108:111], v27 offset:46080
  v_mfma_f32_16x16x32_bf16 v[172:175], v[64:67], a[236:239], v[172:175]
  s_waitcnt lgkmcnt(4)
  v_mfma_f32_16x16x32_bf16 v[176:179], v[68:71], a[192:195], v[176:179]
  ds_read_b64_tr_b16 v[56:57], v8 offset:8192
  v_mfma_f32_16x16x32_bf16 v[176:179], v[72:75], a[208:211], v[176:179]
  ds_read_b64_tr_b16 v[58:59], v8 offset:10240
  v_mfma_f32_16x16x32_bf16 v[176:179], v[76:79], a[224:227], v[176:179]
  ds_read_b64_tr_b16 v[60:61], v8 offset:12288
  v_mfma_f32_16x16x32_bf16 v[180:183], v[68:71], a[196:199], v[180:183]
  ds_read_b64_tr_b16 v[62:63], v8 offset:14336
  v_mfma_f32_16x16x32_bf16 v[180:183], v[72:75], a[212:215], v[180:183]
  ds_read_b64_tr_b16 v[64:65], v9 offset:49152
  v_mfma_f32_16x16x32_bf16 v[180:183], v[76:79], a[228:231], v[180:183]
  ds_read_b64_tr_b16 v[66:67], v9 offset:51200
  v_mfma_f32_16x16x32_bf16 v[184:187], v[68:71], a[200:203], v[184:187]
  ds_read_b128 v[112:115], v28 offset:24576
  v_mfma_f32_16x16x32_bf16 v[184:187], v[72:75], a[216:219], v[184:187]
  ds_read_b128 v[116:119], v28 offset:25600
  v_mfma_f32_16x16x32_bf16 v[184:187], v[76:79], a[232:235], v[184:187]
  ds_read_b128 v[120:123], v28 offset:28672
  v_mfma_f32_16x16x32_bf16 v[188:191], v[68:71], a[204:207], v[188:191]
  ds_read_b128 v[124:127], v28 offset:29696
  v_mfma_f32_16x16x32_bf16 v[188:191], v[72:75], a[220:223], v[188:191]
  v_mfma_f32_16x16x32_bf16 v[188:191], v[76:79], a[236:239], v[188:191]
  s_waitcnt lgkmcnt(4)
  v_mfma_f32_16x16x32_bf16 v[128:131], v[56:59], a[240:243], v[128:131]
  s_waitcnt vmcnt(11)
  s_barrier
  v_mfma_f32_16x16x32_bf16 v[128:131], v[60:63], v[96:99], v[128:131]
  ds_read_b64_tr_b16 v[68:69], v11 offset:8192
  s_add_u32 m0, s33, 53248
  s_waitcnt lgkmcnt(4)
  v_mfma_f32_16x16x32_bf16 v[128:131], v[64:67], v[112:115], v[128:131]
  ds_read_b64_tr_b16 v[70:71], v11 offset:10240
  s_mov_b32 s34, 884864
  v_mfma_f32_16x16x32_bf16 v[132:135], v[56:59], a[244:247], v[132:135]
  ds_read_b64_tr_b16 v[72:73], v11 offset:12288
  buffer_load_dwordx4 v19, s[8:11], s34 offen lds
  v_mfma_f32_16x16x32_bf16 v[132:135], v[60:63], v[100:103], v[132:135]
  ds_read_b64_tr_b16 v[74:75], v11 offset:14336
  s_add_u32 m0, s33, 57344
  s_waitcnt lgkmcnt(6)
  v_mfma_f32_16x16x32_bf16 v[132:135], v[64:67], v[116:119], v[132:135]
  ds_read_b64_tr_b16 v[76:77], v12 offset:49152
  s_mov_b32 s34, 1179776
  v_mfma_f32_16x16x32_bf16 v[136:139], v[56:59], a[248:251], v[136:139]
  ds_read_b64_tr_b16 v[78:79], v12 offset:51200
  buffer_load_dwordx4 v19, s[8:11], s34 offen lds
  v_mfma_f32_16x16x32_bf16 v[136:139], v[60:63], v[104:107], v[136:139]
  s_add_u32 m0, s33, 61440
  s_waitcnt lgkmcnt(7)
  v_mfma_f32_16x16x32_bf16 v[136:139], v[64:67], v[120:123], v[136:139]
  s_mov_b32 s34, 1474688
  v_mfma_f32_16x16x32_bf16 v[140:143], v[56:59], a[252:255], v[140:143]
  buffer_load_dwordx4 v19, s[8:11], s34 offen lds
  v_mfma_f32_16x16x32_bf16 v[140:143], v[60:63], v[108:111], v[140:143]
  s_waitcnt lgkmcnt(6)
  v_mfma_f32_16x16x32_bf16 v[140:143], v[64:67], v[124:127], v[140:143]
  s_waitcnt lgkmcnt(0)
  v_mfma_f32_16x16x32_bf16 v[144:147], v[68:71], a[240:243], v[144:147]
  ds_read_b64_tr_b16 v[56:57], v9 offset:53248
  v_mfma_f32_16x16x32_bf16 v[144:147], v[72:75], v[96:99], v[144:147]
  ds_read_b64_tr_b16 v[58:59], v9 offset:55296
  v_mfma_f32_16x16x32_bf16 v[144:147], v[76:79], v[112:115], v[144:147]
  ds_read_b64_tr_b16 v[60:61], v9 offset:57344
  v_mfma_f32_16x16x32_bf16 v[148:151], v[68:71], a[244:247], v[148:151]
  ds_read_b64_tr_b16 v[62:63], v9 offset:59392
  v_mfma_f32_16x16x32_bf16 v[148:151], v[72:75], v[100:103], v[148:151]
  ds_read_b64_tr_b16 v[64:65], v8 offset:16384
  v_mfma_f32_16x16x32_bf16 v[148:151], v[76:79], v[116:119], v[148:151]
  ds_read_b64_tr_b16 v[66:67], v8 offset:18432
  v_mfma_f32_16x16x32_bf16 v[152:155], v[68:71], a[248:251], v[152:155]
  v_mfma_f32_16x16x32_bf16 v[152:155], v[72:75], v[104:107], v[152:155]
  v_mfma_f32_16x16x32_bf16 v[152:155], v[76:79], v[120:123], v[152:155]
  v_mfma_f32_16x16x32_bf16 v[156:159], v[68:71], a[252:255], v[156:159]
  v_mfma_f32_16x16x32_bf16 v[156:159], v[72:75], v[108:111], v[156:159]
  v_mfma_f32_16x16x32_bf16 v[156:159], v[76:79], v[124:127], v[156:159]
  s_waitcnt lgkmcnt(0)
  v_mfma_f32_16x16x32_bf16 v[160:163], v[56:59], a[240:243], v[160:163]
  s_waitcnt vmcnt(11)
  s_barrier
  v_mfma_f32_16x16x32_bf16 v[160:163], v[60:63], v[96:99], v[160:163]
  ds_read_b64_tr_b16 v[68:69], v12 offset:53248
  s_add_u32 m0, s33, 65536
  v_mfma_f32_16x16x32_bf16 v[160:163], v[64:67], v[112:115], v[160:163]
  ds_read_b64_tr_b16 v[70:71], v12 offset:55296
  s_mov_b32 s34, 1769600
  v_mfma_f32_16x16x32_bf16 v[164:167], v[56:59], a[244:247], v[164:167]
  ds_read_b64_tr_b16 v[72:73], v12 offset:57344
  buffer_load_dwordx4 v19, s[4:7], s34 offen lds
  v_mfma_f32_16x16x32_bf16 v[164:167], v[60:63], v[100:103], v[164:167]
  ds_read_b64_tr_b16 v[74:75], v12 offset:59392
  s_add_u32 m0, s33, 69632
  v_mfma_f32_16x16x32_bf16 v[164:167], v[64:67], v[116:119], v[164:167]
  ds_read_b64_tr_b16 v[76:77], v11 offset:16384
  s_mov_b32 s34, 2064512
  v_mfma_f32_16x16x32_bf16 v[168:171], v[56:59], a[248:251], v[168:171]
  ds_read_b64_tr_b16 v[78:79], v11 offset:18432
  buffer_load_dwordx4 v19, s[4:7], s34 offen lds
  v_mfma_f32_16x16x32_bf16 v[168:171], v[60:63], v[104:107], v[168:171]
  s_add_u32 m0, s33, 73728
  s_and_b32 s65, s94, 1
  v_mfma_f32_16x16x32_bf16 v[168:171], v[64:67], v[120:123], v[168:171]
  s_mov_b32 s34, 2359424
  s_add_u32 s65, s65, 2
  v_mfma_f32_16x16x32_bf16 v[172:175], v[56:59], a[252:255], v[172:175]
  buffer_load_dwordx4 v19, s[4:7], s34 offen lds
  s_cmp_eq_u32 s65, 5
  s_cselect_b32 s65, 0, s65
  v_mfma_f32_16x16x32_bf16 v[172:175], v[60:63], v[108:111], v[172:175]
  s_lshl_b32 s65, s65, 7
  v_mfma_f32_16x16x32_bf16 v[172:175], v[64:67], v[124:127], v[172:175]
  buffer_load_dword v31, v92, s[4:7], s65 offen
  s_waitcnt lgkmcnt(0)
  v_mfma_f32_16x16x32_bf16 v[176:179], v[68:71], a[240:243], v[176:179]
  ds_read_b64_tr_b16 v[56:57], v8 offset:20480
  buffer_load_dword v31, v92, s[8:11], s65 offen
  v_mfma_f32_16x16x32_bf16 v[176:179], v[72:75], v[96:99], v[176:179]
  ds_read_b64_tr_b16 v[58:59], v8 offset:22528
  v_mfma_f32_16x16x32_bf16 v[176:179], v[76:79], v[112:115], v[176:179]
  ds_read_b64_tr_b16 v[60:61], v10 offset:4096
  v_mfma_f32_16x16x32_bf16 v[180:183], v[68:71], a[244:247], v[180:183]
  ds_read_b64_tr_b16 v[62:63], v10 offset:6144
  v_mfma_f32_16x16x32_bf16 v[180:183], v[72:75], v[100:103], v[180:183]
  ds_read_b64_tr_b16 v[64:65], v8 offset:24576
  v_mfma_f32_16x16x32_bf16 v[180:183], v[76:79], v[116:119], v[180:183]
  ds_read_b64_tr_b16 v[66:67], v8 offset:26624
  v_mfma_f32_16x16x32_bf16 v[184:187], v[68:71], a[248:251], v[184:187]
  v_mfma_f32_16x16x32_bf16 v[184:187], v[72:75], v[104:107], v[184:187]
  v_mfma_f32_16x16x32_bf16 v[184:187], v[76:79], v[120:123], v[184:187]
  v_mfma_f32_16x16x32_bf16 v[188:191], v[68:71], a[252:255], v[188:191]
  v_mfma_f32_16x16x32_bf16 v[188:191], v[72:75], v[108:111], v[188:191]
  v_mfma_f32_16x16x32_bf16 v[188:191], v[76:79], v[124:127], v[188:191]
  s_waitcnt lgkmcnt(0)
  v_mfma_f32_16x16x32_bf16 v[192:195], v[56:59], a[0:3], 0
  s_waitcnt vmcnt(8)
  s_barrier
  v_mfma_f32_16x16x32_bf16 v[192:195], v[60:63], a[16:19], v[192:195]
  ds_read_b64_tr_b16 v[68:69], v11 offset:20480
  v_mul_f32 v128, v128, v160
  v_mfma_f32_16x16x32_bf16 v[192:195], v[64:67], a[32:35], v[192:195]
  ds_read_b64_tr_b16 v[70:71], v11 offset:22528
  v_mul_f32 v129, v129, v161
  v_mfma_f32_16x16x32_bf16 v[196:199], v[56:59], a[4:7], 0
  ds_read_b64_tr_b16 v[72:73], v13 offset:4096
  v_mul_f32 v130, v130, v162
  v_mfma_f32_16x16x32_bf16 v[196:199], v[60:63], a[20:23], v[196:199]
  ds_read_b64_tr_b16 v[74:75], v13 offset:6144
  v_mul_f32 v131, v131, v163
  v_mfma_f32_16x16x32_bf16 v[196:199], v[64:67], a[36:39], v[196:199]
  ds_read_b64_tr_b16 v[76:77], v11 offset:24576
  v_cvt_pk_bf16_f32 v32, v128, v129
  v_mfma_f32_16x16x32_bf16 v[200:203], v[56:59], a[8:11], 0
  ds_read_b64_tr_b16 v[78:79], v11 offset:26624
  v_cvt_pk_bf16_f32 v33, v130, v131
  v_mfma_f32_16x16x32_bf16 v[200:203], v[60:63], a[24:27], v[200:203]
  s_add_u32 m0, s33, 77824
  v_mul_f32 v144, v144, v176
  v_mfma_f32_16x16x32_bf16 v[200:203], v[64:67], a[40:43], v[200:203]
  s_mov_b32 s34, 1769600
  v_mul_f32 v145, v145, v177
  v_mfma_f32_16x16x32_bf16 v[204:207], v[56:59], a[12:15], 0
  buffer_load_dwordx4 v19, s[8:11], s34 offen lds
  v_mul_f32 v146, v146, v178
  v_mfma_f32_16x16x32_bf16 v[204:207], v[60:63], a[28:31], v[204:207]
  s_add_u32 m0, s33, 0
  v_mul_f32 v147, v147, v179
  v_mfma_f32_16x16x32_bf16 v[204:207], v[64:67], a[44:47], v[204:207]
  s_mov_b32 s34, 2064512
  buffer_load_dwordx4 v19, s[8:11], s34 offen lds
  s_waitcnt lgkmcnt(0)
  v_mfma_f32_16x16x32_bf16 v[208:211], v[68:71], a[0:3], 0
  ds_read_b64_tr_b16 v[56:57], v8 offset:28672
  v_cvt_pk_bf16_f32 v34, v144, v145
  v_mfma_f32_16x16x32_bf16 v[208:211], v[72:75], a[16:19], v[208:211]
  ds_read_b64_tr_b16 v[58:59], v8 offset:30720
  v_cvt_pk_bf16_f32 v35, v146, v147
  v_mfma_f32_16x16x32_bf16 v[208:211], v[76:79], a[32:35], v[208:211]
  ds_read_b64_tr_b16 v[60:61], v8 offset:32768
  ds_write_b128 v17, v[32:35]
  v_mfma_f32_16x16x32_bf16 v[212:215], v[68:71], a[4:7], 0
  ds_read_b64_tr_b16 v[62:63], v8 offset:34816
  s_mov_b32 s61, 0
  v_mfma_f32_16x16x32_bf16 v[212:215], v[72:75], a[20:23], v[212:215]
  ds_read_b64_tr_b16 v[64:65], v8 offset:36864
  buffer_store_dwordx4 v[32:35], v80, s[28:31], s61 offen sc1
  v_mfma_f32_16x16x32_bf16 v[212:215], v[76:79], a[36:39], v[212:215]
  ds_read_b64_tr_b16 v[66:67], v8 offset:38912
  v_mul_f32 v132, v132, v164
  v_mfma_f32_16x16x32_bf16 v[216:219], v[68:71], a[8:11], 0
  s_add_u32 m0, s33, 4096
  v_mul_f32 v133, v133, v165
  v_mfma_f32_16x16x32_bf16 v[216:219], v[72:75], a[24:27], v[216:219]
  s_mov_b32 s34, 2359424
  v_mul_f32 v134, v134, v166
  v_mfma_f32_16x16x32_bf16 v[216:219], v[76:79], a[40:43], v[216:219]
  buffer_load_dwordx4 v19, s[8:11], s34 offen lds
  v_mul_f32 v135, v135, v167
  v_mfma_f32_16x16x32_bf16 v[220:223], v[68:71], a[12:15], 0
  s_add_u32 m0, s33, 81920
  v_cvt_pk_bf16_f32 v36, v132, v133
  v_mfma_f32_16x16x32_bf16 v[220:223], v[72:75], a[28:31], v[220:223]
  s_mov_b32 s34, 2654336
  v_cvt_pk_bf16_f32 v37, v134, v135
  v_mfma_f32_16x16x32_bf16 v[220:223], v[76:79], a[44:47], v[220:223]
  buffer_load_dwordx4 v19, s[4:7], s34 offen lds
  s_waitcnt lgkmcnt(0)
  v_mfma_f32_16x16x32_bf16 v[224:227], v[56:59], a[0:3], 0
  ds_read_b64_tr_b16 v[68:69], v11 offset:28672
  v_mul_f32 v148, v148, v180
  v_mfma_f32_16x16x32_bf16 v[224:227], v[60:63], a[16:19], v[224:227]
  ds_read_b64_tr_b16 v[70:71], v11 offset:30720
  v_mul_f32 v149, v149, v181
  v_mfma_f32_16x16x32_bf16 v[224:227], v[64:67], a[32:35], v[224:227]
  ds_read_b64_tr_b16 v[72:73], v11 offset:32768
  v_mul_f32 v150, v150, v182
  v_mfma_f32_16x16x32_bf16 v[228:231], v[56:59], a[4:7], 0
  ds_read_b64_tr_b16 v[74:75], v11 offset:34816
  v_mul_f32 v151, v151, v183
  v_mfma_f32_16x16x32_bf16 v[228:231], v[60:63], a[20:23], v[228:231]
  ds_read_b64_tr_b16 v[76:77], v11 offset:36864
  v_cvt_pk_bf16_f32 v38, v148, v149
  v_mfma_f32_16x16x32_bf16 v[228:231], v[64:67], a[36:39], v[228:231]
  ds_read_b64_tr_b16 v[78:79], v11 offset:38912
  v_cvt_pk_bf16_f32 v39, v150, v151
  v_mfma_f32_16x16x32_bf16 v[232:235], v[56:59], a[8:11], 0
  s_add_u32 m0, s33, 86016
  ds_write_b128 v17, v[36:39] offset:1024
  v_mfma_f32_16x16x32_bf16 v[232:235], v[60:63], a[24:27], v[232:235]
  s_mov_b32 s34, 2949248
  s_mov_b32 s61, 1024
  v_mfma_f32_16x16x32_bf16 v[232:235], v[64:67], a[40:43], v[232:235]
  buffer_load_dwordx4 v19, s[4:7], s34 offen lds
  buffer_store_dwordx4 v[36:39], v80, s[28:31], s61 offen sc1
  v_mfma_f32_16x16x32_bf16 v[236:239], v[56:59], a[12:15], 0
  s_add_u32 m0, s33, 139264
  v_mul_f32 v136, v136, v168
  v_mfma_f32_16x16x32_bf16 v[236:239], v[60:63], a[28:31], v[236:239]
  s_mov_b32 s34, 3244160
  v_mul_f32 v137, v137, v169
  v_mfma_f32_16x16x32_bf16 v[236:239], v[64:67], a[44:47], v[236:239]
  buffer_load_dwordx4 v19, s[4:7], s34 offen lds
  s_waitcnt lgkmcnt(1)
  v_mfma_f32_16x16x32_bf16 v[240:243], v[68:71], a[0:3], 0
  ds_read_b64_tr_b16 v[56:57], v8 offset:40960
  v_mul_f32 v138, v138, v170
  v_mfma_f32_16x16x32_bf16 v[240:243], v[72:75], a[16:19], v[240:243]
  ds_read_b64_tr_b16 v[58:59], v8 offset:43008
  v_mul_f32 v139, v139, v171
  v_mfma_f32_16x16x32_bf16 v[240:243], v[76:79], a[32:35], v[240:243]
  ds_read_b64_tr_b16 v[60:61], v8 offset:45056
  v_cvt_pk_bf16_f32 v32, v136, v137
  v_mfma_f32_16x16x32_bf16 v[244:247], v[68:71], a[4:7], 0
  ds_read_b64_tr_b16 v[62:63], v8 offset:47104
  v_cvt_pk_bf16_f32 v33, v138, v139
  v_mfma_f32_16x16x32_bf16 v[244:247], v[72:75], a[20:23], v[244:247]
  ds_read_b64_tr_b16 v[64:65], v8 offset:49152
  v_mul_f32 v152, v152, v184
  v_mfma_f32_16x16x32_bf16 v[244:247], v[76:79], a[36:39], v[244:247]
  ds_read_b64_tr_b16 v[66:67], v8 offset:51200
  v_mul_f32 v153, v153, v185
  v_mfma_f32_16x16x32_bf16 v[248:251], v[68:71], a[8:11], 0
  s_add_u32 m0, s33, 143360
  v_mul_f32 v154, v154, v186
  v_mfma_f32_16x16x32_bf16 v[248:251], v[72:75], a[24:27], v[248:251]
  s_mov_b32 s34, 2654336
  v_mul_f32 v155, v155, v187
  v_mfma_f32_16x16x32_bf16 v[248:251], v[76:79], a[40:43], v[248:251]
  buffer_load_dwordx4 v19, s[8:11], s34 offen lds
  v_cvt_pk_bf16_f32 v34, v152, v153
  v_mfma_f32_16x16x32_bf16 v[252:255], v[68:71], a[12:15], 0
  s_add_u32 m0, s33, 98304
  v_cvt_pk_bf16_f32 v35, v154, v155
  v_mfma_f32_16x16x32_bf16 v[252:255], v[72:75], a[28:31], v[252:255]
  s_mov_b32 s34, 2949248
  ds_write_b128 v17, v[32:35] offset:2048
  v_mfma_f32_16x16x32_bf16 v[252:255], v[76:79], a[44:47], v[252:255]
  buffer_load_dwordx4 v19, s[8:11], s34 offen lds
  s_waitcnt lgkmcnt(1)
  v_mfma_f32_16x16x32_bf16 v[192:195], v[56:59], a[48:51], v[192:195]
  s_waitcnt vmcnt(12)
  s_barrier
  v_mfma_f32_16x16x32_bf16 v[192:195], v[60:63], a[64:67], v[192:195]
  ds_read_b64_tr_b16 v[68:69], v11 offset:40960
  s_mov_b32 s61, 2048
  v_mfma_f32_16x16x32_bf16 v[192:195], v[64:67], a[80:83], v[192:195]
  ds_read_b64_tr_b16 v[70:71], v11 offset:43008
  buffer_store_dwordx4 v[32:35], v80, s[28:31], s61 offen sc1
  v_mfma_f32_16x16x32_bf16 v[196:199], v[56:59], a[52:55], v[196:199]
  ds_read_b64_tr_b16 v[72:73], v11 offset:45056
  v_mul_f32 v140, v140, v172
  v_mfma_f32_16x16x32_bf16 v[196:199], v[60:63], a[68:71], v[196:199]
  ds_read_b64_tr_b16 v[74:75], v11 offset:47104
  v_mul_f32 v141, v141, v173
  v_mfma_f32_16x16x32_bf16 v[196:199], v[64:67], a[84:87], v[196:199]
  ds_read_b64_tr_b16 v[76:77], v11 offset:49152
  v_mul_f32 v142, v142, v174
  v_mfma_f32_16x16x32_bf16 v[200:203], v[56:59], a[56:59], v[200:203]
  ds_read_b64_tr_b16 v[78:79], v11 offset:51200
  v_mul_f32 v143, v143, v175
  v_mfma_f32_16x16x32_bf16 v[200:203], v[60:63], a[72:75], v[200:203]
  s_add_u32 m0, s33, 147456
  v_cvt_pk_bf16_f32 v36, v140, v141
  v_mfma_f32_16x16x32_bf16 v[200:203], v[64:67], a[88:91], v[200:203]
  s_mov_b32 s34, 3244160
  v_cvt_pk_bf16_f32 v37, v142, v143
  v_mfma_f32_16x16x32_bf16 v[204:207], v[56:59], a[60:63], v[204:207]
  buffer_load_dwordx4 v19, s[8:11], s34 offen lds
  v_mul_f32 v156, v156, v188
  v_mfma_f32_16x16x32_bf16 v[204:207], v[60:63], a[76:79], v[204:207]
  s_add_u32 m0, s33, 151552
  v_mul_f32 v157, v157, v189
  v_mfma_f32_16x16x32_bf16 v[204:207], v[64:67], a[92:95], v[204:207]
  s_mov_b32 s34, 3539072
  buffer_load_dwordx4 v19, s[4:7], s34 offen lds
  s_waitcnt lgkmcnt(0)
  v_mfma_f32_16x16x32_bf16 v[208:211], v[68:71], a[48:51], v[208:211]
  ds_read_b64_tr_b16 v[56:57], v8 offset:53248
  v_mul_f32 v158, v158, v190
  v_mfma_f32_16x16x32_bf16 v[208:211], v[72:75], a[64:67], v[208:211]
  ds_read_b64_tr_b16 v[58:59], v8 offset:55296
  v_mul_f32 v159, v159, v191
  v_mfma_f32_16x16x32_bf16 v[208:211], v[76:79], a[80:83], v[208:211]
  ds_read_b64_tr_b16 v[60:61], v8 offset:57344
  v_cvt_pk_bf16_f32 v38, v156, v157
  v_mfma_f32_16x16x32_bf16 v[212:215], v[68:71], a[52:55], v[212:215]
  ds_read_b64_tr_b16 v[62:63], v8 offset:59392
  v_cvt_pk_bf16_f32 v39, v158, v159
  v_mfma_f32_16x16x32_bf16 v[212:215], v[72:75], a[68:71], v[212:215]
  ds_read_b64_tr_b16 v[64:65], v8 offset:61440
  ds_write_b128 v17, v[36:39] offset:3072
  v_mfma_f32_16x16x32_bf16 v[212:215], v[76:79], a[84:87], v[212:215]
  ds_read_b64_tr_b16 v[66:67], v8 offset:63488
  s_mov_b32 s61, 3072
  v_mfma_f32_16x16x32_bf16 v[216:219], v[68:71], a[56:59], v[216:219]
  s_add_u32 m0, s33, 102400
  buffer_store_dwordx4 v[36:39], v80, s[28:31], s61 offen sc1
  v_mfma_f32_16x16x32_bf16 v[216:219], v[72:75], a[72:75], v[216:219]
  s_mov_b32 s34, 3833984
  v_mfma_f32_16x16x32_bf16 v[216:219], v[76:79], a[88:91], v[216:219]
  buffer_load_dwordx4 v19, s[4:7], s34 offen lds
  v_mfma_f32_16x16x32_bf16 v[220:223], v[68:71], a[60:63], v[220:223]
  s_add_u32 m0, s33, 106496
  v_mfma_f32_16x16x32_bf16 v[220:223], v[72:75], a[76:79], v[220:223]
  s_mov_b32 s34, 4128896
  v_mfma_f32_16x16x32_bf16 v[220:223], v[76:79], a[92:95], v[220:223]
  buffer_load_dwordx4 v19, s[4:7], s34 offen lds
  s_waitcnt lgkmcnt(0)
  v_mfma_f32_16x16x32_bf16 v[224:227], v[56:59], a[48:51], v[224:227]
  ds_read_b64_tr_b16 v[68:69], v11 offset:53248
  v_mfma_f32_16x16x32_bf16 v[224:227], v[60:63], a[64:67], v[224:227]
  ds_read_b64_tr_b16 v[70:71], v11 offset:55296
  v_mfma_f32_16x16x32_bf16 v[224:227], v[64:67], a[80:83], v[224:227]
  ds_read_b64_tr_b16 v[72:73], v11 offset:57344
  v_mfma_f32_16x16x32_bf16 v[228:231], v[56:59], a[52:55], v[228:231]
  ds_read_b64_tr_b16 v[74:75], v11 offset:59392
  v_mfma_f32_16x16x32_bf16 v[228:231], v[60:63], a[68:71], v[228:231]
  ds_read_b64_tr_b16 v[76:77], v11 offset:61440
  v_mfma_f32_16x16x32_bf16 v[228:231], v[64:67], a[84:87], v[228:231]
  ds_read_b64_tr_b16 v[78:79], v11 offset:63488
  v_mfma_f32_16x16x32_bf16 v[232:235], v[56:59], a[56:59], v[232:235]
  s_add_u32 m0, s33, 110592
  v_mfma_f32_16x16x32_bf16 v[232:235], v[60:63], a[72:75], v[232:235]
  s_mov_b32 s34, 3539072
  v_mfma_f32_16x16x32_bf16 v[232:235], v[64:67], a[88:91], v[232:235]
  buffer_load_dwordx4 v19, s[8:11], s34 offen lds
  v_mfma_f32_16x16x32_bf16 v[236:239], v[56:59], a[60:63], v[236:239]
  s_add_u32 m0, s33, 155648
  v_mfma_f32_16x16x32_bf16 v[236:239], v[60:63], a[76:79], v[236:239]
  s_mov_b32 s34, 3833984
  v_mfma_f32_16x16x32_bf16 v[236:239], v[64:67], a[92:95], v[236:239]
  buffer_load_dwordx4 v19, s[8:11], s34 offen lds
  s_waitcnt lgkmcnt(0)
  v_mfma_f32_16x16x32_bf16 v[240:243], v[68:71], a[48:51], v[240:243]
  ds_read_b64_tr_b16 v[56:57], v9
  v_mfma_f32_16x16x32_bf16 v[240:243], v[72:75], a[64:67], v[240:243]
  ds_read_b64_tr_b16 v[58:59], v9 offset:2048
  v_mfma_f32_16x16x32_bf16 v[240:243], v[76:79], a[80:83], v[240:243]
  ds_read_b64_tr_b16 v[60:61], v9 offset:4096
  v_mfma_f32_16x16x32_bf16 v[244:247], v[68:71], a[52:55], v[244:247]
  ds_read_b64_tr_b16 v[62:63], v9 offset:6144
  v_mfma_f32_16x16x32_bf16 v[244:247], v[72:75], a[68:71], v[244:247]
  ds_read_b64_tr_b16 v[64:65], v9 offset:8192
  v_mfma_f32_16x16x32_bf16 v[244:247], v[76:79], a[84:87], v[244:247]
  ds_read_b64_tr_b16 v[66:67], v9 offset:10240
  v_mfma_f32_16x16x32_bf16 v[248:251], v[68:71], a[56:59], v[248:251]
  s_add_u32 m0, s33, 159744
  v_mfma_f32_16x16x32_bf16 v[248:251], v[72:75], a[72:75], v[248:251]
  s_mov_b32 s34, 4128896
  v_mfma_f32_16x16x32_bf16 v[248:251], v[76:79], a[88:91], v[248:251]
  buffer_load_dwordx4 v19, s[8:11], s34 offen lds
  v_mfma_f32_16x16x32_bf16 v[252:255], v[68:71], a[60:63], v[252:255]
  s_add_u32 m0, s33, 8192
  v_mfma_f32_16x16x32_bf16 v[252:255], v[72:75], a[76:79], v[252:255]
  s_mov_b32 s34, 4423808
  v_mfma_f32_16x16x32_bf16 v[252:255], v[76:79], a[92:95], v[252:255]
  buffer_load_dwordx4 v19, s[4:7], s34 offen lds
  s_waitcnt lgkmcnt(0)
  v_mfma_f32_16x16x32_bf16 v[192:195], v[56:59], a[96:99], v[192:195]
  s_waitcnt vmcnt(12)
  s_barrier
  v_mfma_f32_16x16x32_bf16 v[192:195], v[60:63], a[112:115], v[192:195]
  ds_read_b64_tr_b16 v[68:69], v12
  v_mfma_f32_16x16x32_bf16 v[192:195], v[64:67], a[128:131], v[192:195]
  ds_read_b64_tr_b16 v[70:71], v12 offset:2048
  v_mfma_f32_16x16x32_bf16 v[196:199], v[56:59], a[100:103], v[196:199]
  ds_read_b64_tr_b16 v[72:73], v12 offset:4096
  v_mfma_f32_16x16x32_bf16 v[196:199], v[60:63], a[116:119], v[196:199]
  ds_read_b64_tr_b16 v[74:75], v12 offset:6144
  v_mfma_f32_16x16x32_bf16 v[196:199], v[64:67], a[132:135], v[196:199]
  ds_read_b64_tr_b16 v[76:77], v12 offset:8192
  v_mfma_f32_16x16x32_bf16 v[200:203], v[56:59], a[104:107], v[200:203]
  ds_read_b64_tr_b16 v[78:79], v12 offset:10240
  v_mfma_f32_16x16x32_bf16 v[200:203], v[60:63], a[120:123], v[200:203]
  s_add_u32 m0, s33, 12288
  v_mfma_f32_16x16x32_bf16 v[200:203], v[64:67], a[136:139], v[200:203]
  s_mov_b32 s34, 4718720
  v_mfma_f32_16x16x32_bf16 v[204:207], v[56:59], a[108:111], v[204:207]
  buffer_load_dwordx4 v19, s[4:7], s34 offen lds
  v_mfma_f32_16x16x32_bf16 v[204:207], v[60:63], a[124:127], v[204:207]
  s_add_u32 m0, s33, 114688
  v_mfma_f32_16x16x32_bf16 v[204:207], v[64:67], a[140:143], v[204:207]
  s_mov_b32 s34, 5013632
  buffer_load_dwordx4 v19, s[4:7], s34 offen lds
  s_waitcnt lgkmcnt(0)
  v_mfma_f32_16x16x32_bf16 v[208:211], v[68:71], a[96:99], v[208:211]
  ds_read_b64_tr_b16 v[56:57], v9 offset:12288
  v_mfma_f32_16x16x32_bf16 v[208:211], v[72:75], a[112:115], v[208:211]
  ds_read_b64_tr_b16 v[58:59], v9 offset:14336
  v_mfma_f32_16x16x32_bf16 v[208:211], v[76:79], a[128:131], v[208:211]
  ds_read_b64_tr_b16 v[60:61], v8
  v_mfma_f32_16x16x32_bf16 v[212:215], v[68:71], a[100:103], v[212:215]
  ds_read_b64_tr_b16 v[62:63], v8 offset:2048
  v_mfma_f32_16x16x32_bf16 v[212:215], v[72:75], a[116:119], v[212:215]
  ds_read_b64_tr_b16 v[64:65], v8 offset:4096
  v_mfma_f32_16x16x32_bf16 v[212:215], v[76:79], a[132:135], v[212:215]
  ds_read_b64_tr_b16 v[66:67], v8 offset:6144
  v_mfma_f32_16x16x32_bf16 v[216:219], v[68:71], a[104:107], v[216:219]
  s_add_u32 m0, s33, 118784
  v_mfma_f32_16x16x32_bf16 v[216:219], v[72:75], a[120:123], v[216:219]
  s_mov_b32 s34, 4423808
  v_mfma_f32_16x16x32_bf16 v[216:219], v[76:79], a[136:139], v[216:219]
  buffer_load_dwordx4 v19, s[8:11], s34 offen lds
  v_mfma_f32_16x16x32_bf16 v[220:223], v[68:71], a[108:111], v[220:223]
  s_add_u32 m0, s33, 122880
  v_mfma_f32_16x16x32_bf16 v[220:223], v[72:75], a[124:127], v[220:223]
  s_mov_b32 s34, 4718720
  v_mfma_f32_16x16x32_bf16 v[220:223], v[76:79], a[140:143], v[220:223]
  buffer_load_dwordx4 v19, s[8:11], s34 offen lds
  s_waitcnt lgkmcnt(0)
  v_mfma_f32_16x16x32_bf16 v[224:227], v[56:59], a[96:99], v[224:227]
  ds_read_b64_tr_b16 v[68:69], v12 offset:12288
  v_mfma_f32_16x16x32_bf16 v[224:227], v[60:63], a[112:115], v[224:227]
  ds_read_b64_tr_b16 v[70:71], v12 offset:14336
  v_mfma_f32_16x16x32_bf16 v[224:227], v[64:67], a[128:131], v[224:227]
  ds_read_b64_tr_b16 v[72:73], v11
  v_mfma_f32_16x16x32_bf16 v[228:231], v[56:59], a[100:103], v[228:231]
  ds_read_b64_tr_b16 v[74:75], v11 offset:2048
  v_mfma_f32_16x16x32_bf16 v[228:231], v[60:63], a[116:119], v[228:231]
  ds_read_b64_tr_b16 v[76:77], v11 offset:4096
  v_mfma_f32_16x16x32_bf16 v[228:231], v[64:67], a[132:135], v[228:231]
  ds_read_b64_tr_b16 v[78:79], v11 offset:6144
  v_mfma_f32_16x16x32_bf16 v[232:235], v[56:59], a[104:107], v[232:235]
  s_add_u32 m0, s33, 16384
  v_mfma_f32_16x16x32_bf16 v[232:235], v[60:63], a[120:123], v[232:235]
  s_mov_b32 s34, 5013632
  v_mfma_f32_16x16x32_bf16 v[232:235], v[64:67], a[136:139], v[232:235]
  buffer_load_dwordx4 v19, s[8:11], s34 offen lds
  v_mfma_f32_16x16x32_bf16 v[236:239], v[56:59], a[108:111], v[236:239]
  s_add_u32 m0, s33, 20480
  v_mfma_f32_16x16x32_bf16 v[236:239], v[60:63], a[124:127], v[236:239]
  s_mov_b32 s34, 256
  v_mfma_f32_16x16x32_bf16 v[236:239], v[64:67], a[140:143], v[236:239]
  buffer_load_dwordx4 v19, s[4:7], s34 offen lds
  s_waitcnt lgkmcnt(0)
  v_mfma_f32_16x16x32_bf16 v[240:243], v[68:71], a[96:99], v[240:243]
  ds_read_b64_tr_b16 v[56:57], v9 offset:16384
  v_mfma_f32_16x16x32_bf16 v[240:243], v[72:75], a[112:115], v[240:243]
  ds_read_b64_tr_b16 v[58:59], v9 offset:18432
  v_mfma_f32_16x16x32_bf16 v[240:243], v[76:79], a[128:131], v[240:243]
  ds_read_b64_tr_b16 v[60:61], v9 offset:20480
  v_mfma_f32_16x16x32_bf16 v[244:247], v[68:71], a[100:103], v[244:247]
  ds_read_b64_tr_b16 v[62:63], v9 offset:22528
  v_mfma_f32_16x16x32_bf16 v[244:247], v[72:75], a[116:119], v[244:247]
  ds_read_b64_tr_b16 v[64:65], v10 offset:8192
  v_mfma_f32_16x16x32_bf16 v[244:247], v[76:79], a[132:135], v[244:247]
  ds_read_b64_tr_b16 v[66:67], v10 offset:10240
  v_mfma_f32_16x16x32_bf16 v[248:251], v[68:71], a[104:107], v[248:251]
  s_add_u32 m0, s33, 24576
  v_mfma_f32_16x16x32_bf16 v[248:251], v[72:75], a[120:123], v[248:251]
  s_mov_b32 s34, 295168
  v_mfma_f32_16x16x32_bf16 v[248:251], v[76:79], a[136:139], v[248:251]
  buffer_load_dwordx4 v19, s[4:7], s34 offen lds
  v_mfma_f32_16x16x32_bf16 v[252:255], v[68:71], a[108:111], v[252:255]
  s_add_u32 m0, s33, 28672
  v_mfma_f32_16x16x32_bf16 v[252:255], v[72:75], a[124:127], v[252:255]
  s_mov_b32 s34, 590080
  v_mfma_f32_16x16x32_bf16 v[252:255], v[76:79], a[140:143], v[252:255]
  buffer_load_dwordx4 v19, s[4:7], s34 offen lds
  s_waitcnt lgkmcnt(0)
  v_mfma_f32_16x16x32_bf16 v[192:195], v[56:59], a[144:147], v[192:195]
  s_waitcnt vmcnt(12)
  s_barrier
  v_mfma_f32_16x16x32_bf16 v[192:195], v[60:63], a[160:163], v[192:195]
  ds_read_b64_tr_b16 v[68:69], v12 offset:16384
  v_mfma_f32_16x16x32_bf16 v[192:195], v[64:67], a[176:179], v[192:195]
  ds_read_b64_tr_b16 v[70:71], v12 offset:18432
  v_mfma_f32_16x16x32_bf16 v[196:199], v[56:59], a[148:151], v[196:199]
  ds_read_b64_tr_b16 v[72:73], v12 offset:20480
  v_mfma_f32_16x16x32_bf16 v[196:199], v[60:63], a[164:167], v[196:199]
  ds_read_b64_tr_b16 v[74:75], v12 offset:22528
  v_mfma_f32_16x16x32_bf16 v[196:199], v[64:67], a[180:183], v[196:199]
  ds_read_b64_tr_b16 v[76:77], v13 offset:8192
  v_mfma_f32_16x16x32_bf16 v[200:203], v[56:59], a[152:155], v[200:203]
  ds_read_b64_tr_b16 v[78:79], v13 offset:10240
  v_mfma_f32_16x16x32_bf16 v[200:203], v[60:63], a[168:171], v[200:203]
  s_add_u32 m0, s33, 32768
  v_mfma_f32_16x16x32_bf16 v[200:203], v[64:67], a[184:187], v[200:203]
  s_mov_b32 s34, 256
  v_mfma_f32_16x16x32_bf16 v[204:207], v[56:59], a[156:159], v[204:207]
  buffer_load_dwordx4 v19, s[8:11], s34 offen lds
  v_mfma_f32_16x16x32_bf16 v[204:207], v[60:63], a[172:175], v[204:207]
  s_add_u32 m0, s33, 36864
  v_mfma_f32_16x16x32_bf16 v[204:207], v[64:67], a[188:191], v[204:207]
  s_mov_b32 s34, 295168
  buffer_load_dwordx4 v19, s[8:11], s34 offen lds
  s_waitcnt lgkmcnt(0)
  v_mfma_f32_16x16x32_bf16 v[208:211], v[68:71], a[144:147], v[208:211]
  ds_read_b64_tr_b16 v[56:57], v10 offset:12288
  v_mfma_f32_16x16x32_bf16 v[208:211], v[72:75], a[160:163], v[208:211]
  ds_read_b64_tr_b16 v[58:59], v10 offset:14336
  v_mfma_f32_16x16x32_bf16 v[208:211], v[76:79], a[176:179], v[208:211]
  ds_read_b64_tr_b16 v[60:61], v9 offset:32768
  v_mfma_f32_16x16x32_bf16 v[212:215], v[68:71], a[148:151], v[212:215]
  ds_read_b64_tr_b16 v[62:63], v9 offset:34816
  v_mfma_f32_16x16x32_bf16 v[212:215], v[72:75], a[164:167], v[212:215]
  ds_read_b64_tr_b16 v[64:65], v10 offset:16384
  v_mfma_f32_16x16x32_bf16 v[212:215], v[76:79], a[180:183], v[212:215]
  ds_read_b64_tr_b16 v[66:67], v10 offset:18432
  v_mfma_f32_16x16x32_bf16 v[216:219], v[68:71], a[152:155], v[216:219]
  s_add_u32 m0, s33, 40960
  v_mfma_f32_16x16x32_bf16 v[216:219], v[72:75], a[168:171], v[216:219]
  s_mov_b32 s34, 590080
  v_mfma_f32_16x16x32_bf16 v[216:219], v[76:79], a[184:187], v[216:219]
  buffer_load_dwordx4 v19, s[8:11], s34 offen lds
  v_mfma_f32_16x16x32_bf16 v[220:223], v[68:71], a[156:159], v[220:223]
  s_add_u32 m0, s33, 45056
  v_mfma_f32_16x16x32_bf16 v[220:223], v[72:75], a[172:175], v[220:223]
  s_mov_b32 s34, 884992
  v_mfma_f32_16x16x32_bf16 v[220:223], v[76:79], a[188:191], v[220:223]
  buffer_load_dwordx4 v19, s[4:7], s34 offen lds
  s_waitcnt lgkmcnt(0)
  v_mfma_f32_16x16x32_bf16 v[224:227], v[56:59], a[144:147], v[224:227]
  ds_read_b64_tr_b16 v[68:69], v13 offset:12288
  v_mfma_f32_16x16x32_bf16 v[224:227], v[60:63], a[160:163], v[224:227]
  ds_read_b64_tr_b16 v[70:71], v13 offset:14336
  v_mfma_f32_16x16x32_bf16 v[224:227], v[64:67], a[176:179], v[224:227]
  ds_read_b64_tr_b16 v[72:73], v12 offset:32768
  v_mfma_f32_16x16x32_bf16 v[228:231], v[56:59], a[148:151], v[228:231]
  ds_read_b64_tr_b16 v[74:75], v12 offset:34816
  v_mfma_f32_16x16x32_bf16 v[228:231], v[60:63], a[164:167], v[228:231]
  ds_read_b64_tr_b16 v[76:77], v13 offset:16384
  v_mfma_f32_16x16x32_bf16 v[228:231], v[64:67], a[180:183], v[228:231]
  ds_read_b64_tr_b16 v[78:79], v13 offset:18432
  v_mfma_f32_16x16x32_bf16 v[232:235], v[56:59], a[152:155], v[232:235]
  s_add_u32 m0, s33, 49152
  v_mfma_f32_16x16x32_bf16 v[232:235], v[60:63], a[168:171], v[232:235]
  s_mov_b32 s34, 1179904
  v_mfma_f32_16x16x32_bf16 v[232:235], v[64:67], a[184:187], v[232:235]
  buffer_load_dwordx4 v19, s[4:7], s34 offen lds
  v_mfma_f32_16x16x32_bf16 v[236:239], v[56:59], a[156:159], v[236:239]
  s_add_u32 m0, s33, 53248
  v_mfma_f32_16x16x32_bf16 v[236:239], v[60:63], a[172:175], v[236:239]
  s_mov_b32 s34, 1474816
  v_mfma_f32_16x16x32_bf16 v[236:239], v[64:67], a[188:191], v[236:239]
  buffer_load_dwordx4 v19, s[4:7], s34 offen lds
  s_waitcnt lgkmcnt(0)
  v_mfma_f32_16x16x32_bf16 v[240:243], v[68:71], a[144:147], v[240:243]
  ds_read_b64_tr_b16 v[56:57], v10 offset:20480
  v_mfma_f32_16x16x32_bf16 v[240:243], v[72:75], a[160:163], v[240:243]
  ds_read_b64_tr_b16 v[58:59], v10 offset:22528
  v_mfma_f32_16x16x32_bf16 v[240:243], v[76:79], a[176:179], v[240:243]
  ds_read_b64_tr_b16 v[60:61], v9 offset:36864
  v_mfma_f32_16x16x32_bf16 v[244:247], v[68:71], a[148:151], v[244:247]
  ds_read_b64_tr_b16 v[62:63], v9 offset:38912
  v_mfma_f32_16x16x32_bf16 v[244:247], v[72:75], a[164:167], v[244:247]
  ds_read_b64_tr_b16 v[64:65], v9 offset:40960
  v_mfma_f32_16x16x32_bf16 v[244:247], v[76:79], a[180:183], v[244:247]
  ds_read_b64_tr_b16 v[66:67], v9 offset:43008
  v_mfma_f32_16x16x32_bf16 v[248:251], v[68:71], a[152:155], v[248:251]
  s_add_u32 m0, s33, 57344
  v_mfma_f32_16x16x32_bf16 v[248:251], v[72:75], a[168:171], v[248:251]
  s_mov_b32 s34, 884992
  v_mfma_f32_16x16x32_bf16 v[248:251], v[76:79], a[184:187], v[248:251]
  buffer_load_dwordx4 v19, s[8:11], s34 offen lds
  v_mfma_f32_16x16x32_bf16 v[252:255], v[68:71], a[156:159], v[252:255]
  s_add_u32 m0, s33, 61440
  v_mfma_f32_16x16x32_bf16 v[252:255], v[72:75], a[172:175], v[252:255]
  s_mov_b32 s34, 1179904
  v_mfma_f32_16x16x32_bf16 v[252:255], v[76:79], a[188:191], v[252:255]
  buffer_load_dwordx4 v19, s[8:11], s34 offen lds
  s_waitcnt lgkmcnt(0)
  v_mfma_f32_16x16x32_bf16 v[192:195], v[56:59], a[192:195], v[192:195]
  s_waitcnt vmcnt(14)
  s_barrier
  v_mfma_f32_16x16x32_bf16 v[192:195], v[60:63], a[208:211], v[192:195]
  ds_read_b64_tr_b16 v[68:69], v13 offset:20480
  s_and_b32 s65, s94, 1
  v_mfma_f32_16x16x32_bf16 v[192:195], v[64:67], a[224:227], v[192:195]
  ds_read_b64_tr_b16 v[70:71], v13 offset:22528
  s_add_u32 s65, s65, 3
  v_mfma_f32_16x16x32_bf16 v[196:199], v[56:59], a[196:199], v[196:199]
  ds_read_b64_tr_b16 v[72:73], v12 offset:36864
  s_cmp_eq_u32 s65, 5
  s_cselect_b32 s65, 0, s65
  v_mfma_f32_16x16x32_bf16 v[196:199], v[60:63], a[212:215], v[196:199]
  ds_read_b64_tr_b16 v[74:75], v12 offset:38912
  s_lshl_b32 s65, s65, 7
  v_mfma_f32_16x16x32_bf16 v[196:199], v[64:67], a[228:231], v[196:199]
  ds_read_b64_tr_b16 v[76:77], v12 offset:40960
  buffer_load_dword v31, v92, s[4:7], s65 offen
  v_mfma_f32_16x16x32_bf16 v[200:203], v[56:59], a[200:203], v[200:203]
  ds_read_b64_tr_b16 v[78:79], v12 offset:43008
  buffer_load_dword v31, v92, s[8:11], s65 offen
  v_mfma_f32_16x16x32_bf16 v[200:203], v[60:63], a[216:219], v[200:203]
  s_add_u32 m0, s33, 65536
  v_mfma_f32_16x16x32_bf16 v[200:203], v[64:67], a[232:235], v[200:203]
  s_mov_b32 s34, 1474816
  v_mfma_f32_16x16x32_bf16 v[204:207], v[56:59], a[204:207], v[204:207]
  buffer_load_dwordx4 v19, s[8:11], s34 offen lds
  v_mfma_f32_16x16x32_bf16 v[204:207], v[60:63], a[220:223], v[204:207]
  s_add_u32 m0, s33, 69632
  v_mfma_f32_16x16x32_bf16 v[204:207], v[64:67], a[236:239], v[204:207]
  s_mov_b32 s34, 1769728
  buffer_load_dwordx4 v19, s[4:7], s34 offen lds
  s_waitcnt lgkmcnt(0)
  v_mfma_f32_16x16x32_bf16 v[208:211], v[68:71], a[192:195], v[208:211]
  ds_read_b64_tr_b16 v[56:57], v9 offset:45056
  v_mfma_f32_16x16x32_bf16 v[208:211], v[72:75], a[208:211], v[208:211]
  ds_read_b64_tr_b16 v[58:59], v9 offset:47104
  v_mfma_f32_16x16x32_bf16 v[208:211], v[76:79], a[224:227], v[208:211]
  ds_read_b64_tr_b16 v[60:61], v10 offset:24576
  v_mfma_f32_16x16x32_bf16 v[212:215], v[68:71], a[196:199], v[212:215]
  ds_read_b64_tr_b16 v[62:63], v10 offset:26624
  v_mfma_f32_16x16x32_bf16 v[212:215], v[72:75], a[212:215], v[212:215]
  ds_read_b64_tr_b16 v[64:65], v10 offset:28672
  v_mfma_f32_16x16x32_bf16 v[212:215], v[76:79], a[228:231], v[212:215]
  ds_read_b64_tr_b16 v[66:67], v10 offset:30720
  v_mfma_f32_16x16x32_bf16 v[216:219], v[68:71], a[200:203], v[216:219]
  s_add_u32 m0, s33, 73728
  v_mfma_f32_16x16x32_bf16 v[216:219], v[72:75], a[216:219], v[216:219]
  s_mov_b32 s34, 2064640
  v_mfma_f32_16x16x32_bf16 v[216:219], v[76:79], a[232:235], v[216:219]
  buffer_load_dwordx4 v19, s[4:7], s34 offen lds
  v_mfma_f32_16x16x32_bf16 v[220:223], v[68:71], a[204:207], v[220:223]
  s_add_u32 m0, s33, 77824
  v_mfma_f32_16x16x32_bf16 v[220:223], v[72:75], a[220:223], v[220:223]
  s_mov_b32 s34, 2359552
  v_mfma_f32_16x16x32_bf16 v[220:223], v[76:79], a[236:239], v[220:223]
  buffer_load_dwordx4 v19, s[4:7], s34 offen lds
  s_waitcnt lgkmcnt(0)
  v_mfma_f32_16x16x32_bf16 v[224:227], v[56:59], a[192:195], v[224:227]
  ds_read_b64_tr_b16 v[68:69], v12 offset:45056
  v_mfma_f32_16x16x32_bf16 v[224:227], v[60:63], a[208:211], v[224:227]
  ds_read_b64_tr_b16 v[70:71], v12 offset:47104
  v_mfma_f32_16x16x32_bf16 v[224:227], v[64:67], a[224:227], v[224:227]
  ds_read_b64_tr_b16 v[72:73], v13 offset:24576
  v_mfma_f32_16x16x32_bf16 v[228:231], v[56:59], a[196:199], v[228:231]
  ds_read_b64_tr_b16 v[74:75], v13 offset:26624
  v_mfma_f32_16x16x32_bf16 v[228:231], v[60:63], a[212:215], v[228:231]
  ds_read_b64_tr_b16 v[76:77], v13 offset:28672
  v_mfma_f32_16x16x32_bf16 v[228:231], v[64:67], a[228:231], v[228:231]
  ds_read_b64_tr_b16 v[78:79], v13 offset:30720
  v_mfma_f32_16x16x32_bf16 v[232:235], v[56:59], a[200:203], v[232:235]
  s_add_u32 m0, s33, 0
  v_mfma_f32_16x16x32_bf16 v[232:235], v[60:63], a[216:219], v[232:235]
  s_mov_b32 s34, 1769728
  v_mfma_f32_16x16x32_bf16 v[232:235], v[64:67], a[232:235], v[232:235]
  buffer_load_dwordx4 v19, s[8:11], s34 offen lds
  v_mfma_f32_16x16x32_bf16 v[236:239], v[56:59], a[204:207], v[236:239]
  s_add_u32 m0, s33, 4096
  v_mfma_f32_16x16x32_bf16 v[236:239], v[60:63], a[220:223], v[236:239]
  s_mov_b32 s34, 2064640
  v_mfma_f32_16x16x32_bf16 v[236:239], v[64:67], a[236:239], v[236:239]
  buffer_load_dwordx4 v19, s[8:11], s34 offen lds
  s_waitcnt lgkmcnt(0)
  v_mfma_f32_16x16x32_bf16 v[240:243], v[68:71], a[192:195], v[240:243]
  ds_read_b64_tr_b16 v[56:57], v8 offset:8192
  v_mfma_f32_16x16x32_bf16 v[240:243], v[72:75], a[208:211], v[240:243]
  ds_read_b64_tr_b16 v[58:59], v8 offset:10240
  v_mfma_f32_16x16x32_bf16 v[240:243], v[76:79], a[224:227], v[240:243]
  ds_read_b64_tr_b16 v[60:61], v8 offset:12288
  v_mfma_f32_16x16x32_bf16 v[244:247], v[68:71], a[196:199], v[244:247]
  ds_read_b64_tr_b16 v[62:63], v8 offset:14336
  v_mfma_f32_16x16x32_bf16 v[244:247], v[72:75], a[212:215], v[244:247]
  ds_read_b64_tr_b16 v[64:65], v9 offset:49152
  v_mfma_f32_16x16x32_bf16 v[244:247], v[76:79], a[228:231], v[244:247]
  ds_read_b64_tr_b16 v[66:67], v9 offset:51200
  v_mfma_f32_16x16x32_bf16 v[248:251], v[68:71], a[200:203], v[248:251]
  s_add_u32 m0, s33, 81920
  v_mfma_f32_16x16x32_bf16 v[248:251], v[72:75], a[216:219], v[248:251]
  s_mov_b32 s34, 2359552
  v_mfma_f32_16x16x32_bf16 v[248:251], v[76:79], a[232:235], v[248:251]
  buffer_load_dwordx4 v19, s[8:11], s34 offen lds
  v_mfma_f32_16x16x32_bf16 v[252:255], v[68:71], a[204:207], v[252:255]
  v_mfma_f32_16x16x32_bf16 v[252:255], v[72:75], a[220:223], v[252:255]
  v_mfma_f32_16x16x32_bf16 v[252:255], v[76:79], a[236:239], v[252:255]
  s_waitcnt lgkmcnt(0)
  v_mfma_f32_16x16x32_bf16 v[192:195], v[56:59], a[240:243], v[192:195]
  s_waitcnt vmcnt(17)
  s_barrier
  v_mfma_f32_16x16x32_bf16 v[192:195], v[60:63], v[96:99], v[192:195]
  ds_read_b64_tr_b16 v[68:69], v11 offset:8192
  v_mfma_f32_16x16x32_bf16 v[192:195], v[64:67], v[112:115], v[192:195]
  ds_read_b64_tr_b16 v[70:71], v11 offset:10240
  v_mfma_f32_16x16x32_bf16 v[196:199], v[56:59], a[244:247], v[196:199]
  ds_read_b64_tr_b16 v[72:73], v11 offset:12288
  v_mfma_f32_16x16x32_bf16 v[196:199], v[60:63], v[100:103], v[196:199]
  ds_read_b64_tr_b16 v[74:75], v11 offset:14336
  v_mfma_f32_16x16x32_bf16 v[196:199], v[64:67], v[116:119], v[196:199]
  ds_read_b64_tr_b16 v[76:77], v12 offset:49152
  v_mfma_f32_16x16x32_bf16 v[200:203], v[56:59], a[248:251], v[200:203]
  ds_read_b64_tr_b16 v[78:79], v12 offset:51200
  v_mfma_f32_16x16x32_bf16 v[200:203], v[60:63], v[104:107], v[200:203]
  s_add_u32 m0, s33, 86016
  v_mfma_f32_16x16x32_bf16 v[200:203], v[64:67], v[120:123], v[200:203]
  s_mov_b32 s34, 2654464
  v_mfma_f32_16x16x32_bf16 v[204:207], v[56:59], a[252:255], v[204:207]
  buffer_load_dwordx4 v19, s[4:7], s34 offen lds
  v_mfma_f32_16x16x32_bf16 v[204:207], v[60:63], v[108:111], v[204:207]
  s_add_u32 m0, s33, 143360
  v_mfma_f32_16x16x32_bf16 v[204:207], v[64:67], v[124:127], v[204:207]
  s_mov_b32 s34, 2949376
  buffer_load_dwordx4 v19, s[4:7], s34 offen lds
  s_waitcnt lgkmcnt(0)
  v_mfma_f32_16x16x32_bf16 v[208:211], v[68:71], a[240:243], v[208:211]
  ds_read_b64_tr_b16 v[56:57], v9 offset:53248
  v_mfma_f32_16x16x32_bf16 v[208:211], v[72:75], v[96:99], v[208:211]
  ds_read_b64_tr_b16 v[58:59], v9 offset:55296
  v_mfma_f32_16x16x32_bf16 v[208:211], v[76:79], v[112:115], v[208:211]
  ds_read_b64_tr_b16 v[60:61], v9 offset:57344
  v_mfma_f32_16x16x32_bf16 v[212:215], v[68:71], a[244:247], v[212:215]
  ds_read_b64_tr_b16 v[62:63], v9 offset:59392
  v_mfma_f32_16x16x32_bf16 v[212:215], v[72:75], v[100:103], v[212:215]
  ds_read_b64_tr_b16 v[64:65], v8 offset:16384
  v_mfma_f32_16x16x32_bf16 v[212:215], v[76:79], v[116:119], v[212:215]
  ds_read_b64_tr_b16 v[66:67], v8 offset:18432
  v_mfma_f32_16x16x32_bf16 v[216:219], v[68:71], a[248:251], v[216:219]
  s_add_u32 m0, s33, 147456
  v_mfma_f32_16x16x32_bf16 v[216:219], v[72:75], v[104:107], v[216:219]
  s_mov_b32 s34, 3244288
  v_mfma_f32_16x16x32_bf16 v[216:219], v[76:79], v[120:123], v[216:219]
  buffer_load_dwordx4 v19, s[4:7], s34 offen lds
  v_mfma_f32_16x16x32_bf16 v[220:223], v[68:71], a[252:255], v[220:223]
  v_mfma_f32_16x16x32_bf16 v[220:223], v[72:75], v[108:111], v[220:223]
  v_mfma_f32_16x16x32_bf16 v[220:223], v[76:79], v[124:127], v[220:223]
  s_waitcnt lgkmcnt(0)
  v_mfma_f32_16x16x32_bf16 v[224:227], v[56:59], a[240:243], v[224:227]
  ds_read_b64_tr_b16 v[68:69], v12 offset:53248
  v_mfma_f32_16x16x32_bf16 v[224:227], v[60:63], v[96:99], v[224:227]
  ds_read_b64_tr_b16 v[70:71], v12 offset:55296
  v_mfma_f32_16x16x32_bf16 v[224:227], v[64:67], v[112:115], v[224:227]
  ds_read_b64_tr_b16 v[72:73], v12 offset:57344
  v_mfma_f32_16x16x32_bf16 v[228:231], v[56:59], a[244:247], v[228:231]
  ds_read_b64_tr_b16 v[74:75], v12 offset:59392
  v_mfma_f32_16x16x32_bf16 v[228:231], v[60:63], v[100:103], v[228:231]
  ds_read_b64_tr_b16 v[76:77], v11 offset:16384
  v_mfma_f32_16x16x32_bf16 v[228:231], v[64:67], v[116:119], v[228:231]
  ds_read_b64_tr_b16 v[78:79], v11 offset:18432
  v_mfma_f32_16x16x32_bf16 v[232:235], v[56:59], a[248:251], v[232:235]
  s_add_u32 m0, s33, 151552
  v_mfma_f32_16x16x32_bf16 v[232:235], v[60:63], v[104:107], v[232:235]
  s_mov_b32 s34, 2654464
  v_mfma_f32_16x16x32_bf16 v[232:235], v[64:67], v[120:123], v[232:235]
  buffer_load_dwordx4 v19, s[8:11], s34 offen lds
  v_mfma_f32_16x16x32_bf16 v[236:239], v[56:59], a[252:255], v[236:239]
  s_add_u32 m0, s33, 106496
  v_mfma_f32_16x16x32_bf16 v[236:239], v[60:63], v[108:111], v[236:239]
  s_mov_b32 s34, 2949376
  v_mfma_f32_16x16x32_bf16 v[236:239], v[64:67], v[124:127], v[236:239]
  buffer_load_dwordx4 v19, s[8:11], s34 offen lds
  s_waitcnt lgkmcnt(0)
  v_mfma_f32_16x16x32_bf16 v[240:243], v[68:71], a[240:243], v[240:243]
  ds_read_b64_tr_b16 v[56:57], v8 offset:20480
  v_mfma_f32_16x16x32_bf16 v[240:243], v[72:75], v[96:99], v[240:243]
  ds_read_b64_tr_b16 v[58:59], v8 offset:22528
  v_mfma_f32_16x16x32_bf16 v[240:243], v[76:79], v[112:115], v[240:243]
  ds_read_b64_tr_b16 v[60:61], v8 offset:24576
  v_mfma_f32_16x16x32_bf16 v[244:247], v[68:71], a[244:247], v[244:247]
  ds_read_b64_tr_b16 v[62:63], v8 offset:26624
  v_mfma_f32_16x16x32_bf16 v[244:247], v[72:75], v[100:103], v[244:247]
  ds_read_b64_tr_b16 v[64:65], v8 offset:28672
  v_mfma_f32_16x16x32_bf16 v[244:247], v[76:79], v[116:119], v[244:247]
  ds_read_b64_tr_b16 v[66:67], v8 offset:30720
  v_mfma_f32_16x16x32_bf16 v[248:251], v[68:71], a[248:251], v[248:251]
  s_add_u32 m0, s33, 110592
  v_mfma_f32_16x16x32_bf16 v[248:251], v[72:75], v[104:107], v[248:251]
  s_mov_b32 s34, 3244288
  v_mfma_f32_16x16x32_bf16 v[248:251], v[76:79], v[120:123], v[248:251]
  buffer_load_dwordx4 v19, s[8:11], s34 offen lds
  v_mfma_f32_16x16x32_bf16 v[252:255], v[68:71], a[252:255], v[252:255]
  v_mfma_f32_16x16x32_bf16 v[252:255], v[72:75], v[108:111], v[252:255]
  v_mfma_f32_16x16x32_bf16 v[252:255], v[76:79], v[124:127], v[252:255]
  s_waitcnt lgkmcnt(0)
  v_mfma_f32_16x16x32_bf16 v[128:131], v[56:59], a[0:3], 0
  s_waitcnt vmcnt(17)
  s_barrier
  v_mfma_f32_16x16x32_bf16 v[128:131], v[60:63], a[16:19], v[128:131]
  ds_read_b64_tr_b16 v[68:69], v11 offset:20480
  v_mul_f32 v192, v192, v224
  v_mfma_f32_16x16x32_bf16 v[128:131], v[64:67], a[32:35], v[128:131]
  ds_read_b64_tr_b16 v[70:71], v11 offset:22528
  v_mul_f32 v193, v193, v225
  v_mfma_f32_16x16x32_bf16 v[132:135], v[56:59], a[4:7], 0
  ds_read_b64_tr_b16 v[72:73], v11 offset:24576
  v_mul_f32 v194, v194, v226
  v_mfma_f32_16x16x32_bf16 v[132:135], v[60:63], a[20:23], v[132:135]
  ds_read_b64_tr_b16 v[74:75], v11 offset:26624
  v_mul_f32 v195, v195, v227
  v_mfma_f32_16x16x32_bf16 v[132:135], v[64:67], a[36:39], v[132:135]
  ds_read_b64_tr_b16 v[76:77], v11 offset:28672
  v_cvt_pk_bf16_f32 v32, v192, v193
  v_mfma_f32_16x16x32_bf16 v[136:139], v[56:59], a[8:11], 0
  ds_read_b64_tr_b16 v[78:79], v11 offset:30720
  v_cvt_pk_bf16_f32 v33, v194, v195
  v_mfma_f32_16x16x32_bf16 v[136:139], v[60:63], a[24:27], v[136:139]
  s_add_u32 m0, s33, 155648
  v_mul_f32 v208, v208, v240
  v_mfma_f32_16x16x32_bf16 v[136:139], v[64:67], a[40:43], v[136:139]
  s_mov_b32 s34, 3539200
  v_mul_f32 v209, v209, v241
  v_mfma_f32_16x16x32_bf16 v[140:143], v[56:59], a[12:15], 0
  buffer_load_dwordx4 v19, s[4:7], s34 offen lds
  v_mul_f32 v210, v210, v242
  v_mfma_f32_16x16x32_bf16 v[140:143], v[60:63], a[28:31], v[140:143]
  s_add_u32 m0, s33, 159744
  v_mul_f32 v211, v211, v243
  v_mfma_f32_16x16x32_bf16 v[140:143], v[64:67], a[44:47], v[140:143]
  s_mov_b32 s34, 3834112
  buffer_load_dwordx4 v19, s[4:7], s34 offen lds
  s_waitcnt lgkmcnt(0)
  v_mfma_f32_16x16x32_bf16 v[144:147], v[68:71], a[0:3], 0
  ds_read_b64_tr_b16 v[56:57], v8 offset:32768
  v_cvt_pk_bf16_f32 v34, v208, v209
  v_mfma_f32_16x16x32_bf16 v[144:147], v[72:75], a[16:19], v[144:147]
  ds_read_b64_tr_b16 v[58:59], v8 offset:34816
  v_cvt_pk_bf16_f32 v35, v210, v211
  v_mfma_f32_16x16x32_bf16 v[144:147], v[76:79], a[32:35], v[144:147]
  ds_read_b64_tr_b16 v[60:61], v8 offset:36864
  ds_write_b128 v17, v[32:35] offset:8192
  v_mfma_f32_16x16x32_bf16 v[148:151], v[68:71], a[4:7], 0
  ds_read_b64_tr_b16 v[62:63], v8 offset:38912
  s_mov_b32 s61, 8192
  v_mfma_f32_16x16x32_bf16 v[148:151], v[72:75], a[20:23], v[148:151]
  ds_read_b64_tr_b16 v[64:65], v8 offset:40960
  buffer_store_dwordx4 v[32:35], v80, s[28:31], s61 offen sc1
  v_mfma_f32_16x16x32_bf16 v[148:151], v[76:79], a[36:39], v[148:151]
  ds_read_b64_tr_b16 v[66:67], v8 offset:43008
  v_mul_f32 v196, v196, v228
  v_mfma_f32_16x16x32_bf16 v[152:155], v[68:71], a[8:11], 0
  s_add_u32 m0, s33, 8192
  v_mul_f32 v197, v197, v229
  v_mfma_f32_16x16x32_bf16 v[152:155], v[72:75], a[24:27], v[152:155]
  s_mov_b32 s34, 4129024
  v_mul_f32 v198, v198, v230
  v_mfma_f32_16x16x32_bf16 v[152:155], v[76:79], a[40:43], v[152:155]
  buffer_load_dwordx4 v19, s[4:7], s34 offen lds
  v_mul_f32 v199, v199, v231
  v_mfma_f32_16x16x32_bf16 v[156:159], v[68:71], a[12:15], 0
  v_cvt_pk_bf16_f32 v36, v196, v197
  v_mfma_f32_16x16x32_bf16 v[156:159], v[72:75], a[28:31], v[156:159]
  v_cvt_pk_bf16_f32 v37, v198, v199
  v_mfma_f32_16x16x32_bf16 v[156:159], v[76:79], a[44:47], v[156:159]
  v_mul_f32 v212, v212, v244
  s_waitcnt lgkmcnt(0)
  v_mfma_f32_16x16x32_bf16 v[160:163], v[56:59], a[0:3], 0
  ds_read_b64_tr_b16 v[68:69], v11 offset:32768
  v_mul_f32 v213, v213, v245
  v_mfma_f32_16x16x32_bf16 v[160:163], v[60:63], a[16:19], v[160:163]
  ds_read_b64_tr_b16 v[70:71], v11 offset:34816
  v_mul_f32 v214, v214, v246
  v_mfma_f32_16x16x32_bf16 v[160:163], v[64:67], a[32:35], v[160:163]
  ds_read_b64_tr_b16 v[72:73], v11 offset:36864
  v_mul_f32 v215, v215, v247
  v_mfma_f32_16x16x32_bf16 v[164:167], v[56:59], a[4:7], 0
  ds_read_b64_tr_b16 v[74:75], v11 offset:38912
  v_cvt_pk_bf16_f32 v38, v212, v213
  v_mfma_f32_16x16x32_bf16 v[164:167], v[60:63], a[20:23], v[164:167]
  ds_read_b64_tr_b16 v[76:77], v11 offset:40960
  v_cvt_pk_bf16_f32 v39, v214, v215
  v_mfma_f32_16x16x32_bf16 v[164:167], v[64:67], a[36:39], v[164:167]
  ds_read_b64_tr_b16 v[78:79], v11 offset:43008
  ds_write_b128 v17, v[36:39] offset:9216
  v_mfma_f32_16x16x32_bf16 v[168:171], v[56:59], a[8:11], 0
  s_add_u32 m0, s33, 12288
  s_mov_b32 s61, 9216
  v_mfma_f32_16x16x32_bf16 v[168:171], v[60:63], a[24:27], v[168:171]
  s_mov_b32 s34, 3539200
  buffer_store_dwordx4 v[36:39], v80, s[28:31], s61 offen sc1
  v_mfma_f32_16x16x32_bf16 v[168:171], v[64:67], a[40:43], v[168:171]
  buffer_load_dwordx4 v19, s[8:11], s34 offen lds
  v_mul_f32 v200, v200, v232
  v_mfma_f32_16x16x32_bf16 v[172:175], v[56:59], a[12:15], 0
  s_add_u32 m0, s33, 114688
  v_mul_f32 v201, v201, v233
  v_mfma_f32_16x16x32_bf16 v[172:175], v[60:63], a[28:31], v[172:175]
  s_mov_b32 s34, 3834112
  v_mul_f32 v202, v202, v234
  v_mfma_f32_16x16x32_bf16 v[172:175], v[64:67], a[44:47], v[172:175]
  buffer_load_dwordx4 v19, s[8:11], s34 offen lds
  s_waitcnt lgkmcnt(1)
  v_mfma_f32_16x16x32_bf16 v[176:179], v[68:71], a[0:3], 0
  ds_read_b64_tr_b16 v[56:57], v8 offset:45056
  v_mul_f32 v203, v203, v235
  v_mfma_f32_16x16x32_bf16 v[176:179], v[72:75], a[16:19], v[176:179]
  ds_read_b64_tr_b16 v[58:59], v8 offset:47104
  v_cvt_pk_bf16_f32 v32, v200, v201
  v_mfma_f32_16x16x32_bf16 v[176:179], v[76:79], a[32:35], v[176:179]
  ds_read_b64_tr_b16 v[60:61], v8 offset:49152
  v_cvt_pk_bf16_f32 v33, v202, v203
  v_mfma_f32_16x16x32_bf16 v[180:183], v[68:71], a[4:7], 0
  ds_read_b64_tr_b16 v[62:63], v8 offset:51200
  v_mul_f32 v216, v216, v248
  v_mfma_f32_16x16x32_bf16 v[180:183], v[72:75], a[20:23], v[180:183]
  ds_read_b64_tr_b16 v[64:65], v8 offset:53248
  v_mul_f32 v217, v217, v249
  v_mfma_f32_16x16x32_bf16 v[180:183], v[76:79], a[36:39], v[180:183]
  ds_read_b64_tr_b16 v[66:67], v8 offset:55296
  v_mul_f32 v218, v218, v250
  v_mfma_f32_16x16x32_bf16 v[184:187], v[68:71], a[8:11], 0
  s_add_u32 m0, s33, 118784
  v_mul_f32 v219, v219, v251
  v_mfma_f32_16x16x32_bf16 v[184:187], v[72:75], a[24:27], v[184:187]
  s_mov_b32 s34, 4129024
  v_cvt_pk_bf16_f32 v34, v216, v217
  v_mfma_f32_16x16x32_bf16 v[184:187], v[76:79], a[40:43], v[184:187]
  buffer_load_dwordx4 v19, s[8:11], s34 offen lds
  v_cvt_pk_bf16_f32 v35, v218, v219
  v_mfma_f32_16x16x32_bf16 v[188:191], v[68:71], a[12:15], 0
  ds_write_b128 v17, v[32:35] offset:10240
  v_mfma_f32_16x16x32_bf16 v[188:191], v[72:75], a[28:31], v[188:191]
  s_mov_b32 s61, 10240
  v_mfma_f32_16x16x32_bf16 v[188:191], v[76:79], a[44:47], v[188:191]
  buffer_store_dwordx4 v[32:35], v80, s[28:31], s61 offen sc1
  s_waitcnt lgkmcnt(1)
  v_mfma_f32_16x16x32_bf16 v[128:131], v[56:59], a[48:51], v[128:131]
  s_waitcnt vmcnt(18)
  s_barrier
  v_mfma_f32_16x16x32_bf16 v[128:131], v[60:63], a[64:67], v[128:131]
  ds_read_b64_tr_b16 v[68:69], v11 offset:45056
  s_and_b32 s65, s94, 1
  v_mfma_f32_16x16x32_bf16 v[128:131], v[64:67], a[80:83], v[128:131]
  ds_read_b64_tr_b16 v[70:71], v11 offset:47104
  s_add_u32 s65, s65, 4
  v_mfma_f32_16x16x32_bf16 v[132:135], v[56:59], a[52:55], v[132:135]
  ds_read_b64_tr_b16 v[72:73], v11 offset:49152
  s_cmp_eq_u32 s65, 5
  s_cselect_b32 s65, 0, s65
  v_mfma_f32_16x16x32_bf16 v[132:135], v[60:63], a[68:71], v[132:135]
  ds_read_b64_tr_b16 v[74:75], v11 offset:51200
  s_lshl_b32 s65, s65, 7
  v_mfma_f32_16x16x32_bf16 v[132:135], v[64:67], a[84:87], v[132:135]
  ds_read_b64_tr_b16 v[76:77], v11 offset:53248
  buffer_load_dword v31, v92, s[4:7], s65 offen
  v_mfma_f32_16x16x32_bf16 v[136:139], v[56:59], a[56:59], v[136:139]
  ds_read_b64_tr_b16 v[78:79], v11 offset:55296
  buffer_load_dword v31, v92, s[8:11], s65 offen
  v_mfma_f32_16x16x32_bf16 v[136:139], v[60:63], a[72:75], v[136:139]
  s_add_u32 m0, s33, 122880
  v_mul_f32 v204, v204, v236
  v_mfma_f32_16x16x32_bf16 v[136:139], v[64:67], a[88:91], v[136:139]
  s_mov_b32 s34, 4423936
  v_mul_f32 v205, v205, v237
  v_mfma_f32_16x16x32_bf16 v[140:143], v[56:59], a[60:63], v[140:143]
  buffer_load_dwordx4 v19, s[4:7], s34 offen lds
  v_mul_f32 v206, v206, v238
  v_mfma_f32_16x16x32_bf16 v[140:143], v[60:63], a[76:79], v[140:143]
  s_add_u32 m0, s33, 16384
  v_mul_f32 v207, v207, v239
  v_mfma_f32_16x16x32_bf16 v[140:143], v[64:67], a[92:95], v[140:143]
  s_mov_b32 s34, 4718848
  buffer_load_dwordx4 v19, s[4:7], s34 offen lds
  s_waitcnt lgkmcnt(0)
  v_mfma_f32_16x16x32_bf16 v[144:147], v[68:71], a[48:51], v[144:147]
  ds_read_b64_tr_b16 v[56:57], v8 offset:57344
  v_cvt_pk_bf16_f32 v36, v204, v205
  v_mfma_f32_16x16x32_bf16 v[144:147], v[72:75], a[64:67], v[144:147]
  ds_read_b64_tr_b16 v[58:59], v8 offset:59392
  v_cvt_pk_bf16_f32 v37, v206, v207
  v_mfma_f32_16x16x32_bf16 v[144:147], v[76:79], a[80:83], v[144:147]
  ds_read_b64_tr_b16 v[60:61], v8 offset:61440
  v_mul_f32 v220, v220, v252
  v_mfma_f32_16x16x32_bf16 v[148:151], v[68:71], a[52:55], v[148:151]
  ds_read_b64_tr_b16 v[62:63], v8 offset:63488
  v_mul_f32 v221, v221, v253
  v_mfma_f32_16x16x32_bf16 v[148:151], v[72:75], a[68:71], v[148:151]
  ds_read_b64_tr_b16 v[64:65], v9
  v_mul_f32 v222, v222, v254
  v_mfma_f32_16x16x32_bf16 v[148:151], v[76:79], a[84:87], v[148:151]
  ds_read_b64_tr_b16 v[66:67], v9 offset:2048
  v_mul_f32 v223, v223, v255
  v_mfma_f32_16x16x32_bf16 v[152:155], v[68:71], a[56:59], v[152:155]
  s_add_u32 m0, s33, 20480
  v_cvt_pk_bf16_f32 v38, v220, v221
  v_mfma_f32_16x16x32_bf16 v[152:155], v[72:75], a[72:75], v[152:155]
  s_mov_b32 s34, 5013760
  v_cvt_pk_bf16_f32 v39, v222, v223
  v_mfma_f32_16x16x32_bf16 v[152:155], v[76:79], a[88:91], v[152:155]
  buffer_load_dwordx4 v19, s[4:7], s34 offen lds
  ds_write_b128 v17, v[36:39] offset:11264
  v_mfma_f32_16x16x32_bf16 v[156:159], v[68:71], a[60:63], v[156:159]
  s_mov_b32 s61, 11264
  v_mfma_f32_16x16x32_bf16 v[156:159], v[72:75], a[76:79], v[156:159]
  buffer_store_dwordx4 v[36:39], v80, s[28:31], s61 offen sc1
  v_mfma_f32_16x16x32_bf16 v[156:159], v[76:79], a[92:95], v[156:159]
  s_waitcnt lgkmcnt(1)
  v_mfma_f32_16x16x32_bf16 v[160:163], v[56:59], a[48:51], v[160:163]
  ds_read_b64_tr_b16 v[68:69], v11 offset:57344
  v_mfma_f32_16x16x32_bf16 v[160:163], v[60:63], a[64:67], v[160:163]
  ds_read_b64_tr_b16 v[70:71], v11 offset:59392
  v_mfma_f32_16x16x32_bf16 v[160:163], v[64:67], a[80:83], v[160:163]
  ds_read_b64_tr_b16 v[72:73], v11 offset:61440
  v_mfma_f32_16x16x32_bf16 v[164:167], v[56:59], a[52:55], v[164:167]
  ds_read_b64_tr_b16 v[74:75], v11 offset:63488
  v_mfma_f32_16x16x32_bf16 v[164:167], v[60:63], a[68:71], v[164:167]
  ds_read_b64_tr_b16 v[76:77], v12
  v_mfma_f32_16x16x32_bf16 v[164:167], v[64:67], a[84:87], v[164:167]
  ds_read_b64_tr_b16 v[78:79], v12 offset:2048
  v_mfma_f32_16x16x32_bf16 v[168:171], v[56:59], a[56:59], v[168:171]
  s_add_u32 m0, s33, 24576
  v_mfma_f32_16x16x32_bf16 v[168:171], v[60:63], a[72:75], v[168:171]
  s_mov_b32 s34, 4423936
  v_mfma_f32_16x16x32_bf16 v[168:171], v[64:67], a[88:91], v[168:171]
  buffer_load_dwordx4 v19, s[8:11], s34 offen lds
  v_mfma_f32_16x16x32_bf16 v[172:175], v[56:59], a[60:63], v[172:175]
  s_add_u32 m0, s33, 28672
  v_mfma_f32_16x16x32_bf16 v[172:175], v[60:63], a[76:79], v[172:175]
  s_mov_b32 s34, 4718848
  v_mfma_f32_16x16x32_bf16 v[172:175], v[64:67], a[92:95], v[172:175]
  buffer_load_dwordx4 v19, s[8:11], s34 offen lds
  s_waitcnt lgkmcnt(0)
  v_mfma_f32_16x16x32_bf16 v[176:179], v[68:71], a[48:51], v[176:179]
  ds_read_b64_tr_b16 v[56:57], v9 offset:4096
  v_mfma_f32_16x16x32_bf16 v[176:179], v[72:75], a[64:67], v[176:179]
  ds_read_b64_tr_b16 v[58:59], v9 offset:6144
  v_mfma_f32_16x16x32_bf16 v[176:179], v[76:79], a[80:83], v[176:179]
  ds_read_b64_tr_b16 v[60:61], v9 offset:8192
  v_mfma_f32_16x16x32_bf16 v[180:183], v[68:71], a[52:55], v[180:183]
  ds_read_b64_tr_b16 v[62:63], v9 offset:10240
  v_mfma_f32_16x16x32_bf16 v[180:183], v[72:75], a[68:71], v[180:183]
  ds_read_b64_tr_b16 v[64:65], v9 offset:12288
  v_mfma_f32_16x16x32_bf16 v[180:183], v[76:79], a[84:87], v[180:183]
  ds_read_b64_tr_b16 v[66:67], v9 offset:14336
  v_mfma_f32_16x16x32_bf16 v[184:187], v[68:71], a[56:59], v[184:187]
  s_add_u32 m0, s33, 32768
  v_mfma_f32_16x16x32_bf16 v[184:187], v[72:75], a[72:75], v[184:187]
  s_mov_b32 s34, 5013760
  v_mfma_f32_16x16x32_bf16 v[184:187], v[76:79], a[88:91], v[184:187]
  buffer_load_dwordx4 v19, s[8:11], s34 offen lds
  v_mfma_f32_16x16x32_bf16 v[188:191], v[68:71], a[60:63], v[188:191]
  v_mfma_f32_16x16x32_bf16 v[188:191], v[72:75], a[76:79], v[188:191]
  v_mfma_f32_16x16x32_bf16 v[188:191], v[76:79], a[92:95], v[188:191]
  s_waitcnt lgkmcnt(0)
  v_mfma_f32_16x16x32_bf16 v[128:131], v[56:59], a[96:99], v[128:131]
  s_waitcnt vmcnt(21)
  s_barrier
  v_mfma_f32_16x16x32_bf16 v[128:131], v[60:63], a[112:115], v[128:131]
  ds_read_b64_tr_b16 v[68:69], v12 offset:4096
  v_mfma_f32_16x16x32_bf16 v[128:131], v[64:67], a[128:131], v[128:131]
  ds_read_b64_tr_b16 v[70:71], v12 offset:6144
  v_mfma_f32_16x16x32_bf16 v[132:135], v[56:59], a[100:103], v[132:135]
  ds_read_b64_tr_b16 v[72:73], v12 offset:8192
  v_mfma_f32_16x16x32_bf16 v[132:135], v[60:63], a[116:119], v[132:135]
  ds_read_b64_tr_b16 v[74:75], v12 offset:10240
  v_mfma_f32_16x16x32_bf16 v[132:135], v[64:67], a[132:135], v[132:135]
  ds_read_b64_tr_b16 v[76:77], v12 offset:12288
  v_mfma_f32_16x16x32_bf16 v[136:139], v[56:59], a[104:107], v[136:139]
  ds_read_b64_tr_b16 v[78:79], v12 offset:14336
  v_mfma_f32_16x16x32_bf16 v[136:139], v[60:63], a[120:123], v[136:139]
  s_add_u32 m0, s33, 36864
  v_mfma_f32_16x16x32_bf16 v[136:139], v[64:67], a[136:139], v[136:139]
  s_mov_b32 s34, 384
  v_mfma_f32_16x16x32_bf16 v[140:143], v[56:59], a[108:111], v[140:143]
  buffer_load_dwordx4 v19, s[4:7], s34 offen lds
  v_mfma_f32_16x16x32_bf16 v[140:143], v[60:63], a[124:127], v[140:143]
  s_add_u32 m0, s33, 40960
  v_mfma_f32_16x16x32_bf16 v[140:143], v[64:67], a[140:143], v[140:143]
  s_mov_b32 s34, 295296
  buffer_load_dwordx4 v19, s[4:7], s34 offen lds
  s_waitcnt lgkmcnt(0)
  v_mfma_f32_16x16x32_bf16 v[144:147], v[68:71], a[96:99], v[144:147]
  ds_read_b64_tr_b16 v[56:57], v8
  v_mfma_f32_16x16x32_bf16 v[144:147], v[72:75], a[112:115], v[144:147]
  ds_read_b64_tr_b16 v[58:59], v8 offset:2048
  v_mfma_f32_16x16x32_bf16 v[144:147], v[76:79], a[128:131], v[144:147]
  ds_read_b64_tr_b16 v[60:61], v8 offset:4096
  v_mfma_f32_16x16x32_bf16 v[148:151], v[68:71], a[100:103], v[148:151]
  ds_read_b64_tr_b16 v[62:63], v8 offset:6144
  v_mfma_f32_16x16x32_bf16 v[148:151], v[72:75], a[116:119], v[148:151]
  ds_read_b64_tr_b16 v[64:65], v9 offset:16384
  v_mfma_f32_16x16x32_bf16 v[148:151], v[76:79], a[132:135], v[148:151]
  ds_read_b64_tr_b16 v[66:67], v9 offset:18432
  v_mfma_f32_16x16x32_bf16 v[152:155], v[68:71], a[104:107], v[152:155]
  s_add_u32 m0, s33, 45056
  v_mfma_f32_16x16x32_bf16 v[152:155], v[72:75], a[120:123], v[152:155]
  s_mov_b32 s34, 590208
  v_mfma_f32_16x16x32_bf16 v[152:155], v[76:79], a[136:139], v[152:155]
  buffer_load_dwordx4 v19, s[4:7], s34 offen lds
  v_mfma_f32_16x16x32_bf16 v[156:159], v[68:71], a[108:111], v[156:159]
  v_mfma_f32_16x16x32_bf16 v[156:159], v[72:75], a[124:127], v[156:159]
  v_mfma_f32_16x16x32_bf16 v[156:159], v[76:79], a[140:143], v[156:159]
  s_waitcnt lgkmcnt(0)
  v_mfma_f32_16x16x32_bf16 v[160:163], v[56:59], a[96:99], v[160:163]
  ds_read_b64_tr_b16 v[68:69], v11
  v_mfma_f32_16x16x32_bf16 v[160:163], v[60:63], a[112:115], v[160:163]
  ds_read_b64_tr_b16 v[70:71], v11 offset:2048
  v_mfma_f32_16x16x32_bf16 v[160:163], v[64:67], a[128:131], v[160:163]
  ds_read_b64_tr_b16 v[72:73], v11 offset:4096
  v_mfma_f32_16x16x32_bf16 v[164:167], v[56:59], a[100:103], v[164:167]
  ds_read_b64_tr_b16 v[74:75], v11 offset:6144
  v_mfma_f32_16x16x32_bf16 v[164:167], v[60:63], a[116:119], v[164:167]
  ds_read_b64_tr_b16 v[76:77], v12 offset:16384
  v_mfma_f32_16x16x32_bf16 v[164:167], v[64:67], a[132:135], v[164:167]
  ds_read_b64_tr_b16 v[78:79], v12 offset:18432
  v_mfma_f32_16x16x32_bf16 v[168:171], v[56:59], a[104:107], v[168:171]
  s_add_u32 m0, s33, 49152
  v_mfma_f32_16x16x32_bf16 v[168:171], v[60:63], a[120:123], v[168:171]
  s_mov_b32 s34, 384
  v_mfma_f32_16x16x32_bf16 v[168:171], v[64:67], a[136:139], v[168:171]
  buffer_load_dwordx4 v19, s[8:11], s34 offen lds
  v_mfma_f32_16x16x32_bf16 v[172:175], v[56:59], a[108:111], v[172:175]
  s_add_u32 m0, s33, 53248
  v_mfma_f32_16x16x32_bf16 v[172:175], v[60:63], a[124:127], v[172:175]
  s_mov_b32 s34, 295296
  v_mfma_f32_16x16x32_bf16 v[172:175], v[64:67], a[140:143], v[172:175]
  buffer_load_dwordx4 v19, s[8:11], s34 offen lds
  s_waitcnt lgkmcnt(0)
  v_mfma_f32_16x16x32_bf16 v[176:179], v[68:71], a[96:99], v[176:179]
  ds_read_b64_tr_b16 v[56:57], v9 offset:20480
  v_mfma_f32_16x16x32_bf16 v[176:179], v[72:75], a[112:115], v[176:179]
  ds_read_b64_tr_b16 v[58:59], v9 offset:22528
  v_mfma_f32_16x16x32_bf16 v[176:179], v[76:79], a[128:131], v[176:179]
  ds_read_b64_tr_b16 v[60:61], v10 offset:12288
  v_mfma_f32_16x16x32_bf16 v[180:183], v[68:71], a[100:103], v[180:183]
  ds_read_b64_tr_b16 v[62:63], v10 offset:14336
  v_mfma_f32_16x16x32_bf16 v[180:183], v[72:75], a[116:119], v[180:183]
  ds_read_b64_tr_b16 v[64:65], v10 offset:16384
  v_mfma_f32_16x16x32_bf16 v[180:183], v[76:79], a[132:135], v[180:183]
  ds_read_b64_tr_b16 v[66:67], v10 offset:18432
  v_mfma_f32_16x16x32_bf16 v[184:187], v[68:71], a[104:107], v[184:187]
  s_add_u32 m0, s33, 57344
  v_mfma_f32_16x16x32_bf16 v[184:187], v[72:75], a[120:123], v[184:187]
  s_mov_b32 s34, 590208
  v_mfma_f32_16x16x32_bf16 v[184:187], v[76:79], a[136:139], v[184:187]
  buffer_load_dwordx4 v19, s[8:11], s34 offen lds
  v_mfma_f32_16x16x32_bf16 v[188:191], v[68:71], a[108:111], v[188:191]
  v_mfma_f32_16x16x32_bf16 v[188:191], v[72:75], a[124:127], v[188:191]
  v_mfma_f32_16x16x32_bf16 v[188:191], v[76:79], a[140:143], v[188:191]
  s_waitcnt lgkmcnt(0)
  v_mfma_f32_16x16x32_bf16 v[128:131], v[56:59], a[144:147], v[128:131]
  s_waitcnt vmcnt(20)
  s_barrier
  v_mfma_f32_16x16x32_bf16 v[128:131], v[60:63], a[160:163], v[128:131]
  ds_read_b64_tr_b16 v[68:69], v12 offset:20480
  s_mov_b32 s65, 0
  v_mfma_f32_16x16x32_bf16 v[128:131], v[64:67], a[176:179], v[128:131]
  ds_read_b64_tr_b16 v[70:71], v12 offset:22528
  buffer_load_dword v31, v93, s[12:15], s65 offen
  v_mfma_f32_16x16x32_bf16 v[132:135], v[56:59], a[148:151], v[132:135]
  ds_read_b64_tr_b16 v[72:73], v13 offset:12288
  s_and_b32 s36, s94, 1
  v_mfma_f32_16x16x32_bf16 v[132:135], v[60:63], a[164:167], v[132:135]
  ds_read_b64_tr_b16 v[74:75], v13 offset:14336
  s_lshr_b32 s37, s94, 1
  v_mfma_f32_16x16x32_bf16 v[132:135], v[64:67], a[180:183], v[132:135]
  ds_read_b64_tr_b16 v[76:77], v13 offset:16384
  s_mul_i32 s37, s37, 663552
  v_mfma_f32_16x16x32_bf16 v[136:139], v[56:59], a[152:155], v[136:139]
  ds_read_b64_tr_b16 v[78:79], v13 offset:18432
  s_lshr_b32 s39, s92, 1
  v_mfma_f32_16x16x32_bf16 v[136:139], v[60:63], a[168:171], v[136:139]
  s_add_u32 m0, s33, 61440
  s_and_b32 s40, s92, 1
  v_mfma_f32_16x16x32_bf16 v[136:139], v[64:67], a[184:187], v[136:139]
  s_mov_b32 s34, 885120
  s_mul_i32 s38, s36, 640
  v_mfma_f32_16x16x32_bf16 v[140:143], v[56:59], a[156:159], v[140:143]
  buffer_load_dwordx4 v19, s[4:7], s34 offen lds
  s_add_u32 s38, s38, s37
  v_mfma_f32_16x16x32_bf16 v[140:143], v[60:63], a[172:175], v[140:143]
  s_add_u32 m0, s33, 65536
  v_add_u32 v4, s38, v21
  v_mfma_f32_16x16x32_bf16 v[140:143], v[64:67], a[188:191], v[140:143]
  s_mov_b32 s34, 1180032
  buffer_load_dwordx4 v19, s[4:7], s34 offen lds
  s_waitcnt lgkmcnt(0)
  v_mfma_f32_16x16x32_bf16 v[144:147], v[68:71], a[144:147], v[144:147]
  ds_read_b64_tr_b16 v[56:57], v10 offset:20480
  s_mul_i32 s38, s36, 368640
  v_mfma_f32_16x16x32_bf16 v[144:147], v[72:75], a[160:163], v[144:147]
  ds_read_b64_tr_b16 v[58:59], v10 offset:22528
  v_add_u32 v82, s38, v4
  v_mfma_f32_16x16x32_bf16 v[144:147], v[76:79], a[176:179], v[144:147]
  ds_read_b64_tr_b16 v[60:61], v9 offset:40960
  v_add_u32 v82, 0, v82
  v_mfma_f32_16x16x32_bf16 v[148:151], v[68:71], a[148:151], v[148:151]
  ds_read_b64_tr_b16 v[62:63], v9 offset:43008
  s_mul_i32 s38, s36, 36864
  v_mfma_f32_16x16x32_bf16 v[148:151], v[72:75], a[164:167], v[148:151]
  ds_read_b64_tr_b16 v[64:65], v9 offset:45056
  v_add_u32 v83, s38, v4
  v_mfma_f32_16x16x32_bf16 v[148:151], v[76:79], a[180:183], v[148:151]
  ds_read_b64_tr_b16 v[66:67], v9 offset:47104
  v_add_u32 v83, 294912, v83
  v_mfma_f32_16x16x32_bf16 v[152:155], v[68:71], a[152:155], v[152:155]
  s_add_u32 m0, s33, 69632
  s_mul_i32 s38, s36, -368640
  v_mfma_f32_16x16x32_bf16 v[152:155], v[72:75], a[168:171], v[152:155]
  s_mov_b32 s34, 1474944
  v_add_u32 v84, s38, v4
  v_mfma_f32_16x16x32_bf16 v[152:155], v[76:79], a[184:187], v[152:155]
  buffer_load_dwordx4 v19, s[4:7], s34 offen lds
  v_add_u32 v84, 368640, v84
  v_mfma_f32_16x16x32_bf16 v[156:159], v[68:71], a[156:159], v[156:159]
  s_mul_i32 s38, s36, -36864
  v_mfma_f32_16x16x32_bf16 v[156:159], v[72:75], a[172:175], v[156:159]
  v_add_u32 v85, s38, v4
  v_mfma_f32_16x16x32_bf16 v[156:159], v[76:79], a[188:191], v[156:159]
  v_add_u32 v85, 331776, v85
  s_waitcnt lgkmcnt(0)
  v_mfma_f32_16x16x32_bf16 v[160:163], v[56:59], a[144:147], v[160:163]
  ds_read_b64_tr_b16 v[68:69], v13 offset:20480
  v_and_b32 v1, 63, v0
  v_mfma_f32_16x16x32_bf16 v[160:163], v[60:63], a[160:163], v[160:163]
  ds_read_b64_tr_b16 v[70:71], v13 offset:22528
  v_bfe_u32 v4, v1, 1, 1
  v_mfma_f32_16x16x32_bf16 v[160:163], v[64:67], a[176:179], v[160:163]
  ds_read_b64_tr_b16 v[72:73], v12 offset:40960
  v_bfe_u32 v5, v1, 4, 1
  v_mfma_f32_16x16x32_bf16 v[164:167], v[56:59], a[148:151], v[164:167]
  ds_read_b64_tr_b16 v[74:75], v12 offset:43008
  v_xor_b32 v4, v4, v5
  v_mfma_f32_16x16x32_bf16 v[164:167], v[60:63], a[164:167], v[164:167]
  ds_read_b64_tr_b16 v[76:77], v12 offset:45056
  v_lshlrev_b32 v4, 5, v4
  v_mfma_f32_16x16x32_bf16 v[164:167], v[64:67], a[180:183], v[164:167]
  ds_read_b64_tr_b16 v[78:79], v12 offset:47104
  v_and_b32 v5, 1, v1
  v_mfma_f32_16x16x32_bf16 v[168:171], v[56:59], a[152:155], v[168:171]
  s_add_u32 m0, s33, 73728
  v_lshl_add_u32 v4, v5, 4, v4
  v_mfma_f32_16x16x32_bf16 v[168:171], v[60:63], a[168:171], v[168:171]
  s_mov_b32 s34, 885120
  v_lshrrev_b32 v5, 2, v1
  v_mfma_f32_16x16x32_bf16 v[168:171], v[64:67], a[184:187], v[168:171]
  buffer_load_dwordx4 v19, s[8:11], s34 offen lds
  s_lshl_b32 s38, s40, 4
  v_mfma_f32_16x16x32_bf16 v[172:175], v[56:59], a[156:159], v[172:175]
  s_add_u32 m0, s33, 77824
  v_add_u32 v5, s38, v5
  v_mfma_f32_16x16x32_bf16 v[172:175], v[60:63], a[172:175], v[172:175]
  s_mov_b32 s34, 1180032
  v_mul_u32_u24 v5, 1152, v5
  v_mfma_f32_16x16x32_bf16 v[172:175], v[64:67], a[188:191], v[172:175]
  buffer_load_dwordx4 v19, s[8:11], s34 offen lds
  s_waitcnt lgkmcnt(0)
  v_mfma_f32_16x16x32_bf16 v[176:179], v[68:71], a[144:147], v[176:179]
  ds_read_b64_tr_b16 v[56:57], v10 offset:24576
  s_lshl_b32 s38, s36, 6
  v_mfma_f32_16x16x32_bf16 v[176:179], v[72:75], a[160:163], v[176:179]
  ds_read_b64_tr_b16 v[58:59], v10 offset:26624
  s_add_u32 s38, s38, s37
  v_mfma_f32_16x16x32_bf16 v[176:179], v[76:79], a[176:179], v[176:179]
  ds_read_b64_tr_b16 v[60:61], v10 offset:28672
  s_add_u32 s38, s38, 512
  v_mfma_f32_16x16x32_bf16 v[180:183], v[68:71], a[148:151], v[180:183]
  ds_read_b64_tr_b16 v[62:63], v10 offset:30720
  v_add3_u32 v4, v4, v5, s38
  v_mfma_f32_16x16x32_bf16 v[180:183], v[72:75], a[164:167], v[180:183]
  ds_read_b64_tr_b16 v[64:65], v8 offset:8192
  s_xor_b32 s38, s36, s39
  v_mfma_f32_16x16x32_bf16 v[180:183], v[76:79], a[180:183], v[180:183]
  ds_read_b64_tr_b16 v[66:67], v8 offset:10240
  s_mul_i32 s41, s38, 368640
  v_mfma_f32_16x16x32_bf16 v[184:187], v[68:71], a[152:155], v[184:187]
  s_add_u32 m0, s33, 0
  v_add_u32 v86, s41, v4
  v_mfma_f32_16x16x32_bf16 v[184:187], v[72:75], a[168:171], v[184:187]
  s_mov_b32 s34, 1474944
  s_mul_i32 s41, s38, 36864
  v_mfma_f32_16x16x32_bf16 v[184:187], v[76:79], a[184:187], v[184:187]
  buffer_load_dwordx4 v19, s[8:11], s34 offen lds
  s_add_u32 s41, s41, 294912
  v_mfma_f32_16x16x32_bf16 v[188:191], v[68:71], a[156:159], v[188:191]
  v_add_u32 v87, s41, v4
  v_mfma_f32_16x16x32_bf16 v[188:191], v[72:75], a[172:175], v[188:191]
  s_mul_i32 s38, s39, 36864
  v_mfma_f32_16x16x32_bf16 v[188:191], v[76:79], a[188:191], v[188:191]
  v_add_u32 v89, s38, v24
  s_waitcnt lgkmcnt(0)
  v_mfma_f32_16x16x32_bf16 v[128:131], v[56:59], a[192:195], v[128:131]
  s_waitcnt vmcnt(17)
  s_barrier
  v_mfma_f32_16x16x32_bf16 v[128:131], v[60:63], a[208:211], v[128:131]
  ds_read_b64_tr_b16 v[68:69], v13 offset:24576
  v_lshlrev_b32 v4, 3, v1
  v_mfma_f32_16x16x32_bf16 v[128:131], v[64:67], a[224:227], v[128:131]
  ds_read_b64_tr_b16 v[70:71], v13 offset:26624
  v_add_u32 v90, s38, v4
  v_mfma_f32_16x16x32_bf16 v[132:135], v[56:59], a[196:199], v[132:135]
  ds_read_b64_tr_b16 v[72:73], v13 offset:28672
  s_lshl_b32 s41, s40, 10
  v_mfma_f32_16x16x32_bf16 v[132:135], v[60:63], a[212:215], v[132:135]
  ds_read_b64_tr_b16 v[74:75], v13 offset:30720
  v_add_u32 v88, s41, v89
  v_mfma_f32_16x16x32_bf16 v[132:135], v[64:67], a[228:231], v[132:135]
  ds_read_b64_tr_b16 v[76:77], v11 offset:8192
  s_xor_b32 s38, s94, 1
  v_mfma_f32_16x16x32_bf16 v[136:139], v[56:59], a[200:203], v[136:139]
  ds_read_b64_tr_b16 v[78:79], v11 offset:10240
  s_lshl_b32 s41, s93, 4
  v_mfma_f32_16x16x32_bf16 v[136:139], v[60:63], a[216:219], v[136:139]
  s_add_u32 m0, s33, 4096
  s_add_u32 s41, s41, s38
  v_mfma_f32_16x16x32_bf16 v[136:139], v[64:67], a[232:235], v[136:139]
  s_mov_b32 s34, 1769856
  s_lshl_b32 s39, s93, 11
  v_mfma_f32_16x16x32_bf16 v[140:143], v[56:59], a[204:207], v[140:143]
  buffer_load_dwordx4 v19, s[4:7], s34 offen lds
  s_lshl_b32 s38, s38, 7
  v_mfma_f32_16x16x32_bf16 v[140:143], v[60:63], a[220:223], v[140:143]
  s_add_u32 m0, s33, 81920
  s_add_u32 s38, s38, s39
  v_mfma_f32_16x16x32_bf16 v[140:143], v[64:67], a[236:239], v[140:143]
  s_mov_b32 s34, 2064768
  buffer_load_dwordx4 v19, s[4:7], s34 offen lds
  s_waitcnt lgkmcnt(0)
  v_mfma_f32_16x16x32_bf16 v[144:147], v[68:71], a[192:195], v[144:147]
  ds_read_b64_tr_b16 v[56:57], v8 offset:12288
  v_and_b32 v91, 4, v30
  v_mfma_f32_16x16x32_bf16 v[144:147], v[72:75], a[208:211], v[144:147]
  ds_read_b64_tr_b16 v[58:59], v8 offset:14336
  v_add_u32 v91, s38, v91
  v_mfma_f32_16x16x32_bf16 v[144:147], v[76:79], a[224:227], v[144:147]
  ds_read_b64_tr_b16 v[60:61], v9 offset:49152
  s_mul_i32 s41, s41, 73728
  v_mfma_f32_16x16x32_bf16 v[148:151], v[68:71], a[196:199], v[148:151]
  ds_read_b64_tr_b16 v[62:63], v9 offset:51200
  s_add_u32 s41, s41, 7774208
  v_mfma_f32_16x16x32_bf16 v[148:151], v[72:75], a[212:215], v[148:151]
  ds_read_b64_tr_b16 v[64:65], v9 offset:53248
  s_add_u32 s68, s90, s41
  s_addc_u32 s69, s91, 0
  v_mfma_f32_16x16x32_bf16 v[148:151], v[76:79], a[228:231], v[148:151]
  ds_read_b64_tr_b16 v[66:67], v9 offset:55296
  s_and_b32 s69, s69, 0xffff
  v_mfma_f32_16x16x32_bf16 v[152:155], v[68:71], a[200:203], v[152:155]
  s_add_u32 m0, s33, 86016
  s_mov_b32 s70, 73728
  v_mfma_f32_16x16x32_bf16 v[152:155], v[72:75], a[216:219], v[152:155]
  s_mov_b32 s34, 2359680
  s_mov_b32 s71, 0x20000
  v_mfma_f32_16x16x32_bf16 v[152:155], v[76:79], a[232:235], v[152:155]
  buffer_load_dwordx4 v19, s[4:7], s34 offen lds
  v_mfma_f32_16x16x32_bf16 v[156:159], v[68:71], a[204:207], v[156:159]
  v_mfma_f32_16x16x32_bf16 v[156:159], v[72:75], a[220:223], v[156:159]
  v_mfma_f32_16x16x32_bf16 v[156:159], v[76:79], a[236:239], v[156:159]
  s_waitcnt lgkmcnt(0)
  v_mfma_f32_16x16x32_bf16 v[160:163], v[56:59], a[192:195], v[160:163]
  ds_read_b64_tr_b16 v[68:69], v11 offset:12288
  v_mfma_f32_16x16x32_bf16 v[160:163], v[60:63], a[208:211], v[160:163]
  ds_read_b64_tr_b16 v[70:71], v11 offset:14336
  v_mfma_f32_16x16x32_bf16 v[160:163], v[64:67], a[224:227], v[160:163]
  ds_read_b64_tr_b16 v[72:73], v12 offset:49152
  v_mfma_f32_16x16x32_bf16 v[164:167], v[56:59], a[196:199], v[164:167]
  ds_read_b64_tr_b16 v[74:75], v12 offset:51200
  v_mfma_f32_16x16x32_bf16 v[164:167], v[60:63], a[212:215], v[164:167]
  ds_read_b64_tr_b16 v[76:77], v12 offset:53248
  v_mfma_f32_16x16x32_bf16 v[164:167], v[64:67], a[228:231], v[164:167]
  ds_read_b64_tr_b16 v[78:79], v12 offset:55296
  v_mfma_f32_16x16x32_bf16 v[168:171], v[56:59], a[200:203], v[168:171]
  s_add_u32 m0, s33, 151552
  v_mfma_f32_16x16x32_bf16 v[168:171], v[60:63], a[216:219], v[168:171]
  s_mov_b32 s34, 1769856
  v_mfma_f32_16x16x32_bf16 v[168:171], v[64:67], a[232:235], v[168:171]
  buffer_load_dwordx4 v19, s[8:11], s34 offen lds
  v_mfma_f32_16x16x32_bf16 v[172:175], v[56:59], a[204:207], v[172:175]
  v_mfma_f32_16x16x32_bf16 v[172:175], v[60:63], a[220:223], v[172:175]
  v_mfma_f32_16x16x32_bf16 v[172:175], v[64:67], a[236:239], v[172:175]
  s_waitcnt lgkmcnt(0)
  v_mfma_f32_16x16x32_bf16 v[176:179], v[68:71], a[192:195], v[176:179]
  ds_read_b64_tr_b16 v[56:57], v9 offset:57344
  v_mfma_f32_16x16x32_bf16 v[176:179], v[72:75], a[208:211], v[176:179]
  ds_read_b64_tr_b16 v[58:59], v9 offset:59392
  v_mfma_f32_16x16x32_bf16 v[176:179], v[76:79], a[224:227], v[176:179]
  ds_read_b64_tr_b16 v[60:61], v8 offset:16384
  v_mfma_f32_16x16x32_bf16 v[180:183], v[68:71], a[196:199], v[180:183]
  ds_read_b64_tr_b16 v[62:63], v8 offset:18432
  v_mfma_f32_16x16x32_bf16 v[180:183], v[72:75], a[212:215], v[180:183]
  ds_read_b64_tr_b16 v[64:65], v8 offset:20480
  v_mfma_f32_16x16x32_bf16 v[180:183], v[76:79], a[228:231], v[180:183]
  ds_read_b64_tr_b16 v[66:67], v8 offset:22528
  v_mfma_f32_16x16x32_bf16 v[184:187], v[68:71], a[200:203], v[184:187]
  v_mfma_f32_16x16x32_bf16 v[184:187], v[72:75], a[216:219], v[184:187]
  v_mfma_f32_16x16x32_bf16 v[184:187], v[76:79], a[232:235], v[184:187]
  v_mfma_f32_16x16x32_bf16 v[188:191], v[68:71], a[204:207], v[188:191]
  v_mfma_f32_16x16x32_bf16 v[188:191], v[72:75], a[220:223], v[188:191]
  v_mfma_f32_16x16x32_bf16 v[188:191], v[76:79], a[236:239], v[188:191]
  s_waitcnt lgkmcnt(0)
  v_mfma_f32_16x16x32_bf16 v[128:131], v[56:59], a[240:243], v[128:131]
  s_waitcnt vmcnt(14)
  s_barrier
  v_mfma_f32_16x16x32_bf16 v[128:131], v[60:63], v[96:99], v[128:131]
  ds_read_b64_tr_b16 v[68:69], v12 offset:57344
  s_mov_b32 s65, 6912
  v_mfma_f32_16x16x32_bf16 v[128:131], v[64:67], v[112:115], v[128:131]
  ds_read_b64_tr_b16 v[70:71], v12 offset:59392
  buffer_load_dword v31, v93, s[12:15], s65 offen
  v_mfma_f32_16x16x32_bf16 v[132:135], v[56:59], a[244:247], v[132:135]
  ds_read_b64_tr_b16 v[72:73], v11 offset:16384
  v_mfma_f32_16x16x32_bf16 v[132:135], v[60:63], v[100:103], v[132:135]
  ds_read_b64_tr_b16 v[74:75], v11 offset:18432
  v_mfma_f32_16x16x32_bf16 v[132:135], v[64:67], v[116:119], v[132:135]
  ds_read_b64_tr_b16 v[76:77], v11 offset:20480
  v_mfma_f32_16x16x32_bf16 v[136:139], v[56:59], a[248:251], v[136:139]
  ds_read_b64_tr_b16 v[78:79], v11 offset:22528
  v_mfma_f32_16x16x32_bf16 v[136:139], v[60:63], v[104:107], v[136:139]
  s_add_u32 m0, s33, 155648
  v_mfma_f32_16x16x32_bf16 v[136:139], v[64:67], v[120:123], v[136:139]
  s_mov_b32 s34, 2064768
  v_mfma_f32_16x16x32_bf16 v[140:143], v[56:59], a[252:255], v[140:143]
  buffer_load_dwordx4 v19, s[8:11], s34 offen lds
  v_mfma_f32_16x16x32_bf16 v[140:143], v[60:63], v[108:111], v[140:143]
  s_add_u32 m0, s33, 159744
  v_mfma_f32_16x16x32_bf16 v[140:143], v[64:67], v[124:127], v[140:143]
  s_mov_b32 s34, 2359680
  buffer_load_dwordx4 v19, s[8:11], s34 offen lds
  s_waitcnt lgkmcnt(0)
  v_mfma_f32_16x16x32_bf16 v[144:147], v[68:71], a[240:243], v[144:147]
  ds_read_b64_tr_b16 v[56:57], v8 offset:24576
  v_mfma_f32_16x16x32_bf16 v[144:147], v[72:75], v[96:99], v[144:147]
  ds_read_b64_tr_b16 v[58:59], v8 offset:26624
  v_mfma_f32_16x16x32_bf16 v[144:147], v[76:79], v[112:115], v[144:147]
  ds_read_b64_tr_b16 v[60:61], v8 offset:28672
  v_mfma_f32_16x16x32_bf16 v[148:151], v[68:71], a[244:247], v[148:151]
  ds_read_b64_tr_b16 v[62:63], v8 offset:30720
  v_mfma_f32_16x16x32_bf16 v[148:151], v[72:75], v[100:103], v[148:151]
  ds_read_b64_tr_b16 v[64:65], v8 offset:32768
  v_mfma_f32_16x16x32_bf16 v[148:151], v[76:79], v[116:119], v[148:151]
  ds_read_b64_tr_b16 v[66:67], v8 offset:34816
  v_mfma_f32_16x16x32_bf16 v[152:155], v[68:71], a[248:251], v[152:155]
  s_add_u32 m0, s33, 8192
  v_mfma_f32_16x16x32_bf16 v[152:155], v[72:75], v[104:107], v[152:155]
  s_mov_b32 s34, 2654592
  v_mfma_f32_16x16x32_bf16 v[152:155], v[76:79], v[120:123], v[152:155]
  buffer_load_dwordx4 v19, s[4:7], s34 offen lds
  v_mfma_f32_16x16x32_bf16 v[156:159], v[68:71], a[252:255], v[156:159]
  s_add_u32 m0, s33, 12288
  v_mfma_f32_16x16x32_bf16 v[156:159], v[72:75], v[108:111], v[156:159]
  s_mov_b32 s34, 2949504
  v_mfma_f32_16x16x32_bf16 v[156:159], v[76:79], v[124:127], v[156:159]
  buffer_load_dwordx4 v19, s[4:7], s34 offen lds
  s_waitcnt lgkmcnt(0)
  v_mfma_f32_16x16x32_bf16 v[160:163], v[56:59], a[240:243], v[160:163]
  ds_read_b64_tr_b16 v[68:69], v11 offset:24576
  v_mfma_f32_16x16x32_bf16 v[160:163], v[60:63], v[96:99], v[160:163]
  ds_read_b64_tr_b16 v[70:71], v11 offset:26624
  v_mfma_f32_16x16x32_bf16 v[160:163], v[64:67], v[112:115], v[160:163]
  ds_read_b64_tr_b16 v[72:73], v11 offset:28672
  v_mfma_f32_16x16x32_bf16 v[164:167], v[56:59], a[244:247], v[164:167]
  ds_read_b64_tr_b16 v[74:75], v11 offset:30720
  v_mfma_f32_16x16x32_bf16 v[164:167], v[60:63], v[100:103], v[164:167]
  ds_read_b64_tr_b16 v[76:77], v11 offset:32768
  v_mfma_f32_16x16x32_bf16 v[164:167], v[64:67], v[116:119], v[164:167]
  ds_read_b64_tr_b16 v[78:79], v11 offset:34816
  v_mfma_f32_16x16x32_bf16 v[168:171], v[56:59], a[248:251], v[168:171]
  s_add_u32 m0, s33, 114688
  v_mfma_f32_16x16x32_bf16 v[168:171], v[60:63], v[104:107], v[168:171]
  s_mov_b32 s34, 3244416
  v_mfma_f32_16x16x32_bf16 v[168:171], v[64:67], v[120:123], v[168:171]
  buffer_load_dwordx4 v19, s[4:7], s34 offen lds
  v_mfma_f32_16x16x32_bf16 v[172:175], v[56:59], a[252:255], v[172:175]
  s_add_u32 m0, s33, 118784
  v_mfma_f32_16x16x32_bf16 v[172:175], v[60:63], v[108:111], v[172:175]
  s_mov_b32 s34, 2654592
  v_mfma_f32_16x16x32_bf16 v[172:175], v[64:67], v[124:127], v[172:175]
  buffer_load_dwordx4 v19, s[8:11], s34 offen lds
  s_waitcnt lgkmcnt(0)
  v_mfma_f32_16x16x32_bf16 v[176:179], v[68:71], a[240:243], v[176:179]
  ds_read_b64_tr_b16 v[56:57], v8 offset:36864
  v_mfma_f32_16x16x32_bf16 v[176:179], v[72:75], v[96:99], v[176:179]
  ds_read_b64_tr_b16 v[58:59], v8 offset:38912
  v_mfma_f32_16x16x32_bf16 v[176:179], v[76:79], v[112:115], v[176:179]
  ds_read_b64_tr_b16 v[60:61], v8 offset:40960
  v_mfma_f32_16x16x32_bf16 v[180:183], v[68:71], a[244:247], v[180:183]
  ds_read_b64_tr_b16 v[62:63], v8 offset:43008
  v_mfma_f32_16x16x32_bf16 v[180:183], v[72:75], v[100:103], v[180:183]
  ds_read_b64_tr_b16 v[64:65], v8 offset:45056
  v_mfma_f32_16x16x32_bf16 v[180:183], v[76:79], v[116:119], v[180:183]
  ds_read_b64_tr_b16 v[66:67], v8 offset:47104
  v_mfma_f32_16x16x32_bf16 v[184:187], v[68:71], a[248:251], v[184:187]
  v_mfma_f32_16x16x32_bf16 v[184:187], v[72:75], v[104:107], v[184:187]
  v_mfma_f32_16x16x32_bf16 v[184:187], v[76:79], v[120:123], v[184:187]
  v_mfma_f32_16x16x32_bf16 v[188:191], v[68:71], a[252:255], v[188:191]
  v_mfma_f32_16x16x32_bf16 v[188:191], v[72:75], v[108:111], v[188:191]
  v_mfma_f32_16x16x32_bf16 v[188:191], v[76:79], v[124:127], v[188:191]
  s_waitcnt lgkmcnt(0)
  v_mfma_f32_16x16x32_bf16 v[192:195], v[56:59], a[0:3], 0
  s_waitcnt vmcnt(14)
  s_barrier
  v_mfma_f32_16x16x32_bf16 v[192:195], v[60:63], a[16:19], v[192:195]
  ds_read_b64_tr_b16 v[68:69], v11 offset:36864
  v_mul_f32 v128, v128, v160
  v_mfma_f32_16x16x32_bf16 v[192:195], v[64:67], a[32:35], v[192:195]
  ds_read_b64_tr_b16 v[70:71], v11 offset:38912
  v_mul_f32 v129, v129, v161
  v_mfma_f32_16x16x32_bf16 v[196:199], v[56:59], a[4:7], 0
  ds_read_b64_tr_b16 v[72:73], v11 offset:40960
  v_mul_f32 v130, v130, v162
  v_mfma_f32_16x16x32_bf16 v[196:199], v[60:63], a[20:23], v[196:199]
  ds_read_b64_tr_b16 v[74:75], v11 offset:43008
  v_mul_f32 v131, v131, v163
  v_mfma_f32_16x16x32_bf16 v[196:199], v[64:67], a[36:39], v[196:199]
  ds_read_b64_tr_b16 v[76:77], v11 offset:45056
  v_cvt_pk_bf16_f32 v32, v128, v129
  v_mfma_f32_16x16x32_bf16 v[200:203], v[56:59], a[8:11], 0
  ds_read_b64_tr_b16 v[78:79], v11 offset:47104
  v_cvt_pk_bf16_f32 v33, v130, v131
  v_mfma_f32_16x16x32_bf16 v[200:203], v[60:63], a[24:27], v[200:203]
  v_mul_f32 v144, v144, v176
  v_mfma_f32_16x16x32_bf16 v[200:203], v[64:67], a[40:43], v[200:203]
  v_mul_f32 v145, v145, v177
  v_mfma_f32_16x16x32_bf16 v[204:207], v[56:59], a[12:15], 0
  v_mul_f32 v146, v146, v178
  v_mfma_f32_16x16x32_bf16 v[204:207], v[60:63], a[28:31], v[204:207]
  v_mul_f32 v147, v147, v179
  v_mfma_f32_16x16x32_bf16 v[204:207], v[64:67], a[44:47], v[204:207]
  v_cvt_pk_bf16_f32 v34, v144, v145
  s_waitcnt lgkmcnt(0)
  v_mfma_f32_16x16x32_bf16 v[208:211], v[68:71], a[0:3], 0
  ds_read_b64_tr_b16 v[56:57], v8 offset:49152
  v_cvt_pk_bf16_f32 v35, v146, v147
  v_mfma_f32_16x16x32_bf16 v[208:211], v[72:75], a[16:19], v[208:211]
  ds_read_b64_tr_b16 v[58:59], v8 offset:51200
  ds_write_b128 v17, v[32:35] offset:16384
  v_mfma_f32_16x16x32_bf16 v[208:211], v[76:79], a[32:35], v[208:211]
  ds_read_b64_tr_b16 v[60:61], v8 offset:53248
  s_mov_b32 s61, 16384
  v_mfma_f32_16x16x32_bf16 v[212:215], v[68:71], a[4:7], 0
  ds_read_b64_tr_b16 v[62:63], v8 offset:55296
  buffer_store_dwordx4 v[32:35], v80, s[28:31], s61 offen sc1
  v_mfma_f32_16x16x32_bf16 v[212:215], v[72:75], a[20:23], v[212:215]
  ds_read_b64_tr_b16 v[64:65], v8 offset:57344
  v_mul_f32 v132, v132, v164
  v_mfma_f32_16x16x32_bf16 v[212:215], v[76:79], a[36:39], v[212:215]
  ds_read_b64_tr_b16 v[66:67], v8 offset:59392
  v_mul_f32 v133, v133, v165
  v_mfma_f32_16x16x32_bf16 v[216:219], v[68:71], a[8:11], 0
  v_mul_f32 v134, v134, v166
  v_mfma_f32_16x16x32_bf16 v[216:219], v[72:75], a[24:27], v[216:219]
  v_mul_f32 v135, v135, v167
  v_mfma_f32_16x16x32_bf16 v[216:219], v[76:79], a[40:43], v[216:219]
  v_cvt_pk_bf16_f32 v36, v132, v133
  v_mfma_f32_16x16x32_bf16 v[220:223], v[68:71], a[12:15], 0
  v_cvt_pk_bf16_f32 v37, v134, v135
  v_mfma_f32_16x16x32_bf16 v[220:223], v[72:75], a[28:31], v[220:223]
  v_mul_f32 v148, v148, v180
  v_mfma_f32_16x16x32_bf16 v[220:223], v[76:79], a[44:47], v[220:223]
  v_mul_f32 v149, v149, v181
  s_waitcnt lgkmcnt(0)
  v_mfma_f32_16x16x32_bf16 v[224:227], v[56:59], a[0:3], 0
  ds_read_b64_tr_b16 v[68:69], v11 offset:49152
  v_mul_f32 v150, v150, v182
  v_mfma_f32_16x16x32_bf16 v[224:227], v[60:63], a[16:19], v[224:227]
  ds_read_b64_tr_b16 v[70:71], v11 offset:51200
  v_mul_f32 v151, v151, v183
  v_mfma_f32_16x16x32_bf16 v[224:227], v[64:67], a[32:35], v[224:227]
  ds_read_b64_tr_b16 v[72:73], v11 offset:53248
  v_cvt_pk_bf16_f32 v38, v148, v149
  v_mfma_f32_16x16x32_bf16 v[228:231], v[56:59], a[4:7], 0
  ds_read_b64_tr_b16 v[74:75], v11 offset:55296
  v_cvt_pk_bf16_f32 v39, v150, v151
  v_mfma_f32_16x16x32_bf16 v[228:231], v[60:63], a[20:23], v[228:231]
  ds_read_b64_tr_b16 v[76:77], v11 offset:57344
  ds_write_b128 v17, v[36:39] offset:17408
  v_mfma_f32_16x16x32_bf16 v[228:231], v[64:67], a[36:39], v[228:231]
  ds_read_b64_tr_b16 v[78:79], v11 offset:59392
  s_mov_b32 s61, 17408
  v_mfma_f32_16x16x32_bf16 v[232:235], v[56:59], a[8:11], 0
  buffer_store_dwordx4 v[36:39], v80, s[28:31], s61 offen sc1
  v_mfma_f32_16x16x32_bf16 v[232:235], v[60:63], a[24:27], v[232:235]
  v_mul_f32 v136, v136, v168
  v_mfma_f32_16x16x32_bf16 v[232:235], v[64:67], a[40:43], v[232:235]
  v_mul_f32 v137, v137, v169
  v_mfma_f32_16x16x32_bf16 v[236:239], v[56:59], a[12:15], 0
  v_mul_f32 v138, v138, v170
  v_mfma_f32_16x16x32_bf16 v[236:239], v[60:63], a[28:31], v[236:239]
  v_mul_f32 v139, v139, v171
  v_mfma_f32_16x16x32_bf16 v[236:239], v[64:67], a[44:47], v[236:239]
  v_cvt_pk_bf16_f32 v32, v136, v137
  s_waitcnt lgkmcnt(0)
  v_mfma_f32_16x16x32_bf16 v[240:243], v[68:71], a[0:3], 0
  ds_read_b64_tr_b16 v[56:57], v8 offset:61440
  v_cvt_pk_bf16_f32 v33, v138, v139
  v_mfma_f32_16x16x32_bf16 v[240:243], v[72:75], a[16:19], v[240:243]
  ds_read_b64_tr_b16 v[58:59], v8 offset:63488
  v_mul_f32 v152, v152, v184
  v_mfma_f32_16x16x32_bf16 v[240:243], v[76:79], a[32:35], v[240:243]
  ds_read_b64_tr_b16 v[60:61], v9
  v_mul_f32 v153, v153, v185
  v_mfma_f32_16x16x32_bf16 v[244:247], v[68:71], a[4:7], 0
  ds_read_b64_tr_b16 v[62:63], v9 offset:2048
  v_mul_f32 v154, v154, v186
  v_mfma_f32_16x16x32_bf16 v[244:247], v[72:75], a[20:23], v[244:247]
  ds_read_b64_tr_b16 v[64:65], v9 offset:4096
  v_mul_f32 v155, v155, v187
  v_mfma_f32_16x16x32_bf16 v[244:247], v[76:79], a[36:39], v[244:247]
  ds_read_b64_tr_b16 v[66:67], v9 offset:6144
  v_cvt_pk_bf16_f32 v34, v152, v153
  v_mfma_f32_16x16x32_bf16 v[248:251], v[68:71], a[8:11], 0
  v_cvt_pk_bf16_f32 v35, v154, v155
  v_mfma_f32_16x16x32_bf16 v[248:251], v[72:75], a[24:27], v[248:251]
  ds_write_b128 v17, v[32:35] offset:18432
  v_mfma_f32_16x16x32_bf16 v[248:251], v[76:79], a[40:43], v[248:251]
  s_mov_b32 s61, 18432
  v_mfma_f32_16x16x32_bf16 v[252:255], v[68:71], a[12:15], 0
  buffer_store_dwordx4 v[32:35], v80, s[28:31], s61 offen sc1
  v_mfma_f32_16x16x32_bf16 v[252:255], v[72:75], a[28:31], v[252:255]
  v_mul_f32 v140, v140, v172
  v_mfma_f32_16x16x32_bf16 v[252:255], v[76:79], a[44:47], v[252:255]
  v_mul_f32 v141, v141, v173
  s_waitcnt lgkmcnt(1)
  v_mfma_f32_16x16x32_bf16 v[192:195], v[56:59], a[48:51], v[192:195]
  s_waitcnt vmcnt(11)
  s_barrier
  v_mfma_f32_16x16x32_bf16 v[192:195], v[60:63], a[64:67], v[192:195]
  ds_read_b64_tr_b16 v[68:69], v11 offset:61440
  s_mov_b32 s65, 13824
  v_mfma_f32_16x16x32_bf16 v[192:195], v[64:67], a[80:83], v[192:195]
  ds_read_b64_tr_b16 v[70:71], v11 offset:63488
  buffer_load_dword v31, v93, s[12:15], s65 offen
  v_mfma_f32_16x16x32_bf16 v[196:199], v[56:59], a[52:55], v[196:199]
  ds_read_b64_tr_b16 v[72:73], v12
  v_mul_f32 v142, v142, v174
  v_mfma_f32_16x16x32_bf16 v[196:199], v[60:63], a[68:71], v[196:199]
  ds_read_b64_tr_b16 v[74:75], v12 offset:2048
  v_mul_f32 v143, v143, v175
  v_mfma_f32_16x16x32_bf16 v[196:199], v[64:67], a[84:87], v[196:199]
  ds_read_b64_tr_b16 v[76:77], v12 offset:4096
  v_cvt_pk_bf16_f32 v36, v140, v141
  v_mfma_f32_16x16x32_bf16 v[200:203], v[56:59], a[56:59], v[200:203]
  ds_read_b64_tr_b16 v[78:79], v12 offset:6144
  v_cvt_pk_bf16_f32 v37, v142, v143
  v_mfma_f32_16x16x32_bf16 v[200:203], v[60:63], a[72:75], v[200:203]
  s_add_u32 m0, s33, 122880
  v_mul_f32 v156, v156, v188
  v_mfma_f32_16x16x32_bf16 v[200:203], v[64:67], a[88:91], v[200:203]
  s_mov_b32 s34, 2949504
  v_mul_f32 v157, v157, v189
  v_mfma_f32_16x16x32_bf16 v[204:207], v[56:59], a[60:63], v[204:207]
  buffer_load_dwordx4 v19, s[8:11], s34 offen lds
  v_mul_f32 v158, v158, v190
  v_mfma_f32_16x16x32_bf16 v[204:207], v[60:63], a[76:79], v[204:207]
  s_add_u32 m0, s33, 16384
  v_mul_f32 v159, v159, v191
  v_mfma_f32_16x16x32_bf16 v[204:207], v[64:67], a[92:95], v[204:207]
  s_mov_b32 s34, 3244416
  buffer_load_dwordx4 v19, s[8:11], s34 offen lds
  s_waitcnt lgkmcnt(0)
  v_mfma_f32_16x16x32_bf16 v[208:211], v[68:71], a[48:51], v[208:211]
  ds_read_b64_tr_b16 v[56:57], v9 offset:8192
  v_cvt_pk_bf16_f32 v38, v156, v157
  v_mfma_f32_16x16x32_bf16 v[208:211], v[72:75], a[64:67], v[208:211]
  ds_read_b64_tr_b16 v[58:59], v9 offset:10240
  v_cvt_pk_bf16_f32 v39, v158, v159
  v_mfma_f32_16x16x32_bf16 v[208:211], v[76:79], a[80:83], v[208:211]
  ds_read_b64_tr_b16 v[60:61], v9 offset:12288
  ds_write_b128 v17, v[36:39] offset:19456
  v_mfma_f32_16x16x32_bf16 v[212:215], v[68:71], a[52:55], v[212:215]
  ds_read_b64_tr_b16 v[62:63], v9 offset:14336
  s_mov_b32 s61, 19456
  v_mfma_f32_16x16x32_bf16 v[212:215], v[72:75], a[68:71], v[212:215]
  ds_read_b64_tr_b16 v[64:65], v8
  buffer_store_dwordx4 v[36:39], v80, s[28:31], s61 offen sc1
  v_mfma_f32_16x16x32_bf16 v[212:215], v[76:79], a[84:87], v[212:215]
  ds_read_b64_tr_b16 v[66:67], v8 offset:2048
  v_mfma_f32_16x16x32_bf16 v[216:219], v[68:71], a[56:59], v[216:219]
  v_mfma_f32_16x16x32_bf16 v[216:219], v[72:75], a[72:75], v[216:219]
  v_mfma_f32_16x16x32_bf16 v[216:219], v[76:79], a[88:91], v[216:219]
  v_mfma_f32_16x16x32_bf16 v[220:223], v[68:71], a[60:63], v[220:223]
  v_mfma_f32_16x16x32_bf16 v[220:223], v[72:75], a[76:79], v[220:223]
  v_mfma_f32_16x16x32_bf16 v[220:223], v[76:79], a[92:95], v[220:223]
  s_waitcnt lgkmcnt(0)
  v_mfma_f32_16x16x32_bf16 v[224:227], v[56:59], a[48:51], v[224:227]
  ds_read_b64_tr_b16 v[68:69], v12 offset:8192
  s_add_u32 s72, s90, 26648576
  s_addc_u32 s73, s91, 0
  v_mfma_f32_16x16x32_bf16 v[224:227], v[60:63], a[64:67], v[224:227]
  ds_read_b64_tr_b16 v[70:71], v12 offset:10240
  s_and_b32 s73, s73, 0xffff
  v_mfma_f32_16x16x32_bf16 v[224:227], v[64:67], a[80:83], v[224:227]
  ds_read_b64_tr_b16 v[72:73], v12 offset:12288
  s_mov_b32 s74, 18874368
  v_mfma_f32_16x16x32_bf16 v[228:231], v[56:59], a[52:55], v[228:231]
  ds_read_b64_tr_b16 v[74:75], v12 offset:14336
  s_mov_b32 s75, 0x20000
  v_mfma_f32_16x16x32_bf16 v[228:231], v[60:63], a[68:71], v[228:231]
  ds_read_b64_tr_b16 v[76:77], v11
  s_and_b32 s36, s94, 1
  v_mfma_f32_16x16x32_bf16 v[228:231], v[64:67], a[84:87], v[228:231]
  ds_read_b64_tr_b16 v[78:79], v11 offset:2048
  s_and_b32 s37, s92, 1
  v_mfma_f32_16x16x32_bf16 v[232:235], v[56:59], a[56:59], v[232:235]
  s_add_u32 m0, s33, 20480
  s_mul_i32 s38, s36, 10
  v_mfma_f32_16x16x32_bf16 v[232:235], v[60:63], a[72:75], v[232:235]
  s_mov_b32 s34, 3539328
  s_add_u32 s38, s38, s37
  v_mfma_f32_16x16x32_bf16 v[232:235], v[64:67], a[88:91], v[232:235]
  buffer_load_dwordx4 v19, s[4:7], s34 offen lds
  s_lshl_b32 s38, s38, 10
  v_mfma_f32_16x16x32_bf16 v[236:239], v[56:59], a[60:63], v[236:239]
  s_add_u32 m0, s33, 24576
  v_add_u32 v191, s38, v24
  v_mfma_f32_16x16x32_bf16 v[236:239], v[60:63], a[76:79], v[236:239]
  s_mov_b32 s34, 3834240
  s_lshl_b32 s36, s36, 1
  v_mfma_f32_16x16x32_bf16 v[236:239], v[64:67], a[92:95], v[236:239]
  buffer_load_dwordx4 v19, s[4:7], s34 offen lds
  s_waitcnt lgkmcnt(0)
  v_mfma_f32_16x16x32_bf16 v[240:243], v[68:71], a[48:51], v[240:243]
  ds_read_b64_tr_b16 v[56:57], v8 offset:4096
  s_add_u32 s36, s36, s37
  v_mfma_f32_16x16x32_bf16 v[240:243], v[72:75], a[64:67], v[240:243]
  ds_read_b64_tr_b16 v[58:59], v8 offset:6144
  s_add_u32 s36, s36, 16
  v_mfma_f32_16x16x32_bf16 v[240:243], v[76:79], a[80:83], v[240:243]
  ds_read_b64_tr_b16 v[60:61], v9 offset:16384
  s_lshl_b32 s36, s36, 9
  v_mfma_f32_16x16x32_bf16 v[244:247], v[68:71], a[52:55], v[244:247]
  ds_read_b64_tr_b16 v[62:63], v9 offset:18432
  v_lshrrev_b32 v4, 1, v24
  v_mfma_f32_16x16x32_bf16 v[244:247], v[72:75], a[68:71], v[244:247]
  ds_read_b64_tr_b16 v[64:65], v9 offset:20480
  v_add_u32 v3, s36, v4
  v_mfma_f32_16x16x32_bf16 v[244:247], v[76:79], a[84:87], v[244:247]
  ds_read_b64_tr_b16 v[66:67], v9 offset:22528
  s_lshl_b32 s36, s93, 4
  v_mfma_f32_16x16x32_bf16 v[248:251], v[68:71], a[56:59], v[248:251]
  s_add_u32 m0, s33, 28672
  s_add_u32 s36, s36, s94
  v_mfma_f32_16x16x32_bf16 v[248:251], v[72:75], a[72:75], v[248:251]
  s_mov_b32 s34, 4129152
  s_lshr_b32 s37, s36, 1
  v_mfma_f32_16x16x32_bf16 v[248:251], v[76:79], a[88:91], v[248:251]
  buffer_load_dwordx4 v19, s[4:7], s34 offen lds
  s_mul_i32 s37, s37, 18432
  v_mfma_f32_16x16x32_bf16 v[252:255], v[68:71], a[60:63], v[252:255]
  s_and_b32 s38, s36, 1
  v_mfma_f32_16x16x32_bf16 v[252:255], v[72:75], a[76:79], v[252:255]
  s_lshl_b32 s38, s38, 7
  v_mfma_f32_16x16x32_bf16 v[252:255], v[76:79], a[92:95], v[252:255]
  s_add_u32 s39, s37, s38
  s_waitcnt lgkmcnt(0)
  v_mfma_f32_16x16x32_bf16 v[192:195], v[56:59], a[96:99], v[192:195]
  s_waitcnt vmcnt(11)
  s_barrier
  v_mfma_f32_16x16x32_bf16 v[192:195], v[60:63], a[112:115], v[192:195]
  ds_read_b64_tr_b16 v[68:69], v11 offset:4096
  s_lshl_b32 s38, s92, 9
  v_mfma_f32_16x16x32_bf16 v[192:195], v[64:67], a[128:131], v[192:195]
  ds_read_b64_tr_b16 v[70:71], v11 offset:6144
  s_add_u32 s39, s39, s38
  v_mfma_f32_16x16x32_bf16 v[196:199], v[56:59], a[100:103], v[196:199]
  ds_read_b64_tr_b16 v[72:73], v12 offset:16384
  v_and_b32 v4, 7, v0
  v_mfma_f32_16x16x32_bf16 v[196:199], v[60:63], a[116:119], v[196:199]
  ds_read_b64_tr_b16 v[74:75], v12 offset:18432
  v_bfe_u32 v6, v0, 3, 1
  v_mfma_f32_16x16x32_bf16 v[196:199], v[64:67], a[132:135], v[196:199]
  ds_read_b64_tr_b16 v[76:77], v12 offset:20480
  v_lshlrev_b32 v4, 4, v4
  v_mfma_f32_16x16x32_bf16 v[200:203], v[56:59], a[104:107], v[200:203]
  ds_read_b64_tr_b16 v[78:79], v12 offset:22528
  v_lshl_add_u32 v4, v6, 8, v4
  v_mfma_f32_16x16x32_bf16 v[200:203], v[60:63], a[120:123], v[200:203]
  s_add_u32 m0, s33, 32768
  v_add_u32 v4, s39, v4
  v_mfma_f32_16x16x32_bf16 v[200:203], v[64:67], a[136:139], v[200:203]
  s_mov_b32 s34, 3539328
  v_subrev_u32 v189, s37, v4
  v_mfma_f32_16x16x32_bf16 v[204:207], v[56:59], a[108:111], v[204:207]
  buffer_load_dwordx4 v19, s[8:11], s34 offen lds
  v_and_b32 v189, 1023, v189
  v_mfma_f32_16x16x32_bf16 v[204:207], v[60:63], a[124:127], v[204:207]
  s_add_u32 m0, s33, 36864
  v_lshrrev_b32 v189, 1, v189
  v_mfma_f32_16x16x32_bf16 v[204:207], v[64:67], a[140:143], v[204:207]
  s_mov_b32 s34, 3834240
  buffer_load_dwordx4 v19, s[8:11], s34 offen lds
  s_waitcnt lgkmcnt(0)
  v_mfma_f32_16x16x32_bf16 v[208:211], v[68:71], a[96:99], v[208:211]
  ds_read_b64_tr_b16 v[56:57], v10 offset:20480
  s_lshr_b32 s38, s92, 1
  v_mfma_f32_16x16x32_bf16 v[208:211], v[72:75], a[112:115], v[208:211]
  ds_read_b64_tr_b16 v[58:59], v10 offset:22528
  s_lshl_b32 s38, s38, 10
  v_mfma_f32_16x16x32_bf16 v[208:211], v[76:79], a[128:131], v[208:211]
  ds_read_b64_tr_b16 v[60:61], v10 offset:24576
  s_add_u32 s38, s38, s37
  v_mfma_f32_16x16x32_bf16 v[212:215], v[68:71], a[100:103], v[212:215]
  ds_read_b64_tr_b16 v[62:63], v10 offset:26624
  v_add_u32 v189, s38, v189
  v_mfma_f32_16x16x32_bf16 v[212:215], v[72:75], a[116:119], v[212:215]
  ds_read_b64_tr_b16 v[64:65], v10 offset:28672
  v_bfe_u32 v2, v0, 4, 2
  v_mfma_f32_16x16x32_bf16 v[212:215], v[76:79], a[132:135], v[212:215]
  ds_read_b64_tr_b16 v[66:67], v10 offset:30720
  s_mov_b32 s38, 2359296
  v_mfma_f32_16x16x32_bf16 v[216:219], v[68:71], a[104:107], v[216:219]
  s_add_u32 m0, s33, 40960
  v_mul_lo_u32 v5, v2, s38
  v_mfma_f32_16x16x32_bf16 v[216:219], v[72:75], a[120:123], v[216:219]
  s_mov_b32 s34, 4129152
  v_add_u32 v188, v4, v5
  v_mfma_f32_16x16x32_bf16 v[216:219], v[76:79], a[136:139], v[216:219]
  buffer_load_dwordx4 v19, s[8:11], s34 offen lds
  v_add_u32 v189, v189, v5
  v_mfma_f32_16x16x32_bf16 v[220:223], v[68:71], a[108:111], v[220:223]
  v_and_b32 v4, 1, v0
  v_mfma_f32_16x16x32_bf16 v[220:223], v[72:75], a[124:127], v[220:223]
  v_lshlrev_b32 v4, 4, v4
  v_mfma_f32_16x16x32_bf16 v[220:223], v[76:79], a[140:143], v[220:223]
  v_mov_b32 v5, 0x3f80
  s_waitcnt lgkmcnt(0)
  v_mfma_f32_16x16x32_bf16 v[224:227], v[56:59], a[96:99], v[224:227]
  ds_read_b64_tr_b16 v[68:69], v13 offset:20480
  v_lshlrev_b32 v4, v4, v5
  v_mfma_f32_16x16x32_bf16 v[224:227], v[60:63], a[112:115], v[224:227]
  ds_read_b64_tr_b16 v[70:71], v13 offset:22528
  v_bfe_u32 v5, v0, 1, 3
  v_mfma_f32_16x16x32_bf16 v[224:227], v[64:67], a[128:131], v[224:227]
  ds_read_b64_tr_b16 v[72:73], v13 offset:24576
  v_cmp_eq_u32 vcc, 0, v5
  v_mfma_f32_16x16x32_bf16 v[228:231], v[56:59], a[100:103], v[228:231]
  ds_read_b64_tr_b16 v[74:75], v13 offset:26624
  v_cndmask_b32 v180, 0, v4, vcc
  v_mfma_f32_16x16x32_bf16 v[228:231], v[60:63], a[116:119], v[228:231]
  ds_read_b64_tr_b16 v[76:77], v13 offset:28672
  v_cmp_eq_u32 vcc, 2, v5
  v_mfma_f32_16x16x32_bf16 v[228:231], v[64:67], a[132:135], v[228:231]
  ds_read_b64_tr_b16 v[78:79], v13 offset:30720
  v_cndmask_b32 v181, 0, v4, vcc
  v_mfma_f32_16x16x32_bf16 v[232:235], v[56:59], a[104:107], v[232:235]
  s_add_u32 m0, s33, 45056
  v_cmp_eq_u32 vcc, 4, v5
  v_mfma_f32_16x16x32_bf16 v[232:235], v[60:63], a[120:123], v[232:235]
  s_mov_b32 s34, 4424064
  v_cndmask_b32 v182, 0, v4, vcc
  v_mfma_f32_16x16x32_bf16 v[232:235], v[64:67], a[136:139], v[232:235]
  buffer_load_dwordx4 v19, s[4:7], s34 offen lds
  v_cmp_eq_u32 vcc, 6, v5
  v_mfma_f32_16x16x32_bf16 v[236:239], v[56:59], a[108:111], v[236:239]
  s_add_u32 m0, s33, 49152
  v_cndmask_b32 v183, 0, v4, vcc
  v_mfma_f32_16x16x32_bf16 v[236:239], v[60:63], a[124:127], v[236:239]
  s_mov_b32 s34, 4718976
  v_cmp_eq_u32 vcc, 1, v5
  v_mfma_f32_16x16x32_bf16 v[236:239], v[64:67], a[140:143], v[236:239]
  buffer_load_dwordx4 v19, s[4:7], s34 offen lds
  s_waitcnt lgkmcnt(0)
  v_mfma_f32_16x16x32_bf16 v[240:243], v[68:71], a[96:99], v[240:243]
  ds_read_b64_tr_b16 v[56:57], v8 offset:8192
  v_cndmask_b32 v184, 0, v4, vcc
  v_mfma_f32_16x16x32_bf16 v[240:243], v[72:75], a[112:115], v[240:243]
  ds_read_b64_tr_b16 v[58:59], v8 offset:10240
  v_cmp_eq_u32 vcc, 3, v5
  v_mfma_f32_16x16x32_bf16 v[240:243], v[76:79], a[128:131], v[240:243]
  ds_read_b64_tr_b16 v[60:61], v8 offset:12288
  v_cndmask_b32 v185, 0, v4, vcc
  v_mfma_f32_16x16x32_bf16 v[244:247], v[68:71], a[100:103], v[244:247]
  ds_read_b64_tr_b16 v[62:63], v8 offset:14336
  v_cmp_eq_u32 vcc, 5, v5
  v_mfma_f32_16x16x32_bf16 v[244:247], v[72:75], a[116:119], v[244:247]
  ds_read_b64_tr_b16 v[64:65], v9 offset:49152
  v_cndmask_b32 v186, 0, v4, vcc
  v_mfma_f32_16x16x32_bf16 v[244:247], v[76:79], a[132:135], v[244:247]
  ds_read_b64_tr_b16 v[66:67], v9 offset:51200
  v_cmp_eq_u32 vcc, 7, v5
  v_mfma_f32_16x16x32_bf16 v[248:251], v[68:71], a[104:107], v[248:251]
  s_add_u32 m0, s33, 53248
  v_cndmask_b32 v187, 0, v4, vcc
  v_mfma_f32_16x16x32_bf16 v[248:251], v[72:75], a[120:123], v[248:251]
  s_mov_b32 s34, 5013888
  s_add_u32 s44, s86, 0
  s_addc_u32 s45, s87, 0
  v_mfma_f32_16x16x32_bf16 v[248:251], v[76:79], a[136:139], v[248:251]
  buffer_load_dwordx4 v19, s[4:7], s34 offen lds
  s_and_b32 s45, s45, 0xffff
  v_mfma_f32_16x16x32_bf16 v[252:255], v[68:71], a[108:111], v[252:255]
  s_mov_b32 s46, 2064384
  v_mfma_f32_16x16x32_bf16 v[252:255], v[72:75], a[124:127], v[252:255]
  s_mov_b32 s47, 0x20000
  v_mfma_f32_16x16x32_bf16 v[252:255], v[76:79], a[140:143], v[252:255]
  s_cmp_eq_u32 s95, 0
  s_cselect_b32 s46, s46, 0
  s_waitcnt lgkmcnt(0)
  v_mfma_f32_16x16x32_bf16 v[192:195], v[56:59], a[144:147], v[192:195]
  s_waitcnt vmcnt(6)
  s_barrier
  v_mfma_f32_16x16x32_bf16 v[192:195], v[60:63], a[160:163], v[192:195]
  ds_read_b64_tr_b16 v[68:69], v11 offset:8192
  s_mul_i32 s36, s94, 129024
  v_mfma_f32_16x16x32_bf16 v[192:195], v[64:67], a[176:179], v[192:195]
  ds_read_b64_tr_b16 v[70:71], v11 offset:10240
  s_lshl_b32 s101, s92, 12
  v_mfma_f32_16x16x32_bf16 v[196:199], v[56:59], a[148:151], v[196:199]
  ds_read_b64_tr_b16 v[72:73], v11 offset:12288
  s_add_u32 s36, s36, s101
  v_mfma_f32_16x16x32_bf16 v[196:199], v[60:63], a[164:167], v[196:199]
  ds_read_b64_tr_b16 v[74:75], v11 offset:14336
  v_and_b32 v94, 63, v0
  v_mfma_f32_16x16x32_bf16 v[196:199], v[64:67], a[180:183], v[196:199]
  ds_read_b64_tr_b16 v[76:77], v12 offset:49152
  v_lshlrev_b32 v94, 4, v94
  v_mfma_f32_16x16x32_bf16 v[200:203], v[56:59], a[152:155], v[200:203]
  ds_read_b64_tr_b16 v[78:79], v12 offset:51200
  v_add_u32 v94, s36, v94
  v_mfma_f32_16x16x32_bf16 v[200:203], v[60:63], a[168:171], v[200:203]
  s_add_u32 m0, s33, 57344
  v_mfma_f32_16x16x32_bf16 v[200:203], v[64:67], a[184:187], v[200:203]
  s_mov_b32 s34, 4424064
  v_mfma_f32_16x16x32_bf16 v[204:207], v[56:59], a[156:159], v[204:207]
  buffer_load_dwordx4 v19, s[8:11], s34 offen lds
  v_mfma_f32_16x16x32_bf16 v[204:207], v[60:63], a[172:175], v[204:207]
  s_add_u32 m0, s33, 61440
  v_mfma_f32_16x16x32_bf16 v[204:207], v[64:67], a[188:191], v[204:207]
  s_mov_b32 s34, 4718976
  buffer_load_dwordx4 v19, s[8:11], s34 offen lds
  s_waitcnt lgkmcnt(0)
  v_mfma_f32_16x16x32_bf16 v[208:211], v[68:71], a[144:147], v[208:211]
  ds_read_b64_tr_b16 v[56:57], v9 offset:53248
  v_mfma_f32_16x16x32_bf16 v[208:211], v[72:75], a[160:163], v[208:211]
  ds_read_b64_tr_b16 v[58:59], v9 offset:55296
  v_mfma_f32_16x16x32_bf16 v[208:211], v[76:79], a[176:179], v[208:211]
  ds_read_b64_tr_b16 v[60:61], v9 offset:57344
  v_mfma_f32_16x16x32_bf16 v[212:215], v[68:71], a[148:151], v[212:215]
  ds_read_b64_tr_b16 v[62:63], v9 offset:59392
  v_mfma_f32_16x16x32_bf16 v[212:215], v[72:75], a[164:167], v[212:215]
  ds_read_b64_tr_b16 v[64:65], v8 offset:16384
  v_mfma_f32_16x16x32_bf16 v[212:215], v[76:79], a[180:183], v[212:215]
  ds_read_b64_tr_b16 v[66:67], v8 offset:18432
  v_mfma_f32_16x16x32_bf16 v[216:219], v[68:71], a[152:155], v[216:219]
  s_add_u32 m0, s33, 65536
  v_mfma_f32_16x16x32_bf16 v[216:219], v[72:75], a[168:171], v[216:219]
  s_mov_b32 s34, 5013888
  v_mfma_f32_16x16x32_bf16 v[216:219], v[76:79], a[184:187], v[216:219]
  buffer_load_dwordx4 v19, s[8:11], s34 offen lds
  v_mfma_f32_16x16x32_bf16 v[220:223], v[68:71], a[156:159], v[220:223]
  v_mfma_f32_16x16x32_bf16 v[220:223], v[72:75], a[172:175], v[220:223]
  v_mfma_f32_16x16x32_bf16 v[220:223], v[76:79], a[188:191], v[220:223]
  s_waitcnt lgkmcnt(0)
  v_mfma_f32_16x16x32_bf16 v[224:227], v[56:59], a[144:147], v[224:227]
  ds_read_b64_tr_b16 v[68:69], v12 offset:53248
  v_mfma_f32_16x16x32_bf16 v[224:227], v[60:63], a[160:163], v[224:227]
  ds_read_b64_tr_b16 v[70:71], v12 offset:55296
  v_mfma_f32_16x16x32_bf16 v[224:227], v[64:67], a[176:179], v[224:227]
  ds_read_b64_tr_b16 v[72:73], v12 offset:57344
  v_mfma_f32_16x16x32_bf16 v[228:231], v[56:59], a[148:151], v[228:231]
  ds_read_b64_tr_b16 v[74:75], v12 offset:59392
  v_mfma_f32_16x16x32_bf16 v[228:231], v[60:63], a[164:167], v[228:231]
  ds_read_b64_tr_b16 v[76:77], v11 offset:16384
  v_mfma_f32_16x16x32_bf16 v[228:231], v[64:67], a[180:183], v[228:231]
  ds_read_b64_tr_b16 v[78:79], v11 offset:18432
  v_mfma_f32_16x16x32_bf16 v[232:235], v[56:59], a[152:155], v[232:235]
  s_add_u32 m0, s33, 69632
  v_mfma_f32_16x16x32_bf16 v[232:235], v[60:63], a[168:171], v[232:235]
  s_mov_b32 s34, 0
  v_mfma_f32_16x16x32_bf16 v[232:235], v[64:67], a[184:187], v[232:235]
  buffer_load_dwordx4 v20, s[24:27], s34 offen lds
  v_mfma_f32_16x16x32_bf16 v[236:239], v[56:59], a[156:159], v[236:239]
  s_add_u32 m0, s33, 73728
  v_mfma_f32_16x16x32_bf16 v[236:239], v[60:63], a[172:175], v[236:239]
  s_mov_b32 s34, 294912
  v_mfma_f32_16x16x32_bf16 v[236:239], v[64:67], a[188:191], v[236:239]
  buffer_load_dwordx4 v20, s[24:27], s34 offen lds
  s_waitcnt lgkmcnt(0)
  v_mfma_f32_16x16x32_bf16 v[240:243], v[68:71], a[144:147], v[240:243]
  ds_read_b64_tr_b16 v[56:57], v8 offset:20480
  v_mfma_f32_16x16x32_bf16 v[240:243], v[72:75], a[160:163], v[240:243]
  ds_read_b64_tr_b16 v[58:59], v8 offset:22528
  v_mfma_f32_16x16x32_bf16 v[240:243], v[76:79], a[176:179], v[240:243]
  ds_read_b64_tr_b16 v[60:61], v8 offset:24576
  v_mfma_f32_16x16x32_bf16 v[244:247], v[68:71], a[148:151], v[244:247]
  ds_read_b64_tr_b16 v[62:63], v8 offset:26624
  v_mfma_f32_16x16x32_bf16 v[244:247], v[72:75], a[164:167], v[244:247]
  ds_read_b64_tr_b16 v[64:65], v8 offset:28672
  v_mfma_f32_16x16x32_bf16 v[244:247], v[76:79], a[180:183], v[244:247]
  ds_read_b64_tr_b16 v[66:67], v8 offset:30720
  v_mfma_f32_16x16x32_bf16 v[248:251], v[68:71], a[152:155], v[248:251]
  s_add_u32 m0, s33, 77824
  v_mfma_f32_16x16x32_bf16 v[248:251], v[72:75], a[168:171], v[248:251]
  s_mov_b32 s34, 589824
  v_mfma_f32_16x16x32_bf16 v[248:251], v[76:79], a[184:187], v[248:251]
  buffer_load_dwordx4 v20, s[24:27], s34 offen lds
  v_mfma_f32_16x16x32_bf16 v[252:255], v[68:71], a[156:159], v[252:255]
  v_mfma_f32_16x16x32_bf16 v[252:255], v[72:75], a[172:175], v[252:255]
  v_mfma_f32_16x16x32_bf16 v[252:255], v[76:79], a[188:191], v[252:255]
  s_waitcnt lgkmcnt(0)
  v_mfma_f32_16x16x32_bf16 v[192:195], v[56:59], a[192:195], v[192:195]
  s_waitcnt vmcnt(6)
  s_barrier
  s_mov_b32 s63, 131072
  buffer_store_dword v7, v29, s[96:99], s63 offen sc1
  v_mfma_f32_16x16x32_bf16 v[192:195], v[60:63], a[208:211], v[192:195]
  ds_read_b64_tr_b16 v[68:69], v11 offset:20480
  v_mfma_f32_16x16x32_bf16 v[192:195], v[64:67], a[224:227], v[192:195]
  ds_read_b64_tr_b16 v[70:71], v11 offset:22528
  v_mfma_f32_16x16x32_bf16 v[196:199], v[56:59], a[196:199], v[196:199]
  ds_read_b64_tr_b16 v[72:73], v11 offset:24576
  v_mfma_f32_16x16x32_bf16 v[196:199], v[60:63], a[212:215], v[196:199]
  ds_read_b64_tr_b16 v[74:75], v11 offset:26624
  v_mfma_f32_16x16x32_bf16 v[196:199], v[64:67], a[228:231], v[196:199]
  ds_read_b64_tr_b16 v[76:77], v11 offset:28672
  v_mfma_f32_16x16x32_bf16 v[200:203], v[56:59], a[200:203], v[200:203]
  ds_read_b64_tr_b16 v[78:79], v11 offset:30720
  v_mfma_f32_16x16x32_bf16 v[200:203], v[60:63], a[216:219], v[200:203]
  s_add_u32 m0, s33, 0
  v_mfma_f32_16x16x32_bf16 v[200:203], v[64:67], a[232:235], v[200:203]
  s_mov_b32 s34, 884736
  v_mfma_f32_16x16x32_bf16 v[204:207], v[56:59], a[204:207], v[204:207]
  buffer_load_dwordx4 v20, s[24:27], s34 offen lds
  v_mfma_f32_16x16x32_bf16 v[204:207], v[60:63], a[220:223], v[204:207]
  s_add_u32 m0, s33, 4096
  v_mfma_f32_16x16x32_bf16 v[204:207], v[64:67], a[236:239], v[204:207]
  s_mov_b32 s34, 1179648
  buffer_load_dwordx4 v20, s[24:27], s34 offen lds
  s_waitcnt lgkmcnt(0)
  v_mfma_f32_16x16x32_bf16 v[208:211], v[68:71], a[192:195], v[208:211]
  ds_read_b64_tr_b16 v[56:57], v8 offset:32768
  v_mfma_f32_16x16x32_bf16 v[208:211], v[72:75], a[208:211], v[208:211]
  ds_read_b64_tr_b16 v[58:59], v8 offset:34816
  v_mfma_f32_16x16x32_bf16 v[208:211], v[76:79], a[224:227], v[208:211]
  ds_read_b64_tr_b16 v[60:61], v8 offset:36864
  v_mfma_f32_16x16x32_bf16 v[212:215], v[68:71], a[196:199], v[212:215]
  ds_read_b64_tr_b16 v[62:63], v8 offset:38912
  v_mfma_f32_16x16x32_bf16 v[212:215], v[72:75], a[212:215], v[212:215]
  ds_read_b64_tr_b16 v[64:65], v8 offset:40960
  v_mfma_f32_16x16x32_bf16 v[212:215], v[76:79], a[228:231], v[212:215]
  ds_read_b64_tr_b16 v[66:67], v8 offset:43008
  v_mfma_f32_16x16x32_bf16 v[216:219], v[68:71], a[200:203], v[216:219]
  s_add_u32 m0, s33, 81920
  v_mfma_f32_16x16x32_bf16 v[216:219], v[72:75], a[216:219], v[216:219]
  s_mov_b32 s34, 1474560
  v_mfma_f32_16x16x32_bf16 v[216:219], v[76:79], a[232:235], v[216:219]
  buffer_load_dwordx4 v20, s[24:27], s34 offen lds
  v_mfma_f32_16x16x32_bf16 v[220:223], v[68:71], a[204:207], v[220:223]
  v_mfma_f32_16x16x32_bf16 v[220:223], v[72:75], a[220:223], v[220:223]
  v_mfma_f32_16x16x32_bf16 v[220:223], v[76:79], a[236:239], v[220:223]
  s_waitcnt lgkmcnt(0)
  v_mfma_f32_16x16x32_bf16 v[224:227], v[56:59], a[192:195], v[224:227]
  ds_read_b64_tr_b16 v[68:69], v11 offset:32768
  v_mfma_f32_16x16x32_bf16 v[224:227], v[60:63], a[208:211], v[224:227]
  ds_read_b64_tr_b16 v[70:71], v11 offset:34816
  s_mov_b32 s63, 131072
  buffer_load_dword v31, v91, s[96:99], s63 offen sc1
  v_mfma_f32_16x16x32_bf16 v[224:227], v[64:67], a[224:227], v[224:227]
  ds_read_b64_tr_b16 v[72:73], v11 offset:36864
  v_mfma_f32_16x16x32_bf16 v[228:231], v[56:59], a[196:199], v[228:231]
  ds_read_b64_tr_b16 v[74:75], v11 offset:38912
  v_mfma_f32_16x16x32_bf16 v[228:231], v[60:63], a[212:215], v[228:231]
  ds_read_b64_tr_b16 v[76:77], v11 offset:40960
  v_mfma_f32_16x16x32_bf16 v[228:231], v[64:67], a[228:231], v[228:231]
  ds_read_b64_tr_b16 v[78:79], v11 offset:43008
  v_mfma_f32_16x16x32_bf16 v[232:235], v[56:59], a[200:203], v[232:235]
  s_add_u32 m0, s33, 86016
  v_mfma_f32_16x16x32_bf16 v[232:235], v[60:63], a[216:219], v[232:235]
  s_mov_b32 s34, 1769472
  v_mfma_f32_16x16x32_bf16 v[232:235], v[64:67], a[232:235], v[232:235]
  buffer_load_dwordx4 v20, s[24:27], s34 offen lds
  v_mfma_f32_16x16x32_bf16 v[236:239], v[56:59], a[204:207], v[236:239]
  s_add_u32 m0, s33, 159744
  v_mfma_f32_16x16x32_bf16 v[236:239], v[60:63], a[220:223], v[236:239]
  s_mov_b32 s34, 2064384
  v_mfma_f32_16x16x32_bf16 v[236:239], v[64:67], a[236:239], v[236:239]
  buffer_load_dwordx4 v20, s[24:27], s34 offen lds
  s_waitcnt lgkmcnt(0)
  v_mfma_f32_16x16x32_bf16 v[240:243], v[68:71], a[192:195], v[240:243]
  ds_read_b64_tr_b16 v[56:57], v8 offset:45056
  v_mfma_f32_16x16x32_bf16 v[240:243], v[72:75], a[208:211], v[240:243]
  ds_read_b64_tr_b16 v[58:59], v8 offset:47104
  v_mfma_f32_16x16x32_bf16 v[240:243], v[76:79], a[224:227], v[240:243]
  ds_read_b64_tr_b16 v[60:61], v8 offset:49152
  v_mfma_f32_16x16x32_bf16 v[244:247], v[68:71], a[196:199], v[244:247]
  ds_read_b64_tr_b16 v[62:63], v8 offset:51200
  v_mfma_f32_16x16x32_bf16 v[244:247], v[72:75], a[212:215], v[244:247]
  ds_read_b64_tr_b16 v[64:65], v8 offset:53248
  v_mfma_f32_16x16x32_bf16 v[244:247], v[76:79], a[228:231], v[244:247]
  ds_read_b64_tr_b16 v[66:67], v8 offset:55296
  v_mfma_f32_16x16x32_bf16 v[248:251], v[68:71], a[200:203], v[248:251]
  s_add_u32 m0, s33, 8192
  v_mfma_f32_16x16x32_bf16 v[248:251], v[72:75], a[216:219], v[248:251]
  s_mov_b32 s34, 2359296
  v_mfma_f32_16x16x32_bf16 v[248:251], v[76:79], a[232:235], v[248:251]
  buffer_load_dwordx4 v20, s[24:27], s34 offen lds
  v_mfma_f32_16x16x32_bf16 v[252:255], v[68:71], a[204:207], v[252:255]
  v_mfma_f32_16x16x32_bf16 v[252:255], v[72:75], a[220:223], v[252:255]
  v_mfma_f32_16x16x32_bf16 v[252:255], v[76:79], a[236:239], v[252:255]
  s_waitcnt lgkmcnt(0)
  v_mfma_f32_16x16x32_bf16 v[192:195], v[56:59], a[240:243], v[192:195]
  s_waitcnt vmcnt(8)
  s_barrier
  v_mfma_f32_16x16x32_bf16 v[192:195], v[60:63], v[96:99], v[192:195]
  ds_read_b64_tr_b16 v[68:69], v11 offset:45056
  s_add_u32 m0, s33, 12288
  v_mfma_f32_16x16x32_bf16 v[192:195], v[64:67], v[112:115], v[192:195]
  ds_read_b64_tr_b16 v[70:71], v11 offset:47104
  s_mov_b32 s34, 2654208
  v_mfma_f32_16x16x32_bf16 v[196:199], v[56:59], a[244:247], v[196:199]
  ds_read_b64_tr_b16 v[72:73], v11 offset:49152
  buffer_load_dwordx4 v20, s[24:27], s34 offen lds
  v_mfma_f32_16x16x32_bf16 v[196:199], v[60:63], v[100:103], v[196:199]
  ds_read_b64_tr_b16 v[74:75], v11 offset:51200
  s_add_u32 m0, s33, 122880
  v_mfma_f32_16x16x32_bf16 v[196:199], v[64:67], v[116:119], v[196:199]
  ds_read_b64_tr_b16 v[76:77], v11 offset:53248
  s_mov_b32 s34, 2949120
  v_mfma_f32_16x16x32_bf16 v[200:203], v[56:59], a[248:251], v[200:203]
  ds_read_b64_tr_b16 v[78:79], v11 offset:55296
  buffer_load_dwordx4 v20, s[24:27], s34 offen lds
  v_mfma_f32_16x16x32_bf16 v[200:203], v[60:63], v[104:107], v[200:203]
  s_add_u32 m0, s33, 16384
  v_mfma_f32_16x16x32_bf16 v[200:203], v[64:67], v[120:123], v[200:203]
  s_mov_b32 s34, 3244032
  v_mfma_f32_16x16x32_bf16 v[204:207], v[56:59], a[252:255], v[204:207]
  buffer_load_dwordx4 v20, s[24:27], s34 offen lds
  v_mfma_f32_16x16x32_bf16 v[204:207], v[60:63], v[108:111], v[204:207]
  v_mfma_f32_16x16x32_bf16 v[204:207], v[64:67], v[124:127], v[204:207]
  s_waitcnt lgkmcnt(0)
  v_mfma_f32_16x16x32_bf16 v[208:211], v[68:71], a[240:243], v[208:211]
  ds_read_b64_tr_b16 v[56:57], v8 offset:57344
  v_mfma_f32_16x16x32_bf16 v[208:211], v[72:75], v[96:99], v[208:211]
  ds_read_b64_tr_b16 v[58:59], v8 offset:59392
  s_waitcnt vmcnt(6)
  v_cmp_ne_u32 vcc, v7, v31
  s_cbranch_vccnz L_sp_22
L_bk_23:
  v_mfma_f32_16x16x32_bf16 v[208:211], v[76:79], v[112:115], v[208:211]
  ds_read_b64_tr_b16 v[60:61], v8 offset:61440
  v_mfma_f32_16x16x32_bf16 v[212:215], v[68:71], a[244:247], v[212:215]
  ds_read_b64_tr_b16 v[62:63], v8 offset:63488
  v_mfma_f32_16x16x32_bf16 v[212:215], v[72:75], v[100:103], v[212:215]
  ds_read_b64_tr_b16 v[64:65], v9
  v_mfma_f32_16x16x32_bf16 v[212:215], v[76:79], v[116:119], v[212:215]
  ds_read_b64_tr_b16 v[66:67], v9 offset:2048
  v_mfma_f32_16x16x32_bf16 v[216:219], v[68:71], a[248:251], v[216:219]
  v_mfma_f32_16x16x32_bf16 v[216:219], v[72:75], v[104:107], v[216:219]
  v_mfma_f32_16x16x32_bf16 v[216:219], v[76:79], v[120:123], v[216:219]
  v_mfma_f32_16x16x32_bf16 v[220:223], v[68:71], a[252:255], v[220:223]
  v_mfma_f32_16x16x32_bf16 v[220:223], v[72:75], v[108:111], v[220:223]
  v_mfma_f32_16x16x32_bf16 v[220:223], v[76:79], v[124:127], v[220:223]
  s_waitcnt lgkmcnt(0)
  v_mfma_f32_16x16x32_bf16 v[224:227], v[56:59], a[240:243], v[224:227]
  ds_read_b64_tr_b16 v[68:69], v11 offset:57344
  v_mfma_f32_16x16x32_bf16 v[224:227], v[60:63], v[96:99], v[224:227]
  ds_read_b64_tr_b16 v[70:71], v11 offset:59392
  v_mfma_f32_16x16x32_bf16 v[224:227], v[64:67], v[112:115], v[224:227]
  ds_read_b64_tr_b16 v[72:73], v11 offset:61440
  v_mfma_f32_16x16x32_bf16 v[228:231], v[56:59], a[244:247], v[228:231]
  ds_read_b64_tr_b16 v[74:75], v11 offset:63488
  v_mfma_f32_16x16x32_bf16 v[228:231], v[60:63], v[100:103], v[228:231]
  ds_read_b64_tr_b16 v[76:77], v12
  v_mfma_f32_16x16x32_bf16 v[228:231], v[64:67], v[116:119], v[228:231]
  ds_read_b64_tr_b16 v[78:79], v12 offset:2048
  v_mfma_f32_16x16x32_bf16 v[232:235], v[56:59], a[248:251], v[232:235]
  v_mfma_f32_16x16x32_bf16 v[232:235], v[60:63], v[104:107], v[232:235]
  v_mfma_f32_16x16x32_bf16 v[232:235], v[64:67], v[120:123], v[232:235]
  v_mfma_f32_16x16x32_bf16 v[236:239], v[56:59], a[252:255], v[236:239]
  v_mfma_f32_16x16x32_bf16 v[236:239], v[60:63], v[108:111], v[236:239]
  v_mfma_f32_16x16x32_bf16 v[236:239], v[64:67], v[124:127], v[236:239]
  s_waitcnt lgkmcnt(0)
  v_mfma_f32_16x16x32_bf16 v[240:243], v[68:71], a[240:243], v[240:243]
  ds_read_b64_tr_b16 v[56:57], v15 offset:4096
  v_mfma_f32_16x16x32_bf16 v[240:243], v[72:75], v[96:99], v[240:243]
  ds_read_b64_tr_b16 v[58:59], v15 offset:5120
  v_mfma_f32_16x16x32_bf16 v[240:243], v[76:79], v[112:115], v[240:243]
  ds_read_b64_tr_b16 v[60:61], v15 offset:8192
  v_mfma_f32_16x16x32_bf16 v[244:247], v[68:71], a[244:247], v[244:247]
  ds_read_b64_tr_b16 v[62:63], v15 offset:9216
  v_mfma_f32_16x16x32_bf16 v[244:247], v[72:75], v[100:103], v[244:247]
  ds_read_b64_tr_b16 v[64:65], v15 offset:12288
  v_mfma_f32_16x16x32_bf16 v[244:247], v[76:79], v[116:119], v[244:247]
  ds_read_b64_tr_b16 v[66:67], v15 offset:13312
  v_mfma_f32_16x16x32_bf16 v[248:251], v[68:71], a[248:251], v[248:251]
  s_add_u32 m0, s33, 20480
  v_mfma_f32_16x16x32_bf16 v[248:251], v[72:75], v[104:107], v[248:251]
  s_mov_b32 s34, 0
  v_mfma_f32_16x16x32_bf16 v[248:251], v[76:79], v[120:123], v[248:251]
  buffer_load_dwordx4 v88, s[68:71], s34 offen sc1 lds
  v_mfma_f32_16x16x32_bf16 v[252:255], v[68:71], a[252:255], v[252:255]
  s_add_u32 m0, s33, 24576
  v_mfma_f32_16x16x32_bf16 v[252:255], v[72:75], v[108:111], v[252:255]
  s_mov_b32 s34, 2048
  v_mfma_f32_16x16x32_bf16 v[252:255], v[76:79], v[124:127], v[252:255]
  buffer_load_dwordx4 v88, s[68:71], s34 offen sc1 lds
  s_waitcnt lgkmcnt(0)
  v_mfma_f32_16x16x32_bf16 v[128:131], v[56:59], a[0:3], 0
  s_barrier
  v_mfma_f32_16x16x32_bf16 v[128:131], v[60:63], a[16:19], v[128:131]
  ds_read_b64_tr_b16 v[68:69], v15 offset:6144
  v_mul_f32 v192, v192, v224
  v_mul_f32 v193, v193, v225
  v_mfma_f32_16x16x32_bf16 v[128:131], v[64:67], a[32:35], v[128:131]
  ds_read_b64_tr_b16 v[70:71], v15 offset:7168
  v_mul_f32 v194, v194, v226
  v_mul_f32 v195, v195, v227
  v_mfma_f32_16x16x32_bf16 v[132:135], v[56:59], a[4:7], 0
  ds_read_b64_tr_b16 v[72:73], v15 offset:10240
  v_cvt_pk_bf16_f32 v32, v192, v193
  v_cvt_pk_bf16_f32 v33, v194, v195
  v_mfma_f32_16x16x32_bf16 v[132:135], v[60:63], a[20:23], v[132:135]
  ds_read_b64_tr_b16 v[74:75], v15 offset:11264
  v_mul_f32 v208, v208, v240
  v_mul_f32 v209, v209, v241
  v_mfma_f32_16x16x32_bf16 v[132:135], v[64:67], a[36:39], v[132:135]
  ds_read_b64_tr_b16 v[76:77], v15 offset:14336
  v_mul_f32 v210, v210, v242
  v_mul_f32 v211, v211, v243
  v_mfma_f32_16x16x32_bf16 v[136:139], v[56:59], a[8:11], 0
  ds_read_b64_tr_b16 v[78:79], v15 offset:15360
  v_cvt_pk_bf16_f32 v34, v208, v209
  v_cvt_pk_bf16_f32 v35, v210, v211
  v_mfma_f32_16x16x32_bf16 v[136:139], v[60:63], a[24:27], v[136:139]
  s_add_u32 m0, s33, 28672
  ds_write_b128 v17, v[32:35] offset:24576
  s_mov_b32 s61, 24576
  v_mfma_f32_16x16x32_bf16 v[136:139], v[64:67], a[40:43], v[136:139]
  s_mov_b32 s34, 4096
  buffer_store_dwordx4 v[32:35], v80, s[28:31], s61 offen sc1
  v_mul_f32 v196, v196, v228
  v_mfma_f32_16x16x32_bf16 v[140:143], v[56:59], a[12:15], 0
  buffer_load_dwordx4 v88, s[68:71], s34 offen sc1 lds
  v_mul_f32 v197, v197, v229
  v_mul_f32 v198, v198, v230
  v_mfma_f32_16x16x32_bf16 v[140:143], v[60:63], a[28:31], v[140:143]
  s_add_u32 m0, s33, 32768
  v_mul_f32 v199, v199, v231
  v_cvt_pk_bf16_f32 v36, v196, v197
  v_mfma_f32_16x16x32_bf16 v[140:143], v[64:67], a[44:47], v[140:143]
  s_mov_b32 s34, 6144
  buffer_load_dwordx4 v88, s[68:71], s34 offen sc1 lds
  s_waitcnt lgkmcnt(1)
  v_mfma_f32_16x16x32_bf16 v[144:147], v[68:71], a[0:3], 0
  ds_read_b64_tr_b16 v[56:57], v14
  s_add_u32 m0, s33, 36864
  v_cvt_pk_bf16_f32 v37, v198, v199
  v_mfma_f32_16x16x32_bf16 v[144:147], v[72:75], a[16:19], v[144:147]
  ds_read_b64_tr_b16 v[58:59], v14 offset:1024
  s_mov_b32 s34, 8192
  v_mul_f32 v212, v212, v244
  v_mfma_f32_16x16x32_bf16 v[144:147], v[76:79], a[32:35], v[144:147]
  ds_read_b64_tr_b16 v[60:61], v14 offset:4096
  buffer_load_dwordx4 v88, s[68:71], s34 offen sc1 lds
  v_mul_f32 v213, v213, v245
  v_mfma_f32_16x16x32_bf16 v[148:151], v[68:71], a[4:7], 0
  ds_read_b64_tr_b16 v[62:63], v14 offset:5120
  s_add_u32 m0, s33, 40960
  v_mul_f32 v214, v214, v246
  v_mfma_f32_16x16x32_bf16 v[148:151], v[72:75], a[20:23], v[148:151]
  ds_read_b64_tr_b16 v[64:65], v15 offset:16384
  s_mov_b32 s34, 10240
  v_mul_f32 v215, v215, v247
  v_mfma_f32_16x16x32_bf16 v[148:151], v[76:79], a[36:39], v[148:151]
  ds_read_b64_tr_b16 v[66:67], v15 offset:17408
  buffer_load_dwordx4 v88, s[68:71], s34 offen sc1 lds
  v_cvt_pk_bf16_f32 v38, v212, v213
  v_mfma_f32_16x16x32_bf16 v[152:155], v[68:71], a[8:11], 0
  s_add_u32 m0, s33, 45056
  v_cvt_pk_bf16_f32 v39, v214, v215
  ds_write_b128 v17, v[36:39] offset:25600
  v_mfma_f32_16x16x32_bf16 v[152:155], v[72:75], a[24:27], v[152:155]
  s_mov_b32 s34, 3538944
  s_mov_b32 s61, 25600
  buffer_store_dwordx4 v[36:39], v80, s[28:31], s61 offen sc1
  v_mfma_f32_16x16x32_bf16 v[152:155], v[76:79], a[40:43], v[152:155]
  buffer_load_dwordx4 v20, s[24:27], s34 offen lds
  v_mul_f32 v200, v200, v232
  v_mul_f32 v201, v201, v233
  v_mfma_f32_16x16x32_bf16 v[156:159], v[68:71], a[12:15], 0
  v_mul_f32 v202, v202, v234
  v_mul_f32 v203, v203, v235
  v_mfma_f32_16x16x32_bf16 v[156:159], v[72:75], a[28:31], v[156:159]
  v_cvt_pk_bf16_f32 v32, v200, v201
  v_cvt_pk_bf16_f32 v33, v202, v203
  v_mfma_f32_16x16x32_bf16 v[156:159], v[76:79], a[44:47], v[156:159]
  v_mul_f32 v216, v216, v248
  v_mul_f32 v217, v217, v249
  s_waitcnt lgkmcnt(1)
  v_mfma_f32_16x16x32_bf16 v[128:131], v[56:59], a[48:51], v[128:131]
  ds_read_b64_tr_b16 v[68:69], v14 offset:2048
  s_add_u32 m0, s33, 49152
  v_mul_f32 v218, v218, v250
  v_mfma_f32_16x16x32_bf16 v[128:131], v[60:63], a[64:67], v[128:131]
  ds_read_b64_tr_b16 v[70:71], v14 offset:3072
  s_mov_b32 s34, 3833856
  v_mul_f32 v219, v219, v251
  v_mfma_f32_16x16x32_bf16 v[128:131], v[64:67], a[80:83], v[128:131]
  ds_read_b64_tr_b16 v[72:73], v14 offset:6144
  buffer_load_dwordx4 v20, s[24:27], s34 offen lds
  v_cvt_pk_bf16_f32 v34, v216, v217
  v_mfma_f32_16x16x32_bf16 v[132:135], v[56:59], a[52:55], v[132:135]
  ds_read_b64_tr_b16 v[74:75], v14 offset:7168
  s_add_u32 m0, s33, 53248
  v_cvt_pk_bf16_f32 v35, v218, v219
  v_mfma_f32_16x16x32_bf16 v[132:135], v[60:63], a[68:71], v[132:135]
  ds_read_b64_tr_b16 v[76:77], v15 offset:18432
  s_mov_b32 s34, 4128768
  ds_write_b128 v17, v[32:35] offset:26624
  v_mfma_f32_16x16x32_bf16 v[132:135], v[64:67], a[84:87], v[132:135]
  ds_read_b64_tr_b16 v[78:79], v15 offset:19456
  buffer_load_dwordx4 v20, s[24:27], s34 offen lds
  s_mov_b32 s61, 26624
  v_mfma_f32_16x16x32_bf16 v[136:139], v[56:59], a[56:59], v[136:139]
  ds_read_b128 a[0:3], v16
  s_add_u32 m0, s33, 57344
  buffer_store_dwordx4 v[32:35], v80, s[28:31], s61 offen sc1
  v_mfma_f32_16x16x32_bf16 v[136:139], v[60:63], a[72:75], v[136:139]
  ds_read_b128 a[4:7], v16 offset:1024
  s_mov_b32 s34, 12288
  v_mul_f32 v204, v204, v236
  v_mfma_f32_16x16x32_bf16 v[136:139], v[64:67], a[88:91], v[136:139]
  ds_read_b128 a[8:11], v16 offset:2048
  buffer_load_dwordx4 v88, s[68:71], s34 offen sc1 lds
  v_mul_f32 v205, v205, v237
  v_mfma_f32_16x16x32_bf16 v[140:143], v[56:59], a[60:63], v[140:143]
  ds_read_b128 a[12:15], v16 offset:3072
  v_mul_f32 v206, v206, v238
  v_mul_f32 v207, v207, v239
  v_mfma_f32_16x16x32_bf16 v[140:143], v[60:63], a[76:79], v[140:143]
  v_cvt_pk_bf16_f32 v36, v204, v205
  v_cvt_pk_bf16_f32 v37, v206, v207
  v_mfma_f32_16x16x32_bf16 v[140:143], v[64:67], a[92:95], v[140:143]
  v_mul_f32 v220, v220, v252
  v_mul_f32 v221, v221, v253
  s_waitcnt lgkmcnt(4)
  v_mfma_f32_16x16x32_bf16 v[144:147], v[68:71], a[48:51], v[144:147]
  s_waitcnt vmcnt(13)
  s_barrier
  v_mul_f32 v222, v222, v254
  v_mfma_f32_16x16x32_bf16 v[144:147], v[72:75], a[64:67], v[144:147]
  ds_read_b64_tr_b16 v[56:57], v15 offset:20480
  s_add_u32 m0, s33, 61440
  v_mul_f32 v223, v223, v255
  v_mfma_f32_16x16x32_bf16 v[144:147], v[76:79], a[80:83], v[144:147]
  ds_read_b64_tr_b16 v[58:59], v15 offset:21504
  s_mov_b32 s34, 14336
  v_cvt_pk_bf16_f32 v38, v220, v221
  v_mfma_f32_16x16x32_bf16 v[148:151], v[68:71], a[52:55], v[148:151]
  ds_read_b64_tr_b16 v[60:61], v25 offset:28672
  buffer_load_dwordx4 v88, s[68:71], s34 offen sc1 lds
  v_cvt_pk_bf16_f32 v39, v222, v223
  v_mfma_f32_16x16x32_bf16 v[148:151], v[72:75], a[68:71], v[148:151]
  ds_read_b64_tr_b16 v[62:63], v25 offset:29696
  s_add_u32 m0, s33, 65536
  ds_write_b128 v17, v[36:39] offset:27648
  v_mfma_f32_16x16x32_bf16 v[148:151], v[76:79], a[84:87], v[148:151]
  ds_read_b64_tr_b16 v[64:65], v14 offset:8192
  s_mov_b32 s34, 4423680
  s_mov_b32 s61, 27648
  v_mfma_f32_16x16x32_bf16 v[152:155], v[68:71], a[56:59], v[152:155]
  ds_read_b64_tr_b16 v[66:67], v14 offset:9216
  buffer_load_dwordx4 v20, s[24:27], s34 offen lds
  buffer_store_dwordx4 v[36:39], v80, s[28:31], s61 offen sc1
  v_mfma_f32_16x16x32_bf16 v[152:155], v[72:75], a[72:75], v[152:155]
  ds_read_b128 a[16:19], v16 offset:4096
  s_add_u32 m0, s33, 69632
  v_mfma_f32_16x16x32_bf16 v[152:155], v[76:79], a[88:91], v[152:155]
  ds_read_b128 a[20:23], v16 offset:5120
  s_mov_b32 s34, 4718592
  v_mfma_f32_16x16x32_bf16 v[156:159], v[68:71], a[60:63], v[156:159]
  ds_read_b128 a[24:27], v16 offset:6144
  buffer_load_dwordx4 v20, s[24:27], s34 offen lds
  v_mfma_f32_16x16x32_bf16 v[156:159], v[72:75], a[76:79], v[156:159]
  ds_read_b128 a[28:31], v16 offset:7168
  v_mfma_f32_16x16x32_bf16 v[156:159], v[76:79], a[92:95], v[156:159]
  s_waitcnt lgkmcnt(4)
  v_mfma_f32_16x16x32_bf16 v[128:131], v[56:59], a[96:99], v[128:131]
  ds_read_b64_tr_b16 v[68:69], v15 offset:22528
  s_add_u32 m0, s33, 73728
  v_mfma_f32_16x16x32_bf16 v[128:131], v[60:63], a[112:115], v[128:131]
  ds_read_b64_tr_b16 v[70:71], v15 offset:23552
  s_mov_b32 s34, 5013504
  v_mfma_f32_16x16x32_bf16 v[128:131], v[64:67], a[128:131], v[128:131]
  ds_read_b64_tr_b16 v[72:73], v25 offset:30720
  buffer_load_dwordx4 v20, s[24:27], s34 offen lds
  v_mfma_f32_16x16x32_bf16 v[132:135], v[56:59], a[100:103], v[132:135]
  ds_read_b64_tr_b16 v[74:75], v25 offset:31744
  s_add_u32 m0, s33, 77824
  v_mfma_f32_16x16x32_bf16 v[132:135], v[60:63], a[116:119], v[132:135]
  ds_read_b64_tr_b16 v[76:77], v14 offset:10240
  s_mov_b32 s34, 16384
  v_mfma_f32_16x16x32_bf16 v[132:135], v[64:67], a[132:135], v[132:135]
  ds_read_b64_tr_b16 v[78:79], v14 offset:11264
  buffer_load_dwordx4 v88, s[68:71], s34 offen sc1 lds
  v_mfma_f32_16x16x32_bf16 v[136:139], v[56:59], a[104:107], v[136:139]
  ds_read_b128 a[32:35], v16 offset:8192
  s_add_u32 m0, s33, 0
  v_mfma_f32_16x16x32_bf16 v[136:139], v[60:63], a[120:123], v[136:139]
  ds_read_b128 a[36:39], v16 offset:9216
  s_mov_b32 s34, 18432
  v_mfma_f32_16x16x32_bf16 v[136:139], v[64:67], a[136:139], v[136:139]
  ds_read_b128 a[40:43], v16 offset:10240
  buffer_load_dwordx4 v88, s[68:71], s34 offen sc1 lds
  v_mfma_f32_16x16x32_bf16 v[140:143], v[56:59], a[108:111], v[140:143]
  ds_read_b128 a[44:47], v16 offset:11264
  v_mfma_f32_16x16x32_bf16 v[140:143], v[60:63], a[124:127], v[140:143]
  v_mfma_f32_16x16x32_bf16 v[140:143], v[64:67], a[140:143], v[140:143]
  s_waitcnt lgkmcnt(4)
  v_mfma_f32_16x16x32_bf16 v[144:147], v[68:71], a[96:99], v[144:147]
  ds_read_b64_tr_b16 v[56:57], v14 offset:12288
  v_mfma_f32_16x16x32_bf16 v[144:147], v[72:75], a[112:115], v[144:147]
  ds_read_b64_tr_b16 v[58:59], v14 offset:13312
  v_mfma_f32_16x16x32_bf16 v[144:147], v[76:79], a[128:131], v[144:147]
  ds_read_b64_tr_b16 v[60:61], v15 offset:57344
  v_mfma_f32_16x16x32_bf16 v[148:151], v[68:71], a[100:103], v[148:151]
  ds_read_b64_tr_b16 v[62:63], v15 offset:58368
  v_mfma_f32_16x16x32_bf16 v[148:151], v[72:75], a[116:119], v[148:151]
  ds_read_b64_tr_b16 v[64:65], v14 offset:16384
  v_mfma_f32_16x16x32_bf16 v[148:151], v[76:79], a[132:135], v[148:151]
  ds_read_b64_tr_b16 v[66:67], v14 offset:17408
  v_mfma_f32_16x16x32_bf16 v[152:155], v[68:71], a[104:107], v[152:155]
  ds_read_b128 a[48:51], v16 offset:12288
  s_add_u32 m0, s33, 4096
  v_mfma_f32_16x16x32_bf16 v[152:155], v[72:75], a[120:123], v[152:155]
  ds_read_b128 a[52:55], v16 offset:13312
  s_mov_b32 s34, 20480
  v_mfma_f32_16x16x32_bf16 v[152:155], v[76:79], a[136:139], v[152:155]
  ds_read_b128 a[56:59], v16 offset:14336
  buffer_load_dwordx4 v88, s[68:71], s34 offen sc1 lds
  v_mfma_f32_16x16x32_bf16 v[156:159], v[68:71], a[108:111], v[156:159]
  ds_read_b128 a[60:63], v16 offset:15360
  s_add_u32 m0, s33, 81920
  v_mfma_f32_16x16x32_bf16 v[156:159], v[72:75], a[124:127], v[156:159]
  s_mov_b32 s34, 22528
  v_mfma_f32_16x16x32_bf16 v[156:159], v[76:79], a[140:143], v[156:159]
  buffer_load_dwordx4 v88, s[68:71], s34 offen sc1 lds
  s_waitcnt lgkmcnt(4)
  v_mfma_f32_16x16x32_bf16 v[128:131], v[56:59], a[144:147], v[128:131]
  s_waitcnt vmcnt(11)
  s_barrier
  v_mfma_f32_16x16x32_bf16 v[128:131], v[60:63], a[160:163], v[128:131]
  ds_read_b64_tr_b16 v[68:69], v14 offset:14336
  s_add_u32 m0, s33, 126976
  v_mfma_f32_16x16x32_bf16 v[128:131], v[64:67], a[176:179], v[128:131]
  ds_read_b64_tr_b16 v[70:71], v14 offset:15360
  s_mov_b32 s34, 0
  v_mfma_f32_16x16x32_bf16 v[132:135], v[56:59], a[148:151], v[132:135]
  ds_read_b64_tr_b16 v[72:73], v15 offset:59392
  buffer_load_dwordx4 v82, s[12:15], s34 offen lds
  v_mfma_f32_16x16x32_bf16 v[132:135], v[60:63], a[164:167], v[132:135]
  ds_read_b64_tr_b16 v[74:75], v15 offset:60416
  s_add_u32 m0, s33, 131072
  v_mfma_f32_16x16x32_bf16 v[132:135], v[64:67], a[180:183], v[132:135]
  ds_read_b64_tr_b16 v[76:77], v14 offset:18432
  s_mov_b32 s34, 36864
  v_mfma_f32_16x16x32_bf16 v[136:139], v[56:59], a[152:155], v[136:139]
  ds_read_b64_tr_b16 v[78:79], v14 offset:19456
  buffer_load_dwordx4 v82, s[12:15], s34 offen lds
  v_mfma_f32_16x16x32_bf16 v[136:139], v[60:63], a[168:171], v[136:139]
  ds_read_b128 a[64:67], v16 offset:16384
  s_add_u32 m0, s33, 90112
  v_mfma_f32_16x16x32_bf16 v[136:139], v[64:67], a[184:187], v[136:139]
  ds_read_b128 a[68:71], v16 offset:17408
  s_mov_b32 s34, 73728
  v_mfma_f32_16x16x32_bf16 v[140:143], v[56:59], a[156:159], v[140:143]
  ds_read_b128 a[72:75], v16 offset:18432
  buffer_load_dwordx4 v82, s[12:15], s34 offen lds
  v_mfma_f32_16x16x32_bf16 v[140:143], v[60:63], a[172:175], v[140:143]
  ds_read_b128 a[76:79], v16 offset:19456
  v_mfma_f32_16x16x32_bf16 v[140:143], v[64:67], a[188:191], v[140:143]
  s_waitcnt lgkmcnt(4)
  v_mfma_f32_16x16x32_bf16 v[144:147], v[68:71], a[144:147], v[144:147]
  s_waitcnt vmcnt(9)
  s_barrier
  s_mov_b32 s63, 163840
  buffer_store_dword v7, v29, s[96:99], s63 offen sc1
  ds_read_b64_tr_b16 v[56:57], v14 offset:45056
  s_add_u32 m0, s33, 94208
  v_mfma_f32_16x16x32_bf16 v[144:147], v[72:75], a[160:163], v[144:147]
  ds_read_b64_tr_b16 v[58:59], v14 offset:46080
  s_mov_b32 s34, 110592
  v_mfma_f32_16x16x32_bf16 v[144:147], v[76:79], a[176:179], v[144:147]
  ds_read_b64_tr_b16 v[60:61], v14 offset:49152
  buffer_load_dwordx4 v82, s[12:15], s34 offen lds
  v_mfma_f32_16x16x32_bf16 v[148:151], v[68:71], a[148:151], v[148:151]
  ds_read_b64_tr_b16 v[62:63], v14 offset:50176
  s_add_u32 m0, s33, 135168
  v_mfma_f32_16x16x32_bf16 v[148:151], v[72:75], a[164:167], v[148:151]
  ds_read_b64_tr_b16 v[64:65], v14 offset:53248
  s_mov_b32 s34, 147456
  v_mfma_f32_16x16x32_bf16 v[148:151], v[76:79], a[180:183], v[148:151]
  ds_read_b64_tr_b16 v[66:67], v14 offset:54272
  buffer_load_dwordx4 v82, s[12:15], s34 offen lds
  v_mfma_f32_16x16x32_bf16 v[152:155], v[68:71], a[152:155], v[152:155]
  ds_read_b128 a[80:83], v16 offset:20480
  s_add_u32 m0, s33, 98304
  v_mfma_f32_16x16x32_bf16 v[152:155], v[72:75], a[168:171], v[152:155]
  ds_read_b128 a[84:87], v16 offset:21504
  s_mov_b32 s34, 184320
  v_mfma_f32_16x16x32_bf16 v[152:155], v[76:79], a[184:187], v[152:155]
  ds_read_b128 a[88:91], v16 offset:22528
  buffer_load_dwordx4 v82, s[12:15], s34 offen lds
  v_mfma_f32_16x16x32_bf16 v[156:159], v[68:71], a[156:159], v[156:159]
  ds_read_b128 a[92:95], v16 offset:23552
  v_mfma_f32_16x16x32_bf16 v[156:159], v[72:75], a[172:175], v[156:159]
  v_mfma_f32_16x16x32_bf16 v[156:159], v[76:79], a[188:191], v[156:159]
  s_waitcnt lgkmcnt(4)
  v_mfma_f32_16x16x32_bf16 v[128:131], v[56:59], a[192:195], v[128:131]
  ds_read_b64_tr_b16 v[68:69], v14 offset:47104
  v_mfma_f32_16x16x32_bf16 v[128:131], v[60:63], a[208:211], v[128:131]
  ds_read_b64_tr_b16 v[70:71], v14 offset:48128
  v_mfma_f32_16x16x32_bf16 v[128:131], v[64:67], a[224:227], v[128:131]
  ds_read_b64_tr_b16 v[72:73], v14 offset:51200
  v_mfma_f32_16x16x32_bf16 v[132:135], v[56:59], a[196:199], v[132:135]
  ds_read_b64_tr_b16 v[74:75], v14 offset:52224
  v_mfma_f32_16x16x32_bf16 v[132:135], v[60:63], a[212:215], v[132:135]
  ds_read_b64_tr_b16 v[76:77], v14 offset:55296
  v_mfma_f32_16x16x32_bf16 v[132:135], v[64:67], a[228:231], v[132:135]
  ds_read_b64_tr_b16 v[78:79], v14 offset:56320
  v_mfma_f32_16x16x32_bf16 v[136:139], v[56:59], a[200:203], v[136:139]
  ds_read_b128 a[144:147], v26 offset:20480
  s_add_u32 m0, s33, 86016
  v_mfma_f32_16x16x32_bf16 v[136:139], v[60:63], a[216:219], v[136:139]
  ds_read_b128 a[148:151], v26 offset:21504
  s_mov_b32 s34, 0
  v_mfma_f32_16x16x32_bf16 v[136:139], v[64:67], a[232:235], v[136:139]
  ds_read_b128 a[152:155], v26 offset:24576
  buffer_load_dwordx4 v84, s[12:15], s34 offen lds
  v_mfma_f32_16x16x32_bf16 v[140:143], v[56:59], a[204:207], v[140:143]
  ds_read_b128 a[156:159], v26 offset:25600
  s_add_u32 m0, s33, 8192
  v_mfma_f32_16x16x32_bf16 v[140:143], v[60:63], a[220:223], v[140:143]
  s_mov_b32 s34, 36864
  v_mfma_f32_16x16x32_bf16 v[140:143], v[64:67], a[236:239], v[140:143]
  buffer_load_dwordx4 v84, s[12:15], s34 offen lds
  s_waitcnt lgkmcnt(4)
  v_mfma_f32_16x16x32_bf16 v[144:147], v[68:71], a[192:195], v[144:147]
  s_waitcnt vmcnt(6)
  s_barrier
  v_mfma_f32_16x16x32_bf16 v[144:147], v[72:75], a[208:211], v[144:147]
  ds_read_b64_tr_b16 v[56:57], v15
  s_add_u32 m0, s33, 139264
  v_mfma_f32_16x16x32_bf16 v[144:147], v[76:79], a[224:227], v[144:147]
  ds_read_b64_tr_b16 v[58:59], v15 offset:1024
  s_mov_b32 s34, 73728
  v_mfma_f32_16x16x32_bf16 v[148:151], v[68:71], a[196:199], v[148:151]
  ds_read_b64_tr_b16 v[60:61], v15 offset:4096
  buffer_load_dwordx4 v84, s[12:15], s34 offen lds
  v_mfma_f32_16x16x32_bf16 v[148:151], v[72:75], a[212:215], v[148:151]
  ds_read_b64_tr_b16 v[62:63], v15 offset:5120
  s_add_u32 m0, s33, 102400
  v_mfma_f32_16x16x32_bf16 v[148:151], v[76:79], a[228:231], v[148:151]
  ds_read_b64_tr_b16 v[64:65], v15 offset:8192
  s_mov_b32 s34, 110592
  v_mfma_f32_16x16x32_bf16 v[152:155], v[68:71], a[200:203], v[152:155]
  ds_read_b64_tr_b16 v[66:67], v15 offset:9216
  buffer_load_dwordx4 v84, s[12:15], s34 offen lds
  v_mfma_f32_16x16x32_bf16 v[152:155], v[72:75], a[216:219], v[152:155]
  ds_read_b128 a[160:163], v26 offset:28672
  s_add_u32 m0, s33, 143360
  v_mfma_f32_16x16x32_bf16 v[152:155], v[76:79], a[232:235], v[152:155]
  ds_read_b128 a[164:167], v26 offset:29696
  s_mov_b32 s34, 147456
  v_mfma_f32_16x16x32_bf16 v[156:159], v[68:71], a[204:207], v[156:159]
  ds_read_b128 a[168:171], v26 offset:32768
  buffer_load_dwordx4 v84, s[12:15], s34 offen lds
  v_mfma_f32_16x16x32_bf16 v[156:159], v[72:75], a[220:223], v[156:159]
  ds_read_b128 a[172:175], v26 offset:33792
  s_mov_b32 s63, 163840
  buffer_load_dword v31, v91, s[96:99], s63 offen sc1
  v_mfma_f32_16x16x32_bf16 v[156:159], v[76:79], a[236:239], v[156:159]
  s_waitcnt lgkmcnt(4)
  v_mfma_f32_16x16x32_bf16 v[128:131], v[56:59], a[240:243], v[128:131]
  ds_read_b64_tr_b16 v[68:69], v15 offset:2048
  s_add_u32 m0, s33, 147456
  v_mfma_f32_16x16x32_bf16 v[128:131], v[60:63], v[96:99], v[128:131]
  ds_read_b64_tr_b16 v[70:71], v15 offset:3072
  s_mov_b32 s34, 184320
  v_mfma_f32_16x16x32_bf16 v[128:131], v[64:67], v[112:115], v[128:131]
  ds_read_b64_tr_b16 v[72:73], v15 offset:6144
  buffer_load_dwordx4 v84, s[12:15], s34 offen lds
  v_mfma_f32_16x16x32_bf16 v[132:135], v[56:59], a[244:247], v[132:135]
  ds_read_b64_tr_b16 v[74:75], v15 offset:7168
  s_add_u32 m0, s33, 106496
  v_mfma_f32_16x16x32_bf16 v[132:135], v[60:63], v[100:103], v[132:135]
  ds_read_b64_tr_b16 v[76:77], v15 offset:10240
  s_mov_b32 s34, 221184
  v_mfma_f32_16x16x32_bf16 v[132:135], v[64:67], v[116:119], v[132:135]
  ds_read_b64_tr_b16 v[78:79], v15 offset:11264
  buffer_load_dwordx4 v82, s[12:15], s34 offen lds
  v_mfma_f32_16x16x32_bf16 v[136:139], v[56:59], a[248:251], v[136:139]
  ds_read_b128 a[176:179], v26 offset:36864
  s_add_u32 m0, s33, 110592
  v_mfma_f32_16x16x32_bf16 v[136:139], v[60:63], v[104:107], v[136:139]
  ds_read_b128 a[180:183], v26 offset:37888
  s_mov_b32 s34, 258048
  v_mfma_f32_16x16x32_bf16 v[136:139], v[64:67], v[120:123], v[136:139]
  ds_read_b128 a[184:187], v26 offset:40960
  buffer_load_dwordx4 v82, s[12:15], s34 offen lds
  v_mfma_f32_16x16x32_bf16 v[140:143], v[56:59], a[252:255], v[140:143]
  ds_read_b128 a[188:191], v26 offset:41984
  v_mfma_f32_16x16x32_bf16 v[140:143], v[60:63], v[108:111], v[140:143]
  v_mfma_f32_16x16x32_bf16 v[140:143], v[64:67], v[124:127], v[140:143]
  s_waitcnt lgkmcnt(4)
  v_mfma_f32_16x16x32_bf16 v[144:147], v[68:71], a[240:243], v[144:147]
  ds_read_b64_tr_b16 v[56:57], v9 offset:61440
  v_mfma_f32_16x16x32_bf16 v[144:147], v[72:75], v[96:99], v[144:147]
  ds_read_b64_tr_b16 v[58:59], v9 offset:63488
  v_mfma_f32_16x16x32_bf16 v[144:147], v[76:79], v[112:115], v[144:147]
  ds_read_b64_tr_b16 v[60:61], v10
  v_mfma_f32_16x16x32_bf16 v[148:151], v[68:71], a[244:247], v[148:151]
  ds_read_b64_tr_b16 v[62:63], v10 offset:2048
  v_mfma_f32_16x16x32_bf16 v[148:151], v[72:75], v[100:103], v[148:151]
  ds_read_b64_tr_b16 v[64:65], v9 offset:24576
  v_mfma_f32_16x16x32_bf16 v[148:151], v[76:79], v[116:119], v[148:151]
  ds_read_b64_tr_b16 v[66:67], v9 offset:26624
  v_mfma_f32_16x16x32_bf16 v[152:155], v[68:71], a[248:251], v[152:155]
  ds_read_b128 a[192:195], v26 offset:57344
  s_add_u32 m0, s33, 12288
  v_mfma_f32_16x16x32_bf16 v[152:155], v[72:75], v[104:107], v[152:155]
  ds_read_b128 a[196:199], v26 offset:58368
  s_mov_b32 s34, 0
  v_mfma_f32_16x16x32_bf16 v[152:155], v[76:79], v[120:123], v[152:155]
  ds_read_b128 a[200:203], v26 offset:61440
  buffer_load_dwordx4 v83, s[12:15], s34 offen lds
  v_mfma_f32_16x16x32_bf16 v[156:159], v[68:71], a[252:255], v[156:159]
  ds_read_b128 a[204:207], v26 offset:62464
  v_mfma_f32_16x16x32_bf16 v[156:159], v[72:75], v[108:111], v[156:159]
  v_mfma_f32_16x16x32_bf16 v[156:159], v[76:79], v[124:127], v[156:159]
  s_waitcnt lgkmcnt(4)
  v_mfma_f32_16x16x32_bf16 v[192:195], v[56:59], a[0:3], 0
  s_waitcnt vmcnt(10)
  s_barrier
  v_mfma_f32_16x16x32_bf16 v[192:195], v[60:63], a[16:19], v[192:195]
  ds_read_b64_tr_b16 v[68:69], v12 offset:61440
  s_add_u32 m0, s33, 16384
  v_mul_f32 v128, v128, v144
  s_waitcnt vmcnt(4)
  v_cmp_ne_u32 vcc, v7, v31
  s_cbranch_vccnz L_sp_24
L_bk_25:
  v_mfma_f32_16x16x32_bf16 v[192:195], v[64:67], a[32:35], v[192:195]
  ds_read_b64_tr_b16 v[70:71], v12 offset:63488
  s_mov_b32 s34, 128
  v_mul_f32 v129, v129, v145
  v_mfma_f32_16x16x32_bf16 v[196:199], v[56:59], a[4:7], 0
  ds_read_b64_tr_b16 v[72:73], v13
  buffer_load_dwordx4 v82, s[12:15], s34 offen lds
  v_mul_f32 v130, v130, v146
  v_mfma_f32_16x16x32_bf16 v[196:199], v[60:63], a[20:23], v[196:199]
  ds_read_b64_tr_b16 v[74:75], v13 offset:2048
  s_add_u32 m0, s33, 45056
  v_mul_f32 v131, v131, v147
  v_mfma_f32_16x16x32_bf16 v[196:199], v[64:67], a[36:39], v[196:199]
  ds_read_b64_tr_b16 v[76:77], v12 offset:24576
  s_mov_b32 s34, 36992
  v_cvt_pk_bf16_f32 v32, v128, v129
  v_mfma_f32_16x16x32_bf16 v[200:203], v[56:59], a[8:11], 0
  ds_read_b64_tr_b16 v[78:79], v12 offset:26624
  buffer_load_dwordx4 v82, s[12:15], s34 offen lds
  v_cvt_pk_bf16_f32 v33, v130, v131
  v_mfma_f32_16x16x32_bf16 v[200:203], v[60:63], a[24:27], v[200:203]
  ds_read_b128 a[96:99], v16 offset:24576
  s_add_u32 m0, s33, 49152
  ds_write_b64 v18, v[32:33] offset:32768
  v_mfma_f32_16x16x32_bf16 v[200:203], v[64:67], a[40:43], v[200:203]
  ds_read_b128 a[100:103], v16 offset:25600
  s_mov_b32 s34, 73856
  s_mov_b32 s61, 32768
  v_mfma_f32_16x16x32_bf16 v[204:207], v[56:59], a[12:15], 0
  ds_read_b128 a[104:107], v16 offset:26624
  buffer_load_dwordx4 v82, s[12:15], s34 offen lds
  buffer_store_dwordx2 v[32:33], v81, s[28:31], s61 offen sc1
  v_mfma_f32_16x16x32_bf16 v[204:207], v[60:63], a[28:31], v[204:207]
  ds_read_b128 a[108:111], v16 offset:27648
  v_mul_f32 v132, v132, v148
  v_mul_f32 v133, v133, v149
  v_mfma_f32_16x16x32_bf16 v[204:207], v[64:67], a[44:47], v[204:207]
  v_mul_f32 v134, v134, v150
  v_mul_f32 v135, v135, v151
  s_waitcnt lgkmcnt(5)
  v_mfma_f32_16x16x32_bf16 v[208:211], v[68:71], a[0:3], 0
  ds_read_b64_tr_b16 v[56:57], v9 offset:28672
  v_cvt_pk_bf16_f32 v34, v132, v133
  v_cvt_pk_bf16_f32 v35, v134, v135
  v_mfma_f32_16x16x32_bf16 v[208:211], v[72:75], a[16:19], v[208:211]
  ds_read_b64_tr_b16 v[58:59], v9 offset:30720
  ds_write_b64 v18, v[34:35] offset:33792
  s_mov_b32 s61, 33792
  v_mfma_f32_16x16x32_bf16 v[208:211], v[76:79], a[32:35], v[208:211]
  ds_read_b64_tr_b16 v[60:61], v10 offset:4096
  buffer_store_dwordx2 v[34:35], v81, s[28:31], s61 offen sc1
  v_mul_f32 v136, v136, v152
  v_mfma_f32_16x16x32_bf16 v[212:215], v[68:71], a[4:7], 0
  ds_read_b64_tr_b16 v[62:63], v10 offset:6144
  v_mul_f32 v137, v137, v153
  v_mul_f32 v138, v138, v154
  v_mfma_f32_16x16x32_bf16 v[212:215], v[72:75], a[20:23], v[212:215]
  ds_read_b64_tr_b16 v[64:65], v9 offset:32768
  v_mul_f32 v139, v139, v155
  v_cvt_pk_bf16_f32 v36, v136, v137
  v_mfma_f32_16x16x32_bf16 v[212:215], v[76:79], a[36:39], v[212:215]
  ds_read_b64_tr_b16 v[66:67], v9 offset:34816
  v_cvt_pk_bf16_f32 v37, v138, v139
  ds_write_b64 v18, v[36:37] offset:34816
  v_mfma_f32_16x16x32_bf16 v[216:219], v[68:71], a[8:11], 0
  ds_read_b128 a[208:211], v27 offset:12288
  s_mov_b32 s61, 34816
  buffer_store_dwordx2 v[36:37], v81, s[28:31], s61 offen sc1
  v_mfma_f32_16x16x32_bf16 v[216:219], v[72:75], a[24:27], v[216:219]
  ds_read_b128 a[212:215], v27 offset:13312
  v_mul_f32 v140, v140, v156
  v_mul_f32 v141, v141, v157
  v_mfma_f32_16x16x32_bf16 v[216:219], v[76:79], a[40:43], v[216:219]
  ds_read_b128 a[216:219], v26
  v_mul_f32 v142, v142, v158
  v_mul_f32 v143, v143, v159
  v_mfma_f32_16x16x32_bf16 v[220:223], v[68:71], a[12:15], 0
  ds_read_b128 a[220:223], v26 offset:1024
  v_cvt_pk_bf16_f32 v38, v140, v141
  v_cvt_pk_bf16_f32 v39, v142, v143
  v_mfma_f32_16x16x32_bf16 v[220:223], v[72:75], a[28:31], v[220:223]
  ds_write_b64 v18, v[38:39] offset:35840
  s_mov_b32 s61, 35840
  v_mfma_f32_16x16x32_bf16 v[220:223], v[76:79], a[44:47], v[220:223]
  buffer_store_dwordx2 v[38:39], v81, s[28:31], s61 offen sc1
  s_waitcnt lgkmcnt(6)
  v_mfma_f32_16x16x32_bf16 v[192:195], v[56:59], a[48:51], v[192:195]
  ds_read_b64_tr_b16 v[68:69], v12 offset:28672
  s_add_u32 m0, s33, 53248
  v_mfma_f32_16x16x32_bf16 v[192:195], v[60:63], a[64:67], v[192:195]
  ds_read_b64_tr_b16 v[70:71], v12 offset:30720
  s_mov_b32 s34, 110720
  v_mfma_f32_16x16x32_bf16 v[192:195], v[64:67], a[80:83], v[192:195]
  ds_read_b64_tr_b16 v[72:73], v13 offset:4096
  buffer_load_dwordx4 v82, s[12:15], s34 offen lds
  v_mfma_f32_16x16x32_bf16 v[196:199], v[56:59], a[52:55], v[196:199]
  ds_read_b64_tr_b16 v[74:75], v13 offset:6144
  s_add_u32 m0, s33, 20480
  v_mfma_f32_16x16x32_bf16 v[196:199], v[60:63], a[68:71], v[196:199]
  ds_read_b64_tr_b16 v[76:77], v12 offset:32768
  s_mov_b32 s34, 147584
  v_mfma_f32_16x16x32_bf16 v[196:199], v[64:67], a[84:87], v[196:199]
  ds_read_b64_tr_b16 v[78:79], v12 offset:34816
  buffer_load_dwordx4 v82, s[12:15], s34 offen lds
  v_mfma_f32_16x16x32_bf16 v[200:203], v[56:59], a[56:59], v[200:203]
  ds_read_b128 a[224:227], v26 offset:4096
  s_add_u32 m0, s33, 24576
  v_mfma_f32_16x16x32_bf16 v[200:203], v[60:63], a[72:75], v[200:203]
  ds_read_b128 a[228:231], v26 offset:5120
  s_mov_b32 s34, 184448
  v_mfma_f32_16x16x32_bf16 v[200:203], v[64:67], a[88:91], v[200:203]
  ds_read_b128 a[232:235], v27 offset:16384
  buffer_load_dwordx4 v82, s[12:15], s34 offen lds
  v_mfma_f32_16x16x32_bf16 v[204:207], v[56:59], a[60:63], v[204:207]
  ds_read_b128 a[236:239], v27 offset:17408
  s_mov_b32 s65, 24576
  v_mfma_f32_16x16x32_bf16 v[204:207], v[60:63], a[76:79], v[204:207]
  buffer_load_dwordx4 a[240:243], v89, s[68:71], s65 offen sc1
  buffer_load_dwordx4 a[244:247], v89, s[68:71], s65 offen offset:1024 sc1
  v_mfma_f32_16x16x32_bf16 v[204:207], v[64:67], a[92:95], v[204:207]
  buffer_load_dwordx4 a[248:251], v89, s[68:71], s65 offen offset:2048 sc1
  s_waitcnt lgkmcnt(4)
  v_mfma_f32_16x16x32_bf16 v[208:211], v[68:71], a[48:51], v[208:211]
  s_waitcnt vmcnt(16)
  s_barrier
  v_mfma_f32_16x16x32_bf16 v[208:211], v[72:75], a[64:67], v[208:211]
  ds_read_b64_tr_b16 v[56:57], v9 offset:20480
  buffer_load_dwordx4 a[252:255], v89, s[68:71], s65 offen offset:3072 sc1
  v_mfma_f32_16x16x32_bf16 v[208:211], v[76:79], a[80:83], v[208:211]
  ds_read_b64_tr_b16 v[58:59], v9 offset:22528
  s_mov_b32 s65, 28672
  v_mfma_f32_16x16x32_bf16 v[212:215], v[68:71], a[52:55], v[212:215]
  ds_read_b64_tr_b16 v[60:61], v8 offset:8192
  buffer_load_dwordx4 v[96:99], v89, s[68:71], s65 offen sc1
  v_mfma_f32_16x16x32_bf16 v[212:215], v[72:75], a[68:71], v[212:215]
  ds_read_b64_tr_b16 v[62:63], v8 offset:10240
  buffer_load_dwordx4 v[100:103], v89, s[68:71], s65 offen offset:1024 sc1
  v_mfma_f32_16x16x32_bf16 v[212:215], v[76:79], a[84:87], v[212:215]
  ds_read_b64_tr_b16 v[64:65], v10 offset:8192
  buffer_load_dwordx4 v[104:107], v89, s[68:71], s65 offen offset:2048 sc1
  v_mfma_f32_16x16x32_bf16 v[216:219], v[68:71], a[56:59], v[216:219]
  ds_read_b64_tr_b16 v[66:67], v10 offset:10240
  buffer_load_dwordx4 v[108:111], v89, s[68:71], s65 offen offset:3072 sc1
  v_mfma_f32_16x16x32_bf16 v[216:219], v[72:75], a[72:75], v[216:219]
  ds_read_b128 a[112:115], v16 offset:28672
  v_mfma_f32_16x16x32_bf16 v[216:219], v[76:79], a[88:91], v[216:219]
  ds_read_b128 a[116:119], v16 offset:29696
  v_mfma_f32_16x16x32_bf16 v[220:223], v[68:71], a[60:63], v[220:223]
  ds_read_b128 a[120:123], v16 offset:30720
  v_mfma_f32_16x16x32_bf16 v[220:223], v[72:75], a[76:79], v[220:223]
  ds_read_b128 a[124:127], v16 offset:31744
  v_mfma_f32_16x16x32_bf16 v[220:223], v[76:79], a[92:95], v[220:223]
  s_waitcnt lgkmcnt(4)
  v_mfma_f32_16x16x32_bf16 v[192:195], v[56:59], a[144:147], v[192:195]
  ds_read_b64_tr_b16 v[68:69], v12 offset:20480
  v_mfma_f32_16x16x32_bf16 v[192:195], v[60:63], a[160:163], v[192:195]
  ds_read_b64_tr_b16 v[70:71], v12 offset:22528
  v_mfma_f32_16x16x32_bf16 v[192:195], v[64:67], a[176:179], v[192:195]
  ds_read_b64_tr_b16 v[72:73], v11 offset:8192
  v_mfma_f32_16x16x32_bf16 v[196:199], v[56:59], a[148:151], v[196:199]
  ds_read_b64_tr_b16 v[74:75], v11 offset:10240
  v_mfma_f32_16x16x32_bf16 v[196:199], v[60:63], a[164:167], v[196:199]
  ds_read_b64_tr_b16 v[76:77], v13 offset:8192
  v_mfma_f32_16x16x32_bf16 v[196:199], v[64:67], a[180:183], v[196:199]
  ds_read_b64_tr_b16 v[78:79], v13 offset:10240
  v_mfma_f32_16x16x32_bf16 v[200:203], v[56:59], a[152:155], v[200:203]
  ds_read_b128 a[128:131], v16 offset:32768
  s_add_u32 m0, s33, 151552
  v_mfma_f32_16x16x32_bf16 v[200:203], v[60:63], a[168:171], v[200:203]
  ds_read_b128 a[132:135], v16 offset:33792
  s_mov_b32 s34, 221184
  v_mfma_f32_16x16x32_bf16 v[200:203], v[64:67], a[184:187], v[200:203]
  ds_read_b128 a[136:139], v16 offset:34816
  buffer_load_dwordx4 v84, s[12:15], s34 offen lds
  v_mfma_f32_16x16x32_bf16 v[204:207], v[56:59], a[156:159], v[204:207]
  ds_read_b128 a[140:143], v16 offset:35840
  s_add_u32 m0, s33, 114688
  v_mfma_f32_16x16x32_bf16 v[204:207], v[60:63], a[172:175], v[204:207]
  s_mov_b32 s34, 258048
  v_mfma_f32_16x16x32_bf16 v[204:207], v[64:67], a[188:191], v[204:207]
  buffer_load_dwordx4 v84, s[12:15], s34 offen lds
  s_waitcnt lgkmcnt(4)
  v_mfma_f32_16x16x32_bf16 v[208:211], v[68:71], a[144:147], v[208:211]
  s_waitcnt vmcnt(13)
  s_barrier
  s_mov_b32 s63, 196608
  buffer_store_dword v7, v29, s[96:99], s63 offen sc1
  ds_read_b64_tr_b16 v[56:57], v9 offset:36864
  v_mfma_f32_16x16x32_bf16 v[208:211], v[72:75], a[160:163], v[208:211]
  ds_read_b64_tr_b16 v[58:59], v9 offset:38912
  v_mfma_f32_16x16x32_bf16 v[208:211], v[76:79], a[176:179], v[208:211]
  ds_read_b64_tr_b16 v[60:61], v10 offset:12288
  v_mfma_f32_16x16x32_bf16 v[212:215], v[68:71], a[148:151], v[212:215]
  ds_read_b64_tr_b16 v[62:63], v10 offset:14336
  v_mfma_f32_16x16x32_bf16 v[212:215], v[72:75], a[164:167], v[212:215]
  ds_read_b64_tr_b16 v[64:65], v10 offset:16384
  v_mfma_f32_16x16x32_bf16 v[212:215], v[76:79], a[180:183], v[212:215]
  ds_read_b64_tr_b16 v[66:67], v10 offset:18432
  v_mfma_f32_16x16x32_bf16 v[216:219], v[68:71], a[152:155], v[216:219]
  s_add_u32 m0, s33, 28672
  v_mfma_f32_16x16x32_bf16 v[216:219], v[72:75], a[168:171], v[216:219]
  s_mov_b32 s34, 0
  v_mfma_f32_16x16x32_bf16 v[216:219], v[76:79], a[184:187], v[216:219]
  buffer_load_dwordx4 v85, s[12:15], s34 offen lds
  v_mfma_f32_16x16x32_bf16 v[220:223], v[68:71], a[156:159], v[220:223]
  v_mfma_f32_16x16x32_bf16 v[220:223], v[72:75], a[172:175], v[220:223]
  v_mfma_f32_16x16x32_bf16 v[220:223], v[76:79], a[188:191], v[220:223]
  s_waitcnt lgkmcnt(0)
  v_mfma_f32_16x16x32_bf16 v[192:195], v[56:59], a[192:195], v[192:195]
  s_barrier
  v_mfma_f32_16x16x32_bf16 v[192:195], v[60:63], a[208:211], v[192:195]
  ds_read_b64_tr_b16 v[68:69], v12 offset:36864
  v_mfma_f32_16x16x32_bf16 v[192:195], v[64:67], a[224:227], v[192:195]
  ds_read_b64_tr_b16 v[70:71], v12 offset:38912
  v_mfma_f32_16x16x32_bf16 v[196:199], v[56:59], a[196:199], v[196:199]
  ds_read_b64_tr_b16 v[72:73], v13 offset:12288
  v_mfma_f32_16x16x32_bf16 v[196:199], v[60:63], a[212:215], v[196:199]
  ds_read_b64_tr_b16 v[74:75], v13 offset:14336
  v_mfma_f32_16x16x32_bf16 v[196:199], v[64:67], a[228:231], v[196:199]
  ds_read_b64_tr_b16 v[76:77], v13 offset:16384
  v_mfma_f32_16x16x32_bf16 v[200:203], v[56:59], a[200:203], v[200:203]
  ds_read_b64_tr_b16 v[78:79], v13 offset:18432
  v_mfma_f32_16x16x32_bf16 v[200:203], v[60:63], a[216:219], v[200:203]
  s_add_u32 m0, s33, 155648
  v_mfma_f32_16x16x32_bf16 v[200:203], v[64:67], a[232:235], v[200:203]
  s_mov_b32 s34, 221312
  v_mfma_f32_16x16x32_bf16 v[204:207], v[56:59], a[204:207], v[204:207]
  buffer_load_dwordx4 v82, s[12:15], s34 offen lds
  v_mfma_f32_16x16x32_bf16 v[204:207], v[60:63], a[220:223], v[204:207]
  s_add_u32 m0, s33, 118784
  v_mfma_f32_16x16x32_bf16 v[204:207], v[64:67], a[236:239], v[204:207]
  s_mov_b32 s34, 258176
  buffer_load_dwordx4 v82, s[12:15], s34 offen lds
  s_waitcnt lgkmcnt(0)
  v_mfma_f32_16x16x32_bf16 v[208:211], v[68:71], a[192:195], v[208:211]
  ds_read_b64_tr_b16 v[56:57], v9 offset:40960
  v_mfma_f32_16x16x32_bf16 v[208:211], v[72:75], a[208:211], v[208:211]
  ds_read_b64_tr_b16 v[58:59], v9 offset:43008
  s_mov_b32 s63, 196608
  buffer_load_dword v31, v91, s[96:99], s63 offen sc1
  v_mfma_f32_16x16x32_bf16 v[208:211], v[76:79], a[224:227], v[208:211]
  ds_read_b64_tr_b16 v[60:61], v9 offset:45056
  v_mfma_f32_16x16x32_bf16 v[212:215], v[68:71], a[196:199], v[212:215]
  ds_read_b64_tr_b16 v[62:63], v9 offset:47104
  v_mfma_f32_16x16x32_bf16 v[212:215], v[72:75], a[212:215], v[212:215]
  ds_read_b64_tr_b16 v[64:65], v8 offset:12288
  v_mfma_f32_16x16x32_bf16 v[212:215], v[76:79], a[228:231], v[212:215]
  ds_read_b64_tr_b16 v[66:67], v8 offset:14336
  v_mfma_f32_16x16x32_bf16 v[216:219], v[68:71], a[200:203], v[216:219]
  s_add_u32 m0, s33, 159744
  v_mfma_f32_16x16x32_bf16 v[216:219], v[72:75], a[216:219], v[216:219]
  s_mov_b32 s34, 128
  v_mfma_f32_16x16x32_bf16 v[216:219], v[76:79], a[232:235], v[216:219]
  buffer_load_dwordx4 v83, s[12:15], s34 offen lds
  v_mfma_f32_16x16x32_bf16 v[220:223], v[68:71], a[204:207], v[220:223]
  s_add_u32 m0, s33, 122880
  v_mfma_f32_16x16x32_bf16 v[220:223], v[72:75], a[220:223], v[220:223]
  s_mov_b32 s34, 128
  v_mfma_f32_16x16x32_bf16 v[220:223], v[76:79], a[236:239], v[220:223]
  buffer_load_dwordx4 v84, s[12:15], s34 offen lds
  s_waitcnt lgkmcnt(0)
  v_mfma_f32_16x16x32_bf16 v[192:195], v[56:59], a[96:99], v[192:195]
  ds_read_b64_tr_b16 v[68:69], v12 offset:40960
  v_mfma_f32_16x16x32_bf16 v[192:195], v[60:63], a[112:115], v[192:195]
  ds_read_b64_tr_b16 v[70:71], v12 offset:43008
  v_mfma_f32_16x16x32_bf16 v[192:195], v[64:67], a[128:131], v[192:195]
  ds_read_b64_tr_b16 v[72:73], v12 offset:45056
  v_mfma_f32_16x16x32_bf16 v[196:199], v[56:59], a[100:103], v[196:199]
  ds_read_b64_tr_b16 v[74:75], v12 offset:47104
  v_mfma_f32_16x16x32_bf16 v[196:199], v[60:63], a[116:119], v[196:199]
  ds_read_b64_tr_b16 v[76:77], v11 offset:12288
  v_mfma_f32_16x16x32_bf16 v[196:199], v[64:67], a[132:135], v[196:199]
  ds_read_b64_tr_b16 v[78:79], v11 offset:14336
  v_mfma_f32_16x16x32_bf16 v[200:203], v[56:59], a[104:107], v[200:203]
  s_add_u32 m0, s33, 32768
  v_mfma_f32_16x16x32_bf16 v[200:203], v[60:63], a[120:123], v[200:203]
  s_mov_b32 s34, 36992
  v_mfma_f32_16x16x32_bf16 v[200:203], v[64:67], a[136:139], v[200:203]
  buffer_load_dwordx4 v84, s[12:15], s34 offen lds
  v_mfma_f32_16x16x32_bf16 v[204:207], v[56:59], a[108:111], v[204:207]
  s_add_u32 m0, s33, 36864
  v_mfma_f32_16x16x32_bf16 v[204:207], v[60:63], a[124:127], v[204:207]
  s_mov_b32 s34, 73856
  v_mfma_f32_16x16x32_bf16 v[204:207], v[64:67], a[140:143], v[204:207]
  buffer_load_dwordx4 v84, s[12:15], s34 offen lds
  s_waitcnt lgkmcnt(0)
  v_mfma_f32_16x16x32_bf16 v[208:211], v[68:71], a[96:99], v[208:211]
  s_waitcnt vmcnt(19)
  s_barrier
  v_mfma_f32_16x16x32_bf16 v[208:211], v[72:75], a[112:115], v[208:211]
  ds_read_b64_tr_b16 v[56:57], v8 offset:16384
  v_mfma_f32_16x16x32_bf16 v[208:211], v[76:79], a[128:131], v[208:211]
  ds_read_b64_tr_b16 v[58:59], v8 offset:18432
  v_mfma_f32_16x16x32_bf16 v[212:215], v[68:71], a[100:103], v[212:215]
  ds_read_b64_tr_b16 v[60:61], v8 offset:45056
  v_mfma_f32_16x16x32_bf16 v[212:215], v[72:75], a[116:119], v[212:215]
  ds_read_b64_tr_b16 v[62:63], v8 offset:47104
  v_mfma_f32_16x16x32_bf16 v[212:215], v[76:79], a[132:135], v[212:215]
  ds_read_b64_tr_b16 v[64:65], v8 offset:49152
  v_mfma_f32_16x16x32_bf16 v[216:219], v[68:71], a[104:107], v[216:219]
  ds_read_b64_tr_b16 v[66:67], v8 offset:51200
  v_mfma_f32_16x16x32_bf16 v[216:219], v[72:75], a[120:123], v[216:219]
  s_add_u32 m0, s33, 40960
  v_mfma_f32_16x16x32_bf16 v[216:219], v[76:79], a[136:139], v[216:219]
  s_mov_b32 s34, 110720
  v_mfma_f32_16x16x32_bf16 v[220:223], v[68:71], a[108:111], v[220:223]
  buffer_load_dwordx4 v84, s[12:15], s34 offen lds
  v_mfma_f32_16x16x32_bf16 v[220:223], v[72:75], a[124:127], v[220:223]
  s_add_u32 m0, s33, 65536
  v_mfma_f32_16x16x32_bf16 v[220:223], v[76:79], a[140:143], v[220:223]
  s_mov_b32 s34, 147584
  buffer_load_dwordx4 v84, s[12:15], s34 offen lds
  s_waitcnt lgkmcnt(0)
  v_mfma_f32_16x16x32_bf16 v[224:227], v[56:59], a[0:3], 0
  ds_read_b64_tr_b16 v[68:69], v11 offset:16384
  v_mfma_f32_16x16x32_bf16 v[224:227], v[60:63], a[16:19], v[224:227]
  ds_read_b64_tr_b16 v[70:71], v11 offset:18432
  s_waitcnt vmcnt(6)
  v_cmp_ne_u32 vcc, v7, v31
  s_cbranch_vccnz L_sp_26
L_bk_27:
  v_mfma_f32_16x16x32_bf16 v[224:227], v[64:67], a[32:35], v[224:227]
  ds_read_b64_tr_b16 v[72:73], v11 offset:45056
  s_mov_b32 s65, 32768
  v_mfma_f32_16x16x32_bf16 v[228:231], v[56:59], a[4:7], 0
  ds_read_b64_tr_b16 v[74:75], v11 offset:47104
  buffer_load_dwordx2 v[112:113], v90, s[68:71], s65 offen sc1
  v_mfma_f32_16x16x32_bf16 v[228:231], v[60:63], a[20:23], v[228:231]
  ds_read_b64_tr_b16 v[76:77], v11 offset:49152
  buffer_load_dwordx2 v[114:115], v90, s[68:71], s65 offen offset:512 sc1
  v_mfma_f32_16x16x32_bf16 v[228:231], v[64:67], a[36:39], v[228:231]
  ds_read_b64_tr_b16 v[78:79], v11 offset:51200
  buffer_load_dwordx2 v[116:117], v90, s[68:71], s65 offen offset:1024 sc1
  v_mfma_f32_16x16x32_bf16 v[232:235], v[56:59], a[8:11], 0
  s_add_u32 m0, s33, 69632
  buffer_load_dwordx2 v[118:119], v90, s[68:71], s65 offen offset:1536 sc1
  v_mfma_f32_16x16x32_bf16 v[232:235], v[60:63], a[24:27], v[232:235]
  s_mov_b32 s34, 184448
  buffer_load_dwordx2 v[120:121], v90, s[68:71], s65 offen offset:2048 sc1
  v_mfma_f32_16x16x32_bf16 v[232:235], v[64:67], a[40:43], v[232:235]
  buffer_load_dwordx4 v84, s[12:15], s34 offen lds
  buffer_load_dwordx2 v[122:123], v90, s[68:71], s65 offen offset:2560 sc1
  v_mfma_f32_16x16x32_bf16 v[236:239], v[56:59], a[12:15], 0
  s_add_u32 m0, s33, 73728
  buffer_load_dwordx2 v[124:125], v90, s[68:71], s65 offen offset:3072 sc1
  v_mfma_f32_16x16x32_bf16 v[236:239], v[60:63], a[28:31], v[236:239]
  s_mov_b32 s34, 221312
  buffer_load_dwordx2 v[126:127], v90, s[68:71], s65 offen offset:3584 sc1
  v_mfma_f32_16x16x32_bf16 v[236:239], v[64:67], a[44:47], v[236:239]
  buffer_load_dwordx4 v84, s[12:15], s34 offen lds
  s_waitcnt lgkmcnt(0)
  v_mfma_f32_16x16x32_bf16 v[240:243], v[68:71], a[0:3], 0
  ds_read_b64_tr_b16 v[56:57], v8 offset:53248
  v_mfma_f32_16x16x32_bf16 v[240:243], v[72:75], a[16:19], v[240:243]
  ds_read_b64_tr_b16 v[58:59], v8 offset:55296
  v_mfma_f32_16x16x32_bf16 v[240:243], v[76:79], a[32:35], v[240:243]
  ds_read_b64_tr_b16 v[60:61], v8 offset:20480
  v_mfma_f32_16x16x32_bf16 v[244:247], v[68:71], a[4:7], 0
  ds_read_b64_tr_b16 v[62:63], v8 offset:22528
  v_mfma_f32_16x16x32_bf16 v[244:247], v[72:75], a[20:23], v[244:247]
  ds_read_b64_tr_b16 v[64:65], v8 offset:24576
  v_mfma_f32_16x16x32_bf16 v[244:247], v[76:79], a[36:39], v[244:247]
  ds_read_b64_tr_b16 v[66:67], v8 offset:26624
  v_mfma_f32_16x16x32_bf16 v[248:251], v[68:71], a[8:11], 0
  s_add_u32 m0, s33, 57344
  v_mfma_f32_16x16x32_bf16 v[248:251], v[72:75], a[24:27], v[248:251]
  s_mov_b32 s34, 258176
  v_mfma_f32_16x16x32_bf16 v[248:251], v[76:79], a[40:43], v[248:251]
  buffer_load_dwordx4 v84, s[12:15], s34 offen lds
  v_mfma_f32_16x16x32_bf16 v[252:255], v[68:71], a[12:15], 0
  s_add_u32 m0, s33, 61440
  v_mfma_f32_16x16x32_bf16 v[252:255], v[72:75], a[28:31], v[252:255]
  s_mov_b32 s34, 128
  v_mfma_f32_16x16x32_bf16 v[252:255], v[76:79], a[44:47], v[252:255]
  buffer_load_dwordx4 v85, s[12:15], s34 offen lds
  s_waitcnt lgkmcnt(0)
  v_mfma_f32_16x16x32_bf16 v[224:227], v[56:59], a[48:51], v[224:227]
  s_barrier
  v_mfma_f32_16x16x32_bf16 v[224:227], v[60:63], a[64:67], v[224:227]
  ds_read_b64_tr_b16 v[68:69], v11 offset:53248
  v_mfma_f32_16x16x32_bf16 v[224:227], v[64:67], a[80:83], v[224:227]
  ds_read_b64_tr_b16 v[70:71], v11 offset:55296
  v_mfma_f32_16x16x32_bf16 v[228:231], v[56:59], a[52:55], v[228:231]
  ds_read_b64_tr_b16 v[72:73], v11 offset:20480
  v_mfma_f32_16x16x32_bf16 v[228:231], v[60:63], a[68:71], v[228:231]
  ds_read_b64_tr_b16 v[74:75], v11 offset:22528
  v_mfma_f32_16x16x32_bf16 v[228:231], v[64:67], a[84:87], v[228:231]
  ds_read_b64_tr_b16 v[76:77], v11 offset:24576
  v_mfma_f32_16x16x32_bf16 v[232:235], v[56:59], a[56:59], v[232:235]
  ds_read_b64_tr_b16 v[78:79], v11 offset:26624
  v_mfma_f32_16x16x32_bf16 v[232:235], v[60:63], a[72:75], v[232:235]
  s_add_u32 m0, s33, 77824
  v_mfma_f32_16x16x32_bf16 v[232:235], v[64:67], a[88:91], v[232:235]
  s_mov_b32 s34, 256
  v_mfma_f32_16x16x32_bf16 v[236:239], v[56:59], a[60:63], v[236:239]
  buffer_load_dwordx4 v82, s[12:15], s34 offen lds
  v_mfma_f32_16x16x32_bf16 v[236:239], v[60:63], a[76:79], v[236:239]
  s_add_u32 m0, s33, 0
  v_mfma_f32_16x16x32_bf16 v[236:239], v[64:67], a[92:95], v[236:239]
  s_mov_b32 s34, 37120
  buffer_load_dwordx4 v82, s[12:15], s34 offen lds
  s_waitcnt lgkmcnt(0)
  v_mfma_f32_16x16x32_bf16 v[240:243], v[68:71], a[48:51], v[240:243]
  ds_read_b64_tr_b16 v[56:57], v10 offset:20480
  v_mfma_f32_16x16x32_bf16 v[240:243], v[72:75], a[64:67], v[240:243]
  ds_read_b64_tr_b16 v[58:59], v10 offset:22528
  v_mfma_f32_16x16x32_bf16 v[240:243], v[76:79], a[80:83], v[240:243]
  ds_read_b64_tr_b16 v[60:61], v9 offset:49152
  v_mfma_f32_16x16x32_bf16 v[244:247], v[68:71], a[52:55], v[244:247]
  ds_read_b64_tr_b16 v[62:63], v9 offset:51200
  v_mfma_f32_16x16x32_bf16 v[244:247], v[72:75], a[68:71], v[244:247]
  ds_read_b64_tr_b16 v[64:65], v8 offset:28672
  v_mfma_f32_16x16x32_bf16 v[244:247], v[76:79], a[84:87], v[244:247]
  ds_read_b64_tr_b16 v[66:67], v8 offset:30720
  v_mfma_f32_16x16x32_bf16 v[248:251], v[68:71], a[56:59], v[248:251]
  s_add_u32 m0, s33, 126976
  v_mfma_f32_16x16x32_bf16 v[248:251], v[72:75], a[72:75], v[248:251]
  s_mov_b32 s34, 73984
  v_mfma_f32_16x16x32_bf16 v[248:251], v[76:79], a[88:91], v[248:251]
  buffer_load_dwordx4 v82, s[12:15], s34 offen lds
  v_mfma_f32_16x16x32_bf16 v[252:255], v[68:71], a[60:63], v[252:255]
  s_add_u32 m0, s33, 131072
  v_mfma_f32_16x16x32_bf16 v[252:255], v[72:75], a[76:79], v[252:255]
  s_mov_b32 s34, 110848
  v_mfma_f32_16x16x32_bf16 v[252:255], v[76:79], a[92:95], v[252:255]
  buffer_load_dwordx4 v82, s[12:15], s34 offen lds
  s_waitcnt lgkmcnt(0)
  v_mfma_f32_16x16x32_bf16 v[192:195], v[56:59], a[240:243], v[192:195]
  ds_read_b64_tr_b16 v[68:69], v13 offset:20480
  v_mfma_f32_16x16x32_bf16 v[192:195], v[60:63], v[96:99], v[192:195]
  ds_read_b64_tr_b16 v[70:71], v13 offset:22528
  s_waitcnt vmcnt(14)
  v_mfma_f32_16x16x32_bf16 v[192:195], v[64:67], v[112:115], v[192:195]
  ds_read_b64_tr_b16 v[72:73], v12 offset:49152
  v_mfma_f32_16x16x32_bf16 v[196:199], v[56:59], a[244:247], v[196:199]
  ds_read_b64_tr_b16 v[74:75], v12 offset:51200
  v_mfma_f32_16x16x32_bf16 v[196:199], v[60:63], v[100:103], v[196:199]
  ds_read_b64_tr_b16 v[76:77], v11 offset:28672
  s_waitcnt vmcnt(12)
  v_mfma_f32_16x16x32_bf16 v[196:199], v[64:67], v[116:119], v[196:199]
  ds_read_b64_tr_b16 v[78:79], v11 offset:30720
  v_mfma_f32_16x16x32_bf16 v[200:203], v[56:59], a[248:251], v[200:203]
  s_add_u32 m0, s33, 90112
  v_mfma_f32_16x16x32_bf16 v[200:203], v[60:63], v[104:107], v[200:203]
  s_mov_b32 s34, 147712
  s_waitcnt vmcnt(9)
  v_mfma_f32_16x16x32_bf16 v[200:203], v[64:67], v[120:123], v[200:203]
  buffer_load_dwordx4 v82, s[12:15], s34 offen lds
  v_mfma_f32_16x16x32_bf16 v[204:207], v[56:59], a[252:255], v[204:207]
  s_add_u32 m0, s33, 94208
  v_mfma_f32_16x16x32_bf16 v[204:207], v[60:63], v[108:111], v[204:207]
  s_mov_b32 s34, 184576
  s_waitcnt vmcnt(8)
  v_mfma_f32_16x16x32_bf16 v[204:207], v[64:67], v[124:127], v[204:207]
  buffer_load_dwordx4 v82, s[12:15], s34 offen lds
  s_waitcnt lgkmcnt(0)
  v_mfma_f32_16x16x32_bf16 v[208:211], v[68:71], a[240:243], v[208:211]
  s_barrier
  v_mfma_f32_16x16x32_bf16 v[208:211], v[72:75], v[96:99], v[208:211]
  ds_read_b64_tr_b16 v[56:57], v10 offset:24576
  v_mfma_f32_16x16x32_bf16 v[208:211], v[76:79], v[112:115], v[208:211]
  ds_read_b64_tr_b16 v[58:59], v10 offset:26624
  v_mfma_f32_16x16x32_bf16 v[212:215], v[68:71], a[244:247], v[212:215]
  ds_read_b64_tr_b16 v[60:61], v9 offset:53248
  v_mfma_f32_16x16x32_bf16 v[212:215], v[72:75], v[100:103], v[212:215]
  ds_read_b64_tr_b16 v[62:63], v9 offset:55296
  v_mfma_f32_16x16x32_bf16 v[212:215], v[76:79], v[116:119], v[212:215]
  ds_read_b64_tr_b16 v[64:65], v10 offset:28672
  v_mfma_f32_16x16x32_bf16 v[216:219], v[68:71], a[248:251], v[216:219]
  ds_read_b64_tr_b16 v[66:67], v10 offset:30720
  v_mfma_f32_16x16x32_bf16 v[216:219], v[72:75], v[104:107], v[216:219]
  s_add_u32 m0, s33, 135168
  v_mfma_f32_16x16x32_bf16 v[216:219], v[76:79], v[120:123], v[216:219]
  s_mov_b32 s34, 221440
  v_mfma_f32_16x16x32_bf16 v[220:223], v[68:71], a[252:255], v[220:223]
  buffer_load_dwordx4 v82, s[12:15], s34 offen lds
  v_mfma_f32_16x16x32_bf16 v[220:223], v[72:75], v[108:111], v[220:223]
  s_add_u32 m0, s33, 98304
  v_mfma_f32_16x16x32_bf16 v[220:223], v[76:79], v[124:127], v[220:223]
  s_mov_b32 s34, 258304
  buffer_load_dwordx4 v82, s[12:15], s34 offen lds
  s_waitcnt lgkmcnt(0)
  v_mfma_f32_16x16x32_bf16 v[224:227], v[56:59], a[96:99], v[224:227]
  ds_read_b64_tr_b16 v[68:69], v13 offset:24576
  v_mfma_f32_16x16x32_bf16 v[224:227], v[60:63], a[112:115], v[224:227]
  ds_read_b64_tr_b16 v[70:71], v13 offset:26624
  v_cvt_pk_bf16_f32 v40, v192, v193
  v_mfma_f32_16x16x32_bf16 v[224:227], v[64:67], a[128:131], v[224:227]
  ds_read_b64_tr_b16 v[72:73], v12 offset:53248
  v_cvt_pk_bf16_f32 v41, v194, v195
  v_mfma_f32_16x16x32_bf16 v[228:231], v[56:59], a[100:103], v[228:231]
  ds_read_b64_tr_b16 v[74:75], v12 offset:55296
  v_cvt_pk_bf16_f32 v42, v208, v209
  v_mfma_f32_16x16x32_bf16 v[228:231], v[60:63], a[116:119], v[228:231]
  ds_read_b64_tr_b16 v[76:77], v13 offset:28672
  v_cvt_pk_bf16_f32 v43, v210, v211
  v_mfma_f32_16x16x32_bf16 v[228:231], v[64:67], a[132:135], v[228:231]
  ds_read_b64_tr_b16 v[78:79], v13 offset:30720
  s_mov_b32 s35, 0
  v_mfma_f32_16x16x32_bf16 v[232:235], v[56:59], a[104:107], v[232:235]
  s_add_u32 m0, s33, 4096
  buffer_store_dwordx4 v[40:43], v191, s[20:23], s35 offen sc1
  v_mfma_f32_16x16x32_bf16 v[232:235], v[60:63], a[120:123], v[232:235]
  s_mov_b32 s34, 256
  v_cvt_pk_bf16_f32 v44, v196, v197
  v_mfma_f32_16x16x32_bf16 v[232:235], v[64:67], a[136:139], v[232:235]
  buffer_load_dwordx4 v83, s[12:15], s34 offen lds
  v_cvt_pk_bf16_f32 v45, v198, v199
  v_mfma_f32_16x16x32_bf16 v[236:239], v[56:59], a[108:111], v[236:239]
  s_add_u32 m0, s33, 81920
  v_cvt_pk_bf16_f32 v46, v212, v213
  v_mfma_f32_16x16x32_bf16 v[236:239], v[60:63], a[124:127], v[236:239]
  s_mov_b32 s34, 256
  v_cvt_pk_bf16_f32 v47, v214, v215
  v_mfma_f32_16x16x32_bf16 v[236:239], v[64:67], a[140:143], v[236:239]
  buffer_load_dwordx4 v84, s[12:15], s34 offen lds
  s_waitcnt lgkmcnt(0)
  v_mfma_f32_16x16x32_bf16 v[240:243], v[68:71], a[96:99], v[240:243]
  ds_read_b64_tr_b16 v[56:57], v9 offset:57344
  v_cvt_pk_bf16_f32 v48, v200, v201
  v_mfma_f32_16x16x32_bf16 v[240:243], v[72:75], a[112:115], v[240:243]
  ds_read_b64_tr_b16 v[58:59], v9 offset:59392
  v_cvt_pk_bf16_f32 v49, v202, v203
  v_mfma_f32_16x16x32_bf16 v[240:243], v[76:79], a[128:131], v[240:243]
  ds_read_b64_tr_b16 v[60:61], v8 offset:32768
  v_cvt_pk_bf16_f32 v50, v216, v217
  v_mfma_f32_16x16x32_bf16 v[244:247], v[68:71], a[100:103], v[244:247]
  ds_read_b64_tr_b16 v[62:63], v8 offset:34816
  v_cvt_pk_bf16_f32 v51, v218, v219
  v_mfma_f32_16x16x32_bf16 v[244:247], v[72:75], a[116:119], v[244:247]
  ds_read_b64_tr_b16 v[64:65], v8 offset:36864
  v_cvt_pk_bf16_f32 v52, v204, v205
  v_mfma_f32_16x16x32_bf16 v[244:247], v[76:79], a[132:135], v[244:247]
  ds_read_b64_tr_b16 v[66:67], v8 offset:38912
  v_cvt_pk_bf16_f32 v53, v206, v207
  v_mfma_f32_16x16x32_bf16 v[248:251], v[68:71], a[104:107], v[248:251]
  s_add_u32 m0, s33, 86016
  v_cvt_pk_bf16_f32 v54, v220, v221
  v_mfma_f32_16x16x32_bf16 v[248:251], v[72:75], a[120:123], v[248:251]
  s_mov_b32 s34, 37120
  v_cvt_pk_bf16_f32 v55, v222, v223
  v_mfma_f32_16x16x32_bf16 v[248:251], v[76:79], a[136:139], v[248:251]
  buffer_load_dwordx4 v84, s[12:15], s34 offen lds
  v_mfma_f32_16x16x32_bf16 v[252:255], v[68:71], a[108:111], v[252:255]
  s_add_u32 m0, s33, 8192
  v_mfma_f32_16x16x32_bf16 v[252:255], v[72:75], a[124:127], v[252:255]
  s_mov_b32 s34, 73984
  v_mfma_f32_16x16x32_bf16 v[252:255], v[76:79], a[140:143], v[252:255]
  buffer_load_dwordx4 v84, s[12:15], s34 offen lds
  s_waitcnt lgkmcnt(0)
  v_mfma_f32_16x16x32_bf16 v[224:227], v[56:59], a[144:147], v[224:227]
  s_barrier
  v_mfma_f32_16x16x32_bf16 v[224:227], v[60:63], a[160:163], v[224:227]
  ds_read_b64_tr_b16 v[68:69], v12 offset:57344
  v_mfma_f32_16x16x32_bf16 v[224:227], v[64:67], a[176:179], v[224:227]
  ds_read_b64_tr_b16 v[70:71], v12 offset:59392
  v_mfma_f32_16x16x32_bf16 v[228:231], v[56:59], a[148:151], v[228:231]
  ds_read_b64_tr_b16 v[72:73], v11 offset:32768
  v_mfma_f32_16x16x32_bf16 v[228:231], v[60:63], a[164:167], v[228:231]
  ds_read_b64_tr_b16 v[74:75], v11 offset:34816
  v_mfma_f32_16x16x32_bf16 v[228:231], v[64:67], a[180:183], v[228:231]
  ds_read_b64_tr_b16 v[76:77], v11 offset:36864
  v_mfma_f32_16x16x32_bf16 v[232:235], v[56:59], a[152:155], v[232:235]
  ds_read_b64_tr_b16 v[78:79], v11 offset:38912
  v_mfma_f32_16x16x32_bf16 v[232:235], v[60:63], a[168:171], v[232:235]
  s_add_u32 m0, s33, 139264
  s_mov_b32 s35, 18432
  v_mfma_f32_16x16x32_bf16 v[232:235], v[64:67], a[184:187], v[232:235]
  s_mov_b32 s34, 110848
  buffer_store_dwordx4 v[44:47], v191, s[20:23], s35 offen sc1
  v_mfma_f32_16x16x32_bf16 v[236:239], v[56:59], a[156:159], v[236:239]
  buffer_load_dwordx4 v84, s[12:15], s34 offen lds
  v_mfma_f32_16x16x32_bf16 v[236:239], v[60:63], a[172:175], v[236:239]
  s_add_u32 m0, s33, 102400
  v_mfma_f32_16x16x32_bf16 v[236:239], v[64:67], a[188:191], v[236:239]
  s_mov_b32 s34, 147712
  buffer_load_dwordx4 v84, s[12:15], s34 offen lds
  s_waitcnt lgkmcnt(0)
  v_mfma_f32_16x16x32_bf16 v[240:243], v[68:71], a[144:147], v[240:243]
  ds_read_b64_tr_b16 v[56:57], v8 offset:40960
  v_mfma_f32_16x16x32_bf16 v[240:243], v[72:75], a[160:163], v[240:243]
  ds_read_b64_tr_b16 v[58:59], v8 offset:43008
  v_mfma_f32_16x16x32_bf16 v[240:243], v[76:79], a[176:179], v[240:243]
  ds_read_b64_tr_b16 v[60:61], v9
  v_mfma_f32_16x16x32_bf16 v[244:247], v[68:71], a[148:151], v[244:247]
  ds_read_b64_tr_b16 v[62:63], v9 offset:2048
  v_mfma_f32_16x16x32_bf16 v[244:247], v[72:75], a[164:167], v[244:247]
  ds_read_b64_tr_b16 v[64:65], v9 offset:4096
  v_mfma_f32_16x16x32_bf16 v[244:247], v[76:79], a[180:183], v[244:247]
  ds_read_b64_tr_b16 v[66:67], v9 offset:6144
  v_mfma_f32_16x16x32_bf16 v[248:251], v[68:71], a[152:155], v[248:251]
  s_add_u32 m0, s33, 143360
  v_mfma_f32_16x16x32_bf16 v[248:251], v[72:75], a[168:171], v[248:251]
  s_mov_b32 s34, 184576
  v_mfma_f32_16x16x32_bf16 v[248:251], v[76:79], a[184:187], v[248:251]
  buffer_load_dwordx4 v84, s[12:15], s34 offen lds
  s_mov_b32 s35, 36864
  v_mfma_f32_16x16x32_bf16 v[252:255], v[68:71], a[156:159], v[252:255]
  s_add_u32 m0, s33, 147456
  buffer_store_dwordx4 v[48:51], v191, s[20:23], s35 offen sc1
  v_mfma_f32_16x16x32_bf16 v[252:255], v[72:75], a[172:175], v[252:255]
  s_mov_b32 s34, 221440
  v_mfma_f32_16x16x32_bf16 v[252:255], v[76:79], a[188:191], v[252:255]
  buffer_load_dwordx4 v84, s[12:15], s34 offen lds
  s_waitcnt lgkmcnt(0)
  v_mfma_f32_16x16x32_bf16 v[224:227], v[56:59], a[192:195], v[224:227]
  ds_read_b64_tr_b16 v[68:69], v11 offset:40960
  v_mfma_f32_16x16x32_bf16 v[224:227], v[60:63], a[208:211], v[224:227]
  ds_read_b64_tr_b16 v[70:71], v11 offset:43008
  v_mfma_f32_16x16x32_bf16 v[224:227], v[64:67], a[224:227], v[224:227]
  ds_read_b64_tr_b16 v[72:73], v12
  v_mfma_f32_16x16x32_bf16 v[228:231], v[56:59], a[196:199], v[228:231]
  ds_read_b64_tr_b16 v[74:75], v12 offset:2048
  v_mfma_f32_16x16x32_bf16 v[228:231], v[60:63], a[212:215], v[228:231]
  ds_read_b64_tr_b16 v[76:77], v12 offset:4096
  v_mfma_f32_16x16x32_bf16 v[228:231], v[64:67], a[228:231], v[228:231]
  ds_read_b64_tr_b16 v[78:79], v12 offset:6144
  v_mfma_f32_16x16x32_bf16 v[232:235], v[56:59], a[200:203], v[232:235]
  s_add_u32 m0, s33, 106496
  v_mfma_f32_16x16x32_bf16 v[232:235], v[60:63], a[216:219], v[232:235]
  s_mov_b32 s34, 258304
  v_mfma_f32_16x16x32_bf16 v[232:235], v[64:67], a[232:235], v[232:235]
  buffer_load_dwordx4 v84, s[12:15], s34 offen lds
  v_mfma_f32_16x16x32_bf16 v[236:239], v[56:59], a[204:207], v[236:239]
  s_add_u32 m0, s33, 110592
  s_mov_b32 s35, 55296
  v_mfma_f32_16x16x32_bf16 v[236:239], v[60:63], a[220:223], v[236:239]
  s_mov_b32 s34, 256
  buffer_store_dwordx4 v[52:55], v191, s[20:23], s35 offen sc1
  v_mfma_f32_16x16x32_bf16 v[236:239], v[64:67], a[236:239], v[236:239]
  buffer_load_dwordx4 v85, s[12:15], s34 offen lds
  s_waitcnt lgkmcnt(0)
  v_mfma_f32_16x16x32_bf16 v[240:243], v[68:71], a[192:195], v[240:243]
  s_waitcnt vmcnt(19)
  s_barrier
  v_mfma_f32_16x16x32_bf16 v[240:243], v[72:75], a[208:211], v[240:243]
  ds_read_b64_tr_b16 v[56:57], v9 offset:8192
  v_mfma_f32_16x16x32_bf16 v[240:243], v[76:79], a[224:227], v[240:243]
  ds_read_b64_tr_b16 v[58:59], v9 offset:10240
  v_mfma_f32_16x16x32_bf16 v[244:247], v[68:71], a[196:199], v[244:247]
  ds_read_b64_tr_b16 v[60:61], v8 offset:57344
  v_mfma_f32_16x16x32_bf16 v[244:247], v[72:75], a[212:215], v[244:247]
  ds_read_b64_tr_b16 v[62:63], v8 offset:59392
  v_mfma_f32_16x16x32_bf16 v[244:247], v[76:79], a[228:231], v[244:247]
  ds_read_b64_tr_b16 v[64:65], v8 offset:61440
  v_mfma_f32_16x16x32_bf16 v[248:251], v[68:71], a[200:203], v[248:251]
  ds_read_b64_tr_b16 v[66:67], v8 offset:63488
  v_mfma_f32_16x16x32_bf16 v[248:251], v[72:75], a[216:219], v[248:251]
  s_add_u32 m0, s33, 12288
  v_mfma_f32_16x16x32_bf16 v[248:251], v[76:79], a[232:235], v[248:251]
  s_mov_b32 s34, 384
  v_mfma_f32_16x16x32_bf16 v[252:255], v[68:71], a[204:207], v[252:255]
  buffer_load_dwordx4 v82, s[12:15], s34 offen lds
  v_mfma_f32_16x16x32_bf16 v[252:255], v[72:75], a[220:223], v[252:255]
  s_add_u32 m0, s33, 16384
  v_mfma_f32_16x16x32_bf16 v[252:255], v[76:79], a[236:239], v[252:255]
  s_mov_b32 s34, 37248
  buffer_load_dwordx4 v82, s[12:15], s34 offen lds
  s_waitcnt lgkmcnt(0)
  v_mfma_f32_16x16x32_bf16 v[224:227], v[56:59], a[240:243], v[224:227]
  ds_read_b64_tr_b16 v[68:69], v12 offset:8192
  v_mfma_f32_16x16x32_bf16 v[224:227], v[60:63], v[96:99], v[224:227]
  ds_read_b64_tr_b16 v[70:71], v12 offset:10240
  v_mfma_f32_16x16x32_bf16 v[224:227], v[64:67], v[112:115], v[224:227]
  ds_read_b64_tr_b16 v[72:73], v11 offset:57344
  v_mfma_f32_16x16x32_bf16 v[228:231], v[56:59], a[244:247], v[228:231]
  ds_read_b64_tr_b16 v[74:75], v11 offset:59392
  v_mfma_f32_16x16x32_bf16 v[228:231], v[60:63], v[100:103], v[228:231]
  ds_read_b64_tr_b16 v[76:77], v11 offset:61440
  v_mfma_f32_16x16x32_bf16 v[228:231], v[64:67], v[116:119], v[228:231]
  ds_read_b64_tr_b16 v[78:79], v11 offset:63488
  v_mfma_f32_16x16x32_bf16 v[232:235], v[56:59], a[248:251], v[232:235]
  s_add_u32 m0, s33, 45056
  v_mfma_f32_16x16x32_bf16 v[232:235], v[60:63], v[104:107], v[232:235]
  s_mov_b32 s34, 74112
  v_mfma_f32_16x16x32_bf16 v[232:235], v[64:67], v[120:123], v[232:235]
  buffer_load_dwordx4 v82, s[12:15], s34 offen lds
  v_mfma_f32_16x16x32_bf16 v[236:239], v[56:59], a[252:255], v[236:239]
  v_mfma_f32_16x16x32_bf16 v[236:239], v[60:63], v[108:111], v[236:239]
  v_mfma_f32_16x16x32_bf16 v[236:239], v[64:67], v[124:127], v[236:239]
  s_waitcnt lgkmcnt(0)
  v_mfma_f32_16x16x32_bf16 v[240:243], v[68:71], a[240:243], v[240:243]
  ds_read_b64_tr_b16 v[56:57], v9 offset:12288
  v_mfma_f32_16x16x32_bf16 v[240:243], v[72:75], v[96:99], v[240:243]
  ds_read_b64_tr_b16 v[58:59], v9 offset:14336
  v_mfma_f32_16x16x32_bf16 v[240:243], v[76:79], v[112:115], v[240:243]
  ds_read_b64_tr_b16 v[60:61], v8
  v_mfma_f32_16x16x32_bf16 v[244:247], v[68:71], a[244:247], v[244:247]
  ds_read_b64_tr_b16 v[62:63], v8 offset:2048
  v_mfma_f32_16x16x32_bf16 v[244:247], v[72:75], v[100:103], v[244:247]
  ds_read_b64_tr_b16 v[64:65], v9 offset:61440
  v_mfma_f32_16x16x32_bf16 v[244:247], v[76:79], v[116:119], v[244:247]
  ds_read_b64_tr_b16 v[66:67], v9 offset:63488
  v_mfma_f32_16x16x32_bf16 v[248:251], v[68:71], a[248:251], v[248:251]
  s_add_u32 m0, s33, 49152
  v_mfma_f32_16x16x32_bf16 v[248:251], v[72:75], v[104:107], v[248:251]
  s_mov_b32 s34, 110976
  v_mfma_f32_16x16x32_bf16 v[248:251], v[76:79], v[120:123], v[248:251]
  buffer_load_dwordx4 v82, s[12:15], s34 offen lds
  v_mfma_f32_16x16x32_bf16 v[252:255], v[68:71], a[252:255], v[252:255]
  s_add_u32 m0, s33, 53248
  v_mfma_f32_16x16x32_bf16 v[252:255], v[72:75], v[108:111], v[252:255]
  s_mov_b32 s34, 147840
  v_mfma_f32_16x16x32_bf16 v[252:255], v[76:79], v[124:127], v[252:255]
  buffer_load_dwordx4 v82, s[12:15], s34 offen lds
  s_waitcnt lgkmcnt(0)
  v_mfma_f32_16x16x32_bf16 v[192:195], v[56:59], a[0:3], 0
  s_waitcnt vmcnt(21)
  s_barrier
  v_mfma_f32_16x16x32_bf16 v[192:195], v[60:63], a[16:19], v[192:195]
  ds_read_b64_tr_b16 v[68:69], v12 offset:12288
  v_cvt_pk_bf16_f32 v40, v224, v225
  v_mfma_f32_16x16x32_bf16 v[192:195], v[64:67], a[32:35], v[192:195]
  ds_read_b64_tr_b16 v[70:71], v12 offset:14336
  v_cvt_pk_bf16_f32 v41, v226, v227
  v_mfma_f32_16x16x32_bf16 v[196:199], v[56:59], a[4:7], 0
  ds_read_b64_tr_b16 v[72:73], v11
  v_cvt_pk_bf16_f32 v42, v240, v241
  v_mfma_f32_16x16x32_bf16 v[196:199], v[60:63], a[20:23], v[196:199]
  ds_read_b64_tr_b16 v[74:75], v11 offset:2048
  v_cvt_pk_bf16_f32 v43, v242, v243
  v_mfma_f32_16x16x32_bf16 v[196:199], v[64:67], a[36:39], v[196:199]
  ds_read_b64_tr_b16 v[76:77], v12 offset:61440
  s_mov_b32 s35, 2048
  v_mfma_f32_16x16x32_bf16 v[200:203], v[56:59], a[8:11], 0
  ds_read_b64_tr_b16 v[78:79], v12 offset:63488
  buffer_store_dwordx4 v[40:43], v191, s[20:23], s35 offen sc1
  v_mfma_f32_16x16x32_bf16 v[200:203], v[60:63], a[24:27], v[200:203]
  s_add_u32 m0, s33, 20480
  v_cvt_pk_bf16_f32 v44, v228, v229
  v_mfma_f32_16x16x32_bf16 v[200:203], v[64:67], a[40:43], v[200:203]
  s_mov_b32 s34, 184704
  v_cvt_pk_bf16_f32 v45, v230, v231
  v_mfma_f32_16x16x32_bf16 v[204:207], v[56:59], a[12:15], 0
  buffer_load_dwordx4 v82, s[12:15], s34 offen lds
  v_cvt_pk_bf16_f32 v46, v244, v245
  v_mfma_f32_16x16x32_bf16 v[204:207], v[60:63], a[28:31], v[204:207]
  v_cvt_pk_bf16_f32 v47, v246, v247
  v_cvt_pk_bf16_f32 v48, v232, v233
  v_mfma_f32_16x16x32_bf16 v[204:207], v[64:67], a[44:47], v[204:207]
  v_cvt_pk_bf16_f32 v49, v234, v235
  s_waitcnt lgkmcnt(0)
  v_mfma_f32_16x16x32_bf16 v[208:211], v[68:71], a[0:3], 0
  s_waitcnt vmcnt(8)
  s_barrier
  s_mov_b32 s63, 262144
  buffer_store_dword v7, v29, s[96:99], s63 offen sc1
  ds_read_b64_tr_b16 v[56:57], v10
  v_mfma_f32_16x16x32_bf16 v[208:211], v[72:75], a[16:19], v[208:211]
  ds_read_b64_tr_b16 v[58:59], v10 offset:2048
  v_cvt_pk_bf16_f32 v50, v248, v249
  v_mfma_f32_16x16x32_bf16 v[208:211], v[76:79], a[32:35], v[208:211]
  ds_read_b64_tr_b16 v[60:61], v9 offset:24576
  v_cvt_pk_bf16_f32 v51, v250, v251
  v_mfma_f32_16x16x32_bf16 v[212:215], v[68:71], a[4:7], 0
  ds_read_b64_tr_b16 v[62:63], v9 offset:26624
  v_cvt_pk_bf16_f32 v52, v236, v237
  v_mfma_f32_16x16x32_bf16 v[212:215], v[72:75], a[20:23], v[212:215]
  ds_read_b64_tr_b16 v[64:65], v9 offset:28672
  v_cvt_pk_bf16_f32 v53, v238, v239
  v_mfma_f32_16x16x32_bf16 v[212:215], v[76:79], a[36:39], v[212:215]
  ds_read_b64_tr_b16 v[66:67], v9 offset:30720
  v_cvt_pk_bf16_f32 v54, v252, v253
  v_mfma_f32_16x16x32_bf16 v[216:219], v[68:71], a[8:11], 0
  s_add_u32 m0, s33, 24576
  v_cvt_pk_bf16_f32 v55, v254, v255
  v_mfma_f32_16x16x32_bf16 v[216:219], v[72:75], a[24:27], v[216:219]
  s_mov_b32 s34, 221568
  v_mfma_f32_16x16x32_bf16 v[216:219], v[76:79], a[40:43], v[216:219]
  buffer_load_dwordx4 v82, s[12:15], s34 offen lds
  v_mfma_f32_16x16x32_bf16 v[220:223], v[68:71], a[12:15], 0
  s_add_u32 m0, s33, 151552
  v_mfma_f32_16x16x32_bf16 v[220:223], v[72:75], a[28:31], v[220:223]
  s_mov_b32 s34, 258432
  v_mfma_f32_16x16x32_bf16 v[220:223], v[76:79], a[44:47], v[220:223]
  buffer_load_dwordx4 v82, s[12:15], s34 offen lds
  s_waitcnt lgkmcnt(0)
  v_mfma_f32_16x16x32_bf16 v[192:195], v[56:59], a[48:51], v[192:195]
  ds_read_b64_tr_b16 v[68:69], v13
  v_mfma_f32_16x16x32_bf16 v[192:195], v[60:63], a[64:67], v[192:195]
  ds_read_b64_tr_b16 v[70:71], v13 offset:2048
  v_mfma_f32_16x16x32_bf16 v[192:195], v[64:67], a[80:83], v[192:195]
  ds_read_b64_tr_b16 v[72:73], v12 offset:24576
  v_mfma_f32_16x16x32_bf16 v[196:199], v[56:59], a[52:55], v[196:199]
  ds_read_b64_tr_b16 v[74:75], v12 offset:26624
  v_mfma_f32_16x16x32_bf16 v[196:199], v[60:63], a[68:71], v[196:199]
  ds_read_b64_tr_b16 v[76:77], v12 offset:28672
  v_mfma_f32_16x16x32_bf16 v[196:199], v[64:67], a[84:87], v[196:199]
  ds_read_b64_tr_b16 v[78:79], v12 offset:30720
  v_mfma_f32_16x16x32_bf16 v[200:203], v[56:59], a[56:59], v[200:203]
  s_add_u32 m0, s33, 114688
  s_mov_b32 s35, 20480
  v_mfma_f32_16x16x32_bf16 v[200:203], v[60:63], a[72:75], v[200:203]
  s_mov_b32 s34, 384
  buffer_store_dwordx4 v[44:47], v191, s[20:23], s35 offen sc1
  v_mfma_f32_16x16x32_bf16 v[200:203], v[64:67], a[88:91], v[200:203]
  buffer_load_dwordx4 v83, s[12:15], s34 offen lds
  v_mfma_f32_16x16x32_bf16 v[204:207], v[56:59], a[60:63], v[204:207]
  v_mfma_f32_16x16x32_bf16 v[204:207], v[60:63], a[76:79], v[204:207]
  v_mfma_f32_16x16x32_bf16 v[204:207], v[64:67], a[92:95], v[204:207]
  s_waitcnt lgkmcnt(0)
  v_mfma_f32_16x16x32_bf16 v[208:211], v[68:71], a[48:51], v[208:211]
  s_barrier
  v_mfma_f32_16x16x32_bf16 v[208:211], v[72:75], a[64:67], v[208:211]
  ds_read_b64_tr_b16 v[56:57], v10 offset:4096
  v_mfma_f32_16x16x32_bf16 v[208:211], v[76:79], a[80:83], v[208:211]
  ds_read_b64_tr_b16 v[58:59], v10 offset:6144
  v_mfma_f32_16x16x32_bf16 v[212:215], v[68:71], a[52:55], v[212:215]
  ds_read_b64_tr_b16 v[60:61], v9 offset:32768
  v_mfma_f32_16x16x32_bf16 v[212:215], v[72:75], a[68:71], v[212:215]
  ds_read_b64_tr_b16 v[62:63], v9 offset:34816
  v_mfma_f32_16x16x32_bf16 v[212:215], v[76:79], a[84:87], v[212:215]
  ds_read_b64_tr_b16 v[64:65], v8 offset:4096
  v_mfma_f32_16x16x32_bf16 v[216:219], v[68:71], a[56:59], v[216:219]
  ds_read_b64_tr_b16 v[66:67], v8 offset:6144
  v_mfma_f32_16x16x32_bf16 v[216:219], v[72:75], a[72:75], v[216:219]
  s_add_u32 m0, s33, 155648
  s_mov_b32 s35, 38912
  v_mfma_f32_16x16x32_bf16 v[216:219], v[76:79], a[88:91], v[216:219]
  s_mov_b32 s34, 384
  buffer_store_dwordx4 v[48:51], v191, s[20:23], s35 offen sc1
  v_mfma_f32_16x16x32_bf16 v[220:223], v[68:71], a[60:63], v[220:223]
  buffer_load_dwordx4 v84, s[12:15], s34 offen lds
  v_mfma_f32_16x16x32_bf16 v[220:223], v[72:75], a[76:79], v[220:223]
  s_add_u32 m0, s33, 118784
  v_mfma_f32_16x16x32_bf16 v[220:223], v[76:79], a[92:95], v[220:223]
  s_mov_b32 s34, 37248
  buffer_load_dwordx4 v84, s[12:15], s34 offen lds
  s_waitcnt lgkmcnt(0)
  v_mfma_f32_16x16x32_bf16 v[192:195], v[56:59], a[96:99], v[192:195]
  ds_read_b64_tr_b16 v[68:69], v13 offset:4096
  v_mfma_f32_16x16x32_bf16 v[192:195], v[60:63], a[112:115], v[192:195]
  ds_read_b64_tr_b16 v[70:71], v13 offset:6144
  v_mfma_f32_16x16x32_bf16 v[192:195], v[64:67], a[128:131], v[192:195]
  ds_read_b64_tr_b16 v[72:73], v12 offset:32768
  v_mfma_f32_16x16x32_bf16 v[196:199], v[56:59], a[100:103], v[196:199]
  ds_read_b64_tr_b16 v[74:75], v12 offset:34816
  v_mfma_f32_16x16x32_bf16 v[196:199], v[60:63], a[116:119], v[196:199]
  ds_read_b64_tr_b16 v[76:77], v11 offset:4096
  v_mfma_f32_16x16x32_bf16 v[196:199], v[64:67], a[132:135], v[196:199]
  ds_read_b64_tr_b16 v[78:79], v11 offset:6144
  v_mfma_f32_16x16x32_bf16 v[200:203], v[56:59], a[104:107], v[200:203]
  s_add_u32 m0, s33, 159744
  v_mfma_f32_16x16x32_bf16 v[200:203], v[60:63], a[120:123], v[200:203]
  s_mov_b32 s34, 74112
  v_mfma_f32_16x16x32_bf16 v[200:203], v[64:67], a[136:139], v[200:203]
  buffer_load_dwordx4 v84, s[12:15], s34 offen lds
  s_mov_b32 s35, 57344
  v_mfma_f32_16x16x32_bf16 v[204:207], v[56:59], a[108:111], v[204:207]
  buffer_store_dwordx4 v[52:55], v191, s[20:23], s35 offen sc1
  v_mfma_f32_16x16x32_bf16 v[204:207], v[60:63], a[124:127], v[204:207]
  v_mfma_f32_16x16x32_bf16 v[204:207], v[64:67], a[140:143], v[204:207]
  s_waitcnt lgkmcnt(0)
  v_mfma_f32_16x16x32_bf16 v[208:211], v[68:71], a[96:99], v[208:211]
  ds_read_b64_tr_b16 v[56:57], v9 offset:16384
  v_mfma_f32_16x16x32_bf16 v[208:211], v[72:75], a[112:115], v[208:211]
  ds_read_b64_tr_b16 v[58:59], v9 offset:18432
  s_mov_b32 s63, 262144
  buffer_load_dword v31, v30, s[96:99], s63 offen sc1
  v_mfma_f32_16x16x32_bf16 v[208:211], v[76:79], a[128:131], v[208:211]
  ds_read_b64_tr_b16 v[60:61], v9 offset:20480
  v_mfma_f32_16x16x32_bf16 v[212:215], v[68:71], a[100:103], v[212:215]
  ds_read_b64_tr_b16 v[62:63], v9 offset:22528
  v_mfma_f32_16x16x32_bf16 v[212:215], v[72:75], a[116:119], v[212:215]
  ds_read_b64_tr_b16 v[64:65], v8 offset:8192
  v_mfma_f32_16x16x32_bf16 v[212:215], v[76:79], a[132:135], v[212:215]
  ds_read_b64_tr_b16 v[66:67], v8 offset:10240
  v_mfma_f32_16x16x32_bf16 v[216:219], v[68:71], a[104:107], v[216:219]
  s_add_u32 m0, s33, 122880
  v_mfma_f32_16x16x32_bf16 v[216:219], v[72:75], a[120:123], v[216:219]
  s_mov_b32 s34, 110976
  v_mfma_f32_16x16x32_bf16 v[216:219], v[76:79], a[136:139], v[216:219]
  buffer_load_dwordx4 v84, s[12:15], s34 offen lds
  v_mfma_f32_16x16x32_bf16 v[220:223], v[68:71], a[108:111], v[220:223]
  s_add_u32 m0, s33, 32768
  v_mfma_f32_16x16x32_bf16 v[220:223], v[72:75], a[124:127], v[220:223]
  s_mov_b32 s34, 147840
  v_mfma_f32_16x16x32_bf16 v[220:223], v[76:79], a[140:143], v[220:223]
  buffer_load_dwordx4 v84, s[12:15], s34 offen lds
  s_waitcnt lgkmcnt(0)
  v_mfma_f32_16x16x32_bf16 v[192:195], v[56:59], a[144:147], v[192:195]
  s_barrier
  v_mfma_f32_16x16x32_bf16 v[192:195], v[60:63], a[160:163], v[192:195]
  ds_read_b64_tr_b16 v[68:69], v12 offset:16384
  v_mfma_f32_16x16x32_bf16 v[192:195], v[64:67], a[176:179], v[192:195]
  ds_read_b64_tr_b16 v[70:71], v12 offset:18432
  v_mfma_f32_16x16x32_bf16 v[196:199], v[56:59], a[148:151], v[196:199]
  ds_read_b64_tr_b16 v[72:73], v12 offset:20480
  v_mfma_f32_16x16x32_bf16 v[196:199], v[60:63], a[164:167], v[196:199]
  ds_read_b64_tr_b16 v[74:75], v12 offset:22528
  v_mfma_f32_16x16x32_bf16 v[196:199], v[64:67], a[180:183], v[196:199]
  ds_read_b64_tr_b16 v[76:77], v11 offset:8192
  v_mfma_f32_16x16x32_bf16 v[200:203], v[56:59], a[152:155], v[200:203]
  ds_read_b64_tr_b16 v[78:79], v11 offset:10240
  v_mfma_f32_16x16x32_bf16 v[200:203], v[60:63], a[168:171], v[200:203]
  s_add_u32 m0, s33, 36864
  v_mfma_f32_16x16x32_bf16 v[200:203], v[64:67], a[184:187], v[200:203]
  s_mov_b32 s34, 184704
  v_mfma_f32_16x16x32_bf16 v[204:207], v[56:59], a[156:159], v[204:207]
  buffer_load_dwordx4 v84, s[12:15], s34 offen lds
  v_mfma_f32_16x16x32_bf16 v[204:207], v[60:63], a[172:175], v[204:207]
  v_mfma_f32_16x16x32_bf16 v[204:207], v[64:67], a[188:191], v[204:207]
  s_waitcnt lgkmcnt(0)
  v_mfma_f32_16x16x32_bf16 v[208:211], v[68:71], a[144:147], v[208:211]
  ds_read_b64_tr_b16 v[56:57], v10 offset:8192
  v_mfma_f32_16x16x32_bf16 v[208:211], v[72:75], a[160:163], v[208:211]
  ds_read_b64_tr_b16 v[58:59], v10 offset:10240
  v_mfma_f32_16x16x32_bf16 v[208:211], v[76:79], a[176:179], v[208:211]
  ds_read_b64_tr_b16 v[60:61], v9 offset:36864
  v_mfma_f32_16x16x32_bf16 v[212:215], v[68:71], a[148:151], v[212:215]
  ds_read_b64_tr_b16 v[62:63], v9 offset:38912
  v_mfma_f32_16x16x32_bf16 v[212:215], v[72:75], a[164:167], v[212:215]
  ds_read_b64_tr_b16 v[64:65], v10 offset:12288
  v_mfma_f32_16x16x32_bf16 v[212:215], v[76:79], a[180:183], v[212:215]
  ds_read_b64_tr_b16 v[66:67], v10 offset:14336
  v_mfma_f32_16x16x32_bf16 v[216:219], v[68:71], a[152:155], v[216:219]
  s_add_u32 m0, s33, 65536
  v_mfma_f32_16x16x32_bf16 v[216:219], v[72:75], a[168:171], v[216:219]
  s_mov_b32 s34, 221568
  v_mfma_f32_16x16x32_bf16 v[216:219], v[76:79], a[184:187], v[216:219]
  buffer_load_dwordx4 v84, s[12:15], s34 offen lds
  v_mfma_f32_16x16x32_bf16 v[220:223], v[68:71], a[156:159], v[220:223]
  s_add_u32 m0, s33, 69632
  v_mfma_f32_16x16x32_bf16 v[220:223], v[72:75], a[172:175], v[220:223]
  s_mov_b32 s34, 258432
  v_mfma_f32_16x16x32_bf16 v[220:223], v[76:79], a[188:191], v[220:223]
  buffer_load_dwordx4 v84, s[12:15], s34 offen lds
  s_waitcnt lgkmcnt(0)
  v_mfma_f32_16x16x32_bf16 v[192:195], v[56:59], a[192:195], v[192:195]
  ds_read_b64_tr_b16 v[68:69], v13 offset:8192
  v_mfma_f32_16x16x32_bf16 v[192:195], v[60:63], a[208:211], v[192:195]
  ds_read_b64_tr_b16 v[70:71], v13 offset:10240
  v_mfma_f32_16x16x32_bf16 v[192:195], v[64:67], a[224:227], v[192:195]
  ds_read_b64_tr_b16 v[72:73], v12 offset:36864
  v_mfma_f32_16x16x32_bf16 v[196:199], v[56:59], a[196:199], v[196:199]
  ds_read_b64_tr_b16 v[74:75], v12 offset:38912
  v_mfma_f32_16x16x32_bf16 v[196:199], v[60:63], a[212:215], v[196:199]
  ds_read_b64_tr_b16 v[76:77], v13 offset:12288
  v_mfma_f32_16x16x32_bf16 v[196:199], v[64:67], a[228:231], v[196:199]
  ds_read_b64_tr_b16 v[78:79], v13 offset:14336
  v_mfma_f32_16x16x32_bf16 v[200:203], v[56:59], a[200:203], v[200:203]
  s_add_u32 m0, s33, 73728
  v_mfma_f32_16x16x32_bf16 v[200:203], v[60:63], a[216:219], v[200:203]
  s_mov_b32 s34, 384
  v_mfma_f32_16x16x32_bf16 v[200:203], v[64:67], a[232:235], v[200:203]
  buffer_load_dwordx4 v85, s[12:15], s34 offen lds
  v_mfma_f32_16x16x32_bf16 v[204:207], v[56:59], a[204:207], v[204:207]
  v_mfma_f32_16x16x32_bf16 v[204:207], v[60:63], a[220:223], v[204:207]
  v_mfma_f32_16x16x32_bf16 v[204:207], v[64:67], a[236:239], v[204:207]
  s_waitcnt lgkmcnt(0)
  v_mfma_f32_16x16x32_bf16 v[208:211], v[68:71], a[192:195], v[208:211]
  s_waitcnt vmcnt(7)
  s_barrier
  s_mov_b32 s63, 294912
  buffer_store_dword v7, v29, s[96:99], s63 offen sc1
  v_mfma_f32_16x16x32_bf16 v[208:211], v[72:75], a[208:211], v[208:211]
  ds_read_b64_tr_b16 v[56:57], v10 offset:16384
  s_waitcnt vmcnt(7)
  v_cmp_ne_u32 vcc, v7, v31
  s_cbranch_vccnz L_sp_28
L_bk_29:
  v_mfma_f32_16x16x32_bf16 v[208:211], v[76:79], a[224:227], v[208:211]
  ds_read_b64_tr_b16 v[58:59], v10 offset:18432
  s_mov_b32 s65, 0
  v_mfma_f32_16x16x32_bf16 v[212:215], v[68:71], a[196:199], v[212:215]
  ds_read_b64_tr_b16 v[60:61], v9 offset:40960
  buffer_load_dwordx4 v[128:131], v188, s[72:75], s65 offen sc1
  v_mfma_f32_16x16x32_bf16 v[212:215], v[72:75], a[212:215], v[212:215]
  ds_read_b64_tr_b16 v[62:63], v9 offset:43008
  v_mfma_f32_16x16x32_bf16 v[212:215], v[76:79], a[228:231], v[212:215]
  ds_read_b64_tr_b16 v[64:65], v9 offset:45056
  v_mfma_f32_16x16x32_bf16 v[216:219], v[68:71], a[200:203], v[216:219]
  ds_read_b64_tr_b16 v[66:67], v9 offset:47104
  v_mfma_f32_16x16x32_bf16 v[216:219], v[72:75], a[216:219], v[216:219]
  s_add_u32 m0, s33, 77824
  v_mfma_f32_16x16x32_bf16 v[216:219], v[76:79], a[232:235], v[216:219]
  s_mov_b32 s34, 0
  v_mfma_f32_16x16x32_bf16 v[220:223], v[68:71], a[204:207], v[220:223]
  buffer_load_dwordx4 v86, s[12:15], s34 offen lds
  s_mov_b32 s65, 9437184
  v_mfma_f32_16x16x32_bf16 v[220:223], v[72:75], a[220:223], v[220:223]
  s_add_u32 m0, s33, 126976
  buffer_load_dwordx4 v[132:135], v188, s[72:75], s65 offen sc1
  v_mfma_f32_16x16x32_bf16 v[220:223], v[76:79], a[236:239], v[220:223]
  s_mov_b32 s34, 36864
  buffer_load_dwordx4 v86, s[12:15], s34 offen lds
  s_waitcnt lgkmcnt(0)
  v_mfma_f32_16x16x32_bf16 v[192:195], v[56:59], a[240:243], v[192:195]
  ds_read_b64_tr_b16 v[68:69], v13 offset:16384
  v_mfma_f32_16x16x32_bf16 v[192:195], v[60:63], v[96:99], v[192:195]
  ds_read_b64_tr_b16 v[70:71], v13 offset:18432
  v_mfma_f32_16x16x32_bf16 v[192:195], v[64:67], v[112:115], v[192:195]
  ds_read_b64_tr_b16 v[72:73], v12 offset:40960
  v_mfma_f32_16x16x32_bf16 v[196:199], v[56:59], a[244:247], v[196:199]
  ds_read_b64_tr_b16 v[74:75], v12 offset:43008
  v_mfma_f32_16x16x32_bf16 v[196:199], v[60:63], v[100:103], v[196:199]
  ds_read_b64_tr_b16 v[76:77], v12 offset:45056
  s_mov_b32 s65, 10240
  v_mfma_f32_16x16x32_bf16 v[196:199], v[64:67], v[116:119], v[196:199]
  ds_read_b64_tr_b16 v[78:79], v12 offset:47104
  buffer_load_dwordx4 v[136:139], v188, s[72:75], s65 offen sc1
  v_mfma_f32_16x16x32_bf16 v[200:203], v[56:59], a[248:251], v[200:203]
  s_add_u32 m0, s33, 131072
  v_mfma_f32_16x16x32_bf16 v[200:203], v[60:63], v[104:107], v[200:203]
  s_mov_b32 s34, 73728
  v_mfma_f32_16x16x32_bf16 v[200:203], v[64:67], v[120:123], v[200:203]
  buffer_load_dwordx4 v86, s[12:15], s34 offen lds
  v_mfma_f32_16x16x32_bf16 v[204:207], v[56:59], a[252:255], v[204:207]
  v_mfma_f32_16x16x32_bf16 v[204:207], v[60:63], v[108:111], v[204:207]
  v_mfma_f32_16x16x32_bf16 v[204:207], v[64:67], v[124:127], v[204:207]
  s_mov_b32 s65, 9447424
  s_waitcnt lgkmcnt(0)
  v_mfma_f32_16x16x32_bf16 v[208:211], v[68:71], a[240:243], v[208:211]
  ds_read_b64_tr_b16 v[56:57], v8 offset:12288
  buffer_load_dwordx4 v[140:143], v188, s[72:75], s65 offen sc1
  v_mfma_f32_16x16x32_bf16 v[208:211], v[72:75], v[96:99], v[208:211]
  ds_read_b64_tr_b16 v[58:59], v8 offset:14336
  v_mfma_f32_16x16x32_bf16 v[208:211], v[76:79], v[112:115], v[208:211]
  ds_read_b64_tr_b16 v[60:61], v8 offset:16384
  v_mfma_f32_16x16x32_bf16 v[212:215], v[68:71], a[244:247], v[212:215]
  ds_read_b64_tr_b16 v[62:63], v8 offset:18432
  v_mfma_f32_16x16x32_bf16 v[212:215], v[72:75], v[100:103], v[212:215]
  ds_read_b64_tr_b16 v[64:65], v8 offset:45056
  v_mfma_f32_16x16x32_bf16 v[212:215], v[76:79], v[116:119], v[212:215]
  ds_read_b64_tr_b16 v[66:67], v8 offset:47104
  v_mfma_f32_16x16x32_bf16 v[216:219], v[68:71], a[248:251], v[216:219]
  s_add_u32 m0, s33, 90112
  v_mfma_f32_16x16x32_bf16 v[216:219], v[72:75], v[104:107], v[216:219]
  s_mov_b32 s34, 110592
  v_mfma_f32_16x16x32_bf16 v[216:219], v[76:79], v[120:123], v[216:219]
  buffer_load_dwordx4 v86, s[12:15], s34 offen lds
  v_mfma_f32_16x16x32_bf16 v[220:223], v[68:71], a[252:255], v[220:223]
  s_add_u32 m0, s33, 94208
  v_mfma_f32_16x16x32_bf16 v[220:223], v[72:75], v[108:111], v[220:223]
  s_mov_b32 s34, 147456
  v_mfma_f32_16x16x32_bf16 v[220:223], v[76:79], v[124:127], v[220:223]
  buffer_load_dwordx4 v86, s[12:15], s34 offen lds
  s_waitcnt lgkmcnt(0)
  v_mfma_f32_16x16x32_bf16 v[224:227], v[56:59], a[0:3], 0
  s_barrier
  v_mfma_f32_16x16x32_bf16 v[224:227], v[60:63], a[16:19], v[224:227]
  ds_read_b64_tr_b16 v[68:69], v11 offset:12288
  v_cvt_pk_bf16_f32 v40, v192, v193
  v_mfma_f32_16x16x32_bf16 v[224:227], v[64:67], a[32:35], v[224:227]
  ds_read_b64_tr_b16 v[70:71], v11 offset:14336
  v_cvt_pk_bf16_f32 v41, v194, v195
  v_mfma_f32_16x16x32_bf16 v[228:231], v[56:59], a[4:7], 0
  ds_read_b64_tr_b16 v[72:73], v11 offset:16384
  v_cvt_pk_bf16_f32 v42, v208, v209
  v_mfma_f32_16x16x32_bf16 v[228:231], v[60:63], a[20:23], v[228:231]
  ds_read_b64_tr_b16 v[74:75], v11 offset:18432
  v_cvt_pk_bf16_f32 v43, v210, v211
  v_mfma_f32_16x16x32_bf16 v[228:231], v[64:67], a[36:39], v[228:231]
  ds_read_b64_tr_b16 v[76:77], v11 offset:45056
  s_mov_b32 s35, 4096
  v_mfma_f32_16x16x32_bf16 v[232:235], v[56:59], a[8:11], 0
  ds_read_b64_tr_b16 v[78:79], v11 offset:47104
  buffer_store_dwordx4 v[40:43], v191, s[20:23], s35 offen sc1
  v_mfma_f32_16x16x32_bf16 v[232:235], v[60:63], a[24:27], v[232:235]
  s_add_u32 m0, s33, 135168
  v_cvt_pk_bf16_f32 v44, v196, v197
  v_mfma_f32_16x16x32_bf16 v[232:235], v[64:67], a[40:43], v[232:235]
  s_mov_b32 s34, 184320
  v_cvt_pk_bf16_f32 v45, v198, v199
  v_mfma_f32_16x16x32_bf16 v[236:239], v[56:59], a[12:15], 0
  buffer_load_dwordx4 v86, s[12:15], s34 offen lds
  v_cvt_pk_bf16_f32 v46, v212, v213
  v_mfma_f32_16x16x32_bf16 v[236:239], v[60:63], a[28:31], v[236:239]
  v_cvt_pk_bf16_f32 v47, v214, v215
  v_cvt_pk_bf16_f32 v48, v200, v201
  v_mfma_f32_16x16x32_bf16 v[236:239], v[64:67], a[44:47], v[236:239]
  v_cvt_pk_bf16_f32 v49, v202, v203
  s_waitcnt lgkmcnt(0)
  v_mfma_f32_16x16x32_bf16 v[240:243], v[68:71], a[0:3], 0
  ds_read_b64_tr_b16 v[56:57], v8 offset:49152
  v_cvt_pk_bf16_f32 v50, v216, v217
  v_mfma_f32_16x16x32_bf16 v[240:243], v[72:75], a[16:19], v[240:243]
  ds_read_b64_tr_b16 v[58:59], v8 offset:51200
  s_mov_b32 s63, 294912
  buffer_load_dword v31, v30, s[96:99], s63 offen sc1
  v_mfma_f32_16x16x32_bf16 v[240:243], v[76:79], a[32:35], v[240:243]
  ds_read_b64_tr_b16 v[60:61], v8 offset:53248
  v_cvt_pk_bf16_f32 v51, v218, v219
  v_mfma_f32_16x16x32_bf16 v[244:247], v[68:71], a[4:7], 0
  ds_read_b64_tr_b16 v[62:63], v8 offset:55296
  v_cvt_pk_bf16_f32 v52, v204, v205
  v_mfma_f32_16x16x32_bf16 v[244:247], v[72:75], a[20:23], v[244:247]
  ds_read_b64_tr_b16 v[64:65], v8 offset:20480
  v_cvt_pk_bf16_f32 v53, v206, v207
  v_mfma_f32_16x16x32_bf16 v[244:247], v[76:79], a[36:39], v[244:247]
  ds_read_b64_tr_b16 v[66:67], v8 offset:22528
  v_cvt_pk_bf16_f32 v54, v220, v221
  v_mfma_f32_16x16x32_bf16 v[248:251], v[68:71], a[8:11], 0
  s_add_u32 m0, s33, 98304
  v_cvt_pk_bf16_f32 v55, v222, v223
  v_mfma_f32_16x16x32_bf16 v[248:251], v[72:75], a[24:27], v[248:251]
  s_mov_b32 s34, 221184
  v_mfma_f32_16x16x32_bf16 v[248:251], v[76:79], a[40:43], v[248:251]
  buffer_load_dwordx4 v86, s[12:15], s34 offen lds
  v_mfma_f32_16x16x32_bf16 v[252:255], v[68:71], a[12:15], 0
  s_add_u32 m0, s33, 81920
  v_mfma_f32_16x16x32_bf16 v[252:255], v[72:75], a[28:31], v[252:255]
  s_mov_b32 s34, 258048
  v_mfma_f32_16x16x32_bf16 v[252:255], v[76:79], a[44:47], v[252:255]
  buffer_load_dwordx4 v86, s[12:15], s34 offen lds
  s_waitcnt lgkmcnt(0)
  v_mfma_f32_16x16x32_bf16 v[224:227], v[56:59], a[48:51], v[224:227]
  ds_read_b64_tr_b16 v[68:69], v11 offset:49152
  v_mfma_f32_16x16x32_bf16 v[224:227], v[60:63], a[64:67], v[224:227]
  ds_read_b64_tr_b16 v[70:71], v11 offset:51200
  v_mfma_f32_16x16x32_bf16 v[224:227], v[64:67], a[80:83], v[224:227]
  ds_read_b64_tr_b16 v[72:73], v11 offset:53248
  v_mfma_f32_16x16x32_bf16 v[228:231], v[56:59], a[52:55], v[228:231]
  ds_read_b64_tr_b16 v[74:75], v11 offset:55296
  v_mfma_f32_16x16x32_bf16 v[228:231], v[60:63], a[68:71], v[228:231]
  ds_read_b64_tr_b16 v[76:77], v11 offset:20480
  v_mfma_f32_16x16x32_bf16 v[228:231], v[64:67], a[84:87], v[228:231]
  ds_read_b64_tr_b16 v[78:79], v11 offset:22528
  v_mfma_f32_16x16x32_bf16 v[232:235], v[56:59], a[56:59], v[232:235]
  s_add_u32 m0, s33, 86016
  s_mov_b32 s35, 22528
  v_mfma_f32_16x16x32_bf16 v[232:235], v[60:63], a[72:75], v[232:235]
  s_mov_b32 s34, 0
  buffer_store_dwordx4 v[44:47], v191, s[20:23], s35 offen sc1
  v_mfma_f32_16x16x32_bf16 v[232:235], v[64:67], a[88:91], v[232:235]
  buffer_load_dwordx4 v87, s[12:15], s34 offen lds
  v_mfma_f32_16x16x32_bf16 v[236:239], v[56:59], a[60:63], v[236:239]
  v_mfma_f32_16x16x32_bf16 v[236:239], v[60:63], a[76:79], v[236:239]
  v_mfma_f32_16x16x32_bf16 v[236:239], v[64:67], a[92:95], v[236:239]
  s_waitcnt lgkmcnt(0)
  v_mfma_f32_16x16x32_bf16 v[240:243], v[68:71], a[48:51], v[240:243]
  s_barrier
  v_mfma_f32_16x16x32_bf16 v[240:243], v[72:75], a[64:67], v[240:243]
  ds_read_b64_tr_b16 v[56:57], v8 offset:24576
  s_add_u32 m0, s101, 0
  v_mfma_f32_16x16x32_bf16 v[240:243], v[76:79], a[80:83], v[240:243]
  ds_read_b64_tr_b16 v[58:59], v8 offset:26624
  s_mov_b32 s64, 0
  v_mfma_f32_16x16x32_bf16 v[244:247], v[68:71], a[52:55], v[244:247]
  ds_read_b64_tr_b16 v[60:61], v10 offset:20480
  buffer_load_dwordx4 v94, s[44:47], s64 offen lds
  v_mfma_f32_16x16x32_bf16 v[244:247], v[72:75], a[68:71], v[244:247]
  ds_read_b64_tr_b16 v[62:63], v10 offset:22528
  s_add_u32 m0, s101, 0
  v_mfma_f32_16x16x32_bf16 v[244:247], v[76:79], a[84:87], v[244:247]
  ds_read_b64_tr_b16 v[64:65], v9 offset:49152
  s_mov_b32 s64, 0
  v_mfma_f32_16x16x32_bf16 v[248:251], v[68:71], a[56:59], v[248:251]
  ds_read_b64_tr_b16 v[66:67], v9 offset:51200
  buffer_load_dwordx4 v94, s[44:47], s64 offen offset:1024 lds
  v_mfma_f32_16x16x32_bf16 v[248:251], v[72:75], a[72:75], v[248:251]
  s_add_u32 m0, s101, 0
  s_waitcnt vmcnt(17)
  v_mfma_f32_16x16x32_bf16 v[160:163], v[180:183], v[128:131], 0
  v_mfma_f32_16x16x32_bf16 v[248:251], v[76:79], a[88:91], v[248:251]
  s_mov_b32 s64, 0
  s_waitcnt vmcnt(15)
  v_mfma_f32_16x16x32_bf16 v[160:163], v[180:183], v[132:135], v[160:163]
  v_mfma_f32_16x16x32_bf16 v[252:255], v[68:71], a[60:63], v[252:255]
  buffer_load_dwordx4 v94, s[44:47], s64 offen offset:2048 lds
  s_waitcnt vmcnt(14)
  v_mfma_f32_16x16x32_bf16 v[160:163], v[184:187], v[136:139], v[160:163]
  v_mfma_f32_16x16x32_bf16 v[252:255], v[72:75], a[76:79], v[252:255]
  s_waitcnt vmcnt(12)
  v_mfma_f32_16x16x32_bf16 v[160:163], v[184:187], v[140:143], v[160:163]
  v_mfma_f32_16x16x32_bf16 v[252:255], v[76:79], a[92:95], v[252:255]
  s_mov_b32 s35, 40960
  s_waitcnt lgkmcnt(0)
  v_mfma_f32_16x16x32_bf16 v[224:227], v[56:59], a[96:99], v[224:227]
  ds_read_b64_tr_b16 v[68:69], v11 offset:24576
  buffer_store_dwordx4 v[48:51], v191, s[20:23], s35 offen sc1
  v_mfma_f32_16x16x32_bf16 v[224:227], v[60:63], a[112:115], v[224:227]
  ds_read_b64_tr_b16 v[70:71], v11 offset:26624
  v_mfma_f32_16x16x32_bf16 v[224:227], v[64:67], a[128:131], v[224:227]
  ds_read_b64_tr_b16 v[72:73], v13 offset:20480
  v_mfma_f32_16x16x32_bf16 v[228:231], v[56:59], a[100:103], v[228:231]
  ds_read_b64_tr_b16 v[74:75], v13 offset:22528
  v_mfma_f32_16x16x32_bf16 v[228:231], v[60:63], a[116:119], v[228:231]
  ds_read_b64_tr_b16 v[76:77], v12 offset:49152
  v_mfma_f32_16x16x32_bf16 v[228:231], v[64:67], a[132:135], v[228:231]
  ds_read_b64_tr_b16 v[78:79], v12 offset:51200
  v_mfma_f32_16x16x32_bf16 v[232:235], v[56:59], a[104:107], v[232:235]
  s_add_u32 m0, s101, 0
  v_mfma_f32_16x16x32_bf16 v[232:235], v[60:63], a[120:123], v[232:235]
  s_mov_b32 s64, 0
  v_mfma_f32_16x16x32_bf16 v[232:235], v[64:67], a[136:139], v[232:235]
  buffer_load_dwordx4 v94, s[44:47], s64 offen offset:3072 lds
  v_mfma_f32_16x16x32_bf16 v[236:239], v[56:59], a[108:111], v[236:239]
  v_mfma_f32_16x16x32_bf16 v[236:239], v[60:63], a[124:127], v[236:239]
  v_mfma_f32_16x16x32_bf16 v[236:239], v[64:67], a[140:143], v[236:239]
  s_waitcnt lgkmcnt(0)
  v_mfma_f32_16x16x32_bf16 v[240:243], v[68:71], a[96:99], v[240:243]
  ds_read_b64_tr_b16 v[56:57], v10 offset:24576
  s_mov_b32 s35, 59392
  v_mfma_f32_16x16x32_bf16 v[240:243], v[72:75], a[112:115], v[240:243]
  ds_read_b64_tr_b16 v[58:59], v10 offset:26624
  s_waitcnt vmcnt(9)
  v_cmp_ne_u32 vcc, v7, v31
  s_cbranch_vccnz L_sp_30
L_bk_31:
  v_mfma_f32_16x16x32_bf16 v[240:243], v[76:79], a[128:131], v[240:243]
  ds_read_b64_tr_b16 v[60:61], v9 offset:53248
  s_mov_b32 s65, 2048
  v_mfma_f32_16x16x32_bf16 v[244:247], v[68:71], a[100:103], v[244:247]
  ds_read_b64_tr_b16 v[62:63], v9 offset:55296
  buffer_load_dwordx4 v[144:147], v188, s[72:75], s65 offen sc1
  v_mfma_f32_16x16x32_bf16 v[244:247], v[72:75], a[116:119], v[244:247]
  ds_read_b64_tr_b16 v[64:65], v10 offset:28672
  buffer_store_dwordx4 v[52:55], v191, s[20:23], s35 offen sc1
  v_mfma_f32_16x16x32_bf16 v[244:247], v[76:79], a[132:135], v[244:247]
  ds_read_b64_tr_b16 v[66:67], v10 offset:30720
  v_mfma_f32_16x16x32_bf16 v[248:251], v[68:71], a[104:107], v[248:251]
  v_mfma_f32_16x16x32_bf16 v[248:251], v[72:75], a[120:123], v[248:251]
  v_mfma_f32_16x16x32_bf16 v[248:251], v[76:79], a[136:139], v[248:251]
  v_mfma_f32_16x16x32_bf16 v[252:255], v[68:71], a[108:111], v[252:255]
  s_mov_b32 s65, 9439232
  buffer_load_dwordx4 v[148:151], v188, s[72:75], s65 offen sc1
  v_mfma_f32_16x16x32_bf16 v[252:255], v[72:75], a[124:127], v[252:255]
  v_mfma_f32_16x16x32_bf16 v[252:255], v[76:79], a[140:143], v[252:255]
  s_waitcnt lgkmcnt(0)
  v_mfma_f32_16x16x32_bf16 v[224:227], v[56:59], a[144:147], v[224:227]
  s_barrier
  v_mfma_f32_16x16x32_bf16 v[224:227], v[60:63], a[160:163], v[224:227]
  ds_read_b64_tr_b16 v[68:69], v13 offset:24576
  s_add_u32 m0, s101, 16384
  v_mfma_f32_16x16x32_bf16 v[224:227], v[64:67], a[176:179], v[224:227]
  ds_read_b64_tr_b16 v[70:71], v13 offset:26624
  s_mov_b32 s64, 16384
  v_mfma_f32_16x16x32_bf16 v[228:231], v[56:59], a[148:151], v[228:231]
  ds_read_b64_tr_b16 v[72:73], v12 offset:53248
  buffer_load_dwordx4 v94, s[44:47], s64 offen lds
  v_mfma_f32_16x16x32_bf16 v[228:231], v[60:63], a[164:167], v[228:231]
  ds_read_b64_tr_b16 v[74:75], v12 offset:55296
  s_add_u32 m0, s101, 16384
  v_mfma_f32_16x16x32_bf16 v[228:231], v[64:67], a[180:183], v[228:231]
  ds_read_b64_tr_b16 v[76:77], v13 offset:28672
  s_mov_b32 s64, 16384
  v_mfma_f32_16x16x32_bf16 v[232:235], v[56:59], a[152:155], v[232:235]
  ds_read_b64_tr_b16 v[78:79], v13 offset:30720
  buffer_load_dwordx4 v94, s[44:47], s64 offen offset:1024 lds
  v_mfma_f32_16x16x32_bf16 v[232:235], v[60:63], a[168:171], v[232:235]
  s_add_u32 m0, s101, 16384
  s_mov_b32 s65, 12288
  v_mfma_f32_16x16x32_bf16 v[232:235], v[64:67], a[184:187], v[232:235]
  s_mov_b32 s64, 16384
  buffer_load_dwordx4 v[152:155], v188, s[72:75], s65 offen sc1
  v_mfma_f32_16x16x32_bf16 v[236:239], v[56:59], a[156:159], v[236:239]
  buffer_load_dwordx4 v94, s[44:47], s64 offen offset:2048 lds
  v_mfma_f32_16x16x32_bf16 v[236:239], v[60:63], a[172:175], v[236:239]
  v_mfma_f32_16x16x32_bf16 v[236:239], v[64:67], a[188:191], v[236:239]
  s_waitcnt lgkmcnt(0)
  v_mfma_f32_16x16x32_bf16 v[240:243], v[68:71], a[144:147], v[240:243]
  ds_read_b64_tr_b16 v[56:57], v9 offset:57344
  v_mfma_f32_16x16x32_bf16 v[240:243], v[72:75], a[160:163], v[240:243]
  ds_read_b64_tr_b16 v[58:59], v9 offset:59392
  v_mfma_f32_16x16x32_bf16 v[240:243], v[76:79], a[176:179], v[240:243]
  ds_read_b64_tr_b16 v[60:61], v8 offset:32768
  s_mov_b32 s65, 9449472
  v_mfma_f32_16x16x32_bf16 v[244:247], v[68:71], a[148:151], v[244:247]
  ds_read_b64_tr_b16 v[62:63], v8 offset:34816
  buffer_load_dwordx4 v[156:159], v188, s[72:75], s65 offen sc1
  v_mfma_f32_16x16x32_bf16 v[244:247], v[72:75], a[164:167], v[244:247]
  ds_read_b64_tr_b16 v[64:65], v8 offset:36864
  v_mfma_f32_16x16x32_bf16 v[244:247], v[76:79], a[180:183], v[244:247]
  ds_read_b64_tr_b16 v[66:67], v8 offset:38912
  v_mfma_f32_16x16x32_bf16 v[248:251], v[68:71], a[152:155], v[248:251]
  s_add_u32 m0, s101, 16384
  v_mfma_f32_16x16x32_bf16 v[248:251], v[72:75], a[168:171], v[248:251]
  s_mov_b32 s64, 16384
  v_mfma_f32_16x16x32_bf16 v[248:251], v[76:79], a[184:187], v[248:251]
  buffer_load_dwordx4 v94, s[44:47], s64 offen offset:3072 lds
  v_mfma_f32_16x16x32_bf16 v[252:255], v[68:71], a[156:159], v[252:255]
  v_mfma_f32_16x16x32_bf16 v[252:255], v[72:75], a[172:175], v[252:255]
  v_mfma_f32_16x16x32_bf16 v[252:255], v[76:79], a[188:191], v[252:255]
  s_waitcnt lgkmcnt(0)
  v_mfma_f32_16x16x32_bf16 v[224:227], v[56:59], a[192:195], v[224:227]
  ds_read_b64_tr_b16 v[68:69], v12 offset:57344
  v_mfma_f32_16x16x32_bf16 v[224:227], v[60:63], a[208:211], v[224:227]
  ds_read_b64_tr_b16 v[70:71], v12 offset:59392
  v_mfma_f32_16x16x32_bf16 v[224:227], v[64:67], a[224:227], v[224:227]
  ds_read_b64_tr_b16 v[72:73], v11 offset:32768
  v_mfma_f32_16x16x32_bf16 v[228:231], v[56:59], a[196:199], v[228:231]
  ds_read_b64_tr_b16 v[74:75], v11 offset:34816
  v_mfma_f32_16x16x32_bf16 v[228:231], v[60:63], a[212:215], v[228:231]
  ds_read_b64_tr_b16 v[76:77], v11 offset:36864
  v_mfma_f32_16x16x32_bf16 v[228:231], v[64:67], a[228:231], v[228:231]
  ds_read_b64_tr_b16 v[78:79], v11 offset:38912
  v_mfma_f32_16x16x32_bf16 v[232:235], v[56:59], a[200:203], v[232:235]
  v_mfma_f32_16x16x32_bf16 v[232:235], v[60:63], a[216:219], v[232:235]
  v_mfma_f32_16x16x32_bf16 v[232:235], v[64:67], a[232:235], v[232:235]
  v_mfma_f32_16x16x32_bf16 v[236:239], v[56:59], a[204:207], v[236:239]
  v_mfma_f32_16x16x32_bf16 v[236:239], v[60:63], a[220:223], v[236:239]
  v_mfma_f32_16x16x32_bf16 v[236:239], v[64:67], a[236:239], v[236:239]
  s_waitcnt lgkmcnt(0)
  v_mfma_f32_16x16x32_bf16 v[240:243], v[68:71], a[192:195], v[240:243]
  s_barrier
  v_mfma_f32_16x16x32_bf16 v[240:243], v[72:75], a[208:211], v[240:243]
  ds_read_b64_tr_b16 v[56:57], v9
  s_add_u32 m0, s101, 32768
  v_mfma_f32_16x16x32_bf16 v[240:243], v[76:79], a[224:227], v[240:243]
  ds_read_b64_tr_b16 v[58:59], v9 offset:2048
  s_mov_b32 s64, 32768
  v_mfma_f32_16x16x32_bf16 v[244:247], v[68:71], a[196:199], v[244:247]
  ds_read_b64_tr_b16 v[60:61], v9 offset:4096
  buffer_load_dwordx4 v94, s[44:47], s64 offen lds
  v_mfma_f32_16x16x32_bf16 v[244:247], v[72:75], a[212:215], v[244:247]
  ds_read_b64_tr_b16 v[62:63], v9 offset:6144
  s_add_u32 m0, s101, 32768
  v_mfma_f32_16x16x32_bf16 v[244:247], v[76:79], a[228:231], v[244:247]
  ds_read_b64_tr_b16 v[64:65], v9 offset:8192
  s_mov_b32 s64, 32768
  v_mfma_f32_16x16x32_bf16 v[248:251], v[68:71], a[200:203], v[248:251]
  ds_read_b64_tr_b16 v[66:67], v9 offset:10240
  buffer_load_dwordx4 v94, s[44:47], s64 offen offset:1024 lds
  v_mfma_f32_16x16x32_bf16 v[248:251], v[72:75], a[216:219], v[248:251]
  s_add_u32 m0, s101, 32768
  v_mfma_f32_16x16x32_bf16 v[248:251], v[76:79], a[232:235], v[248:251]
  s_mov_b32 s64, 32768
  v_mfma_f32_16x16x32_bf16 v[252:255], v[68:71], a[204:207], v[252:255]
  buffer_load_dwordx4 v94, s[44:47], s64 offen offset:2048 lds
  v_mfma_f32_16x16x32_bf16 v[252:255], v[72:75], a[220:223], v[252:255]
  v_mfma_f32_16x16x32_bf16 v[252:255], v[76:79], a[236:239], v[252:255]
  s_waitcnt lgkmcnt(0)
  v_mfma_f32_16x16x32_bf16 v[224:227], v[56:59], a[240:243], v[224:227]
  s_waitcnt vmcnt(10)
  s_barrier
  s_mov_b32 s63, 327680
  buffer_store_dword v7, v29, s[96:99], s63 offen sc1
  ds_read_b64_tr_b16 v[68:69], v12
  v_mfma_f32_16x16x32_bf16 v[224:227], v[60:63], v[96:99], v[224:227]
  ds_read_b64_tr_b16 v[70:71], v12 offset:2048
  v_mfma_f32_16x16x32_bf16 v[224:227], v[64:67], v[112:115], v[224:227]
  ds_read_b64_tr_b16 v[72:73], v12 offset:4096
  v_mfma_f32_16x16x32_bf16 v[228:231], v[56:59], a[244:247], v[228:231]
  ds_read_b64_tr_b16 v[74:75], v12 offset:6144
  v_mfma_f32_16x16x32_bf16 v[228:231], v[60:63], v[100:103], v[228:231]
  ds_read_b64_tr_b16 v[76:77], v12 offset:8192
  v_mfma_f32_16x16x32_bf16 v[228:231], v[64:67], v[116:119], v[228:231]
  ds_read_b64_tr_b16 v[78:79], v12 offset:10240
  v_mfma_f32_16x16x32_bf16 v[232:235], v[56:59], a[248:251], v[232:235]
  s_add_u32 m0, s101, 32768
  v_mfma_f32_16x16x32_bf16 v[232:235], v[60:63], v[104:107], v[232:235]
  s_mov_b32 s64, 32768
  v_mfma_f32_16x16x32_bf16 v[232:235], v[64:67], v[120:123], v[232:235]
  buffer_load_dwordx4 v94, s[44:47], s64 offen offset:3072 lds
  v_mfma_f32_16x16x32_bf16 v[236:239], v[56:59], a[252:255], v[236:239]
  v_mfma_f32_16x16x32_bf16 v[236:239], v[60:63], v[108:111], v[236:239]
  v_mfma_f32_16x16x32_bf16 v[236:239], v[64:67], v[124:127], v[236:239]
  s_waitcnt lgkmcnt(0)
  v_mfma_f32_16x16x32_bf16 v[240:243], v[68:71], a[240:243], v[240:243]
  ds_read_b64_tr_b16 v[56:57], v15 offset:12288
  v_mfma_f32_16x16x32_bf16 v[164:167], v[180:183], v[144:147], 0
  v_mfma_f32_16x16x32_bf16 v[240:243], v[72:75], v[96:99], v[240:243]
  ds_read_b64_tr_b16 v[58:59], v15 offset:13312
  s_waitcnt vmcnt(11)
  v_mfma_f32_16x16x32_bf16 v[164:167], v[180:183], v[148:151], v[164:167]
  v_mfma_f32_16x16x32_bf16 v[240:243], v[76:79], v[112:115], v[240:243]
  ds_read_b64_tr_b16 v[60:61], v15 offset:61440
  s_waitcnt vmcnt(8)
  v_mfma_f32_16x16x32_bf16 v[164:167], v[184:187], v[152:155], v[164:167]
  v_mfma_f32_16x16x32_bf16 v[244:247], v[68:71], a[244:247], v[244:247]
  ds_read_b64_tr_b16 v[62:63], v15 offset:62464
  s_waitcnt vmcnt(6)
  v_mfma_f32_16x16x32_bf16 v[164:167], v[184:187], v[156:159], v[164:167]
  v_mfma_f32_16x16x32_bf16 v[244:247], v[72:75], v[100:103], v[244:247]
  ds_read_b64_tr_b16 v[64:65], v25
  v_mfma_f32_16x16x32_bf16 v[244:247], v[76:79], v[116:119], v[244:247]
  ds_read_b64_tr_b16 v[66:67], v25 offset:1024
  v_mfma_f32_16x16x32_bf16 v[248:251], v[68:71], a[248:251], v[248:251]
  v_mfma_f32_16x16x32_bf16 v[248:251], v[72:75], v[104:107], v[248:251]
  v_mfma_f32_16x16x32_bf16 v[248:251], v[76:79], v[120:123], v[248:251]
  v_mfma_f32_16x16x32_bf16 v[252:255], v[68:71], a[252:255], v[252:255]
  v_mfma_f32_16x16x32_bf16 v[252:255], v[72:75], v[108:111], v[252:255]
  v_mfma_f32_16x16x32_bf16 v[252:255], v[76:79], v[124:127], v[252:255]
  s_waitcnt lgkmcnt(0)
  v_mfma_f32_16x16x32_bf16 v[192:195], v[56:59], a[0:3], 0
  s_barrier
  v_mfma_f32_16x16x32_bf16 v[192:195], v[60:63], a[16:19], v[192:195]
  ds_read_b64_tr_b16 v[68:69], v15 offset:14336
  s_add_u32 m0, s101, 49152
  v_mfma_f32_16x16x32_bf16 v[192:195], v[64:67], a[32:35], v[192:195]
  ds_read_b64_tr_b16 v[70:71], v15 offset:15360
  s_mov_b32 s64, 49152
  v_mfma_f32_16x16x32_bf16 v[196:199], v[56:59], a[4:7], 0
  ds_read_b64_tr_b16 v[72:73], v15 offset:63488
  buffer_load_dwordx4 v94, s[44:47], s64 offen lds
  v_mfma_f32_16x16x32_bf16 v[196:199], v[60:63], a[20:23], v[196:199]
  ds_read_b64_tr_b16 v[74:75], v15 offset:64512
  s_add_u32 m0, s101, 49152
  v_mfma_f32_16x16x32_bf16 v[196:199], v[64:67], a[36:39], v[196:199]
  ds_read_b64_tr_b16 v[76:77], v25 offset:2048
  s_mov_b32 s64, 49152
  v_mfma_f32_16x16x32_bf16 v[200:203], v[56:59], a[8:11], 0
  ds_read_b64_tr_b16 v[78:79], v25 offset:3072
  buffer_load_dwordx4 v94, s[44:47], s64 offen offset:1024 lds
  v_mfma_f32_16x16x32_bf16 v[200:203], v[60:63], a[24:27], v[200:203]
  s_add_u32 m0, s101, 49152
  v_cvt_pk_bf16_f32 v40, v224, v225
  v_mfma_f32_16x16x32_bf16 v[200:203], v[64:67], a[40:43], v[200:203]
  s_mov_b32 s64, 49152
  v_cvt_pk_bf16_f32 v41, v226, v227
  v_mfma_f32_16x16x32_bf16 v[204:207], v[56:59], a[12:15], 0
  buffer_load_dwordx4 v94, s[44:47], s64 offen offset:2048 lds
  v_cvt_pk_bf16_f32 v42, v240, v241
  v_mfma_f32_16x16x32_bf16 v[204:207], v[60:63], a[28:31], v[204:207]
  v_cvt_pk_bf16_f32 v43, v242, v243
  s_mov_b32 s35, 6144
  v_mfma_f32_16x16x32_bf16 v[204:207], v[64:67], a[44:47], v[204:207]
  buffer_store_dwordx4 v[40:43], v191, s[20:23], s35 offen sc1
  s_waitcnt lgkmcnt(0)
  v_mfma_f32_16x16x32_bf16 v[192:195], v[68:71], a[144:147], v[192:195]
  ds_read_b64_tr_b16 v[56:57], v15 offset:24576
  v_cvt_pk_bf16_f32 v44, v228, v229
  v_mfma_f32_16x16x32_bf16 v[192:195], v[72:75], a[160:163], v[192:195]
  ds_read_b64_tr_b16 v[58:59], v15 offset:25600
  v_cvt_pk_bf16_f32 v45, v230, v231
  v_mfma_f32_16x16x32_bf16 v[192:195], v[76:79], a[176:179], v[192:195]
  ds_read_b64_tr_b16 v[60:61], v15 offset:28672
  v_cvt_pk_bf16_f32 v46, v244, v245
  v_mfma_f32_16x16x32_bf16 v[196:199], v[68:71], a[148:151], v[196:199]
  ds_read_b64_tr_b16 v[62:63], v15 offset:29696
  v_cvt_pk_bf16_f32 v47, v246, v247
  v_mfma_f32_16x16x32_bf16 v[196:199], v[72:75], a[164:167], v[196:199]
  ds_read_b64_tr_b16 v[64:65], v25 offset:4096
  s_mov_b32 s35, 24576
  v_mfma_f32_16x16x32_bf16 v[196:199], v[76:79], a[180:183], v[196:199]
  ds_read_b64_tr_b16 v[66:67], v25 offset:5120
  buffer_store_dwordx4 v[44:47], v191, s[20:23], s35 offen sc1
  v_mfma_f32_16x16x32_bf16 v[200:203], v[68:71], a[152:155], v[200:203]
  s_add_u32 m0, s101, 49152
  v_cvt_pk_bf16_f32 v48, v232, v233
  v_mfma_f32_16x16x32_bf16 v[200:203], v[72:75], a[168:171], v[200:203]
  s_mov_b32 s64, 49152
  v_cvt_pk_bf16_f32 v49, v234, v235
  v_mfma_f32_16x16x32_bf16 v[200:203], v[76:79], a[184:187], v[200:203]
  buffer_load_dwordx4 v94, s[44:47], s64 offen offset:3072 lds
  v_cvt_pk_bf16_f32 v50, v248, v249
  v_mfma_f32_16x16x32_bf16 v[204:207], v[68:71], a[156:159], v[204:207]
  v_cvt_pk_bf16_f32 v51, v250, v251
  s_mov_b32 s35, 43008
  v_mfma_f32_16x16x32_bf16 v[204:207], v[72:75], a[172:175], v[204:207]
  buffer_store_dwordx4 v[48:51], v191, s[20:23], s35 offen sc1
  v_cvt_pk_bf16_f32 v52, v236, v237
  v_mfma_f32_16x16x32_bf16 v[204:207], v[76:79], a[188:191], v[204:207]
  v_cvt_pk_bf16_f32 v53, v238, v239
  s_waitcnt lgkmcnt(0)
  v_mfma_f32_16x16x32_bf16 v[192:195], v[56:59], a[48:51], v[192:195]
  ds_read_b64_tr_b16 v[68:69], v15 offset:26624
  v_cvt_pk_bf16_f32 v54, v252, v253
  v_mfma_f32_16x16x32_bf16 v[192:195], v[60:63], a[64:67], v[192:195]
  ds_read_b64_tr_b16 v[70:71], v15 offset:27648
  s_mov_b32 s63, 327680
  buffer_load_dword v31, v30, s[96:99], s63 offen sc1
  v_mfma_f32_16x16x32_bf16 v[192:195], v[64:67], a[80:83], v[192:195]
  ds_read_b64_tr_b16 v[72:73], v15 offset:30720
  v_cvt_pk_bf16_f32 v55, v254, v255
  v_mfma_f32_16x16x32_bf16 v[196:199], v[56:59], a[52:55], v[196:199]
  ds_read_b64_tr_b16 v[74:75], v15 offset:31744
  s_mov_b32 s35, 61440
  v_mfma_f32_16x16x32_bf16 v[196:199], v[60:63], a[68:71], v[196:199]
  ds_read_b64_tr_b16 v[76:77], v25 offset:6144
  buffer_store_dwordx4 v[52:55], v191, s[20:23], s35 offen sc1
  v_mfma_f32_16x16x32_bf16 v[196:199], v[64:67], a[84:87], v[196:199]
  ds_read_b64_tr_b16 v[78:79], v25 offset:7168
  v_mfma_f32_16x16x32_bf16 v[200:203], v[56:59], a[56:59], v[200:203]
  v_mfma_f32_16x16x32_bf16 v[200:203], v[60:63], a[72:75], v[200:203]
  v_mfma_f32_16x16x32_bf16 v[200:203], v[64:67], a[88:91], v[200:203]
  v_mfma_f32_16x16x32_bf16 v[204:207], v[56:59], a[60:63], v[204:207]
  v_mfma_f32_16x16x32_bf16 v[204:207], v[60:63], a[76:79], v[204:207]
  v_mfma_f32_16x16x32_bf16 v[204:207], v[64:67], a[92:95], v[204:207]
  s_waitcnt lgkmcnt(0)
  v_mfma_f32_16x16x32_bf16 v[192:195], v[68:71], a[192:195], v[192:195]
  s_barrier
  v_mfma_f32_16x16x32_bf16 v[192:195], v[72:75], a[208:211], v[192:195]
  ds_read_b64_tr_b16 v[56:57], v15 offset:32768
  v_mfma_f32_16x16x32_bf16 v[192:195], v[76:79], a[224:227], v[192:195]
  ds_read_b64_tr_b16 v[58:59], v15 offset:33792
  v_mfma_f32_16x16x32_bf16 v[196:199], v[68:71], a[196:199], v[196:199]
  ds_read_b64_tr_b16 v[60:61], v15 offset:16384
  v_mfma_f32_16x16x32_bf16 v[196:199], v[72:75], a[212:215], v[196:199]
  ds_read_b64_tr_b16 v[62:63], v15 offset:17408
  v_mfma_f32_16x16x32_bf16 v[196:199], v[76:79], a[228:231], v[196:199]
  ds_read_b64_tr_b16 v[64:65], v15 offset:20480
  v_mfma_f32_16x16x32_bf16 v[200:203], v[68:71], a[200:203], v[200:203]
  ds_read_b64_tr_b16 v[66:67], v15 offset:21504
  v_mfma_f32_16x16x32_bf16 v[200:203], v[72:75], a[216:219], v[200:203]
  v_mfma_f32_16x16x32_bf16 v[200:203], v[76:79], a[232:235], v[200:203]
  v_mfma_f32_16x16x32_bf16 v[204:207], v[68:71], a[204:207], v[204:207]
  v_mfma_f32_16x16x32_bf16 v[204:207], v[72:75], a[220:223], v[204:207]
  v_mfma_f32_16x16x32_bf16 v[204:207], v[76:79], a[236:239], v[204:207]
  s_waitcnt lgkmcnt(0)
  v_mfma_f32_16x16x32_bf16 v[192:195], v[56:59], a[96:99], v[192:195]
  ds_read_b64_tr_b16 v[68:69], v15 offset:34816
  v_mfma_f32_16x16x32_bf16 v[192:195], v[60:63], a[112:115], v[192:195]
  ds_read_b64_tr_b16 v[70:71], v15 offset:35840
  v_mfma_f32_16x16x32_bf16 v[192:195], v[64:67], a[128:131], v[192:195]
  ds_read_b64_tr_b16 v[72:73], v15 offset:18432
  v_mfma_f32_16x16x32_bf16 v[196:199], v[56:59], a[100:103], v[196:199]
  ds_read_b64_tr_b16 v[74:75], v15 offset:19456
  v_mfma_f32_16x16x32_bf16 v[196:199], v[60:63], a[116:119], v[196:199]
  ds_read_b64_tr_b16 v[76:77], v15 offset:22528
  v_mfma_f32_16x16x32_bf16 v[196:199], v[64:67], a[132:135], v[196:199]
  ds_read_b64_tr_b16 v[78:79], v15 offset:23552
  v_mfma_f32_16x16x32_bf16 v[200:203], v[56:59], a[104:107], v[200:203]
  v_mfma_f32_16x16x32_bf16 v[200:203], v[60:63], a[120:123], v[200:203]
  v_mfma_f32_16x16x32_bf16 v[200:203], v[64:67], a[136:139], v[200:203]
  v_mfma_f32_16x16x32_bf16 v[204:207], v[56:59], a[108:111], v[204:207]
  v_mfma_f32_16x16x32_bf16 v[204:207], v[60:63], a[124:127], v[204:207]
  v_mfma_f32_16x16x32_bf16 v[204:207], v[64:67], a[140:143], v[204:207]
  s_waitcnt lgkmcnt(0)
  v_mfma_f32_16x16x32_bf16 v[192:195], v[68:71], a[240:243], v[192:195]
  v_mfma_f32_16x16x32_bf16 v[192:195], v[72:75], v[96:99], v[192:195]
  v_mfma_f32_16x16x32_bf16 v[192:195], v[76:79], v[112:115], v[192:195]
  v_mfma_f32_16x16x32_bf16 v[196:199], v[68:71], a[244:247], v[196:199]
  v_mfma_f32_16x16x32_bf16 v[196:199], v[72:75], v[100:103], v[196:199]
  v_mfma_f32_16x16x32_bf16 v[196:199], v[76:79], v[116:119], v[196:199]
  v_mfma_f32_16x16x32_bf16 v[200:203], v[68:71], a[248:251], v[200:203]
  v_mfma_f32_16x16x32_bf16 v[200:203], v[72:75], v[104:107], v[200:203]
  v_mfma_f32_16x16x32_bf16 v[200:203], v[76:79], v[120:123], v[200:203]
  v_mfma_f32_16x16x32_bf16 v[204:207], v[68:71], a[252:255], v[204:207]
  v_mfma_f32_16x16x32_bf16 v[204:207], v[72:75], v[108:111], v[204:207]
  v_mfma_f32_16x16x32_bf16 v[204:207], v[76:79], v[124:127], v[204:207]
  v_cvt_pk_bf16_f32 v40, v192, v193
  v_cvt_pk_bf16_f32 v41, v194, v195
  s_mov_b32 s35, 0
  buffer_store_dwordx2 v[40:41], v3, s[20:23], s35 offen sc1
  v_cvt_pk_bf16_f32 v44, v196, v197
  v_cvt_pk_bf16_f32 v45, v198, v199
  s_mov_b32 s35, 18432
  buffer_store_dwordx2 v[44:45], v3, s[20:23], s35 offen sc1
  v_cvt_pk_bf16_f32 v48, v200, v201
  v_cvt_pk_bf16_f32 v49, v202, v203
  s_mov_b32 s35, 36864
  buffer_store_dwordx2 v[48:49], v3, s[20:23], s35 offen sc1
  v_cvt_pk_bf16_f32 v52, v204, v205
  v_cvt_pk_bf16_f32 v53, v206, v207
  s_mov_b32 s35, 55296
  buffer_store_dwordx2 v[52:53], v3, s[20:23], s35 offen sc1
  s_waitcnt vmcnt(5)
  v_cmp_ne_u32 vcc, v7, v31
  s_cbranch_vccnz L_sp_32
L_bk_33:
  s_mov_b32 s65, 4096
  buffer_load_dwordx4 v[128:131], v188, s[72:75], s65 offen sc1
  s_mov_b32 s65, 9441280
  buffer_load_dwordx4 v[132:135], v188, s[72:75], s65 offen sc1
  s_mov_b32 s65, 14336
  buffer_load_dwordx4 v[136:139], v188, s[72:75], s65 offen sc1
  s_mov_b32 s65, 9451520
  buffer_load_dwordx4 v[140:143], v188, s[72:75], s65 offen sc1
  s_add_u32 s48, s90, 7118848
  s_addc_u32 s49, s91, 0
  s_and_b32 s49, s49, 0xffff
  s_mov_b32 s50, 131072
  s_mov_b32 s51, 0x20000
  s_add_u32 s52, s90, 7077888
  s_addc_u32 s53, s91, 0
  s_and_b32 s53, s53, 0xffff
  s_mov_b32 s54, 32768
  s_mov_b32 s55, 0x20000
  s_add_u32 s56, s90, 7110656
  s_addc_u32 s57, s91, 0
  s_and_b32 s57, s57, 0xffff
  s_mov_b32 s58, 8192
  s_mov_b32 s59, 0x20000
  s_lshl_b32 s36, s93, 4
  s_add_u32 s36, s36, s94
  s_lshr_b32 s37, s36, 1
  s_mul_i32 s37, s37, 18432
  s_and_b32 s38, s36, 1
  s_lshl_b32 s38, s38, 7
  s_add_u32 s39, s37, s38
  s_lshl_b32 s38, s92, 9
  s_add_u32 s39, s39, s38
  v_and_b32 v4, 7, v0
  v_bfe_u32 v6, v0, 3, 1
  v_lshlrev_b32 v4, 4, v4
  v_lshl_add_u32 v4, v6, 8, v4
  v_add_u32 v4, s39, v4
  v_subrev_u32 v18, s37, v4
  v_and_b32 v18, 1023, v18
  v_lshrrev_b32 v18, 1, v18
  s_lshr_b32 s38, s92, 1
  s_lshl_b32 s38, s38, 10
  s_add_u32 s38, s38, s37
  v_add_u32 v18, s38, v18
  v_bfe_u32 v2, v0, 4, 2
  v_lshl_add_u32 v8, v2, 2, v4
  v_lshl_add_u32 v9, v2, 11, v4
  v_lshrrev_b32 v5, 1, v2
  v_lshl_add_u32 v18, v5, 9, v18
  v_and_b32 v4, 1, v2
  v_lshl_add_u32 v18, v4, 2, v18
  s_cmp_lt_u32 s92, 2
  s_cselect_b64 vcc, -1, 0
  v_cndmask_b32 v19, v18, v8, vcc
  v_cndmask_b32 v18, v8, v18, vcc
  s_mov_b32 s65, 0
  buffer_load_dword v56, v8, s[16:19], s65 offen sc1
  buffer_load_dword v57, v8, s[16:19], s65 offen offset:2048 sc1
  s_mov_b32 s65, 4096
  buffer_load_dword v58, v18, s[16:19], s65 offen sc1
  buffer_load_dword v59, v8, s[16:19], s65 offen offset:2048 sc1
  s_mov_b32 s65, 8192
  buffer_load_dword v60, v8, s[16:19], s65 offen sc1
  buffer_load_dword v61, v8, s[16:19], s65 offen offset:2048 sc1
  s_mov_b32 s65, 12288
  buffer_load_dword v62, v19, s[16:19], s65 offen sc1
  buffer_load_dword v63, v8, s[16:19], s65 offen offset:2048 sc1
  s_mov_b32 s65, 16384
  buffer_load_dword v64, v8, s[16:19], s65 offen sc1
  s_lshl_b32 s37, s36, 3
  v_and_b32 v15, 7, v0
  v_add_u32 v10, s37, v15
  v_lshlrev_b32 v12, 2, v10
  v_bfe_u32 v13, v0, 3, 3
  v_lshl_add_u32 v13, v13, 14, v12
  s_mov_b32 s65, 8192
  buffer_load_dword v68, v13, s[48:51], 0 offen sc1
  buffer_load_dword v69, v13, s[48:51], s65 offen sc1
  s_lshl_b32 s37, s36, 7
  v_lshl_add_u32 v17, v15, 2, s37
  buffer_load_dword v67, v17, s[52:55], 0 offen offset:32 sc1
  buffer_load_dword v66, v12, s[56:59], 0 offen sc1
  v_lshl_add_u32 v17, v0, 2, s37
  v_mov_b32 v16, 0x7ffffff0
  v_cmp_gt_u32 vcc, 32, v0
  s_nop 1
  v_cndmask_b32 v17, v16, v17, vcc
  v_lshlrev_b32 v15, 4, v15
  v_add_u32 v15, 163328, v15
  s_lshl_b32 s37, s92, 2
  v_add_u32 v14, s37, v15
  v_mul_u32_u24 v10, 1152, v10
  v_lshl_add_u32 v10, v6, 3, v10
  s_lshr_b32 s37, s92, 1
  s_lshl_b32 s37, s37, 6
  s_and_b32 s38, s92, 1
  s_lshl_b32 s38, s38, 4
  s_add_u32 s37, s37, s38
  v_add_u32 v10, s37, v10
  v_lshl_add_u32 v11, v5, 5, v10
  v_lshl_add_u32 v11, v4, 2, v11
  v_lshl_add_u32 v10, v2, 7, v10
  s_waitcnt vmcnt(17)
  s_barrier
  s_mov_b32 s63, 393216
  buffer_store_dword v7, v29, s[96:99], s63 offen sc1
  s_mov_b32 s63, 393216
  buffer_load_dword v31, v30, s[96:99], s63 offen sc1
  s_waitcnt vmcnt(18)
  v_mfma_f32_16x16x32_bf16 v[168:171], v[180:183], v[128:131], 0
  s_waitcnt vmcnt(17)
  v_mfma_f32_16x16x32_bf16 v[168:171], v[180:183], v[132:135], v[168:171]
  s_waitcnt vmcnt(16)
  v_mfma_f32_16x16x32_bf16 v[168:171], v[184:187], v[136:139], v[168:171]
  s_waitcnt vmcnt(15)
  v_mfma_f32_16x16x32_bf16 v[168:171], v[184:187], v[140:143], v[168:171]
  s_waitcnt vmcnt(2)
  v_add_f32 v67, v67, v66
  v_add_f32 v68, v68, v69
  s_nop 1
  v_add_f32_dpp v68, v68, v68 row_ror:8 row_mask:0xf bank_mask:0xf
  v_mov_b32 v69, v68
  s_nop 1
  v_permlane16_swap_b32 v68, v69
  v_add_f32 v68, v68, v69
  v_mov_b32 v69, v68
  s_nop 1
  v_permlane32_swap_b32 v68, v69
  v_add_f32 v68, v68, v69
  v_mov_b32 v69, 0x3727c5ac
  v_fmac_f32 v69, 0x3ae38e39, v68
  v_rcp_f32 v66, v69
  s_waitcnt vmcnt(0)
  v_cmp_ne_u32 vcc, v7, v31
  s_cbranch_vccnz L_sp_34
L_bk_35:
  s_mov_b32 s65, 6144
  buffer_load_dwordx4 v[144:147], v188, s[72:75], s65 offen sc1
  s_mov_b32 s65, 9443328
  buffer_load_dwordx4 v[148:151], v188, s[72:75], s65 offen sc1
  s_mov_b32 s65, 16384
  buffer_load_dwordx4 v[152:155], v188, s[72:75], s65 offen sc1
  s_mov_b32 s65, 9453568
  buffer_load_dwordx4 v[156:159], v188, s[72:75], s65 offen sc1
  s_mov_b32 s65, 8192
  buffer_load_dwordx2 v[224:225], v189, s[72:75], s65 offen sc1
  buffer_load_dwordx2 v[226:227], v189, s[72:75], s65 offen offset:512 sc1
  s_mov_b32 s65, 9445376
  buffer_load_dwordx2 v[228:229], v189, s[72:75], s65 offen sc1
  buffer_load_dwordx2 v[230:231], v189, s[72:75], s65 offen offset:512 sc1
  s_add_u32 m0, s101, 65536
  s_mov_b32 s64, 65536
  buffer_load_dwordx4 v94, s[44:47], s64 offen lds
  s_add_u32 m0, s101, 65536
  s_mov_b32 s64, 65536
  buffer_load_dwordx4 v94, s[44:47], s64 offen offset:1024 lds
  s_add_u32 m0, s101, 65536
  s_mov_b32 s64, 65536
  buffer_load_dwordx4 v94, s[44:47], s64 offen offset:2048 lds
  s_add_u32 m0, s101, 65536
  s_mov_b32 s64, 65536
  buffer_load_dwordx4 v94, s[44:47], s64 offen offset:3072 lds
  s_add_u32 m0, s101, 81920
  s_mov_b32 s64, 81920
  buffer_load_dwordx4 v94, s[44:47], s64 offen lds
  s_add_u32 m0, s101, 81920
  s_mov_b32 s64, 81920
  buffer_load_dwordx4 v94, s[44:47], s64 offen offset:1024 lds
  s_add_u32 m0, s101, 81920
  s_mov_b32 s64, 81920
  buffer_load_dwordx4 v94, s[44:47], s64 offen offset:2048 lds
  s_add_u32 m0, s101, 81920
  s_mov_b32 s64, 81920
  buffer_load_dwordx4 v94, s[44:47], s64 offen offset:3072 lds
  s_add_u32 m0, s101, 98304
  s_mov_b32 s64, 98304
  buffer_load_dwordx4 v94, s[44:47], s64 offen lds
  s_add_u32 m0, s101, 98304
  s_mov_b32 s64, 98304
  buffer_load_dwordx4 v94, s[44:47], s64 offen offset:1024 lds
  s_add_u32 m0, s101, 98304
  s_mov_b32 s64, 98304
  buffer_load_dwordx4 v94, s[44:47], s64 offen offset:2048 lds
  s_add_u32 m0, s101, 98304
  s_mov_b32 s64, 98304
  buffer_load_dwordx4 v94, s[44:47], s64 offen offset:3072 lds
  s_add_u32 m0, s101, 114688
  s_mov_b32 s64, 114688
  buffer_load_dwordx4 v94, s[44:47], s64 offen lds
  s_add_u32 m0, s101, 114688
  s_mov_b32 s64, 114688
  buffer_load_dwordx4 v94, s[44:47], s64 offen offset:1024 lds
  s_add_u32 m0, s101, 114688
  s_mov_b32 s64, 114688
  buffer_load_dwordx4 v94, s[44:47], s64 offen offset:2048 lds
  s_add_u32 m0, s101, 114688
  s_mov_b32 s64, 114688
  buffer_load_dwordx4 v94, s[44:47], s64 offen offset:3072 lds
  s_waitcnt vmcnt(23)
  v_mfma_f32_16x16x32_bf16 v[172:175], v[180:183], v[144:147], 0
  s_waitcnt vmcnt(22)
  v_mfma_f32_16x16x32_bf16 v[172:175], v[180:183], v[148:151], v[172:175]
  s_waitcnt vmcnt(21)
  v_mfma_f32_16x16x32_bf16 v[172:175], v[184:187], v[152:155], v[172:175]
  s_waitcnt vmcnt(20)
  v_mfma_f32_16x16x32_bf16 v[172:175], v[184:187], v[156:159], v[172:175]
  s_waitcnt vmcnt(18)
  v_mfma_f32_16x16x32_bf16 v[176:179], v[180:183], v[224:227], 0
  s_waitcnt vmcnt(16)
  v_mfma_f32_16x16x32_bf16 v[176:179], v[180:183], v[228:231], v[176:179]
  s_cmp_lg_u32 s95, 0
  s_cbranch_scc1 L_last
  s_add_u32 s48, s90, 45522944
  s_addc_u32 s49, s91, 0
  s_and_b32 s49, s49, 0xffff
  s_mov_b32 s50, 2359296
  s_mov_b32 s51, 0x20000
  s_add_u32 s52, s90, 52600832
  s_addc_u32 s53, s91, 0
  s_and_b32 s53, s53, 0xffff
  s_mov_b32 s54, 32768
  s_mov_b32 s55, 0x20000
  v_lshlrev_b32 v68, 16, v56
  v_and_b32 v69, 0xffff0000, v56
  v_fma_f32 v160, v160, v66, v68
  v_fma_f32 v161, v161, v66, v69
  v_lshlrev_b32 v68, 16, v57
  v_and_b32 v69, 0xffff0000, v57
  v_fma_f32 v164, v164, v66, v68
  v_fma_f32 v165, v165, v66, v69
  v_lshlrev_b32 v68, 16, v58
  v_and_b32 v69, 0xffff0000, v58
  v_fma_f32 v168, v168, v66, v68
  v_fma_f32 v169, v169, v66, v69
  v_lshlrev_b32 v68, 16, v59
  v_and_b32 v69, 0xffff0000, v59
  v_fma_f32 v172, v172, v66, v68
  v_fma_f32 v173, v173, v66, v69
  v_lshlrev_b32 v68, 16, v60
  v_and_b32 v69, 0xffff0000, v60
  v_fma_f32 v176, v176, v66, v68
  v_fma_f32 v177, v177, v66, v69
  v_lshlrev_b32 v68, 16, v61
  v_and_b32 v69, 0xffff0000, v61
  v_fma_f32 v162, v162, v66, v68
  v_fma_f32 v163, v163, v66, v69
  v_lshlrev_b32 v68, 16, v62
  v_and_b32 v69, 0xffff0000, v62
  v_fma_f32 v166, v166, v66, v68
  v_fma_f32 v167, v167, v66, v69
  v_lshlrev_b32 v68, 16, v63
  v_and_b32 v69, 0xffff0000, v63
  v_fma_f32 v170, v170, v66, v68
  v_fma_f32 v171, v171, v66, v69
  v_lshlrev_b32 v68, 16, v64
  v_and_b32 v69, 0xffff0000, v64
  v_fma_f32 v174, v174, v66, v68
  v_fma_f32 v175, v175, v66, v69
  v_add_f32 v32, v160, v161
  v_add_f32 v33, v164, v165
  v_add_f32 v32, v32, v168
  v_add_f32 v33, v33, v169
  v_add_f32 v32, v32, v172
  v_add_f32 v33, v33, v173
  v_add_f32 v32, v32, v176
  v_add_f32 v33, v33, v177
  v_add_f32 v32, v32, v162
  v_add_f32 v33, v33, v163
  v_add_f32 v32, v32, v166
  v_add_f32 v33, v33, v167
  v_add_f32 v32, v32, v170
  v_add_f32 v33, v33, v171
  v_add_f32 v32, v32, v174
  v_add_f32 v33, v33, v175
  v_add_f32 v32, v32, v33
  s_nop 1
  v_add_f32_dpp v32, v32, v32 row_ror:8 row_mask:0xf bank_mask:0xf
  v_mov_b32 v33, v32
  s_nop 1
  v_permlane16_swap_b32 v32, v33
  v_add_f32 v32, v32, v33
  v_mov_b32 v33, v32
  s_nop 1
  v_permlane32_swap_b32 v32, v33
  v_add_f32 v32, v32, v33
  ds_write_b32 v14, v32
  s_waitcnt lgkmcnt(0)
  s_barrier
  ds_read_b128 v[36:39], v15
  s_waitcnt lgkmcnt(0)
  v_add_f32 v36, v36, v37
  v_add_f32 v38, v38, v39
  v_add_f32 v32, v36, v38
  v_mul_f32 v32, 0x3ae38e39, v32
  v_sub_f32 v160, v160, v32
  v_sub_f32 v161, v161, v32
  v_sub_f32 v164, v164, v32
  v_sub_f32 v165, v165, v32
  v_sub_f32 v168, v168, v32
  v_sub_f32 v169, v169, v32
  v_sub_f32 v172, v172, v32
  v_sub_f32 v173, v173, v32
  v_sub_f32 v176, v176, v32
  v_sub_f32 v177, v177, v32
  v_sub_f32 v162, v162, v32
  v_sub_f32 v163, v163, v32
  v_sub_f32 v166, v166, v32
  v_sub_f32 v167, v167, v32
  v_sub_f32 v170, v170, v32
  v_sub_f32 v171, v171, v32
  v_sub_f32 v174, v174, v32
  v_sub_f32 v175, v175, v32
  v_cvt_pk_bf16_f32 v40, v160, v161
  v_cvt_pk_bf16_f32 v41, v164, v165
  v_cvt_pk_bf16_f32 v42, v168, v169
  v_cvt_pk_bf16_f32 v43, v172, v173
  v_cvt_pk_bf16_f32 v44, v176, v177
  v_cvt_pk_bf16_f32 v45, v162, v163
  v_cvt_pk_bf16_f32 v46, v166, v167
  v_cvt_pk_bf16_f32 v47, v170, v171
  v_cvt_pk_bf16_f32 v48, v174, v175
  v_permlane32_swap_b32 v40, v42
  v_permlane32_swap_b32 v41, v43
  v_permlane32_swap_b32 v44, v46
  v_permlane32_swap_b32 v45, v47
  v_permlane16_swap_b32 v40, v41
  v_permlane16_swap_b32 v42, v43
  v_permlane16_swap_b32 v44, v45
  v_permlane16_swap_b32 v46, v47
  s_mov_b32 s34, 8192
  s_mov_b32 s35, 16384
  buffer_store_dwordx4 v[40:43], v9, s[48:51], 0 offen sc1
  buffer_store_dwordx4 v[44:47], v9, s[48:51], s34 offen sc1
  buffer_store_dword v48, v8, s[48:51], s35 offen sc1
  v_mul_f32 v34, v160, v160
  v_mul_f32 v35, v161, v161
  v_fmac_f32 v34, v164, v164
  v_fmac_f32 v35, v165, v165
  v_fmac_f32 v34, v168, v168
  v_fmac_f32 v35, v169, v169
  v_fmac_f32 v34, v172, v172
  v_fmac_f32 v35, v173, v173
  v_fmac_f32 v34, v176, v176
  v_fmac_f32 v35, v177, v177
  v_fmac_f32 v34, v162, v162
  v_fmac_f32 v35, v163, v163
  v_fmac_f32 v34, v166, v166
  v_fmac_f32 v35, v167, v167
  v_fmac_f32 v34, v170, v170
  v_fmac_f32 v35, v171, v171
  v_fmac_f32 v34, v174, v174
  v_fmac_f32 v35, v175, v175
  v_add_f32 v34, v34, v35
  s_nop 1
  v_add_f32_dpp v34, v34, v34 row_ror:8 row_mask:0xf bank_mask:0xf
  v_mov_b32 v33, v34
  s_nop 1
  v_permlane16_swap_b32 v34, v33
  v_add_f32 v34, v34, v33
  v_mov_b32 v33, v34
  s_nop 1
  v_permlane32_swap_b32 v34, v33
  v_add_f32 v34, v34, v33
  ds_write_b32 v14, v34 offset:128
  s_waitcnt lgkmcnt(0)
  s_barrier
  ds_read_b128 v[36:39], v15 offset:128
  s_waitcnt lgkmcnt(0)
  v_add_f32 v36, v36, v37
  v_add_f32 v38, v38, v39
  v_add_f32 v34, v36, v38
  v_mov_b32 v33, 0x3727c5ac
  v_fmac_f32 v33, 0x3ae38e39, v34
  v_rsq_f32 v33, v33
  v_add_f32 v32, v32, v67
  v_and_b32 v35, 8, v0
  v_cmp_eq_u32 vcc, 0, v35
  s_nop 1
  v_cndmask_b32 v32, v32, v33, vcc
  buffer_store_dword v32, v17, s[52:55], 0 offen sc1
  s_waitcnt vmcnt(0)
  s_barrier
  s_mov_b32 s36, 45522944
  buffer_store_dword v7, v29, s[96:99], s36 offen sc1
  s_mov_b32 s95, 1
  s_add_u32 s90, s90, 45522944
  s_addc_u32 s91, s91, 0
  s_add_u32 s96, s90, 7249920
  s_addc_u32 s97, s91, 0
  s_and_b32 s97, s97, 0xffff
  s_mov_b32 s98, 46047232
  s_mov_b32 s99, 0x20000
  s_branch L_layer
L_last:
  s_mov_b32 s48, s88
  s_and_b32 s49, s89, 0xffff
  s_mov_b32 s50, 2359296
  s_mov_b32 s51, 0x20000
  v_lshlrev_b32 v68, 16, v56
  v_and_b32 v69, 0xffff0000, v56
  v_fma_f32 v160, v160, v66, v68
  v_fma_f32 v161, v161, v66, v69
  v_lshlrev_b32 v68, 16, v57
  v_and_b32 v69, 0xffff0000, v57
  v_fma_f32 v164, v164, v66, v68
  v_fma_f32 v165, v165, v66, v69
  v_lshlrev_b32 v68, 16, v58
  v_and_b32 v69, 0xffff0000, v58
  v_fma_f32 v168, v168, v66, v68
  v_fma_f32 v169, v169, v66, v69
  v_lshlrev_b32 v68, 16, v59
  v_and_b32 v69, 0xffff0000, v59
  v_fma_f32 v172, v172, v66, v68
  v_fma_f32 v173, v173, v66, v69
  v_lshlrev_b32 v68, 16, v60
  v_and_b32 v69, 0xffff0000, v60
  v_fma_f32 v176, v176, v66, v68
  v_fma_f32 v177, v177, v66, v69
  v_lshlrev_b32 v68, 16, v61
  v_and_b32 v69, 0xffff0000, v61
  v_fma_f32 v162, v162, v66, v68
  v_fma_f32 v163, v163, v66, v69
  v_lshlrev_b32 v68, 16, v62
  v_and_b32 v69, 0xffff0000, v62
  v_fma_f32 v166, v166, v66, v68
  v_fma_f32 v167, v167, v66, v69
  v_lshlrev_b32 v68, 16, v63
  v_and_b32 v69, 0xffff0000, v63
  v_fma_f32 v170, v170, v66, v68
  v_fma_f32 v171, v171, v66, v69
  v_lshlrev_b32 v68, 16, v64
  v_and_b32 v69, 0xffff0000, v64
  v_fma_f32 v174, v174, v66, v68
  v_fma_f32 v175, v175, v66, v69
  v_add_f32 v160, v160, v67
  v_add_f32 v161, v161, v67
  v_add_f32 v164, v164, v67
  v_add_f32 v165, v165, v67
  v_add_f32 v168, v168, v67
  v_add_f32 v169, v169, v67
  v_add_f32 v172, v172, v67
  v_add_f32 v173, v173, v67
  v_add_f32 v176, v176, v67
  v_add_f32 v177, v177, v67
  v_add_f32 v162, v162, v67
  v_add_f32 v163, v163, v67
  v_add_f32 v166, v166, v67
  v_add_f32 v167, v167, v67
  v_add_f32 v170, v170, v67
  v_add_f32 v171, v171, v67
  v_add_f32 v174, v174, v67
  v_add_f32 v175, v175, v67
  v_cvt_pk_bf16_f32 v40, v160, v161
  v_cvt_pk_bf16_f32 v41, v164, v165
  v_cvt_pk_bf16_f32 v42, v168, v169
  v_cvt_pk_bf16_f32 v43, v172, v173
  v_cvt_pk_bf16_f32 v44, v176, v177
  v_cvt_pk_bf16_f32 v45, v162, v163
  v_cvt_pk_bf16_f32 v46, v166, v167
  v_cvt_pk_bf16_f32 v47, v170, v171
  v_cvt_pk_bf16_f32 v48, v174, v175
  v_permlane32_swap_b32 v40, v42
  v_permlane32_swap_b32 v41, v43
  v_permlane32_swap_b32 v44, v46
  v_permlane32_swap_b32 v45, v47
  v_permlane16_swap_b32 v40, v41
  v_permlane16_swap_b32 v42, v43
  v_permlane16_swap_b32 v44, v45
  v_permlane16_swap_b32 v46, v47
  buffer_store_dwordx2 v[40:41], v10, s[48:51], 0 offen
  buffer_store_dwordx2 v[42:43], v10, s[48:51], 0 offen offset:32
  buffer_store_dwordx2 v[44:45], v10, s[48:51], 0 offen offset:512
  buffer_store_dwordx2 v[46:47], v10, s[48:51], 0 offen offset:544
  buffer_store_dword v48, v11, s[48:51], 0 offen offset:1024
L_main_end:
  s_endpgm
L_sp_2:
  s_mov_b32 s100, 0
L_sp_2_l:
  buffer_load_dword v7, v112, s[72:75], 0 offen sc1
  s_add_u32 s100, s100, 1
  s_cmp_gt_u32 s100, 65536
  s_cbranch_scc1 L_bk_3
  s_waitcnt vmcnt(0)
  v_cmp_eq_u32 vcc, 0, v7
  s_cbranch_vccnz L_sp_2_l
  s_branch L_bk_3
L_sp_4:
  s_mov_b32 s100, 0
  s_mov_b32 s36, 0
L_sp_4_l:
  buffer_load_dword v31, v1, s[96:99], s36 offen sc1
  s_add_u32 s100, s100, 1
  s_cmp_gt_u32 s100, 65536
  s_cbranch_scc1 L_bk_5
  s_waitcnt vmcnt(0)
  v_cmp_ne_u32 vcc, v7, v31
  s_cbranch_vccnz L_sp_4_l
  s_branch L_bk_5
L_sp_6:
  s_mov_b32 s100, 0
  s_mov_b32 s37, 0
L_sp_6_l:
  buffer_load_dword v31, v27, s[96:99], s37 offen sc1
  s_add_u32 s100, s100, 1
  s_cmp_gt_u32 s100, 65536
  s_cbranch_scc1 L_bk_7
  s_waitcnt vmcnt(0)
  v_cmp_ne_u32 vcc, v7, v31
  s_cbranch_vccnz L_sp_6_l
  s_branch L_bk_7
L_sp_8:
  s_mov_b32 s100, 0
  s_mov_b32 s37, 0
L_sp_8_l:
  buffer_load_dword v26, v28, s[96:99], s37 offen sc1
  s_add_u32 s100, s100, 1
  s_cmp_gt_u32 s100, 65536
  s_cbranch_scc1 L_bk_9
  s_waitcnt vmcnt(0)
  v_cmp_ne_u32 vcc, v7, v26
  s_cbranch_vccnz L_sp_8_l
  s_branch L_bk_9
L_sp_10:
  s_mov_b32 s100, 0
  s_mov_b32 s36, 0
L_sp_10_l:
  buffer_load_dword v31, v25, s[96:99], s36 offen sc1
  s_add_u32 s100, s100, 1
  s_cmp_gt_u32 s100, 65536
  s_cbranch_scc1 L_bk_11
  s_waitcnt vmcnt(0)
  v_cmp_ne_u32 vcc, v7, v31
  s_cbranch_vccnz L_sp_10_l
  s_branch L_bk_11
L_sp_18:
  s_mov_b32 s100, 0
  s_mov_b32 s36, 32768
L_sp_18_l:
  buffer_load_dword v31, v30, s[96:99], s36 offen sc1
  s_add_u32 s100, s100, 1
  s_cmp_gt_u32 s100, 65536
  s_cbranch_scc1 L_bk_19
  s_waitcnt vmcnt(0)
  v_cmp_ne_u32 vcc, v7, v31
  s_cbranch_vccnz L_sp_18_l
  s_branch L_bk_19
L_sp_20:
  s_mov_b32 s100, 0
  s_mov_b32 s36, 65536
L_sp_20_l:
  buffer_load_dword v31, v30, s[96:99], s36 offen sc1
  s_add_u32 s100, s100, 1
  s_cmp_gt_u32 s100, 65536
  s_cbranch_scc1 L_bk_21
  s_waitcnt vmcnt(0)
  v_cmp_ne_u32 vcc, v7, v31
  s_cbranch_vccnz L_sp_20_l
  s_branch L_bk_21
L_sp_22:
  s_mov_b32 s100, 0
  s_mov_b32 s63, 131072
L_sp_22_l:
  buffer_load_dword v31, v91, s[96:99], s63 offen sc1
  s_add_u32 s100, s100, 1
  s_cmp_gt_u32 s100, 65536
  s_cbranch_scc1 L_bk_23
  s_waitcnt vmcnt(0)
  v_cmp_ne_u32 vcc, v7, v31
  s_cbranch_vccnz L_sp_22_l
  s_branch L_bk_23
L_sp_24:
  s_mov_b32 s100, 0
  s_mov_b32 s63, 163840
L_sp_24_l:
  buffer_load_dword v31, v91, s[96:99], s63 offen sc1
  s_add_u32 s100, s100, 1
  s_cmp_gt_u32 s100, 65536
  s_cbranch_scc1 L_bk_25
  s_waitcnt vmcnt(0)
  v_cmp_ne_u32 vcc, v7, v31
  s_cbranch_vccnz L_sp_24_l
  s_branch L_bk_25
L_sp_26:
  s_mov_b32 s100, 0
  s_mov_b32 s63, 196608
L_sp_26_l:
  buffer_load_dword v31, v91, s[96:99], s63 offen sc1
  s_add_u32 s100, s100, 1
  s_cmp_gt_u32 s100, 65536
  s_cbranch_scc1 L_bk_27
  s_waitcnt vmcnt(0)
  v_cmp_ne_u32 vcc, v7, v31
  s_cbranch_vccnz L_sp_26_l
  s_branch L_bk_27
L_sp_28:
  s_mov_b32 s100, 0
  s_mov_b32 s63, 262144
L_sp_28_l:
  buffer_load_dword v31, v30, s[96:99], s63 offen sc1
  s_add_u32 s100, s100, 1
  s_cmp_gt_u32 s100, 65536
  s_cbranch_scc1 L_bk_29
  s_waitcnt vmcnt(0)
  v_cmp_ne_u32 vcc, v7, v31
  s_cbranch_vccnz L_sp_28_l
  s_branch L_bk_29
L_sp_30:
  s_mov_b32 s100, 0
  s_mov_b32 s63, 294912
L_sp_30_l:
  buffer_load_dword v31, v30, s[96:99], s63 offen sc1
  s_add_u32 s100, s100, 1
  s_cmp_gt_u32 s100, 65536
  s_cbranch_scc1 L_bk_31
  s_waitcnt vmcnt(0)
  v_cmp_ne_u32 vcc, v7, v31
  s_cbranch_vccnz L_sp_30_l
  s_branch L_bk_31
L_sp_32:
  s_mov_b32 s100, 0
  s_mov_b32 s63, 327680
L_sp_32_l:
  buffer_load_dword v31, v30, s[96:99], s63 offen sc1
  s_add_u32 s100, s100, 1
  s_cmp_gt_u32 s100, 65536
  s_cbranch_scc1 L_bk_33
  s_waitcnt vmcnt(0)
  v_cmp_ne_u32 vcc, v7, v31
  s_cbranch_vccnz L_sp_32_l
  s_branch L_bk_33
L_sp_34:
  s_mov_b32 s100, 0
  s_mov_b32 s63, 393216
L_sp_34_l:
  buffer_load_dword v31, v30, s[96:99], s63 offen sc1
  s_add_u32 s100, s100, 1
  s_cmp_gt_u32 s100, 65536
  s_cbranch_scc1 L_bk_35
  s_waitcnt vmcnt(0)
  v_cmp_ne_u32 vcc, v7, v31
  s_cbranch_vccnz L_sp_34_l
  s_branch L_bk_35
L_code_end:
.section .rodata,"a"
.p2align 6
.amdhsa_kernel interleave_layers__sliding_local_dilated__glu_gated_bilinear__prompt_kernel
  .amdhsa_next_free_vgpr 512
  .amdhsa_next_free_sgpr 102
  .amdhsa_accum_offset 256
  .amdhsa_group_segment_fixed_size 0
  .amdhsa_kernarg_size 80
  .amdhsa_user_sgpr_count 2
  .amdhsa_user_sgpr_kernarg_segment_ptr 1
  .amdhsa_system_sgpr_workgroup_id_x 1
  .amdhsa_float_denorm_mode_32 3
.end_amdhsa_kernel
```

```asm
; @launch grid=(256,1,1) block=(256,1,1) lds=163840
.amdgcn_target "amdgcn-amd-amdhsa--gfx950"
.text
.globl interleave_layers__sliding_local_dilated__glu_gated_bilinear__prompt_kernel
.p2align 8
.type interleave_layers__sliding_local_dilated__glu_gated_bilinear__prompt_kernel,@function
interleave_layers__sliding_local_dilated__glu_gated_bilinear__prompt_kernel:
  s_cmp_ge_u32 s2, 256
  s_cbranch_scc1 L_main_end
  s_load_dwordx4 s[44:47], s[0:1], 0
  s_load_dwordx2 s[48:49], s[0:1], 16
  s_load_dwordx2 s[86:87], s[0:1], 72
  s_load_dwordx4 s[80:83], s[0:1], 32
  s_load_dwordx2 s[84:85], s[0:1], 48
  s_load_dwordx4 s[76:79], s[0:1], 56
  s_getpc_b64 s[74:75]
L_pc:
  s_lshr_b32 s36, s2, 3
  s_lshl_b32 s36, s36, 11
  v_and_b32 v113, 15, v0
  v_lshl_add_u32 v113, v113, 7, s36
  v_min_u32 v113, L_code_end-L_pc-4, v113
  global_load_dword v114, v113, s[74:75]
  v_lshrrev_b32 v1, 6, v0
  s_mov_b32 s95, 0
  v_readfirstlane_b32 s92, v1
  s_and_b32 s36, s2, 7
  s_lshr_b32 s37, s2, 3
  s_and_b32 s94, s36, 3
  s_lshl_b32 s94, s94, 2
  s_and_b32 s38, s37, 3
  s_add_u32 s94, s94, s38
  s_lshr_b32 s93, s36, 2
  s_lshl_b32 s93, s93, 3
  s_lshr_b32 s38, s37, 2
  s_add_u32 s93, s93, s38
  v_and_b32 v112, 1, v0
  v_lshlrev_b32 v112, 2, v112
  v_and_b32 v1, 63, v0
  v_lshrrev_b32 v2, 3, v1
  v_and_b32 v3, 7, v1
  s_lshl_b32 s36, s93, 4
  s_add_u32 s33, s36, s94
  s_lshl_b32 s36, s33, 3
  v_add_u32 v13, s36, v3
  v_mul_u32_u24 v13, 1152, v13
  v_lshrrev_b32 v12, 2, v2
  v_lshl_add_u32 v13, v12, 6, v13
  v_and_b32 v12, 3, v2
  v_lshl_add_u32 v13, v12, 3, v13
  s_lshl_b32 s37, s92, 8
  v_add_u32 v6, s37, v13
  s_lshr_b32 s37, s92, 1
  s_lshl_b32 s37, s37, 5
  s_and_b32 s38, s92, 1
  s_lshl_b32 s38, s38, 2
  s_add_u32 s37, s37, s38
  s_add_u32 s37, s37, 1024
  v_add_u32 v7, s37, v13
  v_mov_b32 v11, 0x7ffffff0
  s_waitcnt lgkmcnt(0)
  s_mov_b32 s4, s44
  s_and_b32 s5, s45, 0xffff
  s_mov_b32 s6, 2359296
  s_mov_b32 s7, 0x20000
  buffer_load_dwordx2 v[24:25], v6, s[4:7], 0 offen
  buffer_load_dwordx2 v[26:27], v6, s[4:7], 0 offen offset:32
  buffer_load_dwordx2 v[28:29], v6, s[4:7], 0 offen offset:128
  buffer_load_dwordx2 v[30:31], v6, s[4:7], 0 offen offset:160
  buffer_load_dword v32, v7, s[4:7], 0 offen
  s_mov_b32 s8, s46
  s_and_b32 s9, s47, 0xffff
  s_mov_b32 s10, 1990656
  s_mov_b32 s11, 0x20000
  s_lshl_b32 s53, s93, 2
  s_add_u32 s53, s53, s92
  v_and_b32 v34, 15, v1
  v_lshrrev_b32 v35, 4, v1
  s_mul_hi_u32 s55, s53, 613566757
  s_mul_i32 s37, s55, 7
  s_sub_u32 s54, s53, s37
  s_lshl_b32 s37, s54, 4
  v_add_u32 v36, s37, v34
  v_cmp_le_u32 vcc, 40, v36
  v_subrev_u32 v38, 40, v36
  s_nop 0
  v_cndmask_b32 v39, v36, v38, vcc
  v_cndmask_b32 v37, 0, 18, vcc
  v_cmp_le_u32 vcc, 18, v39
  v_add_u32 v37, v37, v39
  v_add_u32 v38, 558, v37
  v_cndmask_b32 v37, v37, v38, vcc
  v_cmp_le_u32 vcc, 76, v36
  v_add_u32 v37, 576, v37
  v_subrev_u32 v38, 76, v36
  v_cndmask_b32 v37, v37, v38, vcc
  s_mul_i32 s37, s94, 72
  s_mul_i32 s38, s55, 221184
  s_add_u32 s37, s37, s38
  v_mul_u32_u24 v38, 13824, v35
  v_lshl_add_u32 v38, v37, 1, v38
  v_add_u32 v52, s37, v38
  v_subrev_u32 v38, 36, v36
  v_cmp_gt_u32 vcc, 4, v38
  s_cmp_lt_u32 s53, 63
  s_cselect_b32 s39, 0, 0x7ffffff0
  v_cndmask_b32 v52, v52, v11, vcc
  v_or_b32 v52, s39, v52
  s_mov_b32 s37, 0
  buffer_load_ushort v40, v52, s[8:11], s37 offen
  buffer_load_ushort v100, v52, s[8:11], s37 offen offset:3456
  s_mov_b32 s37, 6912
  buffer_load_ushort v41, v52, s[8:11], s37 offen
  buffer_load_ushort v101, v52, s[8:11], s37 offen offset:3456
  s_mov_b32 s37, 55296
  buffer_load_ushort v42, v52, s[8:11], s37 offen
  buffer_load_ushort v102, v52, s[8:11], s37 offen offset:3456
  s_mov_b32 s37, 62208
  buffer_load_ushort v43, v52, s[8:11], s37 offen
  buffer_load_ushort v103, v52, s[8:11], s37 offen offset:3456
  s_mov_b32 s37, 110592
  buffer_load_ushort v44, v52, s[8:11], s37 offen
  buffer_load_ushort v104, v52, s[8:11], s37 offen offset:3456
  s_mov_b32 s37, 117504
  buffer_load_ushort v45, v52, s[8:11], s37 offen
  buffer_load_ushort v105, v52, s[8:11], s37 offen offset:3456
  s_mov_b32 s37, 165888
  buffer_load_ushort v46, v52, s[8:11], s37 offen
  buffer_load_ushort v106, v52, s[8:11], s37 offen offset:3456
  s_mov_b32 s37, 172800
  buffer_load_ushort v47, v52, s[8:11], s37 offen
  buffer_load_ushort v107, v52, s[8:11], s37 offen offset:3456
  s_mov_b32 s12, s48
  s_and_b32 s13, s49, 0xffff
  s_mov_b32 s14, 663552
  s_mov_b32 s15, 0x20000
  s_mul_i32 s37, s94, 126
  s_mul_i32 s38, s55, 14
  s_add_u32 s37, s37, s38
  s_add_u32 s37, s37, s54
  s_lshl_b32 s37, s37, 10
  v_lshl_add_u32 v56, v1, 4, s37
  v_or_b32 v56, s39, v56
  s_lshl_b32 s52, s2, 2
  s_add_u32 s52, s52, s92
  s_mul_hi_u32 s54, s52, 238609295
  s_mul_i32 s37, s54, 18
  s_sub_u32 s55, s52, s37
  v_lshrrev_b32 v36, 1, v35
  v_mul_u32_u24 v36, 18, v36
  v_and_b32 v37, 1, v35
  v_lshl_add_u32 v36, v37, 3, v36
  s_mul_i32 s37, s55, 36
  v_add_u32 v36, s37, v36
  v_mul_u32_u24 v37, 72, v35
  s_mul_i32 s37, s55, 288
  s_sub_u32 s37, s37, 4592
  v_add_u32 v37, s37, v37
  s_cmp_lt_u32 s55, 16
  s_cselect_b64 vcc, -1, 0
  v_cndmask_b32 v38, v37, v36, vcc
  s_cselect_b32 s60, 2, 18
  s_mul_i32 s60, s60, 1152
  s_mul_i32 s61, s60, 2
  s_mul_i32 s62, s60, 3
  v_mul_u32_u24 v38, 1152, v38
  s_lshl_b32 s37, s54, 5
  v_lshl_add_u32 v36, v34, 1, s37
  v_add_u32 v54, v38, v36
  s_lshl_b32 s37, s52, 10
  v_lshl_add_u32 v58, v1, 4, s37
  s_cmp_lt_u32 s52, 648
  s_cselect_b32 s37, 0, 0x7ffffff0
  v_or_b32 v54, s37, v54
  v_or_b32 v58, s37, v58
  buffer_load_ushort v48, v54, s[12:15], 0 offen
  buffer_load_ushort v108, v54, s[12:15], 0 offen offset:1152
  buffer_load_ushort v49, v54, s[12:15], s60 offen
  buffer_load_ushort v109, v54, s[12:15], s60 offen offset:1152
  buffer_load_ushort v50, v54, s[12:15], s61 offen
  buffer_load_ushort v110, v54, s[12:15], s61 offen offset:1152
  buffer_load_ushort v51, v54, s[12:15], s62 offen
  buffer_load_ushort v111, v54, s[12:15], s62 offen offset:1152
  s_cmp_lt_u32 s2, 238
  s_cbranch_scc1 L_wb_a
  s_sub_u32 s55, s2, 238
  v_mov_b32 v35, s92
  v_lshrrev_b32 v36, 1, v35
  v_mul_u32_u24 v36, 18, v36
  v_and_b32 v37, 1, v35
  v_lshl_add_u32 v36, v37, 3, v36
  s_mul_i32 s37, s55, 36
  v_add_u32 v36, s37, v36
  v_mul_u32_u24 v37, 72, v35
  s_mul_i32 s37, s55, 288
  s_sub_u32 s37, s37, 4592
  v_add_u32 v37, s37, v37
  s_cmp_lt_u32 s55, 16
  s_cselect_b64 vcc, -1, 0
  v_cndmask_b32 v38, v37, v36, vcc
  v_lshrrev_b32 v36, 1, v2
  v_mul_u32_u24 v36, 18, v36
  v_and_b32 v37, 1, v2
  v_add_u32 v36, v36, v37
  v_cndmask_b32 v36, v36, v2, vcc
  v_add_u32 v38, v38, v36
  v_mul_u32_u24 v38, 1152, v38
  v_lshl_add_u32 v59, v3, 4, v38
  buffer_load_dwordx4 v[128:131], v59, s[12:15], 0 offen
  buffer_load_dwordx4 v[132:135], v59, s[12:15], 0 offen offset:128
  buffer_load_dwordx4 v[136:139], v59, s[12:15], 0 offen offset:256
  buffer_load_dwordx4 v[140:143], v59, s[12:15], 0 offen offset:384
  buffer_load_dwordx4 v[144:147], v59, s[12:15], 0 offen offset:512
  buffer_load_dwordx4 v[148:151], v59, s[12:15], 0 offen offset:640
  buffer_load_dwordx4 v[152:155], v59, s[12:15], 0 offen offset:768
  buffer_load_dwordx4 v[156:159], v59, s[12:15], 0 offen offset:896
  buffer_load_dwordx4 v[160:163], v59, s[12:15], 0 offen offset:1024
L_wb_a:
  s_mov_b32 s72, s78
  s_and_b32 s73, s79, 0xffff
  s_mov_b32 s74, 8
  s_mov_b32 s75, 0x20000
  s_cmp_lg_u32 s2, 0
  s_cbranch_scc1 L_tg_1
  s_memrealtime s[36:37]
  s_waitcnt lgkmcnt(0)
  s_or_b32 s36, s36, 1
  s_or_b32 s37, s37, 0x80000000
  v_mov_b32 v12, s36
  v_mov_b32 v13, s37
  v_cmp_eq_u32 vcc, 0, v112
  s_nop 1
  v_cndmask_b32 v12, v13, v12, vcc
  v_lshlrev_b32 v13, 2, v0
  buffer_store_dword v12, v13, s[72:75], 0 offen sc1
L_tg_1:
  s_mov_b32 s88, s76
  s_mov_b32 s89, s77
  s_add_u32 s90, s86, 3796992
  s_addc_u32 s91, s87, 0
  s_add_u32 s96, s90, 7249920
  s_addc_u32 s97, s91, 0
  s_and_b32 s97, s97, 0xffff
  s_mov_b32 s98, 46047232
  s_mov_b32 s99, 0x20000
  v_lshrrev_b32 v121, 3, v0
  v_and_b32 v120, 15, v121
  v_lshlrev_b32 v120, 15, v120
  v_lshrrev_b32 v113, 4, v121
  s_mov_b32 s36, 45522944
  v_mul_lo_u32 v113, v113, s36
  v_add_u32 v113, v113, v120
  v_and_b32 v120, 7, v0
  v_lshl_add_u32 v113, v120, 4, v113
  v_mov_b32 v120, 8329
  v_lshrrev_b32 v120, v121, v120
  v_and_b32 v120, 1, v120
  v_cmp_eq_u32 vcc, 1, v120
  v_mov_b32 v120, 0x7ffffff0
  s_nop 0
  v_cndmask_b32 v124, v120, v113, vcc
  v_cndmask_b32 v113, v113, v120, vcc
  s_lshl_b32 s36, s93, 11
  s_lshl_b32 s37, s94, 7
  s_add_u32 s36, s36, s37
  buffer_load_dword v124, v124, s[96:99], s36 offen sc1
  v_mov_b32 v120, 0
  v_mov_b32 v121, 0
  v_mov_b32 v122, 0
  v_mov_b32 v123, 0
  buffer_store_dwordx4 v[120:123], v113, s[96:99], s36 offen sc1
  s_mov_b32 s64, s80
  s_and_b32 s65, s81, 0xffff
  s_mov_b32 s66, 5308416
  s_mov_b32 s67, 0x20000
  s_mov_b32 s68, s82
  s_and_b32 s69, s83, 0xffff
  s_mov_b32 s70, 5308416
  s_mov_b32 s71, 0x20000
  s_mul_i32 s36, s93, 36
  v_add_u32 v113, s36, v0
  v_mul_u32_u24 v113, 9216, v113
  s_mul_i32 s36, s94, 576
  s_and_b32 s36, s36, 0xffffff80
  v_add_u32 v113, s36, v113
  v_mov_b32 v115, 0x7ffffff0
  v_cmp_gt_u32 vcc, 36, v0
  s_nop 1
  v_cndmask_b32 v116, v115, v113, vcc
  s_lshl_b32 s36, s94, 4
  s_add_u32 s36, s36, s93
  s_mul_i32 s36, s36, 20736
  v_lshl_add_u32 v113, v0, 7, s36
  v_cmp_gt_u32 vcc, 54, v0
  s_nop 1
  v_cndmask_b32 v117, v115, v113, vcc
  s_cmp_eq_u32 s95, 0
  s_cselect_b32 s36, 0, 0x7ffffff0
  v_or_b32 v116, s36, v116
  v_or_b32 v117, s36, v117
  s_and_b32 s38, s94, 1
  s_add_u32 s38, s38, 0
  s_cmp_eq_u32 s38, 5
  s_cselect_b32 s38, 0, s38
  s_lshl_b32 s38, s38, 7
  buffer_load_dword v118, v116, s[64:67], s38 offen
  buffer_load_dword v118, v116, s[68:71], s38 offen
  s_lshr_b32 s36, s33, 1
  s_mul_i32 s36, s36, 18432
  s_and_b32 s37, s33, 1
  s_lshl_b32 s37, s37, 7
  s_add_u32 s36, s36, s37
  v_lshlrev_b32 v12, 8, v2
  v_lshl_add_u32 v12, v3, 4, v12
  s_lshl_b32 s37, s92, 12
  s_add_u32 s37, s37, s36
  v_add_u32 v4, s37, v12
  s_lshl_b32 s37, s92, 2
  s_add_u32 s37, s37, s36
  s_add_u32 s37, s37, 16384
  v_add_u32 v5, s37, v12
  v_lshlrev_b32 v10, 4, v3
  s_lshl_b32 s37, s92, 2
  v_add_u32 v9, s37, v10
  s_add_u32 s16, s86, 3796992
  s_addc_u32 s17, s87, 0
  s_and_b32 s17, s17, 0xffff
  s_mov_b32 s18, 2359296
  s_mov_b32 s19, 0x20000
  s_add_u32 s20, s86, 10874880
  s_addc_u32 s21, s87, 0
  s_and_b32 s21, s21, 0xffff
  s_mov_b32 s22, 32768
  s_mov_b32 s23, 0x20000
  s_add_u32 s28, s86, 0
  s_addc_u32 s29, s87, 0
  s_and_b32 s29, s29, 0xffff
  s_mov_b32 s30, 2064384
  s_mov_b32 s31, 0x20000
  s_add_u32 s40, s86, 2064384
  s_addc_u32 s41, s87, 0
  s_and_b32 s41, s41, 0xffff
  s_mov_b32 s42, 681984
  s_mov_b32 s43, 0x20000
  s_mov_b32 s56, 7168
  s_waitcnt vmcnt(32)
  v_lshlrev_b32 v64, 16, v24
  v_and_b32 v65, 0xffff0000, v24
  v_lshlrev_b32 v66, 16, v25
  v_and_b32 v67, 0xffff0000, v25
  s_waitcnt vmcnt(31)
  v_lshlrev_b32 v68, 16, v26
  v_and_b32 v69, 0xffff0000, v26
  v_lshlrev_b32 v70, 16, v27
  v_and_b32 v71, 0xffff0000, v27
  s_waitcnt vmcnt(30)
  v_lshlrev_b32 v72, 16, v28
  v_and_b32 v73, 0xffff0000, v28
  v_lshlrev_b32 v74, 16, v29
  v_and_b32 v75, 0xffff0000, v29
  s_waitcnt vmcnt(29)
  v_lshlrev_b32 v76, 16, v30
  v_and_b32 v77, 0xffff0000, v30
  v_lshlrev_b32 v78, 16, v31
  v_and_b32 v79, 0xffff0000, v31
  s_waitcnt vmcnt(28)
  v_lshlrev_b32 v80, 16, v32
  v_and_b32 v81, 0xffff0000, v32
  v_add_f32 v14, v64, v65
  v_add_f32 v15, v66, v67
  v_add_f32 v14, v14, v68
  v_add_f32 v15, v15, v69
  v_add_f32 v14, v14, v70
  v_add_f32 v15, v15, v71
  v_add_f32 v14, v14, v72
  v_add_f32 v15, v15, v73
  v_add_f32 v14, v14, v74
  v_add_f32 v15, v15, v75
  v_add_f32 v14, v14, v76
  v_add_f32 v15, v15, v77
  v_add_f32 v14, v14, v78
  v_add_f32 v15, v15, v79
  v_add_f32 v14, v14, v80
  v_add_f32 v15, v15, v81
  v_add_f32 v14, v14, v15
  s_nop 1
  v_add_f32_dpp v14, v14, v14 row_ror:8 row_mask:0xf bank_mask:0xf
  v_mov_b32 v15, v14
  s_nop 1
  v_permlane16_swap_b32 v14, v15
  v_add_f32 v14, v14, v15
  v_mov_b32 v15, v14
  s_nop 1
  v_permlane32_swap_b32 v14, v15
  v_add_f32 v14, v14, v15
  ds_write_b32 v9, v14
  s_waitcnt lgkmcnt(0)
  s_barrier
  ds_read_b128 v[16:19], v10
  s_waitcnt lgkmcnt(0)
  v_add_f32 v16, v16, v17
  v_add_f32 v18, v18, v19
  v_add_f32 v14, v16, v18
  v_mul_f32 v14, 0x3ae38e39, v14
  v_sub_f32 v64, v64, v14
  v_sub_f32 v65, v65, v14
  v_sub_f32 v66, v66, v14
  v_sub_f32 v67, v67, v14
  v_sub_f32 v68, v68, v14
  v_sub_f32 v69, v69, v14
  v_sub_f32 v70, v70, v14
  v_sub_f32 v71, v71, v14
  v_sub_f32 v72, v72, v14
  v_sub_f32 v73, v73, v14
  v_sub_f32 v74, v74, v14
  v_sub_f32 v75, v75, v14
  v_sub_f32 v76, v76, v14
  v_sub_f32 v77, v77, v14
  v_sub_f32 v78, v78, v14
  v_sub_f32 v79, v79, v14
  v_sub_f32 v80, v80, v14
  v_sub_f32 v81, v81, v14
  v_mul_f32 v20, v64, v64
  v_mul_f32 v21, v65, v65
  v_fmac_f32 v20, v66, v66
  v_fmac_f32 v21, v67, v67
  v_fmac_f32 v20, v68, v68
  v_fmac_f32 v21, v69, v69
  v_fmac_f32 v20, v70, v70
  v_fmac_f32 v21, v71, v71
  v_fmac_f32 v20, v72, v72
  v_fmac_f32 v21, v73, v73
  v_fmac_f32 v20, v74, v74
  v_fmac_f32 v21, v75, v75
  v_fmac_f32 v20, v76, v76
  v_fmac_f32 v21, v77, v77
  v_fmac_f32 v20, v78, v78
  v_fmac_f32 v21, v79, v79
  v_fmac_f32 v20, v80, v80
  v_fmac_f32 v21, v81, v81
  v_add_f32 v20, v20, v21
  v_cvt_pk_bf16_f32 v24, v64, v65
  v_cvt_pk_bf16_f32 v25, v66, v67
  v_cvt_pk_bf16_f32 v26, v68, v69
  v_cvt_pk_bf16_f32 v27, v70, v71
  v_cvt_pk_bf16_f32 v28, v72, v73
  v_cvt_pk_bf16_f32 v29, v74, v75
  v_cvt_pk_bf16_f32 v30, v76, v77
  v_cvt_pk_bf16_f32 v31, v78, v79
  v_cvt_pk_bf16_f32 v32, v80, v81
  buffer_store_dwordx4 v[24:27], v4, s[16:19], 0 offen sc1
  buffer_store_dwordx4 v[28:31], v4, s[16:19], 0 offen offset:2048 sc1
  buffer_store_dword v32, v5, s[16:19], 0 offen sc1
  v_add_f32_dpp v20, v20, v20 row_ror:8 row_mask:0xf bank_mask:0xf
  v_mov_b32 v15, v20
  s_nop 1
  v_permlane16_swap_b32 v20, v15
  v_add_f32 v20, v20, v15
  v_mov_b32 v15, v20
  s_nop 1
  v_permlane32_swap_b32 v20, v15
  v_add_f32 v20, v20, v15
  ds_write_b32 v9, v20 offset:128
  s_waitcnt lgkmcnt(0)
  s_barrier
  ds_read_b128 v[16:19], v10 offset:128
  s_waitcnt lgkmcnt(0)
  v_add_f32 v16, v16, v17
  v_add_f32 v18, v18, v19
  v_add_f32 v20, v16, v18
  v_mov_b32 v15, 0x3727c5ac
  v_fmac_f32 v15, 0x3ae38e39, v20
  v_rsq_f32 v15, v15
  v_and_b32 v22, 8, v0
  v_cmp_eq_u32 vcc, 0, v22
  s_nop 1
  v_cndmask_b32 v14, v14, v15, vcc
  s_lshl_b32 s36, s33, 7
  v_lshl_add_u32 v22, v0, 2, s36
  v_cmp_gt_u32 vcc, 32, v0
  s_nop 1
  v_cndmask_b32 v22, v11, v22, vcc
  buffer_store_dword v14, v22, s[20:23], 0 offen sc1
  s_waitcnt vmcnt(30)
  v_lshl_or_b32 v40, v100, 16, v40
  s_waitcnt vmcnt(28)
  v_lshl_or_b32 v41, v101, 16, v41
  s_waitcnt vmcnt(26)
  v_lshl_or_b32 v42, v102, 16, v42
  s_waitcnt vmcnt(24)
  v_lshl_or_b32 v43, v103, 16, v43
  s_waitcnt vmcnt(22)
  v_lshl_or_b32 v44, v104, 16, v44
  s_waitcnt vmcnt(20)
  v_lshl_or_b32 v45, v105, 16, v45
  s_waitcnt vmcnt(18)
  v_lshl_or_b32 v46, v106, 16, v46
  s_waitcnt vmcnt(16)
  v_lshl_or_b32 v47, v107, 16, v47
  s_waitcnt vmcnt(14)
  v_lshl_or_b32 v48, v108, 16, v48
  s_waitcnt vmcnt(12)
  v_lshl_or_b32 v49, v109, 16, v49
  s_waitcnt vmcnt(10)
  v_lshl_or_b32 v50, v110, 16, v50
  s_waitcnt vmcnt(8)
  v_lshl_or_b32 v51, v111, 16, v51
  buffer_store_dwordx4 v[40:43], v56, s[28:31], 0 offen sc1
  buffer_store_dwordx4 v[44:47], v56, s[28:31], s56 offen sc1
  buffer_store_dwordx4 v[48:51], v58, s[40:43], 0 offen sc1
  s_cmp_lt_u32 s2, 238
  s_cbranch_scc1 L_wb_b
  s_waitcnt vmcnt(11)
  v_mov_b32 v36, 0
  v_mov_b32 v37, 0
  s_mov_b32 s37, 0x3f803f80
  v_dot2c_f32_bf16 v36, s37, v128
  v_dot2c_f32_bf16 v37, s37, v129
  v_dot2c_f32_bf16 v36, s37, v130
  v_dot2c_f32_bf16 v37, s37, v131
  v_dot2c_f32_bf16 v36, s37, v132
  v_dot2c_f32_bf16 v37, s37, v133
  v_dot2c_f32_bf16 v36, s37, v134
  v_dot2c_f32_bf16 v37, s37, v135
  v_dot2c_f32_bf16 v36, s37, v136
  v_dot2c_f32_bf16 v37, s37, v137
  v_dot2c_f32_bf16 v36, s37, v138
  v_dot2c_f32_bf16 v37, s37, v139
  v_dot2c_f32_bf16 v36, s37, v140
  v_dot2c_f32_bf16 v37, s37, v141
  v_dot2c_f32_bf16 v36, s37, v142
  v_dot2c_f32_bf16 v37, s37, v143
  v_dot2c_f32_bf16 v36, s37, v144
  v_dot2c_f32_bf16 v37, s37, v145
  v_dot2c_f32_bf16 v36, s37, v146
  v_dot2c_f32_bf16 v37, s37, v147
  v_dot2c_f32_bf16 v36, s37, v148
  v_dot2c_f32_bf16 v37, s37, v149
  v_dot2c_f32_bf16 v36, s37, v150
  v_dot2c_f32_bf16 v37, s37, v151
  v_dot2c_f32_bf16 v36, s37, v152
  v_dot2c_f32_bf16 v37, s37, v153
  v_dot2c_f32_bf16 v36, s37, v154
  v_dot2c_f32_bf16 v37, s37, v155
  v_dot2c_f32_bf16 v36, s37, v156
  v_dot2c_f32_bf16 v37, s37, v157
  v_dot2c_f32_bf16 v36, s37, v158
  v_dot2c_f32_bf16 v37, s37, v159
  v_dot2c_f32_bf16 v36, s37, v160
  v_dot2c_f32_bf16 v37, s37, v161
  v_dot2c_f32_bf16 v36, s37, v162
  v_dot2c_f32_bf16 v37, s37, v163
  s_nop 2
  v_add_f32 v36, v36, v37
  s_nop 1
  v_add_f32_dpp v36, v36, v36 quad_perm:[1,0,3,2] row_mask:0xf bank_mask:0xf
  s_nop 1
  v_add_f32_dpp v36, v36, v36 quad_perm:[2,3,0,1] row_mask:0xf bank_mask:0xf
  s_nop 1
  v_add_f32_dpp v36, v36, v36 row_half_mirror row_mask:0xf bank_mask:0xf
  v_mul_f32 v36, 0x3ae38e39, v36
  v_cvt_pk_bf16_f32 v37, v36, v36
  v_and_b32 v37, 0xffff0000, v37
  v_sub_f32 v36, v36, v37
  v_cvt_pk_bf16_f32 v36, v36, v36
  v_and_b32 v36, 0xffff, v36
  v_lshrrev_b32 v37, 16, v37
  s_nop 0
  v_readlane_b32 s64, v37, 0
  v_readlane_b32 s65, v37, 8
  v_readlane_b32 s66, v36, 0
  v_readlane_b32 s67, v36, 8
  s_nop 3
  s_lshl_b32 s65, s65, 16
  s_or_b32 s64, s64, s65
  s_lshl_b32 s67, s67, 16
  s_or_b32 s66, s66, s67
  v_mov_b32 v164, 0
  v_writelane_b32 v164, s64, 0
  v_writelane_b32 v164, s66, 1
  v_readlane_b32 s64, v37, 16
  v_readlane_b32 s65, v37, 24
  v_readlane_b32 s66, v36, 16
  v_readlane_b32 s67, v36, 24
  s_nop 3
  s_lshl_b32 s65, s65, 16
  s_or_b32 s64, s64, s65
  s_lshl_b32 s67, s67, 16
  s_or_b32 s66, s66, s67
  v_mov_b32 v165, 0
  v_writelane_b32 v165, s64, 0
  v_writelane_b32 v165, s66, 1
  v_readlane_b32 s64, v37, 32
  v_readlane_b32 s65, v37, 40
  v_readlane_b32 s66, v36, 32
  v_readlane_b32 s67, v36, 40
  s_nop 3
  s_lshl_b32 s65, s65, 16
  s_or_b32 s64, s64, s65
  s_lshl_b32 s67, s67, 16
  s_or_b32 s66, s66, s67
  v_mov_b32 v166, 0
  v_writelane_b32 v166, s64, 0
  v_writelane_b32 v166, s66, 1
  v_readlane_b32 s64, v37, 48
  v_readlane_b32 s65, v37, 56
  v_readlane_b32 s66, v36, 48
  v_readlane_b32 s67, v36, 56
  s_nop 3
  s_lshl_b32 s65, s65, 16
  s_or_b32 s64, s64, s65
  s_lshl_b32 s67, s67, 16
  s_or_b32 s66, s66, s67
  v_mov_b32 v167, 0
  v_writelane_b32 v167, s64, 0
  v_writelane_b32 v167, s66, 1
  s_add_u32 s37, s55, 648
  s_lshl_b32 s37, s37, 10
  s_lshl_b32 s38, s92, 8
  s_add_u32 s37, s37, s38
  v_lshl_add_u32 v38, v1, 4, s37
  v_cmp_gt_u32 vcc, 16, v1
  s_nop 1
  v_cndmask_b32 v38, v11, v38, vcc
  buffer_store_dwordx4 v[164:167], v38, s[40:43], 0 offen sc1
L_wb_b:
  buffer_load_dword v7, v112, s[72:75], 0 offen sc1
  s_lshl_b32 s36, s93, 11
  s_lshl_b32 s37, s94, 3
  s_add_u32 s37, s37, s36
  v_and_b32 v31, 1, v0
  v_lshlrev_b32 v31, 2, v31
  v_bfe_u32 v30, v0, 1, 4
  v_lshl_add_u32 v29, v30, 7, v31
  v_add_u32 v29, s37, v29
  v_cmp_eq_u32 vcc, s94, v30
  v_lshl_add_u32 v30, v30, 3, v31
  v_xor_b32 v31, 8, v30
  v_cndmask_b32 v30, v30, v31, vcc
  s_lshl_b32 s37, s94, 7
  s_add_u32 s37, s37, s36
  v_add_u32 v30, s37, v30
  v_mov_b32 v31, 0x7ffffff0
  v_cmp_gt_u32 vcc, 32, v0
  s_nop 1
  v_cndmask_b32 v29, v31, v29, vcc
  s_add_u32 s44, s86, 0
  s_addc_u32 s45, s87, 0
  s_and_b32 s45, s45, 0xffff
  s_mov_b32 s46, 2064384
  s_mov_b32 s47, 0x20000
  s_mul_i32 s36, s94, 129024
  s_lshl_b32 s101, s92, 12
  s_add_u32 s36, s36, s101
  v_and_b32 v94, 63, v0
  v_lshlrev_b32 v94, 4, v94
  v_add_u32 v94, s36, v94
  v_bfe_u32 v6, v0, 1, 4
  v_lshlrev_b32 v6, 7, v6
  v_and_b32 v5, 4, v30
  v_add_u32 v6, v6, v5
  s_lshl_b32 s36, s93, 11
  s_lshl_b32 s37, s94, 3
  s_add_u32 s36, s36, s37
  s_add_u32 s36, s36, 427920
  s_cmp_lt_u32 s94, 14
  s_cselect_b32 s36, 0x7ffffff0, s36
  s_cmp_eq_u32 s93, 15
  s_cselect_b32 s36, 0x7ffffff0, s36
  v_add_u32 v6, s36, v6
  v_lshrrev_b32 v5, 5, v0
  v_cmp_eq_u32 vcc, 1, v5
  s_nop 1
  v_cndmask_b32 v5, v29, v6, vcc
  v_bfe_u32 v1, v0, 1, 4
  s_lshl_b32 s36, s94, 7
  s_lshl_b32 s37, s93, 3
  s_add_u32 s37, s37, s36
  v_lshl_add_u32 v2, v1, 11, s37
  v_add_u32 v2, v2, v112
  v_xor_b32 v3, 1, v1
  v_cmp_eq_u32 vcc, s93, v1
  s_nop 1
  v_cndmask_b32 v1, v1, v3, vcc
  v_and_b32 v3, 0xffffff84, v30
  v_lshl_add_u32 v1, v1, 3, v3
  v_and_b32 v3, 0xffffff80, v3
  v_lshl_add_u32 v3, v0, 2, v3
  v_mov_b32 v4, 0x7ffffff0
  v_cmp_gt_u32 vcc, 32, v0
  s_nop 1
  v_cndmask_b32 v2, v4, v2, vcc
  v_cndmask_b32 v3, v4, v3, vcc
  s_waitcnt vmcnt(0)
  v_cmp_eq_u32 vcc, 0, v7
  s_cbranch_vccnz L_sp_2
L_bk_3:
  s_barrier
  s_mov_b32 s36, 98304
  buffer_store_dword v7, v2, s[96:99], s36 offen sc1
  s_mov_b32 s36, 0
  buffer_store_dword v7, v5, s[96:99], s36 offen sc1
  s_mov_b32 s36, 229376
  buffer_store_dword v7, v3, s[96:99], s36 offen sc1
  s_mov_b32 s36, 98304
  buffer_load_dword v31, v1, s[96:99], s36 offen sc1
  s_waitcnt vmcnt(0)
  v_cmp_ne_u32 vcc, v7, v31
  s_cbranch_vccnz L_sp_4
L_bk_5:
  s_add_u32 m0, s101, 0
  s_mov_b32 s38, 0
  buffer_load_dwordx4 v94, s[44:47], s38 offen lds
  buffer_load_dwordx4 v94, s[44:47], s38 offen offset:1024 lds
  buffer_load_dwordx4 v94, s[44:47], s38 offen offset:2048 lds
  buffer_load_dwordx4 v94, s[44:47], s38 offen offset:3072 lds
  s_add_u32 m0, s101, 16384
  s_mov_b32 s38, 16384
  buffer_load_dwordx4 v94, s[44:47], s38 offen lds
  buffer_load_dwordx4 v94, s[44:47], s38 offen offset:1024 lds
  buffer_load_dwordx4 v94, s[44:47], s38 offen offset:2048 lds
  buffer_load_dwordx4 v94, s[44:47], s38 offen offset:3072 lds
  s_add_u32 m0, s101, 32768
  s_mov_b32 s38, 32768
  buffer_load_dwordx4 v94, s[44:47], s38 offen lds
  buffer_load_dwordx4 v94, s[44:47], s38 offen offset:1024 lds
  buffer_load_dwordx4 v94, s[44:47], s38 offen offset:2048 lds
  buffer_load_dwordx4 v94, s[44:47], s38 offen offset:3072 lds
L_layer:
  v_and_b32 v20, 63, v0
  v_and_b32 v21, 15, v20
  v_lshrrev_b32 v22, 4, v20
  v_lshlrev_b32 v1, 4, v20
  v_add_u32 v2, 65536, v1
  v_add_u32 v19, 131072, v1
  s_lshl_b32 s36, s92, 10
  v_add_u32 v3, s36, v1
  v_add_u32 v4, 65536, v3
  s_lshl_b32 s36, s93, 3
  s_max_u32 s37, s36, 1
  s_sub_u32 s37, s37, 1
  s_lshl_b32 s38, s92, 1
  s_add_u32 s36, s36, s38
  v_lshrrev_b32 v23, 3, v21
  v_lshlrev_b32 v23, 7, v23
  v_and_b32 v24, 7, v21
  v_lshl_add_u32 v23, v24, 2, v23
  s_lshl_b32 s38, s37, 8
  v_add_u32 v8, s38, v23
  s_lshl_b32 s38, s36, 8
  v_add_u32 v9, s38, v23
  s_mul_i32 s37, s37, 18432
  s_mul_i32 s35, s92, 5120
  s_add_u32 s37, s37, s35
  v_add_u32 v5, s37, v1
  s_add_u32 s35, s35, 131072
  s_mul_i32 s36, s36, 18432
  v_add_u32 v6, s36, v1
  v_and_b32 v23, 0xffffff84, v30
  v_and_b32 v24, 2, v20
  v_lshl_add_u32 v23, v24, 2, v23
  v_add_u32 v23, 425984, v23
  s_cmp_eq_u32 s93, 0
  s_cselect_b32 s37, 64, 32
  v_cmp_gt_u32 vcc, s37, v20
  s_nop 1
  v_cndmask_b32 v25, v23, v30, vcc
  s_mov_b32 s48, 0
  s_mov_b32 s53, 18432
  s_mov_b32 s49, 4096
  s_mov_b32 s54, 22528
  s_mov_b32 s50, 8192
  s_mov_b32 s55, 26624
  s_mov_b32 s51, 12288
  s_mov_b32 s56, 30720
  s_mov_b32 s52, 16384
  s_mov_b32 s57, 34816
  s_add_u32 s4, s90, 0
  s_addc_u32 s5, s91, 0
  s_and_b32 s5, s5, 0xffff
  s_mov_b32 s6, 2359296
  s_mov_b32 s7, 0x20000
  s_add_u32 s8, s90, 7077888
  s_addc_u32 s9, s91, 0
  s_and_b32 s9, s9, 0xffff
  s_mov_b32 s10, 32768
  s_mov_b32 s11, 0x20000
  s_add_u32 s12, s90, 4718592
  s_addc_u32 s13, s91, 0
  s_and_b32 s13, s13, 0xffff
  s_mov_b32 s14, 2359296
  s_mov_b32 s15, 0x20000
  v_mul_u32_u24 v23, 240, v21
  v_lshl_add_u32 v23, v22, 3, v23
  v_add_u32 v12, 129152, v23
  s_lshl_b32 s36, s92, 5
  s_add_u32 s37, s36, 129024
  v_add_u32 v11, s37, v23
  s_mul_i32 s36, s36, 240
  s_add_u32 s36, s36, 132864
  v_add_u32 v13, s36, v23
  v_lshrrev_b32 v26, 5, v20
  v_and_b32 v23, 31, v20
  s_lshl_b32 s36, s92, 5
  v_add_u32 v23, s36, v23
  v_mul_u32_u24 v24, 240, v23
  v_mul_u32_u24 v14, 80, v26
  v_add_u32 v14, v14, v24
  v_add_u32 v14, 129504, v14
  v_mul_u32_u24 v15, 36, v26
  v_add_u32 v15, v15, v24
  v_add_u32 v15, 133016, v15
  s_lshl_b32 s37, s93, 7
  v_add_u32 v23, s37, v23
  v_cmp_le_u32 s[64:65], 2, v23
  v_cmp_le_u32 s[66:67], 4, v23
  v_cmp_le_u32 s[68:69], 6, v23
  v_cmp_le_u32 s[70:71], 8, v23
  v_cmp_le_u32 s[72:73], 10, v23
  v_cmp_le_u32 s[74:75], 12, v23
  v_cmp_le_u32 s[76:77], 14, v23
  v_lshrrev_b32 v24, 4, v23
  v_mul_u32_u24 v24, 18432, v24
  v_lshl_add_u32 v16, v21, 4, v24
  v_lshl_add_u32 v16, v26, 9, v16
  s_lshl_b32 s37, s94, 10
  v_add_u32 v16, s37, v16
  v_lshl_add_u32 v17, v21, 2, v24
  v_lshl_add_u32 v17, v26, 6, v17
  s_lshl_b32 s37, s94, 7
  s_add_u32 s37, s37, 16384
  v_add_u32 v17, s37, v17
  v_mov_b32 v18, 0xceabfb8f
  s_mov_b32 s32, 0x05040100
  s_mov_b32 s33, 0x07060302
  s_mov_b32 s34, 0x3f803f80
  s_add_u32 s60, s86, 2064384
  s_addc_u32 s61, s87, 0
  s_and_b32 s61, s61, 0xffff
  s_mov_b32 s62, 681984
  s_mov_b32 s63, 0x20000
  s_and_b32 s36, s94, 3
  s_and_b32 s37, s36, 1
  s_mul_i32 s36, s36, 9
  s_add_u32 s38, s36, s37
  s_xor_b32 s37, s37, 1
  s_lshl_b32 s37, s37, 3
  s_add_u32 s36, s36, s37
  s_lshl_b32 s37, s92, 1
  s_add_u32 s38, s38, s37
  s_mul_i32 s38, s38, 18432
  v_add_u32 v250, s38, v1
  s_cmp_lt_u32 s92, 2
  s_cselect_b32 s36, s36, 36
  s_mul_i32 s36, s36, 18432
  v_add_u32 v251, s36, v1
  s_mov_b32 s36, 0
  buffer_load_dword v31, v25, s[96:99], s36 offen sc1
  s_waitcnt vmcnt(0)
  v_cmp_ne_u32 vcc, v7, v31
  s_cbranch_vccnz L_sp_10
L_bk_11:
  buffer_load_dwordx4 a[0:3], v6, s[4:7], s48 offen sc1
  buffer_load_dwordx4 a[72:75], v6, s[4:7], s53 offen sc1
  buffer_load_dwordx4 a[4:7], v6, s[4:7], s48 offen offset:1024 sc1
  buffer_load_dwordx4 a[76:79], v6, s[4:7], s53 offen offset:1024 sc1
  s_mov_b32 m0, s35
  s_nop 0
  buffer_load_dwordx4 v5, s[4:7], 0 offen sc1 lds
  buffer_load_dwordx4 v5, s[4:7], 0 offen offset:1024 sc1 lds
  buffer_load_dwordx4 v5, s[4:7], 0 offen offset:2048 sc1 lds
  buffer_load_dwordx4 v5, s[4:7], 0 offen offset:3072 sc1 lds
  s_add_u32 m0, s35, 4096
  s_nop 0
  buffer_load_dwordx4 v5, s[4:7], s49 offen sc1 lds
  buffer_load_dwordx4 a[8:11], v6, s[4:7], s48 offen offset:2048 sc1
  buffer_load_dwordx4 a[80:83], v6, s[4:7], s53 offen offset:2048 sc1
  buffer_load_dwordx4 a[12:15], v6, s[4:7], s48 offen offset:3072 sc1
  buffer_load_dwordx4 a[84:87], v6, s[4:7], s53 offen offset:3072 sc1
  s_waitcnt vmcnt(11)
  s_barrier
  ds_read_b128 v[176:179], v1
  ds_read_b128 v[180:183], v1 offset:1024
  ds_read_b128 v[184:187], v1 offset:2048
  ds_read_b128 v[188:191], v1 offset:3072
  ds_read_b128 v[192:195], v1 offset:4096
  ds_read_b128 v[196:199], v1 offset:5120
  ds_read_b128 v[200:203], v1 offset:6144
  s_waitcnt lgkmcnt(0)
  v_mfma_f32_16x16x32_bf16 v[112:115], v[176:179], a[0:3], 0
  ds_read_b128 v[204:207], v1 offset:7168
  v_mfma_f32_16x16x32_bf16 v[140:143], v[176:179], a[72:75], 0
  ds_read_b128 v[208:211], v1 offset:8192
  v_mfma_f32_16x16x32_bf16 v[116:119], v[180:183], a[0:3], 0
  ds_read_b128 v[212:215], v1 offset:9216
  v_mfma_f32_16x16x32_bf16 v[144:147], v[180:183], a[72:75], 0
  ds_read_b128 v[216:219], v1 offset:10240
  v_mfma_f32_16x16x32_bf16 v[120:123], v[184:187], a[0:3], 0
  ds_read_b128 v[220:223], v1 offset:11264
  v_mfma_f32_16x16x32_bf16 v[148:151], v[184:187], a[72:75], 0
  ds_read_b128 v[224:227], v1 offset:12288
  v_mfma_f32_16x16x32_bf16 v[124:127], v[188:191], a[0:3], 0
  ds_read_b128 v[228:231], v1 offset:13312
  v_mfma_f32_16x16x32_bf16 v[152:155], v[188:191], a[72:75], 0
  buffer_load_dwordx4 a[16:19], v6, s[4:7], s49 offen sc1
  v_mfma_f32_16x16x32_bf16 v[128:131], v[192:195], a[0:3], 0
  buffer_load_dwordx4 a[88:91], v6, s[4:7], s54 offen sc1
  v_mfma_f32_16x16x32_bf16 v[156:159], v[192:195], a[72:75], 0
  s_cmp_lg_u32 s95, 0
  s_cbranch_scc1 L_l0_12
  s_add_u32 m0, s101, 49152
  s_mov_b32 s36, 49152
  buffer_load_dwordx4 v94, s[44:47], s36 offen lds
  buffer_load_dwordx4 v94, s[44:47], s36 offen offset:1024 lds
  buffer_load_dwordx4 v94, s[44:47], s36 offen offset:2048 lds
  buffer_load_dwordx4 v94, s[44:47], s36 offen offset:3072 lds
L_l0_12:
  v_mfma_f32_16x16x32_bf16 v[132:135], v[196:199], a[0:3], 0
  v_mfma_f32_16x16x32_bf16 v[160:163], v[196:199], a[72:75], 0
  v_mfma_f32_16x16x32_bf16 v[136:139], v[200:203], a[0:3], 0
  v_mfma_f32_16x16x32_bf16 v[164:167], v[200:203], a[72:75], 0
  s_waitcnt vmcnt(11) lgkmcnt(0)
  v_mfma_f32_16x16x32_bf16 v[112:115], v[204:207], a[4:7], v[112:115]
  s_barrier
  v_mfma_f32_16x16x32_bf16 v[140:143], v[204:207], a[76:79], v[140:143]
  ds_read_b128 v[176:179], v1 offset:14336
  v_mfma_f32_16x16x32_bf16 v[116:119], v[208:211], a[4:7], v[116:119]
  ds_read_b128 v[180:183], v1 offset:15360
  v_mfma_f32_16x16x32_bf16 v[144:147], v[208:211], a[76:79], v[144:147]
  ds_read_b128 v[184:187], v1 offset:16384
  v_mfma_f32_16x16x32_bf16 v[120:123], v[212:215], a[4:7], v[120:123]
  ds_read_b128 v[188:191], v1 offset:17408
  v_mfma_f32_16x16x32_bf16 v[148:151], v[212:215], a[76:79], v[148:151]
  ds_read_b128 v[192:195], v1 offset:18432
  v_mfma_f32_16x16x32_bf16 v[124:127], v[216:219], a[4:7], v[124:127]
  ds_read_b128 v[196:199], v1 offset:19456
  v_mfma_f32_16x16x32_bf16 v[152:155], v[216:219], a[76:79], v[152:155]
  ds_read_b128 v[200:203], v1 offset:20480
  v_mfma_f32_16x16x32_bf16 v[128:131], v[220:223], a[4:7], v[128:131]
  buffer_load_dwordx4 a[20:23], v6, s[4:7], s49 offen offset:1024 sc1
  v_mfma_f32_16x16x32_bf16 v[156:159], v[220:223], a[76:79], v[156:159]
  buffer_load_dwordx4 a[92:95], v6, s[4:7], s54 offen offset:1024 sc1
  v_mfma_f32_16x16x32_bf16 v[132:135], v[224:227], a[4:7], v[132:135]
  v_mfma_f32_16x16x32_bf16 v[160:163], v[224:227], a[76:79], v[160:163]
  v_mfma_f32_16x16x32_bf16 v[136:139], v[228:231], a[4:7], v[136:139]
  v_mfma_f32_16x16x32_bf16 v[164:167], v[228:231], a[76:79], v[164:167]
  s_waitcnt vmcnt(6) lgkmcnt(0)
  v_mfma_f32_16x16x32_bf16 v[112:115], v[176:179], a[8:11], v[112:115]
  s_barrier
  v_mfma_f32_16x16x32_bf16 v[140:143], v[176:179], a[80:83], v[140:143]
  ds_read_b128 v[204:207], v1 offset:21504
  v_mfma_f32_16x16x32_bf16 v[116:119], v[180:183], a[8:11], v[116:119]
  ds_read_b128 v[208:211], v1 offset:22528
  v_mfma_f32_16x16x32_bf16 v[144:147], v[180:183], a[80:83], v[144:147]
  ds_read_b128 v[212:215], v1 offset:23552
  v_mfma_f32_16x16x32_bf16 v[120:123], v[184:187], a[8:11], v[120:123]
  ds_read_b128 v[216:219], v1 offset:24576
  v_mfma_f32_16x16x32_bf16 v[148:151], v[184:187], a[80:83], v[148:151]
  ds_read_b128 v[220:223], v1 offset:25600
  v_mfma_f32_16x16x32_bf16 v[124:127], v[188:191], a[8:11], v[124:127]
  ds_read_b128 v[224:227], v1 offset:26624
  v_mfma_f32_16x16x32_bf16 v[152:155], v[188:191], a[80:83], v[152:155]
  ds_read_b128 v[228:231], v1 offset:27648
  v_mfma_f32_16x16x32_bf16 v[128:131], v[192:195], a[8:11], v[128:131]
  ds_read_b128 v[32:35], v3
  v_mfma_f32_16x16x32_bf16 v[156:159], v[192:195], a[80:83], v[156:159]
  s_cmp_lg_u32 s95, 0
  s_cbranch_scc1 L_l0_13
  s_add_u32 m0, s101, 65536
  s_mov_b32 s36, 65536
  buffer_load_dwordx4 v94, s[44:47], s36 offen lds
  buffer_load_dwordx4 v94, s[44:47], s36 offen offset:1024 lds
  buffer_load_dwordx4 v94, s[44:47], s36 offen offset:2048 lds
  buffer_load_dwordx4 v94, s[44:47], s36 offen offset:3072 lds
L_l0_13:
  v_mfma_f32_16x16x32_bf16 v[132:135], v[196:199], a[8:11], v[132:135]
  ds_read_b128 v[36:39], v1 offset:4096
  v_mfma_f32_16x16x32_bf16 v[160:163], v[196:199], a[80:83], v[160:163]
  ds_read_b128 v[40:43], v19
  v_mfma_f32_16x16x32_bf16 v[136:139], v[200:203], a[8:11], v[136:139]
  buffer_load_dwordx4 a[24:27], v6, s[4:7], s49 offen offset:2048 sc1
  v_mfma_f32_16x16x32_bf16 v[164:167], v[200:203], a[80:83], v[164:167]
  buffer_load_dwordx4 a[96:99], v6, s[4:7], s54 offen offset:2048 sc1
  s_waitcnt vmcnt(6) lgkmcnt(0)
  v_mfma_f32_16x16x32_bf16 v[112:115], v[204:207], a[12:15], v[112:115]
  s_barrier
  v_mfma_f32_16x16x32_bf16 v[140:143], v[204:207], a[84:87], v[140:143]
  ds_read_b128 v[176:179], v1 offset:28672
  v_mfma_f32_16x16x32_bf16 v[116:119], v[208:211], a[12:15], v[116:119]
  ds_read_b128 v[180:183], v1 offset:29696
  v_mfma_f32_16x16x32_bf16 v[144:147], v[208:211], a[84:87], v[144:147]
  ds_read_b128 v[184:187], v1 offset:30720
  v_mfma_f32_16x16x32_bf16 v[120:123], v[212:215], a[12:15], v[120:123]
  ds_read_b128 v[188:191], v1 offset:31744
  v_mfma_f32_16x16x32_bf16 v[148:151], v[212:215], a[84:87], v[148:151]
  ds_read_b128 v[192:195], v1 offset:32768
  v_mfma_f32_16x16x32_bf16 v[124:127], v[216:219], a[12:15], v[124:127]
  ds_read_b128 v[196:199], v1 offset:33792
  v_mfma_f32_16x16x32_bf16 v[152:155], v[216:219], a[84:87], v[152:155]
  ds_read_b128 v[200:203], v1 offset:34816
  v_mfma_f32_16x16x32_bf16 v[128:131], v[220:223], a[12:15], v[128:131]
  ds_read_b128 v[44:47], v3 offset:7168
  v_mfma_f32_16x16x32_bf16 v[156:159], v[220:223], a[84:87], v[156:159]
  ds_read_b128 v[48:51], v1 offset:11264
  v_mfma_f32_16x16x32_bf16 v[132:135], v[224:227], a[12:15], v[132:135]
  ds_read_b128 v[52:55], v19 offset:1024
  v_mfma_f32_16x16x32_bf16 v[160:163], v[224:227], a[84:87], v[160:163]
  buffer_load_dwordx4 a[28:31], v6, s[4:7], s49 offen offset:3072 sc1
  v_mfma_f32_16x16x32_bf16 v[136:139], v[228:231], a[12:15], v[136:139]
  buffer_load_dwordx4 a[100:103], v6, s[4:7], s54 offen offset:3072 sc1
  v_mfma_f32_16x16x32_bf16 v[164:167], v[228:231], a[84:87], v[164:167]
  v_mfma_f32_16x16x32_bf16 v[168:171], v[32:35], v[40:43], 0
  v_mfma_f32_16x16x32_bf16 v[172:175], v[36:39], v[40:43], 0
  s_waitcnt vmcnt(6) lgkmcnt(0)
  v_mfma_f32_16x16x32_bf16 v[112:115], v[176:179], a[16:19], v[112:115]
  ds_read_b128 v[204:207], v1 offset:35840
  v_mfma_f32_16x16x32_bf16 v[140:143], v[176:179], a[88:91], v[140:143]
  ds_read_b128 v[208:211], v1 offset:36864
  v_mfma_f32_16x16x32_bf16 v[116:119], v[180:183], a[16:19], v[116:119]
  ds_read_b128 v[212:215], v1 offset:37888
  v_mfma_f32_16x16x32_bf16 v[144:147], v[180:183], a[88:91], v[144:147]
  ds_read_b128 v[216:219], v1 offset:38912
  v_mfma_f32_16x16x32_bf16 v[120:123], v[184:187], a[16:19], v[120:123]
  ds_read_b128 v[220:223], v1 offset:39936
  v_mfma_f32_16x16x32_bf16 v[148:151], v[184:187], a[88:91], v[148:151]
  ds_read_b128 v[224:227], v1 offset:40960
  v_mfma_f32_16x16x32_bf16 v[124:127], v[188:191], a[16:19], v[124:127]
  ds_read_b128 v[228:231], v1 offset:41984
  v_mfma_f32_16x16x32_bf16 v[152:155], v[188:191], a[88:91], v[152:155]
  ds_read_b128 v[32:35], v3 offset:14336
  v_mfma_f32_16x16x32_bf16 v[128:131], v[192:195], a[16:19], v[128:131]
  ds_read_b128 v[36:39], v1 offset:18432
  v_mfma_f32_16x16x32_bf16 v[156:159], v[192:195], a[88:91], v[156:159]
  s_cmp_lg_u32 s95, 0
  s_cbranch_scc1 L_l0_14
  s_add_u32 m0, s101, 81920
  s_mov_b32 s36, 81920
  buffer_load_dwordx4 v94, s[44:47], s36 offen lds
  buffer_load_dwordx4 v94, s[44:47], s36 offen offset:1024 lds
  buffer_load_dwordx4 v94, s[44:47], s36 offen offset:2048 lds
  buffer_load_dwordx4 v94, s[44:47], s36 offen offset:3072 lds
L_l0_14:
  v_mfma_f32_16x16x32_bf16 v[132:135], v[196:199], a[16:19], v[132:135]
  ds_read_b128 v[40:43], v19 offset:2048
  v_mfma_f32_16x16x32_bf16 v[160:163], v[196:199], a[88:91], v[160:163]
  buffer_load_dwordx4 a[32:35], v6, s[4:7], s50 offen sc1
  v_mfma_f32_16x16x32_bf16 v[136:139], v[200:203], a[16:19], v[136:139]
  buffer_load_dwordx4 a[104:107], v6, s[4:7], s55 offen sc1
  v_mfma_f32_16x16x32_bf16 v[164:167], v[200:203], a[88:91], v[164:167]
  v_mfma_f32_16x16x32_bf16 v[168:171], v[44:47], v[52:55], v[168:171]
  v_mfma_f32_16x16x32_bf16 v[172:175], v[48:51], v[52:55], v[172:175]
  s_waitcnt vmcnt(6) lgkmcnt(0)
  v_mfma_f32_16x16x32_bf16 v[112:115], v[204:207], a[20:23], v[112:115]
  s_barrier
  v_mfma_f32_16x16x32_bf16 v[140:143], v[204:207], a[92:95], v[140:143]
  ds_read_b128 v[176:179], v1 offset:43008
  v_mfma_f32_16x16x32_bf16 v[116:119], v[208:211], a[20:23], v[116:119]
  ds_read_b128 v[180:183], v1 offset:44032
  v_mfma_f32_16x16x32_bf16 v[144:147], v[208:211], a[92:95], v[144:147]
  ds_read_b128 v[184:187], v1 offset:45056
  v_mfma_f32_16x16x32_bf16 v[120:123], v[212:215], a[20:23], v[120:123]
  ds_read_b128 v[188:191], v1 offset:46080
  v_mfma_f32_16x16x32_bf16 v[148:151], v[212:215], a[92:95], v[148:151]
  ds_read_b128 v[192:195], v1 offset:47104
  v_mfma_f32_16x16x32_bf16 v[124:127], v[216:219], a[20:23], v[124:127]
  ds_read_b128 v[196:199], v1 offset:48128
  v_mfma_f32_16x16x32_bf16 v[152:155], v[216:219], a[92:95], v[152:155]
  ds_read_b128 v[200:203], v1 offset:49152
  v_mfma_f32_16x16x32_bf16 v[128:131], v[220:223], a[20:23], v[128:131]
  ds_read_b128 v[44:47], v3 offset:21504
  v_mfma_f32_16x16x32_bf16 v[156:159], v[220:223], a[92:95], v[156:159]
  ds_read_b128 v[48:51], v1 offset:25600
  v_mfma_f32_16x16x32_bf16 v[132:135], v[224:227], a[20:23], v[132:135]
  ds_read_b128 v[52:55], v19 offset:3072
  v_mfma_f32_16x16x32_bf16 v[160:163], v[224:227], a[92:95], v[160:163]
  buffer_load_dwordx4 a[36:39], v6, s[4:7], s50 offen offset:1024 sc1
  v_mfma_f32_16x16x32_bf16 v[136:139], v[228:231], a[20:23], v[136:139]
  buffer_load_dwordx4 a[108:111], v6, s[4:7], s55 offen offset:1024 sc1
  v_mfma_f32_16x16x32_bf16 v[164:167], v[228:231], a[92:95], v[164:167]
  v_mfma_f32_16x16x32_bf16 v[168:171], v[32:35], v[40:43], v[168:171]
  v_mfma_f32_16x16x32_bf16 v[172:175], v[36:39], v[40:43], v[172:175]
  s_waitcnt vmcnt(6) lgkmcnt(0)
  v_mfma_f32_16x16x32_bf16 v[112:115], v[176:179], a[24:27], v[112:115]
  ds_read_b128 v[204:207], v1 offset:50176
  v_mfma_f32_16x16x32_bf16 v[140:143], v[176:179], a[96:99], v[140:143]
  ds_read_b128 v[208:211], v1 offset:51200
  v_mfma_f32_16x16x32_bf16 v[116:119], v[180:183], a[24:27], v[116:119]
  ds_read_b128 v[212:215], v1 offset:52224
  v_mfma_f32_16x16x32_bf16 v[144:147], v[180:183], a[96:99], v[144:147]
  ds_read_b128 v[216:219], v1 offset:53248
  v_mfma_f32_16x16x32_bf16 v[120:123], v[184:187], a[24:27], v[120:123]
  ds_read_b128 v[220:223], v1 offset:54272
  v_mfma_f32_16x16x32_bf16 v[148:151], v[184:187], a[96:99], v[148:151]
  ds_read_b128 v[224:227], v1 offset:55296
  v_mfma_f32_16x16x32_bf16 v[124:127], v[188:191], a[24:27], v[124:127]
  ds_read_b128 v[228:231], v1 offset:56320
  v_mfma_f32_16x16x32_bf16 v[152:155], v[188:191], a[96:99], v[152:155]
  ds_read_b128 v[32:35], v3 offset:28672
  v_mfma_f32_16x16x32_bf16 v[128:131], v[192:195], a[24:27], v[128:131]
  ds_read_b128 v[36:39], v1 offset:32768
  v_mfma_f32_16x16x32_bf16 v[156:159], v[192:195], a[96:99], v[156:159]
  s_cmp_lg_u32 s95, 0
  s_cbranch_scc1 L_l0_15
  s_add_u32 m0, s101, 98304
  s_mov_b32 s36, 98304
  buffer_load_dwordx4 v94, s[44:47], s36 offen lds
  buffer_load_dwordx4 v94, s[44:47], s36 offen offset:1024 lds
  buffer_load_dwordx4 v94, s[44:47], s36 offen offset:2048 lds
  buffer_load_dwordx4 v94, s[44:47], s36 offen offset:3072 lds
L_l0_15:
  v_mfma_f32_16x16x32_bf16 v[132:135], v[196:199], a[24:27], v[132:135]
  ds_read_b128 v[40:43], v19 offset:4096
  v_mfma_f32_16x16x32_bf16 v[160:163], v[196:199], a[96:99], v[160:163]
  buffer_load_dwordx4 a[40:43], v6, s[4:7], s50 offen offset:2048 sc1
  v_mfma_f32_16x16x32_bf16 v[136:139], v[200:203], a[24:27], v[136:139]
  buffer_load_dwordx4 a[112:115], v6, s[4:7], s55 offen offset:2048 sc1
  v_mfma_f32_16x16x32_bf16 v[164:167], v[200:203], a[96:99], v[164:167]
  v_mfma_f32_16x16x32_bf16 v[168:171], v[44:47], v[52:55], v[168:171]
  v_mfma_f32_16x16x32_bf16 v[172:175], v[48:51], v[52:55], v[172:175]
  s_waitcnt vmcnt(6) lgkmcnt(0)
  v_mfma_f32_16x16x32_bf16 v[112:115], v[204:207], a[28:31], v[112:115]
  ds_read_b128 v[176:179], v1 offset:57344
  v_mfma_f32_16x16x32_bf16 v[140:143], v[204:207], a[100:103], v[140:143]
  ds_read_b128 v[180:183], v1 offset:58368
  v_mfma_f32_16x16x32_bf16 v[116:119], v[208:211], a[28:31], v[116:119]
  ds_read_b128 v[184:187], v1 offset:59392
  v_mfma_f32_16x16x32_bf16 v[144:147], v[208:211], a[100:103], v[144:147]
  ds_read_b128 v[188:191], v1 offset:60416
  v_mfma_f32_16x16x32_bf16 v[120:123], v[212:215], a[28:31], v[120:123]
  ds_read_b128 v[192:195], v1 offset:61440
  v_mfma_f32_16x16x32_bf16 v[148:151], v[212:215], a[100:103], v[148:151]
  ds_read_b128 v[196:199], v1 offset:62464
  v_mfma_f32_16x16x32_bf16 v[124:127], v[216:219], a[28:31], v[124:127]
  ds_read_b128 v[200:203], v1 offset:63488
  v_mfma_f32_16x16x32_bf16 v[152:155], v[216:219], a[100:103], v[152:155]
  ds_read_b128 v[44:47], v3 offset:35840
  v_mfma_f32_16x16x32_bf16 v[128:131], v[220:223], a[28:31], v[128:131]
  ds_read_b128 v[48:51], v1 offset:39936
  v_mfma_f32_16x16x32_bf16 v[156:159], v[220:223], a[100:103], v[156:159]
  s_cmp_lg_u32 s95, 0
  s_cbranch_scc1 L_l0_16
  v_lshrrev_b32 v27, 1, v0
  v_lshlrev_b32 v27, 7, v27
  v_and_b32 v28, 4, v30
  v_add_u32 v27, v27, v28
  v_add_u32 v28, 16384, v27
  s_mov_b32 s37, 229376
  buffer_load_dword v31, v27, s[96:99], s37 offen sc1
  s_mov_b32 s37, 229376
  buffer_load_dword v26, v28, s[96:99], s37 offen sc1
  s_waitcnt vmcnt(1)
  v_cmp_ne_u32 vcc, v7, v31
  s_cbranch_vccnz L_sp_6
L_bk_7:
  s_waitcnt vmcnt(0)
  v_cmp_ne_u32 vcc, v7, v26
  s_cbranch_vccnz L_sp_8
L_bk_9:
L_l0_16:
  v_mfma_f32_16x16x32_bf16 v[132:135], v[224:227], a[28:31], v[132:135]
  ds_read_b128 v[52:55], v19 offset:5120
  v_mfma_f32_16x16x32_bf16 v[160:163], v[224:227], a[100:103], v[160:163]
  buffer_load_dwordx4 a[44:47], v6, s[4:7], s50 offen offset:3072 sc1
  v_mfma_f32_16x16x32_bf16 v[136:139], v[228:231], a[28:31], v[136:139]
  buffer_load_dwordx4 a[116:119], v6, s[4:7], s55 offen offset:3072 sc1
  v_mfma_f32_16x16x32_bf16 v[164:167], v[228:231], a[100:103], v[164:167]
  v_mfma_f32_16x16x32_bf16 v[168:171], v[32:35], v[40:43], v[168:171]
  v_mfma_f32_16x16x32_bf16 v[172:175], v[36:39], v[40:43], v[172:175]
  s_waitcnt vmcnt(6) lgkmcnt(0)
  v_mfma_f32_16x16x32_bf16 v[112:115], v[176:179], a[32:35], v[112:115]
  s_barrier
  v_mfma_f32_16x16x32_bf16 v[140:143], v[176:179], a[104:107], v[140:143]
  ds_read_b128 v[204:207], v1 offset:64512
  v_mfma_f32_16x16x32_bf16 v[116:119], v[180:183], a[32:35], v[116:119]
  ds_read_b128 v[208:211], v2
  v_mfma_f32_16x16x32_bf16 v[144:147], v[180:183], a[104:107], v[144:147]
  ds_read_b128 v[212:215], v2 offset:1024
  v_mfma_f32_16x16x32_bf16 v[120:123], v[184:187], a[32:35], v[120:123]
  ds_read_b128 v[216:219], v2 offset:2048
  v_mfma_f32_16x16x32_bf16 v[148:151], v[184:187], a[104:107], v[148:151]
  ds_read_b128 v[220:223], v2 offset:3072
  v_mfma_f32_16x16x32_bf16 v[124:127], v[188:191], a[32:35], v[124:127]
  ds_read_b128 v[224:227], v2 offset:4096
  v_mfma_f32_16x16x32_bf16 v[152:155], v[188:191], a[104:107], v[152:155]
  ds_read_b128 v[228:231], v2 offset:5120
  v_mfma_f32_16x16x32_bf16 v[128:131], v[192:195], a[32:35], v[128:131]
  ds_read_b128 v[32:35], v3 offset:43008
  v_mfma_f32_16x16x32_bf16 v[156:159], v[192:195], a[104:107], v[156:159]
  s_cmp_lg_u32 s95, 0
  s_cbranch_scc1 L_l0_17
  s_add_u32 m0, s101, 114688
  s_mov_b32 s36, 114688
  buffer_load_dwordx4 v94, s[44:47], s36 offen lds
  buffer_load_dwordx4 v94, s[44:47], s36 offen offset:1024 lds
  buffer_load_dwordx4 v94, s[44:47], s36 offen offset:2048 lds
  buffer_load_dwordx4 v94, s[44:47], s36 offen offset:3072 lds
L_l0_17:
  v_mfma_f32_16x16x32_bf16 v[132:135], v[196:199], a[32:35], v[132:135]
  ds_read_b128 v[36:39], v1 offset:47104
  v_mfma_f32_16x16x32_bf16 v[160:163], v[196:199], a[104:107], v[160:163]
  ds_read_b128 v[40:43], v19 offset:6144
  v_mfma_f32_16x16x32_bf16 v[136:139], v[200:203], a[32:35], v[136:139]
  buffer_load_dwordx4 a[48:51], v6, s[4:7], s51 offen sc1
  v_mfma_f32_16x16x32_bf16 v[164:167], v[200:203], a[104:107], v[164:167]
  buffer_load_dwordx4 a[120:123], v6, s[4:7], s56 offen sc1
  v_mfma_f32_16x16x32_bf16 v[168:171], v[44:47], v[52:55], v[168:171]
  v_mfma_f32_16x16x32_bf16 v[172:175], v[48:51], v[52:55], v[172:175]
  s_waitcnt vmcnt(6) lgkmcnt(0)
  v_mfma_f32_16x16x32_bf16 v[112:115], v[204:207], a[36:39], v[112:115]
  ds_read_b128 v[176:179], v2 offset:6144
  v_mfma_f32_16x16x32_bf16 v[140:143], v[204:207], a[108:111], v[140:143]
  ds_read_b128 v[180:183], v2 offset:7168
  v_mfma_f32_16x16x32_bf16 v[116:119], v[208:211], a[36:39], v[116:119]
  ds_read_b128 v[184:187], v2 offset:8192
  v_mfma_f32_16x16x32_bf16 v[144:147], v[208:211], a[108:111], v[144:147]
  ds_read_b128 v[188:191], v2 offset:9216
  v_mfma_f32_16x16x32_bf16 v[120:123], v[212:215], a[36:39], v[120:123]
  ds_read_b128 v[192:195], v2 offset:10240
  v_mfma_f32_16x16x32_bf16 v[148:151], v[212:215], a[108:111], v[148:151]
  ds_read_b128 v[196:199], v2 offset:11264
  v_mfma_f32_16x16x32_bf16 v[124:127], v[216:219], a[36:39], v[124:127]
  ds_read_b128 v[200:203], v2 offset:12288
  v_mfma_f32_16x16x32_bf16 v[152:155], v[216:219], a[108:111], v[152:155]
  ds_read_b128 v[44:47], v3 offset:50176
  v_mfma_f32_16x16x32_bf16 v[128:131], v[220:223], a[36:39], v[128:131]
  ds_read_b128 v[48:51], v1 offset:54272
  v_mfma_f32_16x16x32_bf16 v[156:159], v[220:223], a[108:111], v[156:159]
  ds_read_b128 v[52:55], v19 offset:7168
  v_mfma_f32_16x16x32_bf16 v[132:135], v[224:227], a[36:39], v[132:135]
  buffer_load_dwordx4 a[52:55], v6, s[4:7], s51 offen offset:1024 sc1
  v_mfma_f32_16x16x32_bf16 v[160:163], v[224:227], a[108:111], v[160:163]
  buffer_load_dwordx4 a[124:127], v6, s[4:7], s56 offen offset:1024 sc1
  v_mfma_f32_16x16x32_bf16 v[136:139], v[228:231], a[36:39], v[136:139]
  buffer_load_dwordx4 a[144:147], v251, s[60:63], s48 offen
  v_mfma_f32_16x16x32_bf16 v[164:167], v[228:231], a[108:111], v[164:167]
  buffer_load_dwordx4 a[148:151], v251, s[60:63], s48 offen offset:1024
  v_mfma_f32_16x16x32_bf16 v[168:171], v[32:35], v[40:43], v[168:171]
  v_mfma_f32_16x16x32_bf16 v[172:175], v[36:39], v[40:43], v[172:175]
  s_waitcnt vmcnt(8) lgkmcnt(0)
  v_mfma_f32_16x16x32_bf16 v[112:115], v[176:179], a[40:43], v[112:115]
  s_barrier
  v_mfma_f32_16x16x32_bf16 v[140:143], v[176:179], a[112:115], v[140:143]
  ds_read_b128 v[204:207], v2 offset:13312
  v_mfma_f32_16x16x32_bf16 v[116:119], v[180:183], a[40:43], v[116:119]
  ds_read_b128 v[208:211], v2 offset:14336
  v_mfma_f32_16x16x32_bf16 v[144:147], v[180:183], a[112:115], v[144:147]
  ds_read_b128 v[212:215], v2 offset:15360
  v_mfma_f32_16x16x32_bf16 v[120:123], v[184:187], a[40:43], v[120:123]
  ds_read_b128 v[216:219], v2 offset:16384
  v_mfma_f32_16x16x32_bf16 v[148:151], v[184:187], a[112:115], v[148:151]
  ds_read_b128 v[220:223], v2 offset:17408
  v_mfma_f32_16x16x32_bf16 v[124:127], v[188:191], a[40:43], v[124:127]
  ds_read_b128 v[224:227], v2 offset:18432
  v_mfma_f32_16x16x32_bf16 v[152:155], v[188:191], a[112:115], v[152:155]
  ds_read_b128 v[228:231], v2 offset:19456
  v_mfma_f32_16x16x32_bf16 v[128:131], v[192:195], a[40:43], v[128:131]
  ds_read_b128 v[32:35], v3 offset:57344
  v_mfma_f32_16x16x32_bf16 v[156:159], v[192:195], a[112:115], v[156:159]
  ds_read_b128 v[36:39], v1 offset:61440
  v_mfma_f32_16x16x32_bf16 v[132:135], v[196:199], a[40:43], v[132:135]
  ds_read_b128 v[40:43], v19 offset:8192
  v_mfma_f32_16x16x32_bf16 v[160:163], v[196:199], a[112:115], v[160:163]
  buffer_load_dwordx4 a[56:59], v6, s[4:7], s51 offen offset:2048 sc1
  v_mfma_f32_16x16x32_bf16 v[136:139], v[200:203], a[40:43], v[136:139]
  buffer_load_dwordx4 a[128:131], v6, s[4:7], s56 offen offset:2048 sc1
  v_mfma_f32_16x16x32_bf16 v[164:167], v[200:203], a[112:115], v[164:167]
  buffer_load_dwordx4 a[152:155], v251, s[60:63], s48 offen offset:2048
  v_mfma_f32_16x16x32_bf16 v[168:171], v[44:47], v[52:55], v[168:171]
  buffer_load_dwordx4 a[156:159], v251, s[60:63], s48 offen offset:3072
  v_mfma_f32_16x16x32_bf16 v[172:175], v[48:51], v[52:55], v[172:175]
  s_waitcnt vmcnt(10) lgkmcnt(0)
  v_mfma_f32_16x16x32_bf16 v[112:115], v[204:207], a[44:47], v[112:115]
  ds_read_b128 v[176:179], v2 offset:20480
  v_mfma_f32_16x16x32_bf16 v[140:143], v[204:207], a[116:119], v[140:143]
  ds_read_b128 v[180:183], v2 offset:21504
  v_mfma_f32_16x16x32_bf16 v[116:119], v[208:211], a[44:47], v[116:119]
  ds_read_b128 v[184:187], v2 offset:22528
  v_mfma_f32_16x16x32_bf16 v[144:147], v[208:211], a[116:119], v[144:147]
  ds_read_b128 v[188:191], v2 offset:23552
  v_mfma_f32_16x16x32_bf16 v[120:123], v[212:215], a[44:47], v[120:123]
  ds_read_b128 v[192:195], v2 offset:24576
  v_mfma_f32_16x16x32_bf16 v[148:151], v[212:215], a[116:119], v[148:151]
  ds_read_b128 v[196:199], v2 offset:25600
  v_mfma_f32_16x16x32_bf16 v[124:127], v[216:219], a[44:47], v[124:127]
  ds_read_b128 v[200:203], v2 offset:26624
  v_mfma_f32_16x16x32_bf16 v[152:155], v[216:219], a[116:119], v[152:155]
  ds_read_b128 v[44:47], v3 offset:64512
  v_mfma_f32_16x16x32_bf16 v[128:131], v[220:223], a[44:47], v[128:131]
  ds_read_b128 v[48:51], v2 offset:3072
  v_mfma_f32_16x16x32_bf16 v[156:159], v[220:223], a[116:119], v[156:159]
  ds_read_b128 v[52:55], v19 offset:9216
  v_mfma_f32_16x16x32_bf16 v[132:135], v[224:227], a[44:47], v[132:135]
  buffer_load_dwordx4 a[60:63], v6, s[4:7], s51 offen offset:3072 sc1
  v_mfma_f32_16x16x32_bf16 v[160:163], v[224:227], a[116:119], v[160:163]
  buffer_load_dwordx4 a[132:135], v6, s[4:7], s56 offen offset:3072 sc1
  v_mfma_f32_16x16x32_bf16 v[136:139], v[228:231], a[44:47], v[136:139]
  buffer_load_dwordx4 a[160:163], v251, s[60:63], s49 offen
  v_mfma_f32_16x16x32_bf16 v[164:167], v[228:231], a[116:119], v[164:167]
  buffer_load_dwordx4 a[164:167], v251, s[60:63], s49 offen offset:1024
  v_mfma_f32_16x16x32_bf16 v[168:171], v[32:35], v[40:43], v[168:171]
  v_mfma_f32_16x16x32_bf16 v[172:175], v[36:39], v[40:43], v[172:175]
  s_waitcnt vmcnt(12) lgkmcnt(0)
  v_mfma_f32_16x16x32_bf16 v[112:115], v[176:179], a[48:51], v[112:115]
  s_barrier
  v_mfma_f32_16x16x32_bf16 v[140:143], v[176:179], a[120:123], v[140:143]
  ds_read_b128 v[204:207], v2 offset:27648
  v_mfma_f32_16x16x32_bf16 v[116:119], v[180:183], a[48:51], v[116:119]
  ds_read_b128 v[208:211], v2 offset:28672
  v_mfma_f32_16x16x32_bf16 v[144:147], v[180:183], a[120:123], v[144:147]
  ds_read_b128 v[212:215], v2 offset:29696
  v_mfma_f32_16x16x32_bf16 v[120:123], v[184:187], a[48:51], v[120:123]
  ds_read_b128 v[216:219], v2 offset:30720
  v_mfma_f32_16x16x32_bf16 v[148:151], v[184:187], a[120:123], v[148:151]
  ds_read_b128 v[220:223], v2 offset:31744
  v_mfma_f32_16x16x32_bf16 v[124:127], v[188:191], a[48:51], v[124:127]
  ds_read_b128 v[224:227], v2 offset:32768
  v_mfma_f32_16x16x32_bf16 v[152:155], v[188:191], a[120:123], v[152:155]
  ds_read_b128 v[228:231], v2 offset:33792
  v_mfma_f32_16x16x32_bf16 v[128:131], v[192:195], a[48:51], v[128:131]
  ds_read_b128 v[32:35], v4 offset:6144
  v_mfma_f32_16x16x32_bf16 v[156:159], v[192:195], a[120:123], v[156:159]
  ds_read_b128 v[36:39], v2 offset:10240
  v_mfma_f32_16x16x32_bf16 v[132:135], v[196:199], a[48:51], v[132:135]
  ds_read_b128 v[40:43], v19 offset:10240
  v_mfma_f32_16x16x32_bf16 v[160:163], v[196:199], a[120:123], v[160:163]
  buffer_load_dwordx4 a[64:67], v6, s[4:7], s52 offen sc1
  v_mfma_f32_16x16x32_bf16 v[136:139], v[200:203], a[48:51], v[136:139]
  buffer_load_dwordx4 a[136:139], v6, s[4:7], s57 offen sc1
  v_mfma_f32_16x16x32_bf16 v[164:167], v[200:203], a[120:123], v[164:167]
  buffer_load_dwordx4 a[168:171], v251, s[60:63], s49 offen offset:2048
  v_mfma_f32_16x16x32_bf16 v[168:171], v[44:47], v[52:55], v[168:171]
  buffer_load_dwordx4 a[172:175], v251, s[60:63], s49 offen offset:3072
  v_mfma_f32_16x16x32_bf16 v[172:175], v[48:51], v[52:55], v[172:175]
  s_waitcnt vmcnt(14) lgkmcnt(0)
  v_mfma_f32_16x16x32_bf16 v[112:115], v[204:207], a[52:55], v[112:115]
  ds_read_b128 v[176:179], v2 offset:34816
  v_mfma_f32_16x16x32_bf16 v[140:143], v[204:207], a[124:127], v[140:143]
  ds_read_b128 v[180:183], v2 offset:35840
  v_mfma_f32_16x16x32_bf16 v[116:119], v[208:211], a[52:55], v[116:119]
  ds_read_b128 v[184:187], v2 offset:36864
  v_mfma_f32_16x16x32_bf16 v[144:147], v[208:211], a[124:127], v[144:147]
  ds_read_b128 v[188:191], v2 offset:37888
  v_mfma_f32_16x16x32_bf16 v[120:123], v[212:215], a[52:55], v[120:123]
  ds_read_b128 v[192:195], v2 offset:38912
  v_mfma_f32_16x16x32_bf16 v[148:151], v[212:215], a[124:127], v[148:151]
  ds_read_b128 v[196:199], v2 offset:39936
  v_mfma_f32_16x16x32_bf16 v[124:127], v[216:219], a[52:55], v[124:127]
  ds_read_b128 v[200:203], v2 offset:40960
  v_mfma_f32_16x16x32_bf16 v[152:155], v[216:219], a[124:127], v[152:155]
  ds_read_b128 v[44:47], v4 offset:13312
  v_mfma_f32_16x16x32_bf16 v[128:131], v[220:223], a[52:55], v[128:131]
  ds_read_b128 v[48:51], v2 offset:17408
  v_mfma_f32_16x16x32_bf16 v[156:159], v[220:223], a[124:127], v[156:159]
  ds_read_b128 v[52:55], v19 offset:11264
  v_mfma_f32_16x16x32_bf16 v[132:135], v[224:227], a[52:55], v[132:135]
  buffer_load_dwordx4 a[68:71], v6, s[4:7], s52 offen offset:1024 sc1
  v_mfma_f32_16x16x32_bf16 v[160:163], v[224:227], a[124:127], v[160:163]
  buffer_load_dwordx4 a[140:143], v6, s[4:7], s57 offen offset:1024 sc1
  v_mfma_f32_16x16x32_bf16 v[136:139], v[228:231], a[52:55], v[136:139]
  buffer_load_dwordx4 a[176:179], v251, s[60:63], s50 offen
  v_mfma_f32_16x16x32_bf16 v[164:167], v[228:231], a[124:127], v[164:167]
  buffer_load_dwordx4 a[180:183], v251, s[60:63], s50 offen offset:1024
  v_mfma_f32_16x16x32_bf16 v[168:171], v[32:35], v[40:43], v[168:171]
  v_mfma_f32_16x16x32_bf16 v[172:175], v[36:39], v[40:43], v[172:175]
  s_waitcnt vmcnt(14) lgkmcnt(0)
  v_mfma_f32_16x16x32_bf16 v[112:115], v[176:179], a[56:59], v[112:115]
  ds_read_b128 v[204:207], v2 offset:41984
  v_mfma_f32_16x16x32_bf16 v[140:143], v[176:179], a[128:131], v[140:143]
  ds_read_b128 v[208:211], v2 offset:43008
  v_mfma_f32_16x16x32_bf16 v[116:119], v[180:183], a[56:59], v[116:119]
  ds_read_b128 v[212:215], v2 offset:44032
  v_mfma_f32_16x16x32_bf16 v[144:147], v[180:183], a[128:131], v[144:147]
  ds_read_b128 v[216:219], v2 offset:45056
  v_mfma_f32_16x16x32_bf16 v[120:123], v[184:187], a[56:59], v[120:123]
  ds_read_b128 v[220:223], v2 offset:46080
  v_mfma_f32_16x16x32_bf16 v[148:151], v[184:187], a[128:131], v[148:151]
  ds_read_b128 v[224:227], v2 offset:47104
  v_mfma_f32_16x16x32_bf16 v[124:127], v[188:191], a[56:59], v[124:127]
  ds_read_b128 v[228:231], v2 offset:48128
  v_mfma_f32_16x16x32_bf16 v[152:155], v[188:191], a[128:131], v[152:155]
  ds_read_b128 v[32:35], v4 offset:20480
  v_mfma_f32_16x16x32_bf16 v[128:131], v[192:195], a[56:59], v[128:131]
  ds_read_b128 v[36:39], v2 offset:24576
  v_mfma_f32_16x16x32_bf16 v[156:159], v[192:195], a[128:131], v[156:159]
  ds_read_b128 v[40:43], v19 offset:12288
  v_mfma_f32_16x16x32_bf16 v[132:135], v[196:199], a[56:59], v[132:135]
  buffer_load_dword v10, v9, s[8:11], 0 offen offset:256 sc1
  v_mfma_f32_16x16x32_bf16 v[160:163], v[196:199], a[128:131], v[160:163]
  buffer_load_dword v8, v8, s[8:11], 0 offen sc1
  v_mfma_f32_16x16x32_bf16 v[136:139], v[200:203], a[56:59], v[136:139]
  buffer_load_dword v9, v9, s[8:11], 0 offen sc1
  v_mfma_f32_16x16x32_bf16 v[164:167], v[200:203], a[128:131], v[164:167]
  buffer_load_dwordx4 a[184:187], v251, s[60:63], s50 offen offset:2048
  v_mfma_f32_16x16x32_bf16 v[168:171], v[44:47], v[52:55], v[168:171]
  buffer_load_dwordx4 a[188:191], v251, s[60:63], s50 offen offset:3072
  v_mfma_f32_16x16x32_bf16 v[172:175], v[48:51], v[52:55], v[172:175]
  s_waitcnt vmcnt(15) lgkmcnt(0)
  v_mfma_f32_16x16x32_bf16 v[112:115], v[204:207], a[60:63], v[112:115]
  s_barrier
  v_mfma_f32_16x16x32_bf16 v[140:143], v[204:207], a[132:135], v[140:143]
  ds_read_b128 v[176:179], v2 offset:49152
  v_mfma_f32_16x16x32_bf16 v[116:119], v[208:211], a[60:63], v[116:119]
  ds_read_b128 v[180:183], v2 offset:50176
  v_mfma_f32_16x16x32_bf16 v[144:147], v[208:211], a[132:135], v[144:147]
  ds_read_b128 v[184:187], v2 offset:51200
  v_mfma_f32_16x16x32_bf16 v[120:123], v[212:215], a[60:63], v[120:123]
  ds_read_b128 v[188:191], v2 offset:52224
  v_mfma_f32_16x16x32_bf16 v[148:151], v[212:215], a[132:135], v[148:151]
  ds_read_b128 v[192:195], v2 offset:53248
  v_mfma_f32_16x16x32_bf16 v[124:127], v[216:219], a[60:63], v[124:127]
  ds_read_b128 v[196:199], v2 offset:54272
  v_mfma_f32_16x16x32_bf16 v[152:155], v[216:219], a[132:135], v[152:155]
  ds_read_b128 v[200:203], v2 offset:55296
  v_mfma_f32_16x16x32_bf16 v[128:131], v[220:223], a[60:63], v[128:131]
  ds_read_b128 v[44:47], v4 offset:27648
  v_mfma_f32_16x16x32_bf16 v[156:159], v[220:223], a[132:135], v[156:159]
  ds_read_b128 v[48:51], v2 offset:31744
  v_mfma_f32_16x16x32_bf16 v[132:135], v[224:227], a[60:63], v[132:135]
  ds_read_b128 v[52:55], v19 offset:13312
  v_mfma_f32_16x16x32_bf16 v[160:163], v[224:227], a[132:135], v[160:163]
  buffer_load_dwordx4 a[192:195], v251, s[60:63], s51 offen
  v_mfma_f32_16x16x32_bf16 v[136:139], v[228:231], a[60:63], v[136:139]
  buffer_load_dwordx4 a[196:199], v251, s[60:63], s51 offen offset:1024
  v_mfma_f32_16x16x32_bf16 v[164:167], v[228:231], a[132:135], v[164:167]
  buffer_load_dwordx4 a[0:3], v250, s[60:63], s48 offen
  v_mfma_f32_16x16x32_bf16 v[168:171], v[32:35], v[40:43], v[168:171]
  buffer_load_dwordx4 a[72:75], v250, s[60:63], s53 offen
  v_mfma_f32_16x16x32_bf16 v[172:175], v[36:39], v[40:43], v[172:175]
  s_waitcnt vmcnt(15) lgkmcnt(0)
  v_mfma_f32_16x16x32_bf16 v[112:115], v[176:179], a[64:67], v[112:115]
  ds_read_b128 v[204:207], v2 offset:56320
  v_mfma_f32_16x16x32_bf16 v[140:143], v[176:179], a[136:139], v[140:143]
  ds_read_b128 v[208:211], v2 offset:57344
  v_mfma_f32_16x16x32_bf16 v[116:119], v[180:183], a[64:67], v[116:119]
  ds_read_b128 v[212:215], v2 offset:58368
  v_mfma_f32_16x16x32_bf16 v[144:147], v[180:183], a[136:139], v[144:147]
  ds_read_b128 v[216:219], v2 offset:59392
  v_mfma_f32_16x16x32_bf16 v[120:123], v[184:187], a[64:67], v[120:123]
  ds_read_b128 v[220:223], v2 offset:60416
  v_mfma_f32_16x16x32_bf16 v[148:151], v[184:187], a[136:139], v[148:151]
  ds_read_b128 v[224:227], v2 offset:61440
  v_mfma_f32_16x16x32_bf16 v[124:127], v[188:191], a[64:67], v[124:127]
  ds_read_b128 v[228:231], v2 offset:62464
  v_mfma_f32_16x16x32_bf16 v[152:155], v[188:191], a[136:139], v[152:155]
  ds_read_b128 v[32:35], v4 offset:34816
  v_mfma_f32_16x16x32_bf16 v[128:131], v[192:195], a[64:67], v[128:131]
  ds_read_b128 v[36:39], v2 offset:38912
  v_mfma_f32_16x16x32_bf16 v[156:159], v[192:195], a[136:139], v[156:159]
  ds_read_b128 v[40:43], v19 offset:14336
  v_mfma_f32_16x16x32_bf16 v[132:135], v[196:199], a[64:67], v[132:135]
  buffer_load_dwordx4 a[200:203], v251, s[60:63], s51 offen offset:2048
  v_mfma_f32_16x16x32_bf16 v[160:163], v[196:199], a[136:139], v[160:163]
  buffer_load_dwordx4 a[204:207], v251, s[60:63], s51 offen offset:3072
  v_mfma_f32_16x16x32_bf16 v[136:139], v[200:203], a[64:67], v[136:139]
  buffer_load_dwordx4 a[4:7], v250, s[60:63], s48 offen offset:1024
  v_mfma_f32_16x16x32_bf16 v[164:167], v[200:203], a[136:139], v[164:167]
  buffer_load_dwordx4 a[76:79], v250, s[60:63], s53 offen offset:1024
  v_mfma_f32_16x16x32_bf16 v[168:171], v[44:47], v[52:55], v[168:171]
  v_mfma_f32_16x16x32_bf16 v[172:175], v[48:51], v[52:55], v[172:175]
  s_waitcnt vmcnt(15) lgkmcnt(0)
  v_mfma_f32_16x16x32_bf16 v[112:115], v[204:207], a[68:71], v[112:115]
  ds_read_b128 v[44:47], v4 offset:41984
  v_mfma_f32_16x16x32_bf16 v[140:143], v[204:207], a[140:143], v[140:143]
  ds_read_b128 v[48:51], v2 offset:46080
  v_mfma_f32_16x16x32_bf16 v[116:119], v[208:211], a[68:71], v[116:119]
  ds_read_b128 v[52:55], v19 offset:15360
  v_mfma_f32_16x16x32_bf16 v[144:147], v[208:211], a[140:143], v[144:147]
  buffer_load_dwordx4 a[208:211], v251, s[60:63], s52 offen
  v_mfma_f32_16x16x32_bf16 v[120:123], v[212:215], a[68:71], v[120:123]
  buffer_load_dwordx4 a[212:215], v251, s[60:63], s52 offen offset:1024
  v_mfma_f32_16x16x32_bf16 v[148:151], v[212:215], a[140:143], v[148:151]
  buffer_load_dwordx4 a[8:11], v250, s[60:63], s48 offen offset:2048
  v_mfma_f32_16x16x32_bf16 v[124:127], v[216:219], a[68:71], v[124:127]
  buffer_load_dwordx4 a[80:83], v250, s[60:63], s53 offen offset:2048
  v_mfma_f32_16x16x32_bf16 v[152:155], v[216:219], a[140:143], v[152:155]
  v_mfma_f32_16x16x32_bf16 v[128:131], v[220:223], a[68:71], v[128:131]
  v_mfma_f32_16x16x32_bf16 v[156:159], v[220:223], a[140:143], v[156:159]
  v_mfma_f32_16x16x32_bf16 v[132:135], v[224:227], a[68:71], v[132:135]
  v_mfma_f32_16x16x32_bf16 v[160:163], v[224:227], a[140:143], v[160:163]
  v_mfma_f32_16x16x32_bf16 v[136:139], v[228:231], a[68:71], v[136:139]
  v_mfma_f32_16x16x32_bf16 v[164:167], v[228:231], a[140:143], v[164:167]
  v_mfma_f32_16x16x32_bf16 v[168:171], v[32:35], v[40:43], v[168:171]
  v_mfma_f32_16x16x32_bf16 v[172:175], v[36:39], v[40:43], v[172:175]
  s_waitcnt lgkmcnt(0)
  v_mfma_f32_16x16x32_bf16 v[168:171], v[44:47], v[52:55], v[168:171]
  ds_read_b128 v[32:35], v4 offset:49152
  v_mfma_f32_16x16x32_bf16 v[172:175], v[48:51], v[52:55], v[172:175]
  ds_read_b128 v[36:39], v2 offset:53248
  ds_read_b128 v[40:43], v19 offset:16384
  s_waitcnt lgkmcnt(0)
  v_mfma_f32_16x16x32_bf16 v[168:171], v[32:35], v[40:43], v[168:171]
  ds_read_b128 v[44:47], v4 offset:56320
  v_mfma_f32_16x16x32_bf16 v[172:175], v[36:39], v[40:43], v[172:175]
  ds_read_b128 v[48:51], v2 offset:60416
  ds_read_b128 v[52:55], v19 offset:17408
  s_waitcnt lgkmcnt(0)
  v_mfma_f32_16x16x32_bf16 v[168:171], v[44:47], v[52:55], v[168:171]
  v_mfma_f32_16x16x32_bf16 v[172:175], v[48:51], v[52:55], v[172:175]
  s_barrier
  s_waitcnt vmcnt(14)
  v_mul_f32 v112, v112, v9
  v_mul_f32 v113, v113, v9
  v_mul_f32 v114, v114, v9
  v_mul_f32 v115, v115, v9
  v_cvt_pk_bf16_f32 v176, v112, v113
  v_cvt_pk_bf16_f32 v177, v114, v115
  ds_write_b64 v13, v[176:177]
  v_mul_f32 v140, v140, v10
  v_mul_f32 v141, v141, v10
  v_mul_f32 v142, v142, v10
  v_mul_f32 v143, v143, v10
  buffer_load_dwordx4 a[12:15], v250, s[60:63], s48 offen offset:3072
  v_cvt_pk_bf16_f32 v178, v140, v141
  v_cvt_pk_bf16_f32 v179, v142, v143
  ds_write_b64 v13, v[178:179] offset:3840
  v_mul_f32 v116, v116, v9
  v_mul_f32 v117, v117, v9
  v_mul_f32 v118, v118, v9
  v_mul_f32 v119, v119, v9
  v_cvt_pk_bf16_f32 v180, v116, v117
  v_cvt_pk_bf16_f32 v181, v118, v119
  ds_write_b64 v13, v[180:181] offset:32
  v_mul_f32 v144, v144, v10
  buffer_load_dwordx4 a[84:87], v250, s[60:63], s53 offen offset:3072
  v_mul_f32 v145, v145, v10
  v_mul_f32 v146, v146, v10
  v_mul_f32 v147, v147, v10
  v_cvt_pk_bf16_f32 v182, v144, v145
  v_cvt_pk_bf16_f32 v183, v146, v147
  ds_write_b64 v13, v[182:183] offset:3872
  v_mul_f32 v120, v120, v9
  v_mul_f32 v121, v121, v9
  v_mul_f32 v122, v122, v9
  v_mul_f32 v123, v123, v9
  v_cvt_pk_bf16_f32 v176, v120, v121
  buffer_load_dwordx4 a[16:19], v250, s[60:63], s49 offen
  v_cvt_pk_bf16_f32 v177, v122, v123
  ds_write_b64 v13, v[176:177] offset:64
  v_mul_f32 v148, v148, v10
  v_mul_f32 v149, v149, v10
  v_mul_f32 v150, v150, v10
  v_mul_f32 v151, v151, v10
  v_cvt_pk_bf16_f32 v178, v148, v149
  v_cvt_pk_bf16_f32 v179, v150, v151
  ds_write_b64 v13, v[178:179] offset:3904
  v_mul_f32 v124, v124, v9
  v_mul_f32 v125, v125, v9
  buffer_load_dwordx4 a[88:91], v250, s[60:63], s54 offen
  v_mul_f32 v126, v126, v9
  v_mul_f32 v127, v127, v9
  v_cvt_pk_bf16_f32 v180, v124, v125
  v_cvt_pk_bf16_f32 v181, v126, v127
  ds_write_b64 v13, v[180:181] offset:96
  v_mul_f32 v152, v152, v10
  v_mul_f32 v153, v153, v10
  v_mul_f32 v154, v154, v10
  v_mul_f32 v155, v155, v10
  v_cvt_pk_bf16_f32 v182, v152, v153
  v_cvt_pk_bf16_f32 v183, v154, v155
  buffer_load_dwordx4 a[20:23], v250, s[60:63], s49 offen offset:1024
  ds_write_b64 v13, v[182:183] offset:3936
  v_mul_f32 v128, v128, v9
  v_mul_f32 v129, v129, v9
  v_mul_f32 v130, v130, v9
  v_mul_f32 v131, v131, v9
  v_cvt_pk_bf16_f32 v176, v128, v129
  v_cvt_pk_bf16_f32 v177, v130, v131
  ds_write_b64 v13, v[176:177] offset:128
  v_mul_f32 v156, v156, v10
  v_mul_f32 v157, v157, v10
  v_mul_f32 v158, v158, v10
  buffer_load_dwordx4 a[92:95], v250, s[60:63], s54 offen offset:1024
  v_mul_f32 v159, v159, v10
  v_cvt_pk_bf16_f32 v178, v156, v157
  v_cvt_pk_bf16_f32 v179, v158, v159
  ds_write_b64 v13, v[178:179] offset:3968
  v_mul_f32 v132, v132, v9
  v_mul_f32 v133, v133, v9
  v_mul_f32 v134, v134, v9
  v_mul_f32 v135, v135, v9
  v_cvt_pk_bf16_f32 v180, v132, v133
  v_cvt_pk_bf16_f32 v181, v134, v135
  ds_write_b64 v13, v[180:181] offset:160
  buffer_load_dwordx4 a[24:27], v250, s[60:63], s49 offen offset:2048
  v_mul_f32 v160, v160, v10
  v_mul_f32 v161, v161, v10
  v_mul_f32 v162, v162, v10
  v_mul_f32 v163, v163, v10
  v_cvt_pk_bf16_f32 v182, v160, v161
  v_cvt_pk_bf16_f32 v183, v162, v163
  ds_write_b64 v13, v[182:183] offset:4000
  v_mul_f32 v136, v136, v9
  v_mul_f32 v137, v137, v9
  v_mul_f32 v138, v138, v9
  v_mul_f32 v139, v139, v9
  buffer_load_dwordx4 a[96:99], v250, s[60:63], s54 offen offset:2048
  v_cvt_pk_bf16_f32 v176, v136, v137
  v_cvt_pk_bf16_f32 v177, v138, v139
  ds_write_b64 v13, v[176:177] offset:192
  v_mul_f32 v164, v164, v10
  v_mul_f32 v165, v165, v10
  v_mul_f32 v166, v166, v10
  v_mul_f32 v167, v167, v10
  v_cvt_pk_bf16_f32 v178, v164, v165
  v_cvt_pk_bf16_f32 v179, v166, v167
  ds_write_b64 v13, v[178:179] offset:4032
  v_mul_f32 v168, v168, v8
  buffer_load_dwordx4 a[28:31], v250, s[60:63], s49 offen offset:3072
  v_mul_f32 v169, v169, v8
  v_mul_f32 v170, v170, v8
  v_mul_f32 v171, v171, v8
  v_cvt_pk_bf16_f32 v180, v168, v169
  v_cvt_pk_bf16_f32 v181, v170, v171
  ds_write_b64 v11, v[180:181]
  v_mul_f32 v172, v172, v8
  v_mul_f32 v173, v173, v8
  v_mul_f32 v174, v174, v8
  v_mul_f32 v175, v175, v8
  v_cvt_pk_bf16_f32 v182, v172, v173
  buffer_load_dwordx4 a[100:103], v250, s[60:63], s54 offen offset:3072
  v_cvt_pk_bf16_f32 v183, v174, v175
  ds_write_b64 v12, v[182:183]
  s_waitcnt lgkmcnt(0)
  s_barrier
  ds_read2_b32 v[196:197], v15 offset0:0 offset1:1
  ds_read2_b32 v[198:199], v15 offset0:2 offset1:3
  ds_read2_b32 v[200:201], v15 offset0:4 offset1:5
  ds_read2_b32 v[202:203], v15 offset0:6 offset1:7
  ds_read_b32 v204, v15 offset:32
  ds_read_b128 v[36:39], v14 offset:3360
  ds_read_b128 v[40:43], v14 offset:3376
  buffer_load_dwordx4 a[32:35], v250, s[60:63], s50 offen
  ds_read_b128 v[44:47], v14 offset:3392
  ds_read_b128 v[56:59], v14 offset:2880
  ds_read_b128 v[60:63], v14 offset:2896
  ds_read_b128 v[64:67], v14 offset:2912
  ds_read_b128 v[76:79], v14 offset:2400
  ds_read_b128 v[80:83], v14 offset:2416
  ds_read_b128 v[84:87], v14 offset:2432
  ds_read_b128 v[96:99], v14 offset:1920
  ds_read_b128 v[100:103], v14 offset:1936
  ds_read_b128 v[104:107], v14 offset:1952
  ds_read_b128 v[116:119], v14 offset:1440
  buffer_load_dwordx4 a[104:107], v250, s[60:63], s55 offen
  ds_read_b128 v[120:123], v14 offset:1456
  ds_read_b128 v[124:127], v14 offset:1472
  ds_read_b128 v[136:139], v14 offset:960
  ds_read_b128 v[140:143], v14 offset:976
  ds_read_b128 v[144:147], v14 offset:992
  ds_read_b128 v[156:159], v14 offset:480
  ds_read_b128 v[160:163], v14 offset:496
  ds_read_b128 v[164:167], v14 offset:512
  ds_read_b128 v[176:179], v14
  ds_read_b128 v[180:183], v14 offset:16
  ds_read_b128 v[184:187], v14 offset:32
  buffer_load_dwordx4 a[36:39], v250, s[60:63], s50 offen offset:1024
  s_waitcnt lgkmcnt(15)
  v_dot2_f32_bf16 v208, v196, v36, 0
  v_dot2_f32_bf16 v209, v196, v56, 0
  v_dot2_f32_bf16 v210, v196, v76, 0
  s_waitcnt lgkmcnt(14)
  v_dot2_f32_bf16 v211, v196, v96, 0
  ds_read_b128 v[48:51], v14 offset:3408
  ds_read_b64 v[52:53], v14 offset:3424
  v_dot2_f32_bf16 v208, v197, v37, v208
  v_dot2_f32_bf16 v209, v197, v57, v209
  v_dot2_f32_bf16 v210, v197, v77, v210
  v_dot2_f32_bf16 v211, v197, v97, v211
  ds_read_b128 v[68:71], v14 offset:2928
  buffer_load_dwordx4 a[108:111], v250, s[60:63], s55 offen offset:1024
  ds_read_b64 v[72:73], v14 offset:2944
  v_dot2_f32_bf16 v208, v198, v38, v208
  v_dot2_f32_bf16 v209, v198, v58, v209
  v_dot2_f32_bf16 v210, v198, v78, v210
  v_dot2_f32_bf16 v211, v198, v98, v211
  ds_read_b128 v[88:91], v14 offset:2448
  ds_read_b64 v[92:93], v14 offset:2464
  v_dot2_f32_bf16 v208, v199, v39, v208
  v_dot2_f32_bf16 v209, v199, v59, v209
  v_dot2_f32_bf16 v210, v199, v79, v210
  v_dot2_f32_bf16 v211, v199, v99, v211
  buffer_load_dwordx4 a[40:43], v250, s[60:63], s50 offen offset:2048
  ds_read_b128 v[108:111], v14 offset:1968
  ds_read_b64 v[112:113], v14 offset:1984
  v_dot2_f32_bf16 v208, v200, v40, v208
  v_dot2_f32_bf16 v209, v200, v60, v209
  v_dot2_f32_bf16 v210, v200, v80, v210
  s_waitcnt lgkmcnt(15)
  v_dot2_f32_bf16 v211, v200, v100, v211
  ds_read_b128 v[128:131], v14 offset:1488
  ds_read_b64 v[132:133], v14 offset:1504
  v_dot2_f32_bf16 v208, v201, v41, v208
  v_dot2_f32_bf16 v209, v201, v61, v209
  v_dot2_f32_bf16 v210, v201, v81, v210
  buffer_load_dwordx4 a[112:115], v250, s[60:63], s55 offen offset:2048
  v_dot2_f32_bf16 v211, v201, v101, v211
  ds_read_b128 v[148:151], v14 offset:1008
  ds_read_b64 v[152:153], v14 offset:1024
  v_dot2_f32_bf16 v208, v202, v42, v208
  v_dot2_f32_bf16 v209, v202, v62, v209
  v_dot2_f32_bf16 v210, v202, v82, v210
  v_dot2_f32_bf16 v211, v202, v102, v211
  ds_read_b128 v[168:171], v14 offset:528
  ds_read_b64 v[172:173], v14 offset:544
  v_dot2_f32_bf16 v208, v203, v43, v208
  v_dot2_f32_bf16 v209, v203, v63, v209
  buffer_load_dwordx4 a[44:47], v250, s[60:63], s50 offen offset:3072
  v_dot2_f32_bf16 v210, v203, v83, v210
  v_dot2_f32_bf16 v211, v203, v103, v211
  ds_read_b128 v[188:191], v14 offset:48
  ds_read_b64 v[192:193], v14 offset:64
  v_dot2_f32_bf16 v208, v204, v44, v208
  v_dot2_f32_bf16 v209, v204, v64, v209
  v_dot2_f32_bf16 v210, v204, v84, v210
  v_dot2_f32_bf16 v211, v204, v104, v211
  v_dot2_f32_bf16 v212, v196, v116, 0
  v_dot2_f32_bf16 v213, v196, v136, 0
  s_waitcnt lgkmcnt(15)
  v_dot2_f32_bf16 v214, v196, v156, 0
  buffer_load_dwordx4 a[116:119], v250, s[60:63], s55 offen offset:3072
  v_dot2_f32_bf16 v215, v196, v176, 0
  v_dot2_f32_bf16 v212, v197, v117, v212
  v_dot2_f32_bf16 v213, v197, v137, v213
  v_dot2_f32_bf16 v214, v197, v157, v214
  v_dot2_f32_bf16 v215, v197, v177, v215
  v_dot2_f32_bf16 v212, v198, v118, v212
  v_dot2_f32_bf16 v213, v198, v138, v213
  v_dot2_f32_bf16 v214, v198, v158, v214
  v_dot2_f32_bf16 v215, v198, v178, v215
  v_dot2_f32_bf16 v212, v199, v119, v212
  v_dot2_f32_bf16 v213, v199, v139, v213
  buffer_load_dwordx4 a[48:51], v250, s[60:63], s51 offen
  v_dot2_f32_bf16 v214, v199, v159, v214
  v_dot2_f32_bf16 v215, v199, v179, v215
  v_dot2_f32_bf16 v212, v200, v120, v212
  v_dot2_f32_bf16 v213, v200, v140, v213
  v_dot2_f32_bf16 v214, v200, v160, v214
  v_dot2_f32_bf16 v215, v200, v180, v215
  v_dot2_f32_bf16 v212, v201, v121, v212
  v_dot2_f32_bf16 v213, v201, v141, v213
  v_dot2_f32_bf16 v214, v201, v161, v214
  v_dot2_f32_bf16 v215, v201, v181, v215
  v_dot2_f32_bf16 v212, v202, v122, v212
  buffer_load_dwordx4 a[120:123], v250, s[60:63], s56 offen
  v_dot2_f32_bf16 v213, v202, v142, v213
  v_dot2_f32_bf16 v214, v202, v162, v214
  v_dot2_f32_bf16 v215, v202, v182, v215
  v_dot2_f32_bf16 v212, v203, v123, v212
  v_dot2_f32_bf16 v213, v203, v143, v213
  v_dot2_f32_bf16 v214, v203, v163, v214
  v_dot2_f32_bf16 v215, v203, v183, v215
  v_dot2_f32_bf16 v212, v204, v124, v212
  v_dot2_f32_bf16 v213, v204, v144, v213
  v_dot2_f32_bf16 v214, v204, v164, v214
  v_dot2_f32_bf16 v215, v204, v184, v215
  buffer_load_dwordx4 a[52:55], v250, s[60:63], s51 offen offset:1024
  v_mul_f32 v208, 0x3eae1a93, v208
  v_mul_f32 v209, 0x3eae1a93, v209
  v_mul_f32 v210, 0x3eae1a93, v210
  v_mul_f32 v211, 0x3eae1a93, v211
  v_mul_f32 v212, 0x3eae1a93, v212
  v_mul_f32 v213, 0x3eae1a93, v213
  v_mul_f32 v214, 0x3eae1a93, v214
  v_mul_f32 v215, 0x3eae1a93, v215
  v_cndmask_b32 v209, v18, v209, s[64:65]
  v_cndmask_b32 v210, v18, v210, s[66:67]
  v_cndmask_b32 v211, v18, v211, s[68:69]
  buffer_load_dwordx4 a[124:127], v250, s[60:63], s56 offen offset:1024
  v_cndmask_b32 v212, v18, v212, s[70:71]
  v_cndmask_b32 v213, v18, v213, s[72:73]
  v_cndmask_b32 v214, v18, v214, s[74:75]
  v_cndmask_b32 v215, v18, v215, s[76:77]
  v_max3_f32 v246, v208, v209, v210
  v_max3_f32 v247, v211, v212, v213
  v_max3_f32 v246, v246, v214, v215
  v_max_f32 v246, v246, v247
  v_sub_f32 v208, v208, v246
  v_sub_f32 v209, v209, v246
  v_sub_f32 v210, v210, v246
  buffer_load_dwordx4 a[56:59], v250, s[60:63], s51 offen offset:2048
  v_sub_f32 v211, v211, v246
  v_sub_f32 v212, v212, v246
  v_sub_f32 v213, v213, v246
  v_sub_f32 v214, v214, v246
  v_sub_f32 v215, v215, v246
  v_exp_f32 v208, v208
  v_exp_f32 v209, v209
  v_exp_f32 v210, v210
  v_exp_f32 v211, v211
  v_exp_f32 v212, v212
  v_exp_f32 v213, v213
  buffer_load_dwordx4 a[128:131], v250, s[60:63], s56 offen offset:2048
  v_exp_f32 v214, v214
  v_exp_f32 v215, v215
  v_cvt_pk_bf16_f32 v216, v208, v209
  v_cvt_pk_bf16_f32 v217, v210, v211
  v_cvt_pk_bf16_f32 v218, v212, v213
  v_cvt_pk_bf16_f32 v219, v214, v215
  v_dot2_f32_bf16 v248, v216, s34, 0
  v_dot2_f32_bf16 v248, v217, s34, v248
  v_dot2_f32_bf16 v248, v218, s34, v248
  v_dot2_f32_bf16 v248, v219, s34, v248
  v_perm_b32 v238, v65, v45, s32
  buffer_load_dwordx4 a[60:63], v250, s[60:63], s51 offen offset:3072
  v_perm_b32 v239, v65, v45, s33
  v_perm_b32 v240, v66, v46, s32
  v_perm_b32 v241, v66, v46, s33
  v_dot2_f32_bf16 v220, v216, v238, 0
  v_dot2_f32_bf16 v221, v216, v239, 0
  v_perm_b32 v242, v67, v47, s32
  v_perm_b32 v243, v67, v47, s33
  v_dot2_f32_bf16 v222, v216, v240, 0
  v_dot2_f32_bf16 v223, v216, v241, 0
  s_waitcnt lgkmcnt(13)
  v_perm_b32 v244, v68, v48, s32
  v_perm_b32 v245, v68, v48, s33
  buffer_load_dwordx4 a[132:135], v250, s[60:63], s56 offen offset:3072
  v_dot2_f32_bf16 v224, v216, v242, 0
  v_dot2_f32_bf16 v225, v216, v243, 0
  v_perm_b32 v238, v69, v49, s32
  v_perm_b32 v239, v69, v49, s33
  v_dot2_f32_bf16 v226, v216, v244, 0
  v_dot2_f32_bf16 v227, v216, v245, 0
  v_perm_b32 v240, v70, v50, s32
  v_perm_b32 v241, v70, v50, s33
  v_dot2_f32_bf16 v228, v216, v238, 0
  v_dot2_f32_bf16 v229, v216, v239, 0
  v_perm_b32 v242, v71, v51, s32
  buffer_load_dwordx4 a[64:67], v250, s[60:63], s52 offen
  v_perm_b32 v243, v71, v51, s33
  v_dot2_f32_bf16 v230, v216, v240, 0
  v_dot2_f32_bf16 v231, v216, v241, 0
  s_waitcnt lgkmcnt(12)
  v_perm_b32 v244, v72, v52, s32
  v_perm_b32 v245, v72, v52, s33
  v_dot2_f32_bf16 v232, v216, v242, 0
  v_dot2_f32_bf16 v233, v216, v243, 0
  v_perm_b32 v238, v73, v53, s32
  v_perm_b32 v239, v73, v53, s33
  v_dot2_f32_bf16 v234, v216, v244, 0
  v_dot2_f32_bf16 v235, v216, v245, 0
  buffer_load_dwordx4 a[136:139], v250, s[60:63], s57 offen
  v_perm_b32 v240, v105, v85, s32
  v_perm_b32 v241, v105, v85, s33
  v_dot2_f32_bf16 v236, v216, v238, 0
  v_dot2_f32_bf16 v237, v216, v239, 0
  v_rcp_f32 v248, v248
  v_perm_b32 v242, v106, v86, s32
  v_perm_b32 v243, v106, v86, s33
  v_dot2_f32_bf16 v220, v217, v240, v220
  v_dot2_f32_bf16 v221, v217, v241, v221
  v_perm_b32 v244, v107, v87, s32
  v_perm_b32 v245, v107, v87, s33
  buffer_load_dwordx4 a[68:71], v250, s[60:63], s52 offen offset:1024
  v_dot2_f32_bf16 v222, v217, v242, v222
  v_dot2_f32_bf16 v223, v217, v243, v223
  s_waitcnt lgkmcnt(9)
  v_perm_b32 v238, v108, v88, s32
  v_perm_b32 v239, v108, v88, s33
  v_dot2_f32_bf16 v224, v217, v244, v224
  v_dot2_f32_bf16 v225, v217, v245, v225
  v_perm_b32 v240, v109, v89, s32
  v_perm_b32 v241, v109, v89, s33
  v_dot2_f32_bf16 v226, v217, v238, v226
  v_dot2_f32_bf16 v227, v217, v239, v227
  v_perm_b32 v242, v110, v90, s32
  buffer_load_dwordx4 a[140:143], v250, s[60:63], s57 offen offset:1024
  v_perm_b32 v243, v110, v90, s33
  v_dot2_f32_bf16 v228, v217, v240, v228
  v_dot2_f32_bf16 v229, v217, v241, v229
  v_perm_b32 v244, v111, v91, s32
  v_perm_b32 v245, v111, v91, s33
  v_dot2_f32_bf16 v230, v217, v242, v230
  v_dot2_f32_bf16 v231, v217, v243, v231
  s_waitcnt lgkmcnt(8)
  v_perm_b32 v238, v112, v92, s32
  v_perm_b32 v239, v112, v92, s33
  v_dot2_f32_bf16 v232, v217, v244, v232
  v_dot2_f32_bf16 v233, v217, v245, v233
  v_perm_b32 v240, v113, v93, s32
  v_perm_b32 v241, v113, v93, s33
  v_dot2_f32_bf16 v234, v217, v238, v234
  v_dot2_f32_bf16 v235, v217, v239, v235
  v_perm_b32 v242, v145, v125, s32
  v_perm_b32 v243, v145, v125, s33
  v_dot2_f32_bf16 v236, v217, v240, v236
  v_dot2_f32_bf16 v237, v217, v241, v237
  v_perm_b32 v244, v146, v126, s32
  v_perm_b32 v245, v146, v126, s33
  v_dot2_f32_bf16 v220, v218, v242, v220
  v_dot2_f32_bf16 v221, v218, v243, v221
  v_perm_b32 v238, v147, v127, s32
  v_perm_b32 v239, v147, v127, s33
  v_dot2_f32_bf16 v222, v218, v244, v222
  v_dot2_f32_bf16 v223, v218, v245, v223
  s_waitcnt lgkmcnt(5)
  v_perm_b32 v240, v148, v128, s32
  v_perm_b32 v241, v148, v128, s33
  v_dot2_f32_bf16 v224, v218, v238, v224
  v_dot2_f32_bf16 v225, v218, v239, v225
  v_perm_b32 v242, v149, v129, s32
  v_perm_b32 v243, v149, v129, s33
  v_dot2_f32_bf16 v226, v218, v240, v226
  v_dot2_f32_bf16 v227, v218, v241, v227
  v_perm_b32 v244, v150, v130, s32
  v_perm_b32 v245, v150, v130, s33
  v_dot2_f32_bf16 v228, v218, v242, v228
  v_dot2_f32_bf16 v229, v218, v243, v229
  v_perm_b32 v238, v151, v131, s32
  v_perm_b32 v239, v151, v131, s33
  v_dot2_f32_bf16 v230, v218, v244, v230
  v_dot2_f32_bf16 v231, v218, v245, v231
  s_waitcnt lgkmcnt(4)
  v_perm_b32 v240, v152, v132, s32
  v_perm_b32 v241, v152, v132, s33
  v_dot2_f32_bf16 v232, v218, v238, v232
  v_dot2_f32_bf16 v233, v218, v239, v233
  v_perm_b32 v242, v153, v133, s32
  v_perm_b32 v243, v153, v133, s33
  v_dot2_f32_bf16 v234, v218, v240, v234
  v_dot2_f32_bf16 v235, v218, v241, v235
  v_perm_b32 v244, v185, v165, s32
  v_perm_b32 v245, v185, v165, s33
  v_dot2_f32_bf16 v236, v218, v242, v236
  v_dot2_f32_bf16 v237, v218, v243, v237
  v_perm_b32 v238, v186, v166, s32
  v_perm_b32 v239, v186, v166, s33
  v_dot2_f32_bf16 v220, v219, v244, v220
  v_dot2_f32_bf16 v221, v219, v245, v221
  v_perm_b32 v240, v187, v167, s32
  v_perm_b32 v241, v187, v167, s33
  v_dot2_f32_bf16 v222, v219, v238, v222
  v_dot2_f32_bf16 v223, v219, v239, v223
  s_waitcnt lgkmcnt(1)
  v_perm_b32 v242, v188, v168, s32
  v_perm_b32 v243, v188, v168, s33
  v_dot2_f32_bf16 v224, v219, v240, v224
  v_dot2_f32_bf16 v225, v219, v241, v225
  v_perm_b32 v244, v189, v169, s32
  v_perm_b32 v245, v189, v169, s33
  v_dot2_f32_bf16 v226, v219, v242, v226
  v_dot2_f32_bf16 v227, v219, v243, v227
  v_perm_b32 v238, v190, v170, s32
  v_perm_b32 v239, v190, v170, s33
  v_dot2_f32_bf16 v228, v219, v244, v228
  v_dot2_f32_bf16 v229, v219, v245, v229
  v_perm_b32 v240, v191, v171, s32
  v_perm_b32 v241, v191, v171, s33
  v_dot2_f32_bf16 v230, v219, v238, v230
  v_dot2_f32_bf16 v231, v219, v239, v231
  s_waitcnt lgkmcnt(0)
  v_perm_b32 v242, v192, v172, s32
  v_perm_b32 v243, v192, v172, s33
  v_dot2_f32_bf16 v232, v219, v240, v232
  v_dot2_f32_bf16 v233, v219, v241, v233
  v_perm_b32 v244, v193, v173, s32
  v_perm_b32 v245, v193, v173, s33
  v_dot2_f32_bf16 v234, v219, v242, v234
  v_dot2_f32_bf16 v235, v219, v243, v235
  v_dot2_f32_bf16 v236, v219, v244, v236
  v_dot2_f32_bf16 v237, v219, v245, v237
  v_mul_f32 v220, v220, v248
  v_mul_f32 v221, v221, v248
  v_mul_f32 v222, v222, v248
  v_mul_f32 v223, v223, v248
  v_mul_f32 v224, v224, v248
  v_mul_f32 v225, v225, v248
  v_mul_f32 v226, v226, v248
  v_mul_f32 v227, v227, v248
  v_mul_f32 v228, v228, v248
  v_mul_f32 v229, v229, v248
  v_mul_f32 v230, v230, v248
  v_mul_f32 v231, v231, v248
  v_mul_f32 v232, v232, v248
  v_mul_f32 v233, v233, v248
  v_mul_f32 v234, v234, v248
  v_mul_f32 v235, v235, v248
  v_mul_f32 v236, v236, v248
  v_mul_f32 v237, v237, v248
  v_cvt_pk_bf16_f32 v196, v220, v221
  v_cvt_pk_bf16_f32 v197, v222, v223
  v_cvt_pk_bf16_f32 v198, v224, v225
  v_cvt_pk_bf16_f32 v199, v226, v227
  v_cvt_pk_bf16_f32 v200, v228, v229
  v_cvt_pk_bf16_f32 v201, v230, v231
  v_cvt_pk_bf16_f32 v202, v232, v233
  v_cvt_pk_bf16_f32 v203, v234, v235
  v_cvt_pk_bf16_f32 v204, v236, v237
  buffer_store_dwordx4 v[196:199], v16, s[12:15], 0 offen sc1
  buffer_store_dwordx4 v[200:203], v16, s[12:15], 0 offen offset:256 sc1
  buffer_store_dword v204, v17, s[12:15], 0 offen sc1
  s_waitcnt vmcnt(0)
  s_barrier
  s_mov_b32 s36, 32768
  buffer_store_dword v7, v29, s[96:99], s36 offen sc1
  v_and_b32 v170, 63, v0
  v_and_b32 v171, 15, v170
  v_lshlrev_b32 v160, 4, v170
  v_mov_b32 v175, 0x7ffffff0
  s_lshl_b32 s35, s93, 2
  s_lshr_b32 s36, s94, 2
  s_add_u32 s35, s35, s36
  s_and_b32 s40, s94, 3
  s_mul_i32 s3, s92, 9216
  s_and_b32 s34, s92, 1
  s_mul_i32 s39, s35, 36864
  s_add_u32 s36, s39, s3
  v_add_u32 v162, s36, v160
  s_add_u32 s64, s90, 4718592
  s_addc_u32 s65, s91, 0
  s_and_b32 s65, s65, 0xffff
  s_mov_b32 s66, 2359296
  s_mov_b32 s67, 0x20000
  s_mul_i32 s36, s40, 9
  s_and_b32 s37, s40, 1
  s_add_u32 s32, s36, s37
  s_xor_b32 s37, s37, 1
  s_lshl_b32 s37, s37, 3
  s_add_u32 s33, s36, s37
  s_lshl_b32 s36, s92, 1
  s_add_u32 s32, s32, s36
  s_cmp_lt_u32 s92, 2
  s_cselect_b32 s38, 0, 0x7ffffff0
  s_lshl_b32 s36, s32, 9
  s_add_u32 s36, s36, s39
  v_add_u32 v163, s36, v160
  s_lshr_b32 s36, s33, 1
  s_lshl_b32 s36, s36, 10
  s_and_b32 s37, s33, 1
  s_lshl_b32 s37, s37, 3
  s_add_u32 s36, s36, s37
  s_mul_i32 s37, s34, 18432
  v_add_u32 v161, s37, v160
  s_add_u32 s36, s36, s39
  v_add_u32 v164, s36, v161
  v_or_b32 v164, s38, v164
  s_lshl_b32 s36, s33, 9
  s_add_u32 s36, s36, s39
  s_add_u32 s36, s36, s37
  v_lshl_add_u32 v180, v170, 3, s36
  v_or_b32 v180, s38, v180
  v_lshrrev_b32 v173, 4, v170
  v_lshlrev_b32 v173, 8, v173
  v_lshl_add_u32 v181, v171, 2, v173
  v_add_u32 v181, 16384, v181
  v_add_u32 v182, s37, v181
  s_add_u32 s68, s90, 0
  s_addc_u32 s69, s91, 0
  s_and_b32 s69, s69, 0xffff
  s_mov_b32 s70, 2359296
  s_mov_b32 s71, 0x20000
  buffer_load_dwordx4 v[84:87], v163, s[68:71], 0 offen sc1
  buffer_load_dwordx4 v[88:91], v163, s[68:71], s53 offen sc1
  buffer_load_dwordx2 v[92:93], v164, s[68:71], 0 offen sc1
  s_add_u32 s72, s90, 2359296
  s_addc_u32 s73, s91, 0
  s_and_b32 s73, s73, 0xffff
  s_mov_b32 s74, 2359296
  s_mov_b32 s75, 0x20000
  s_add_u32 s60, s90, 7118848
  s_addc_u32 s61, s91, 0
  s_and_b32 s61, s61, 0xffff
  s_mov_b32 s62, 131072
  s_mov_b32 s63, 0x20000
  s_add_u32 s44, s90, 7110656
  s_addc_u32 s45, s91, 0
  s_and_b32 s45, s45, 0xffff
  s_mov_b32 s46, 8192
  s_mov_b32 s47, 0x20000
  v_lshlrev_b32 v173, 2, v171
  v_add_u32 v166, 36864, v173
  s_lshl_b32 s36, s34, 6
  v_add_u32 v167, s36, v166
  v_lshlrev_b32 v174, 2, v0
  v_add_u32 v174, 36992, v174
  v_and_b32 v173, 176, v0
  v_cmp_eq_u32 vcc, 128, v173
  s_nop 1
  v_cndmask_b32 v165, v174, v167, vcc
  v_lshrrev_b32 v173, 5, v170
  v_lshl_add_u32 v173, v173, 4, v171
  v_lshlrev_b32 v173, 2, v173
  s_lshl_b32 s36, s35, 7
  v_add_u32 v173, s36, v173
  s_lshl_b32 s37, s40, 2
  s_add_u32 s37, s37, s92
  s_lshl_b32 s38, s37, 13
  v_add_u32 v174, s38, v173
  v_and_b32 v169, 16, v170
  v_cmp_eq_u32 vcc, 0, v169
  s_nop 1
  v_cndmask_b32 v169, v175, v174, vcc
  v_cndmask_b32 v168, v175, v173, vcc
  s_cmp_eq_u32 s37, 0
  s_cselect_b32 s37, 0, 0x7ffffff0
  v_or_b32 v168, s37, v168
  v_cmp_gt_u32 s[78:79], 32, v170
  s_cmp_eq_u32 s92, 0
  s_cselect_b32 s58, 1.0, 0
  s_cmp_eq_u32 s92, 1
  s_cselect_b32 s59, 1.0, 0
  s_mov_b32 s36, 32768
  buffer_load_dword v31, v30, s[96:99], s36 offen sc1
  s_waitcnt vmcnt(0)
  v_cmp_ne_u32 vcc, v7, v31
  s_cbranch_vccnz L_sp_18
L_bk_19:
  s_add_u32 m0, s3, 0
  s_nop 0
  buffer_load_dwordx4 v162, s[64:67], s48 offen sc1 lds
  buffer_load_dwordx4 v162, s[64:67], s48 offen offset:1024 sc1 lds
  buffer_load_dwordx4 v162, s[64:67], s48 offen offset:2048 sc1 lds
  buffer_load_dwordx4 v162, s[64:67], s48 offen offset:3072 sc1 lds
  s_add_u32 m0, s3, 4096
  s_nop 0
  buffer_load_dwordx4 v162, s[64:67], s49 offen sc1 lds
  buffer_load_dwordx4 v162, s[64:67], s49 offen offset:1024 sc1 lds
  buffer_load_dwordx4 v162, s[64:67], s49 offen offset:2048 sc1 lds
  buffer_load_dwordx4 v162, s[64:67], s49 offen offset:3072 sc1 lds
  s_add_u32 m0, s3, 8192
  s_nop 0
  buffer_load_dwordx4 v162, s[64:67], s50 offen sc1 lds
  v_and_b32 v1, 63, v0
  v_and_b32 v2, 15, v1
  v_lshrrev_b32 v3, 4, v1
  v_lshlrev_b32 v24, 4, v1
  s_lshl_b32 s33, s92, 10
  s_and_b32 s41, s92, 1
  s_lshr_b32 s42, s92, 1
  s_and_b32 s43, s94, 1
  v_lshrrev_b32 v4, 2, v2
  v_lshl_add_u32 v4, v3, 2, v4
  v_and_b32 v5, 3, v2
  v_lshlrev_b32 v5, 3, v5
  v_lshrrev_b32 v6, 1, v4
  v_and_b32 v6, 3, v6
  s_lshl_b32 s36, s41, 1
  s_add_u32 s37, s36, 0
  v_xor_b32 v8, s37, v6
  v_lshlrev_b32 v8, 5, v8
  v_lshl_add_u32 v8, v4, 7, v8
  v_add_u32 v8, v8, v5
  v_add_u32 v9, 65536, v8
  v_add_u32 v10, 131072, v8
  s_add_u32 s37, s36, 1
  v_xor_b32 v11, s37, v6
  v_lshlrev_b32 v11, 5, v11
  v_lshl_add_u32 v11, v4, 7, v11
  v_add_u32 v11, v11, v5
  v_add_u32 v12, 65536, v11
  v_add_u32 v13, 131072, v11
  v_and_b32 v6, 1, v3
  v_xor_b32 v6, s41, v6
  v_lshlrev_b32 v6, 5, v6
  v_lshl_add_u32 v14, v4, 6, v6
  v_add_u32 v14, v14, v5
  v_add_u32 v15, 65536, v14
  v_add_u32 v25, 131072, v14
  s_lshl_b32 s36, s42, 11
  v_add_u32 v26, s36, v24
  v_add_u32 v27, 65536, v26
  v_add_u32 v28, 131072, v26
  s_mul_i32 s36, s42, 36864
  s_add_u32 s36, s36, 90112
  v_add_u32 v16, s36, v24
  s_lshl_b32 s37, s41, 12
  v_add_u32 v17, s37, v16
  s_lshl_b32 s37, s41, 3
  v_add_u32 v18, s37, v16
  v_bfe_u32 v4, v1, 1, 2
  v_xor_b32 v4, v4, v3
  v_lshlrev_b32 v4, 5, v4
  v_and_b32 v5, 1, v1
  v_lshl_add_u32 v4, v5, 4, v4
  v_lshrrev_b32 v5, 3, v1
  s_lshl_b32 s36, s92, 3
  v_add_u32 v5, s36, v5
  s_mul_i32 s36, s94, 576
  s_lshl_b32 s37, s43, 6
  s_add_u32 s37, s36, s37
  v_mul_u32_u24 v6, 9216, v5
  v_add3_u32 v19, v6, v4, s37
  v_mul_u32_u24 v6, 1152, v5
  v_add_u32 v21, v6, v4
  v_lshlrev_b32 v6, 3, v1
  s_lshl_b32 s37, s42, 11
  v_add_u32 v22, s37, v6
  v_bfe_u32 v4, v1, 1, 1
  v_and_b32 v5, 1, v3
  v_xor_b32 v4, v4, v5
  v_lshlrev_b32 v4, 5, v4
  v_and_b32 v5, 1, v1
  v_lshl_add_u32 v4, v5, 4, v4
  v_lshrrev_b32 v5, 2, v1
  s_lshl_b32 s37, s41, 4
  v_add_u32 v5, s37, v5
  v_mul_u32_u24 v5, 9216, v5
  s_xor_b32 s38, s43, 1
  s_lshl_b32 s38, s38, 9
  s_add_u32 s38, s38, s36
  v_add3_u32 v20, v5, v4, s38
  s_lshl_b32 s37, s93, 1
  s_add_u32 s37, s37, s42
  s_lshl_b32 s37, s37, 2
  s_add_u32 s37, s37, s41
  s_mul_i32 s37, s37, 18432
  v_add_u32 v23, s37, v24
  s_mov_b32 s4, s80
  s_and_b32 s5, s81, 0xffff
  s_mov_b32 s6, 5308416
  s_mov_b32 s7, 0x20000
  s_mov_b32 s8, s82
  s_and_b32 s9, s83, 0xffff
  s_mov_b32 s10, 5308416
  s_mov_b32 s11, 0x20000
  s_mov_b32 s12, s84
  s_and_b32 s13, s85, 0xffff
  s_mov_b32 s14, 5308416
  s_mov_b32 s15, 0x20000
  s_cmp_eq_u32 s42, 0
  s_cselect_b32 s24, s80, s82
  s_cselect_b32 s25, s5, s9
  s_mov_b32 s26, 5308416
  s_mov_b32 s27, 0x20000
  s_add_u32 s16, s90, 2359296
  s_addc_u32 s17, s91, 0
  s_and_b32 s17, s17, 0xffff
  s_mov_b32 s18, 2359296
  s_mov_b32 s19, 0x20000
  s_lshr_b32 s36, s94, 1
  s_mul_i32 s36, s36, 2359296
  s_lshl_b32 s37, s93, 1
  s_add_u32 s37, s37, s42
  s_mul_i32 s37, s37, 73728
  s_add_u32 s36, s36, s37
  s_add_u32 s36, s36, 26648576
  s_add_u32 s20, s90, s36
  s_addc_u32 s21, s91, 0
  s_and_b32 s21, s21, 0xffff
  s_mov_b32 s22, 73728
  s_mov_b32 s23, 0x20000
  s_lshl_b32 s36, s93, 4
  s_add_u32 s36, s36, s94
  s_lshl_b32 s36, s36, 1
  s_add_u32 s36, s36, s42
  s_mul_i32 s36, s36, 36864
  s_add_u32 s36, s36, 7774208
  s_add_u32 s28, s90, s36
  s_addc_u32 s29, s91, 0
  s_and_b32 s29, s29, 0xffff
  s_mov_b32 s30, 36864
  s_mov_b32 s31, 0x20000
  s_waitcnt vmcnt(0)
  s_barrier
  ds_read_b128 v[96:99], v160
  ds_read_b128 v[100:103], v160 offset:18432
  ds_read_b128 v[104:107], v161
  ds_read_b128 v[108:111], v160 offset:1024
  ds_read_b128 v[112:115], v160 offset:19456
  ds_read_b128 v[116:119], v161 offset:1024
  s_waitcnt lgkmcnt(3)
  v_mfma_f32_16x16x32_bf16 v[80:83], a[144:147], v[104:107], 0
  ds_read_b128 v[120:123], v160 offset:2048
  v_mfma_f32_16x16x32_bf16 v[64:67], a[0:3], v[96:99], 0
  ds_read_b128 v[124:127], v160 offset:20480
  v_mfma_f32_16x16x32_bf16 v[68:71], a[0:3], v[100:103], 0
  ds_read_b128 v[128:131], v161 offset:2048
  s_add_u32 m0, s33, 65536
  v_mfma_f32_16x16x32_bf16 v[72:75], a[72:75], v[96:99], 0
  s_mov_b32 s34, 0
  v_mfma_f32_16x16x32_bf16 v[76:79], a[72:75], v[100:103], 0
  buffer_load_dwordx4 v19, s[4:7], s34 offen lds
  s_waitcnt lgkmcnt(3)
  v_mfma_f32_16x16x32_bf16 v[80:83], a[148:151], v[116:119], v[80:83]
  ds_read_b128 v[96:99], v160 offset:3072
  v_mfma_f32_16x16x32_bf16 v[64:67], a[4:7], v[108:111], v[64:67]
  ds_read_b128 v[100:103], v160 offset:21504
  v_mfma_f32_16x16x32_bf16 v[68:71], a[4:7], v[112:115], v[68:71]
  ds_read_b128 v[104:107], v161 offset:3072
  s_add_u32 m0, s33, 69632
  v_mfma_f32_16x16x32_bf16 v[72:75], a[76:79], v[108:111], v[72:75]
  s_mov_b32 s34, 294912
  v_mfma_f32_16x16x32_bf16 v[76:79], a[76:79], v[112:115], v[76:79]
  buffer_load_dwordx4 v19, s[4:7], s34 offen lds
  s_waitcnt lgkmcnt(3)
  v_mfma_f32_16x16x32_bf16 v[80:83], a[152:155], v[128:131], v[80:83]
  ds_read_b128 v[108:111], v160 offset:4096
  v_mfma_f32_16x16x32_bf16 v[64:67], a[8:11], v[120:123], v[64:67]
  ds_read_b128 v[112:115], v160 offset:22528
  v_mfma_f32_16x16x32_bf16 v[68:71], a[8:11], v[124:127], v[68:71]
  ds_read_b128 v[116:119], v161 offset:4096
  s_add_u32 m0, s33, 73728
  v_mfma_f32_16x16x32_bf16 v[72:75], a[80:83], v[120:123], v[72:75]
  s_mov_b32 s34, 589824
  v_mfma_f32_16x16x32_bf16 v[76:79], a[80:83], v[124:127], v[76:79]
  buffer_load_dwordx4 v19, s[4:7], s34 offen lds
  s_waitcnt lgkmcnt(3)
  v_mfma_f32_16x16x32_bf16 v[80:83], a[156:159], v[104:107], v[80:83]
  ds_read_b128 v[120:123], v160 offset:5120
  v_mfma_f32_16x16x32_bf16 v[64:67], a[12:15], v[96:99], v[64:67]
  ds_read_b128 v[124:127], v160 offset:23552
  v_mfma_f32_16x16x32_bf16 v[68:71], a[12:15], v[100:103], v[68:71]
  ds_read_b128 v[128:131], v161 offset:5120
  s_add_u32 m0, s33, 77824
  v_mfma_f32_16x16x32_bf16 v[72:75], a[84:87], v[96:99], v[72:75]
  s_mov_b32 s34, 0
  v_mfma_f32_16x16x32_bf16 v[76:79], a[84:87], v[100:103], v[76:79]
  buffer_load_dwordx4 v19, s[8:11], s34 offen lds
  s_waitcnt lgkmcnt(3)
  v_mfma_f32_16x16x32_bf16 v[80:83], a[160:163], v[116:119], v[80:83]
  ds_read_b128 v[96:99], v160 offset:6144
  v_mfma_f32_16x16x32_bf16 v[64:67], a[16:19], v[108:111], v[64:67]
  ds_read_b128 v[100:103], v160 offset:24576
  v_mfma_f32_16x16x32_bf16 v[68:71], a[16:19], v[112:115], v[68:71]
  ds_read_b128 v[104:107], v161 offset:6144
  s_add_u32 m0, s33, 81920
  v_mfma_f32_16x16x32_bf16 v[72:75], a[88:91], v[108:111], v[72:75]
  s_mov_b32 s34, 294912
  v_mfma_f32_16x16x32_bf16 v[76:79], a[88:91], v[112:115], v[76:79]
  buffer_load_dwordx4 v19, s[8:11], s34 offen lds
  s_waitcnt lgkmcnt(3)
  v_mfma_f32_16x16x32_bf16 v[80:83], a[164:167], v[128:131], v[80:83]
  ds_read_b128 v[108:111], v160 offset:7168
  v_mfma_f32_16x16x32_bf16 v[64:67], a[20:23], v[120:123], v[64:67]
  ds_read_b128 v[112:115], v160 offset:25600
  v_mfma_f32_16x16x32_bf16 v[68:71], a[20:23], v[124:127], v[68:71]
  ds_read_b128 v[116:119], v161 offset:7168
  s_add_u32 m0, s33, 86016
  v_mfma_f32_16x16x32_bf16 v[72:75], a[92:95], v[120:123], v[72:75]
  s_mov_b32 s34, 589824
  v_mfma_f32_16x16x32_bf16 v[76:79], a[92:95], v[124:127], v[76:79]
  buffer_load_dwordx4 v19, s[8:11], s34 offen lds
  s_waitcnt lgkmcnt(3)
  v_mfma_f32_16x16x32_bf16 v[80:83], a[168:171], v[104:107], v[80:83]
  ds_read_b128 v[120:123], v160 offset:8192
  v_mfma_f32_16x16x32_bf16 v[64:67], a[24:27], v[96:99], v[64:67]
  ds_read_b128 v[124:127], v160 offset:26624
  v_mfma_f32_16x16x32_bf16 v[68:71], a[24:27], v[100:103], v[68:71]
  ds_read_b128 v[128:131], v161 offset:8192
  s_add_u32 m0, s33, 90112
  v_mfma_f32_16x16x32_bf16 v[72:75], a[96:99], v[96:99], v[72:75]
  s_mov_b32 s34, 884736
  v_mfma_f32_16x16x32_bf16 v[76:79], a[96:99], v[100:103], v[76:79]
  buffer_load_dwordx4 v19, s[4:7], s34 offen lds
  s_waitcnt lgkmcnt(3)
  v_mfma_f32_16x16x32_bf16 v[80:83], a[172:175], v[116:119], v[80:83]
  ds_read_b128 v[96:99], v160 offset:9216
  v_mfma_f32_16x16x32_bf16 v[64:67], a[28:31], v[108:111], v[64:67]
  ds_read_b128 v[100:103], v160 offset:27648
  v_mfma_f32_16x16x32_bf16 v[68:71], a[28:31], v[112:115], v[68:71]
  ds_read_b128 v[104:107], v161 offset:9216
  s_add_u32 m0, s33, 94208
  v_mfma_f32_16x16x32_bf16 v[72:75], a[100:103], v[108:111], v[72:75]
  s_mov_b32 s34, 1179648
  v_mfma_f32_16x16x32_bf16 v[76:79], a[100:103], v[112:115], v[76:79]
  buffer_load_dwordx4 v19, s[4:7], s34 offen lds
  s_waitcnt lgkmcnt(3)
  v_mfma_f32_16x16x32_bf16 v[80:83], a[176:179], v[128:131], v[80:83]
  ds_read_b128 v[108:111], v160 offset:10240
  v_mfma_f32_16x16x32_bf16 v[64:67], a[32:35], v[120:123], v[64:67]
  ds_read_b128 v[112:115], v160 offset:28672
  v_mfma_f32_16x16x32_bf16 v[68:71], a[32:35], v[124:127], v[68:71]
  ds_read_b128 v[116:119], v161 offset:10240
  s_add_u32 m0, s33, 98304
  v_mfma_f32_16x16x32_bf16 v[72:75], a[104:107], v[120:123], v[72:75]
  s_mov_b32 s34, 1474560
  v_mfma_f32_16x16x32_bf16 v[76:79], a[104:107], v[124:127], v[76:79]
  buffer_load_dwordx4 v19, s[4:7], s34 offen lds
  s_waitcnt lgkmcnt(3)
  v_mfma_f32_16x16x32_bf16 v[80:83], a[180:183], v[104:107], v[80:83]
  ds_read_b128 v[120:123], v160 offset:11264
  v_mfma_f32_16x16x32_bf16 v[64:67], a[36:39], v[96:99], v[64:67]
  ds_read_b128 v[124:127], v160 offset:29696
  v_mfma_f32_16x16x32_bf16 v[68:71], a[36:39], v[100:103], v[68:71]
  ds_read_b128 v[128:131], v161 offset:11264
  s_add_u32 m0, s33, 102400
  v_mfma_f32_16x16x32_bf16 v[72:75], a[108:111], v[96:99], v[72:75]
  s_mov_b32 s34, 884736
  v_mfma_f32_16x16x32_bf16 v[76:79], a[108:111], v[100:103], v[76:79]
  buffer_load_dwordx4 v19, s[8:11], s34 offen lds
  s_waitcnt lgkmcnt(3)
  v_mfma_f32_16x16x32_bf16 v[80:83], a[184:187], v[116:119], v[80:83]
  ds_read_b128 v[96:99], v160 offset:12288
  v_mfma_f32_16x16x32_bf16 v[64:67], a[40:43], v[108:111], v[64:67]
  ds_read_b128 v[100:103], v160 offset:30720
  v_mfma_f32_16x16x32_bf16 v[68:71], a[40:43], v[112:115], v[68:71]
  ds_read_b128 v[104:107], v161 offset:12288
  s_add_u32 m0, s33, 106496
  v_mfma_f32_16x16x32_bf16 v[72:75], a[112:115], v[108:111], v[72:75]
  s_mov_b32 s34, 1179648
  v_mfma_f32_16x16x32_bf16 v[76:79], a[112:115], v[112:115], v[76:79]
  buffer_load_dwordx4 v19, s[8:11], s34 offen lds
  s_waitcnt lgkmcnt(3)
  v_mfma_f32_16x16x32_bf16 v[80:83], a[188:191], v[128:131], v[80:83]
  ds_read_b128 v[108:111], v160 offset:13312
  v_mfma_f32_16x16x32_bf16 v[64:67], a[44:47], v[120:123], v[64:67]
  ds_read_b128 v[112:115], v160 offset:31744
  v_mfma_f32_16x16x32_bf16 v[68:71], a[44:47], v[124:127], v[68:71]
  ds_read_b128 v[116:119], v161 offset:13312
  s_add_u32 m0, s33, 110592
  v_mfma_f32_16x16x32_bf16 v[72:75], a[116:119], v[120:123], v[72:75]
  s_mov_b32 s34, 1474560
  v_mfma_f32_16x16x32_bf16 v[76:79], a[116:119], v[124:127], v[76:79]
  buffer_load_dwordx4 v19, s[8:11], s34 offen lds
  s_waitcnt lgkmcnt(3)
  v_mfma_f32_16x16x32_bf16 v[80:83], a[192:195], v[104:107], v[80:83]
  ds_read_b128 v[120:123], v160 offset:14336
  v_mfma_f32_16x16x32_bf16 v[64:67], a[48:51], v[96:99], v[64:67]
  ds_read_b128 v[124:127], v160 offset:32768
  v_mfma_f32_16x16x32_bf16 v[68:71], a[48:51], v[100:103], v[68:71]
  ds_read_b128 v[128:131], v161 offset:14336
  s_add_u32 m0, s33, 114688
  v_mfma_f32_16x16x32_bf16 v[72:75], a[120:123], v[96:99], v[72:75]
  s_mov_b32 s34, 1769472
  v_mfma_f32_16x16x32_bf16 v[76:79], a[120:123], v[100:103], v[76:79]
  buffer_load_dwordx4 v19, s[4:7], s34 offen lds
  s_waitcnt lgkmcnt(3)
  v_mfma_f32_16x16x32_bf16 v[80:83], a[196:199], v[116:119], v[80:83]
  ds_read_b128 v[96:99], v160 offset:15360
  v_mfma_f32_16x16x32_bf16 v[64:67], a[52:55], v[108:111], v[64:67]
  ds_read_b128 v[100:103], v160 offset:33792
  v_mfma_f32_16x16x32_bf16 v[68:71], a[52:55], v[112:115], v[68:71]
  ds_read_b128 v[104:107], v161 offset:15360
  s_add_u32 m0, s33, 118784
  v_mfma_f32_16x16x32_bf16 v[72:75], a[124:127], v[108:111], v[72:75]
  s_mov_b32 s34, 2064384
  v_mfma_f32_16x16x32_bf16 v[76:79], a[124:127], v[112:115], v[76:79]
  buffer_load_dwordx4 v19, s[4:7], s34 offen lds
  s_waitcnt lgkmcnt(3)
  v_mfma_f32_16x16x32_bf16 v[80:83], a[200:203], v[128:131], v[80:83]
  ds_read_b32 v108, v181
  ds_read_b32 v109, v181 offset:64
  ds_read_b32 v110, v181 offset:128
  v_mfma_f32_16x16x32_bf16 v[64:67], a[56:59], v[120:123], v[64:67]
  ds_read_b32 v111, v181 offset:192
  ds_read_b32 v112, v181 offset:18432
  ds_read_b32 v113, v181 offset:18496
  v_mfma_f32_16x16x32_bf16 v[68:71], a[56:59], v[124:127], v[68:71]
  ds_read_b32 v114, v181 offset:18560
  ds_read_b32 v115, v181 offset:18624
  ds_read_b32 v116, v182
  s_add_u32 m0, s33, 122880
  v_mfma_f32_16x16x32_bf16 v[72:75], a[128:131], v[120:123], v[72:75]
  ds_read_b32 v117, v182 offset:64
  ds_read_b32 v118, v182 offset:128
  ds_read_b32 v119, v182 offset:192
  s_mov_b32 s34, 2359296
  v_mfma_f32_16x16x32_bf16 v[76:79], a[128:131], v[124:127], v[76:79]
  buffer_load_dwordx4 v19, s[4:7], s34 offen lds
  s_waitcnt lgkmcnt(12)
  v_mfma_f32_16x16x32_bf16 v[80:83], a[204:207], v[104:107], v[80:83]
  ds_read_b32 v120, v181 offset:1024
  ds_read_b32 v121, v181 offset:1088
  ds_read_b32 v122, v181 offset:1152
  v_mfma_f32_16x16x32_bf16 v[64:67], a[60:63], v[96:99], v[64:67]
  ds_read_b32 v123, v181 offset:1216
  ds_read_b32 v124, v181 offset:19456
  ds_read_b32 v125, v181 offset:19520
  v_mfma_f32_16x16x32_bf16 v[68:71], a[60:63], v[100:103], v[68:71]
  ds_read_b32 v126, v181 offset:19584
  ds_read_b32 v127, v181 offset:19648
  ds_read_b32 v128, v182 offset:1024
  s_add_u32 m0, s33, 126976
  v_mfma_f32_16x16x32_bf16 v[72:75], a[132:135], v[96:99], v[72:75]
  ds_read_b32 v129, v182 offset:1088
  ds_read_b32 v130, v182 offset:1152
  ds_read_b32 v131, v182 offset:1216
  s_mov_b32 s34, 1769472
  v_mfma_f32_16x16x32_bf16 v[76:79], a[132:135], v[100:103], v[76:79]
  buffer_load_dwordx4 v19, s[8:11], s34 offen lds
  s_waitcnt lgkmcnt(12)
  v_mfma_f32_16x16x32_bf16 v[80:83], a[208:211], v[116:119], v[80:83]
  v_mfma_f32_16x16x32_bf16 v[64:67], a[64:67], v[108:111], v[64:67]
  v_mfma_f32_16x16x32_bf16 v[68:71], a[64:67], v[112:115], v[68:71]
  s_add_u32 m0, s33, 131072
  v_mfma_f32_16x16x32_bf16 v[72:75], a[136:139], v[108:111], v[72:75]
  s_mov_b32 s34, 2064384
  v_mfma_f32_16x16x32_bf16 v[76:79], a[136:139], v[112:115], v[76:79]
  buffer_load_dwordx4 v19, s[8:11], s34 offen lds
  s_waitcnt lgkmcnt(0)
  v_mfma_f32_16x16x32_bf16 v[80:83], a[212:215], v[128:131], v[80:83]
  v_mfma_f32_16x16x32_bf16 v[64:67], a[68:71], v[120:123], v[64:67]
  v_mfma_f32_16x16x32_bf16 v[68:71], a[68:71], v[124:127], v[68:71]
  s_add_u32 m0, s33, 135168
  v_mfma_f32_16x16x32_bf16 v[72:75], a[140:143], v[120:123], v[72:75]
  s_mov_b32 s34, 2359296
  v_mfma_f32_16x16x32_bf16 v[76:79], a[140:143], v[124:127], v[76:79]
  buffer_load_dwordx4 v19, s[8:11], s34 offen lds
  s_nop 0
  v_add_f32 v176, v80, v81
  ds_write_b32 v165, v176
  s_waitcnt lgkmcnt(0)
  s_barrier
  ds_read_b32 v177, v166
  ds_read_b32 v178, v166 offset:64
  ds_read_b32 v179, v167
  v_lshlrev_b32 v32, 16, v84
  v_and_b32 v33, 0xffff0000, v84
  v_add_f32 v64, v64, v32
  v_add_f32 v65, v65, v33
  v_lshlrev_b32 v32, 16, v85
  v_and_b32 v33, 0xffff0000, v85
  v_add_f32 v66, v66, v32
  v_add_f32 v67, v67, v33
  v_lshlrev_b32 v32, 16, v88
  v_and_b32 v33, 0xffff0000, v88
  v_add_f32 v68, v68, v32
  v_add_f32 v69, v69, v33
  v_lshlrev_b32 v32, 16, v89
  v_and_b32 v33, 0xffff0000, v89
  v_add_f32 v70, v70, v32
  v_add_f32 v71, v71, v33
  v_lshlrev_b32 v32, 16, v86
  v_and_b32 v33, 0xffff0000, v86
  v_add_f32 v72, v72, v32
  v_add_f32 v73, v73, v33
  v_lshlrev_b32 v32, 16, v87
  v_and_b32 v33, 0xffff0000, v87
  v_add_f32 v74, v74, v32
  v_add_f32 v75, v75, v33
  v_lshlrev_b32 v32, 16, v90
  v_and_b32 v33, 0xffff0000, v90
  v_add_f32 v76, v76, v32
  v_add_f32 v77, v77, v33
  v_lshlrev_b32 v32, 16, v91
  v_and_b32 v33, 0xffff0000, v91
  v_add_f32 v78, v78, v32
  v_add_f32 v79, v79, v33
  v_lshlrev_b32 v32, 16, v92
  v_and_b32 v33, 0xffff0000, v92
  v_add_f32 v80, v80, v32
  v_add_f32 v81, v81, v33
  v_lshlrev_b32 v32, 16, v93
  v_and_b32 v33, 0xffff0000, v93
  v_add_f32 v82, v82, v32
  v_add_f32 v83, v83, v33
  s_waitcnt lgkmcnt(1)
  v_cndmask_b32 v176, v178, v177, s[78:79]
  buffer_store_dword v176, v168, s[44:47], 0 offen sc1
  v_sub_f32 v64, v64, v177
  v_sub_f32 v65, v65, v177
  v_sub_f32 v66, v66, v177
  v_sub_f32 v67, v67, v177
  v_sub_f32 v68, v68, v178
  v_sub_f32 v69, v69, v178
  v_sub_f32 v70, v70, v178
  v_sub_f32 v71, v71, v178
  v_sub_f32 v72, v72, v177
  v_sub_f32 v73, v73, v177
  v_sub_f32 v74, v74, v177
  v_sub_f32 v75, v75, v177
  v_sub_f32 v76, v76, v178
  v_sub_f32 v77, v77, v178
  v_sub_f32 v78, v78, v178
  v_sub_f32 v79, v79, v178
  s_waitcnt lgkmcnt(0)
  v_sub_f32 v80, v80, v179
  v_sub_f32 v81, v81, v179
  v_sub_f32 v82, v82, v179
  v_sub_f32 v83, v83, v179
  v_cvt_pk_bf16_f32 v36, v64, v65
  v_cvt_pk_bf16_f32 v37, v66, v67
  v_cvt_pk_bf16_f32 v38, v72, v73
  v_cvt_pk_bf16_f32 v39, v74, v75
  v_cvt_pk_bf16_f32 v40, v68, v69
  v_cvt_pk_bf16_f32 v41, v70, v71
  v_cvt_pk_bf16_f32 v42, v76, v77
  v_cvt_pk_bf16_f32 v43, v78, v79
  v_cvt_pk_bf16_f32 v44, v80, v81
  v_cvt_pk_bf16_f32 v45, v82, v83
  buffer_store_dwordx4 v[36:39], v163, s[72:75], 0 offen sc1
  buffer_store_dwordx4 v[40:43], v163, s[72:75], s53 offen sc1
  buffer_store_dwordx2 v[44:45], v180, s[72:75], 0 offen sc1
  v_mul_f32 v48, v64, v64
  v_mul_f32 v49, v68, v68
  v_mul_f32 v50, v80, v80
  v_fmac_f32 v48, v72, v72
  v_fmac_f32 v49, v76, v76
  v_fmac_f32 v48, v65, v65
  v_fmac_f32 v49, v69, v69
  v_fmac_f32 v50, v81, v81
  v_fmac_f32 v48, v73, v73
  v_fmac_f32 v49, v77, v77
  v_fmac_f32 v48, v66, v66
  v_fmac_f32 v49, v70, v70
  v_fmac_f32 v50, v82, v82
  v_fmac_f32 v48, v74, v74
  v_fmac_f32 v49, v78, v78
  v_fmac_f32 v48, v67, v67
  v_fmac_f32 v49, v71, v71
  v_fmac_f32 v50, v83, v83
  v_fmac_f32 v48, v75, v75
  v_fmac_f32 v49, v79, v79
  v_fmac_f32 v48, s58, v50
  v_fmac_f32 v49, s59, v50
  s_nop 1
  v_permlane32_swap_b32 v48, v49
  v_add_f32 v48, v48, v49
  v_mov_b32 v49, v48
  s_nop 1
  v_permlane16_swap_b32 v48, v49
  v_add_f32 v48, v48, v49
  buffer_store_dword v48, v169, s[60:63], 0 offen sc1
  s_waitcnt vmcnt(0)
  s_barrier
  s_mov_b32 s36, 65536
  buffer_store_dword v7, v29, s[96:99], s36 offen sc1
  s_mov_b32 s36, 65536
  buffer_load_dword v31, v30, s[96:99], s36 offen sc1
  s_waitcnt vmcnt(0)
  v_cmp_ne_u32 vcc, v7, v31
  s_cbranch_vccnz L_sp_20
L_bk_21:
  s_add_u32 m0, s33, 40960
  s_mov_b32 s34, 0
  buffer_load_dwordx4 v23, s[16:19], s34 offen sc1 lds
  s_add_u32 m0, s33, 45056
  s_mov_b32 s34, 36864
  buffer_load_dwordx4 v23, s[16:19], s34 offen sc1 lds
  s_add_u32 m0, s33, 49152
  s_mov_b32 s34, 1024
  buffer_load_dwordx4 v23, s[16:19], s34 offen sc1 lds
  s_add_u32 m0, s33, 53248
  s_mov_b32 s34, 37888
  buffer_load_dwordx4 v23, s[16:19], s34 offen sc1 lds
  s_add_u32 m0, s33, 57344
  s_mov_b32 s34, 2048
  buffer_load_dwordx4 v23, s[16:19], s34 offen sc1 lds
  s_add_u32 m0, s33, 61440
  s_mov_b32 s34, 38912
  buffer_load_dwordx4 v23, s[16:19], s34 offen sc1 lds
  s_add_u32 m0, s33, 139264
  s_mov_b32 s34, 3072
  buffer_load_dwordx4 v23, s[16:19], s34 offen sc1 lds
  s_add_u32 m0, s33, 143360
  s_mov_b32 s34, 39936
  buffer_load_dwordx4 v23, s[16:19], s34 offen sc1 lds
  s_add_u32 m0, s33, 0
  s_mov_b32 s34, 4096
  buffer_load_dwordx4 v23, s[16:19], s34 offen sc1 lds
  s_add_u32 m0, s33, 4096
  s_mov_b32 s34, 40960
  buffer_load_dwordx4 v23, s[16:19], s34 offen sc1 lds
  s_add_u32 m0, s33, 147456
  s_mov_b32 s34, 5120
  buffer_load_dwordx4 v23, s[16:19], s34 offen sc1 lds
  s_add_u32 m0, s33, 151552
  s_mov_b32 s34, 41984
  buffer_load_dwordx4 v23, s[16:19], s34 offen sc1 lds
  s_waitcnt vmcnt(6)
  s_barrier
  ds_read_b64_tr_b16 v[56:57], v9
  ds_read_b64_tr_b16 v[58:59], v9 offset:2048
  ds_read_b64_tr_b16 v[60:61], v9 offset:4096
  ds_read_b64_tr_b16 v[62:63], v9 offset:6144
  ds_read_b64_tr_b16 v[64:65], v9 offset:8192
  ds_read_b64_tr_b16 v[66:67], v9 offset:10240
  ds_read_b128 a[0:3], v26 offset:40960
  ds_read_b128 a[4:7], v26 offset:41984
  ds_read_b128 a[8:11], v26 offset:45056
  ds_read_b128 a[12:15], v26 offset:46080
  ds_read_b128 a[16:19], v26 offset:49152
  ds_read_b128 a[20:23], v26 offset:50176
  ds_read_b128 a[24:27], v26 offset:53248
  ds_read_b128 a[28:31], v26 offset:54272
  ds_read_b128 a[32:35], v26 offset:57344
  ds_read_b128 a[36:39], v26 offset:58368
  ds_read_b128 a[40:43], v26 offset:61440
  ds_read_b128 a[44:47], v26 offset:62464
  s_waitcnt lgkmcnt(12)
  s_waitcnt lgkmcnt(11)
  v_mfma_f32_16x16x32_bf16 v[128:131], v[56:59], a[0:3], 0
  s_waitcnt vmcnt(4)
  s_barrier
  s_waitcnt lgkmcnt(7)
  v_mfma_f32_16x16x32_bf16 v[128:131], v[60:63], a[16:19], v[128:131]
  ds_read_b64_tr_b16 v[68:69], v12
  s_add_u32 m0, s33, 155648
  s_waitcnt lgkmcnt(4)
  v_mfma_f32_16x16x32_bf16 v[128:131], v[64:67], a[32:35], v[128:131]
  ds_read_b64_tr_b16 v[70:71], v12 offset:2048
  s_mov_b32 s34, 6144
  v_mfma_f32_16x16x32_bf16 v[132:135], v[56:59], a[4:7], 0
  ds_read_b64_tr_b16 v[72:73], v12 offset:4096
  buffer_load_dwordx4 v23, s[16:19], s34 offen sc1 lds
  v_mfma_f32_16x16x32_bf16 v[132:135], v[60:63], a[20:23], v[132:135]
  ds_read_b64_tr_b16 v[74:75], v12 offset:6144
  s_add_u32 m0, s33, 159744
  s_waitcnt lgkmcnt(6)
  v_mfma_f32_16x16x32_bf16 v[132:135], v[64:67], a[36:39], v[132:135]
  ds_read_b64_tr_b16 v[76:77], v12 offset:8192
  s_mov_b32 s34, 43008
  v_mfma_f32_16x16x32_bf16 v[136:139], v[56:59], a[8:11], 0
  ds_read_b64_tr_b16 v[78:79], v12 offset:10240
  buffer_load_dwordx4 v23, s[16:19], s34 offen sc1 lds
  v_mfma_f32_16x16x32_bf16 v[136:139], v[60:63], a[24:27], v[136:139]
  s_add_u32 m0, s33, 8192
  s_waitcnt lgkmcnt(7)
  v_mfma_f32_16x16x32_bf16 v[136:139], v[64:67], a[40:43], v[136:139]
  s_mov_b32 s34, 7168
  v_mfma_f32_16x16x32_bf16 v[140:143], v[56:59], a[12:15], 0
  buffer_load_dwordx4 v23, s[16:19], s34 offen sc1 lds
  v_mfma_f32_16x16x32_bf16 v[140:143], v[60:63], a[28:31], v[140:143]
  s_waitcnt lgkmcnt(6)
  v_mfma_f32_16x16x32_bf16 v[140:143], v[64:67], a[44:47], v[140:143]
  s_waitcnt lgkmcnt(0)
  v_mfma_f32_16x16x32_bf16 v[144:147], v[68:71], a[0:3], 0
  ds_read_b64_tr_b16 v[56:57], v9 offset:12288
  s_add_u32 m0, s33, 12288
  v_mfma_f32_16x16x32_bf16 v[144:147], v[72:75], a[16:19], v[144:147]
  ds_read_b64_tr_b16 v[58:59], v9 offset:14336
  s_mov_b32 s34, 44032
  v_mfma_f32_16x16x32_bf16 v[144:147], v[76:79], a[32:35], v[144:147]
  ds_read_b64_tr_b16 v[60:61], v9 offset:16384
  buffer_load_dwordx4 v23, s[16:19], s34 offen sc1 lds
  v_mfma_f32_16x16x32_bf16 v[148:151], v[68:71], a[4:7], 0
  ds_read_b64_tr_b16 v[62:63], v9 offset:18432
  s_add_u32 m0, s33, 16384
  v_mfma_f32_16x16x32_bf16 v[148:151], v[72:75], a[20:23], v[148:151]
  ds_read_b64_tr_b16 v[64:65], v9 offset:20480
  s_mov_b32 s34, 8192
  v_mfma_f32_16x16x32_bf16 v[148:151], v[76:79], a[36:39], v[148:151]
  ds_read_b64_tr_b16 v[66:67], v9 offset:22528
  buffer_load_dwordx4 v23, s[16:19], s34 offen sc1 lds
  v_mfma_f32_16x16x32_bf16 v[152:155], v[68:71], a[8:11], 0
  ds_read_b128 a[48:51], v28 offset:8192
  s_add_u32 m0, s33, 20480
  v_mfma_f32_16x16x32_bf16 v[152:155], v[72:75], a[24:27], v[152:155]
  ds_read_b128 a[52:55], v28 offset:9216
  s_mov_b32 s34, 45056
  v_mfma_f32_16x16x32_bf16 v[152:155], v[76:79], a[40:43], v[152:155]
  ds_read_b128 a[56:59], v28 offset:12288
  buffer_load_dwordx4 v23, s[16:19], s34 offen sc1 lds
  v_mfma_f32_16x16x32_bf16 v[156:159], v[68:71], a[12:15], 0
  ds_read_b128 a[60:63], v28 offset:13312
  v_mfma_f32_16x16x32_bf16 v[156:159], v[72:75], a[28:31], v[156:159]
  v_mfma_f32_16x16x32_bf16 v[156:159], v[76:79], a[44:47], v[156:159]
  s_waitcnt lgkmcnt(4)
  v_mfma_f32_16x16x32_bf16 v[160:163], v[56:59], a[0:3], 0
  s_waitcnt vmcnt(6)
  s_barrier
  v_mfma_f32_16x16x32_bf16 v[160:163], v[60:63], a[16:19], v[160:163]
  ds_read_b64_tr_b16 v[68:69], v12 offset:12288
  s_add_u32 m0, s33, 24576
  v_mfma_f32_16x16x32_bf16 v[160:163], v[64:67], a[32:35], v[160:163]
  ds_read_b64_tr_b16 v[70:71], v12 offset:14336
  s_mov_b32 s34, 9216
  v_mfma_f32_16x16x32_bf16 v[164:167], v[56:59], a[4:7], 0
  ds_read_b64_tr_b16 v[72:73], v12 offset:16384
  buffer_load_dwordx4 v23, s[16:19], s34 offen sc1 lds
  v_mfma_f32_16x16x32_bf16 v[164:167], v[60:63], a[20:23], v[164:167]
  ds_read_b64_tr_b16 v[74:75], v12 offset:18432
  s_add_u32 m0, s33, 28672
  v_mfma_f32_16x16x32_bf16 v[164:167], v[64:67], a[36:39], v[164:167]
  ds_read_b64_tr_b16 v[76:77], v12 offset:20480
  s_mov_b32 s34, 46080
  v_mfma_f32_16x16x32_bf16 v[168:171], v[56:59], a[8:11], 0
  ds_read_b64_tr_b16 v[78:79], v12 offset:22528
  ds_read_b64 a[64:65], v22
  buffer_load_dwordx4 v23, s[16:19], s34 offen sc1 lds
  v_mfma_f32_16x16x32_bf16 v[168:171], v[60:63], a[24:27], v[168:171]
  ds_read_b64 a[66:67], v22 offset:512
  ds_read_b64 a[68:69], v22 offset:1024
  s_add_u32 m0, s33, 32768
  v_mfma_f32_16x16x32_bf16 v[168:171], v[64:67], a[40:43], v[168:171]
  ds_read_b64 a[70:71], v22 offset:1536
  ds_read_b64 a[72:73], v22 offset:4096
  s_mov_b32 s34, 10240
  v_mfma_f32_16x16x32_bf16 v[172:175], v[56:59], a[12:15], 0
  ds_read_b64 a[74:75], v22 offset:4608
  ds_read_b64 a[76:77], v22 offset:5120
  buffer_load_dwordx4 v23, s[16:19], s34 offen sc1 lds
  v_mfma_f32_16x16x32_bf16 v[172:175], v[60:63], a[28:31], v[172:175]
  ds_read_b64 a[78:79], v22 offset:5632
  v_mfma_f32_16x16x32_bf16 v[172:175], v[64:67], a[44:47], v[172:175]
  s_waitcnt lgkmcnt(8)
  v_mfma_f32_16x16x32_bf16 v[176:179], v[68:71], a[0:3], 0
  ds_read_b64_tr_b16 v[56:57], v9 offset:24576
  s_add_u32 m0, s33, 36864
  v_mfma_f32_16x16x32_bf16 v[176:179], v[72:75], a[16:19], v[176:179]
  ds_read_b64_tr_b16 v[58:59], v9 offset:26624
  s_mov_b32 s34, 47104
  v_mfma_f32_16x16x32_bf16 v[176:179], v[76:79], a[32:35], v[176:179]
  ds_read_b64_tr_b16 v[60:61], v9 offset:28672
  buffer_load_dwordx4 v23, s[16:19], s34 offen sc1 lds
  v_mfma_f32_16x16x32_bf16 v[180:183], v[68:71], a[4:7], 0
  ds_read_b64_tr_b16 v[62:63], v9 offset:30720
  s_add_u32 m0, s33, 40960
  v_mfma_f32_16x16x32_bf16 v[180:183], v[72:75], a[20:23], v[180:183]
  ds_read_b64_tr_b16 v[64:65], v9 offset:32768
  s_mov_b32 s34, 11264
  v_mfma_f32_16x16x32_bf16 v[180:183], v[76:79], a[36:39], v[180:183]
  ds_read_b64_tr_b16 v[66:67], v9 offset:34816
  buffer_load_dwordx4 v23, s[16:19], s34 offen sc1 lds
  v_mfma_f32_16x16x32_bf16 v[184:187], v[68:71], a[8:11], 0
  ds_read_b128 a[80:83], v28 offset:16384
  s_add_u32 m0, s33, 45056
  v_mfma_f32_16x16x32_bf16 v[184:187], v[72:75], a[24:27], v[184:187]
  ds_read_b128 a[84:87], v28 offset:17408
  s_mov_b32 s34, 48128
  v_mfma_f32_16x16x32_bf16 v[184:187], v[76:79], a[40:43], v[184:187]
  ds_read_b128 a[88:91], v28 offset:20480
  buffer_load_dwordx4 v23, s[16:19], s34 offen sc1 lds
  v_mfma_f32_16x16x32_bf16 v[188:191], v[68:71], a[12:15], 0
  ds_read_b128 a[92:95], v28 offset:21504
  v_mfma_f32_16x16x32_bf16 v[188:191], v[72:75], a[28:31], v[188:191]
  v_mfma_f32_16x16x32_bf16 v[188:191], v[76:79], a[44:47], v[188:191]
  s_waitcnt lgkmcnt(4)
  v_mfma_f32_16x16x32_bf16 v[128:131], v[56:59], a[48:51], v[128:131]
  s_waitcnt vmcnt(10)
  s_barrier
  v_mfma_f32_16x16x32_bf16 v[128:131], v[60:63], a[64:67], v[128:131]
  ds_read_b64_tr_b16 v[68:69], v12 offset:24576
  s_add_u32 m0, s33, 49152
  s_waitcnt lgkmcnt(4)
  v_mfma_f32_16x16x32_bf16 v[128:131], v[64:67], a[80:83], v[128:131]
  ds_read_b64_tr_b16 v[70:71], v12 offset:26624
  s_mov_b32 s34, 2654208
  v_mfma_f32_16x16x32_bf16 v[132:135], v[56:59], a[52:55], v[132:135]
  ds_read_b64_tr_b16 v[72:73], v12 offset:28672
  buffer_load_dwordx4 v19, s[4:7], s34 offen lds
  v_mfma_f32_16x16x32_bf16 v[132:135], v[60:63], a[68:71], v[132:135]
  ds_read_b64_tr_b16 v[74:75], v12 offset:30720
  s_add_u32 m0, s33, 53248
  s_waitcnt lgkmcnt(6)
  v_mfma_f32_16x16x32_bf16 v[132:135], v[64:67], a[84:87], v[132:135]
  ds_read_b64_tr_b16 v[76:77], v12 offset:32768
  s_mov_b32 s34, 2949120
  v_mfma_f32_16x16x32_bf16 v[136:139], v[56:59], a[56:59], v[136:139]
  ds_read_b64_tr_b16 v[78:79], v12 offset:34816
  buffer_load_dwordx4 v19, s[4:7], s34 offen lds
  v_mfma_f32_16x16x32_bf16 v[136:139], v[60:63], a[72:75], v[136:139]
  s_add_u32 m0, s33, 57344
  s_waitcnt lgkmcnt(7)
  v_mfma_f32_16x16x32_bf16 v[136:139], v[64:67], a[88:91], v[136:139]
  s_mov_b32 s34, 3244032
  v_mfma_f32_16x16x32_bf16 v[140:143], v[56:59], a[60:63], v[140:143]
  buffer_load_dwordx4 v19, s[4:7], s34 offen lds
  v_mfma_f32_16x16x32_bf16 v[140:143], v[60:63], a[76:79], v[140:143]
  s_waitcnt lgkmcnt(6)
  v_mfma_f32_16x16x32_bf16 v[140:143], v[64:67], a[92:95], v[140:143]
  s_waitcnt lgkmcnt(0)
  v_mfma_f32_16x16x32_bf16 v[144:147], v[68:71], a[48:51], v[144:147]
  ds_read_b64_tr_b16 v[56:57], v9 offset:36864
  s_add_u32 m0, s33, 61440
  v_mfma_f32_16x16x32_bf16 v[144:147], v[72:75], a[64:67], v[144:147]
  ds_read_b64_tr_b16 v[58:59], v9 offset:38912
  s_mov_b32 s34, 2654208
  v_mfma_f32_16x16x32_bf16 v[144:147], v[76:79], a[80:83], v[144:147]
  ds_read_b64_tr_b16 v[60:61], v9 offset:40960
  buffer_load_dwordx4 v19, s[8:11], s34 offen lds
  v_mfma_f32_16x16x32_bf16 v[148:151], v[68:71], a[52:55], v[148:151]
  ds_read_b64_tr_b16 v[62:63], v9 offset:43008
  s_add_u32 m0, s33, 65536
  v_mfma_f32_16x16x32_bf16 v[148:151], v[72:75], a[68:71], v[148:151]
  ds_read_b64_tr_b16 v[64:65], v9 offset:45056
  s_mov_b32 s34, 2949120
  v_mfma_f32_16x16x32_bf16 v[148:151], v[76:79], a[84:87], v[148:151]
  ds_read_b64_tr_b16 v[66:67], v9 offset:47104
  buffer_load_dwordx4 v19, s[8:11], s34 offen lds
  v_mfma_f32_16x16x32_bf16 v[152:155], v[68:71], a[56:59], v[152:155]
  ds_read_b128 a[96:99], v28 offset:24576
  s_add_u32 m0, s33, 69632
  v_mfma_f32_16x16x32_bf16 v[152:155], v[72:75], a[72:75], v[152:155]
  ds_read_b128 a[100:103], v28 offset:25600
  s_mov_b32 s34, 3244032
  v_mfma_f32_16x16x32_bf16 v[152:155], v[76:79], a[88:91], v[152:155]
  ds_read_b128 a[104:107], v28 offset:28672
  buffer_load_dwordx4 v19, s[8:11], s34 offen lds
  v_mfma_f32_16x16x32_bf16 v[156:159], v[68:71], a[60:63], v[156:159]
  ds_read_b128 a[108:111], v28 offset:29696
  v_mfma_f32_16x16x32_bf16 v[156:159], v[72:75], a[76:79], v[156:159]
  v_mfma_f32_16x16x32_bf16 v[156:159], v[76:79], a[92:95], v[156:159]
  s_waitcnt lgkmcnt(4)
  v_mfma_f32_16x16x32_bf16 v[160:163], v[56:59], a[48:51], v[160:163]
  s_waitcnt vmcnt(12)
  s_barrier
  v_mfma_f32_16x16x32_bf16 v[160:163], v[60:63], a[64:67], v[160:163]
  ds_read_b64_tr_b16 v[68:69], v12 offset:36864
  s_add_u32 m0, s33, 73728
  v_mfma_f32_16x16x32_bf16 v[160:163], v[64:67], a[80:83], v[160:163]
  ds_read_b64_tr_b16 v[70:71], v12 offset:38912
  s_mov_b32 s34, 12288
  v_mfma_f32_16x16x32_bf16 v[164:167], v[56:59], a[52:55], v[164:167]
  ds_read_b64_tr_b16 v[72:73], v12 offset:40960
  buffer_load_dwordx4 v23, s[16:19], s34 offen sc1 lds
  v_mfma_f32_16x16x32_bf16 v[164:167], v[60:63], a[68:71], v[164:167]
  ds_read_b64_tr_b16 v[74:75], v12 offset:43008
  s_add_u32 m0, s33, 77824
  v_mfma_f32_16x16x32_bf16 v[164:167], v[64:67], a[84:87], v[164:167]
  ds_read_b64_tr_b16 v[76:77], v12 offset:45056
  s_mov_b32 s34, 49152
  v_mfma_f32_16x16x32_bf16 v[168:171], v[56:59], a[56:59], v[168:171]
  ds_read_b64_tr_b16 v[78:79], v12 offset:47104
  buffer_load_dwordx4 v23, s[16:19], s34 offen sc1 lds
  v_mfma_f32_16x16x32_bf16 v[168:171], v[60:63], a[72:75], v[168:171]
  ds_read_b128 a[112:115], v26 offset:8192
  s_add_u32 m0, s33, 0
  v_mfma_f32_16x16x32_bf16 v[168:171], v[64:67], a[88:91], v[168:171]
  ds_read_b128 a[116:119], v26 offset:9216
  s_mov_b32 s34, 13312
  v_mfma_f32_16x16x32_bf16 v[172:175], v[56:59], a[60:63], v[172:175]
  ds_read_b128 a[120:123], v26 offset:12288
  buffer_load_dwordx4 v23, s[16:19], s34 offen sc1 lds
  v_mfma_f32_16x16x32_bf16 v[172:175], v[60:63], a[76:79], v[172:175]
  ds_read_b128 a[124:127], v26 offset:13312
  v_mfma_f32_16x16x32_bf16 v[172:175], v[64:67], a[92:95], v[172:175]
  s_waitcnt lgkmcnt(4)
  v_mfma_f32_16x16x32_bf16 v[176:179], v[68:71], a[48:51], v[176:179]
  ds_read_b64_tr_b16 v[56:57], v9 offset:49152
  s_add_u32 m0, s33, 4096
  v_mfma_f32_16x16x32_bf16 v[176:179], v[72:75], a[64:67], v[176:179]
  ds_read_b64_tr_b16 v[58:59], v9 offset:51200
  s_mov_b32 s34, 50176
  v_mfma_f32_16x16x32_bf16 v[176:179], v[76:79], a[80:83], v[176:179]
  ds_read_b64_tr_b16 v[60:61], v9 offset:53248
  buffer_load_dwordx4 v23, s[16:19], s34 offen sc1 lds
  v_mfma_f32_16x16x32_bf16 v[180:183], v[68:71], a[52:55], v[180:183]
  ds_read_b64_tr_b16 v[62:63], v9 offset:55296
  s_add_u32 m0, s33, 81920
  v_mfma_f32_16x16x32_bf16 v[180:183], v[72:75], a[68:71], v[180:183]
  ds_read_b64_tr_b16 v[64:65], v9 offset:57344
  s_mov_b32 s34, 14336
  v_mfma_f32_16x16x32_bf16 v[180:183], v[76:79], a[84:87], v[180:183]
  ds_read_b64_tr_b16 v[66:67], v9 offset:59392
  buffer_load_dwordx4 v23, s[16:19], s34 offen sc1 lds
  v_mfma_f32_16x16x32_bf16 v[184:187], v[68:71], a[56:59], v[184:187]
  ds_read_b128 a[128:131], v26 offset:16384
  s_add_u32 m0, s33, 86016
  v_mfma_f32_16x16x32_bf16 v[184:187], v[72:75], a[72:75], v[184:187]
  ds_read_b128 a[132:135], v26 offset:17408
  s_mov_b32 s34, 51200
  v_mfma_f32_16x16x32_bf16 v[184:187], v[76:79], a[88:91], v[184:187]
  ds_read_b128 a[136:139], v26 offset:20480
  buffer_load_dwordx4 v23, s[16:19], s34 offen sc1 lds
  v_mfma_f32_16x16x32_bf16 v[188:191], v[68:71], a[60:63], v[188:191]
  ds_read_b128 a[140:143], v26 offset:21504
  v_mfma_f32_16x16x32_bf16 v[188:191], v[72:75], a[76:79], v[188:191]
  v_mfma_f32_16x16x32_bf16 v[188:191], v[76:79], a[92:95], v[188:191]
  s_waitcnt lgkmcnt(4)
  v_mfma_f32_16x16x32_bf16 v[128:131], v[56:59], a[96:99], v[128:131]
  s_waitcnt vmcnt(16)
  s_barrier
  v_mfma_f32_16x16x32_bf16 v[128:131], v[60:63], a[112:115], v[128:131]
  ds_read_b64_tr_b16 v[68:69], v12 offset:49152
  s_add_u32 m0, s33, 139264
  s_waitcnt lgkmcnt(4)
  v_mfma_f32_16x16x32_bf16 v[128:131], v[64:67], a[128:131], v[128:131]
  ds_read_b64_tr_b16 v[70:71], v12 offset:51200
  s_mov_b32 s34, 3538944
  v_mfma_f32_16x16x32_bf16 v[132:135], v[56:59], a[100:103], v[132:135]
  ds_read_b64_tr_b16 v[72:73], v12 offset:53248
  buffer_load_dwordx4 v19, s[4:7], s34 offen lds
  v_mfma_f32_16x16x32_bf16 v[132:135], v[60:63], a[116:119], v[132:135]
  ds_read_b64_tr_b16 v[74:75], v12 offset:55296
  s_add_u32 m0, s33, 143360
  s_waitcnt lgkmcnt(6)
  v_mfma_f32_16x16x32_bf16 v[132:135], v[64:67], a[132:135], v[132:135]
  ds_read_b64_tr_b16 v[76:77], v12 offset:57344
  s_mov_b32 s34, 3833856
  v_mfma_f32_16x16x32_bf16 v[136:139], v[56:59], a[104:107], v[136:139]
  ds_read_b64_tr_b16 v[78:79], v12 offset:59392
  buffer_load_dwordx4 v19, s[4:7], s34 offen lds
  v_mfma_f32_16x16x32_bf16 v[136:139], v[60:63], a[120:123], v[136:139]
  s_add_u32 m0, s33, 90112
  s_waitcnt lgkmcnt(7)
  v_mfma_f32_16x16x32_bf16 v[136:139], v[64:67], a[136:139], v[136:139]
  s_mov_b32 s34, 4128768
  v_mfma_f32_16x16x32_bf16 v[140:143], v[56:59], a[108:111], v[140:143]
  buffer_load_dwordx4 v19, s[4:7], s34 offen lds
  v_mfma_f32_16x16x32_bf16 v[140:143], v[60:63], a[124:127], v[140:143]
  s_waitcnt lgkmcnt(6)
  v_mfma_f32_16x16x32_bf16 v[140:143], v[64:67], a[140:143], v[140:143]
  s_waitcnt lgkmcnt(0)
  v_mfma_f32_16x16x32_bf16 v[144:147], v[68:71], a[96:99], v[144:147]
  ds_read_b64_tr_b16 v[56:57], v9 offset:61440
  s_add_u32 m0, s33, 94208
  v_mfma_f32_16x16x32_bf16 v[144:147], v[72:75], a[112:115], v[144:147]
  ds_read_b64_tr_b16 v[58:59], v9 offset:63488
  s_mov_b32 s34, 3538944
  v_mfma_f32_16x16x32_bf16 v[144:147], v[76:79], a[128:131], v[144:147]
  ds_read_b64_tr_b16 v[60:61], v10
  buffer_load_dwordx4 v19, s[8:11], s34 offen lds
  v_mfma_f32_16x16x32_bf16 v[148:151], v[68:71], a[100:103], v[148:151]
  ds_read_b64_tr_b16 v[62:63], v10 offset:2048
  s_add_u32 m0, s33, 98304
  v_mfma_f32_16x16x32_bf16 v[148:151], v[72:75], a[116:119], v[148:151]
  ds_read_b64_tr_b16 v[64:65], v10 offset:4096
  s_mov_b32 s34, 3833856
  v_mfma_f32_16x16x32_bf16 v[148:151], v[76:79], a[132:135], v[148:151]
  ds_read_b64_tr_b16 v[66:67], v10 offset:6144
  buffer_load_dwordx4 v19, s[8:11], s34 offen lds
  v_mfma_f32_16x16x32_bf16 v[152:155], v[68:71], a[104:107], v[152:155]
  ds_read_b128 a[144:147], v26 offset:24576
  s_add_u32 m0, s33, 147456
  v_mfma_f32_16x16x32_bf16 v[152:155], v[72:75], a[120:123], v[152:155]
  ds_read_b128 a[148:151], v26 offset:25600
  s_mov_b32 s34, 4128768
  v_mfma_f32_16x16x32_bf16 v[152:155], v[76:79], a[136:139], v[152:155]
  ds_read_b128 a[152:155], v26 offset:28672
  buffer_load_dwordx4 v19, s[8:11], s34 offen lds
  v_mfma_f32_16x16x32_bf16 v[156:159], v[68:71], a[108:111], v[156:159]
  ds_read_b128 a[156:159], v26 offset:29696
  v_mfma_f32_16x16x32_bf16 v[156:159], v[72:75], a[124:127], v[156:159]
  v_mfma_f32_16x16x32_bf16 v[156:159], v[76:79], a[140:143], v[156:159]
  s_waitcnt lgkmcnt(4)
  v_mfma_f32_16x16x32_bf16 v[160:163], v[56:59], a[96:99], v[160:163]
  s_waitcnt vmcnt(15)
  s_barrier
  v_mfma_f32_16x16x32_bf16 v[160:163], v[60:63], a[112:115], v[160:163]
  ds_read_b64_tr_b16 v[68:69], v12 offset:61440
  s_add_u32 m0, s33, 151552
  v_mfma_f32_16x16x32_bf16 v[160:163], v[64:67], a[128:131], v[160:163]
  ds_read_b64_tr_b16 v[70:71], v12 offset:63488
  s_mov_b32 s34, 15360
  v_mfma_f32_16x16x32_bf16 v[164:167], v[56:59], a[100:103], v[164:167]
  ds_read_b64_tr_b16 v[72:73], v13
  buffer_load_dwordx4 v23, s[16:19], s34 offen sc1 lds
  v_mfma_f32_16x16x32_bf16 v[164:167], v[60:63], a[116:119], v[164:167]
  ds_read_b64_tr_b16 v[74:75], v13 offset:2048
  s_add_u32 m0, s33, 102400
  v_mfma_f32_16x16x32_bf16 v[164:167], v[64:67], a[132:135], v[164:167]
  ds_read_b64_tr_b16 v[76:77], v13 offset:4096
  s_mov_b32 s34, 52224
  v_mfma_f32_16x16x32_bf16 v[168:171], v[56:59], a[104:107], v[168:171]
  ds_read_b64_tr_b16 v[78:79], v13 offset:6144
  buffer_load_dwordx4 v23, s[16:19], s34 offen sc1 lds
  v_mfma_f32_16x16x32_bf16 v[168:171], v[60:63], a[120:123], v[168:171]
  ds_read_b128 a[160:163], v26 offset:32768
  s_add_u32 m0, s33, 106496
  v_mfma_f32_16x16x32_bf16 v[168:171], v[64:67], a[136:139], v[168:171]
  ds_read_b128 a[164:167], v26 offset:33792
  s_mov_b32 s34, 16384
  v_mfma_f32_16x16x32_bf16 v[172:175], v[56:59], a[108:111], v[172:175]
  ds_read_b128 a[168:171], v26 offset:36864
  buffer_load_dwordx4 v23, s[16:19], s34 offen sc1 lds
  v_mfma_f32_16x16x32_bf16 v[172:175], v[60:63], a[124:127], v[172:175]
  ds_read_b128 a[172:175], v26 offset:37888
  v_mfma_f32_16x16x32_bf16 v[172:175], v[64:67], a[140:143], v[172:175]
  s_waitcnt lgkmcnt(4)
  v_mfma_f32_16x16x32_bf16 v[176:179], v[68:71], a[96:99], v[176:179]
  ds_read_b64_tr_b16 v[56:57], v8 offset:49152
  s_add_u32 m0, s33, 110592
  v_mfma_f32_16x16x32_bf16 v[176:179], v[72:75], a[112:115], v[176:179]
  ds_read_b64_tr_b16 v[58:59], v8 offset:51200
  s_mov_b32 s34, 53248
  v_mfma_f32_16x16x32_bf16 v[176:179], v[76:79], a[128:131], v[176:179]
  ds_read_b64_tr_b16 v[60:61], v8 offset:53248
  buffer_load_dwordx4 v23, s[16:19], s34 offen sc1 lds
  v_mfma_f32_16x16x32_bf16 v[180:183], v[68:71], a[100:103], v[180:183]
  ds_read_b64_tr_b16 v[62:63], v8 offset:55296
  s_add_u32 m0, s33, 155648
  v_mfma_f32_16x16x32_bf16 v[180:183], v[72:75], a[116:119], v[180:183]
  ds_read_b64_tr_b16 v[64:65], v8 offset:57344
  s_mov_b32 s34, 17408
  v_mfma_f32_16x16x32_bf16 v[180:183], v[76:79], a[132:135], v[180:183]
  ds_read_b64_tr_b16 v[66:67], v8 offset:59392
  buffer_load_dwordx4 v23, s[16:19], s34 offen sc1 lds
  v_mfma_f32_16x16x32_bf16 v[184:187], v[68:71], a[104:107], v[184:187]
  ds_read_b128 a[176:179], v26 offset:40960
  s_add_u32 m0, s33, 159744
  v_mfma_f32_16x16x32_bf16 v[184:187], v[72:75], a[120:123], v[184:187]
  ds_read_b128 a[180:183], v26 offset:41984
  s_mov_b32 s34, 54272
  v_mfma_f32_16x16x32_bf16 v[184:187], v[76:79], a[136:139], v[184:187]
  ds_read_b128 a[184:187], v26 offset:45056
  buffer_load_dwordx4 v23, s[16:19], s34 offen sc1 lds
  v_mfma_f32_16x16x32_bf16 v[188:191], v[68:71], a[108:111], v[188:191]
  ds_read_b128 a[188:191], v26 offset:46080
  v_mfma_f32_16x16x32_bf16 v[188:191], v[72:75], a[124:127], v[188:191]
  v_mfma_f32_16x16x32_bf16 v[188:191], v[76:79], a[140:143], v[188:191]
  s_waitcnt lgkmcnt(4)
  v_mfma_f32_16x16x32_bf16 v[128:131], v[56:59], a[144:147], v[128:131]
  s_waitcnt vmcnt(16)
  s_barrier
  v_mfma_f32_16x16x32_bf16 v[128:131], v[60:63], a[160:163], v[128:131]
  ds_read_b64_tr_b16 v[68:69], v11 offset:49152
  s_add_u32 m0, s33, 8192
  s_waitcnt lgkmcnt(4)
  v_mfma_f32_16x16x32_bf16 v[128:131], v[64:67], a[176:179], v[128:131]
  ds_read_b64_tr_b16 v[70:71], v11 offset:51200
  s_mov_b32 s34, 4423680
  v_mfma_f32_16x16x32_bf16 v[132:135], v[56:59], a[148:151], v[132:135]
  ds_read_b64_tr_b16 v[72:73], v11 offset:53248
  buffer_load_dwordx4 v19, s[4:7], s34 offen lds
  v_mfma_f32_16x16x32_bf16 v[132:135], v[60:63], a[164:167], v[132:135]
  ds_read_b64_tr_b16 v[74:75], v11 offset:55296
  s_add_u32 m0, s33, 12288
  s_waitcnt lgkmcnt(6)
  v_mfma_f32_16x16x32_bf16 v[132:135], v[64:67], a[180:183], v[132:135]
  ds_read_b64_tr_b16 v[76:77], v11 offset:57344
  s_mov_b32 s34, 4718592
  v_mfma_f32_16x16x32_bf16 v[136:139], v[56:59], a[152:155], v[136:139]
  ds_read_b64_tr_b16 v[78:79], v11 offset:59392
  buffer_load_dwordx4 v19, s[4:7], s34 offen lds
  v_mfma_f32_16x16x32_bf16 v[136:139], v[60:63], a[168:171], v[136:139]
  s_add_u32 m0, s33, 114688
  s_and_b32 s36, s92, 1
  s_waitcnt lgkmcnt(7)
  v_mfma_f32_16x16x32_bf16 v[136:139], v[64:67], a[184:187], v[136:139]
  s_mov_b32 s34, 5013504
  s_lshl_b32 s37, s36, 12
  v_mfma_f32_16x16x32_bf16 v[140:143], v[56:59], a[156:159], v[140:143]
  buffer_load_dwordx4 v19, s[4:7], s34 offen lds
  v_add_u32 v80, s37, v24
  v_mfma_f32_16x16x32_bf16 v[140:143], v[60:63], a[172:175], v[140:143]
  s_lshl_b32 s37, s36, 9
  v_lshrrev_b32 v81, 1, v24
  s_waitcnt lgkmcnt(6)
  v_mfma_f32_16x16x32_bf16 v[140:143], v[64:67], a[188:191], v[140:143]
  v_add_u32 v81, s37, v81
  s_waitcnt lgkmcnt(0)
  v_mfma_f32_16x16x32_bf16 v[144:147], v[68:71], a[144:147], v[144:147]
  ds_read_b64_tr_b16 v[56:57], v8 offset:61440
  s_add_u32 m0, s33, 118784
  v_mfma_f32_16x16x32_bf16 v[144:147], v[72:75], a[160:163], v[144:147]
  ds_read_b64_tr_b16 v[58:59], v8 offset:63488
  s_mov_b32 s34, 4423680
  v_mfma_f32_16x16x32_bf16 v[144:147], v[76:79], a[176:179], v[144:147]
  ds_read_b64_tr_b16 v[60:61], v9
  buffer_load_dwordx4 v19, s[8:11], s34 offen lds
  v_mfma_f32_16x16x32_bf16 v[148:151], v[68:71], a[148:151], v[148:151]
  ds_read_b64_tr_b16 v[62:63], v9 offset:2048
  s_add_u32 m0, s33, 122880
  v_mfma_f32_16x16x32_bf16 v[148:151], v[72:75], a[164:167], v[148:151]
  ds_read_b64_tr_b16 v[64:65], v9 offset:4096
  s_mov_b32 s34, 4718592
  v_mfma_f32_16x16x32_bf16 v[148:151], v[76:79], a[180:183], v[148:151]
  ds_read_b64_tr_b16 v[66:67], v9 offset:6144
  buffer_load_dwordx4 v19, s[8:11], s34 offen lds
  v_mfma_f32_16x16x32_bf16 v[152:155], v[68:71], a[152:155], v[152:155]
  ds_read_b128 a[192:195], v27 offset:8192
  s_add_u32 m0, s33, 16384
  v_mfma_f32_16x16x32_bf16 v[152:155], v[72:75], a[168:171], v[152:155]
  ds_read_b128 a[196:199], v27 offset:9216
  s_mov_b32 s34, 5013504
  v_mfma_f32_16x16x32_bf16 v[152:155], v[76:79], a[184:187], v[152:155]
  ds_read_b128 a[200:203], v27 offset:12288
  buffer_load_dwordx4 v19, s[8:11], s34 offen lds
  v_mfma_f32_16x16x32_bf16 v[156:159], v[68:71], a[156:159], v[156:159]
  ds_read_b128 a[204:207], v27 offset:13312
  s_mul_i32 s36, s93, 36
  v_mfma_f32_16x16x32_bf16 v[156:159], v[72:75], a[172:175], v[156:159]
  v_add_u32 v4, s36, v0
  v_mul_u32_u24 v4, 9216, v4
  v_mfma_f32_16x16x32_bf16 v[156:159], v[76:79], a[188:191], v[156:159]
  s_mul_i32 s36, s94, 576
  s_waitcnt lgkmcnt(4)
  v_mfma_f32_16x16x32_bf16 v[160:163], v[56:59], a[144:147], v[160:163]
  s_waitcnt vmcnt(15)
  s_barrier
  v_mfma_f32_16x16x32_bf16 v[160:163], v[60:63], a[160:163], v[160:163]
  ds_read_b64_tr_b16 v[68:69], v11 offset:61440
  s_add_u32 m0, s33, 20480
  v_mfma_f32_16x16x32_bf16 v[160:163], v[64:67], a[176:179], v[160:163]
  ds_read_b64_tr_b16 v[70:71], v11 offset:63488
  s_mov_b32 s34, 128
  v_mfma_f32_16x16x32_bf16 v[164:167], v[56:59], a[148:151], v[164:167]
  ds_read_b64_tr_b16 v[72:73], v12
  buffer_load_dwordx4 v19, s[4:7], s34 offen lds
  v_mfma_f32_16x16x32_bf16 v[164:167], v[60:63], a[164:167], v[164:167]
  ds_read_b64_tr_b16 v[74:75], v12 offset:2048
  s_add_u32 m0, s33, 135168
  v_mfma_f32_16x16x32_bf16 v[164:167], v[64:67], a[180:183], v[164:167]
  ds_read_b64_tr_b16 v[76:77], v12 offset:4096
  s_mov_b32 s34, 295040
  v_mfma_f32_16x16x32_bf16 v[168:171], v[56:59], a[152:155], v[168:171]
  ds_read_b64_tr_b16 v[78:79], v12 offset:6144
  ds_read_b64 a[208:209], v22
  buffer_load_dwordx4 v19, s[4:7], s34 offen lds
  v_mfma_f32_16x16x32_bf16 v[168:171], v[60:63], a[168:171], v[168:171]
  ds_read_b64 a[210:211], v22 offset:512
  ds_read_b64 a[212:213], v22 offset:1024
  s_add_u32 m0, s33, 24576
  v_mfma_f32_16x16x32_bf16 v[168:171], v[64:67], a[184:187], v[168:171]
  ds_read_b64 a[214:215], v22 offset:1536
  ds_read_b64 a[216:217], v22 offset:4096
  s_mov_b32 s34, 589952
  v_mfma_f32_16x16x32_bf16 v[172:175], v[56:59], a[156:159], v[172:175]
  ds_read_b64 a[218:219], v22 offset:4608
  ds_read_b64 a[220:221], v22 offset:5120
  buffer_load_dwordx4 v19, s[4:7], s34 offen lds
  v_mfma_f32_16x16x32_bf16 v[172:175], v[60:63], a[172:175], v[172:175]
  ds_read_b64 a[222:223], v22 offset:5632
  s_and_b32 s36, s36, 0xffffff80
  v_mfma_f32_16x16x32_bf16 v[172:175], v[64:67], a[188:191], v[172:175]
  v_add_u32 v4, s36, v4
  s_waitcnt lgkmcnt(8)
  v_mfma_f32_16x16x32_bf16 v[176:179], v[68:71], a[144:147], v[176:179]
  ds_read_b64_tr_b16 v[56:57], v10 offset:8192
  v_mov_b32 v6, 0x7ffffff0
  v_mfma_f32_16x16x32_bf16 v[176:179], v[72:75], a[160:163], v[176:179]
  ds_read_b64_tr_b16 v[58:59], v10 offset:10240
  v_cmp_gt_u32 vcc, 36, v0
  v_mfma_f32_16x16x32_bf16 v[176:179], v[76:79], a[176:179], v[176:179]
  ds_read_b64_tr_b16 v[60:61], v10 offset:12288
  v_cndmask_b32 v92, v6, v4, vcc
  v_mfma_f32_16x16x32_bf16 v[180:183], v[68:71], a[148:151], v[180:183]
  ds_read_b64_tr_b16 v[62:63], v10 offset:14336
  s_lshl_b32 s36, s94, 4
  v_mfma_f32_16x16x32_bf16 v[180:183], v[72:75], a[164:167], v[180:183]
  ds_read_b64_tr_b16 v[64:65], v9 offset:24576
  s_add_u32 s36, s36, s93
  v_mfma_f32_16x16x32_bf16 v[180:183], v[76:79], a[180:183], v[180:183]
  ds_read_b64_tr_b16 v[66:67], v9 offset:26624
  s_mul_i32 s36, s36, 20736
  v_mfma_f32_16x16x32_bf16 v[184:187], v[68:71], a[152:155], v[184:187]
  ds_read_b128 a[224:227], v27 offset:16384
  v_lshl_add_u32 v4, v0, 7, s36
  v_mfma_f32_16x16x32_bf16 v[184:187], v[72:75], a[168:171], v[184:187]
  ds_read_b128 a[228:231], v27 offset:17408
  v_cmp_gt_u32 vcc, 54, v0
  v_mfma_f32_16x16x32_bf16 v[184:187], v[76:79], a[184:187], v[184:187]
  ds_read_b128 a[232:235], v27 offset:20480
  v_cndmask_b32 v93, v6, v4, vcc
  v_mfma_f32_16x16x32_bf16 v[188:191], v[68:71], a[156:159], v[188:191]
  ds_read_b128 a[236:239], v27 offset:21504
  s_cmp_eq_u32 s95, 0
  s_cselect_b32 s36, 0, 0x7ffffff0
  v_mfma_f32_16x16x32_bf16 v[188:191], v[72:75], a[172:175], v[188:191]
  v_or_b32 v92, s36, v92
  v_or_b32 v93, s36, v93
  v_mfma_f32_16x16x32_bf16 v[188:191], v[76:79], a[188:191], v[188:191]
  s_and_b32 s65, s94, 1
  s_waitcnt lgkmcnt(4)
  v_mfma_f32_16x16x32_bf16 v[128:131], v[56:59], a[192:195], v[128:131]
  s_waitcnt vmcnt(13)
  s_barrier
  v_mfma_f32_16x16x32_bf16 v[128:131], v[60:63], a[208:211], v[128:131]
  ds_read_b64_tr_b16 v[68:69], v13 offset:8192
  s_add_u32 m0, s33, 28672
  s_waitcnt lgkmcnt(4)
  v_mfma_f32_16x16x32_bf16 v[128:131], v[64:67], a[224:227], v[128:131]
  ds_read_b64_tr_b16 v[70:71], v13 offset:10240
  s_mov_b32 s34, 128
  v_mfma_f32_16x16x32_bf16 v[132:135], v[56:59], a[196:199], v[132:135]
  ds_read_b64_tr_b16 v[72:73], v13 offset:12288
  buffer_load_dwordx4 v19, s[8:11], s34 offen lds
  v_mfma_f32_16x16x32_bf16 v[132:135], v[60:63], a[212:215], v[132:135]
  ds_read_b64_tr_b16 v[74:75], v13 offset:14336
  s_add_u32 m0, s33, 32768
  s_waitcnt lgkmcnt(6)
  v_mfma_f32_16x16x32_bf16 v[132:135], v[64:67], a[228:231], v[132:135]
  ds_read_b64_tr_b16 v[76:77], v12 offset:24576
  s_mov_b32 s34, 295040
  v_mfma_f32_16x16x32_bf16 v[136:139], v[56:59], a[200:203], v[136:139]
  ds_read_b64_tr_b16 v[78:79], v12 offset:26624
  buffer_load_dwordx4 v19, s[8:11], s34 offen lds
  v_mfma_f32_16x16x32_bf16 v[136:139], v[60:63], a[216:219], v[136:139]
  s_add_u32 m0, s33, 36864
  s_add_u32 s65, s65, 1
  s_waitcnt lgkmcnt(7)
  v_mfma_f32_16x16x32_bf16 v[136:139], v[64:67], a[232:235], v[136:139]
  s_mov_b32 s34, 589952
  s_cmp_eq_u32 s65, 5
  s_cselect_b32 s65, 0, s65
  v_mfma_f32_16x16x32_bf16 v[140:143], v[56:59], a[204:207], v[140:143]
  buffer_load_dwordx4 v19, s[8:11], s34 offen lds
  s_lshl_b32 s65, s65, 7
  v_mfma_f32_16x16x32_bf16 v[140:143], v[60:63], a[220:223], v[140:143]
  buffer_load_dword v31, v92, s[4:7], s65 offen
  s_waitcnt lgkmcnt(6)
  v_mfma_f32_16x16x32_bf16 v[140:143], v[64:67], a[236:239], v[140:143]
  buffer_load_dword v31, v92, s[8:11], s65 offen
  s_waitcnt lgkmcnt(0)
  v_mfma_f32_16x16x32_bf16 v[144:147], v[68:71], a[192:195], v[144:147]
  ds_read_b64_tr_b16 v[56:57], v9 offset:28672
  v_mfma_f32_16x16x32_bf16 v[144:147], v[72:75], a[208:211], v[144:147]
  ds_read_b64_tr_b16 v[58:59], v9 offset:30720
  v_mfma_f32_16x16x32_bf16 v[144:147], v[76:79], a[224:227], v[144:147]
  ds_read_b64_tr_b16 v[60:61], v9 offset:32768
  v_mfma_f32_16x16x32_bf16 v[148:151], v[68:71], a[196:199], v[148:151]
  ds_read_b64_tr_b16 v[62:63], v9 offset:34816
  v_mfma_f32_16x16x32_bf16 v[148:151], v[72:75], a[212:215], v[148:151]
  ds_read_b64_tr_b16 v[64:65], v10 offset:16384
  v_mfma_f32_16x16x32_bf16 v[148:151], v[76:79], a[228:231], v[148:151]
  ds_read_b64_tr_b16 v[66:67], v10 offset:18432
  v_mfma_f32_16x16x32_bf16 v[152:155], v[68:71], a[200:203], v[152:155]
  ds_read_b128 a[240:243], v28 offset:20480
  v_mfma_f32_16x16x32_bf16 v[152:155], v[72:75], a[216:219], v[152:155]
  ds_read_b128 a[244:247], v28 offset:21504
  v_mfma_f32_16x16x32_bf16 v[152:155], v[76:79], a[232:235], v[152:155]
  ds_read_b128 a[248:251], v27 offset:36864
  v_mfma_f32_16x16x32_bf16 v[156:159], v[68:71], a[204:207], v[156:159]
  ds_read_b128 a[252:255], v27 offset:37888
  v_mfma_f32_16x16x32_bf16 v[156:159], v[72:75], a[220:223], v[156:159]
  v_mfma_f32_16x16x32_bf16 v[156:159], v[76:79], a[236:239], v[156:159]
  s_waitcnt lgkmcnt(4)
  v_mfma_f32_16x16x32_bf16 v[160:163], v[56:59], a[192:195], v[160:163]
  s_waitcnt vmcnt(11)
  s_barrier
  v_mfma_f32_16x16x32_bf16 v[160:163], v[60:63], a[208:211], v[160:163]
  ds_read_b64_tr_b16 v[68:69], v12 offset:28672
  s_add_u32 m0, s33, 40960
  v_mfma_f32_16x16x32_bf16 v[160:163], v[64:67], a[224:227], v[160:163]
  ds_read_b64_tr_b16 v[70:71], v12 offset:30720
  s_mov_b32 s34, 884864
  v_mfma_f32_16x16x32_bf16 v[164:167], v[56:59], a[196:199], v[164:167]
  ds_read_b64_tr_b16 v[72:73], v12 offset:32768
  buffer_load_dwordx4 v19, s[4:7], s34 offen lds
  v_mfma_f32_16x16x32_bf16 v[164:167], v[60:63], a[212:215], v[164:167]
  ds_read_b64_tr_b16 v[74:75], v12 offset:34816
  s_add_u32 m0, s33, 45056
  v_mfma_f32_16x16x32_bf16 v[164:167], v[64:67], a[228:231], v[164:167]
  ds_read_b64_tr_b16 v[76:77], v13 offset:16384
  s_mov_b32 s34, 1179776
  v_mfma_f32_16x16x32_bf16 v[168:171], v[56:59], a[200:203], v[168:171]
  ds_read_b64_tr_b16 v[78:79], v13 offset:18432
  buffer_load_dwordx4 v19, s[4:7], s34 offen lds
  v_mfma_f32_16x16x32_bf16 v[168:171], v[60:63], a[216:219], v[168:171]
  ds_read_b128 v[96:99], v27 offset:40960
  s_add_u32 m0, s33, 49152
  v_mfma_f32_16x16x32_bf16 v[168:171], v[64:67], a[232:235], v[168:171]
  ds_read_b128 v[100:103], v27 offset:41984
  s_mov_b32 s34, 1474688
  v_mfma_f32_16x16x32_bf16 v[172:175], v[56:59], a[204:207], v[172:175]
  ds_read_b128 v[104:107], v27 offset:45056
  buffer_load_dwordx4 v19, s[4:7], s34 offen lds
  v_mfma_f32_16x16x32_bf16 v[172:175], v[60:63], a[220:223], v[172:175]
  ds_read_b128 v[108:111], v27 offset:46080
  v_mfma_f32_16x16x32_bf16 v[172:175], v[64:67], a[236:239], v[172:175]
  s_waitcnt lgkmcnt(4)
  v_mfma_f32_16x16x32_bf16 v[176:179], v[68:71], a[192:195], v[176:179]
  ds_read_b64_tr_b16 v[56:57], v8 offset:8192
  v_mfma_f32_16x16x32_bf16 v[176:179], v[72:75], a[208:211], v[176:179]
  ds_read_b64_tr_b16 v[58:59], v8 offset:10240
  v_mfma_f32_16x16x32_bf16 v[176:179], v[76:79], a[224:227], v[176:179]
  ds_read_b64_tr_b16 v[60:61], v8 offset:12288
  v_mfma_f32_16x16x32_bf16 v[180:183], v[68:71], a[196:199], v[180:183]
  ds_read_b64_tr_b16 v[62:63], v8 offset:14336
  v_mfma_f32_16x16x32_bf16 v[180:183], v[72:75], a[212:215], v[180:183]
  ds_read_b64_tr_b16 v[64:65], v9 offset:49152
  v_mfma_f32_16x16x32_bf16 v[180:183], v[76:79], a[228:231], v[180:183]
  ds_read_b64_tr_b16 v[66:67], v9 offset:51200
  v_mfma_f32_16x16x32_bf16 v[184:187], v[68:71], a[200:203], v[184:187]
  ds_read_b128 v[112:115], v28 offset:24576
  v_mfma_f32_16x16x32_bf16 v[184:187], v[72:75], a[216:219], v[184:187]
  ds_read_b128 v[116:119], v28 offset:25600
  v_mfma_f32_16x16x32_bf16 v[184:187], v[76:79], a[232:235], v[184:187]
  ds_read_b128 v[120:123], v28 offset:28672
  v_mfma_f32_16x16x32_bf16 v[188:191], v[68:71], a[204:207], v[188:191]
  ds_read_b128 v[124:127], v28 offset:29696
  v_mfma_f32_16x16x32_bf16 v[188:191], v[72:75], a[220:223], v[188:191]
  v_mfma_f32_16x16x32_bf16 v[188:191], v[76:79], a[236:239], v[188:191]
  s_waitcnt lgkmcnt(4)
  v_mfma_f32_16x16x32_bf16 v[128:131], v[56:59], a[240:243], v[128:131]
  s_waitcnt vmcnt(11)
  s_barrier
  v_mfma_f32_16x16x32_bf16 v[128:131], v[60:63], v[96:99], v[128:131]
  ds_read_b64_tr_b16 v[68:69], v11 offset:8192
  s_add_u32 m0, s33, 53248
  s_waitcnt lgkmcnt(4)
  v_mfma_f32_16x16x32_bf16 v[128:131], v[64:67], v[112:115], v[128:131]
  ds_read_b64_tr_b16 v[70:71], v11 offset:10240
  s_mov_b32 s34, 884864
  v_mfma_f32_16x16x32_bf16 v[132:135], v[56:59], a[244:247], v[132:135]
  ds_read_b64_tr_b16 v[72:73], v11 offset:12288
  buffer_load_dwordx4 v19, s[8:11], s34 offen lds
  v_mfma_f32_16x16x32_bf16 v[132:135], v[60:63], v[100:103], v[132:135]
  ds_read_b64_tr_b16 v[74:75], v11 offset:14336
  s_add_u32 m0, s33, 57344
  s_waitcnt lgkmcnt(6)
  v_mfma_f32_16x16x32_bf16 v[132:135], v[64:67], v[116:119], v[132:135]
  ds_read_b64_tr_b16 v[76:77], v12 offset:49152
  s_mov_b32 s34, 1179776
  v_mfma_f32_16x16x32_bf16 v[136:139], v[56:59], a[248:251], v[136:139]
  ds_read_b64_tr_b16 v[78:79], v12 offset:51200
  buffer_load_dwordx4 v19, s[8:11], s34 offen lds
  v_mfma_f32_16x16x32_bf16 v[136:139], v[60:63], v[104:107], v[136:139]
  s_add_u32 m0, s33, 61440
  s_waitcnt lgkmcnt(7)
  v_mfma_f32_16x16x32_bf16 v[136:139], v[64:67], v[120:123], v[136:139]
  s_mov_b32 s34, 1474688
  v_mfma_f32_16x16x32_bf16 v[140:143], v[56:59], a[252:255], v[140:143]
  buffer_load_dwordx4 v19, s[8:11], s34 offen lds
  v_mfma_f32_16x16x32_bf16 v[140:143], v[60:63], v[108:111], v[140:143]
  s_waitcnt lgkmcnt(6)
  v_mfma_f32_16x16x32_bf16 v[140:143], v[64:67], v[124:127], v[140:143]
  s_waitcnt lgkmcnt(0)
  v_mfma_f32_16x16x32_bf16 v[144:147], v[68:71], a[240:243], v[144:147]
  ds_read_b64_tr_b16 v[56:57], v9 offset:53248
  v_mfma_f32_16x16x32_bf16 v[144:147], v[72:75], v[96:99], v[144:147]
  ds_read_b64_tr_b16 v[58:59], v9 offset:55296
  v_mfma_f32_16x16x32_bf16 v[144:147], v[76:79], v[112:115], v[144:147]
  ds_read_b64_tr_b16 v[60:61], v9 offset:57344
  v_mfma_f32_16x16x32_bf16 v[148:151], v[68:71], a[244:247], v[148:151]
  ds_read_b64_tr_b16 v[62:63], v9 offset:59392
  v_mfma_f32_16x16x32_bf16 v[148:151], v[72:75], v[100:103], v[148:151]
  ds_read_b64_tr_b16 v[64:65], v8 offset:16384
  v_mfma_f32_16x16x32_bf16 v[148:151], v[76:79], v[116:119], v[148:151]
  ds_read_b64_tr_b16 v[66:67], v8 offset:18432
  v_mfma_f32_16x16x32_bf16 v[152:155], v[68:71], a[248:251], v[152:155]
  v_mfma_f32_16x16x32_bf16 v[152:155], v[72:75], v[104:107], v[152:155]
  v_mfma_f32_16x16x32_bf16 v[152:155], v[76:79], v[120:123], v[152:155]
  v_mfma_f32_16x16x32_bf16 v[156:159], v[68:71], a[252:255], v[156:159]
  v_mfma_f32_16x16x32_bf16 v[156:159], v[72:75], v[108:111], v[156:159]
  v_mfma_f32_16x16x32_bf16 v[156:159], v[76:79], v[124:127], v[156:159]
  s_waitcnt lgkmcnt(0)
  v_mfma_f32_16x16x32_bf16 v[160:163], v[56:59], a[240:243], v[160:163]
  s_waitcnt vmcnt(11)
  s_barrier
  v_mfma_f32_16x16x32_bf16 v[160:163], v[60:63], v[96:99], v[160:163]
  ds_read_b64_tr_b16 v[68:69], v12 offset:53248
  s_add_u32 m0, s33, 65536
  v_mfma_f32_16x16x32_bf16 v[160:163], v[64:67], v[112:115], v[160:163]
  ds_read_b64_tr_b16 v[70:71], v12 offset:55296
  s_mov_b32 s34, 1769600
  v_mfma_f32_16x16x32_bf16 v[164:167], v[56:59], a[244:247], v[164:167]
  ds_read_b64_tr_b16 v[72:73], v12 offset:57344
  buffer_load_dwordx4 v19, s[4:7], s34 offen lds
  v_mfma_f32_16x16x32_bf16 v[164:167], v[60:63], v[100:103], v[164:167]
  ds_read_b64_tr_b16 v[74:75], v12 offset:59392
  s_add_u32 m0, s33, 69632
  v_mfma_f32_16x16x32_bf16 v[164:167], v[64:67], v[116:119], v[164:167]
  ds_read_b64_tr_b16 v[76:77], v11 offset:16384
  s_mov_b32 s34, 2064512
  v_mfma_f32_16x16x32_bf16 v[168:171], v[56:59], a[248:251], v[168:171]
  ds_read_b64_tr_b16 v[78:79], v11 offset:18432
  buffer_load_dwordx4 v19, s[4:7], s34 offen lds
  v_mfma_f32_16x16x32_bf16 v[168:171], v[60:63], v[104:107], v[168:171]
  s_add_u32 m0, s33, 73728
  s_and_b32 s65, s94, 1
  v_mfma_f32_16x16x32_bf16 v[168:171], v[64:67], v[120:123], v[168:171]
  s_mov_b32 s34, 2359424
  s_add_u32 s65, s65, 2
  v_mfma_f32_16x16x32_bf16 v[172:175], v[56:59], a[252:255], v[172:175]
  buffer_load_dwordx4 v19, s[4:7], s34 offen lds
  s_cmp_eq_u32 s65, 5
  s_cselect_b32 s65, 0, s65
  v_mfma_f32_16x16x32_bf16 v[172:175], v[60:63], v[108:111], v[172:175]
  s_lshl_b32 s65, s65, 7
  v_mfma_f32_16x16x32_bf16 v[172:175], v[64:67], v[124:127], v[172:175]
  buffer_load_dword v31, v92, s[4:7], s65 offen
  s_waitcnt lgkmcnt(0)
  v_mfma_f32_16x16x32_bf16 v[176:179], v[68:71], a[240:243], v[176:179]
  ds_read_b64_tr_b16 v[56:57], v8 offset:20480
  buffer_load_dword v31, v92, s[8:11], s65 offen
  v_mfma_f32_16x16x32_bf16 v[176:179], v[72:75], v[96:99], v[176:179]
  ds_read_b64_tr_b16 v[58:59], v8 offset:22528
  v_mfma_f32_16x16x32_bf16 v[176:179], v[76:79], v[112:115], v[176:179]
  ds_read_b64_tr_b16 v[60:61], v10 offset:4096
  v_mfma_f32_16x16x32_bf16 v[180:183], v[68:71], a[244:247], v[180:183]
  ds_read_b64_tr_b16 v[62:63], v10 offset:6144
  v_mfma_f32_16x16x32_bf16 v[180:183], v[72:75], v[100:103], v[180:183]
  ds_read_b64_tr_b16 v[64:65], v8 offset:24576
  v_mfma_f32_16x16x32_bf16 v[180:183], v[76:79], v[116:119], v[180:183]
  ds_read_b64_tr_b16 v[66:67], v8 offset:26624
  v_mfma_f32_16x16x32_bf16 v[184:187], v[68:71], a[248:251], v[184:187]
  v_mfma_f32_16x16x32_bf16 v[184:187], v[72:75], v[104:107], v[184:187]
  v_mfma_f32_16x16x32_bf16 v[184:187], v[76:79], v[120:123], v[184:187]
  v_mfma_f32_16x16x32_bf16 v[188:191], v[68:71], a[252:255], v[188:191]
  v_mfma_f32_16x16x32_bf16 v[188:191], v[72:75], v[108:111], v[188:191]
  v_mfma_f32_16x16x32_bf16 v[188:191], v[76:79], v[124:127], v[188:191]
  s_waitcnt lgkmcnt(0)
  v_mfma_f32_16x16x32_bf16 v[192:195], v[56:59], a[0:3], 0
  s_waitcnt vmcnt(8)
  s_barrier
  v_mfma_f32_16x16x32_bf16 v[192:195], v[60:63], a[16:19], v[192:195]
  ds_read_b64_tr_b16 v[68:69], v11 offset:20480
  v_mul_f32 v128, v128, v160
  v_mfma_f32_16x16x32_bf16 v[192:195], v[64:67], a[32:35], v[192:195]
  ds_read_b64_tr_b16 v[70:71], v11 offset:22528
  v_mul_f32 v129, v129, v161
  v_mfma_f32_16x16x32_bf16 v[196:199], v[56:59], a[4:7], 0
  ds_read_b64_tr_b16 v[72:73], v13 offset:4096
  v_mul_f32 v130, v130, v162
  v_mfma_f32_16x16x32_bf16 v[196:199], v[60:63], a[20:23], v[196:199]
  ds_read_b64_tr_b16 v[74:75], v13 offset:6144
  v_mul_f32 v131, v131, v163
  v_mfma_f32_16x16x32_bf16 v[196:199], v[64:67], a[36:39], v[196:199]
  ds_read_b64_tr_b16 v[76:77], v11 offset:24576
  v_cvt_pk_bf16_f32 v32, v128, v129
  v_mfma_f32_16x16x32_bf16 v[200:203], v[56:59], a[8:11], 0
  ds_read_b64_tr_b16 v[78:79], v11 offset:26624
  v_cvt_pk_bf16_f32 v33, v130, v131
  v_mfma_f32_16x16x32_bf16 v[200:203], v[60:63], a[24:27], v[200:203]
  s_add_u32 m0, s33, 77824
  v_mul_f32 v144, v144, v176
  v_mfma_f32_16x16x32_bf16 v[200:203], v[64:67], a[40:43], v[200:203]
  s_mov_b32 s34, 1769600
  v_mul_f32 v145, v145, v177
  v_mfma_f32_16x16x32_bf16 v[204:207], v[56:59], a[12:15], 0
  buffer_load_dwordx4 v19, s[8:11], s34 offen lds
  v_mul_f32 v146, v146, v178
  v_mfma_f32_16x16x32_bf16 v[204:207], v[60:63], a[28:31], v[204:207]
  s_add_u32 m0, s33, 0
  v_mul_f32 v147, v147, v179
  v_mfma_f32_16x16x32_bf16 v[204:207], v[64:67], a[44:47], v[204:207]
  s_mov_b32 s34, 2064512
  buffer_load_dwordx4 v19, s[8:11], s34 offen lds
  s_waitcnt lgkmcnt(0)
  v_mfma_f32_16x16x32_bf16 v[208:211], v[68:71], a[0:3], 0
  ds_read_b64_tr_b16 v[56:57], v8 offset:28672
  v_cvt_pk_bf16_f32 v34, v144, v145
  v_mfma_f32_16x16x32_bf16 v[208:211], v[72:75], a[16:19], v[208:211]
  ds_read_b64_tr_b16 v[58:59], v8 offset:30720
  v_cvt_pk_bf16_f32 v35, v146, v147
  v_mfma_f32_16x16x32_bf16 v[208:211], v[76:79], a[32:35], v[208:211]
  ds_read_b64_tr_b16 v[60:61], v8 offset:32768
  ds_write_b128 v17, v[32:35]
  v_mfma_f32_16x16x32_bf16 v[212:215], v[68:71], a[4:7], 0
  ds_read_b64_tr_b16 v[62:63], v8 offset:34816
  s_mov_b32 s61, 0
  v_mfma_f32_16x16x32_bf16 v[212:215], v[72:75], a[20:23], v[212:215]
  ds_read_b64_tr_b16 v[64:65], v8 offset:36864
  buffer_store_dwordx4 v[32:35], v80, s[28:31], s61 offen sc1
  v_mfma_f32_16x16x32_bf16 v[212:215], v[76:79], a[36:39], v[212:215]
  ds_read_b64_tr_b16 v[66:67], v8 offset:38912
  v_mul_f32 v132, v132, v164
  v_mfma_f32_16x16x32_bf16 v[216:219], v[68:71], a[8:11], 0
  s_add_u32 m0, s33, 4096
  v_mul_f32 v133, v133, v165
  v_mfma_f32_16x16x32_bf16 v[216:219], v[72:75], a[24:27], v[216:219]
  s_mov_b32 s34, 2359424
  v_mul_f32 v134, v134, v166
  v_mfma_f32_16x16x32_bf16 v[216:219], v[76:79], a[40:43], v[216:219]
  buffer_load_dwordx4 v19, s[8:11], s34 offen lds
  v_mul_f32 v135, v135, v167
  v_mfma_f32_16x16x32_bf16 v[220:223], v[68:71], a[12:15], 0
  s_add_u32 m0, s33, 81920
  v_cvt_pk_bf16_f32 v36, v132, v133
  v_mfma_f32_16x16x32_bf16 v[220:223], v[72:75], a[28:31], v[220:223]
  s_mov_b32 s34, 2654336
  v_cvt_pk_bf16_f32 v37, v134, v135
  v_mfma_f32_16x16x32_bf16 v[220:223], v[76:79], a[44:47], v[220:223]
  buffer_load_dwordx4 v19, s[4:7], s34 offen lds
  s_waitcnt lgkmcnt(0)
  v_mfma_f32_16x16x32_bf16 v[224:227], v[56:59], a[0:3], 0
  ds_read_b64_tr_b16 v[68:69], v11 offset:28672
  v_mul_f32 v148, v148, v180
  v_mfma_f32_16x16x32_bf16 v[224:227], v[60:63], a[16:19], v[224:227]
  ds_read_b64_tr_b16 v[70:71], v11 offset:30720
  v_mul_f32 v149, v149, v181
  v_mfma_f32_16x16x32_bf16 v[224:227], v[64:67], a[32:35], v[224:227]
  ds_read_b64_tr_b16 v[72:73], v11 offset:32768
  v_mul_f32 v150, v150, v182
  v_mfma_f32_16x16x32_bf16 v[228:231], v[56:59], a[4:7], 0
  ds_read_b64_tr_b16 v[74:75], v11 offset:34816
  v_mul_f32 v151, v151, v183
  v_mfma_f32_16x16x32_bf16 v[228:231], v[60:63], a[20:23], v[228:231]
  ds_read_b64_tr_b16 v[76:77], v11 offset:36864
  v_cvt_pk_bf16_f32 v38, v148, v149
  v_mfma_f32_16x16x32_bf16 v[228:231], v[64:67], a[36:39], v[228:231]
  ds_read_b64_tr_b16 v[78:79], v11 offset:38912
  v_cvt_pk_bf16_f32 v39, v150, v151
  v_mfma_f32_16x16x32_bf16 v[232:235], v[56:59], a[8:11], 0
  s_add_u32 m0, s33, 86016
  ds_write_b128 v17, v[36:39] offset:1024
  v_mfma_f32_16x16x32_bf16 v[232:235], v[60:63], a[24:27], v[232:235]
  s_mov_b32 s34, 2949248
  s_mov_b32 s61, 1024
  v_mfma_f32_16x16x32_bf16 v[232:235], v[64:67], a[40:43], v[232:235]
  buffer_load_dwordx4 v19, s[4:7], s34 offen lds
  buffer_store_dwordx4 v[36:39], v80, s[28:31], s61 offen sc1
  v_mfma_f32_16x16x32_bf16 v[236:239], v[56:59], a[12:15], 0
  s_add_u32 m0, s33, 139264
  v_mul_f32 v136, v136, v168
  v_mfma_f32_16x16x32_bf16 v[236:239], v[60:63], a[28:31], v[236:239]
  s_mov_b32 s34, 3244160
  v_mul_f32 v137, v137, v169
  v_mfma_f32_16x16x32_bf16 v[236:239], v[64:67], a[44:47], v[236:239]
  buffer_load_dwordx4 v19, s[4:7], s34 offen lds
  s_waitcnt lgkmcnt(1)
  v_mfma_f32_16x16x32_bf16 v[240:243], v[68:71], a[0:3], 0
  ds_read_b64_tr_b16 v[56:57], v8 offset:40960
  v_mul_f32 v138, v138, v170
  v_mfma_f32_16x16x32_bf16 v[240:243], v[72:75], a[16:19], v[240:243]
  ds_read_b64_tr_b16 v[58:59], v8 offset:43008
  v_mul_f32 v139, v139, v171
  v_mfma_f32_16x16x32_bf16 v[240:243], v[76:79], a[32:35], v[240:243]
  ds_read_b64_tr_b16 v[60:61], v8 offset:45056
  v_cvt_pk_bf16_f32 v32, v136, v137
  v_mfma_f32_16x16x32_bf16 v[244:247], v[68:71], a[4:7], 0
  ds_read_b64_tr_b16 v[62:63], v8 offset:47104
  v_cvt_pk_bf16_f32 v33, v138, v139
  v_mfma_f32_16x16x32_bf16 v[244:247], v[72:75], a[20:23], v[244:247]
  ds_read_b64_tr_b16 v[64:65], v8 offset:49152
  v_mul_f32 v152, v152, v184
  v_mfma_f32_16x16x32_bf16 v[244:247], v[76:79], a[36:39], v[244:247]
  ds_read_b64_tr_b16 v[66:67], v8 offset:51200
  v_mul_f32 v153, v153, v185
  v_mfma_f32_16x16x32_bf16 v[248:251], v[68:71], a[8:11], 0
  s_add_u32 m0, s33, 143360
  v_mul_f32 v154, v154, v186
  v_mfma_f32_16x16x32_bf16 v[248:251], v[72:75], a[24:27], v[248:251]
  s_mov_b32 s34, 2654336
  v_mul_f32 v155, v155, v187
  v_mfma_f32_16x16x32_bf16 v[248:251], v[76:79], a[40:43], v[248:251]
  buffer_load_dwordx4 v19, s[8:11], s34 offen lds
  v_cvt_pk_bf16_f32 v34, v152, v153
  v_mfma_f32_16x16x32_bf16 v[252:255], v[68:71], a[12:15], 0
  s_add_u32 m0, s33, 98304
  v_cvt_pk_bf16_f32 v35, v154, v155
  v_mfma_f32_16x16x32_bf16 v[252:255], v[72:75], a[28:31], v[252:255]
  s_mov_b32 s34, 2949248
  ds_write_b128 v17, v[32:35] offset:2048
  v_mfma_f32_16x16x32_bf16 v[252:255], v[76:79], a[44:47], v[252:255]
  buffer_load_dwordx4 v19, s[8:11], s34 offen lds
  s_waitcnt lgkmcnt(1)
  v_mfma_f32_16x16x32_bf16 v[192:195], v[56:59], a[48:51], v[192:195]
  s_waitcnt vmcnt(12)
  s_barrier
  v_mfma_f32_16x16x32_bf16 v[192:195], v[60:63], a[64:67], v[192:195]
  ds_read_b64_tr_b16 v[68:69], v11 offset:40960
  s_mov_b32 s61, 2048
  v_mfma_f32_16x16x32_bf16 v[192:195], v[64:67], a[80:83], v[192:195]
  ds_read_b64_tr_b16 v[70:71], v11 offset:43008
  buffer_store_dwordx4 v[32:35], v80, s[28:31], s61 offen sc1
  v_mfma_f32_16x16x32_bf16 v[196:199], v[56:59], a[52:55], v[196:199]
  ds_read_b64_tr_b16 v[72:73], v11 offset:45056
  v_mul_f32 v140, v140, v172
  v_mfma_f32_16x16x32_bf16 v[196:199], v[60:63], a[68:71], v[196:199]
  ds_read_b64_tr_b16 v[74:75], v11 offset:47104
  v_mul_f32 v141, v141, v173
  v_mfma_f32_16x16x32_bf16 v[196:199], v[64:67], a[84:87], v[196:199]
  ds_read_b64_tr_b16 v[76:77], v11 offset:49152
  v_mul_f32 v142, v142, v174
  v_mfma_f32_16x16x32_bf16 v[200:203], v[56:59], a[56:59], v[200:203]
  ds_read_b64_tr_b16 v[78:79], v11 offset:51200
  v_mul_f32 v143, v143, v175
  v_mfma_f32_16x16x32_bf16 v[200:203], v[60:63], a[72:75], v[200:203]
  s_add_u32 m0, s33, 147456
  v_cvt_pk_bf16_f32 v36, v140, v141
  v_mfma_f32_16x16x32_bf16 v[200:203], v[64:67], a[88:91], v[200:203]
  s_mov_b32 s34, 3244160
  v_cvt_pk_bf16_f32 v37, v142, v143
  v_mfma_f32_16x16x32_bf16 v[204:207], v[56:59], a[60:63], v[204:207]
  buffer_load_dwordx4 v19, s[8:11], s34 offen lds
  v_mul_f32 v156, v156, v188
  v_mfma_f32_16x16x32_bf16 v[204:207], v[60:63], a[76:79], v[204:207]
  s_add_u32 m0, s33, 151552
  v_mul_f32 v157, v157, v189
  v_mfma_f32_16x16x32_bf16 v[204:207], v[64:67], a[92:95], v[204:207]
  s_mov_b32 s34, 3539072
  buffer_load_dwordx4 v19, s[4:7], s34 offen lds
  s_waitcnt lgkmcnt(0)
  v_mfma_f32_16x16x32_bf16 v[208:211], v[68:71], a[48:51], v[208:211]
  ds_read_b64_tr_b16 v[56:57], v8 offset:53248
  v_mul_f32 v158, v158, v190
  v_mfma_f32_16x16x32_bf16 v[208:211], v[72:75], a[64:67], v[208:211]
  ds_read_b64_tr_b16 v[58:59], v8 offset:55296
  v_mul_f32 v159, v159, v191
  v_mfma_f32_16x16x32_bf16 v[208:211], v[76:79], a[80:83], v[208:211]
  ds_read_b64_tr_b16 v[60:61], v8 offset:57344
  v_cvt_pk_bf16_f32 v38, v156, v157
  v_mfma_f32_16x16x32_bf16 v[212:215], v[68:71], a[52:55], v[212:215]
  ds_read_b64_tr_b16 v[62:63], v8 offset:59392
  v_cvt_pk_bf16_f32 v39, v158, v159
  v_mfma_f32_16x16x32_bf16 v[212:215], v[72:75], a[68:71], v[212:215]
  ds_read_b64_tr_b16 v[64:65], v8 offset:61440
  ds_write_b128 v17, v[36:39] offset:3072
  v_mfma_f32_16x16x32_bf16 v[212:215], v[76:79], a[84:87], v[212:215]
  ds_read_b64_tr_b16 v[66:67], v8 offset:63488
  s_mov_b32 s61, 3072
  v_mfma_f32_16x16x32_bf16 v[216:219], v[68:71], a[56:59], v[216:219]
  s_add_u32 m0, s33, 102400
  buffer_store_dwordx4 v[36:39], v80, s[28:31], s61 offen sc1
  v_mfma_f32_16x16x32_bf16 v[216:219], v[72:75], a[72:75], v[216:219]
  s_mov_b32 s34, 3833984
  v_mfma_f32_16x16x32_bf16 v[216:219], v[76:79], a[88:91], v[216:219]
  buffer_load_dwordx4 v19, s[4:7], s34 offen lds
  v_mfma_f32_16x16x32_bf16 v[220:223], v[68:71], a[60:63], v[220:223]
  s_add_u32 m0, s33, 106496
  v_mfma_f32_16x16x32_bf16 v[220:223], v[72:75], a[76:79], v[220:223]
  s_mov_b32 s34, 4128896
  v_mfma_f32_16x16x32_bf16 v[220:223], v[76:79], a[92:95], v[220:223]
  buffer_load_dwordx4 v19, s[4:7], s34 offen lds
  s_waitcnt lgkmcnt(0)
  v_mfma_f32_16x16x32_bf16 v[224:227], v[56:59], a[48:51], v[224:227]
  ds_read_b64_tr_b16 v[68:69], v11 offset:53248
  v_mfma_f32_16x16x32_bf16 v[224:227], v[60:63], a[64:67], v[224:227]
  ds_read_b64_tr_b16 v[70:71], v11 offset:55296
  v_mfma_f32_16x16x32_bf16 v[224:227], v[64:67], a[80:83], v[224:227]
  ds_read_b64_tr_b16 v[72:73], v11 offset:57344
  v_mfma_f32_16x16x32_bf16 v[228:231], v[56:59], a[52:55], v[228:231]
  ds_read_b64_tr_b16 v[74:75], v11 offset:59392
  v_mfma_f32_16x16x32_bf16 v[228:231], v[60:63], a[68:71], v[228:231]
  ds_read_b64_tr_b16 v[76:77], v11 offset:61440
  v_mfma_f32_16x16x32_bf16 v[228:231], v[64:67], a[84:87], v[228:231]
  ds_read_b64_tr_b16 v[78:79], v11 offset:63488
  v_mfma_f32_16x16x32_bf16 v[232:235], v[56:59], a[56:59], v[232:235]
  s_add_u32 m0, s33, 110592
  v_mfma_f32_16x16x32_bf16 v[232:235], v[60:63], a[72:75], v[232:235]
  s_mov_b32 s34, 3539072
  v_mfma_f32_16x16x32_bf16 v[232:235], v[64:67], a[88:91], v[232:235]
  buffer_load_dwordx4 v19, s[8:11], s34 offen lds
  v_mfma_f32_16x16x32_bf16 v[236:239], v[56:59], a[60:63], v[236:239]
  s_add_u32 m0, s33, 155648
  v_mfma_f32_16x16x32_bf16 v[236:239], v[60:63], a[76:79], v[236:239]
  s_mov_b32 s34, 3833984
  v_mfma_f32_16x16x32_bf16 v[236:239], v[64:67], a[92:95], v[236:239]
  buffer_load_dwordx4 v19, s[8:11], s34 offen lds
  s_waitcnt lgkmcnt(0)
  v_mfma_f32_16x16x32_bf16 v[240:243], v[68:71], a[48:51], v[240:243]
  ds_read_b64_tr_b16 v[56:57], v9
  v_mfma_f32_16x16x32_bf16 v[240:243], v[72:75], a[64:67], v[240:243]
  ds_read_b64_tr_b16 v[58:59], v9 offset:2048
  v_mfma_f32_16x16x32_bf16 v[240:243], v[76:79], a[80:83], v[240:243]
  ds_read_b64_tr_b16 v[60:61], v9 offset:4096
  v_mfma_f32_16x16x32_bf16 v[244:247], v[68:71], a[52:55], v[244:247]
  ds_read_b64_tr_b16 v[62:63], v9 offset:6144
  v_mfma_f32_16x16x32_bf16 v[244:247], v[72:75], a[68:71], v[244:247]
  ds_read_b64_tr_b16 v[64:65], v9 offset:8192
  v_mfma_f32_16x16x32_bf16 v[244:247], v[76:79], a[84:87], v[244:247]
  ds_read_b64_tr_b16 v[66:67], v9 offset:10240
  v_mfma_f32_16x16x32_bf16 v[248:251], v[68:71], a[56:59], v[248:251]
  s_add_u32 m0, s33, 159744
  v_mfma_f32_16x16x32_bf16 v[248:251], v[72:75], a[72:75], v[248:251]
  s_mov_b32 s34, 4128896
  v_mfma_f32_16x16x32_bf16 v[248:251], v[76:79], a[88:91], v[248:251]
  buffer_load_dwordx4 v19, s[8:11], s34 offen lds
  v_mfma_f32_16x16x32_bf16 v[252:255], v[68:71], a[60:63], v[252:255]
  s_add_u32 m0, s33, 8192
  v_mfma_f32_16x16x32_bf16 v[252:255], v[72:75], a[76:79], v[252:255]
  s_mov_b32 s34, 4423808
  v_mfma_f32_16x16x32_bf16 v[252:255], v[76:79], a[92:95], v[252:255]
  buffer_load_dwordx4 v19, s[4:7], s34 offen lds
  s_waitcnt lgkmcnt(0)
  v_mfma_f32_16x16x32_bf16 v[192:195], v[56:59], a[96:99], v[192:195]
  s_waitcnt vmcnt(12)
  s_barrier
  v_mfma_f32_16x16x32_bf16 v[192:195], v[60:63], a[112:115], v[192:195]
  ds_read_b64_tr_b16 v[68:69], v12
  v_mfma_f32_16x16x32_bf16 v[192:195], v[64:67], a[128:131], v[192:195]
  ds_read_b64_tr_b16 v[70:71], v12 offset:2048
  v_mfma_f32_16x16x32_bf16 v[196:199], v[56:59], a[100:103], v[196:199]
  ds_read_b64_tr_b16 v[72:73], v12 offset:4096
  v_mfma_f32_16x16x32_bf16 v[196:199], v[60:63], a[116:119], v[196:199]
  ds_read_b64_tr_b16 v[74:75], v12 offset:6144
  v_mfma_f32_16x16x32_bf16 v[196:199], v[64:67], a[132:135], v[196:199]
  ds_read_b64_tr_b16 v[76:77], v12 offset:8192
  v_mfma_f32_16x16x32_bf16 v[200:203], v[56:59], a[104:107], v[200:203]
  ds_read_b64_tr_b16 v[78:79], v12 offset:10240
  v_mfma_f32_16x16x32_bf16 v[200:203], v[60:63], a[120:123], v[200:203]
  s_add_u32 m0, s33, 12288
  v_mfma_f32_16x16x32_bf16 v[200:203], v[64:67], a[136:139], v[200:203]
  s_mov_b32 s34, 4718720
  v_mfma_f32_16x16x32_bf16 v[204:207], v[56:59], a[108:111], v[204:207]
  buffer_load_dwordx4 v19, s[4:7], s34 offen lds
  v_mfma_f32_16x16x32_bf16 v[204:207], v[60:63], a[124:127], v[204:207]
  s_add_u32 m0, s33, 114688
  v_mfma_f32_16x16x32_bf16 v[204:207], v[64:67], a[140:143], v[204:207]
  s_mov_b32 s34, 5013632
  buffer_load_dwordx4 v19, s[4:7], s34 offen lds
  s_waitcnt lgkmcnt(0)
  v_mfma_f32_16x16x32_bf16 v[208:211], v[68:71], a[96:99], v[208:211]
  ds_read_b64_tr_b16 v[56:57], v9 offset:12288
  v_mfma_f32_16x16x32_bf16 v[208:211], v[72:75], a[112:115], v[208:211]
  ds_read_b64_tr_b16 v[58:59], v9 offset:14336
  v_mfma_f32_16x16x32_bf16 v[208:211], v[76:79], a[128:131], v[208:211]
  ds_read_b64_tr_b16 v[60:61], v8
  v_mfma_f32_16x16x32_bf16 v[212:215], v[68:71], a[100:103], v[212:215]
  ds_read_b64_tr_b16 v[62:63], v8 offset:2048
  v_mfma_f32_16x16x32_bf16 v[212:215], v[72:75], a[116:119], v[212:215]
  ds_read_b64_tr_b16 v[64:65], v8 offset:4096
  v_mfma_f32_16x16x32_bf16 v[212:215], v[76:79], a[132:135], v[212:215]
  ds_read_b64_tr_b16 v[66:67], v8 offset:6144
  v_mfma_f32_16x16x32_bf16 v[216:219], v[68:71], a[104:107], v[216:219]
  s_add_u32 m0, s33, 118784
  v_mfma_f32_16x16x32_bf16 v[216:219], v[72:75], a[120:123], v[216:219]
  s_mov_b32 s34, 4423808
  v_mfma_f32_16x16x32_bf16 v[216:219], v[76:79], a[136:139], v[216:219]
  buffer_load_dwordx4 v19, s[8:11], s34 offen lds
  v_mfma_f32_16x16x32_bf16 v[220:223], v[68:71], a[108:111], v[220:223]
  s_add_u32 m0, s33, 122880
  v_mfma_f32_16x16x32_bf16 v[220:223], v[72:75], a[124:127], v[220:223]
  s_mov_b32 s34, 4718720
  v_mfma_f32_16x16x32_bf16 v[220:223], v[76:79], a[140:143], v[220:223]
  buffer_load_dwordx4 v19, s[8:11], s34 offen lds
  s_waitcnt lgkmcnt(0)
  v_mfma_f32_16x16x32_bf16 v[224:227], v[56:59], a[96:99], v[224:227]
  ds_read_b64_tr_b16 v[68:69], v12 offset:12288
  s_and_b32 s65, s94, 1
  v_mfma_f32_16x16x32_bf16 v[224:227], v[60:63], a[112:115], v[224:227]
  ds_read_b64_tr_b16 v[70:71], v12 offset:14336
  s_add_u32 s65, s65, 4
  v_mfma_f32_16x16x32_bf16 v[224:227], v[64:67], a[128:131], v[224:227]
  ds_read_b64_tr_b16 v[72:73], v11
  s_cmp_eq_u32 s65, 5
  s_cselect_b32 s65, 0, s65
  v_mfma_f32_16x16x32_bf16 v[228:231], v[56:59], a[100:103], v[228:231]
  ds_read_b64_tr_b16 v[74:75], v11 offset:2048
  s_lshl_b32 s65, s65, 7
  v_mfma_f32_16x16x32_bf16 v[228:231], v[60:63], a[116:119], v[228:231]
  ds_read_b64_tr_b16 v[76:77], v11 offset:4096
  buffer_load_dword v31, v92, s[4:7], s65 offen
  v_mfma_f32_16x16x32_bf16 v[228:231], v[64:67], a[132:135], v[228:231]
  ds_read_b64_tr_b16 v[78:79], v11 offset:6144
  buffer_load_dword v31, v92, s[8:11], s65 offen
  v_mfma_f32_16x16x32_bf16 v[232:235], v[56:59], a[104:107], v[232:235]
  s_add_u32 m0, s33, 16384
  v_mfma_f32_16x16x32_bf16 v[232:235], v[60:63], a[120:123], v[232:235]
  s_mov_b32 s34, 5013632
  v_mfma_f32_16x16x32_bf16 v[232:235], v[64:67], a[136:139], v[232:235]
  buffer_load_dwordx4 v19, s[8:11], s34 offen lds
  v_mfma_f32_16x16x32_bf16 v[236:239], v[56:59], a[108:111], v[236:239]
  s_add_u32 m0, s33, 20480
  v_mfma_f32_16x16x32_bf16 v[236:239], v[60:63], a[124:127], v[236:239]
  s_mov_b32 s34, 256
  v_mfma_f32_16x16x32_bf16 v[236:239], v[64:67], a[140:143], v[236:239]
  buffer_load_dwordx4 v19, s[4:7], s34 offen lds
  s_waitcnt lgkmcnt(0)
  v_mfma_f32_16x16x32_bf16 v[240:243], v[68:71], a[96:99], v[240:243]
  ds_read_b64_tr_b16 v[56:57], v9 offset:16384
  v_mfma_f32_16x16x32_bf16 v[240:243], v[72:75], a[112:115], v[240:243]
  ds_read_b64_tr_b16 v[58:59], v9 offset:18432
  v_mfma_f32_16x16x32_bf16 v[240:243], v[76:79], a[128:131], v[240:243]
  ds_read_b64_tr_b16 v[60:61], v9 offset:20480
  v_mfma_f32_16x16x32_bf16 v[244:247], v[68:71], a[100:103], v[244:247]
  ds_read_b64_tr_b16 v[62:63], v9 offset:22528
  v_mfma_f32_16x16x32_bf16 v[244:247], v[72:75], a[116:119], v[244:247]
  ds_read_b64_tr_b16 v[64:65], v10 offset:8192
  v_mfma_f32_16x16x32_bf16 v[244:247], v[76:79], a[132:135], v[244:247]
  ds_read_b64_tr_b16 v[66:67], v10 offset:10240
  v_mfma_f32_16x16x32_bf16 v[248:251], v[68:71], a[104:107], v[248:251]
  s_add_u32 m0, s33, 24576
  v_mfma_f32_16x16x32_bf16 v[248:251], v[72:75], a[120:123], v[248:251]
  s_mov_b32 s34, 295168
  v_mfma_f32_16x16x32_bf16 v[248:251], v[76:79], a[136:139], v[248:251]
  buffer_load_dwordx4 v19, s[4:7], s34 offen lds
  v_mfma_f32_16x16x32_bf16 v[252:255], v[68:71], a[108:111], v[252:255]
  s_add_u32 m0, s33, 28672
  v_mfma_f32_16x16x32_bf16 v[252:255], v[72:75], a[124:127], v[252:255]
  s_mov_b32 s34, 590080
  v_mfma_f32_16x16x32_bf16 v[252:255], v[76:79], a[140:143], v[252:255]
  buffer_load_dwordx4 v19, s[4:7], s34 offen lds
  s_waitcnt lgkmcnt(0)
  v_mfma_f32_16x16x32_bf16 v[192:195], v[56:59], a[144:147], v[192:195]
  s_waitcnt vmcnt(14)
  s_barrier
  v_mfma_f32_16x16x32_bf16 v[192:195], v[60:63], a[160:163], v[192:195]
  ds_read_b64_tr_b16 v[68:69], v12 offset:16384
  s_and_b32 s36, s94, 1
  v_mfma_f32_16x16x32_bf16 v[192:195], v[64:67], a[176:179], v[192:195]
  ds_read_b64_tr_b16 v[70:71], v12 offset:18432
  s_lshr_b32 s37, s94, 1
  v_mfma_f32_16x16x32_bf16 v[196:199], v[56:59], a[148:151], v[196:199]
  ds_read_b64_tr_b16 v[72:73], v12 offset:20480
  s_mul_i32 s37, s37, 663552
  v_mfma_f32_16x16x32_bf16 v[196:199], v[60:63], a[164:167], v[196:199]
  ds_read_b64_tr_b16 v[74:75], v12 offset:22528
  s_lshr_b32 s39, s92, 1
  v_mfma_f32_16x16x32_bf16 v[196:199], v[64:67], a[180:183], v[196:199]
  ds_read_b64_tr_b16 v[76:77], v13 offset:8192
  s_and_b32 s40, s92, 1
  v_mfma_f32_16x16x32_bf16 v[200:203], v[56:59], a[152:155], v[200:203]
  ds_read_b64_tr_b16 v[78:79], v13 offset:10240
  s_mul_i32 s38, s36, 640
  v_mfma_f32_16x16x32_bf16 v[200:203], v[60:63], a[168:171], v[200:203]
  s_add_u32 m0, s33, 32768
  s_add_u32 s38, s38, s37
  v_mfma_f32_16x16x32_bf16 v[200:203], v[64:67], a[184:187], v[200:203]
  s_mov_b32 s34, 256
  v_add_u32 v4, s38, v21
  v_mfma_f32_16x16x32_bf16 v[204:207], v[56:59], a[156:159], v[204:207]
  buffer_load_dwordx4 v19, s[8:11], s34 offen lds
  s_mul_i32 s38, s36, 368640
  v_mfma_f32_16x16x32_bf16 v[204:207], v[60:63], a[172:175], v[204:207]
  s_add_u32 m0, s33, 36864
  v_add_u32 v82, s38, v4
  v_mfma_f32_16x16x32_bf16 v[204:207], v[64:67], a[188:191], v[204:207]
  s_mov_b32 s34, 295168
  buffer_load_dwordx4 v19, s[8:11], s34 offen lds
  s_waitcnt lgkmcnt(0)
  v_mfma_f32_16x16x32_bf16 v[208:211], v[68:71], a[144:147], v[208:211]
  ds_read_b64_tr_b16 v[56:57], v10 offset:12288
  v_add_u32 v82, 0, v82
  v_mfma_f32_16x16x32_bf16 v[208:211], v[72:75], a[160:163], v[208:211]
  ds_read_b64_tr_b16 v[58:59], v10 offset:14336
  s_mul_i32 s38, s36, 36864
  v_mfma_f32_16x16x32_bf16 v[208:211], v[76:79], a[176:179], v[208:211]
  ds_read_b64_tr_b16 v[60:61], v9 offset:32768
  v_add_u32 v83, s38, v4
  v_mfma_f32_16x16x32_bf16 v[212:215], v[68:71], a[148:151], v[212:215]
  ds_read_b64_tr_b16 v[62:63], v9 offset:34816
  v_add_u32 v83, 294912, v83
  v_mfma_f32_16x16x32_bf16 v[212:215], v[72:75], a[164:167], v[212:215]
  ds_read_b64_tr_b16 v[64:65], v10 offset:16384
  s_mul_i32 s38, s36, -368640
  v_mfma_f32_16x16x32_bf16 v[212:215], v[76:79], a[180:183], v[212:215]
  ds_read_b64_tr_b16 v[66:67], v10 offset:18432
  v_add_u32 v84, s38, v4
  v_mfma_f32_16x16x32_bf16 v[216:219], v[68:71], a[152:155], v[216:219]
  s_add_u32 m0, s33, 40960
  v_add_u32 v84, 368640, v84
  v_mfma_f32_16x16x32_bf16 v[216:219], v[72:75], a[168:171], v[216:219]
  s_mov_b32 s34, 590080
  s_mul_i32 s38, s36, -36864
  v_mfma_f32_16x16x32_bf16 v[216:219], v[76:79], a[184:187], v[216:219]
  buffer_load_dwordx4 v19, s[8:11], s34 offen lds
  v_add_u32 v85, s38, v4
  v_mfma_f32_16x16x32_bf16 v[220:223], v[68:71], a[156:159], v[220:223]
  s_add_u32 m0, s33, 45056
  v_add_u32 v85, 331776, v85
  v_mfma_f32_16x16x32_bf16 v[220:223], v[72:75], a[172:175], v[220:223]
  s_mov_b32 s34, 884992
  v_and_b32 v1, 63, v0
  v_mfma_f32_16x16x32_bf16 v[220:223], v[76:79], a[188:191], v[220:223]
  buffer_load_dwordx4 v19, s[4:7], s34 offen lds
  s_waitcnt lgkmcnt(0)
  v_mfma_f32_16x16x32_bf16 v[224:227], v[56:59], a[144:147], v[224:227]
  ds_read_b64_tr_b16 v[68:69], v13 offset:12288
  v_bfe_u32 v4, v1, 1, 1
  v_mfma_f32_16x16x32_bf16 v[224:227], v[60:63], a[160:163], v[224:227]
  ds_read_b64_tr_b16 v[70:71], v13 offset:14336
  v_bfe_u32 v5, v1, 4, 1
  v_mfma_f32_16x16x32_bf16 v[224:227], v[64:67], a[176:179], v[224:227]
  ds_read_b64_tr_b16 v[72:73], v12 offset:32768
  v_xor_b32 v4, v4, v5
  v_mfma_f32_16x16x32_bf16 v[228:231], v[56:59], a[148:151], v[228:231]
  ds_read_b64_tr_b16 v[74:75], v12 offset:34816
  v_lshlrev_b32 v4, 5, v4
  v_mfma_f32_16x16x32_bf16 v[228:231], v[60:63], a[164:167], v[228:231]
  ds_read_b64_tr_b16 v[76:77], v13 offset:16384
  v_and_b32 v5, 1, v1
  v_mfma_f32_16x16x32_bf16 v[228:231], v[64:67], a[180:183], v[228:231]
  ds_read_b64_tr_b16 v[78:79], v13 offset:18432
  v_lshl_add_u32 v4, v5, 4, v4
  v_mfma_f32_16x16x32_bf16 v[232:235], v[56:59], a[152:155], v[232:235]
  s_add_u32 m0, s33, 49152
  v_lshrrev_b32 v5, 2, v1
  v_mfma_f32_16x16x32_bf16 v[232:235], v[60:63], a[168:171], v[232:235]
  s_mov_b32 s34, 1179904
  s_lshl_b32 s38, s40, 4
  v_mfma_f32_16x16x32_bf16 v[232:235], v[64:67], a[184:187], v[232:235]
  buffer_load_dwordx4 v19, s[4:7], s34 offen lds
  v_add_u32 v5, s38, v5
  v_mfma_f32_16x16x32_bf16 v[236:239], v[56:59], a[156:159], v[236:239]
  s_add_u32 m0, s33, 53248
  v_mul_u32_u24 v5, 1152, v5
  v_mfma_f32_16x16x32_bf16 v[236:239], v[60:63], a[172:175], v[236:239]
  s_mov_b32 s34, 1474816
  s_lshl_b32 s38, s36, 6
  v_mfma_f32_16x16x32_bf16 v[236:239], v[64:67], a[188:191], v[236:239]
  buffer_load_dwordx4 v19, s[4:7], s34 offen lds
  s_waitcnt lgkmcnt(0)
  v_mfma_f32_16x16x32_bf16 v[240:243], v[68:71], a[144:147], v[240:243]
  ds_read_b64_tr_b16 v[56:57], v10 offset:20480
  s_add_u32 s38, s38, s37
  v_mfma_f32_16x16x32_bf16 v[240:243], v[72:75], a[160:163], v[240:243]
  ds_read_b64_tr_b16 v[58:59], v10 offset:22528
  s_add_u32 s38, s38, 512
  v_mfma_f32_16x16x32_bf16 v[240:243], v[76:79], a[176:179], v[240:243]
  ds_read_b64_tr_b16 v[60:61], v9 offset:36864
  v_add3_u32 v4, v4, v5, s38
  v_mfma_f32_16x16x32_bf16 v[244:247], v[68:71], a[148:151], v[244:247]
  ds_read_b64_tr_b16 v[62:63], v9 offset:38912
  s_xor_b32 s38, s36, s39
  v_mfma_f32_16x16x32_bf16 v[244:247], v[72:75], a[164:167], v[244:247]
  ds_read_b64_tr_b16 v[64:65], v9 offset:40960
  s_mul_i32 s41, s38, 368640
  v_mfma_f32_16x16x32_bf16 v[244:247], v[76:79], a[180:183], v[244:247]
  ds_read_b64_tr_b16 v[66:67], v9 offset:43008
  v_add_u32 v86, s41, v4
  v_mfma_f32_16x16x32_bf16 v[248:251], v[68:71], a[152:155], v[248:251]
  s_add_u32 m0, s33, 57344
  s_mul_i32 s41, s38, 36864
  v_mfma_f32_16x16x32_bf16 v[248:251], v[72:75], a[168:171], v[248:251]
  s_mov_b32 s34, 884992
  s_add_u32 s41, s41, 294912
  v_mfma_f32_16x16x32_bf16 v[248:251], v[76:79], a[184:187], v[248:251]
  buffer_load_dwordx4 v19, s[8:11], s34 offen lds
  v_add_u32 v87, s41, v4
  v_mfma_f32_16x16x32_bf16 v[252:255], v[68:71], a[156:159], v[252:255]
  s_add_u32 m0, s33, 61440
  s_mul_i32 s38, s39, 36864
  v_mfma_f32_16x16x32_bf16 v[252:255], v[72:75], a[172:175], v[252:255]
  s_mov_b32 s34, 1179904
  v_add_u32 v89, s38, v24
  v_mfma_f32_16x16x32_bf16 v[252:255], v[76:79], a[188:191], v[252:255]
  buffer_load_dwordx4 v19, s[8:11], s34 offen lds
  s_waitcnt lgkmcnt(0)
  v_mfma_f32_16x16x32_bf16 v[192:195], v[56:59], a[192:195], v[192:195]
  s_waitcnt vmcnt(16)
  s_barrier
  v_mfma_f32_16x16x32_bf16 v[192:195], v[60:63], a[208:211], v[192:195]
  ds_read_b64_tr_b16 v[68:69], v13 offset:20480
  v_lshlrev_b32 v4, 3, v1
  v_mfma_f32_16x16x32_bf16 v[192:195], v[64:67], a[224:227], v[192:195]
  ds_read_b64_tr_b16 v[70:71], v13 offset:22528
  v_add_u32 v90, s38, v4
  v_mfma_f32_16x16x32_bf16 v[196:199], v[56:59], a[196:199], v[196:199]
  ds_read_b64_tr_b16 v[72:73], v12 offset:36864
  s_lshl_b32 s41, s40, 10
  v_mfma_f32_16x16x32_bf16 v[196:199], v[60:63], a[212:215], v[196:199]
  ds_read_b64_tr_b16 v[74:75], v12 offset:38912
  v_add_u32 v88, s41, v89
  v_mfma_f32_16x16x32_bf16 v[196:199], v[64:67], a[228:231], v[196:199]
  ds_read_b64_tr_b16 v[76:77], v12 offset:40960
  s_xor_b32 s38, s94, 1
  v_mfma_f32_16x16x32_bf16 v[200:203], v[56:59], a[200:203], v[200:203]
  ds_read_b64_tr_b16 v[78:79], v12 offset:43008
  s_lshl_b32 s41, s93, 4
  v_mfma_f32_16x16x32_bf16 v[200:203], v[60:63], a[216:219], v[200:203]
  s_add_u32 m0, s33, 65536
  s_add_u32 s41, s41, s38
  v_mfma_f32_16x16x32_bf16 v[200:203], v[64:67], a[232:235], v[200:203]
  s_mov_b32 s34, 1474816
  v_and_b32 v91, 0xffffff84, v30
  v_mfma_f32_16x16x32_bf16 v[204:207], v[56:59], a[204:207], v[204:207]
  buffer_load_dwordx4 v19, s[8:11], s34 offen lds
  v_xor_b32 v4, 128, v91
  v_mfma_f32_16x16x32_bf16 v[204:207], v[60:63], a[220:223], v[204:207]
  s_add_u32 m0, s33, 69632
  v_mov_b32 v5, 0x7ffffff0
  v_mfma_f32_16x16x32_bf16 v[204:207], v[64:67], a[236:239], v[204:207]
  s_mov_b32 s34, 0
  buffer_load_dwordx4 v20, s[24:27], s34 offen lds
  s_waitcnt lgkmcnt(0)
  v_mfma_f32_16x16x32_bf16 v[208:211], v[68:71], a[192:195], v[208:211]
  ds_read_b64_tr_b16 v[56:57], v9 offset:45056
  v_cmp_gt_u32 vcc, 2, v0
  v_mfma_f32_16x16x32_bf16 v[208:211], v[72:75], a[208:211], v[208:211]
  ds_read_b64_tr_b16 v[58:59], v9 offset:47104
  v_cndmask_b32 v22, v5, v4, vcc
  v_mfma_f32_16x16x32_bf16 v[208:211], v[76:79], a[224:227], v[208:211]
  ds_read_b64_tr_b16 v[60:61], v10 offset:24576
  s_mul_i32 s41, s41, 73728
  v_mfma_f32_16x16x32_bf16 v[212:215], v[68:71], a[196:199], v[212:215]
  ds_read_b64_tr_b16 v[62:63], v10 offset:26624
  s_add_u32 s41, s41, 7774208
  v_mfma_f32_16x16x32_bf16 v[212:215], v[72:75], a[212:215], v[212:215]
  ds_read_b64_tr_b16 v[64:65], v10 offset:28672
  s_add_u32 s68, s90, s41
  s_addc_u32 s69, s91, 0
  v_mfma_f32_16x16x32_bf16 v[212:215], v[76:79], a[228:231], v[212:215]
  ds_read_b64_tr_b16 v[66:67], v10 offset:30720
  s_and_b32 s69, s69, 0xffff
  v_mfma_f32_16x16x32_bf16 v[216:219], v[68:71], a[200:203], v[216:219]
  s_add_u32 m0, s33, 73728
  s_mov_b32 s70, 73728
  v_mfma_f32_16x16x32_bf16 v[216:219], v[72:75], a[216:219], v[216:219]
  s_mov_b32 s34, 294912
  s_mov_b32 s71, 0x20000
  v_mfma_f32_16x16x32_bf16 v[216:219], v[76:79], a[232:235], v[216:219]
  buffer_load_dwordx4 v20, s[24:27], s34 offen lds
  v_mfma_f32_16x16x32_bf16 v[220:223], v[68:71], a[204:207], v[220:223]
  s_add_u32 m0, s33, 77824
  v_mfma_f32_16x16x32_bf16 v[220:223], v[72:75], a[220:223], v[220:223]
  s_mov_b32 s34, 589824
  v_mfma_f32_16x16x32_bf16 v[220:223], v[76:79], a[236:239], v[220:223]
  buffer_load_dwordx4 v20, s[24:27], s34 offen lds
  s_waitcnt lgkmcnt(0)
  v_mfma_f32_16x16x32_bf16 v[224:227], v[56:59], a[192:195], v[224:227]
  ds_read_b64_tr_b16 v[68:69], v12 offset:45056
  v_mfma_f32_16x16x32_bf16 v[224:227], v[60:63], a[208:211], v[224:227]
  ds_read_b64_tr_b16 v[70:71], v12 offset:47104
  v_mfma_f32_16x16x32_bf16 v[224:227], v[64:67], a[224:227], v[224:227]
  ds_read_b64_tr_b16 v[72:73], v13 offset:24576
  v_mfma_f32_16x16x32_bf16 v[228:231], v[56:59], a[196:199], v[228:231]
  ds_read_b64_tr_b16 v[74:75], v13 offset:26624
  v_mfma_f32_16x16x32_bf16 v[228:231], v[60:63], a[212:215], v[228:231]
  ds_read_b64_tr_b16 v[76:77], v13 offset:28672
  v_mfma_f32_16x16x32_bf16 v[228:231], v[64:67], a[228:231], v[228:231]
  ds_read_b64_tr_b16 v[78:79], v13 offset:30720
  v_mfma_f32_16x16x32_bf16 v[232:235], v[56:59], a[200:203], v[232:235]
  s_add_u32 m0, s33, 0
  v_mfma_f32_16x16x32_bf16 v[232:235], v[60:63], a[216:219], v[232:235]
  s_mov_b32 s34, 884736
  v_mfma_f32_16x16x32_bf16 v[232:235], v[64:67], a[232:235], v[232:235]
  buffer_load_dwordx4 v20, s[24:27], s34 offen lds
  v_mfma_f32_16x16x32_bf16 v[236:239], v[56:59], a[204:207], v[236:239]
  s_add_u32 m0, s33, 4096
  v_mfma_f32_16x16x32_bf16 v[236:239], v[60:63], a[220:223], v[236:239]
  s_mov_b32 s34, 1179648
  v_mfma_f32_16x16x32_bf16 v[236:239], v[64:67], a[236:239], v[236:239]
  buffer_load_dwordx4 v20, s[24:27], s34 offen lds
  s_waitcnt lgkmcnt(0)
  v_mfma_f32_16x16x32_bf16 v[240:243], v[68:71], a[192:195], v[240:243]
  ds_read_b64_tr_b16 v[56:57], v8 offset:8192
  v_mfma_f32_16x16x32_bf16 v[240:243], v[72:75], a[208:211], v[240:243]
  ds_read_b64_tr_b16 v[58:59], v8 offset:10240
  v_mfma_f32_16x16x32_bf16 v[240:243], v[76:79], a[224:227], v[240:243]
  ds_read_b64_tr_b16 v[60:61], v8 offset:12288
  v_mfma_f32_16x16x32_bf16 v[244:247], v[68:71], a[196:199], v[244:247]
  ds_read_b64_tr_b16 v[62:63], v8 offset:14336
  v_mfma_f32_16x16x32_bf16 v[244:247], v[72:75], a[212:215], v[244:247]
  ds_read_b64_tr_b16 v[64:65], v9 offset:49152
  v_mfma_f32_16x16x32_bf16 v[244:247], v[76:79], a[228:231], v[244:247]
  ds_read_b64_tr_b16 v[66:67], v9 offset:51200
  v_mfma_f32_16x16x32_bf16 v[248:251], v[68:71], a[200:203], v[248:251]
  s_add_u32 m0, s33, 81920
  v_mfma_f32_16x16x32_bf16 v[248:251], v[72:75], a[216:219], v[248:251]
  s_mov_b32 s34, 1474560
  v_mfma_f32_16x16x32_bf16 v[248:251], v[76:79], a[232:235], v[248:251]
  buffer_load_dwordx4 v20, s[24:27], s34 offen lds
  v_mfma_f32_16x16x32_bf16 v[252:255], v[68:71], a[204:207], v[252:255]
  v_mfma_f32_16x16x32_bf16 v[252:255], v[72:75], a[220:223], v[252:255]
  v_mfma_f32_16x16x32_bf16 v[252:255], v[76:79], a[236:239], v[252:255]
  s_waitcnt lgkmcnt(0)
  v_mfma_f32_16x16x32_bf16 v[192:195], v[56:59], a[240:243], v[192:195]
  s_waitcnt vmcnt(15)
  s_barrier
  v_mfma_f32_16x16x32_bf16 v[192:195], v[60:63], v[96:99], v[192:195]
  ds_read_b64_tr_b16 v[68:69], v11 offset:8192
  s_and_b32 s65, s94, 1
  v_mfma_f32_16x16x32_bf16 v[192:195], v[64:67], v[112:115], v[192:195]
  ds_read_b64_tr_b16 v[70:71], v11 offset:10240
  s_add_u32 s65, s65, 3
  v_mfma_f32_16x16x32_bf16 v[196:199], v[56:59], a[244:247], v[196:199]
  ds_read_b64_tr_b16 v[72:73], v11 offset:12288
  s_cmp_eq_u32 s65, 5
  s_cselect_b32 s65, 0, s65
  v_mfma_f32_16x16x32_bf16 v[196:199], v[60:63], v[100:103], v[196:199]
  ds_read_b64_tr_b16 v[74:75], v11 offset:14336
  s_lshl_b32 s65, s65, 7
  v_mfma_f32_16x16x32_bf16 v[196:199], v[64:67], v[116:119], v[196:199]
  ds_read_b64_tr_b16 v[76:77], v12 offset:49152
  buffer_load_dword v31, v92, s[4:7], s65 offen
  v_mfma_f32_16x16x32_bf16 v[200:203], v[56:59], a[248:251], v[200:203]
  ds_read_b64_tr_b16 v[78:79], v12 offset:51200
  buffer_load_dword v31, v92, s[8:11], s65 offen
  v_mfma_f32_16x16x32_bf16 v[200:203], v[60:63], v[104:107], v[200:203]
  s_add_u32 m0, s33, 86016
  v_mfma_f32_16x16x32_bf16 v[200:203], v[64:67], v[120:123], v[200:203]
  s_mov_b32 s34, 1769472
  v_mfma_f32_16x16x32_bf16 v[204:207], v[56:59], a[252:255], v[204:207]
  buffer_load_dwordx4 v20, s[24:27], s34 offen lds
  v_mfma_f32_16x16x32_bf16 v[204:207], v[60:63], v[108:111], v[204:207]
  s_add_u32 m0, s33, 143360
  v_mfma_f32_16x16x32_bf16 v[204:207], v[64:67], v[124:127], v[204:207]
  s_mov_b32 s34, 2064384
  buffer_load_dwordx4 v20, s[24:27], s34 offen lds
  s_waitcnt lgkmcnt(0)
  v_mfma_f32_16x16x32_bf16 v[208:211], v[68:71], a[240:243], v[208:211]
  ds_read_b64_tr_b16 v[56:57], v9 offset:53248
  v_mfma_f32_16x16x32_bf16 v[208:211], v[72:75], v[96:99], v[208:211]
  ds_read_b64_tr_b16 v[58:59], v9 offset:55296
  v_mfma_f32_16x16x32_bf16 v[208:211], v[76:79], v[112:115], v[208:211]
  ds_read_b64_tr_b16 v[60:61], v9 offset:57344
  v_mfma_f32_16x16x32_bf16 v[212:215], v[68:71], a[244:247], v[212:215]
  ds_read_b64_tr_b16 v[62:63], v9 offset:59392
  v_mfma_f32_16x16x32_bf16 v[212:215], v[72:75], v[100:103], v[212:215]
  ds_read_b64_tr_b16 v[64:65], v8 offset:16384
  v_mfma_f32_16x16x32_bf16 v[212:215], v[76:79], v[116:119], v[212:215]
  ds_read_b64_tr_b16 v[66:67], v8 offset:18432
  v_mfma_f32_16x16x32_bf16 v[216:219], v[68:71], a[248:251], v[216:219]
  s_add_u32 m0, s33, 147456
  v_mfma_f32_16x16x32_bf16 v[216:219], v[72:75], v[104:107], v[216:219]
  s_mov_b32 s34, 2359296
  v_mfma_f32_16x16x32_bf16 v[216:219], v[76:79], v[120:123], v[216:219]
  buffer_load_dwordx4 v20, s[24:27], s34 offen lds
  v_mfma_f32_16x16x32_bf16 v[220:223], v[68:71], a[252:255], v[220:223]
  v_mfma_f32_16x16x32_bf16 v[220:223], v[72:75], v[108:111], v[220:223]
  v_mfma_f32_16x16x32_bf16 v[220:223], v[76:79], v[124:127], v[220:223]
  s_waitcnt lgkmcnt(0)
  v_mfma_f32_16x16x32_bf16 v[224:227], v[56:59], a[240:243], v[224:227]
  ds_read_b64_tr_b16 v[68:69], v12 offset:53248
  v_mfma_f32_16x16x32_bf16 v[224:227], v[60:63], v[96:99], v[224:227]
  ds_read_b64_tr_b16 v[70:71], v12 offset:55296
  v_mfma_f32_16x16x32_bf16 v[224:227], v[64:67], v[112:115], v[224:227]
  ds_read_b64_tr_b16 v[72:73], v12 offset:57344
  v_mfma_f32_16x16x32_bf16 v[228:231], v[56:59], a[244:247], v[228:231]
  ds_read_b64_tr_b16 v[74:75], v12 offset:59392
  v_mfma_f32_16x16x32_bf16 v[228:231], v[60:63], v[100:103], v[228:231]
  ds_read_b64_tr_b16 v[76:77], v11 offset:16384
  v_mfma_f32_16x16x32_bf16 v[228:231], v[64:67], v[116:119], v[228:231]
  ds_read_b64_tr_b16 v[78:79], v11 offset:18432
  v_mfma_f32_16x16x32_bf16 v[232:235], v[56:59], a[248:251], v[232:235]
  s_add_u32 m0, s33, 151552
  v_mfma_f32_16x16x32_bf16 v[232:235], v[60:63], v[104:107], v[232:235]
  s_mov_b32 s34, 1769728
  v_mfma_f32_16x16x32_bf16 v[232:235], v[64:67], v[120:123], v[232:235]
  buffer_load_dwordx4 v19, s[4:7], s34 offen lds
  v_mfma_f32_16x16x32_bf16 v[236:239], v[56:59], a[252:255], v[236:239]
  s_add_u32 m0, s33, 106496
  v_mfma_f32_16x16x32_bf16 v[236:239], v[60:63], v[108:111], v[236:239]
  s_mov_b32 s34, 2064640
  v_mfma_f32_16x16x32_bf16 v[236:239], v[64:67], v[124:127], v[236:239]
  buffer_load_dwordx4 v19, s[4:7], s34 offen lds
  s_waitcnt lgkmcnt(0)
  v_mfma_f32_16x16x32_bf16 v[240:243], v[68:71], a[240:243], v[240:243]
  ds_read_b64_tr_b16 v[56:57], v8 offset:20480
  v_mfma_f32_16x16x32_bf16 v[240:243], v[72:75], v[96:99], v[240:243]
  ds_read_b64_tr_b16 v[58:59], v8 offset:22528
  v_mfma_f32_16x16x32_bf16 v[240:243], v[76:79], v[112:115], v[240:243]
  ds_read_b64_tr_b16 v[60:61], v8 offset:24576
  v_mfma_f32_16x16x32_bf16 v[244:247], v[68:71], a[244:247], v[244:247]
  ds_read_b64_tr_b16 v[62:63], v8 offset:26624
  v_mfma_f32_16x16x32_bf16 v[244:247], v[72:75], v[100:103], v[244:247]
  ds_read_b64_tr_b16 v[64:65], v8 offset:28672
  v_mfma_f32_16x16x32_bf16 v[244:247], v[76:79], v[116:119], v[244:247]
  ds_read_b64_tr_b16 v[66:67], v8 offset:30720
  v_mfma_f32_16x16x32_bf16 v[248:251], v[68:71], a[248:251], v[248:251]
  s_add_u32 m0, s33, 110592
  v_mfma_f32_16x16x32_bf16 v[248:251], v[72:75], v[104:107], v[248:251]
  s_mov_b32 s34, 2359552
  v_mfma_f32_16x16x32_bf16 v[248:251], v[76:79], v[120:123], v[248:251]
  buffer_load_dwordx4 v19, s[4:7], s34 offen lds
  v_mfma_f32_16x16x32_bf16 v[252:255], v[68:71], a[252:255], v[252:255]
  v_mfma_f32_16x16x32_bf16 v[252:255], v[72:75], v[108:111], v[252:255]
  v_mfma_f32_16x16x32_bf16 v[252:255], v[76:79], v[124:127], v[252:255]
  s_waitcnt lgkmcnt(0)
  v_mfma_f32_16x16x32_bf16 v[128:131], v[56:59], a[0:3], 0
  s_waitcnt vmcnt(17)
  s_barrier
  v_mfma_f32_16x16x32_bf16 v[128:131], v[60:63], a[16:19], v[128:131]
  ds_read_b64_tr_b16 v[68:69], v11 offset:20480
  v_mul_f32 v192, v192, v224
  v_mfma_f32_16x16x32_bf16 v[128:131], v[64:67], a[32:35], v[128:131]
  ds_read_b64_tr_b16 v[70:71], v11 offset:22528
  v_mul_f32 v193, v193, v225
  v_mfma_f32_16x16x32_bf16 v[132:135], v[56:59], a[4:7], 0
  ds_read_b64_tr_b16 v[72:73], v11 offset:24576
  v_mul_f32 v194, v194, v226
  v_mfma_f32_16x16x32_bf16 v[132:135], v[60:63], a[20:23], v[132:135]
  ds_read_b64_tr_b16 v[74:75], v11 offset:26624
  v_mul_f32 v195, v195, v227
  v_mfma_f32_16x16x32_bf16 v[132:135], v[64:67], a[36:39], v[132:135]
  ds_read_b64_tr_b16 v[76:77], v11 offset:28672
  v_cvt_pk_bf16_f32 v32, v192, v193
  v_mfma_f32_16x16x32_bf16 v[136:139], v[56:59], a[8:11], 0
  ds_read_b64_tr_b16 v[78:79], v11 offset:30720
  v_cvt_pk_bf16_f32 v33, v194, v195
  v_mfma_f32_16x16x32_bf16 v[136:139], v[60:63], a[24:27], v[136:139]
  s_add_u32 m0, s33, 155648
  v_mul_f32 v208, v208, v240
  v_mfma_f32_16x16x32_bf16 v[136:139], v[64:67], a[40:43], v[136:139]
  s_mov_b32 s34, 1769728
  v_mul_f32 v209, v209, v241
  v_mfma_f32_16x16x32_bf16 v[140:143], v[56:59], a[12:15], 0
  buffer_load_dwordx4 v19, s[8:11], s34 offen lds
  v_mul_f32 v210, v210, v242
  v_mfma_f32_16x16x32_bf16 v[140:143], v[60:63], a[28:31], v[140:143]
  s_add_u32 m0, s33, 159744
  v_mul_f32 v211, v211, v243
  v_mfma_f32_16x16x32_bf16 v[140:143], v[64:67], a[44:47], v[140:143]
  s_mov_b32 s34, 2064640
  buffer_load_dwordx4 v19, s[8:11], s34 offen lds
  s_waitcnt lgkmcnt(0)
  v_mfma_f32_16x16x32_bf16 v[144:147], v[68:71], a[0:3], 0
  ds_read_b64_tr_b16 v[56:57], v8 offset:32768
  v_cvt_pk_bf16_f32 v34, v208, v209
  v_mfma_f32_16x16x32_bf16 v[144:147], v[72:75], a[16:19], v[144:147]
  ds_read_b64_tr_b16 v[58:59], v8 offset:34816
  v_cvt_pk_bf16_f32 v35, v210, v211
  v_mfma_f32_16x16x32_bf16 v[144:147], v[76:79], a[32:35], v[144:147]
  ds_read_b64_tr_b16 v[60:61], v8 offset:36864
  ds_write_b128 v17, v[32:35] offset:8192
  v_mfma_f32_16x16x32_bf16 v[148:151], v[68:71], a[4:7], 0
  ds_read_b64_tr_b16 v[62:63], v8 offset:38912
  s_mov_b32 s61, 8192
  v_mfma_f32_16x16x32_bf16 v[148:151], v[72:75], a[20:23], v[148:151]
  ds_read_b64_tr_b16 v[64:65], v8 offset:40960
  buffer_store_dwordx4 v[32:35], v80, s[28:31], s61 offen sc1
  v_mfma_f32_16x16x32_bf16 v[148:151], v[76:79], a[36:39], v[148:151]
  ds_read_b64_tr_b16 v[66:67], v8 offset:43008
  v_mul_f32 v196, v196, v228
  v_mfma_f32_16x16x32_bf16 v[152:155], v[68:71], a[8:11], 0
  s_add_u32 m0, s33, 8192
  v_mul_f32 v197, v197, v229
  v_mfma_f32_16x16x32_bf16 v[152:155], v[72:75], a[24:27], v[152:155]
  s_mov_b32 s34, 2359552
  v_mul_f32 v198, v198, v230
  v_mfma_f32_16x16x32_bf16 v[152:155], v[76:79], a[40:43], v[152:155]
  buffer_load_dwordx4 v19, s[8:11], s34 offen lds
  v_mul_f32 v199, v199, v231
  v_mfma_f32_16x16x32_bf16 v[156:159], v[68:71], a[12:15], 0
  v_cvt_pk_bf16_f32 v36, v196, v197
  v_cvt_pk_bf16_f32 v37, v198, v199
  v_mfma_f32_16x16x32_bf16 v[156:159], v[72:75], a[28:31], v[156:159]
  v_mul_f32 v212, v212, v244
  v_mul_f32 v213, v213, v245
  v_mfma_f32_16x16x32_bf16 v[156:159], v[76:79], a[44:47], v[156:159]
  v_mul_f32 v214, v214, v246
  s_waitcnt lgkmcnt(0)
  v_mfma_f32_16x16x32_bf16 v[160:163], v[56:59], a[0:3], 0
  ds_read_b64_tr_b16 v[68:69], v11 offset:32768
  v_mul_f32 v215, v215, v247
  v_mfma_f32_16x16x32_bf16 v[160:163], v[60:63], a[16:19], v[160:163]
  ds_read_b64_tr_b16 v[70:71], v11 offset:34816
  v_cvt_pk_bf16_f32 v38, v212, v213
  v_mfma_f32_16x16x32_bf16 v[160:163], v[64:67], a[32:35], v[160:163]
  ds_read_b64_tr_b16 v[72:73], v11 offset:36864
  v_cvt_pk_bf16_f32 v39, v214, v215
  v_mfma_f32_16x16x32_bf16 v[164:167], v[56:59], a[4:7], 0
  ds_read_b64_tr_b16 v[74:75], v11 offset:38912
  ds_write_b128 v17, v[36:39] offset:9216
  v_mfma_f32_16x16x32_bf16 v[164:167], v[60:63], a[20:23], v[164:167]
  ds_read_b64_tr_b16 v[76:77], v11 offset:40960
  s_mov_b32 s61, 9216
  v_mfma_f32_16x16x32_bf16 v[164:167], v[64:67], a[36:39], v[164:167]
  ds_read_b64_tr_b16 v[78:79], v11 offset:43008
  buffer_store_dwordx4 v[36:39], v80, s[28:31], s61 offen sc1
  v_mfma_f32_16x16x32_bf16 v[168:171], v[56:59], a[8:11], 0
  s_add_u32 m0, s33, 12288
  v_mul_f32 v200, v200, v232
  v_mfma_f32_16x16x32_bf16 v[168:171], v[60:63], a[24:27], v[168:171]
  s_mov_b32 s34, 2654208
  v_mul_f32 v201, v201, v233
  v_mfma_f32_16x16x32_bf16 v[168:171], v[64:67], a[40:43], v[168:171]
  buffer_load_dwordx4 v20, s[24:27], s34 offen lds
  v_mul_f32 v202, v202, v234
  v_mfma_f32_16x16x32_bf16 v[172:175], v[56:59], a[12:15], 0
  s_add_u32 m0, s33, 114688
  v_mul_f32 v203, v203, v235
  v_mfma_f32_16x16x32_bf16 v[172:175], v[60:63], a[28:31], v[172:175]
  s_mov_b32 s34, 2949120
  v_cvt_pk_bf16_f32 v32, v200, v201
  v_mfma_f32_16x16x32_bf16 v[172:175], v[64:67], a[44:47], v[172:175]
  buffer_load_dwordx4 v20, s[24:27], s34 offen lds
  s_waitcnt lgkmcnt(0)
  v_mfma_f32_16x16x32_bf16 v[176:179], v[68:71], a[0:3], 0
  ds_read_b64_tr_b16 v[56:57], v8 offset:45056
  v_cvt_pk_bf16_f32 v33, v202, v203
  v_mfma_f32_16x16x32_bf16 v[176:179], v[72:75], a[16:19], v[176:179]
  ds_read_b64_tr_b16 v[58:59], v8 offset:47104
  v_mul_f32 v216, v216, v248
  v_mfma_f32_16x16x32_bf16 v[176:179], v[76:79], a[32:35], v[176:179]
  ds_read_b64_tr_b16 v[60:61], v8 offset:49152
  v_mul_f32 v217, v217, v249
  v_mfma_f32_16x16x32_bf16 v[180:183], v[68:71], a[4:7], 0
  ds_read_b64_tr_b16 v[62:63], v8 offset:51200
  v_mul_f32 v218, v218, v250
  v_mfma_f32_16x16x32_bf16 v[180:183], v[72:75], a[20:23], v[180:183]
  ds_read_b64_tr_b16 v[64:65], v8 offset:53248
  v_mul_f32 v219, v219, v251
  v_mfma_f32_16x16x32_bf16 v[180:183], v[76:79], a[36:39], v[180:183]
  ds_read_b64_tr_b16 v[66:67], v8 offset:55296
  v_cvt_pk_bf16_f32 v34, v216, v217
  v_mfma_f32_16x16x32_bf16 v[184:187], v[68:71], a[8:11], 0
  s_add_u32 m0, s33, 118784
  v_cvt_pk_bf16_f32 v35, v218, v219
  v_mfma_f32_16x16x32_bf16 v[184:187], v[72:75], a[24:27], v[184:187]
  s_mov_b32 s34, 3244032
  ds_write_b128 v17, v[32:35] offset:10240
  v_mfma_f32_16x16x32_bf16 v[184:187], v[76:79], a[40:43], v[184:187]
  buffer_load_dwordx4 v20, s[24:27], s34 offen lds
  s_mov_b32 s61, 10240
  v_mfma_f32_16x16x32_bf16 v[188:191], v[68:71], a[12:15], 0
  buffer_store_dwordx4 v[32:35], v80, s[28:31], s61 offen sc1
  v_mul_f32 v204, v204, v236
  v_mfma_f32_16x16x32_bf16 v[188:191], v[72:75], a[28:31], v[188:191]
  v_mul_f32 v205, v205, v237
  v_mul_f32 v206, v206, v238
  v_mfma_f32_16x16x32_bf16 v[188:191], v[76:79], a[44:47], v[188:191]
  v_mul_f32 v207, v207, v239
  s_waitcnt lgkmcnt(1)
  v_mfma_f32_16x16x32_bf16 v[128:131], v[56:59], a[48:51], v[128:131]
  s_waitcnt vmcnt(20)
  s_barrier
  v_mfma_f32_16x16x32_bf16 v[128:131], v[60:63], a[64:67], v[128:131]
  ds_read_b64_tr_b16 v[68:69], v11 offset:45056
  s_mov_b32 s65, 0
  v_mfma_f32_16x16x32_bf16 v[128:131], v[64:67], a[80:83], v[128:131]
  ds_read_b64_tr_b16 v[70:71], v11 offset:47104
  buffer_load_dword v31, v93, s[12:15], s65 offen
  v_mfma_f32_16x16x32_bf16 v[132:135], v[56:59], a[52:55], v[132:135]
  ds_read_b64_tr_b16 v[72:73], v11 offset:49152
  v_cvt_pk_bf16_f32 v36, v204, v205
  v_mfma_f32_16x16x32_bf16 v[132:135], v[60:63], a[68:71], v[132:135]
  ds_read_b64_tr_b16 v[74:75], v11 offset:51200
  v_cvt_pk_bf16_f32 v37, v206, v207
  v_mfma_f32_16x16x32_bf16 v[132:135], v[64:67], a[84:87], v[132:135]
  ds_read_b64_tr_b16 v[76:77], v11 offset:53248
  v_mul_f32 v220, v220, v252
  v_mfma_f32_16x16x32_bf16 v[136:139], v[56:59], a[56:59], v[136:139]
  ds_read_b64_tr_b16 v[78:79], v11 offset:55296
  v_mul_f32 v221, v221, v253
  v_mfma_f32_16x16x32_bf16 v[136:139], v[60:63], a[72:75], v[136:139]
  s_add_u32 m0, s33, 122880
  v_mul_f32 v222, v222, v254
  v_mfma_f32_16x16x32_bf16 v[136:139], v[64:67], a[88:91], v[136:139]
  s_mov_b32 s34, 3538944
  v_mul_f32 v223, v223, v255
  v_mfma_f32_16x16x32_bf16 v[140:143], v[56:59], a[60:63], v[140:143]
  buffer_load_dwordx4 v20, s[24:27], s34 offen lds
  v_cvt_pk_bf16_f32 v38, v220, v221
  v_mfma_f32_16x16x32_bf16 v[140:143], v[60:63], a[76:79], v[140:143]
  s_add_u32 m0, s33, 16384
  v_cvt_pk_bf16_f32 v39, v222, v223
  v_mfma_f32_16x16x32_bf16 v[140:143], v[64:67], a[92:95], v[140:143]
  s_mov_b32 s34, 3833856
  buffer_load_dwordx4 v20, s[24:27], s34 offen lds
  s_waitcnt lgkmcnt(0)
  v_mfma_f32_16x16x32_bf16 v[144:147], v[68:71], a[48:51], v[144:147]
  ds_read_b64_tr_b16 v[56:57], v8 offset:57344
  ds_write_b128 v17, v[36:39] offset:11264
  v_mfma_f32_16x16x32_bf16 v[144:147], v[72:75], a[64:67], v[144:147]
  ds_read_b64_tr_b16 v[58:59], v8 offset:59392
  s_mov_b32 s61, 11264
  v_mfma_f32_16x16x32_bf16 v[144:147], v[76:79], a[80:83], v[144:147]
  ds_read_b64_tr_b16 v[60:61], v8 offset:61440
  buffer_store_dwordx4 v[36:39], v80, s[28:31], s61 offen sc1
  v_mfma_f32_16x16x32_bf16 v[148:151], v[68:71], a[52:55], v[148:151]
  ds_read_b64_tr_b16 v[62:63], v8 offset:63488
  v_mfma_f32_16x16x32_bf16 v[148:151], v[72:75], a[68:71], v[148:151]
  ds_read_b64_tr_b16 v[64:65], v9
  v_mfma_f32_16x16x32_bf16 v[148:151], v[76:79], a[84:87], v[148:151]
  ds_read_b64_tr_b16 v[66:67], v9 offset:2048
  v_mfma_f32_16x16x32_bf16 v[152:155], v[68:71], a[56:59], v[152:155]
  s_add_u32 m0, s33, 20480
  v_mfma_f32_16x16x32_bf16 v[152:155], v[72:75], a[72:75], v[152:155]
  s_mov_b32 s34, 4128768
  v_mfma_f32_16x16x32_bf16 v[152:155], v[76:79], a[88:91], v[152:155]
  buffer_load_dwordx4 v20, s[24:27], s34 offen lds
  v_mfma_f32_16x16x32_bf16 v[156:159], v[68:71], a[60:63], v[156:159]
  v_mfma_f32_16x16x32_bf16 v[156:159], v[72:75], a[76:79], v[156:159]
  v_mfma_f32_16x16x32_bf16 v[156:159], v[76:79], a[92:95], v[156:159]
  s_waitcnt lgkmcnt(0)
  v_mfma_f32_16x16x32_bf16 v[160:163], v[56:59], a[48:51], v[160:163]
  ds_read_b64_tr_b16 v[68:69], v11 offset:57344
  v_mfma_f32_16x16x32_bf16 v[160:163], v[60:63], a[64:67], v[160:163]
  ds_read_b64_tr_b16 v[70:71], v11 offset:59392
  v_mfma_f32_16x16x32_bf16 v[160:163], v[64:67], a[80:83], v[160:163]
  ds_read_b64_tr_b16 v[72:73], v11 offset:61440
  v_mfma_f32_16x16x32_bf16 v[164:167], v[56:59], a[52:55], v[164:167]
  ds_read_b64_tr_b16 v[74:75], v11 offset:63488
  v_mfma_f32_16x16x32_bf16 v[164:167], v[60:63], a[68:71], v[164:167]
  ds_read_b64_tr_b16 v[76:77], v12
  v_mfma_f32_16x16x32_bf16 v[164:167], v[64:67], a[84:87], v[164:167]
  ds_read_b64_tr_b16 v[78:79], v12 offset:2048
  v_mfma_f32_16x16x32_bf16 v[168:171], v[56:59], a[56:59], v[168:171]
  s_add_u32 m0, s33, 24576
  v_mfma_f32_16x16x32_bf16 v[168:171], v[60:63], a[72:75], v[168:171]
  s_mov_b32 s34, 4423680
  v_mfma_f32_16x16x32_bf16 v[168:171], v[64:67], a[88:91], v[168:171]
  buffer_load_dwordx4 v20, s[24:27], s34 offen lds
  v_mfma_f32_16x16x32_bf16 v[172:175], v[56:59], a[60:63], v[172:175]
  s_add_u32 m0, s33, 28672
  v_mfma_f32_16x16x32_bf16 v[172:175], v[60:63], a[76:79], v[172:175]
  s_mov_b32 s34, 4718592
  v_mfma_f32_16x16x32_bf16 v[172:175], v[64:67], a[92:95], v[172:175]
  buffer_load_dwordx4 v20, s[24:27], s34 offen lds
  s_waitcnt lgkmcnt(0)
  v_mfma_f32_16x16x32_bf16 v[176:179], v[68:71], a[48:51], v[176:179]
  ds_read_b64_tr_b16 v[56:57], v15 offset:4096
  v_mfma_f32_16x16x32_bf16 v[176:179], v[72:75], a[64:67], v[176:179]
  ds_read_b64_tr_b16 v[58:59], v15 offset:5120
  v_mfma_f32_16x16x32_bf16 v[176:179], v[76:79], a[80:83], v[176:179]
  ds_read_b64_tr_b16 v[60:61], v15 offset:8192
  v_mfma_f32_16x16x32_bf16 v[180:183], v[68:71], a[52:55], v[180:183]
  ds_read_b64_tr_b16 v[62:63], v15 offset:9216
  v_mfma_f32_16x16x32_bf16 v[180:183], v[72:75], a[68:71], v[180:183]
  ds_read_b64_tr_b16 v[64:65], v15 offset:12288
  v_mfma_f32_16x16x32_bf16 v[180:183], v[76:79], a[84:87], v[180:183]
  ds_read_b64_tr_b16 v[66:67], v15 offset:13312
  v_mfma_f32_16x16x32_bf16 v[184:187], v[68:71], a[56:59], v[184:187]
  s_add_u32 m0, s33, 32768
  v_mfma_f32_16x16x32_bf16 v[184:187], v[72:75], a[72:75], v[184:187]
  s_mov_b32 s34, 5013504
  v_mfma_f32_16x16x32_bf16 v[184:187], v[76:79], a[88:91], v[184:187]
  buffer_load_dwordx4 v20, s[24:27], s34 offen lds
  v_mfma_f32_16x16x32_bf16 v[188:191], v[68:71], a[60:63], v[188:191]
  v_mfma_f32_16x16x32_bf16 v[188:191], v[72:75], a[76:79], v[188:191]
  v_mfma_f32_16x16x32_bf16 v[188:191], v[76:79], a[92:95], v[188:191]
  s_waitcnt lgkmcnt(0)
  v_mfma_f32_16x16x32_bf16 v[192:195], v[56:59], a[0:3], 0
  s_waitcnt vmcnt(20)
  s_barrier
  v_mfma_f32_16x16x32_bf16 v[192:195], v[60:63], a[16:19], v[192:195]
  ds_read_b64_tr_b16 v[68:69], v15 offset:6144
  v_mfma_f32_16x16x32_bf16 v[192:195], v[64:67], a[32:35], v[192:195]
  ds_read_b64_tr_b16 v[70:71], v15 offset:7168
  v_mfma_f32_16x16x32_bf16 v[196:199], v[56:59], a[4:7], 0
  ds_read_b64_tr_b16 v[72:73], v15 offset:10240
  v_mfma_f32_16x16x32_bf16 v[196:199], v[60:63], a[20:23], v[196:199]
  ds_read_b64_tr_b16 v[74:75], v15 offset:11264
  v_mfma_f32_16x16x32_bf16 v[196:199], v[64:67], a[36:39], v[196:199]
  ds_read_b64_tr_b16 v[76:77], v15 offset:14336
  v_mfma_f32_16x16x32_bf16 v[200:203], v[56:59], a[8:11], 0
  ds_read_b64_tr_b16 v[78:79], v15 offset:15360
  v_mfma_f32_16x16x32_bf16 v[200:203], v[60:63], a[24:27], v[200:203]
  s_add_u32 m0, s33, 36864
  v_mfma_f32_16x16x32_bf16 v[200:203], v[64:67], a[40:43], v[200:203]
  s_mov_b32 s34, 2654464
  v_mfma_f32_16x16x32_bf16 v[204:207], v[56:59], a[12:15], 0
  buffer_load_dwordx4 v19, s[4:7], s34 offen lds
  v_mfma_f32_16x16x32_bf16 v[204:207], v[60:63], a[28:31], v[204:207]
  s_add_u32 m0, s33, 40960
  v_mfma_f32_16x16x32_bf16 v[204:207], v[64:67], a[44:47], v[204:207]
  s_mov_b32 s34, 2949376
  buffer_load_dwordx4 v19, s[4:7], s34 offen lds
  s_waitcnt lgkmcnt(0)
  v_mfma_f32_16x16x32_bf16 v[208:211], v[68:71], a[0:3], 0
  ds_read_b64_tr_b16 v[56:57], v14
  v_mfma_f32_16x16x32_bf16 v[208:211], v[72:75], a[16:19], v[208:211]
  ds_read_b64_tr_b16 v[58:59], v14 offset:1024
  v_mfma_f32_16x16x32_bf16 v[208:211], v[76:79], a[32:35], v[208:211]
  ds_read_b64_tr_b16 v[60:61], v14 offset:4096
  v_mfma_f32_16x16x32_bf16 v[212:215], v[68:71], a[4:7], 0
  ds_read_b64_tr_b16 v[62:63], v14 offset:5120
  v_mfma_f32_16x16x32_bf16 v[212:215], v[72:75], a[20:23], v[212:215]
  ds_read_b64_tr_b16 v[64:65], v15 offset:16384
  v_mfma_f32_16x16x32_bf16 v[212:215], v[76:79], a[36:39], v[212:215]
  ds_read_b64_tr_b16 v[66:67], v15 offset:17408
  v_mfma_f32_16x16x32_bf16 v[216:219], v[68:71], a[8:11], 0
  s_add_u32 m0, s33, 45056
  v_mfma_f32_16x16x32_bf16 v[216:219], v[72:75], a[24:27], v[216:219]
  s_mov_b32 s34, 3244288
  v_mfma_f32_16x16x32_bf16 v[216:219], v[76:79], a[40:43], v[216:219]
  buffer_load_dwordx4 v19, s[4:7], s34 offen lds
  v_mfma_f32_16x16x32_bf16 v[220:223], v[68:71], a[12:15], 0
  v_mfma_f32_16x16x32_bf16 v[220:223], v[72:75], a[28:31], v[220:223]
  v_mfma_f32_16x16x32_bf16 v[220:223], v[76:79], a[44:47], v[220:223]
  s_waitcnt lgkmcnt(0)
  v_mfma_f32_16x16x32_bf16 v[192:195], v[56:59], a[48:51], v[192:195]
  ds_read_b64_tr_b16 v[68:69], v14 offset:2048
  v_mfma_f32_16x16x32_bf16 v[192:195], v[60:63], a[64:67], v[192:195]
  ds_read_b64_tr_b16 v[70:71], v14 offset:3072
  v_mfma_f32_16x16x32_bf16 v[192:195], v[64:67], a[80:83], v[192:195]
  ds_read_b64_tr_b16 v[72:73], v14 offset:6144
  v_mfma_f32_16x16x32_bf16 v[196:199], v[56:59], a[52:55], v[196:199]
  ds_read_b64_tr_b16 v[74:75], v14 offset:7168
  v_mfma_f32_16x16x32_bf16 v[196:199], v[60:63], a[68:71], v[196:199]
  ds_read_b64_tr_b16 v[76:77], v15 offset:18432
  v_mfma_f32_16x16x32_bf16 v[196:199], v[64:67], a[84:87], v[196:199]
  ds_read_b64_tr_b16 v[78:79], v15 offset:19456
  v_mfma_f32_16x16x32_bf16 v[200:203], v[56:59], a[56:59], v[200:203]
  s_add_u32 m0, s33, 49152
  v_mfma_f32_16x16x32_bf16 v[200:203], v[60:63], a[72:75], v[200:203]
  s_mov_b32 s34, 2654464
  v_mfma_f32_16x16x32_bf16 v[200:203], v[64:67], a[88:91], v[200:203]
  buffer_load_dwordx4 v19, s[8:11], s34 offen lds
  v_mfma_f32_16x16x32_bf16 v[204:207], v[56:59], a[60:63], v[204:207]
  s_add_u32 m0, s33, 53248
  v_mfma_f32_16x16x32_bf16 v[204:207], v[60:63], a[76:79], v[204:207]
  s_mov_b32 s34, 2949376
  v_mfma_f32_16x16x32_bf16 v[204:207], v[64:67], a[92:95], v[204:207]
  buffer_load_dwordx4 v19, s[8:11], s34 offen lds
  s_waitcnt lgkmcnt(0)
  v_mfma_f32_16x16x32_bf16 v[208:211], v[68:71], a[48:51], v[208:211]
  ds_read_b64_tr_b16 v[56:57], v15 offset:20480
  v_mfma_f32_16x16x32_bf16 v[208:211], v[72:75], a[64:67], v[208:211]
  ds_read_b64_tr_b16 v[58:59], v15 offset:21504
  v_mfma_f32_16x16x32_bf16 v[208:211], v[76:79], a[80:83], v[208:211]
  ds_read_b64_tr_b16 v[60:61], v25 offset:12288
  v_mfma_f32_16x16x32_bf16 v[212:215], v[68:71], a[52:55], v[212:215]
  ds_read_b64_tr_b16 v[62:63], v25 offset:13312
  v_mfma_f32_16x16x32_bf16 v[212:215], v[72:75], a[68:71], v[212:215]
  ds_read_b64_tr_b16 v[64:65], v25 offset:16384
  v_mfma_f32_16x16x32_bf16 v[212:215], v[76:79], a[84:87], v[212:215]
  ds_read_b64_tr_b16 v[66:67], v25 offset:17408
  v_mfma_f32_16x16x32_bf16 v[216:219], v[68:71], a[56:59], v[216:219]
  s_add_u32 m0, s33, 57344
  v_mfma_f32_16x16x32_bf16 v[216:219], v[72:75], a[72:75], v[216:219]
  s_mov_b32 s34, 3244288
  v_mfma_f32_16x16x32_bf16 v[216:219], v[76:79], a[88:91], v[216:219]
  buffer_load_dwordx4 v19, s[8:11], s34 offen lds
  v_mfma_f32_16x16x32_bf16 v[220:223], v[68:71], a[60:63], v[220:223]
  v_mfma_f32_16x16x32_bf16 v[220:223], v[72:75], a[76:79], v[220:223]
  v_mfma_f32_16x16x32_bf16 v[220:223], v[76:79], a[92:95], v[220:223]
  s_waitcnt lgkmcnt(0)
  v_mfma_f32_16x16x32_bf16 v[192:195], v[56:59], a[96:99], v[192:195]
  s_waitcnt vmcnt(10)
  s_barrier
  s_mov_b32 s63, 131072
  buffer_store_dword v7, v22, s[96:99], s63 offen sc1
  v_mfma_f32_16x16x32_bf16 v[192:195], v[60:63], a[112:115], v[192:195]
  ds_read_b64_tr_b16 v[68:69], v15 offset:22528
  v_mfma_f32_16x16x32_bf16 v[192:195], v[64:67], a[128:131], v[192:195]
  ds_read_b64_tr_b16 v[70:71], v15 offset:23552
  v_mfma_f32_16x16x32_bf16 v[196:199], v[56:59], a[100:103], v[196:199]
  ds_read_b64_tr_b16 v[72:73], v25 offset:14336
  v_mfma_f32_16x16x32_bf16 v[196:199], v[60:63], a[116:119], v[196:199]
  ds_read_b64_tr_b16 v[74:75], v25 offset:15360
  v_mfma_f32_16x16x32_bf16 v[196:199], v[64:67], a[132:135], v[196:199]
  ds_read_b64_tr_b16 v[76:77], v25 offset:18432
  v_mfma_f32_16x16x32_bf16 v[200:203], v[56:59], a[104:107], v[200:203]
  ds_read_b64_tr_b16 v[78:79], v25 offset:19456
  v_mfma_f32_16x16x32_bf16 v[200:203], v[60:63], a[120:123], v[200:203]
  s_add_u32 m0, s33, 61440
  v_mfma_f32_16x16x32_bf16 v[200:203], v[64:67], a[136:139], v[200:203]
  s_mov_b32 s34, 3539200
  v_mfma_f32_16x16x32_bf16 v[204:207], v[56:59], a[108:111], v[204:207]
  buffer_load_dwordx4 v19, s[4:7], s34 offen lds
  v_mfma_f32_16x16x32_bf16 v[204:207], v[60:63], a[124:127], v[204:207]
  s_add_u32 m0, s33, 65536
  v_mfma_f32_16x16x32_bf16 v[204:207], v[64:67], a[140:143], v[204:207]
  s_mov_b32 s34, 3834112
  buffer_load_dwordx4 v19, s[4:7], s34 offen lds
  s_waitcnt lgkmcnt(0)
  v_mfma_f32_16x16x32_bf16 v[208:211], v[68:71], a[96:99], v[208:211]
  ds_read_b64_tr_b16 v[56:57], v10 offset:20480
  v_mfma_f32_16x16x32_bf16 v[208:211], v[72:75], a[112:115], v[208:211]
  ds_read_b64_tr_b16 v[58:59], v10 offset:22528
  v_mfma_f32_16x16x32_bf16 v[208:211], v[76:79], a[128:131], v[208:211]
  ds_read_b64_tr_b16 v[60:61], v9 offset:40960
  v_mfma_f32_16x16x32_bf16 v[212:215], v[68:71], a[100:103], v[212:215]
  ds_read_b64_tr_b16 v[62:63], v9 offset:43008
  v_mfma_f32_16x16x32_bf16 v[212:215], v[72:75], a[116:119], v[212:215]
  ds_read_b64_tr_b16 v[64:65], v9 offset:45056
  v_mfma_f32_16x16x32_bf16 v[212:215], v[76:79], a[132:135], v[212:215]
  ds_read_b64_tr_b16 v[66:67], v9 offset:47104
  v_mfma_f32_16x16x32_bf16 v[216:219], v[68:71], a[104:107], v[216:219]
  s_add_u32 m0, s33, 69632
  v_mfma_f32_16x16x32_bf16 v[216:219], v[72:75], a[120:123], v[216:219]
  s_mov_b32 s34, 4129024
  v_mfma_f32_16x16x32_bf16 v[216:219], v[76:79], a[136:139], v[216:219]
  buffer_load_dwordx4 v19, s[4:7], s34 offen lds
  v_mfma_f32_16x16x32_bf16 v[220:223], v[68:71], a[108:111], v[220:223]
  v_mfma_f32_16x16x32_bf16 v[220:223], v[72:75], a[124:127], v[220:223]
  v_mfma_f32_16x16x32_bf16 v[220:223], v[76:79], a[140:143], v[220:223]
  s_waitcnt lgkmcnt(0)
  v_mfma_f32_16x16x32_bf16 v[128:131], v[56:59], a[96:99], v[128:131]
  ds_read_b64_tr_b16 v[68:69], v13 offset:20480
  v_mfma_f32_16x16x32_bf16 v[128:131], v[60:63], a[112:115], v[128:131]
  ds_read_b64_tr_b16 v[70:71], v13 offset:22528
  s_mov_b32 s63, 131072
  buffer_load_dword v31, v91, s[96:99], s63 offen sc1
  v_mfma_f32_16x16x32_bf16 v[128:131], v[64:67], a[128:131], v[128:131]
  ds_read_b64_tr_b16 v[72:73], v12 offset:40960
  v_mfma_f32_16x16x32_bf16 v[132:135], v[56:59], a[100:103], v[132:135]
  ds_read_b64_tr_b16 v[74:75], v12 offset:43008
  v_mfma_f32_16x16x32_bf16 v[132:135], v[60:63], a[116:119], v[132:135]
  ds_read_b64_tr_b16 v[76:77], v12 offset:45056
  v_mfma_f32_16x16x32_bf16 v[132:135], v[64:67], a[132:135], v[132:135]
  ds_read_b64_tr_b16 v[78:79], v12 offset:47104
  v_mfma_f32_16x16x32_bf16 v[136:139], v[56:59], a[104:107], v[136:139]
  s_add_u32 m0, s33, 73728
  v_mfma_f32_16x16x32_bf16 v[136:139], v[60:63], a[120:123], v[136:139]
  s_mov_b32 s34, 3539200
  v_mfma_f32_16x16x32_bf16 v[136:139], v[64:67], a[136:139], v[136:139]
  buffer_load_dwordx4 v19, s[8:11], s34 offen lds
  v_mfma_f32_16x16x32_bf16 v[140:143], v[56:59], a[108:111], v[140:143]
  s_add_u32 m0, s33, 77824
  v_mfma_f32_16x16x32_bf16 v[140:143], v[60:63], a[124:127], v[140:143]
  s_mov_b32 s34, 3834112
  v_mfma_f32_16x16x32_bf16 v[140:143], v[64:67], a[140:143], v[140:143]
  buffer_load_dwordx4 v19, s[8:11], s34 offen lds
  s_waitcnt lgkmcnt(0)
  v_mfma_f32_16x16x32_bf16 v[144:147], v[68:71], a[96:99], v[144:147]
  ds_read_b64_tr_b16 v[56:57], v10 offset:24576
  v_mfma_f32_16x16x32_bf16 v[144:147], v[72:75], a[112:115], v[144:147]
  ds_read_b64_tr_b16 v[58:59], v10 offset:26624
  v_mfma_f32_16x16x32_bf16 v[144:147], v[76:79], a[128:131], v[144:147]
  ds_read_b64_tr_b16 v[60:61], v10 offset:28672
  v_mfma_f32_16x16x32_bf16 v[148:151], v[68:71], a[100:103], v[148:151]
  ds_read_b64_tr_b16 v[62:63], v10 offset:30720
  v_mfma_f32_16x16x32_bf16 v[148:151], v[72:75], a[116:119], v[148:151]
  ds_read_b64_tr_b16 v[64:65], v8 offset:8192
  v_mfma_f32_16x16x32_bf16 v[148:151], v[76:79], a[132:135], v[148:151]
  ds_read_b64_tr_b16 v[66:67], v8 offset:10240
  v_mfma_f32_16x16x32_bf16 v[152:155], v[68:71], a[104:107], v[152:155]
  s_add_u32 m0, s33, 0
  v_mfma_f32_16x16x32_bf16 v[152:155], v[72:75], a[120:123], v[152:155]
  s_mov_b32 s34, 4129024
  v_mfma_f32_16x16x32_bf16 v[152:155], v[76:79], a[136:139], v[152:155]
  buffer_load_dwordx4 v19, s[8:11], s34 offen lds
  v_mfma_f32_16x16x32_bf16 v[156:159], v[68:71], a[108:111], v[156:159]
  v_mfma_f32_16x16x32_bf16 v[156:159], v[72:75], a[124:127], v[156:159]
  v_mfma_f32_16x16x32_bf16 v[156:159], v[76:79], a[140:143], v[156:159]
  s_waitcnt lgkmcnt(0)
  v_mfma_f32_16x16x32_bf16 v[160:163], v[56:59], a[96:99], v[160:163]
  s_waitcnt vmcnt(17)
  s_barrier
  v_mfma_f32_16x16x32_bf16 v[160:163], v[60:63], a[112:115], v[160:163]
  ds_read_b64_tr_b16 v[68:69], v13 offset:24576
  v_mfma_f32_16x16x32_bf16 v[160:163], v[64:67], a[128:131], v[160:163]
  ds_read_b64_tr_b16 v[70:71], v13 offset:26624
  v_mfma_f32_16x16x32_bf16 v[164:167], v[56:59], a[100:103], v[164:167]
  ds_read_b64_tr_b16 v[72:73], v13 offset:28672
  v_mfma_f32_16x16x32_bf16 v[164:167], v[60:63], a[116:119], v[164:167]
  ds_read_b64_tr_b16 v[74:75], v13 offset:30720
  v_mfma_f32_16x16x32_bf16 v[164:167], v[64:67], a[132:135], v[164:167]
  ds_read_b64_tr_b16 v[76:77], v11 offset:8192
  v_mfma_f32_16x16x32_bf16 v[168:171], v[56:59], a[104:107], v[168:171]
  ds_read_b64_tr_b16 v[78:79], v11 offset:10240
  v_mfma_f32_16x16x32_bf16 v[168:171], v[60:63], a[120:123], v[168:171]
  s_add_u32 m0, s33, 4096
  v_mfma_f32_16x16x32_bf16 v[168:171], v[64:67], a[136:139], v[168:171]
  s_mov_b32 s34, 4423936
  v_mfma_f32_16x16x32_bf16 v[172:175], v[56:59], a[108:111], v[172:175]
  buffer_load_dwordx4 v19, s[4:7], s34 offen lds
  v_mfma_f32_16x16x32_bf16 v[172:175], v[60:63], a[124:127], v[172:175]
  s_add_u32 m0, s33, 81920
  v_mfma_f32_16x16x32_bf16 v[172:175], v[64:67], a[140:143], v[172:175]
  s_mov_b32 s34, 4718848
  buffer_load_dwordx4 v19, s[4:7], s34 offen lds
  s_waitcnt lgkmcnt(0)
  v_mfma_f32_16x16x32_bf16 v[176:179], v[68:71], a[96:99], v[176:179]
  ds_read_b64_tr_b16 v[56:57], v14 offset:12288
  v_mfma_f32_16x16x32_bf16 v[176:179], v[72:75], a[112:115], v[176:179]
  ds_read_b64_tr_b16 v[58:59], v14 offset:13312
  s_waitcnt vmcnt(5)
  v_cmp_ne_u32 vcc, v7, v31
  s_cbranch_vccnz L_sp_22
L_bk_23:
  v_mfma_f32_16x16x32_bf16 v[176:179], v[76:79], a[128:131], v[176:179]
  ds_read_b64_tr_b16 v[60:61], v15 offset:49152
  v_mfma_f32_16x16x32_bf16 v[180:183], v[68:71], a[100:103], v[180:183]
  ds_read_b64_tr_b16 v[62:63], v15 offset:50176
  v_mfma_f32_16x16x32_bf16 v[180:183], v[72:75], a[116:119], v[180:183]
  ds_read_b64_tr_b16 v[64:65], v15 offset:53248
  v_mfma_f32_16x16x32_bf16 v[180:183], v[76:79], a[132:135], v[180:183]
  ds_read_b64_tr_b16 v[66:67], v15 offset:54272
  v_mfma_f32_16x16x32_bf16 v[184:187], v[68:71], a[104:107], v[184:187]
  s_add_u32 m0, s33, 86016
  v_mfma_f32_16x16x32_bf16 v[184:187], v[72:75], a[120:123], v[184:187]
  s_mov_b32 s34, 5013760
  v_mfma_f32_16x16x32_bf16 v[184:187], v[76:79], a[136:139], v[184:187]
  buffer_load_dwordx4 v19, s[4:7], s34 offen lds
  v_mfma_f32_16x16x32_bf16 v[188:191], v[68:71], a[108:111], v[188:191]
  v_mfma_f32_16x16x32_bf16 v[188:191], v[72:75], a[124:127], v[188:191]
  v_mfma_f32_16x16x32_bf16 v[188:191], v[76:79], a[140:143], v[188:191]
  s_waitcnt lgkmcnt(0)
  v_mfma_f32_16x16x32_bf16 v[192:195], v[56:59], a[144:147], v[192:195]
  ds_read_b64_tr_b16 v[68:69], v14 offset:14336
  v_mfma_f32_16x16x32_bf16 v[192:195], v[60:63], a[160:163], v[192:195]
  ds_read_b64_tr_b16 v[70:71], v14 offset:15360
  v_mfma_f32_16x16x32_bf16 v[192:195], v[64:67], a[176:179], v[192:195]
  ds_read_b64_tr_b16 v[72:73], v15 offset:51200
  v_mfma_f32_16x16x32_bf16 v[196:199], v[56:59], a[148:151], v[196:199]
  ds_read_b64_tr_b16 v[74:75], v15 offset:52224
  v_mfma_f32_16x16x32_bf16 v[196:199], v[60:63], a[164:167], v[196:199]
  ds_read_b64_tr_b16 v[76:77], v15 offset:55296
  v_mfma_f32_16x16x32_bf16 v[196:199], v[64:67], a[180:183], v[196:199]
  ds_read_b64_tr_b16 v[78:79], v15 offset:56320
  v_mfma_f32_16x16x32_bf16 v[200:203], v[56:59], a[152:155], v[200:203]
  s_add_u32 m0, s33, 143360
  v_mfma_f32_16x16x32_bf16 v[200:203], v[60:63], a[168:171], v[200:203]
  s_mov_b32 s34, 4423936
  v_mfma_f32_16x16x32_bf16 v[200:203], v[64:67], a[184:187], v[200:203]
  buffer_load_dwordx4 v19, s[8:11], s34 offen lds
  v_mfma_f32_16x16x32_bf16 v[204:207], v[56:59], a[156:159], v[204:207]
  s_add_u32 m0, s33, 147456
  v_mfma_f32_16x16x32_bf16 v[204:207], v[60:63], a[172:175], v[204:207]
  s_mov_b32 s34, 4718848
  v_mfma_f32_16x16x32_bf16 v[204:207], v[64:67], a[188:191], v[204:207]
  buffer_load_dwordx4 v19, s[8:11], s34 offen lds
  s_waitcnt lgkmcnt(0)
  v_mfma_f32_16x16x32_bf16 v[208:211], v[68:71], a[144:147], v[208:211]
  ds_read_b64_tr_b16 v[56:57], v15 offset:57344
  v_mfma_f32_16x16x32_bf16 v[208:211], v[72:75], a[160:163], v[208:211]
  ds_read_b64_tr_b16 v[58:59], v15 offset:58368
  v_mfma_f32_16x16x32_bf16 v[208:211], v[76:79], a[176:179], v[208:211]
  ds_read_b64_tr_b16 v[60:61], v14 offset:16384
  v_mfma_f32_16x16x32_bf16 v[212:215], v[68:71], a[148:151], v[212:215]
  ds_read_b64_tr_b16 v[62:63], v14 offset:17408
  v_mfma_f32_16x16x32_bf16 v[212:215], v[72:75], a[164:167], v[212:215]
  ds_read_b64_tr_b16 v[64:65], v14 offset:20480
  v_mfma_f32_16x16x32_bf16 v[212:215], v[76:79], a[180:183], v[212:215]
  ds_read_b64_tr_b16 v[66:67], v14 offset:21504
  v_mfma_f32_16x16x32_bf16 v[216:219], v[68:71], a[152:155], v[216:219]
  s_add_u32 m0, s33, 151552
  v_mfma_f32_16x16x32_bf16 v[216:219], v[72:75], a[168:171], v[216:219]
  s_mov_b32 s34, 5013760
  v_mfma_f32_16x16x32_bf16 v[216:219], v[76:79], a[184:187], v[216:219]
  buffer_load_dwordx4 v19, s[8:11], s34 offen lds
  v_mfma_f32_16x16x32_bf16 v[220:223], v[68:71], a[156:159], v[220:223]
  v_mfma_f32_16x16x32_bf16 v[220:223], v[72:75], a[172:175], v[220:223]
  v_mfma_f32_16x16x32_bf16 v[220:223], v[76:79], a[188:191], v[220:223]
  s_waitcnt lgkmcnt(0)
  v_mfma_f32_16x16x32_bf16 v[192:195], v[56:59], a[192:195], v[192:195]
  s_barrier
  v_mfma_f32_16x16x32_bf16 v[192:195], v[60:63], a[208:211], v[192:195]
  ds_read_b64_tr_b16 v[68:69], v15 offset:59392
  s_add_u32 m0, s33, 155648
  v_mfma_f32_16x16x32_bf16 v[192:195], v[64:67], a[224:227], v[192:195]
  ds_read_b64_tr_b16 v[70:71], v15 offset:60416
  s_mov_b32 s34, 0
  v_mfma_f32_16x16x32_bf16 v[196:199], v[56:59], a[196:199], v[196:199]
  ds_read_b64_tr_b16 v[72:73], v14 offset:18432
  buffer_load_dwordx4 v88, s[68:71], s34 offen sc1 lds
  v_mfma_f32_16x16x32_bf16 v[196:199], v[60:63], a[212:215], v[196:199]
  ds_read_b64_tr_b16 v[74:75], v14 offset:19456
  s_add_u32 m0, s33, 8192
  v_mfma_f32_16x16x32_bf16 v[196:199], v[64:67], a[228:231], v[196:199]
  ds_read_b64_tr_b16 v[76:77], v14 offset:22528
  s_mov_b32 s34, 384
  v_mfma_f32_16x16x32_bf16 v[200:203], v[56:59], a[200:203], v[200:203]
  ds_read_b64_tr_b16 v[78:79], v14 offset:23552
  buffer_load_dwordx4 v19, s[4:7], s34 offen lds
  v_mfma_f32_16x16x32_bf16 v[200:203], v[60:63], a[216:219], v[200:203]
  s_add_u32 m0, s33, 12288
  s_mov_b32 s65, 6912
  v_mfma_f32_16x16x32_bf16 v[200:203], v[64:67], a[232:235], v[200:203]
  s_mov_b32 s34, 295296
  buffer_load_dword v31, v93, s[12:15], s65 offen
  v_mfma_f32_16x16x32_bf16 v[204:207], v[56:59], a[204:207], v[204:207]
  buffer_load_dwordx4 v19, s[4:7], s34 offen lds
  v_mfma_f32_16x16x32_bf16 v[204:207], v[60:63], a[220:223], v[204:207]
  v_mfma_f32_16x16x32_bf16 v[204:207], v[64:67], a[236:239], v[204:207]
  s_waitcnt lgkmcnt(0)
  v_mfma_f32_16x16x32_bf16 v[208:211], v[68:71], a[192:195], v[208:211]
  ds_read_b64_tr_b16 v[56:57], v14 offset:24576
  v_mfma_f32_16x16x32_bf16 v[208:211], v[72:75], a[208:211], v[208:211]
  ds_read_b64_tr_b16 v[58:59], v14 offset:25600
  v_mfma_f32_16x16x32_bf16 v[208:211], v[76:79], a[224:227], v[208:211]
  ds_read_b64_tr_b16 v[60:61], v14 offset:28672
  v_mfma_f32_16x16x32_bf16 v[212:215], v[68:71], a[196:199], v[212:215]
  ds_read_b64_tr_b16 v[62:63], v14 offset:29696
  v_mfma_f32_16x16x32_bf16 v[212:215], v[72:75], a[212:215], v[212:215]
  ds_read_b64_tr_b16 v[64:65], v14 offset:32768
  v_mfma_f32_16x16x32_bf16 v[212:215], v[76:79], a[228:231], v[212:215]
  ds_read_b64_tr_b16 v[66:67], v14 offset:33792
  v_mfma_f32_16x16x32_bf16 v[216:219], v[68:71], a[200:203], v[216:219]
  s_add_u32 m0, s33, 114688
  v_mfma_f32_16x16x32_bf16 v[216:219], v[72:75], a[216:219], v[216:219]
  s_mov_b32 s34, 590208
  v_mfma_f32_16x16x32_bf16 v[216:219], v[76:79], a[232:235], v[216:219]
  buffer_load_dwordx4 v19, s[4:7], s34 offen lds
  v_mfma_f32_16x16x32_bf16 v[220:223], v[68:71], a[204:207], v[220:223]
  v_mfma_f32_16x16x32_bf16 v[220:223], v[72:75], a[220:223], v[220:223]
  v_mfma_f32_16x16x32_bf16 v[220:223], v[76:79], a[236:239], v[220:223]
  s_waitcnt lgkmcnt(0)
  v_mfma_f32_16x16x32_bf16 v[192:195], v[56:59], a[240:243], v[192:195]
  ds_read_b64_tr_b16 v[68:69], v14 offset:26624
  v_mfma_f32_16x16x32_bf16 v[192:195], v[60:63], v[96:99], v[192:195]
  ds_read_b64_tr_b16 v[70:71], v14 offset:27648
  v_mfma_f32_16x16x32_bf16 v[192:195], v[64:67], v[112:115], v[192:195]
  ds_read_b64_tr_b16 v[72:73], v14 offset:30720
  v_mfma_f32_16x16x32_bf16 v[196:199], v[56:59], a[244:247], v[196:199]
  ds_read_b64_tr_b16 v[74:75], v14 offset:31744
  v_mfma_f32_16x16x32_bf16 v[196:199], v[60:63], v[100:103], v[196:199]
  ds_read_b64_tr_b16 v[76:77], v14 offset:34816
  v_mfma_f32_16x16x32_bf16 v[196:199], v[64:67], v[116:119], v[196:199]
  ds_read_b64_tr_b16 v[78:79], v14 offset:35840
  v_mfma_f32_16x16x32_bf16 v[200:203], v[56:59], a[248:251], v[200:203]
  s_add_u32 m0, s33, 118784
  v_mfma_f32_16x16x32_bf16 v[200:203], v[60:63], v[104:107], v[200:203]
  s_mov_b32 s34, 2048
  v_mfma_f32_16x16x32_bf16 v[200:203], v[64:67], v[120:123], v[200:203]
  buffer_load_dwordx4 v88, s[68:71], s34 offen sc1 lds
  v_mfma_f32_16x16x32_bf16 v[204:207], v[56:59], a[252:255], v[204:207]
  v_mfma_f32_16x16x32_bf16 v[204:207], v[60:63], v[108:111], v[204:207]
  v_mfma_f32_16x16x32_bf16 v[204:207], v[64:67], v[124:127], v[204:207]
  s_waitcnt lgkmcnt(0)
  v_mfma_f32_16x16x32_bf16 v[208:211], v[68:71], a[240:243], v[208:211]
  ds_read_b64_tr_b16 v[56:57], v8 offset:36864
  v_mfma_f32_16x16x32_bf16 v[208:211], v[72:75], v[96:99], v[208:211]
  ds_read_b64_tr_b16 v[58:59], v8 offset:38912
  v_mfma_f32_16x16x32_bf16 v[208:211], v[76:79], v[112:115], v[208:211]
  ds_read_b64_tr_b16 v[60:61], v8 offset:40960
  v_mfma_f32_16x16x32_bf16 v[212:215], v[68:71], a[244:247], v[212:215]
  ds_read_b64_tr_b16 v[62:63], v8 offset:43008
  v_mfma_f32_16x16x32_bf16 v[212:215], v[72:75], v[100:103], v[212:215]
  ds_read_b64_tr_b16 v[64:65], v8 offset:45056
  v_mfma_f32_16x16x32_bf16 v[212:215], v[76:79], v[116:119], v[212:215]
  ds_read_b64_tr_b16 v[66:67], v8 offset:47104
  v_mfma_f32_16x16x32_bf16 v[216:219], v[68:71], a[248:251], v[216:219]
  v_mfma_f32_16x16x32_bf16 v[216:219], v[72:75], v[104:107], v[216:219]
  v_mfma_f32_16x16x32_bf16 v[216:219], v[76:79], v[120:123], v[216:219]
  v_mfma_f32_16x16x32_bf16 v[220:223], v[68:71], a[252:255], v[220:223]
  v_mfma_f32_16x16x32_bf16 v[220:223], v[72:75], v[108:111], v[220:223]
  v_mfma_f32_16x16x32_bf16 v[220:223], v[76:79], v[124:127], v[220:223]
  s_waitcnt lgkmcnt(0)
  v_mfma_f32_16x16x32_bf16 v[128:131], v[56:59], a[144:147], v[128:131]
  s_barrier
  v_mfma_f32_16x16x32_bf16 v[128:131], v[60:63], a[160:163], v[128:131]
  ds_read_b64_tr_b16 v[68:69], v11 offset:36864
  v_mul_f32 v192, v192, v208
  v_mfma_f32_16x16x32_bf16 v[128:131], v[64:67], a[176:179], v[128:131]
  ds_read_b64_tr_b16 v[70:71], v11 offset:38912
  v_mul_f32 v193, v193, v209
  v_mfma_f32_16x16x32_bf16 v[132:135], v[56:59], a[148:151], v[132:135]
  ds_read_b64_tr_b16 v[72:73], v11 offset:40960
  v_mul_f32 v194, v194, v210
  v_mfma_f32_16x16x32_bf16 v[132:135], v[60:63], a[164:167], v[132:135]
  ds_read_b64_tr_b16 v[74:75], v11 offset:43008
  v_mul_f32 v195, v195, v211
  v_mfma_f32_16x16x32_bf16 v[132:135], v[64:67], a[180:183], v[132:135]
  ds_read_b64_tr_b16 v[76:77], v11 offset:45056
  v_cvt_pk_bf16_f32 v32, v192, v193
  v_mfma_f32_16x16x32_bf16 v[136:139], v[56:59], a[152:155], v[136:139]
  ds_read_b64_tr_b16 v[78:79], v11 offset:47104
  v_cvt_pk_bf16_f32 v33, v194, v195
  v_mfma_f32_16x16x32_bf16 v[136:139], v[60:63], a[168:171], v[136:139]
  s_add_u32 m0, s33, 16384
  ds_write_b64 v18, v[32:33] offset:32768
  v_mfma_f32_16x16x32_bf16 v[136:139], v[64:67], a[184:187], v[136:139]
  s_mov_b32 s34, 4096
  s_mov_b32 s61, 32768
  v_mfma_f32_16x16x32_bf16 v[140:143], v[56:59], a[156:159], v[140:143]
  buffer_load_dwordx4 v88, s[68:71], s34 offen sc1 lds
  buffer_store_dwordx2 v[32:33], v81, s[28:31], s61 offen sc1
  v_mfma_f32_16x16x32_bf16 v[140:143], v[60:63], a[172:175], v[140:143]
  v_mul_f32 v196, v196, v212
  v_mfma_f32_16x16x32_bf16 v[140:143], v[64:67], a[188:191], v[140:143]
  v_mul_f32 v197, v197, v213
  s_waitcnt lgkmcnt(1)
  v_mfma_f32_16x16x32_bf16 v[144:147], v[68:71], a[144:147], v[144:147]
  ds_read_b64_tr_b16 v[56:57], v8 offset:49152
  v_mul_f32 v198, v198, v214
  v_mfma_f32_16x16x32_bf16 v[144:147], v[72:75], a[160:163], v[144:147]
  ds_read_b64_tr_b16 v[58:59], v8 offset:51200
  v_mul_f32 v199, v199, v215
  v_mfma_f32_16x16x32_bf16 v[144:147], v[76:79], a[176:179], v[144:147]
  ds_read_b64_tr_b16 v[60:61], v8 offset:53248
  v_cvt_pk_bf16_f32 v34, v196, v197
  v_mfma_f32_16x16x32_bf16 v[148:151], v[68:71], a[148:151], v[148:151]
  ds_read_b64_tr_b16 v[62:63], v8 offset:55296
  v_cvt_pk_bf16_f32 v35, v198, v199
  v_mfma_f32_16x16x32_bf16 v[148:151], v[72:75], a[164:167], v[148:151]
  ds_read_b64_tr_b16 v[64:65], v8 offset:57344
  ds_write_b64 v18, v[34:35] offset:33792
  v_mfma_f32_16x16x32_bf16 v[148:151], v[76:79], a[180:183], v[148:151]
  ds_read_b64_tr_b16 v[66:67], v8 offset:59392
  s_mov_b32 s61, 33792
  v_mfma_f32_16x16x32_bf16 v[152:155], v[68:71], a[152:155], v[152:155]
  buffer_store_dwordx2 v[34:35], v81, s[28:31], s61 offen sc1
  v_mfma_f32_16x16x32_bf16 v[152:155], v[72:75], a[168:171], v[152:155]
  v_mul_f32 v200, v200, v216
  v_mfma_f32_16x16x32_bf16 v[152:155], v[76:79], a[184:187], v[152:155]
  v_mul_f32 v201, v201, v217
  v_mfma_f32_16x16x32_bf16 v[156:159], v[68:71], a[156:159], v[156:159]
  v_mul_f32 v202, v202, v218
  v_mfma_f32_16x16x32_bf16 v[156:159], v[72:75], a[172:175], v[156:159]
  v_mul_f32 v203, v203, v219
  v_mfma_f32_16x16x32_bf16 v[156:159], v[76:79], a[188:191], v[156:159]
  v_cvt_pk_bf16_f32 v36, v200, v201
  s_waitcnt lgkmcnt(0)
  v_mfma_f32_16x16x32_bf16 v[160:163], v[56:59], a[144:147], v[160:163]
  ds_read_b64_tr_b16 v[68:69], v11 offset:49152
  v_cvt_pk_bf16_f32 v37, v202, v203
  v_mfma_f32_16x16x32_bf16 v[160:163], v[60:63], a[160:163], v[160:163]
  ds_read_b64_tr_b16 v[70:71], v11 offset:51200
  ds_write_b64 v18, v[36:37] offset:34816
  v_mfma_f32_16x16x32_bf16 v[160:163], v[64:67], a[176:179], v[160:163]
  ds_read_b64_tr_b16 v[72:73], v11 offset:53248
  s_mov_b32 s61, 34816
  v_mfma_f32_16x16x32_bf16 v[164:167], v[56:59], a[148:151], v[164:167]
  ds_read_b64_tr_b16 v[74:75], v11 offset:55296
  buffer_store_dwordx2 v[36:37], v81, s[28:31], s61 offen sc1
  v_mfma_f32_16x16x32_bf16 v[164:167], v[60:63], a[164:167], v[164:167]
  ds_read_b64_tr_b16 v[76:77], v11 offset:57344
  v_mul_f32 v204, v204, v220
  v_mfma_f32_16x16x32_bf16 v[164:167], v[64:67], a[180:183], v[164:167]
  ds_read_b64_tr_b16 v[78:79], v11 offset:59392
  v_mul_f32 v205, v205, v221
  v_mfma_f32_16x16x32_bf16 v[168:171], v[56:59], a[152:155], v[168:171]
  s_add_u32 m0, s33, 20480
  v_mul_f32 v206, v206, v222
  v_mfma_f32_16x16x32_bf16 v[168:171], v[60:63], a[168:171], v[168:171]
  s_mov_b32 s34, 6144
  v_mul_f32 v207, v207, v223
  v_mfma_f32_16x16x32_bf16 v[168:171], v[64:67], a[184:187], v[168:171]
  buffer_load_dwordx4 v88, s[68:71], s34 offen sc1 lds
  v_cvt_pk_bf16_f32 v38, v204, v205
  v_mfma_f32_16x16x32_bf16 v[172:175], v[56:59], a[156:159], v[172:175]
  v_cvt_pk_bf16_f32 v39, v206, v207
  v_mfma_f32_16x16x32_bf16 v[172:175], v[60:63], a[172:175], v[172:175]
  ds_write_b64 v18, v[38:39] offset:35840
  v_mfma_f32_16x16x32_bf16 v[172:175], v[64:67], a[188:191], v[172:175]
  s_mov_b32 s61, 35840
  s_waitcnt lgkmcnt(1)
  v_mfma_f32_16x16x32_bf16 v[176:179], v[68:71], a[144:147], v[176:179]
  ds_read_b64_tr_b16 v[56:57], v8 offset:61440
  buffer_store_dwordx2 v[38:39], v81, s[28:31], s61 offen sc1
  v_mfma_f32_16x16x32_bf16 v[176:179], v[72:75], a[160:163], v[176:179]
  ds_read_b64_tr_b16 v[58:59], v8 offset:63488
  v_mfma_f32_16x16x32_bf16 v[176:179], v[76:79], a[176:179], v[176:179]
  ds_read_b64_tr_b16 v[60:61], v9
  v_mfma_f32_16x16x32_bf16 v[180:183], v[68:71], a[148:151], v[180:183]
  ds_read_b64_tr_b16 v[62:63], v9 offset:2048
  v_mfma_f32_16x16x32_bf16 v[180:183], v[72:75], a[164:167], v[180:183]
  ds_read_b64_tr_b16 v[64:65], v9 offset:4096
  v_mfma_f32_16x16x32_bf16 v[180:183], v[76:79], a[180:183], v[180:183]
  ds_read_b64_tr_b16 v[66:67], v9 offset:6144
  v_mfma_f32_16x16x32_bf16 v[184:187], v[68:71], a[152:155], v[184:187]
  v_mfma_f32_16x16x32_bf16 v[184:187], v[72:75], a[168:171], v[184:187]
  v_mfma_f32_16x16x32_bf16 v[184:187], v[76:79], a[184:187], v[184:187]
  v_mfma_f32_16x16x32_bf16 v[188:191], v[68:71], a[156:159], v[188:191]
  v_mfma_f32_16x16x32_bf16 v[188:191], v[72:75], a[172:175], v[188:191]
  v_mfma_f32_16x16x32_bf16 v[188:191], v[76:79], a[188:191], v[188:191]
  s_waitcnt lgkmcnt(0)
  v_mfma_f32_16x16x32_bf16 v[128:131], v[56:59], a[192:195], v[128:131]
  s_waitcnt vmcnt(15)
  s_barrier
  v_mfma_f32_16x16x32_bf16 v[128:131], v[60:63], a[208:211], v[128:131]
  ds_read_b64_tr_b16 v[68:69], v11 offset:61440
  s_add_u32 m0, s33, 24576
  v_mfma_f32_16x16x32_bf16 v[128:131], v[64:67], a[224:227], v[128:131]
  ds_read_b64_tr_b16 v[70:71], v11 offset:63488
  s_mov_b32 s34, 8192
  v_mfma_f32_16x16x32_bf16 v[132:135], v[56:59], a[196:199], v[132:135]
  ds_read_b64_tr_b16 v[72:73], v12
  buffer_load_dwordx4 v88, s[68:71], s34 offen sc1 lds
  v_mfma_f32_16x16x32_bf16 v[132:135], v[60:63], a[212:215], v[132:135]
  ds_read_b64_tr_b16 v[74:75], v12 offset:2048
  s_add_u32 m0, s33, 28672
  v_mfma_f32_16x16x32_bf16 v[132:135], v[64:67], a[228:231], v[132:135]
  ds_read_b64_tr_b16 v[76:77], v12 offset:4096
  s_mov_b32 s34, 384
  v_mfma_f32_16x16x32_bf16 v[136:139], v[56:59], a[200:203], v[136:139]
  ds_read_b64_tr_b16 v[78:79], v12 offset:6144
  buffer_load_dwordx4 v19, s[8:11], s34 offen lds
  v_mfma_f32_16x16x32_bf16 v[136:139], v[60:63], a[216:219], v[136:139]
  s_add_u32 m0, s33, 32768
  s_mov_b32 s65, 13824
  v_mfma_f32_16x16x32_bf16 v[136:139], v[64:67], a[232:235], v[136:139]
  s_mov_b32 s34, 295296
  buffer_load_dword v31, v93, s[12:15], s65 offen
  v_mfma_f32_16x16x32_bf16 v[140:143], v[56:59], a[204:207], v[140:143]
  buffer_load_dwordx4 v19, s[8:11], s34 offen lds
  v_mfma_f32_16x16x32_bf16 v[140:143], v[60:63], a[220:223], v[140:143]
  v_mfma_f32_16x16x32_bf16 v[140:143], v[64:67], a[236:239], v[140:143]
  s_waitcnt lgkmcnt(0)
  v_mfma_f32_16x16x32_bf16 v[144:147], v[68:71], a[192:195], v[144:147]
  ds_read_b64_tr_b16 v[56:57], v9 offset:8192
  v_mfma_f32_16x16x32_bf16 v[144:147], v[72:75], a[208:211], v[144:147]
  ds_read_b64_tr_b16 v[58:59], v9 offset:10240
  v_mfma_f32_16x16x32_bf16 v[144:147], v[76:79], a[224:227], v[144:147]
  ds_read_b64_tr_b16 v[60:61], v9 offset:12288
  v_mfma_f32_16x16x32_bf16 v[148:151], v[68:71], a[196:199], v[148:151]
  ds_read_b64_tr_b16 v[62:63], v9 offset:14336
  v_mfma_f32_16x16x32_bf16 v[148:151], v[72:75], a[212:215], v[148:151]
  ds_read_b64_tr_b16 v[64:65], v8
  v_mfma_f32_16x16x32_bf16 v[148:151], v[76:79], a[228:231], v[148:151]
  ds_read_b64_tr_b16 v[66:67], v8 offset:2048
  v_mfma_f32_16x16x32_bf16 v[152:155], v[68:71], a[200:203], v[152:155]
  s_add_u32 m0, s33, 36864
  v_mfma_f32_16x16x32_bf16 v[152:155], v[72:75], a[216:219], v[152:155]
  s_mov_b32 s34, 590208
  v_mfma_f32_16x16x32_bf16 v[152:155], v[76:79], a[232:235], v[152:155]
  buffer_load_dwordx4 v19, s[8:11], s34 offen lds
  v_mfma_f32_16x16x32_bf16 v[156:159], v[68:71], a[204:207], v[156:159]
  v_mfma_f32_16x16x32_bf16 v[156:159], v[72:75], a[220:223], v[156:159]
  v_mfma_f32_16x16x32_bf16 v[156:159], v[76:79], a[236:239], v[156:159]
  s_waitcnt lgkmcnt(0)
  v_mfma_f32_16x16x32_bf16 v[160:163], v[56:59], a[192:195], v[160:163]
  ds_read_b64_tr_b16 v[68:69], v12 offset:8192
  s_add_u32 m0, s33, 40960
  v_mfma_f32_16x16x32_bf16 v[160:163], v[60:63], a[208:211], v[160:163]
  ds_read_b64_tr_b16 v[70:71], v12 offset:10240
  s_mov_b32 s34, 10240
  v_mfma_f32_16x16x32_bf16 v[160:163], v[64:67], a[224:227], v[160:163]
  ds_read_b64_tr_b16 v[72:73], v12 offset:12288
  buffer_load_dwordx4 v88, s[68:71], s34 offen sc1 lds
  v_mfma_f32_16x16x32_bf16 v[164:167], v[56:59], a[196:199], v[164:167]
  ds_read_b64_tr_b16 v[74:75], v12 offset:14336
  s_add_u32 m0, s33, 45056
  v_mfma_f32_16x16x32_bf16 v[164:167], v[60:63], a[212:215], v[164:167]
  ds_read_b64_tr_b16 v[76:77], v11
  s_mov_b32 s34, 885120
  v_mfma_f32_16x16x32_bf16 v[164:167], v[64:67], a[228:231], v[164:167]
  ds_read_b64_tr_b16 v[78:79], v11 offset:2048
  buffer_load_dwordx4 v19, s[4:7], s34 offen lds
  v_mfma_f32_16x16x32_bf16 v[168:171], v[56:59], a[200:203], v[168:171]
  s_add_u32 m0, s33, 49152
  v_mfma_f32_16x16x32_bf16 v[168:171], v[60:63], a[216:219], v[168:171]
  s_mov_b32 s34, 1180032
  v_mfma_f32_16x16x32_bf16 v[168:171], v[64:67], a[232:235], v[168:171]
  buffer_load_dwordx4 v19, s[4:7], s34 offen lds
  v_mfma_f32_16x16x32_bf16 v[172:175], v[56:59], a[204:207], v[172:175]
  v_mfma_f32_16x16x32_bf16 v[172:175], v[60:63], a[220:223], v[172:175]
  v_mfma_f32_16x16x32_bf16 v[172:175], v[64:67], a[236:239], v[172:175]
  s_waitcnt lgkmcnt(0)
  v_mfma_f32_16x16x32_bf16 v[176:179], v[68:71], a[192:195], v[176:179]
  ds_read_b64_tr_b16 v[56:57], v8 offset:4096
  v_mfma_f32_16x16x32_bf16 v[176:179], v[72:75], a[208:211], v[176:179]
  ds_read_b64_tr_b16 v[58:59], v8 offset:6144
  v_mfma_f32_16x16x32_bf16 v[176:179], v[76:79], a[224:227], v[176:179]
  ds_read_b64_tr_b16 v[60:61], v9 offset:16384
  v_mfma_f32_16x16x32_bf16 v[180:183], v[68:71], a[196:199], v[180:183]
  ds_read_b64_tr_b16 v[62:63], v9 offset:18432
  v_mfma_f32_16x16x32_bf16 v[180:183], v[72:75], a[212:215], v[180:183]
  ds_read_b64_tr_b16 v[64:65], v9 offset:20480
  v_mfma_f32_16x16x32_bf16 v[180:183], v[76:79], a[228:231], v[180:183]
  ds_read_b64_tr_b16 v[66:67], v9 offset:22528
  v_mfma_f32_16x16x32_bf16 v[184:187], v[68:71], a[200:203], v[184:187]
  s_add_u32 m0, s33, 53248
  v_mfma_f32_16x16x32_bf16 v[184:187], v[72:75], a[216:219], v[184:187]
  s_mov_b32 s34, 1474944
  v_mfma_f32_16x16x32_bf16 v[184:187], v[76:79], a[232:235], v[184:187]
  buffer_load_dwordx4 v19, s[4:7], s34 offen lds
  v_mfma_f32_16x16x32_bf16 v[188:191], v[68:71], a[204:207], v[188:191]
  v_mfma_f32_16x16x32_bf16 v[188:191], v[72:75], a[220:223], v[188:191]
  v_mfma_f32_16x16x32_bf16 v[188:191], v[76:79], a[236:239], v[188:191]
  s_waitcnt lgkmcnt(0)
  v_mfma_f32_16x16x32_bf16 v[128:131], v[56:59], a[240:243], v[128:131]
  s_waitcnt vmcnt(16)
  s_barrier
  v_mfma_f32_16x16x32_bf16 v[128:131], v[60:63], v[96:99], v[128:131]
  ds_read_b64_tr_b16 v[68:69], v11 offset:4096
  s_add_u32 m0, s33, 57344
  v_mfma_f32_16x16x32_bf16 v[128:131], v[64:67], v[112:115], v[128:131]
  ds_read_b64_tr_b16 v[70:71], v11 offset:6144
  s_mov_b32 s34, 12288
  v_mfma_f32_16x16x32_bf16 v[132:135], v[56:59], a[244:247], v[132:135]
  ds_read_b64_tr_b16 v[72:73], v12 offset:16384
  buffer_load_dwordx4 v88, s[68:71], s34 offen sc1 lds
  v_mfma_f32_16x16x32_bf16 v[132:135], v[60:63], v[100:103], v[132:135]
  ds_read_b64_tr_b16 v[74:75], v12 offset:18432
  s_add_u32 m0, s33, 61440
  v_mfma_f32_16x16x32_bf16 v[132:135], v[64:67], v[116:119], v[132:135]
  ds_read_b64_tr_b16 v[76:77], v12 offset:20480
  s_mov_b32 s34, 885120
  v_mfma_f32_16x16x32_bf16 v[136:139], v[56:59], a[248:251], v[136:139]
  ds_read_b64_tr_b16 v[78:79], v12 offset:22528
  buffer_load_dwordx4 v19, s[8:11], s34 offen lds
  v_mfma_f32_16x16x32_bf16 v[136:139], v[60:63], v[104:107], v[136:139]
  s_add_u32 m0, s33, 65536
  v_mfma_f32_16x16x32_bf16 v[136:139], v[64:67], v[120:123], v[136:139]
  s_mov_b32 s34, 1180032
  v_mfma_f32_16x16x32_bf16 v[140:143], v[56:59], a[252:255], v[140:143]
  buffer_load_dwordx4 v19, s[8:11], s34 offen lds
  v_mfma_f32_16x16x32_bf16 v[140:143], v[60:63], v[108:111], v[140:143]
  v_mfma_f32_16x16x32_bf16 v[140:143], v[64:67], v[124:127], v[140:143]
  s_waitcnt lgkmcnt(0)
  v_mfma_f32_16x16x32_bf16 v[144:147], v[68:71], a[240:243], v[144:147]
  ds_read_b64_tr_b16 v[56:57], v10 offset:12288
  v_mfma_f32_16x16x32_bf16 v[144:147], v[72:75], v[96:99], v[144:147]
  ds_read_b64_tr_b16 v[58:59], v10 offset:14336
  v_mfma_f32_16x16x32_bf16 v[144:147], v[76:79], v[112:115], v[144:147]
  ds_read_b64_tr_b16 v[60:61], v10 offset:16384
  v_mfma_f32_16x16x32_bf16 v[148:151], v[68:71], a[244:247], v[148:151]
  ds_read_b64_tr_b16 v[62:63], v10 offset:18432
  v_mfma_f32_16x16x32_bf16 v[148:151], v[72:75], v[100:103], v[148:151]
  ds_read_b64_tr_b16 v[64:65], v10 offset:20480
  v_mfma_f32_16x16x32_bf16 v[148:151], v[76:79], v[116:119], v[148:151]
  ds_read_b64_tr_b16 v[66:67], v10 offset:22528
  v_mfma_f32_16x16x32_bf16 v[152:155], v[68:71], a[248:251], v[152:155]
  s_add_u32 m0, s33, 69632
  v_mfma_f32_16x16x32_bf16 v[152:155], v[72:75], v[104:107], v[152:155]
  s_mov_b32 s34, 1474944
  v_mfma_f32_16x16x32_bf16 v[152:155], v[76:79], v[120:123], v[152:155]
  buffer_load_dwordx4 v19, s[8:11], s34 offen lds
  v_mfma_f32_16x16x32_bf16 v[156:159], v[68:71], a[252:255], v[156:159]
  v_mfma_f32_16x16x32_bf16 v[156:159], v[72:75], v[108:111], v[156:159]
  v_mfma_f32_16x16x32_bf16 v[156:159], v[76:79], v[124:127], v[156:159]
  s_waitcnt lgkmcnt(0)
  v_mfma_f32_16x16x32_bf16 v[160:163], v[56:59], a[240:243], v[160:163]
  ds_read_b64_tr_b16 v[68:69], v13 offset:12288
  s_add_u32 m0, s33, 73728
  v_mfma_f32_16x16x32_bf16 v[160:163], v[60:63], v[96:99], v[160:163]
  ds_read_b64_tr_b16 v[70:71], v13 offset:14336
  s_mov_b32 s34, 14336
  v_mfma_f32_16x16x32_bf16 v[160:163], v[64:67], v[112:115], v[160:163]
  ds_read_b64_tr_b16 v[72:73], v13 offset:16384
  buffer_load_dwordx4 v88, s[68:71], s34 offen sc1 lds
  v_mfma_f32_16x16x32_bf16 v[164:167], v[56:59], a[244:247], v[164:167]
  ds_read_b64_tr_b16 v[74:75], v13 offset:18432
  s_add_u32 m0, s33, 77824
  v_mfma_f32_16x16x32_bf16 v[164:167], v[60:63], v[100:103], v[164:167]
  ds_read_b64_tr_b16 v[76:77], v13 offset:20480
  s_mov_b32 s34, 1769856
  v_mfma_f32_16x16x32_bf16 v[164:167], v[64:67], v[116:119], v[164:167]
  ds_read_b64_tr_b16 v[78:79], v13 offset:22528
  buffer_load_dwordx4 v19, s[4:7], s34 offen lds
  v_mfma_f32_16x16x32_bf16 v[168:171], v[56:59], a[248:251], v[168:171]
  s_add_u32 m0, s33, 0
  v_mfma_f32_16x16x32_bf16 v[168:171], v[60:63], v[104:107], v[168:171]
  s_mov_b32 s34, 2064768
  v_mfma_f32_16x16x32_bf16 v[168:171], v[64:67], v[120:123], v[168:171]
  buffer_load_dwordx4 v19, s[4:7], s34 offen lds
  v_mfma_f32_16x16x32_bf16 v[172:175], v[56:59], a[252:255], v[172:175]
  v_mfma_f32_16x16x32_bf16 v[172:175], v[60:63], v[108:111], v[172:175]
  v_mfma_f32_16x16x32_bf16 v[172:175], v[64:67], v[124:127], v[172:175]
  s_waitcnt lgkmcnt(0)
  v_mfma_f32_16x16x32_bf16 v[176:179], v[68:71], a[240:243], v[176:179]
  ds_read_b64_tr_b16 v[56:57], v8 offset:8192
  v_mfma_f32_16x16x32_bf16 v[176:179], v[72:75], v[96:99], v[176:179]
  ds_read_b64_tr_b16 v[58:59], v8 offset:10240
  v_mfma_f32_16x16x32_bf16 v[176:179], v[76:79], v[112:115], v[176:179]
  ds_read_b64_tr_b16 v[60:61], v8 offset:12288
  v_mfma_f32_16x16x32_bf16 v[180:183], v[68:71], a[244:247], v[180:183]
  ds_read_b64_tr_b16 v[62:63], v8 offset:14336
  v_mfma_f32_16x16x32_bf16 v[180:183], v[72:75], v[100:103], v[180:183]
  ds_read_b64_tr_b16 v[64:65], v9 offset:49152
  v_mfma_f32_16x16x32_bf16 v[180:183], v[76:79], v[116:119], v[180:183]
  ds_read_b64_tr_b16 v[66:67], v9 offset:51200
  v_mfma_f32_16x16x32_bf16 v[184:187], v[68:71], a[248:251], v[184:187]
  v_mfma_f32_16x16x32_bf16 v[184:187], v[72:75], v[104:107], v[184:187]
  v_mfma_f32_16x16x32_bf16 v[184:187], v[76:79], v[120:123], v[184:187]
  v_mfma_f32_16x16x32_bf16 v[188:191], v[68:71], a[252:255], v[188:191]
  v_mfma_f32_16x16x32_bf16 v[188:191], v[72:75], v[108:111], v[188:191]
  v_mfma_f32_16x16x32_bf16 v[188:191], v[76:79], v[124:127], v[188:191]
  s_waitcnt lgkmcnt(0)
  v_mfma_f32_16x16x32_bf16 v[192:195], v[56:59], a[0:3], 0
  s_waitcnt vmcnt(11)
  s_barrier
  v_mfma_f32_16x16x32_bf16 v[192:195], v[60:63], a[16:19], v[192:195]
  ds_read_b64_tr_b16 v[68:69], v11 offset:8192
  v_mul_f32 v128, v128, v160
  v_mfma_f32_16x16x32_bf16 v[192:195], v[64:67], a[32:35], v[192:195]
  ds_read_b64_tr_b16 v[70:71], v11 offset:10240
  v_mul_f32 v129, v129, v161
  v_mfma_f32_16x16x32_bf16 v[196:199], v[56:59], a[4:7], 0
  ds_read_b64_tr_b16 v[72:73], v11 offset:12288
  v_mul_f32 v130, v130, v162
  v_mfma_f32_16x16x32_bf16 v[196:199], v[60:63], a[20:23], v[196:199]
  ds_read_b64_tr_b16 v[74:75], v11 offset:14336
  v_mul_f32 v131, v131, v163
  v_mfma_f32_16x16x32_bf16 v[196:199], v[64:67], a[36:39], v[196:199]
  ds_read_b64_tr_b16 v[76:77], v12 offset:49152
  v_cvt_pk_bf16_f32 v32, v128, v129
  v_mfma_f32_16x16x32_bf16 v[200:203], v[56:59], a[8:11], 0
  ds_read_b64_tr_b16 v[78:79], v12 offset:51200
  v_cvt_pk_bf16_f32 v33, v130, v131
  v_mfma_f32_16x16x32_bf16 v[200:203], v[60:63], a[24:27], v[200:203]
  s_add_u32 m0, s33, 4096
  v_mul_f32 v144, v144, v176
  v_mfma_f32_16x16x32_bf16 v[200:203], v[64:67], a[40:43], v[200:203]
  s_mov_b32 s34, 2359680
  v_mul_f32 v145, v145, v177
  v_mfma_f32_16x16x32_bf16 v[204:207], v[56:59], a[12:15], 0
  buffer_load_dwordx4 v19, s[4:7], s34 offen lds
  v_mul_f32 v146, v146, v178
  v_mfma_f32_16x16x32_bf16 v[204:207], v[60:63], a[28:31], v[204:207]
  s_add_u32 m0, s33, 81920
  v_mul_f32 v147, v147, v179
  v_mfma_f32_16x16x32_bf16 v[204:207], v[64:67], a[44:47], v[204:207]
  s_mov_b32 s34, 1769856
  buffer_load_dwordx4 v19, s[8:11], s34 offen lds
  s_waitcnt lgkmcnt(0)
  v_mfma_f32_16x16x32_bf16 v[208:211], v[68:71], a[0:3], 0
  ds_read_b64_tr_b16 v[56:57], v8 offset:28672
  v_cvt_pk_bf16_f32 v34, v144, v145
  v_mfma_f32_16x16x32_bf16 v[208:211], v[72:75], a[16:19], v[208:211]
  ds_read_b64_tr_b16 v[58:59], v8 offset:30720
  v_cvt_pk_bf16_f32 v35, v146, v147
  v_mfma_f32_16x16x32_bf16 v[208:211], v[76:79], a[32:35], v[208:211]
  ds_read_b64_tr_b16 v[60:61], v8 offset:32768
  ds_write_b128 v17, v[32:35] offset:16384
  v_mfma_f32_16x16x32_bf16 v[212:215], v[68:71], a[4:7], 0
  ds_read_b64_tr_b16 v[62:63], v8 offset:34816
  s_mov_b32 s61, 16384
  v_mfma_f32_16x16x32_bf16 v[212:215], v[72:75], a[20:23], v[212:215]
  ds_read_b64_tr_b16 v[64:65], v8 offset:36864
  buffer_store_dwordx4 v[32:35], v80, s[28:31], s61 offen sc1
  v_mfma_f32_16x16x32_bf16 v[212:215], v[76:79], a[36:39], v[212:215]
  ds_read_b64_tr_b16 v[66:67], v8 offset:38912
  v_mul_f32 v132, v132, v164
  v_mfma_f32_16x16x32_bf16 v[216:219], v[68:71], a[8:11], 0
  s_add_u32 m0, s33, 86016
  v_mul_f32 v133, v133, v165
  v_mfma_f32_16x16x32_bf16 v[216:219], v[72:75], a[24:27], v[216:219]
  s_mov_b32 s34, 2064768
  v_mul_f32 v134, v134, v166
  v_mfma_f32_16x16x32_bf16 v[216:219], v[76:79], a[40:43], v[216:219]
  buffer_load_dwordx4 v19, s[8:11], s34 offen lds
  v_mul_f32 v135, v135, v167
  v_mfma_f32_16x16x32_bf16 v[220:223], v[68:71], a[12:15], 0
  s_add_u32 m0, s33, 151552
  v_cvt_pk_bf16_f32 v36, v132, v133
  v_mfma_f32_16x16x32_bf16 v[220:223], v[72:75], a[28:31], v[220:223]
  s_mov_b32 s34, 2359680
  v_cvt_pk_bf16_f32 v37, v134, v135
  v_mfma_f32_16x16x32_bf16 v[220:223], v[76:79], a[44:47], v[220:223]
  buffer_load_dwordx4 v19, s[8:11], s34 offen lds
  s_waitcnt lgkmcnt(0)
  v_mfma_f32_16x16x32_bf16 v[224:227], v[56:59], a[0:3], 0
  ds_read_b64_tr_b16 v[68:69], v11 offset:28672
  v_mul_f32 v148, v148, v180
  v_mfma_f32_16x16x32_bf16 v[224:227], v[60:63], a[16:19], v[224:227]
  ds_read_b64_tr_b16 v[70:71], v11 offset:30720
  v_mul_f32 v149, v149, v181
  v_mfma_f32_16x16x32_bf16 v[224:227], v[64:67], a[32:35], v[224:227]
  ds_read_b64_tr_b16 v[72:73], v11 offset:32768
  v_mul_f32 v150, v150, v182
  v_mfma_f32_16x16x32_bf16 v[228:231], v[56:59], a[4:7], 0
  ds_read_b64_tr_b16 v[74:75], v11 offset:34816
  v_mul_f32 v151, v151, v183
  v_mfma_f32_16x16x32_bf16 v[228:231], v[60:63], a[20:23], v[228:231]
  ds_read_b64_tr_b16 v[76:77], v11 offset:36864
  v_cvt_pk_bf16_f32 v38, v148, v149
  v_mfma_f32_16x16x32_bf16 v[228:231], v[64:67], a[36:39], v[228:231]
  ds_read_b64_tr_b16 v[78:79], v11 offset:38912
  v_cvt_pk_bf16_f32 v39, v150, v151
  v_mfma_f32_16x16x32_bf16 v[232:235], v[56:59], a[8:11], 0
  ds_write_b128 v17, v[36:39] offset:17408
  v_mfma_f32_16x16x32_bf16 v[232:235], v[60:63], a[24:27], v[232:235]
  s_mov_b32 s61, 17408
  v_mfma_f32_16x16x32_bf16 v[232:235], v[64:67], a[40:43], v[232:235]
  buffer_store_dwordx4 v[36:39], v80, s[28:31], s61 offen sc1
  v_mfma_f32_16x16x32_bf16 v[236:239], v[56:59], a[12:15], 0
  v_mul_f32 v136, v136, v168
  v_mfma_f32_16x16x32_bf16 v[236:239], v[60:63], a[28:31], v[236:239]
  v_mul_f32 v137, v137, v169
  v_mfma_f32_16x16x32_bf16 v[236:239], v[64:67], a[44:47], v[236:239]
  v_mul_f32 v138, v138, v170
  s_waitcnt lgkmcnt(1)
  v_mfma_f32_16x16x32_bf16 v[240:243], v[68:71], a[0:3], 0
  s_waitcnt vmcnt(9)
  s_barrier
  v_mfma_f32_16x16x32_bf16 v[240:243], v[72:75], a[16:19], v[240:243]
  ds_read_b64_tr_b16 v[56:57], v8 offset:45056
  v_mul_f32 v139, v139, v171
  v_mfma_f32_16x16x32_bf16 v[240:243], v[76:79], a[32:35], v[240:243]
  ds_read_b64_tr_b16 v[58:59], v8 offset:47104
  v_cvt_pk_bf16_f32 v32, v136, v137
  v_mfma_f32_16x16x32_bf16 v[244:247], v[68:71], a[4:7], 0
  ds_read_b64_tr_b16 v[60:61], v8 offset:49152
  v_cvt_pk_bf16_f32 v33, v138, v139
  v_mfma_f32_16x16x32_bf16 v[244:247], v[72:75], a[20:23], v[244:247]
  ds_read_b64_tr_b16 v[62:63], v8 offset:51200
  v_mul_f32 v152, v152, v184
  v_mfma_f32_16x16x32_bf16 v[244:247], v[76:79], a[36:39], v[244:247]
  ds_read_b64_tr_b16 v[64:65], v8 offset:53248
  v_mul_f32 v153, v153, v185
  v_mfma_f32_16x16x32_bf16 v[248:251], v[68:71], a[8:11], 0
  ds_read_b64_tr_b16 v[66:67], v8 offset:55296
  v_mul_f32 v154, v154, v186
  v_mfma_f32_16x16x32_bf16 v[248:251], v[72:75], a[24:27], v[248:251]
  s_add_u32 m0, s33, 8192
  v_mul_f32 v155, v155, v187
  v_mfma_f32_16x16x32_bf16 v[248:251], v[76:79], a[40:43], v[248:251]
  s_mov_b32 s34, 2654592
  v_cvt_pk_bf16_f32 v34, v152, v153
  v_mfma_f32_16x16x32_bf16 v[252:255], v[68:71], a[12:15], 0
  buffer_load_dwordx4 v19, s[4:7], s34 offen lds
  v_cvt_pk_bf16_f32 v35, v154, v155
  v_mfma_f32_16x16x32_bf16 v[252:255], v[72:75], a[28:31], v[252:255]
  s_add_u32 m0, s33, 12288
  ds_write_b128 v17, v[32:35] offset:18432
  v_mfma_f32_16x16x32_bf16 v[252:255], v[76:79], a[44:47], v[252:255]
  s_mov_b32 s34, 2949504
  buffer_load_dwordx4 v19, s[4:7], s34 offen lds
  s_waitcnt lgkmcnt(1)
  v_mfma_f32_16x16x32_bf16 v[192:195], v[56:59], a[48:51], v[192:195]
  ds_read_b64_tr_b16 v[68:69], v11 offset:45056
  s_mov_b32 s61, 18432
  v_mfma_f32_16x16x32_bf16 v[192:195], v[60:63], a[64:67], v[192:195]
  ds_read_b64_tr_b16 v[70:71], v11 offset:47104
  buffer_store_dwordx4 v[32:35], v80, s[28:31], s61 offen sc1
  v_mfma_f32_16x16x32_bf16 v[192:195], v[64:67], a[80:83], v[192:195]
  ds_read_b64_tr_b16 v[72:73], v11 offset:49152
  v_mul_f32 v140, v140, v172
  v_mfma_f32_16x16x32_bf16 v[196:199], v[56:59], a[52:55], v[196:199]
  ds_read_b64_tr_b16 v[74:75], v11 offset:51200
  v_mul_f32 v141, v141, v173
  v_mfma_f32_16x16x32_bf16 v[196:199], v[60:63], a[68:71], v[196:199]
  ds_read_b64_tr_b16 v[76:77], v11 offset:53248
  v_mul_f32 v142, v142, v174
  v_mfma_f32_16x16x32_bf16 v[196:199], v[64:67], a[84:87], v[196:199]
  ds_read_b64_tr_b16 v[78:79], v11 offset:55296
  v_mul_f32 v143, v143, v175
  v_mfma_f32_16x16x32_bf16 v[200:203], v[56:59], a[56:59], v[200:203]
  s_add_u32 m0, s33, 114688
  v_cvt_pk_bf16_f32 v36, v140, v141
  v_mfma_f32_16x16x32_bf16 v[200:203], v[60:63], a[72:75], v[200:203]
  s_mov_b32 s34, 3244416
  v_cvt_pk_bf16_f32 v37, v142, v143
  v_mfma_f32_16x16x32_bf16 v[200:203], v[64:67], a[88:91], v[200:203]
  buffer_load_dwordx4 v19, s[4:7], s34 offen lds
  v_mul_f32 v156, v156, v188
  v_mfma_f32_16x16x32_bf16 v[204:207], v[56:59], a[60:63], v[204:207]
  s_add_u32 m0, s33, 28672
  v_mul_f32 v157, v157, v189
  v_mfma_f32_16x16x32_bf16 v[204:207], v[60:63], a[76:79], v[204:207]
  s_mov_b32 s34, 2654592
  v_mul_f32 v158, v158, v190
  v_mfma_f32_16x16x32_bf16 v[204:207], v[64:67], a[92:95], v[204:207]
  buffer_load_dwordx4 v19, s[8:11], s34 offen lds
  s_waitcnt lgkmcnt(0)
  v_mfma_f32_16x16x32_bf16 v[208:211], v[68:71], a[48:51], v[208:211]
  ds_read_b64_tr_b16 v[56:57], v8 offset:61440
  v_mul_f32 v159, v159, v191
  v_mfma_f32_16x16x32_bf16 v[208:211], v[72:75], a[64:67], v[208:211]
  ds_read_b64_tr_b16 v[58:59], v8 offset:63488
  v_cvt_pk_bf16_f32 v38, v156, v157
  v_mfma_f32_16x16x32_bf16 v[208:211], v[76:79], a[80:83], v[208:211]
  ds_read_b64_tr_b16 v[60:61], v9
  v_cvt_pk_bf16_f32 v39, v158, v159
  v_mfma_f32_16x16x32_bf16 v[212:215], v[68:71], a[52:55], v[212:215]
  ds_read_b64_tr_b16 v[62:63], v9 offset:2048
  ds_write_b128 v17, v[36:39] offset:19456
  v_mfma_f32_16x16x32_bf16 v[212:215], v[72:75], a[68:71], v[212:215]
  ds_read_b64_tr_b16 v[64:65], v9 offset:4096
  s_mov_b32 s61, 19456
  v_mfma_f32_16x16x32_bf16 v[212:215], v[76:79], a[84:87], v[212:215]
  ds_read_b64_tr_b16 v[66:67], v9 offset:6144
  buffer_store_dwordx4 v[36:39], v80, s[28:31], s61 offen sc1
  v_mfma_f32_16x16x32_bf16 v[216:219], v[68:71], a[56:59], v[216:219]
  ds_read_b128 a[0:3], v28 offset:24576
  s_add_u32 m0, s33, 32768
  v_mfma_f32_16x16x32_bf16 v[216:219], v[72:75], a[72:75], v[216:219]
  ds_read_b128 a[4:7], v28 offset:25600
  s_mov_b32 s34, 2949504
  v_mfma_f32_16x16x32_bf16 v[216:219], v[76:79], a[88:91], v[216:219]
  ds_read_b128 a[8:11], v27 offset:53248
  buffer_load_dwordx4 v19, s[8:11], s34 offen lds
  v_mfma_f32_16x16x32_bf16 v[220:223], v[68:71], a[60:63], v[220:223]
  ds_read_b128 a[12:15], v27 offset:54272
  s_add_u32 m0, s33, 36864
  v_mfma_f32_16x16x32_bf16 v[220:223], v[72:75], a[76:79], v[220:223]
  s_mov_b32 s34, 3244416
  v_mfma_f32_16x16x32_bf16 v[220:223], v[76:79], a[92:95], v[220:223]
  buffer_load_dwordx4 v19, s[8:11], s34 offen lds
  s_waitcnt lgkmcnt(4)
  v_mfma_f32_16x16x32_bf16 v[224:227], v[56:59], a[48:51], v[224:227]
  s_waitcnt vmcnt(13)
  s_barrier
  v_mfma_f32_16x16x32_bf16 v[224:227], v[60:63], a[64:67], v[224:227]
  ds_read_b64_tr_b16 v[68:69], v11 offset:61440
  v_mfma_f32_16x16x32_bf16 v[224:227], v[64:67], a[80:83], v[224:227]
  ds_read_b64_tr_b16 v[70:71], v11 offset:63488
  v_mfma_f32_16x16x32_bf16 v[228:231], v[56:59], a[52:55], v[228:231]
  ds_read_b64_tr_b16 v[72:73], v12
  v_mfma_f32_16x16x32_bf16 v[228:231], v[60:63], a[68:71], v[228:231]
  ds_read_b64_tr_b16 v[74:75], v12 offset:2048
  v_mfma_f32_16x16x32_bf16 v[228:231], v[64:67], a[84:87], v[228:231]
  ds_read_b64_tr_b16 v[76:77], v12 offset:4096
  v_mfma_f32_16x16x32_bf16 v[232:235], v[56:59], a[56:59], v[232:235]
  ds_read_b64_tr_b16 v[78:79], v12 offset:6144
  v_mfma_f32_16x16x32_bf16 v[232:235], v[60:63], a[72:75], v[232:235]
  ds_read_b128 a[16:19], v26 offset:16384
  s_add_u32 m0, s33, 45056
  v_mfma_f32_16x16x32_bf16 v[232:235], v[64:67], a[88:91], v[232:235]
  ds_read_b128 a[20:23], v26 offset:17408
  s_mov_b32 s34, 3539328
  v_mfma_f32_16x16x32_bf16 v[236:239], v[56:59], a[60:63], v[236:239]
  ds_read_b128 a[24:27], v26 offset:20480
  buffer_load_dwordx4 v19, s[4:7], s34 offen lds
  v_mfma_f32_16x16x32_bf16 v[236:239], v[60:63], a[76:79], v[236:239]
  ds_read_b128 a[28:31], v26 offset:21504
  s_add_u32 m0, s33, 49152
  v_mfma_f32_16x16x32_bf16 v[236:239], v[64:67], a[92:95], v[236:239]
  s_mov_b32 s34, 3834240
  buffer_load_dwordx4 v19, s[4:7], s34 offen lds
  s_waitcnt lgkmcnt(4)
  v_mfma_f32_16x16x32_bf16 v[240:243], v[68:71], a[48:51], v[240:243]
  ds_read_b64_tr_b16 v[56:57], v9 offset:12288
  v_mfma_f32_16x16x32_bf16 v[240:243], v[72:75], a[64:67], v[240:243]
  ds_read_b64_tr_b16 v[58:59], v9 offset:14336
  v_mfma_f32_16x16x32_bf16 v[240:243], v[76:79], a[80:83], v[240:243]
  ds_read_b64_tr_b16 v[60:61], v8
  v_mfma_f32_16x16x32_bf16 v[244:247], v[68:71], a[52:55], v[244:247]
  ds_read_b64_tr_b16 v[62:63], v8 offset:2048
  v_mfma_f32_16x16x32_bf16 v[244:247], v[72:75], a[68:71], v[244:247]
  ds_read_b64_tr_b16 v[64:65], v8 offset:4096
  v_mfma_f32_16x16x32_bf16 v[244:247], v[76:79], a[84:87], v[244:247]
  ds_read_b64_tr_b16 v[66:67], v8 offset:6144
  v_mfma_f32_16x16x32_bf16 v[248:251], v[68:71], a[56:59], v[248:251]
  ds_read_b128 a[32:35], v26 offset:24576
  s_add_u32 m0, s33, 53248
  v_mfma_f32_16x16x32_bf16 v[248:251], v[72:75], a[72:75], v[248:251]
  ds_read_b128 a[36:39], v26 offset:25600
  s_mov_b32 s34, 4129152
  v_mfma_f32_16x16x32_bf16 v[248:251], v[76:79], a[88:91], v[248:251]
  ds_read_b128 a[40:43], v26 offset:40960
  buffer_load_dwordx4 v19, s[4:7], s34 offen lds
  v_mfma_f32_16x16x32_bf16 v[252:255], v[68:71], a[60:63], v[252:255]
  ds_read_b128 a[44:47], v26 offset:41984
  v_mfma_f32_16x16x32_bf16 v[252:255], v[72:75], a[76:79], v[252:255]
  v_mfma_f32_16x16x32_bf16 v[252:255], v[76:79], a[92:95], v[252:255]
  s_waitcnt lgkmcnt(4)
  v_mfma_f32_16x16x32_bf16 v[192:195], v[56:59], a[96:99], v[192:195]
  ds_read_b64_tr_b16 v[68:69], v12 offset:12288
  v_mfma_f32_16x16x32_bf16 v[192:195], v[60:63], a[112:115], v[192:195]
  ds_read_b64_tr_b16 v[70:71], v12 offset:14336
  v_mfma_f32_16x16x32_bf16 v[192:195], v[64:67], a[128:131], v[192:195]
  ds_read_b64_tr_b16 v[72:73], v11
  v_mfma_f32_16x16x32_bf16 v[196:199], v[56:59], a[100:103], v[196:199]
  ds_read_b64_tr_b16 v[74:75], v11 offset:2048
  v_mfma_f32_16x16x32_bf16 v[196:199], v[60:63], a[116:119], v[196:199]
  ds_read_b64_tr_b16 v[76:77], v11 offset:4096
  v_mfma_f32_16x16x32_bf16 v[196:199], v[64:67], a[132:135], v[196:199]
  ds_read_b64_tr_b16 v[78:79], v11 offset:6144
  v_mfma_f32_16x16x32_bf16 v[200:203], v[56:59], a[104:107], v[200:203]
  v_mfma_f32_16x16x32_bf16 v[200:203], v[60:63], a[120:123], v[200:203]
  v_mfma_f32_16x16x32_bf16 v[200:203], v[64:67], a[136:139], v[200:203]
  v_mfma_f32_16x16x32_bf16 v[204:207], v[56:59], a[108:111], v[204:207]
  v_mfma_f32_16x16x32_bf16 v[204:207], v[60:63], a[124:127], v[204:207]
  v_mfma_f32_16x16x32_bf16 v[204:207], v[64:67], a[140:143], v[204:207]
  s_waitcnt lgkmcnt(0)
  v_mfma_f32_16x16x32_bf16 v[208:211], v[68:71], a[96:99], v[208:211]
  s_waitcnt vmcnt(7)
  s_barrier
  v_mfma_f32_16x16x32_bf16 v[208:211], v[72:75], a[112:115], v[208:211]
  ds_read_b64_tr_b16 v[56:57], v9 offset:16384
  v_mfma_f32_16x16x32_bf16 v[208:211], v[76:79], a[128:131], v[208:211]
  ds_read_b64_tr_b16 v[58:59], v9 offset:18432
  v_mfma_f32_16x16x32_bf16 v[212:215], v[68:71], a[100:103], v[212:215]
  ds_read_b64_tr_b16 v[60:61], v9 offset:20480
  v_mfma_f32_16x16x32_bf16 v[212:215], v[72:75], a[116:119], v[212:215]
  ds_read_b64_tr_b16 v[62:63], v9 offset:22528
  v_mfma_f32_16x16x32_bf16 v[212:215], v[76:79], a[132:135], v[212:215]
  ds_read_b64_tr_b16 v[64:65], v10 offset:20480
  v_mfma_f32_16x16x32_bf16 v[216:219], v[68:71], a[104:107], v[216:219]
  ds_read_b64_tr_b16 v[66:67], v10 offset:22528
  v_mfma_f32_16x16x32_bf16 v[216:219], v[72:75], a[120:123], v[216:219]
  ds_read_b128 a[48:51], v16
  s_add_u32 m0, s33, 155648
  v_mfma_f32_16x16x32_bf16 v[216:219], v[76:79], a[136:139], v[216:219]
  ds_read_b128 a[52:55], v16 offset:1024
  s_mov_b32 s34, 3539328
  v_mfma_f32_16x16x32_bf16 v[220:223], v[68:71], a[108:111], v[220:223]
  ds_read_b128 a[56:59], v16 offset:2048
  buffer_load_dwordx4 v19, s[8:11], s34 offen lds
  v_mfma_f32_16x16x32_bf16 v[220:223], v[72:75], a[124:127], v[220:223]
  ds_read_b128 a[60:63], v16 offset:3072
  s_add_u32 m0, s33, 118784
  v_mfma_f32_16x16x32_bf16 v[220:223], v[76:79], a[140:143], v[220:223]
  s_mov_b32 s34, 3834240
  buffer_load_dwordx4 v19, s[8:11], s34 offen lds
  s_waitcnt lgkmcnt(4)
  v_mfma_f32_16x16x32_bf16 v[224:227], v[56:59], a[96:99], v[224:227]
  ds_read_b64_tr_b16 v[68:69], v12 offset:16384
  v_mfma_f32_16x16x32_bf16 v[224:227], v[60:63], a[112:115], v[224:227]
  ds_read_b64_tr_b16 v[70:71], v12 offset:18432
  v_mfma_f32_16x16x32_bf16 v[224:227], v[64:67], a[128:131], v[224:227]
  ds_read_b64_tr_b16 v[72:73], v12 offset:20480
  v_mfma_f32_16x16x32_bf16 v[228:231], v[56:59], a[100:103], v[228:231]
  ds_read_b64_tr_b16 v[74:75], v12 offset:22528
  v_mfma_f32_16x16x32_bf16 v[228:231], v[60:63], a[116:119], v[228:231]
  ds_read_b64_tr_b16 v[76:77], v13 offset:20480
  v_mfma_f32_16x16x32_bf16 v[228:231], v[64:67], a[132:135], v[228:231]
  ds_read_b64_tr_b16 v[78:79], v13 offset:22528
  v_mfma_f32_16x16x32_bf16 v[232:235], v[56:59], a[104:107], v[232:235]
  ds_read_b128 a[64:67], v16 offset:4096
  s_add_u32 m0, s33, 16384
  v_mfma_f32_16x16x32_bf16 v[232:235], v[60:63], a[120:123], v[232:235]
  ds_read_b128 a[68:71], v16 offset:5120
  s_mov_b32 s34, 4129152
  v_mfma_f32_16x16x32_bf16 v[232:235], v[64:67], a[136:139], v[232:235]
  ds_read_b128 a[72:75], v16 offset:6144
  buffer_load_dwordx4 v19, s[8:11], s34 offen lds
  v_mfma_f32_16x16x32_bf16 v[236:239], v[56:59], a[108:111], v[236:239]
  ds_read_b128 a[76:79], v16 offset:7168
  s_add_u32 m0, s33, 20480
  v_mfma_f32_16x16x32_bf16 v[236:239], v[60:63], a[124:127], v[236:239]
  s_mov_b32 s34, 4424064
  v_mfma_f32_16x16x32_bf16 v[236:239], v[64:67], a[140:143], v[236:239]
  buffer_load_dwordx4 v19, s[4:7], s34 offen lds
  s_waitcnt lgkmcnt(4)
  v_mfma_f32_16x16x32_bf16 v[240:243], v[68:71], a[96:99], v[240:243]
  ds_read_b64_tr_b16 v[56:57], v8 offset:8192
  v_mfma_f32_16x16x32_bf16 v[240:243], v[72:75], a[112:115], v[240:243]
  ds_read_b64_tr_b16 v[58:59], v8 offset:10240
  v_mfma_f32_16x16x32_bf16 v[240:243], v[76:79], a[128:131], v[240:243]
  ds_read_b64_tr_b16 v[60:61], v8 offset:12288
  v_mfma_f32_16x16x32_bf16 v[244:247], v[68:71], a[100:103], v[244:247]
  ds_read_b64_tr_b16 v[62:63], v8 offset:14336
  v_mfma_f32_16x16x32_bf16 v[244:247], v[72:75], a[116:119], v[244:247]
  ds_read_b64_tr_b16 v[64:65], v9 offset:49152
  v_mfma_f32_16x16x32_bf16 v[244:247], v[76:79], a[132:135], v[244:247]
  ds_read_b64_tr_b16 v[66:67], v9 offset:51200
  v_mfma_f32_16x16x32_bf16 v[248:251], v[68:71], a[104:107], v[248:251]
  ds_read_b128 a[80:83], v16 offset:8192
  s_add_u32 m0, s33, 24576
  v_mfma_f32_16x16x32_bf16 v[248:251], v[72:75], a[120:123], v[248:251]
  ds_read_b128 a[84:87], v16 offset:9216
  s_mov_b32 s34, 4718976
  v_mfma_f32_16x16x32_bf16 v[248:251], v[76:79], a[136:139], v[248:251]
  ds_read_b128 a[88:91], v16 offset:10240
  buffer_load_dwordx4 v19, s[4:7], s34 offen lds
  v_mfma_f32_16x16x32_bf16 v[252:255], v[68:71], a[108:111], v[252:255]
  ds_read_b128 a[92:95], v16 offset:11264
  s_add_u32 m0, s33, 40960
  v_mfma_f32_16x16x32_bf16 v[252:255], v[72:75], a[124:127], v[252:255]
  s_mov_b32 s34, 5013888
  v_mfma_f32_16x16x32_bf16 v[252:255], v[76:79], a[140:143], v[252:255]
  buffer_load_dwordx4 v19, s[4:7], s34 offen lds
  s_waitcnt lgkmcnt(4)
  v_mfma_f32_16x16x32_bf16 v[192:195], v[56:59], a[144:147], v[192:195]
  s_waitcnt vmcnt(9)
  s_barrier
  s_mov_b32 s63, 163840
  buffer_store_dword v7, v22, s[96:99], s63 offen sc1
  v_mfma_f32_16x16x32_bf16 v[192:195], v[60:63], a[160:163], v[192:195]
  ds_read_b64_tr_b16 v[68:69], v11 offset:8192
  v_mfma_f32_16x16x32_bf16 v[192:195], v[64:67], a[176:179], v[192:195]
  ds_read_b64_tr_b16 v[70:71], v11 offset:10240
  v_mfma_f32_16x16x32_bf16 v[196:199], v[56:59], a[148:151], v[196:199]
  ds_read_b64_tr_b16 v[72:73], v11 offset:12288
  v_mfma_f32_16x16x32_bf16 v[196:199], v[60:63], a[164:167], v[196:199]
  ds_read_b64_tr_b16 v[74:75], v11 offset:14336
  v_mfma_f32_16x16x32_bf16 v[196:199], v[64:67], a[180:183], v[196:199]
  ds_read_b64_tr_b16 v[76:77], v12 offset:49152
  v_mfma_f32_16x16x32_bf16 v[200:203], v[56:59], a[152:155], v[200:203]
  ds_read_b64_tr_b16 v[78:79], v12 offset:51200
  v_mfma_f32_16x16x32_bf16 v[200:203], v[60:63], a[168:171], v[200:203]
  s_add_u32 m0, s33, 126976
  v_mfma_f32_16x16x32_bf16 v[200:203], v[64:67], a[184:187], v[200:203]
  s_mov_b32 s34, 4424064
  v_mfma_f32_16x16x32_bf16 v[204:207], v[56:59], a[156:159], v[204:207]
  buffer_load_dwordx4 v19, s[8:11], s34 offen lds
  v_mfma_f32_16x16x32_bf16 v[204:207], v[60:63], a[172:175], v[204:207]
  s_add_u32 m0, s33, 131072
  v_mfma_f32_16x16x32_bf16 v[204:207], v[64:67], a[188:191], v[204:207]
  s_mov_b32 s34, 4718976
  buffer_load_dwordx4 v19, s[8:11], s34 offen lds
  s_waitcnt lgkmcnt(0)
  v_mfma_f32_16x16x32_bf16 v[208:211], v[68:71], a[144:147], v[208:211]
  ds_read_b64_tr_b16 v[56:57], v8 offset:28672
  v_mfma_f32_16x16x32_bf16 v[208:211], v[72:75], a[160:163], v[208:211]
  ds_read_b64_tr_b16 v[58:59], v8 offset:30720
  v_mfma_f32_16x16x32_bf16 v[208:211], v[76:79], a[176:179], v[208:211]
  ds_read_b64_tr_b16 v[60:61], v8 offset:32768
  v_mfma_f32_16x16x32_bf16 v[212:215], v[68:71], a[148:151], v[212:215]
  ds_read_b64_tr_b16 v[62:63], v8 offset:34816
  v_mfma_f32_16x16x32_bf16 v[212:215], v[72:75], a[164:167], v[212:215]
  ds_read_b64_tr_b16 v[64:65], v8 offset:36864
  v_mfma_f32_16x16x32_bf16 v[212:215], v[76:79], a[180:183], v[212:215]
  ds_read_b64_tr_b16 v[66:67], v8 offset:38912
  v_mfma_f32_16x16x32_bf16 v[216:219], v[68:71], a[152:155], v[216:219]
  ds_read_b128 a[96:99], v26 offset:57344
  s_add_u32 m0, s33, 90112
  v_mfma_f32_16x16x32_bf16 v[216:219], v[72:75], a[168:171], v[216:219]
  ds_read_b128 a[100:103], v26 offset:58368
  s_mov_b32 s34, 5013888
  v_mfma_f32_16x16x32_bf16 v[216:219], v[76:79], a[184:187], v[216:219]
  ds_read_b128 a[104:107], v27 offset:8192
  buffer_load_dwordx4 v19, s[8:11], s34 offen lds
  v_mfma_f32_16x16x32_bf16 v[220:223], v[68:71], a[156:159], v[220:223]
  ds_read_b128 a[108:111], v27 offset:9216
  v_mfma_f32_16x16x32_bf16 v[220:223], v[72:75], a[172:175], v[220:223]
  v_mfma_f32_16x16x32_bf16 v[220:223], v[76:79], a[188:191], v[220:223]
  s_waitcnt lgkmcnt(4)
  v_mfma_f32_16x16x32_bf16 v[224:227], v[56:59], a[144:147], v[224:227]
  ds_read_b64_tr_b16 v[68:69], v11 offset:28672
  v_mfma_f32_16x16x32_bf16 v[224:227], v[60:63], a[160:163], v[224:227]
  ds_read_b64_tr_b16 v[70:71], v11 offset:30720
  s_mov_b32 s63, 163840
  buffer_load_dword v31, v91, s[96:99], s63 offen sc1
  v_mfma_f32_16x16x32_bf16 v[224:227], v[64:67], a[176:179], v[224:227]
  ds_read_b64_tr_b16 v[72:73], v11 offset:32768
  v_mfma_f32_16x16x32_bf16 v[228:231], v[56:59], a[148:151], v[228:231]
  ds_read_b64_tr_b16 v[74:75], v11 offset:34816
  v_mfma_f32_16x16x32_bf16 v[228:231], v[60:63], a[164:167], v[228:231]
  ds_read_b64_tr_b16 v[76:77], v11 offset:36864
  v_mfma_f32_16x16x32_bf16 v[228:231], v[64:67], a[180:183], v[228:231]
  ds_read_b64_tr_b16 v[78:79], v11 offset:38912
  v_mfma_f32_16x16x32_bf16 v[232:235], v[56:59], a[152:155], v[232:235]
  ds_read_b128 a[112:115], v16 offset:12288
  s_add_u32 m0, s33, 94208
  v_mfma_f32_16x16x32_bf16 v[232:235], v[60:63], a[168:171], v[232:235]
  ds_read_b128 a[116:119], v16 offset:13312
  s_mov_b32 s34, 0
  v_mfma_f32_16x16x32_bf16 v[232:235], v[64:67], a[184:187], v[232:235]
  ds_read_b128 a[120:123], v16 offset:14336
  buffer_load_dwordx4 v82, s[12:15], s34 offen lds
  v_mfma_f32_16x16x32_bf16 v[236:239], v[56:59], a[156:159], v[236:239]
  ds_read_b128 a[124:127], v16 offset:15360
  s_add_u32 m0, s33, 61440
  v_mfma_f32_16x16x32_bf16 v[236:239], v[60:63], a[172:175], v[236:239]
  s_mov_b32 s34, 36864
  v_mfma_f32_16x16x32_bf16 v[236:239], v[64:67], a[188:191], v[236:239]
  buffer_load_dwordx4 v82, s[12:15], s34 offen lds
  s_waitcnt lgkmcnt(4)
  v_mfma_f32_16x16x32_bf16 v[240:243], v[68:71], a[144:147], v[240:243]
  s_waitcnt vmcnt(10)
  s_barrier
  v_mfma_f32_16x16x32_bf16 v[240:243], v[72:75], a[160:163], v[240:243]
  ds_read_b64_tr_b16 v[56:57], v8 offset:45056
  v_mfma_f32_16x16x32_bf16 v[240:243], v[76:79], a[176:179], v[240:243]
  ds_read_b64_tr_b16 v[58:59], v8 offset:47104
  v_mfma_f32_16x16x32_bf16 v[244:247], v[68:71], a[148:151], v[244:247]
  ds_read_b64_tr_b16 v[60:61], v8 offset:49152
  v_mfma_f32_16x16x32_bf16 v[244:247], v[72:75], a[164:167], v[244:247]
  ds_read_b64_tr_b16 v[62:63], v8 offset:51200
  v_mfma_f32_16x16x32_bf16 v[244:247], v[76:79], a[180:183], v[244:247]
  ds_read_b64_tr_b16 v[64:65], v8 offset:53248
  v_mfma_f32_16x16x32_bf16 v[248:251], v[68:71], a[152:155], v[248:251]
  ds_read_b64_tr_b16 v[66:67], v8 offset:55296
  v_mfma_f32_16x16x32_bf16 v[248:251], v[72:75], a[168:171], v[248:251]
  ds_read_b128 a[128:131], v16 offset:16384
  s_add_u32 m0, s33, 135168
  v_mfma_f32_16x16x32_bf16 v[248:251], v[76:79], a[184:187], v[248:251]
  ds_read_b128 a[132:135], v16 offset:17408
  s_mov_b32 s34, 73728
  v_mfma_f32_16x16x32_bf16 v[252:255], v[68:71], a[156:159], v[252:255]
  ds_read_b128 a[136:139], v16 offset:18432
  buffer_load_dwordx4 v82, s[12:15], s34 offen lds
  v_mfma_f32_16x16x32_bf16 v[252:255], v[72:75], a[172:175], v[252:255]
  ds_read_b128 a[140:143], v16 offset:19456
  v_mfma_f32_16x16x32_bf16 v[252:255], v[76:79], a[188:191], v[252:255]
  s_waitcnt lgkmcnt(4)
  v_mfma_f32_16x16x32_bf16 v[192:195], v[56:59], a[192:195], v[192:195]
  ds_read_b64_tr_b16 v[68:69], v11 offset:45056
  s_add_u32 m0, s33, 98304
  v_mfma_f32_16x16x32_bf16 v[192:195], v[60:63], a[208:211], v[192:195]
  ds_read_b64_tr_b16 v[70:71], v11 offset:47104
  s_mov_b32 s34, 0
  v_mfma_f32_16x16x32_bf16 v[192:195], v[64:67], a[224:227], v[192:195]
  ds_read_b64_tr_b16 v[72:73], v11 offset:49152
  buffer_load_dwordx4 v84, s[12:15], s34 offen lds
  v_mfma_f32_16x16x32_bf16 v[196:199], v[56:59], a[196:199], v[196:199]
  ds_read_b64_tr_b16 v[74:75], v11 offset:51200
  s_add_u32 m0, s33, 65536
  v_mfma_f32_16x16x32_bf16 v[196:199], v[60:63], a[212:215], v[196:199]
  ds_read_b64_tr_b16 v[76:77], v11 offset:53248
  s_mov_b32 s34, 36864
  v_mfma_f32_16x16x32_bf16 v[196:199], v[64:67], a[228:231], v[196:199]
  ds_read_b64_tr_b16 v[78:79], v11 offset:55296
  buffer_load_dwordx4 v84, s[12:15], s34 offen lds
  v_mfma_f32_16x16x32_bf16 v[200:203], v[56:59], a[200:203], v[200:203]
  s_add_u32 m0, s33, 69632
  v_mfma_f32_16x16x32_bf16 v[200:203], v[60:63], a[216:219], v[200:203]
  s_mov_b32 s34, 73728
  v_mfma_f32_16x16x32_bf16 v[200:203], v[64:67], a[232:235], v[200:203]
  buffer_load_dwordx4 v84, s[12:15], s34 offen lds
  v_mfma_f32_16x16x32_bf16 v[204:207], v[56:59], a[204:207], v[204:207]
  v_mfma_f32_16x16x32_bf16 v[204:207], v[60:63], a[220:223], v[204:207]
  v_mfma_f32_16x16x32_bf16 v[204:207], v[64:67], a[236:239], v[204:207]
  s_waitcnt lgkmcnt(0)
  v_mfma_f32_16x16x32_bf16 v[208:211], v[68:71], a[192:195], v[208:211]
  ds_read_b64_tr_b16 v[56:57], v10 offset:24576
  v_mfma_f32_16x16x32_bf16 v[208:211], v[72:75], a[208:211], v[208:211]
  ds_read_b64_tr_b16 v[58:59], v10 offset:26624
  s_waitcnt vmcnt(6)
  v_cmp_ne_u32 vcc, v7, v31
  s_cbranch_vccnz L_sp_24
L_bk_25:
  v_mfma_f32_16x16x32_bf16 v[208:211], v[76:79], a[224:227], v[208:211]
  ds_read_b64_tr_b16 v[60:61], v9 offset:53248
  s_mov_b32 s65, 32768
  v_mfma_f32_16x16x32_bf16 v[212:215], v[68:71], a[196:199], v[212:215]
  ds_read_b64_tr_b16 v[62:63], v9 offset:55296
  buffer_load_dwordx2 a[176:177], v90, s[68:71], s65 offen sc1
  v_mfma_f32_16x16x32_bf16 v[212:215], v[72:75], a[212:215], v[212:215]
  ds_read_b64_tr_b16 v[64:65], v8 offset:16384
  buffer_load_dwordx2 a[178:179], v90, s[68:71], s65 offen offset:512 sc1
  v_mfma_f32_16x16x32_bf16 v[212:215], v[76:79], a[228:231], v[212:215]
  ds_read_b64_tr_b16 v[66:67], v8 offset:18432
  buffer_load_dwordx2 a[180:181], v90, s[68:71], s65 offen offset:1024 sc1
  v_mfma_f32_16x16x32_bf16 v[216:219], v[68:71], a[200:203], v[216:219]
  ds_read_b128 a[144:147], v16 offset:20480
  buffer_load_dwordx2 a[182:183], v90, s[68:71], s65 offen offset:1536 sc1
  v_mfma_f32_16x16x32_bf16 v[216:219], v[72:75], a[216:219], v[216:219]
  ds_read_b128 a[148:151], v16 offset:21504
  buffer_load_dwordx2 a[184:185], v90, s[68:71], s65 offen offset:2048 sc1
  v_mfma_f32_16x16x32_bf16 v[216:219], v[76:79], a[232:235], v[216:219]
  ds_read_b128 a[152:155], v16 offset:22528
  buffer_load_dwordx2 a[186:187], v90, s[68:71], s65 offen offset:2560 sc1
  v_mfma_f32_16x16x32_bf16 v[220:223], v[68:71], a[204:207], v[220:223]
  ds_read_b128 a[156:159], v16 offset:23552
  buffer_load_dwordx2 a[188:189], v90, s[68:71], s65 offen offset:3072 sc1
  v_mfma_f32_16x16x32_bf16 v[220:223], v[72:75], a[220:223], v[220:223]
  buffer_load_dwordx2 a[190:191], v90, s[68:71], s65 offen offset:3584 sc1
  v_mfma_f32_16x16x32_bf16 v[220:223], v[76:79], a[236:239], v[220:223]
  s_waitcnt lgkmcnt(4)
  v_mfma_f32_16x16x32_bf16 v[224:227], v[56:59], a[192:195], v[224:227]
  s_barrier
  v_mfma_f32_16x16x32_bf16 v[224:227], v[60:63], a[208:211], v[224:227]
  ds_read_b64_tr_b16 v[68:69], v13 offset:24576
  s_add_u32 m0, s33, 139264
  v_mfma_f32_16x16x32_bf16 v[224:227], v[64:67], a[224:227], v[224:227]
  ds_read_b64_tr_b16 v[70:71], v13 offset:26624
  s_mov_b32 s34, 16384
  v_mfma_f32_16x16x32_bf16 v[228:231], v[56:59], a[196:199], v[228:231]
  ds_read_b64_tr_b16 v[72:73], v12 offset:53248
  buffer_load_dwordx4 v88, s[68:71], s34 offen sc1 lds
  v_mfma_f32_16x16x32_bf16 v[228:231], v[60:63], a[212:215], v[228:231]
  ds_read_b64_tr_b16 v[74:75], v12 offset:55296
  s_add_u32 m0, s33, 102400
  v_mfma_f32_16x16x32_bf16 v[228:231], v[64:67], a[228:231], v[228:231]
  ds_read_b64_tr_b16 v[76:77], v11 offset:16384
  s_mov_b32 s34, 110592
  v_mfma_f32_16x16x32_bf16 v[232:235], v[56:59], a[200:203], v[232:235]
  ds_read_b64_tr_b16 v[78:79], v11 offset:18432
  buffer_load_dwordx4 v82, s[12:15], s34 offen lds
  v_mfma_f32_16x16x32_bf16 v[232:235], v[60:63], a[216:219], v[232:235]
  ds_read_b128 a[160:163], v16 offset:32768
  s_add_u32 m0, s33, 106496
  v_mfma_f32_16x16x32_bf16 v[232:235], v[64:67], a[232:235], v[232:235]
  ds_read_b128 a[164:167], v16 offset:33792
  s_mov_b32 s34, 147456
  v_mfma_f32_16x16x32_bf16 v[236:239], v[56:59], a[204:207], v[236:239]
  ds_read_b128 a[168:171], v16 offset:34816
  buffer_load_dwordx4 v82, s[12:15], s34 offen lds
  v_mfma_f32_16x16x32_bf16 v[236:239], v[60:63], a[220:223], v[236:239]
  ds_read_b128 a[172:175], v16 offset:35840
  v_mfma_f32_16x16x32_bf16 v[236:239], v[64:67], a[236:239], v[236:239]
  s_waitcnt lgkmcnt(4)
  v_mfma_f32_16x16x32_bf16 v[240:243], v[68:71], a[192:195], v[240:243]
  ds_read_b64_tr_b16 v[56:57], v8 offset:20480
  v_mfma_f32_16x16x32_bf16 v[240:243], v[72:75], a[208:211], v[240:243]
  ds_read_b64_tr_b16 v[58:59], v8 offset:22528
  v_mfma_f32_16x16x32_bf16 v[240:243], v[76:79], a[224:227], v[240:243]
  ds_read_b64_tr_b16 v[60:61], v8 offset:24576
  v_mfma_f32_16x16x32_bf16 v[244:247], v[68:71], a[196:199], v[244:247]
  ds_read_b64_tr_b16 v[62:63], v8 offset:26624
  v_mfma_f32_16x16x32_bf16 v[244:247], v[72:75], a[212:215], v[244:247]
  ds_read_b64_tr_b16 v[64:65], v8 offset:40960
  v_mfma_f32_16x16x32_bf16 v[244:247], v[76:79], a[228:231], v[244:247]
  ds_read_b64_tr_b16 v[66:67], v8 offset:43008
  v_mfma_f32_16x16x32_bf16 v[248:251], v[68:71], a[200:203], v[248:251]
  s_add_u32 m0, s33, 143360
  v_mfma_f32_16x16x32_bf16 v[248:251], v[72:75], a[216:219], v[248:251]
  s_mov_b32 s34, 184320
  v_mfma_f32_16x16x32_bf16 v[248:251], v[76:79], a[232:235], v[248:251]
  buffer_load_dwordx4 v82, s[12:15], s34 offen lds
  v_mfma_f32_16x16x32_bf16 v[252:255], v[68:71], a[204:207], v[252:255]
  v_mfma_f32_16x16x32_bf16 v[252:255], v[72:75], a[220:223], v[252:255]
  v_mfma_f32_16x16x32_bf16 v[252:255], v[76:79], a[236:239], v[252:255]
  s_waitcnt lgkmcnt(0)
  v_mfma_f32_16x16x32_bf16 v[192:195], v[56:59], a[240:243], v[192:195]
  ds_read_b64_tr_b16 v[68:69], v11 offset:20480
  s_add_u32 m0, s33, 77824
  v_mfma_f32_16x16x32_bf16 v[192:195], v[60:63], v[96:99], v[192:195]
  ds_read_b64_tr_b16 v[70:71], v11 offset:22528
  s_mov_b32 s34, 18432
  v_mfma_f32_16x16x32_bf16 v[192:195], v[64:67], v[112:115], v[192:195]
  ds_read_b64_tr_b16 v[72:73], v11 offset:24576
  buffer_load_dwordx4 v88, s[68:71], s34 offen sc1 lds
  v_mfma_f32_16x16x32_bf16 v[196:199], v[56:59], a[244:247], v[196:199]
  ds_read_b64_tr_b16 v[74:75], v11 offset:26624
  s_add_u32 m0, s33, 0
  v_mfma_f32_16x16x32_bf16 v[196:199], v[60:63], v[100:103], v[196:199]
  ds_read_b64_tr_b16 v[76:77], v11 offset:40960
  s_mov_b32 s34, 110592
  v_mfma_f32_16x16x32_bf16 v[196:199], v[64:67], v[116:119], v[196:199]
  ds_read_b64_tr_b16 v[78:79], v11 offset:43008
  buffer_load_dwordx4 v84, s[12:15], s34 offen lds
  v_mfma_f32_16x16x32_bf16 v[200:203], v[56:59], a[248:251], v[200:203]
  s_add_u32 m0, s33, 4096
  v_mfma_f32_16x16x32_bf16 v[200:203], v[60:63], v[104:107], v[200:203]
  s_mov_b32 s34, 0
  v_mfma_f32_16x16x32_bf16 v[200:203], v[64:67], v[120:123], v[200:203]
  buffer_load_dwordx4 v83, s[12:15], s34 offen lds
  v_mfma_f32_16x16x32_bf16 v[204:207], v[56:59], a[252:255], v[204:207]
  v_mfma_f32_16x16x32_bf16 v[204:207], v[60:63], v[108:111], v[204:207]
  v_mfma_f32_16x16x32_bf16 v[204:207], v[64:67], v[124:127], v[204:207]
  s_waitcnt lgkmcnt(0)
  v_mfma_f32_16x16x32_bf16 v[208:211], v[68:71], a[240:243], v[208:211]
  s_waitcnt vmcnt(18)
  s_barrier
  v_mfma_f32_16x16x32_bf16 v[208:211], v[72:75], v[96:99], v[208:211]
  ds_read_b64_tr_b16 v[56:57], v9 offset:61440
  v_mfma_f32_16x16x32_bf16 v[208:211], v[76:79], v[112:115], v[208:211]
  ds_read_b64_tr_b16 v[58:59], v9 offset:63488
  v_mfma_f32_16x16x32_bf16 v[212:215], v[68:71], a[244:247], v[212:215]
  ds_read_b64_tr_b16 v[60:61], v10
  v_mfma_f32_16x16x32_bf16 v[212:215], v[72:75], v[100:103], v[212:215]
  ds_read_b64_tr_b16 v[62:63], v10 offset:2048
  v_mfma_f32_16x16x32_bf16 v[212:215], v[76:79], v[116:119], v[212:215]
  ds_read_b64_tr_b16 v[64:65], v9 offset:24576
  v_mfma_f32_16x16x32_bf16 v[216:219], v[68:71], a[248:251], v[216:219]
  ds_read_b64_tr_b16 v[66:67], v9 offset:26624
  v_mfma_f32_16x16x32_bf16 v[216:219], v[72:75], v[104:107], v[216:219]
  s_add_u32 m0, s33, 110592
  v_mfma_f32_16x16x32_bf16 v[216:219], v[76:79], v[120:123], v[216:219]
  s_mov_b32 s34, 0
  v_mfma_f32_16x16x32_bf16 v[220:223], v[68:71], a[252:255], v[220:223]
  buffer_load_dwordx4 v85, s[12:15], s34 offen lds
  v_mfma_f32_16x16x32_bf16 v[220:223], v[72:75], v[108:111], v[220:223]
  v_mfma_f32_16x16x32_bf16 v[220:223], v[76:79], v[124:127], v[220:223]
  s_waitcnt lgkmcnt(0)
  v_mfma_f32_16x16x32_bf16 v[224:227], v[56:59], a[240:243], v[224:227]
  ds_read_b64_tr_b16 v[68:69], v12 offset:61440
  s_add_u32 m0, s33, 159744
  v_mfma_f32_16x16x32_bf16 v[224:227], v[60:63], v[96:99], v[224:227]
  ds_read_b64_tr_b16 v[70:71], v12 offset:63488
  s_mov_b32 s34, 20480
  v_mfma_f32_16x16x32_bf16 v[224:227], v[64:67], v[112:115], v[224:227]
  ds_read_b64_tr_b16 v[72:73], v13
  buffer_load_dwordx4 v88, s[68:71], s34 offen sc1 lds
  v_mfma_f32_16x16x32_bf16 v[228:231], v[56:59], a[244:247], v[228:231]
  ds_read_b64_tr_b16 v[74:75], v13 offset:2048
  s_add_u32 m0, s33, 122880
  v_mfma_f32_16x16x32_bf16 v[228:231], v[60:63], v[100:103], v[228:231]
  ds_read_b64_tr_b16 v[76:77], v12 offset:24576
  s_mov_b32 s34, 147456
  v_mfma_f32_16x16x32_bf16 v[228:231], v[64:67], v[116:119], v[228:231]
  ds_read_b64_tr_b16 v[78:79], v12 offset:26624
  buffer_load_dwordx4 v84, s[12:15], s34 offen lds
  v_mfma_f32_16x16x32_bf16 v[232:235], v[56:59], a[248:251], v[232:235]
  s_add_u32 m0, s33, 147456
  v_mfma_f32_16x16x32_bf16 v[232:235], v[60:63], v[104:107], v[232:235]
  s_mov_b32 s34, 184320
  v_mfma_f32_16x16x32_bf16 v[232:235], v[64:67], v[120:123], v[232:235]
  buffer_load_dwordx4 v84, s[12:15], s34 offen lds
  v_mfma_f32_16x16x32_bf16 v[236:239], v[56:59], a[252:255], v[236:239]
  v_mfma_f32_16x16x32_bf16 v[236:239], v[60:63], v[108:111], v[236:239]
  v_mfma_f32_16x16x32_bf16 v[236:239], v[64:67], v[124:127], v[236:239]
  s_waitcnt lgkmcnt(0)
  v_mfma_f32_16x16x32_bf16 v[240:243], v[68:71], a[240:243], v[240:243]
  ds_read_b64_tr_b16 v[56:57], v9 offset:28672
  v_mfma_f32_16x16x32_bf16 v[240:243], v[72:75], v[96:99], v[240:243]
  ds_read_b64_tr_b16 v[58:59], v9 offset:30720
  v_mfma_f32_16x16x32_bf16 v[240:243], v[76:79], v[112:115], v[240:243]
  ds_read_b64_tr_b16 v[60:61], v8 offset:61440
  v_mfma_f32_16x16x32_bf16 v[244:247], v[68:71], a[244:247], v[244:247]
  ds_read_b64_tr_b16 v[62:63], v8 offset:63488
  v_mfma_f32_16x16x32_bf16 v[244:247], v[72:75], v[100:103], v[244:247]
  ds_read_b64_tr_b16 v[64:65], v10 offset:4096
  v_mfma_f32_16x16x32_bf16 v[244:247], v[76:79], v[116:119], v[244:247]
  ds_read_b64_tr_b16 v[66:67], v10 offset:6144
  v_mfma_f32_16x16x32_bf16 v[248:251], v[68:71], a[248:251], v[248:251]
  s_add_u32 m0, s33, 81920
  v_mfma_f32_16x16x32_bf16 v[248:251], v[72:75], v[104:107], v[248:251]
  s_mov_b32 s34, 22528
  v_mfma_f32_16x16x32_bf16 v[248:251], v[76:79], v[120:123], v[248:251]
  buffer_load_dwordx4 v88, s[68:71], s34 offen sc1 lds
  v_mfma_f32_16x16x32_bf16 v[252:255], v[68:71], a[252:255], v[252:255]
  s_add_u32 m0, s33, 86016
  v_mfma_f32_16x16x32_bf16 v[252:255], v[72:75], v[108:111], v[252:255]
  s_mov_b32 s34, 221184
  v_mfma_f32_16x16x32_bf16 v[252:255], v[76:79], v[124:127], v[252:255]
  buffer_load_dwordx4 v82, s[12:15], s34 offen lds
  s_waitcnt lgkmcnt(0)
  v_mfma_f32_16x16x32_bf16 v[128:131], v[56:59], a[48:51], 0
  s_waitcnt vmcnt(21)
  s_barrier
  v_mfma_f32_16x16x32_bf16 v[128:131], v[60:63], a[64:67], v[128:131]
  ds_read_b64_tr_b16 v[68:69], v12 offset:28672
  s_add_u32 m0, s33, 57344
  v_mul_f32 v192, v192, v224
  v_mfma_f32_16x16x32_bf16 v[128:131], v[64:67], a[80:83], v[128:131]
  ds_read_b64_tr_b16 v[70:71], v12 offset:30720
  s_mov_b32 s34, 128
  v_mul_f32 v193, v193, v225
  v_mfma_f32_16x16x32_bf16 v[132:135], v[56:59], a[52:55], 0
  ds_read_b64_tr_b16 v[72:73], v11 offset:61440
  buffer_load_dwordx4 v82, s[12:15], s34 offen lds
  v_mul_f32 v194, v194, v226
  v_mfma_f32_16x16x32_bf16 v[132:135], v[60:63], a[68:71], v[132:135]
  ds_read_b64_tr_b16 v[74:75], v11 offset:63488
  s_add_u32 m0, s33, 73728
  v_mul_f32 v195, v195, v227
  v_mfma_f32_16x16x32_bf16 v[132:135], v[64:67], a[84:87], v[132:135]
  ds_read_b64_tr_b16 v[76:77], v13 offset:4096
  s_mov_b32 s34, 36992
  v_cvt_pk_bf16_f32 v32, v192, v193
  v_mfma_f32_16x16x32_bf16 v[136:139], v[56:59], a[56:59], 0
  ds_read_b64_tr_b16 v[78:79], v13 offset:6144
  buffer_load_dwordx4 v82, s[12:15], s34 offen lds
  v_cvt_pk_bf16_f32 v33, v194, v195
  v_mfma_f32_16x16x32_bf16 v[136:139], v[60:63], a[72:75], v[136:139]
  s_add_u32 m0, s33, 8192
  v_mul_f32 v208, v208, v240
  v_mul_f32 v209, v209, v241
  v_mfma_f32_16x16x32_bf16 v[136:139], v[64:67], a[88:91], v[136:139]
  s_mov_b32 s34, 73856
  v_mul_f32 v210, v210, v242
  v_mul_f32 v211, v211, v243
  v_mfma_f32_16x16x32_bf16 v[140:143], v[56:59], a[60:63], 0
  buffer_load_dwordx4 v82, s[12:15], s34 offen lds
  v_cvt_pk_bf16_f32 v34, v208, v209
  v_cvt_pk_bf16_f32 v35, v210, v211
  v_mfma_f32_16x16x32_bf16 v[140:143], v[60:63], a[76:79], v[140:143]
  ds_write_b128 v17, v[32:35] offset:24576
  s_mov_b32 s61, 24576
  v_mfma_f32_16x16x32_bf16 v[140:143], v[64:67], a[92:95], v[140:143]
  buffer_store_dwordx4 v[32:35], v80, s[28:31], s61 offen sc1
  v_mul_f32 v196, v196, v228
  s_waitcnt lgkmcnt(1)
  v_mfma_f32_16x16x32_bf16 v[144:147], v[68:71], a[48:51], 0
  ds_read_b64_tr_b16 v[56:57], v9 offset:32768
  v_mul_f32 v197, v197, v229
  v_mul_f32 v198, v198, v230
  v_mfma_f32_16x16x32_bf16 v[144:147], v[72:75], a[64:67], v[144:147]
  ds_read_b64_tr_b16 v[58:59], v9 offset:34816
  v_mul_f32 v199, v199, v231
  v_cvt_pk_bf16_f32 v36, v196, v197
  v_mfma_f32_16x16x32_bf16 v[144:147], v[76:79], a[80:83], v[144:147]
  ds_read_b64_tr_b16 v[60:61], v9
  v_cvt_pk_bf16_f32 v37, v198, v199
  v_mul_f32 v212, v212, v244
  v_mfma_f32_16x16x32_bf16 v[148:151], v[68:71], a[52:55], 0
  ds_read_b64_tr_b16 v[62:63], v9 offset:2048
  v_mul_f32 v213, v213, v245
  v_mul_f32 v214, v214, v246
  v_mfma_f32_16x16x32_bf16 v[148:151], v[72:75], a[68:71], v[148:151]
  ds_read_b64_tr_b16 v[64:65], v9 offset:4096
  v_mul_f32 v215, v215, v247
  v_cvt_pk_bf16_f32 v38, v212, v213
  v_mfma_f32_16x16x32_bf16 v[148:151], v[76:79], a[84:87], v[148:151]
  ds_read_b64_tr_b16 v[66:67], v9 offset:6144
  v_cvt_pk_bf16_f32 v39, v214, v215
  ds_write_b128 v17, v[36:39] offset:25600
  v_mfma_f32_16x16x32_bf16 v[152:155], v[68:71], a[56:59], 0
  s_mov_b32 s61, 25600
  buffer_store_dwordx4 v[36:39], v80, s[28:31], s61 offen sc1
  v_mfma_f32_16x16x32_bf16 v[152:155], v[72:75], a[72:75], v[152:155]
  v_mul_f32 v200, v200, v232
  v_mul_f32 v201, v201, v233
  v_mfma_f32_16x16x32_bf16 v[152:155], v[76:79], a[88:91], v[152:155]
  v_mul_f32 v202, v202, v234
  v_mul_f32 v203, v203, v235
  v_mfma_f32_16x16x32_bf16 v[156:159], v[68:71], a[60:63], 0
  v_cvt_pk_bf16_f32 v32, v200, v201
  v_cvt_pk_bf16_f32 v33, v202, v203
  v_mfma_f32_16x16x32_bf16 v[156:159], v[72:75], a[76:79], v[156:159]
  v_mul_f32 v216, v216, v248
  v_mul_f32 v217, v217, v249
  v_mfma_f32_16x16x32_bf16 v[156:159], v[76:79], a[92:95], v[156:159]
  v_mul_f32 v218, v218, v250
  v_mul_f32 v219, v219, v251
  s_waitcnt lgkmcnt(1)
  v_mfma_f32_16x16x32_bf16 v[128:131], v[56:59], a[0:3], v[128:131]
  ds_read_b64_tr_b16 v[68:69], v12 offset:32768
  s_add_u32 m0, s33, 12288
  v_cvt_pk_bf16_f32 v34, v216, v217
  v_mfma_f32_16x16x32_bf16 v[128:131], v[60:63], a[16:19], v[128:131]
  ds_read_b64_tr_b16 v[70:71], v12 offset:34816
  s_mov_b32 s34, 128
  v_cvt_pk_bf16_f32 v35, v218, v219
  v_mfma_f32_16x16x32_bf16 v[128:131], v[64:67], a[32:35], v[128:131]
  ds_read_b64_tr_b16 v[72:73], v12
  buffer_load_dwordx4 v84, s[12:15], s34 offen lds
  ds_write_b128 v17, v[32:35] offset:26624
  v_mfma_f32_16x16x32_bf16 v[132:135], v[56:59], a[4:7], v[132:135]
  ds_read_b64_tr_b16 v[74:75], v12 offset:2048
  s_add_u32 m0, s33, 28672
  s_mov_b32 s61, 26624
  v_mfma_f32_16x16x32_bf16 v[132:135], v[60:63], a[20:23], v[132:135]
  ds_read_b64_tr_b16 v[76:77], v12 offset:4096
  s_mov_b32 s34, 36992
  buffer_store_dwordx4 v[32:35], v80, s[28:31], s61 offen sc1
  v_mfma_f32_16x16x32_bf16 v[132:135], v[64:67], a[36:39], v[132:135]
  ds_read_b64_tr_b16 v[78:79], v12 offset:6144
  buffer_load_dwordx4 v84, s[12:15], s34 offen lds
  v_mul_f32 v204, v204, v236
  v_mfma_f32_16x16x32_bf16 v[136:139], v[56:59], a[8:11], v[136:139]
  s_add_u32 m0, s33, 32768
  v_mul_f32 v205, v205, v237
  v_mul_f32 v206, v206, v238
  v_mfma_f32_16x16x32_bf16 v[136:139], v[60:63], a[24:27], v[136:139]
  s_mov_b32 s34, 73856
  v_mul_f32 v207, v207, v239
  v_cvt_pk_bf16_f32 v36, v204, v205
  v_mfma_f32_16x16x32_bf16 v[136:139], v[64:67], a[40:43], v[136:139]
  buffer_load_dwordx4 v84, s[12:15], s34 offen lds
  v_cvt_pk_bf16_f32 v37, v206, v207
  v_mul_f32 v220, v220, v252
  v_mfma_f32_16x16x32_bf16 v[140:143], v[56:59], a[12:15], v[140:143]
  v_mul_f32 v221, v221, v253
  v_mul_f32 v222, v222, v254
  v_mfma_f32_16x16x32_bf16 v[140:143], v[60:63], a[28:31], v[140:143]
  v_mul_f32 v223, v223, v255
  v_cvt_pk_bf16_f32 v38, v220, v221
  v_mfma_f32_16x16x32_bf16 v[140:143], v[64:67], a[44:47], v[140:143]
  v_cvt_pk_bf16_f32 v39, v222, v223
  ds_write_b128 v17, v[36:39] offset:27648
  s_waitcnt lgkmcnt(1)
  v_mfma_f32_16x16x32_bf16 v[144:147], v[68:71], a[0:3], v[144:147]
  s_waitcnt vmcnt(10)
  s_barrier
  s_mov_b32 s61, 27648
  v_mfma_f32_16x16x32_bf16 v[144:147], v[72:75], a[16:19], v[144:147]
  ds_read_b64_tr_b16 v[56:57], v9 offset:36864
  buffer_store_dwordx4 v[36:39], v80, s[28:31], s61 offen sc1
  v_mfma_f32_16x16x32_bf16 v[144:147], v[76:79], a[32:35], v[144:147]
  ds_read_b64_tr_b16 v[58:59], v9 offset:38912
  v_mfma_f32_16x16x32_bf16 v[148:151], v[68:71], a[4:7], v[148:151]
  ds_read_b64_tr_b16 v[60:61], v9 offset:40960
  v_mfma_f32_16x16x32_bf16 v[148:151], v[72:75], a[20:23], v[148:151]
  ds_read_b64_tr_b16 v[62:63], v9 offset:43008
  v_mfma_f32_16x16x32_bf16 v[148:151], v[76:79], a[36:39], v[148:151]
  ds_read_b64_tr_b16 v[64:65], v10 offset:12288
  v_mfma_f32_16x16x32_bf16 v[152:155], v[68:71], a[8:11], v[152:155]
  ds_read_b64_tr_b16 v[66:67], v10 offset:14336
  v_mfma_f32_16x16x32_bf16 v[152:155], v[72:75], a[24:27], v[152:155]
  v_mfma_f32_16x16x32_bf16 v[152:155], v[76:79], a[40:43], v[152:155]
  v_mfma_f32_16x16x32_bf16 v[156:159], v[68:71], a[12:15], v[156:159]
  v_mfma_f32_16x16x32_bf16 v[156:159], v[72:75], a[28:31], v[156:159]
  v_mfma_f32_16x16x32_bf16 v[156:159], v[76:79], a[44:47], v[156:159]
  s_waitcnt lgkmcnt(0)
  v_mfma_f32_16x16x32_bf16 v[128:131], v[56:59], a[112:115], v[128:131]
  ds_read_b64_tr_b16 v[68:69], v12 offset:36864
  s_add_u32 s72, s90, 26648576
  s_addc_u32 s73, s91, 0
  v_mfma_f32_16x16x32_bf16 v[128:131], v[60:63], a[128:131], v[128:131]
  ds_read_b64_tr_b16 v[70:71], v12 offset:38912
  s_and_b32 s73, s73, 0xffff
  v_mfma_f32_16x16x32_bf16 v[128:131], v[64:67], a[144:147], v[128:131]
  ds_read_b64_tr_b16 v[72:73], v12 offset:40960
  s_mov_b32 s74, 18874368
  v_mfma_f32_16x16x32_bf16 v[132:135], v[56:59], a[116:119], v[132:135]
  ds_read_b64_tr_b16 v[74:75], v12 offset:43008
  s_mov_b32 s75, 0x20000
  v_mfma_f32_16x16x32_bf16 v[132:135], v[60:63], a[132:135], v[132:135]
  ds_read_b64_tr_b16 v[76:77], v13 offset:12288
  s_and_b32 s36, s94, 1
  v_mfma_f32_16x16x32_bf16 v[132:135], v[64:67], a[148:151], v[132:135]
  ds_read_b64_tr_b16 v[78:79], v13 offset:14336
  s_and_b32 s37, s92, 1
  v_mfma_f32_16x16x32_bf16 v[136:139], v[56:59], a[120:123], v[136:139]
  ds_read_b128 a[192:195], v28 offset:8192
  s_add_u32 m0, s33, 36864
  v_mfma_f32_16x16x32_bf16 v[136:139], v[60:63], a[136:139], v[136:139]
  ds_read_b128 a[196:199], v28 offset:9216
  s_mov_b32 s34, 110720
  v_mfma_f32_16x16x32_bf16 v[136:139], v[64:67], a[152:155], v[136:139]
  ds_read_b128 a[200:203], v27 offset:12288
  buffer_load_dwordx4 v82, s[12:15], s34 offen lds
  v_mfma_f32_16x16x32_bf16 v[140:143], v[56:59], a[124:127], v[140:143]
  ds_read_b128 a[204:207], v27 offset:13312
  s_add_u32 m0, s33, 45056
  v_mfma_f32_16x16x32_bf16 v[140:143], v[60:63], a[140:143], v[140:143]
  s_mov_b32 s34, 147584
  s_mul_i32 s38, s36, 10
  v_mfma_f32_16x16x32_bf16 v[140:143], v[64:67], a[156:159], v[140:143]
  buffer_load_dwordx4 v82, s[12:15], s34 offen lds
  s_waitcnt lgkmcnt(4)
  v_mfma_f32_16x16x32_bf16 v[144:147], v[68:71], a[112:115], v[144:147]
  ds_read_b64_tr_b16 v[56:57], v8
  s_add_u32 s38, s38, s37
  v_mfma_f32_16x16x32_bf16 v[144:147], v[72:75], a[128:131], v[144:147]
  ds_read_b64_tr_b16 v[58:59], v8 offset:2048
  s_lshl_b32 s38, s38, 10
  v_mfma_f32_16x16x32_bf16 v[144:147], v[76:79], a[144:147], v[144:147]
  ds_read_b64_tr_b16 v[60:61], v8 offset:4096
  v_add_u32 v222, s38, v24
  v_mfma_f32_16x16x32_bf16 v[148:151], v[68:71], a[116:119], v[148:151]
  ds_read_b64_tr_b16 v[62:63], v8 offset:6144
  s_lshl_b32 s36, s36, 1
  v_mfma_f32_16x16x32_bf16 v[148:151], v[72:75], a[132:135], v[148:151]
  ds_read_b64_tr_b16 v[64:65], v9 offset:45056
  s_add_u32 s36, s36, s37
  v_mfma_f32_16x16x32_bf16 v[148:151], v[76:79], a[148:151], v[148:151]
  ds_read_b64_tr_b16 v[66:67], v9 offset:47104
  s_add_u32 s36, s36, 16
  v_mfma_f32_16x16x32_bf16 v[152:155], v[68:71], a[120:123], v[152:155]
  ds_read_b128 a[208:211], v28 offset:28672
  s_add_u32 m0, s33, 49152
  v_mfma_f32_16x16x32_bf16 v[152:155], v[72:75], a[136:139], v[152:155]
  ds_read_b128 a[212:215], v28 offset:29696
  s_mov_b32 s34, 184448
  v_mfma_f32_16x16x32_bf16 v[152:155], v[76:79], a[152:155], v[152:155]
  ds_read_b128 a[216:219], v27 offset:16384
  buffer_load_dwordx4 v82, s[12:15], s34 offen lds
  v_mfma_f32_16x16x32_bf16 v[156:159], v[68:71], a[124:127], v[156:159]
  ds_read_b128 a[220:223], v27 offset:17408
  s_lshl_b32 s36, s36, 9
  v_mfma_f32_16x16x32_bf16 v[156:159], v[72:75], a[140:143], v[156:159]
  v_lshrrev_b32 v4, 1, v24
  v_mfma_f32_16x16x32_bf16 v[156:159], v[76:79], a[156:159], v[156:159]
  v_add_u32 v3, s36, v4
  s_waitcnt lgkmcnt(4)
  v_mfma_f32_16x16x32_bf16 v[128:131], v[56:59], a[96:99], v[128:131]
  s_waitcnt vmcnt(13)
  s_barrier
  v_mfma_f32_16x16x32_bf16 v[128:131], v[60:63], a[160:163], v[128:131]
  ds_read_b64_tr_b16 v[68:69], v11
  s_lshl_b32 s36, s93, 4
  v_mfma_f32_16x16x32_bf16 v[128:131], v[64:67], a[176:179], v[128:131]
  ds_read_b64_tr_b16 v[70:71], v11 offset:2048
  s_add_u32 s36, s36, s94
  v_mfma_f32_16x16x32_bf16 v[132:135], v[56:59], a[100:103], v[132:135]
  ds_read_b64_tr_b16 v[72:73], v11 offset:4096
  s_lshr_b32 s37, s36, 1
  v_mfma_f32_16x16x32_bf16 v[132:135], v[60:63], a[164:167], v[132:135]
  ds_read_b64_tr_b16 v[74:75], v11 offset:6144
  s_mul_i32 s37, s37, 18432
  v_mfma_f32_16x16x32_bf16 v[132:135], v[64:67], a[180:183], v[132:135]
  ds_read_b64_tr_b16 v[76:77], v12 offset:45056
  s_and_b32 s38, s36, 1
  v_mfma_f32_16x16x32_bf16 v[136:139], v[56:59], a[104:107], v[136:139]
  ds_read_b64_tr_b16 v[78:79], v12 offset:47104
  s_lshl_b32 s38, s38, 7
  v_mfma_f32_16x16x32_bf16 v[136:139], v[60:63], a[168:171], v[136:139]
  ds_read_b128 a[224:227], v16 offset:24576
  s_add_u32 m0, s33, 53248
  v_mfma_f32_16x16x32_bf16 v[136:139], v[64:67], a[184:187], v[136:139]
  ds_read_b128 a[228:231], v16 offset:25600
  s_mov_b32 s34, 258048
  v_mfma_f32_16x16x32_bf16 v[140:143], v[56:59], a[108:111], v[140:143]
  ds_read_b128 a[232:235], v16 offset:26624
  buffer_load_dwordx4 v82, s[12:15], s34 offen lds
  v_mfma_f32_16x16x32_bf16 v[140:143], v[60:63], a[172:175], v[140:143]
  ds_read_b128 a[236:239], v16 offset:27648
  s_add_u32 m0, s33, 16384
  v_mfma_f32_16x16x32_bf16 v[140:143], v[64:67], a[188:191], v[140:143]
  s_mov_b32 s34, 221184
  buffer_load_dwordx4 v84, s[12:15], s34 offen lds
  s_waitcnt lgkmcnt(4)
  v_mfma_f32_16x16x32_bf16 v[144:147], v[68:71], a[96:99], v[144:147]
  s_waitcnt vmcnt(5)
  s_barrier
  s_mov_b32 s63, 196608
  buffer_store_dword v7, v22, s[96:99], s63 offen sc1
  ds_read_b64_tr_b16 v[56:57], v9 offset:57344
  v_mfma_f32_16x16x32_bf16 v[144:147], v[72:75], a[160:163], v[144:147]
  ds_read_b64_tr_b16 v[58:59], v9 offset:59392
  s_add_u32 s39, s37, s38
  v_mfma_f32_16x16x32_bf16 v[144:147], v[76:79], a[176:179], v[144:147]
  ds_read_b64_tr_b16 v[60:61], v10 offset:16384
  s_lshl_b32 s38, s92, 9
  v_mfma_f32_16x16x32_bf16 v[148:151], v[68:71], a[100:103], v[148:151]
  ds_read_b64_tr_b16 v[62:63], v10 offset:18432
  s_add_u32 s39, s39, s38
  v_mfma_f32_16x16x32_bf16 v[148:151], v[72:75], a[164:167], v[148:151]
  ds_read_b64_tr_b16 v[64:65], v9 offset:20480
  v_and_b32 v4, 7, v0
  v_mfma_f32_16x16x32_bf16 v[148:151], v[76:79], a[180:183], v[148:151]
  ds_read_b64_tr_b16 v[66:67], v9 offset:22528
  v_bfe_u32 v6, v0, 3, 1
  v_mfma_f32_16x16x32_bf16 v[152:155], v[68:71], a[104:107], v[152:155]
  ds_read_b128 a[240:243], v16 offset:28672
  s_add_u32 m0, s33, 20480
  v_mfma_f32_16x16x32_bf16 v[152:155], v[72:75], a[168:171], v[152:155]
  ds_read_b128 a[244:247], v16 offset:29696
  s_mov_b32 s34, 258048
  v_mfma_f32_16x16x32_bf16 v[152:155], v[76:79], a[184:187], v[152:155]
  ds_read_b128 a[248:251], v16 offset:30720
  buffer_load_dwordx4 v84, s[12:15], s34 offen lds
  v_mfma_f32_16x16x32_bf16 v[156:159], v[68:71], a[108:111], v[156:159]
  ds_read_b128 a[252:255], v16 offset:31744
  s_add_u32 m0, s33, 24576
  v_mfma_f32_16x16x32_bf16 v[156:159], v[72:75], a[172:175], v[156:159]
  s_mov_b32 s34, 110720
  v_lshlrev_b32 v4, 4, v4
  v_mfma_f32_16x16x32_bf16 v[156:159], v[76:79], a[188:191], v[156:159]
  buffer_load_dwordx4 v84, s[12:15], s34 offen lds
  s_waitcnt lgkmcnt(4)
  v_mfma_f32_16x16x32_bf16 v[128:131], v[56:59], a[192:195], v[128:131]
  ds_read_b64_tr_b16 v[68:69], v12 offset:57344
  v_lshl_add_u32 v4, v6, 8, v4
  v_mfma_f32_16x16x32_bf16 v[128:131], v[60:63], a[208:211], v[128:131]
  ds_read_b64_tr_b16 v[70:71], v12 offset:59392
  v_add_u32 v4, s39, v4
  v_mfma_f32_16x16x32_bf16 v[128:131], v[64:67], a[224:227], v[128:131]
  ds_read_b64_tr_b16 v[72:73], v13 offset:16384
  v_subrev_u32 v221, s37, v4
  v_mfma_f32_16x16x32_bf16 v[132:135], v[56:59], a[196:199], v[132:135]
  ds_read_b64_tr_b16 v[74:75], v13 offset:18432
  v_and_b32 v221, 1023, v221
  v_mfma_f32_16x16x32_bf16 v[132:135], v[60:63], a[212:215], v[132:135]
  ds_read_b64_tr_b16 v[76:77], v12 offset:20480
  v_lshrrev_b32 v221, 1, v221
  v_mfma_f32_16x16x32_bf16 v[132:135], v[64:67], a[228:231], v[132:135]
  ds_read_b64_tr_b16 v[78:79], v12 offset:22528
  s_lshr_b32 s38, s92, 1
  v_mfma_f32_16x16x32_bf16 v[136:139], v[56:59], a[200:203], v[136:139]
  s_add_u32 m0, s33, 40960
  s_lshl_b32 s38, s38, 10
  v_mfma_f32_16x16x32_bf16 v[136:139], v[60:63], a[216:219], v[136:139]
  s_mov_b32 s34, 128
  s_add_u32 s38, s38, s37
  v_mfma_f32_16x16x32_bf16 v[136:139], v[64:67], a[232:235], v[136:139]
  buffer_load_dwordx4 v83, s[12:15], s34 offen lds
  v_add_u32 v221, s38, v221
  v_mfma_f32_16x16x32_bf16 v[140:143], v[56:59], a[204:207], v[140:143]
  s_add_u32 m0, s33, 126976
  v_bfe_u32 v2, v0, 4, 2
  v_mfma_f32_16x16x32_bf16 v[140:143], v[60:63], a[220:223], v[140:143]
  s_mov_b32 s34, 128
  s_mov_b32 s38, 2359296
  v_mfma_f32_16x16x32_bf16 v[140:143], v[64:67], a[236:239], v[140:143]
  buffer_load_dwordx4 v85, s[12:15], s34 offen lds
  s_waitcnt lgkmcnt(0)
  v_mfma_f32_16x16x32_bf16 v[144:147], v[68:71], a[192:195], v[144:147]
  s_barrier
  v_mfma_f32_16x16x32_bf16 v[144:147], v[72:75], a[208:211], v[144:147]
  ds_read_b64_tr_b16 v[56:57], v8 offset:57344
  s_mov_b32 s63, 196608
  buffer_load_dword v31, v91, s[96:99], s63 offen sc1
  v_mfma_f32_16x16x32_bf16 v[144:147], v[76:79], a[224:227], v[144:147]
  ds_read_b64_tr_b16 v[58:59], v8 offset:59392
  v_mul_lo_u32 v5, v2, s38
  v_mfma_f32_16x16x32_bf16 v[148:151], v[68:71], a[196:199], v[148:151]
  ds_read_b64_tr_b16 v[60:61], v9 offset:8192
  v_add_u32 v220, v4, v5
  v_mfma_f32_16x16x32_bf16 v[148:151], v[72:75], a[212:215], v[148:151]
  ds_read_b64_tr_b16 v[62:63], v9 offset:10240
  v_add_u32 v221, v221, v5
  v_mfma_f32_16x16x32_bf16 v[148:151], v[76:79], a[228:231], v[148:151]
  ds_read_b64_tr_b16 v[64:65], v8 offset:8192
  v_and_b32 v4, 1, v0
  v_mfma_f32_16x16x32_bf16 v[152:155], v[68:71], a[200:203], v[152:155]
  ds_read_b64_tr_b16 v[66:67], v8 offset:10240
  v_lshlrev_b32 v4, 4, v4
  v_mfma_f32_16x16x32_bf16 v[152:155], v[72:75], a[216:219], v[152:155]
  s_add_u32 m0, s33, 151552
  v_mov_b32 v5, 0x3f80
  v_mfma_f32_16x16x32_bf16 v[152:155], v[76:79], a[232:235], v[152:155]
  s_mov_b32 s34, 147584
  v_lshlrev_b32 v4, v4, v5
  v_mfma_f32_16x16x32_bf16 v[156:159], v[68:71], a[204:207], v[156:159]
  buffer_load_dwordx4 v84, s[12:15], s34 offen lds
  v_bfe_u32 v5, v0, 1, 3
  v_mfma_f32_16x16x32_bf16 v[156:159], v[72:75], a[220:223], v[156:159]
  s_add_u32 m0, s33, 114688
  v_cmp_eq_u32 vcc, 0, v5
  v_mfma_f32_16x16x32_bf16 v[156:159], v[76:79], a[236:239], v[156:159]
  s_mov_b32 s34, 184448
  buffer_load_dwordx4 v84, s[12:15], s34 offen lds
  s_waitcnt lgkmcnt(0)
  v_mfma_f32_16x16x32_bf16 v[160:163], v[56:59], a[48:51], 0
  ds_read_b64_tr_b16 v[68:69], v11 offset:57344
  v_cndmask_b32 v212, 0, v4, vcc
  v_mfma_f32_16x16x32_bf16 v[160:163], v[60:63], a[64:67], v[160:163]
  ds_read_b64_tr_b16 v[70:71], v11 offset:59392
  v_cmp_eq_u32 vcc, 2, v5
  v_mfma_f32_16x16x32_bf16 v[160:163], v[64:67], a[80:83], v[160:163]
  ds_read_b64_tr_b16 v[72:73], v12 offset:8192
  v_cndmask_b32 v213, 0, v4, vcc
  v_mfma_f32_16x16x32_bf16 v[164:167], v[56:59], a[52:55], 0
  ds_read_b64_tr_b16 v[74:75], v12 offset:10240
  v_cmp_eq_u32 vcc, 4, v5
  v_mfma_f32_16x16x32_bf16 v[164:167], v[60:63], a[68:71], v[164:167]
  ds_read_b64_tr_b16 v[76:77], v11 offset:8192
  v_cndmask_b32 v214, 0, v4, vcc
  v_mfma_f32_16x16x32_bf16 v[164:167], v[64:67], a[84:87], v[164:167]
  ds_read_b64_tr_b16 v[78:79], v11 offset:10240
  v_cmp_eq_u32 vcc, 6, v5
  v_mfma_f32_16x16x32_bf16 v[168:171], v[56:59], a[56:59], 0
  s_add_u32 m0, s33, 155648
  v_cndmask_b32 v215, 0, v4, vcc
  v_mfma_f32_16x16x32_bf16 v[168:171], v[60:63], a[72:75], v[168:171]
  s_mov_b32 s34, 221312
  v_cmp_eq_u32 vcc, 1, v5
  v_mfma_f32_16x16x32_bf16 v[168:171], v[64:67], a[88:91], v[168:171]
  buffer_load_dwordx4 v82, s[12:15], s34 offen lds
  v_cndmask_b32 v216, 0, v4, vcc
  v_mfma_f32_16x16x32_bf16 v[172:175], v[56:59], a[60:63], 0
  s_add_u32 m0, s33, 118784
  v_cmp_eq_u32 vcc, 3, v5
  v_mfma_f32_16x16x32_bf16 v[172:175], v[60:63], a[76:79], v[172:175]
  s_mov_b32 s34, 258176
  v_cndmask_b32 v217, 0, v4, vcc
  v_mfma_f32_16x16x32_bf16 v[172:175], v[64:67], a[92:95], v[172:175]
  buffer_load_dwordx4 v82, s[12:15], s34 offen lds
  s_waitcnt lgkmcnt(0)
  v_mfma_f32_16x16x32_bf16 v[176:179], v[68:71], a[48:51], 0
  ds_read_b64_tr_b16 v[56:57], v8 offset:12288
  v_cmp_eq_u32 vcc, 5, v5
  v_mfma_f32_16x16x32_bf16 v[176:179], v[72:75], a[64:67], v[176:179]
  ds_read_b64_tr_b16 v[58:59], v8 offset:14336
  v_cndmask_b32 v218, 0, v4, vcc
  v_mfma_f32_16x16x32_bf16 v[176:179], v[76:79], a[80:83], v[176:179]
  ds_read_b64_tr_b16 v[60:61], v8 offset:28672
  v_cmp_eq_u32 vcc, 7, v5
  v_mfma_f32_16x16x32_bf16 v[180:183], v[68:71], a[52:55], 0
  ds_read_b64_tr_b16 v[62:63], v8 offset:30720
  v_cndmask_b32 v219, 0, v4, vcc
  v_mfma_f32_16x16x32_bf16 v[180:183], v[72:75], a[68:71], v[180:183]
  ds_read_b64_tr_b16 v[64:65], v8 offset:32768
  s_add_u32 s44, s86, 0
  s_addc_u32 s45, s87, 0
  v_mfma_f32_16x16x32_bf16 v[180:183], v[76:79], a[84:87], v[180:183]
  ds_read_b64_tr_b16 v[66:67], v8 offset:34816
  s_and_b32 s45, s45, 0xffff
  v_mfma_f32_16x16x32_bf16 v[184:187], v[68:71], a[56:59], 0
  s_add_u32 m0, s33, 131072
  s_mov_b32 s46, 2064384
  v_mfma_f32_16x16x32_bf16 v[184:187], v[72:75], a[72:75], v[184:187]
  s_mov_b32 s34, 221312
  s_mov_b32 s47, 0x20000
  v_mfma_f32_16x16x32_bf16 v[184:187], v[76:79], a[88:91], v[184:187]
  buffer_load_dwordx4 v84, s[12:15], s34 offen lds
  s_cmp_eq_u32 s95, 0
  s_cselect_b32 s46, s46, 0
  v_mfma_f32_16x16x32_bf16 v[188:191], v[68:71], a[60:63], 0
  s_add_u32 m0, s33, 90112
  s_mul_i32 s36, s94, 129024
  v_mfma_f32_16x16x32_bf16 v[188:191], v[72:75], a[76:79], v[188:191]
  s_mov_b32 s34, 258176
  s_lshl_b32 s101, s92, 12
  v_mfma_f32_16x16x32_bf16 v[188:191], v[76:79], a[92:95], v[188:191]
  buffer_load_dwordx4 v84, s[12:15], s34 offen lds
  s_waitcnt lgkmcnt(0)
  v_mfma_f32_16x16x32_bf16 v[160:163], v[56:59], a[0:3], v[160:163]
  s_waitcnt vmcnt(14)
  s_barrier
  v_mfma_f32_16x16x32_bf16 v[160:163], v[60:63], a[16:19], v[160:163]
  ds_read_b64_tr_b16 v[68:69], v11 offset:12288
  s_waitcnt vmcnt(6)
  v_cmp_ne_u32 vcc, v7, v31
  s_cbranch_vccnz L_sp_26
L_bk_27:
  v_mfma_f32_16x16x32_bf16 v[160:163], v[64:67], a[32:35], v[160:163]
  ds_read_b64_tr_b16 v[70:71], v11 offset:14336
  s_mov_b32 s65, 24576
  v_mfma_f32_16x16x32_bf16 v[164:167], v[56:59], a[4:7], v[164:167]
  ds_read_b64_tr_b16 v[72:73], v11 offset:28672
  buffer_load_dwordx4 v[96:99], v89, s[68:71], s65 offen sc1
  v_mfma_f32_16x16x32_bf16 v[164:167], v[60:63], a[20:23], v[164:167]
  ds_read_b64_tr_b16 v[74:75], v11 offset:30720
  buffer_load_dwordx4 v[100:103], v89, s[68:71], s65 offen offset:1024 sc1
  v_mfma_f32_16x16x32_bf16 v[164:167], v[64:67], a[36:39], v[164:167]
  ds_read_b64_tr_b16 v[76:77], v11 offset:32768
  buffer_load_dwordx4 v[104:107], v89, s[68:71], s65 offen offset:2048 sc1
  v_mfma_f32_16x16x32_bf16 v[168:171], v[56:59], a[8:11], v[168:171]
  ds_read_b64_tr_b16 v[78:79], v11 offset:34816
  buffer_load_dwordx4 v[108:111], v89, s[68:71], s65 offen offset:3072 sc1
  v_mfma_f32_16x16x32_bf16 v[168:171], v[60:63], a[24:27], v[168:171]
  s_add_u32 m0, s33, 94208
  s_mov_b32 s65, 28672
  v_mfma_f32_16x16x32_bf16 v[168:171], v[64:67], a[40:43], v[168:171]
  s_mov_b32 s34, 256
  buffer_load_dwordx4 v[112:115], v89, s[68:71], s65 offen sc1
  v_mfma_f32_16x16x32_bf16 v[172:175], v[56:59], a[12:15], v[172:175]
  buffer_load_dwordx4 v82, s[12:15], s34 offen lds
  buffer_load_dwordx4 v[116:119], v89, s[68:71], s65 offen offset:1024 sc1
  v_mfma_f32_16x16x32_bf16 v[172:175], v[60:63], a[28:31], v[172:175]
  s_add_u32 m0, s33, 61440
  buffer_load_dwordx4 v[120:123], v89, s[68:71], s65 offen offset:2048 sc1
  v_mfma_f32_16x16x32_bf16 v[172:175], v[64:67], a[44:47], v[172:175]
  s_mov_b32 s34, 37120
  buffer_load_dwordx4 v82, s[12:15], s34 offen lds
  s_waitcnt lgkmcnt(0)
  v_mfma_f32_16x16x32_bf16 v[176:179], v[68:71], a[0:3], v[176:179]
  ds_read_b64_tr_b16 v[56:57], v8 offset:36864
  buffer_load_dwordx4 v[124:127], v89, s[68:71], s65 offen offset:3072 sc1
  v_mfma_f32_16x16x32_bf16 v[176:179], v[72:75], a[16:19], v[176:179]
  ds_read_b64_tr_b16 v[58:59], v8 offset:38912
  s_add_u32 s36, s36, s101
  v_mfma_f32_16x16x32_bf16 v[176:179], v[76:79], a[32:35], v[176:179]
  ds_read_b64_tr_b16 v[60:61], v8 offset:45056
  v_and_b32 v94, 63, v0
  v_mfma_f32_16x16x32_bf16 v[180:183], v[68:71], a[4:7], v[180:183]
  ds_read_b64_tr_b16 v[62:63], v8 offset:47104
  v_lshlrev_b32 v94, 4, v94
  v_mfma_f32_16x16x32_bf16 v[180:183], v[72:75], a[20:23], v[180:183]
  ds_read_b64_tr_b16 v[64:65], v8 offset:49152
  v_add_u32 v94, s36, v94
  v_mfma_f32_16x16x32_bf16 v[180:183], v[76:79], a[36:39], v[180:183]
  ds_read_b64_tr_b16 v[66:67], v8 offset:51200
  v_mfma_f32_16x16x32_bf16 v[184:187], v[68:71], a[8:11], v[184:187]
  s_add_u32 m0, s33, 135168
  v_mfma_f32_16x16x32_bf16 v[184:187], v[72:75], a[24:27], v[184:187]
  s_mov_b32 s34, 73984
  v_mfma_f32_16x16x32_bf16 v[184:187], v[76:79], a[40:43], v[184:187]
  buffer_load_dwordx4 v82, s[12:15], s34 offen lds
  v_mfma_f32_16x16x32_bf16 v[188:191], v[68:71], a[12:15], v[188:191]
  s_add_u32 m0, s33, 98304
  v_mfma_f32_16x16x32_bf16 v[188:191], v[72:75], a[28:31], v[188:191]
  s_mov_b32 s34, 256
  v_mfma_f32_16x16x32_bf16 v[188:191], v[76:79], a[44:47], v[188:191]
  buffer_load_dwordx4 v84, s[12:15], s34 offen lds
  s_waitcnt lgkmcnt(0)
  v_mfma_f32_16x16x32_bf16 v[160:163], v[56:59], a[112:115], v[160:163]
  ds_read_b64_tr_b16 v[68:69], v11 offset:36864
  v_mfma_f32_16x16x32_bf16 v[160:163], v[60:63], a[128:131], v[160:163]
  ds_read_b64_tr_b16 v[70:71], v11 offset:38912
  v_mfma_f32_16x16x32_bf16 v[160:163], v[64:67], a[144:147], v[160:163]
  ds_read_b64_tr_b16 v[72:73], v11 offset:45056
  v_mfma_f32_16x16x32_bf16 v[164:167], v[56:59], a[116:119], v[164:167]
  ds_read_b64_tr_b16 v[74:75], v11 offset:47104
  v_mfma_f32_16x16x32_bf16 v[164:167], v[60:63], a[132:135], v[164:167]
  ds_read_b64_tr_b16 v[76:77], v11 offset:49152
  v_mfma_f32_16x16x32_bf16 v[164:167], v[64:67], a[148:151], v[164:167]
  ds_read_b64_tr_b16 v[78:79], v11 offset:51200
  v_mfma_f32_16x16x32_bf16 v[168:171], v[56:59], a[120:123], v[168:171]
  s_add_u32 m0, s33, 65536
  v_mfma_f32_16x16x32_bf16 v[168:171], v[60:63], a[136:139], v[168:171]
  s_mov_b32 s34, 37120
  v_mfma_f32_16x16x32_bf16 v[168:171], v[64:67], a[152:155], v[168:171]
  buffer_load_dwordx4 v84, s[12:15], s34 offen lds
  v_mfma_f32_16x16x32_bf16 v[172:175], v[56:59], a[124:127], v[172:175]
  s_add_u32 m0, s33, 69632
  v_mfma_f32_16x16x32_bf16 v[172:175], v[60:63], a[140:143], v[172:175]
  s_mov_b32 s34, 73984
  v_mfma_f32_16x16x32_bf16 v[172:175], v[64:67], a[156:159], v[172:175]
  buffer_load_dwordx4 v84, s[12:15], s34 offen lds
  s_waitcnt lgkmcnt(0)
  v_mfma_f32_16x16x32_bf16 v[176:179], v[68:71], a[112:115], v[176:179]
  s_barrier
  v_mfma_f32_16x16x32_bf16 v[176:179], v[72:75], a[128:131], v[176:179]
  ds_read_b64_tr_b16 v[56:57], v8 offset:53248
  v_mfma_f32_16x16x32_bf16 v[176:179], v[76:79], a[144:147], v[176:179]
  ds_read_b64_tr_b16 v[58:59], v8 offset:55296
  v_mfma_f32_16x16x32_bf16 v[180:183], v[68:71], a[116:119], v[180:183]
  ds_read_b64_tr_b16 v[60:61], v8 offset:16384
  v_mfma_f32_16x16x32_bf16 v[180:183], v[72:75], a[132:135], v[180:183]
  ds_read_b64_tr_b16 v[62:63], v8 offset:18432
  v_mfma_f32_16x16x32_bf16 v[180:183], v[76:79], a[148:151], v[180:183]
  ds_read_b64_tr_b16 v[64:65], v8 offset:20480
  v_mfma_f32_16x16x32_bf16 v[184:187], v[68:71], a[120:123], v[184:187]
  ds_read_b64_tr_b16 v[66:67], v8 offset:22528
  v_mfma_f32_16x16x32_bf16 v[184:187], v[72:75], a[136:139], v[184:187]
  s_add_u32 m0, s33, 139264
  v_mfma_f32_16x16x32_bf16 v[184:187], v[76:79], a[152:155], v[184:187]
  s_mov_b32 s34, 110848
  v_mfma_f32_16x16x32_bf16 v[188:191], v[68:71], a[124:127], v[188:191]
  buffer_load_dwordx4 v82, s[12:15], s34 offen lds
  v_mfma_f32_16x16x32_bf16 v[188:191], v[72:75], a[140:143], v[188:191]
  s_add_u32 m0, s33, 102400
  v_mfma_f32_16x16x32_bf16 v[188:191], v[76:79], a[156:159], v[188:191]
  s_mov_b32 s34, 147712
  buffer_load_dwordx4 v82, s[12:15], s34 offen lds
  s_waitcnt lgkmcnt(0)
  v_mfma_f32_16x16x32_bf16 v[128:131], v[56:59], a[240:243], v[128:131]
  ds_read_b64_tr_b16 v[68:69], v11 offset:53248
  s_waitcnt vmcnt(15)
  v_mfma_f32_16x16x32_bf16 v[128:131], v[60:63], v[96:99], v[128:131]
  ds_read_b64_tr_b16 v[70:71], v11 offset:55296
  s_waitcnt vmcnt(11)
  v_mfma_f32_16x16x32_bf16 v[128:131], v[64:67], v[112:115], v[128:131]
  ds_read_b64_tr_b16 v[72:73], v11 offset:16384
  v_mfma_f32_16x16x32_bf16 v[132:135], v[56:59], a[244:247], v[132:135]
  ds_read_b64_tr_b16 v[74:75], v11 offset:18432
  v_mfma_f32_16x16x32_bf16 v[132:135], v[60:63], v[100:103], v[132:135]
  ds_read_b64_tr_b16 v[76:77], v11 offset:20480
  s_waitcnt vmcnt(9)
  v_mfma_f32_16x16x32_bf16 v[132:135], v[64:67], v[116:119], v[132:135]
  ds_read_b64_tr_b16 v[78:79], v11 offset:22528
  v_mfma_f32_16x16x32_bf16 v[136:139], v[56:59], a[248:251], v[136:139]
  s_add_u32 m0, s33, 106496
  v_mfma_f32_16x16x32_bf16 v[136:139], v[60:63], v[104:107], v[136:139]
  s_mov_b32 s34, 184576
  s_waitcnt vmcnt(8)
  v_mfma_f32_16x16x32_bf16 v[136:139], v[64:67], v[120:123], v[136:139]
  buffer_load_dwordx4 v82, s[12:15], s34 offen lds
  v_mfma_f32_16x16x32_bf16 v[140:143], v[56:59], a[252:255], v[140:143]
  s_add_u32 m0, s33, 143360
  v_mfma_f32_16x16x32_bf16 v[140:143], v[60:63], v[108:111], v[140:143]
  s_mov_b32 s34, 110848
  s_waitcnt vmcnt(7)
  v_mfma_f32_16x16x32_bf16 v[140:143], v[64:67], v[124:127], v[140:143]
  buffer_load_dwordx4 v84, s[12:15], s34 offen lds
  s_waitcnt lgkmcnt(0)
  v_mfma_f32_16x16x32_bf16 v[144:147], v[68:71], a[240:243], v[144:147]
  ds_read_b64_tr_b16 v[56:57], v8 offset:24576
  v_mfma_f32_16x16x32_bf16 v[144:147], v[72:75], v[96:99], v[144:147]
  ds_read_b64_tr_b16 v[58:59], v8 offset:26624
  v_mfma_f32_16x16x32_bf16 v[144:147], v[76:79], v[112:115], v[144:147]
  ds_read_b64_tr_b16 v[60:61], v8 offset:40960
  v_mfma_f32_16x16x32_bf16 v[148:151], v[68:71], a[244:247], v[148:151]
  ds_read_b64_tr_b16 v[62:63], v8 offset:43008
  v_mfma_f32_16x16x32_bf16 v[148:151], v[72:75], v[100:103], v[148:151]
  ds_read_b64_tr_b16 v[64:65], v9 offset:61440
  v_mfma_f32_16x16x32_bf16 v[148:151], v[76:79], v[116:119], v[148:151]
  ds_read_b64_tr_b16 v[66:67], v9 offset:63488
  v_mfma_f32_16x16x32_bf16 v[152:155], v[68:71], a[248:251], v[152:155]
  s_add_u32 m0, s33, 77824
  v_mfma_f32_16x16x32_bf16 v[152:155], v[72:75], v[104:107], v[152:155]
  s_mov_b32 s34, 256
  v_mfma_f32_16x16x32_bf16 v[152:155], v[76:79], v[120:123], v[152:155]
  buffer_load_dwordx4 v83, s[12:15], s34 offen lds
  v_mfma_f32_16x16x32_bf16 v[156:159], v[68:71], a[252:255], v[156:159]
  s_add_u32 m0, s33, 0
  v_mfma_f32_16x16x32_bf16 v[156:159], v[72:75], v[108:111], v[156:159]
  s_mov_b32 s34, 256
  v_mfma_f32_16x16x32_bf16 v[156:159], v[76:79], v[124:127], v[156:159]
  buffer_load_dwordx4 v85, s[12:15], s34 offen lds
  s_waitcnt lgkmcnt(0)
  v_mfma_f32_16x16x32_bf16 v[160:163], v[56:59], a[96:99], v[160:163]
  s_barrier
  v_mfma_f32_16x16x32_bf16 v[160:163], v[60:63], a[160:163], v[160:163]
  ds_read_b64_tr_b16 v[68:69], v11 offset:24576
  v_cvt_pk_bf16_f32 v40, v128, v129
  v_mfma_f32_16x16x32_bf16 v[160:163], v[64:67], a[176:179], v[160:163]
  ds_read_b64_tr_b16 v[70:71], v11 offset:26624
  v_cvt_pk_bf16_f32 v41, v130, v131
  v_mfma_f32_16x16x32_bf16 v[164:167], v[56:59], a[100:103], v[164:167]
  ds_read_b64_tr_b16 v[72:73], v11 offset:40960
  v_cvt_pk_bf16_f32 v42, v144, v145
  v_mfma_f32_16x16x32_bf16 v[164:167], v[60:63], a[164:167], v[164:167]
  ds_read_b64_tr_b16 v[74:75], v11 offset:43008
  v_cvt_pk_bf16_f32 v43, v146, v147
  v_mfma_f32_16x16x32_bf16 v[164:167], v[64:67], a[180:183], v[164:167]
  ds_read_b64_tr_b16 v[76:77], v12 offset:61440
  s_mov_b32 s35, 0
  v_mfma_f32_16x16x32_bf16 v[168:171], v[56:59], a[104:107], v[168:171]
  ds_read_b64_tr_b16 v[78:79], v12 offset:63488
  buffer_store_dwordx4 v[40:43], v222, s[20:23], s35 offen sc1
  v_mfma_f32_16x16x32_bf16 v[168:171], v[60:63], a[168:171], v[168:171]
  s_add_u32 m0, s33, 4096
  v_cvt_pk_bf16_f32 v44, v132, v133
  v_mfma_f32_16x16x32_bf16 v[168:171], v[64:67], a[184:187], v[168:171]
  s_mov_b32 s34, 147712
  v_cvt_pk_bf16_f32 v45, v134, v135
  v_mfma_f32_16x16x32_bf16 v[172:175], v[56:59], a[108:111], v[172:175]
  buffer_load_dwordx4 v84, s[12:15], s34 offen lds
  v_cvt_pk_bf16_f32 v46, v148, v149
  v_mfma_f32_16x16x32_bf16 v[172:175], v[60:63], a[172:175], v[172:175]
  s_add_u32 m0, s33, 110592
  v_cvt_pk_bf16_f32 v47, v150, v151
  v_mfma_f32_16x16x32_bf16 v[172:175], v[64:67], a[188:191], v[172:175]
  s_mov_b32 s34, 184576
  buffer_load_dwordx4 v84, s[12:15], s34 offen lds
  s_waitcnt lgkmcnt(0)
  v_mfma_f32_16x16x32_bf16 v[176:179], v[68:71], a[96:99], v[176:179]
  ds_read_b64_tr_b16 v[56:57], v10 offset:20480
  v_cvt_pk_bf16_f32 v48, v136, v137
  v_mfma_f32_16x16x32_bf16 v[176:179], v[72:75], a[160:163], v[176:179]
  ds_read_b64_tr_b16 v[58:59], v10 offset:22528
  v_cvt_pk_bf16_f32 v49, v138, v139
  v_mfma_f32_16x16x32_bf16 v[176:179], v[76:79], a[176:179], v[176:179]
  ds_read_b64_tr_b16 v[60:61], v9 offset:49152
  v_cvt_pk_bf16_f32 v50, v152, v153
  v_mfma_f32_16x16x32_bf16 v[180:183], v[68:71], a[100:103], v[180:183]
  ds_read_b64_tr_b16 v[62:63], v9 offset:51200
  v_cvt_pk_bf16_f32 v51, v154, v155
  v_mfma_f32_16x16x32_bf16 v[180:183], v[72:75], a[164:167], v[180:183]
  ds_read_b64_tr_b16 v[64:65], v10 offset:24576
  v_cvt_pk_bf16_f32 v52, v140, v141
  v_mfma_f32_16x16x32_bf16 v[180:183], v[76:79], a[180:183], v[180:183]
  ds_read_b64_tr_b16 v[66:67], v10 offset:26624
  v_cvt_pk_bf16_f32 v53, v142, v143
  v_mfma_f32_16x16x32_bf16 v[184:187], v[68:71], a[104:107], v[184:187]
  s_add_u32 m0, s33, 159744
  v_cvt_pk_bf16_f32 v54, v156, v157
  v_mfma_f32_16x16x32_bf16 v[184:187], v[72:75], a[168:171], v[184:187]
  s_mov_b32 s34, 221440
  v_cvt_pk_bf16_f32 v55, v158, v159
  v_mfma_f32_16x16x32_bf16 v[184:187], v[76:79], a[184:187], v[184:187]
  buffer_load_dwordx4 v82, s[12:15], s34 offen lds
  v_mfma_f32_16x16x32_bf16 v[188:191], v[68:71], a[108:111], v[188:191]
  s_add_u32 m0, s33, 122880
  v_mfma_f32_16x16x32_bf16 v[188:191], v[72:75], a[172:175], v[188:191]
  s_mov_b32 s34, 258304
  v_mfma_f32_16x16x32_bf16 v[188:191], v[76:79], a[188:191], v[188:191]
  buffer_load_dwordx4 v82, s[12:15], s34 offen lds
  s_waitcnt lgkmcnt(0)
  v_mfma_f32_16x16x32_bf16 v[160:163], v[56:59], a[192:195], v[160:163]
  ds_read_b64_tr_b16 v[68:69], v13 offset:20480
  v_mfma_f32_16x16x32_bf16 v[160:163], v[60:63], a[208:211], v[160:163]
  ds_read_b64_tr_b16 v[70:71], v13 offset:22528
  v_mfma_f32_16x16x32_bf16 v[160:163], v[64:67], a[224:227], v[160:163]
  ds_read_b64_tr_b16 v[72:73], v12 offset:49152
  v_mfma_f32_16x16x32_bf16 v[164:167], v[56:59], a[196:199], v[164:167]
  ds_read_b64_tr_b16 v[74:75], v12 offset:51200
  v_mfma_f32_16x16x32_bf16 v[164:167], v[60:63], a[212:215], v[164:167]
  ds_read_b64_tr_b16 v[76:77], v13 offset:24576
  v_mfma_f32_16x16x32_bf16 v[164:167], v[64:67], a[228:231], v[164:167]
  ds_read_b64_tr_b16 v[78:79], v13 offset:26624
  v_mfma_f32_16x16x32_bf16 v[168:171], v[56:59], a[200:203], v[168:171]
  s_add_u32 m0, s33, 147456
  v_mfma_f32_16x16x32_bf16 v[168:171], v[60:63], a[216:219], v[168:171]
  s_mov_b32 s34, 221440
  s_mov_b32 s35, 18432
  v_mfma_f32_16x16x32_bf16 v[168:171], v[64:67], a[232:235], v[168:171]
  buffer_load_dwordx4 v84, s[12:15], s34 offen lds
  buffer_store_dwordx4 v[44:47], v222, s[20:23], s35 offen sc1
  v_mfma_f32_16x16x32_bf16 v[172:175], v[56:59], a[204:207], v[172:175]
  s_add_u32 m0, s33, 81920
  v_mfma_f32_16x16x32_bf16 v[172:175], v[60:63], a[220:223], v[172:175]
  s_mov_b32 s34, 258304
  v_mfma_f32_16x16x32_bf16 v[172:175], v[64:67], a[236:239], v[172:175]
  buffer_load_dwordx4 v84, s[12:15], s34 offen lds
  s_waitcnt lgkmcnt(0)
  v_mfma_f32_16x16x32_bf16 v[176:179], v[68:71], a[192:195], v[176:179]
  s_waitcnt vmcnt(17)
  s_barrier
  v_mfma_f32_16x16x32_bf16 v[176:179], v[72:75], a[208:211], v[176:179]
  ds_read_b64_tr_b16 v[56:57], v9 offset:53248
  v_mfma_f32_16x16x32_bf16 v[176:179], v[76:79], a[224:227], v[176:179]
  ds_read_b64_tr_b16 v[58:59], v9 offset:55296
  v_mfma_f32_16x16x32_bf16 v[180:183], v[68:71], a[196:199], v[180:183]
  ds_read_b64_tr_b16 v[60:61], v10
  v_mfma_f32_16x16x32_bf16 v[180:183], v[72:75], a[212:215], v[180:183]
  ds_read_b64_tr_b16 v[62:63], v10 offset:2048
  v_mfma_f32_16x16x32_bf16 v[180:183], v[76:79], a[228:231], v[180:183]
  ds_read_b64_tr_b16 v[64:65], v9 offset:24576
  v_mfma_f32_16x16x32_bf16 v[184:187], v[68:71], a[200:203], v[184:187]
  ds_read_b64_tr_b16 v[66:67], v9 offset:26624
  v_mfma_f32_16x16x32_bf16 v[184:187], v[72:75], a[216:219], v[184:187]
  s_add_u32 m0, s33, 86016
  v_mfma_f32_16x16x32_bf16 v[184:187], v[76:79], a[232:235], v[184:187]
  s_mov_b32 s34, 384
  s_mov_b32 s35, 36864
  v_mfma_f32_16x16x32_bf16 v[188:191], v[68:71], a[204:207], v[188:191]
  buffer_load_dwordx4 v82, s[12:15], s34 offen lds
  buffer_store_dwordx4 v[48:51], v222, s[20:23], s35 offen sc1
  v_mfma_f32_16x16x32_bf16 v[188:191], v[72:75], a[220:223], v[188:191]
  s_add_u32 m0, s33, 57344
  v_mfma_f32_16x16x32_bf16 v[188:191], v[76:79], a[236:239], v[188:191]
  s_mov_b32 s34, 37248
  buffer_load_dwordx4 v82, s[12:15], s34 offen lds
  s_waitcnt lgkmcnt(0)
  v_mfma_f32_16x16x32_bf16 v[160:163], v[56:59], a[240:243], v[160:163]
  ds_read_b64_tr_b16 v[68:69], v12 offset:53248
  v_mfma_f32_16x16x32_bf16 v[160:163], v[60:63], v[96:99], v[160:163]
  ds_read_b64_tr_b16 v[70:71], v12 offset:55296
  v_mfma_f32_16x16x32_bf16 v[160:163], v[64:67], v[112:115], v[160:163]
  ds_read_b64_tr_b16 v[72:73], v13
  v_mfma_f32_16x16x32_bf16 v[164:167], v[56:59], a[244:247], v[164:167]
  ds_read_b64_tr_b16 v[74:75], v13 offset:2048
  v_mfma_f32_16x16x32_bf16 v[164:167], v[60:63], v[100:103], v[164:167]
  ds_read_b64_tr_b16 v[76:77], v12 offset:24576
  v_mfma_f32_16x16x32_bf16 v[164:167], v[64:67], v[116:119], v[164:167]
  ds_read_b64_tr_b16 v[78:79], v12 offset:26624
  v_mfma_f32_16x16x32_bf16 v[168:171], v[56:59], a[248:251], v[168:171]
  s_add_u32 m0, s33, 73728
  v_mfma_f32_16x16x32_bf16 v[168:171], v[60:63], v[104:107], v[168:171]
  s_mov_b32 s34, 74112
  v_mfma_f32_16x16x32_bf16 v[168:171], v[64:67], v[120:123], v[168:171]
  buffer_load_dwordx4 v82, s[12:15], s34 offen lds
  v_mfma_f32_16x16x32_bf16 v[172:175], v[56:59], a[252:255], v[172:175]
  s_add_u32 m0, s33, 8192
  s_mov_b32 s35, 55296
  v_mfma_f32_16x16x32_bf16 v[172:175], v[60:63], v[108:111], v[172:175]
  s_mov_b32 s34, 384
  buffer_store_dwordx4 v[52:55], v222, s[20:23], s35 offen sc1
  v_mfma_f32_16x16x32_bf16 v[172:175], v[64:67], v[124:127], v[172:175]
  buffer_load_dwordx4 v84, s[12:15], s34 offen lds
  s_waitcnt lgkmcnt(0)
  v_mfma_f32_16x16x32_bf16 v[176:179], v[68:71], a[240:243], v[176:179]
  ds_read_b64_tr_b16 v[56:57], v9 offset:28672
  v_mfma_f32_16x16x32_bf16 v[176:179], v[72:75], v[96:99], v[176:179]
  ds_read_b64_tr_b16 v[58:59], v9 offset:30720
  v_mfma_f32_16x16x32_bf16 v[176:179], v[76:79], v[112:115], v[176:179]
  ds_read_b64_tr_b16 v[60:61], v8 offset:61440
  v_mfma_f32_16x16x32_bf16 v[180:183], v[68:71], a[244:247], v[180:183]
  ds_read_b64_tr_b16 v[62:63], v8 offset:63488
  v_mfma_f32_16x16x32_bf16 v[180:183], v[72:75], v[100:103], v[180:183]
  ds_read_b64_tr_b16 v[64:65], v10 offset:4096
  v_mfma_f32_16x16x32_bf16 v[180:183], v[76:79], v[116:119], v[180:183]
  ds_read_b64_tr_b16 v[66:67], v10 offset:6144
  v_mfma_f32_16x16x32_bf16 v[184:187], v[68:71], a[248:251], v[184:187]
  s_add_u32 m0, s33, 12288
  v_mfma_f32_16x16x32_bf16 v[184:187], v[72:75], v[104:107], v[184:187]
  s_mov_b32 s34, 37248
  v_mfma_f32_16x16x32_bf16 v[184:187], v[76:79], v[120:123], v[184:187]
  buffer_load_dwordx4 v84, s[12:15], s34 offen lds
  v_mfma_f32_16x16x32_bf16 v[188:191], v[68:71], a[252:255], v[188:191]
  s_add_u32 m0, s33, 28672
  v_mfma_f32_16x16x32_bf16 v[188:191], v[72:75], v[108:111], v[188:191]
  s_mov_b32 s34, 74112
  v_mfma_f32_16x16x32_bf16 v[188:191], v[76:79], v[124:127], v[188:191]
  buffer_load_dwordx4 v84, s[12:15], s34 offen lds
  s_waitcnt lgkmcnt(0)
  v_mfma_f32_16x16x32_bf16 v[128:131], v[56:59], a[48:51], 0
  s_waitcnt vmcnt(22)
  s_barrier
  v_mfma_f32_16x16x32_bf16 v[128:131], v[60:63], a[64:67], v[128:131]
  ds_read_b64_tr_b16 v[68:69], v12 offset:28672
  v_cvt_pk_bf16_f32 v40, v160, v161
  v_mfma_f32_16x16x32_bf16 v[128:131], v[64:67], a[80:83], v[128:131]
  ds_read_b64_tr_b16 v[70:71], v12 offset:30720
  v_cvt_pk_bf16_f32 v41, v162, v163
  v_mfma_f32_16x16x32_bf16 v[132:135], v[56:59], a[52:55], 0
  ds_read_b64_tr_b16 v[72:73], v11 offset:61440
  v_cvt_pk_bf16_f32 v42, v176, v177
  v_mfma_f32_16x16x32_bf16 v[132:135], v[60:63], a[68:71], v[132:135]
  ds_read_b64_tr_b16 v[74:75], v11 offset:63488
  v_cvt_pk_bf16_f32 v43, v178, v179
  v_mfma_f32_16x16x32_bf16 v[132:135], v[64:67], a[84:87], v[132:135]
  ds_read_b64_tr_b16 v[76:77], v13 offset:4096
  s_mov_b32 s35, 2048
  v_mfma_f32_16x16x32_bf16 v[136:139], v[56:59], a[56:59], 0
  ds_read_b64_tr_b16 v[78:79], v13 offset:6144
  buffer_store_dwordx4 v[40:43], v222, s[20:23], s35 offen sc1
  v_mfma_f32_16x16x32_bf16 v[136:139], v[60:63], a[72:75], v[136:139]
  s_add_u32 m0, s33, 32768
  v_cvt_pk_bf16_f32 v44, v164, v165
  v_mfma_f32_16x16x32_bf16 v[136:139], v[64:67], a[88:91], v[136:139]
  s_mov_b32 s34, 110976
  v_cvt_pk_bf16_f32 v45, v166, v167
  v_mfma_f32_16x16x32_bf16 v[140:143], v[56:59], a[60:63], 0
  buffer_load_dwordx4 v82, s[12:15], s34 offen lds
  v_cvt_pk_bf16_f32 v46, v180, v181
  v_mfma_f32_16x16x32_bf16 v[140:143], v[60:63], a[76:79], v[140:143]
  s_add_u32 m0, s33, 36864
  v_cvt_pk_bf16_f32 v47, v182, v183
  v_mfma_f32_16x16x32_bf16 v[140:143], v[64:67], a[92:95], v[140:143]
  s_mov_b32 s34, 147840
  buffer_load_dwordx4 v82, s[12:15], s34 offen lds
  s_waitcnt lgkmcnt(0)
  v_mfma_f32_16x16x32_bf16 v[144:147], v[68:71], a[48:51], 0
  ds_read_b64_tr_b16 v[56:57], v9 offset:32768
  v_cvt_pk_bf16_f32 v48, v168, v169
  v_mfma_f32_16x16x32_bf16 v[144:147], v[72:75], a[64:67], v[144:147]
  ds_read_b64_tr_b16 v[58:59], v9 offset:34816
  v_cvt_pk_bf16_f32 v49, v170, v171
  v_mfma_f32_16x16x32_bf16 v[144:147], v[76:79], a[80:83], v[144:147]
  ds_read_b64_tr_b16 v[60:61], v9
  v_cvt_pk_bf16_f32 v50, v184, v185
  v_mfma_f32_16x16x32_bf16 v[148:151], v[68:71], a[52:55], 0
  ds_read_b64_tr_b16 v[62:63], v9 offset:2048
  v_cvt_pk_bf16_f32 v51, v186, v187
  v_mfma_f32_16x16x32_bf16 v[148:151], v[72:75], a[68:71], v[148:151]
  ds_read_b64_tr_b16 v[64:65], v9 offset:4096
  v_cvt_pk_bf16_f32 v52, v172, v173
  v_mfma_f32_16x16x32_bf16 v[148:151], v[76:79], a[84:87], v[148:151]
  ds_read_b64_tr_b16 v[66:67], v9 offset:6144
  v_cvt_pk_bf16_f32 v53, v174, v175
  v_mfma_f32_16x16x32_bf16 v[152:155], v[68:71], a[56:59], 0
  s_add_u32 m0, s33, 45056
  v_cvt_pk_bf16_f32 v54, v188, v189
  v_mfma_f32_16x16x32_bf16 v[152:155], v[72:75], a[72:75], v[152:155]
  s_mov_b32 s34, 184704
  v_cvt_pk_bf16_f32 v55, v190, v191
  v_mfma_f32_16x16x32_bf16 v[152:155], v[76:79], a[88:91], v[152:155]
  buffer_load_dwordx4 v82, s[12:15], s34 offen lds
  v_mfma_f32_16x16x32_bf16 v[156:159], v[68:71], a[60:63], 0
  s_add_u32 m0, s33, 49152
  v_mfma_f32_16x16x32_bf16 v[156:159], v[72:75], a[76:79], v[156:159]
  s_mov_b32 s34, 110976
  v_mfma_f32_16x16x32_bf16 v[156:159], v[76:79], a[92:95], v[156:159]
  buffer_load_dwordx4 v84, s[12:15], s34 offen lds
  s_waitcnt lgkmcnt(0)
  v_mfma_f32_16x16x32_bf16 v[128:131], v[56:59], a[0:3], v[128:131]
  ds_read_b64_tr_b16 v[68:69], v12 offset:32768
  v_mfma_f32_16x16x32_bf16 v[128:131], v[60:63], a[16:19], v[128:131]
  ds_read_b64_tr_b16 v[70:71], v12 offset:34816
  v_mfma_f32_16x16x32_bf16 v[128:131], v[64:67], a[32:35], v[128:131]
  ds_read_b64_tr_b16 v[72:73], v12
  v_mfma_f32_16x16x32_bf16 v[132:135], v[56:59], a[4:7], v[132:135]
  ds_read_b64_tr_b16 v[74:75], v12 offset:2048
  v_mfma_f32_16x16x32_bf16 v[132:135], v[60:63], a[20:23], v[132:135]
  ds_read_b64_tr_b16 v[76:77], v12 offset:4096
  v_mfma_f32_16x16x32_bf16 v[132:135], v[64:67], a[36:39], v[132:135]
  ds_read_b64_tr_b16 v[78:79], v12 offset:6144
  v_mfma_f32_16x16x32_bf16 v[136:139], v[56:59], a[8:11], v[136:139]
  s_add_u32 m0, s33, 53248
  v_mfma_f32_16x16x32_bf16 v[136:139], v[60:63], a[24:27], v[136:139]
  s_mov_b32 s34, 384
  s_mov_b32 s35, 20480
  v_mfma_f32_16x16x32_bf16 v[136:139], v[64:67], a[40:43], v[136:139]
  buffer_load_dwordx4 v83, s[12:15], s34 offen lds
  buffer_store_dwordx4 v[44:47], v222, s[20:23], s35 offen sc1
  v_mfma_f32_16x16x32_bf16 v[140:143], v[56:59], a[12:15], v[140:143]
  s_add_u32 m0, s33, 16384
  v_mfma_f32_16x16x32_bf16 v[140:143], v[60:63], a[28:31], v[140:143]
  s_mov_b32 s34, 384
  v_mfma_f32_16x16x32_bf16 v[140:143], v[64:67], a[44:47], v[140:143]
  buffer_load_dwordx4 v85, s[12:15], s34 offen lds
  s_waitcnt lgkmcnt(0)
  v_mfma_f32_16x16x32_bf16 v[144:147], v[68:71], a[0:3], v[144:147]
  s_waitcnt vmcnt(24)
  s_barrier
  v_mfma_f32_16x16x32_bf16 v[144:147], v[72:75], a[16:19], v[144:147]
  ds_read_b64_tr_b16 v[56:57], v10 offset:8192
  v_mfma_f32_16x16x32_bf16 v[144:147], v[76:79], a[32:35], v[144:147]
  ds_read_b64_tr_b16 v[58:59], v10 offset:10240
  v_mfma_f32_16x16x32_bf16 v[148:151], v[68:71], a[4:7], v[148:151]
  ds_read_b64_tr_b16 v[60:61], v9 offset:36864
  v_mfma_f32_16x16x32_bf16 v[148:151], v[72:75], a[20:23], v[148:151]
  ds_read_b64_tr_b16 v[62:63], v9 offset:38912
  v_mfma_f32_16x16x32_bf16 v[148:151], v[76:79], a[36:39], v[148:151]
  ds_read_b64_tr_b16 v[64:65], v9 offset:40960
  v_mfma_f32_16x16x32_bf16 v[152:155], v[68:71], a[8:11], v[152:155]
  ds_read_b64_tr_b16 v[66:67], v9 offset:43008
  v_mfma_f32_16x16x32_bf16 v[152:155], v[72:75], a[24:27], v[152:155]
  s_add_u32 m0, s33, 20480
  v_mfma_f32_16x16x32_bf16 v[152:155], v[76:79], a[40:43], v[152:155]
  s_mov_b32 s34, 147840
  s_mov_b32 s35, 38912
  v_mfma_f32_16x16x32_bf16 v[156:159], v[68:71], a[12:15], v[156:159]
  buffer_load_dwordx4 v84, s[12:15], s34 offen lds
  buffer_store_dwordx4 v[48:51], v222, s[20:23], s35 offen sc1
  v_mfma_f32_16x16x32_bf16 v[156:159], v[72:75], a[28:31], v[156:159]
  s_add_u32 m0, s33, 24576
  v_mfma_f32_16x16x32_bf16 v[156:159], v[76:79], a[44:47], v[156:159]
  s_mov_b32 s34, 184704
  buffer_load_dwordx4 v84, s[12:15], s34 offen lds
  s_waitcnt lgkmcnt(0)
  v_mfma_f32_16x16x32_bf16 v[128:131], v[56:59], a[112:115], v[128:131]
  ds_read_b64_tr_b16 v[68:69], v13 offset:8192
  v_mfma_f32_16x16x32_bf16 v[128:131], v[60:63], a[128:131], v[128:131]
  ds_read_b64_tr_b16 v[70:71], v13 offset:10240
  v_mfma_f32_16x16x32_bf16 v[128:131], v[64:67], a[144:147], v[128:131]
  ds_read_b64_tr_b16 v[72:73], v12 offset:36864
  v_mfma_f32_16x16x32_bf16 v[132:135], v[56:59], a[116:119], v[132:135]
  ds_read_b64_tr_b16 v[74:75], v12 offset:38912
  v_mfma_f32_16x16x32_bf16 v[132:135], v[60:63], a[132:135], v[132:135]
  ds_read_b64_tr_b16 v[76:77], v12 offset:40960
  v_mfma_f32_16x16x32_bf16 v[132:135], v[64:67], a[148:151], v[132:135]
  ds_read_b64_tr_b16 v[78:79], v12 offset:43008
  v_mfma_f32_16x16x32_bf16 v[136:139], v[56:59], a[120:123], v[136:139]
  s_add_u32 m0, s33, 40960
  v_mfma_f32_16x16x32_bf16 v[136:139], v[60:63], a[136:139], v[136:139]
  s_mov_b32 s34, 221568
  v_mfma_f32_16x16x32_bf16 v[136:139], v[64:67], a[152:155], v[136:139]
  buffer_load_dwordx4 v82, s[12:15], s34 offen lds
  v_mfma_f32_16x16x32_bf16 v[140:143], v[56:59], a[124:127], v[140:143]
  s_add_u32 m0, s33, 126976
  s_mov_b32 s35, 57344
  v_mfma_f32_16x16x32_bf16 v[140:143], v[60:63], a[140:143], v[140:143]
  s_mov_b32 s34, 258432
  buffer_store_dwordx4 v[52:55], v222, s[20:23], s35 offen sc1
  v_mfma_f32_16x16x32_bf16 v[140:143], v[64:67], a[156:159], v[140:143]
  buffer_load_dwordx4 v82, s[12:15], s34 offen lds
  s_waitcnt lgkmcnt(0)
  v_mfma_f32_16x16x32_bf16 v[144:147], v[68:71], a[112:115], v[144:147]
  ds_read_b64_tr_b16 v[56:57], v10 offset:12288
  v_mfma_f32_16x16x32_bf16 v[144:147], v[72:75], a[128:131], v[144:147]
  ds_read_b64_tr_b16 v[58:59], v10 offset:14336
  v_mfma_f32_16x16x32_bf16 v[144:147], v[76:79], a[144:147], v[144:147]
  ds_read_b64_tr_b16 v[60:61], v9 offset:12288
  v_mfma_f32_16x16x32_bf16 v[148:151], v[68:71], a[116:119], v[148:151]
  ds_read_b64_tr_b16 v[62:63], v9 offset:14336
  v_mfma_f32_16x16x32_bf16 v[148:151], v[72:75], a[132:135], v[148:151]
  ds_read_b64_tr_b16 v[64:65], v8
  v_mfma_f32_16x16x32_bf16 v[148:151], v[76:79], a[148:151], v[148:151]
  ds_read_b64_tr_b16 v[66:67], v8 offset:2048
  v_mfma_f32_16x16x32_bf16 v[152:155], v[68:71], a[120:123], v[152:155]
  s_add_u32 m0, s33, 151552
  v_mfma_f32_16x16x32_bf16 v[152:155], v[72:75], a[136:139], v[152:155]
  s_mov_b32 s34, 221568
  v_mfma_f32_16x16x32_bf16 v[152:155], v[76:79], a[152:155], v[152:155]
  buffer_load_dwordx4 v84, s[12:15], s34 offen lds
  v_mfma_f32_16x16x32_bf16 v[156:159], v[68:71], a[124:127], v[156:159]
  s_add_u32 m0, s33, 114688
  v_mfma_f32_16x16x32_bf16 v[156:159], v[72:75], a[140:143], v[156:159]
  s_mov_b32 s34, 258432
  v_mfma_f32_16x16x32_bf16 v[156:159], v[76:79], a[156:159], v[156:159]
  buffer_load_dwordx4 v84, s[12:15], s34 offen lds
  s_waitcnt lgkmcnt(0)
  v_mfma_f32_16x16x32_bf16 v[128:131], v[56:59], a[96:99], v[128:131]
  s_waitcnt vmcnt(19)
  s_barrier
  s_mov_b32 s63, 262144
  buffer_store_dword v7, v29, s[96:99], s63 offen sc1
  v_mfma_f32_16x16x32_bf16 v[128:131], v[60:63], a[160:163], v[128:131]
  ds_read_b64_tr_b16 v[68:69], v13 offset:12288
  v_mfma_f32_16x16x32_bf16 v[128:131], v[64:67], a[176:179], v[128:131]
  ds_read_b64_tr_b16 v[70:71], v13 offset:14336
  v_mfma_f32_16x16x32_bf16 v[132:135], v[56:59], a[100:103], v[132:135]
  ds_read_b64_tr_b16 v[72:73], v12 offset:12288
  v_mfma_f32_16x16x32_bf16 v[132:135], v[60:63], a[164:167], v[132:135]
  ds_read_b64_tr_b16 v[74:75], v12 offset:14336
  v_mfma_f32_16x16x32_bf16 v[132:135], v[64:67], a[180:183], v[132:135]
  ds_read_b64_tr_b16 v[76:77], v11
  v_mfma_f32_16x16x32_bf16 v[136:139], v[56:59], a[104:107], v[136:139]
  ds_read_b64_tr_b16 v[78:79], v11 offset:2048
  v_mfma_f32_16x16x32_bf16 v[136:139], v[60:63], a[168:171], v[136:139]
  s_add_u32 m0, s33, 155648
  v_mfma_f32_16x16x32_bf16 v[136:139], v[64:67], a[184:187], v[136:139]
  s_mov_b32 s34, 0
  v_mfma_f32_16x16x32_bf16 v[140:143], v[56:59], a[108:111], v[140:143]
  buffer_load_dwordx4 v86, s[12:15], s34 offen lds
  v_mfma_f32_16x16x32_bf16 v[140:143], v[60:63], a[172:175], v[140:143]
  s_add_u32 m0, s33, 118784
  v_mfma_f32_16x16x32_bf16 v[140:143], v[64:67], a[188:191], v[140:143]
  s_mov_b32 s34, 36864
  buffer_load_dwordx4 v86, s[12:15], s34 offen lds
  s_waitcnt lgkmcnt(0)
  v_mfma_f32_16x16x32_bf16 v[144:147], v[68:71], a[96:99], v[144:147]
  ds_read_b64_tr_b16 v[56:57], v8 offset:4096
  v_mfma_f32_16x16x32_bf16 v[144:147], v[72:75], a[160:163], v[144:147]
  ds_read_b64_tr_b16 v[58:59], v8 offset:6144
  v_mfma_f32_16x16x32_bf16 v[144:147], v[76:79], a[176:179], v[144:147]
  ds_read_b64_tr_b16 v[60:61], v9 offset:45056
  v_mfma_f32_16x16x32_bf16 v[148:151], v[68:71], a[100:103], v[148:151]
  ds_read_b64_tr_b16 v[62:63], v9 offset:47104
  v_mfma_f32_16x16x32_bf16 v[148:151], v[72:75], a[164:167], v[148:151]
  ds_read_b64_tr_b16 v[64:65], v10 offset:28672
  v_mfma_f32_16x16x32_bf16 v[148:151], v[76:79], a[180:183], v[148:151]
  ds_read_b64_tr_b16 v[66:67], v10 offset:30720
  v_mfma_f32_16x16x32_bf16 v[152:155], v[68:71], a[104:107], v[152:155]
  s_add_u32 m0, s33, 131072
  v_mfma_f32_16x16x32_bf16 v[152:155], v[72:75], a[168:171], v[152:155]
  s_mov_b32 s34, 73728
  v_mfma_f32_16x16x32_bf16 v[152:155], v[76:79], a[184:187], v[152:155]
  buffer_load_dwordx4 v86, s[12:15], s34 offen lds
  v_mfma_f32_16x16x32_bf16 v[156:159], v[68:71], a[108:111], v[156:159]
  s_add_u32 m0, s33, 90112
  v_mfma_f32_16x16x32_bf16 v[156:159], v[72:75], a[172:175], v[156:159]
  s_mov_b32 s34, 110592
  v_mfma_f32_16x16x32_bf16 v[156:159], v[76:79], a[188:191], v[156:159]
  buffer_load_dwordx4 v86, s[12:15], s34 offen lds
  s_waitcnt lgkmcnt(0)
  v_mfma_f32_16x16x32_bf16 v[128:131], v[56:59], a[192:195], v[128:131]
  ds_read_b64_tr_b16 v[68:69], v11 offset:4096
  v_mfma_f32_16x16x32_bf16 v[128:131], v[60:63], a[208:211], v[128:131]
  ds_read_b64_tr_b16 v[70:71], v11 offset:6144
  v_mfma_f32_16x16x32_bf16 v[128:131], v[64:67], a[224:227], v[128:131]
  ds_read_b64_tr_b16 v[72:73], v12 offset:45056
  v_mfma_f32_16x16x32_bf16 v[132:135], v[56:59], a[196:199], v[132:135]
  ds_read_b64_tr_b16 v[74:75], v12 offset:47104
  v_mfma_f32_16x16x32_bf16 v[132:135], v[60:63], a[212:215], v[132:135]
  ds_read_b64_tr_b16 v[76:77], v13 offset:28672
  v_mfma_f32_16x16x32_bf16 v[132:135], v[64:67], a[228:231], v[132:135]
  ds_read_b64_tr_b16 v[78:79], v13 offset:30720
  v_mfma_f32_16x16x32_bf16 v[136:139], v[56:59], a[200:203], v[136:139]
  s_add_u32 m0, s33, 94208
  v_mfma_f32_16x16x32_bf16 v[136:139], v[60:63], a[216:219], v[136:139]
  s_mov_b32 s34, 147456
  v_mfma_f32_16x16x32_bf16 v[136:139], v[64:67], a[232:235], v[136:139]
  buffer_load_dwordx4 v86, s[12:15], s34 offen lds
  v_mfma_f32_16x16x32_bf16 v[140:143], v[56:59], a[204:207], v[140:143]
  s_add_u32 m0, s33, 61440
  v_mfma_f32_16x16x32_bf16 v[140:143], v[60:63], a[220:223], v[140:143]
  s_mov_b32 s34, 184320
  v_mfma_f32_16x16x32_bf16 v[140:143], v[64:67], a[236:239], v[140:143]
  buffer_load_dwordx4 v86, s[12:15], s34 offen lds
  s_waitcnt lgkmcnt(0)
  v_mfma_f32_16x16x32_bf16 v[144:147], v[68:71], a[192:195], v[144:147]
  s_barrier
  v_mfma_f32_16x16x32_bf16 v[144:147], v[72:75], a[208:211], v[144:147]
  ds_read_b64_tr_b16 v[56:57], v9 offset:57344
  v_mfma_f32_16x16x32_bf16 v[144:147], v[76:79], a[224:227], v[144:147]
  ds_read_b64_tr_b16 v[58:59], v9 offset:59392
  v_mfma_f32_16x16x32_bf16 v[148:151], v[68:71], a[196:199], v[148:151]
  ds_read_b64_tr_b16 v[60:61], v10 offset:16384
  v_mfma_f32_16x16x32_bf16 v[148:151], v[72:75], a[212:215], v[148:151]
  ds_read_b64_tr_b16 v[62:63], v10 offset:18432
  v_mfma_f32_16x16x32_bf16 v[148:151], v[76:79], a[228:231], v[148:151]
  ds_read_b64_tr_b16 v[64:65], v9 offset:16384
  v_mfma_f32_16x16x32_bf16 v[152:155], v[68:71], a[200:203], v[152:155]
  ds_read_b64_tr_b16 v[66:67], v9 offset:18432
  v_mfma_f32_16x16x32_bf16 v[152:155], v[72:75], a[216:219], v[152:155]
  s_add_u32 m0, s33, 135168
  v_mfma_f32_16x16x32_bf16 v[152:155], v[76:79], a[232:235], v[152:155]
  s_mov_b32 s34, 221184
  v_mfma_f32_16x16x32_bf16 v[156:159], v[68:71], a[204:207], v[156:159]
  buffer_load_dwordx4 v86, s[12:15], s34 offen lds
  v_mfma_f32_16x16x32_bf16 v[156:159], v[72:75], a[220:223], v[156:159]
  s_add_u32 m0, s33, 98304
  v_mfma_f32_16x16x32_bf16 v[156:159], v[76:79], a[236:239], v[156:159]
  s_mov_b32 s34, 258048
  buffer_load_dwordx4 v86, s[12:15], s34 offen lds
  s_waitcnt lgkmcnt(0)
  v_mfma_f32_16x16x32_bf16 v[128:131], v[56:59], a[240:243], v[128:131]
  ds_read_b64_tr_b16 v[68:69], v12 offset:57344
  v_mfma_f32_16x16x32_bf16 v[128:131], v[60:63], v[96:99], v[128:131]
  ds_read_b64_tr_b16 v[70:71], v12 offset:59392
  s_mov_b32 s63, 262144
  buffer_load_dword v31, v30, s[96:99], s63 offen sc1
  v_mfma_f32_16x16x32_bf16 v[128:131], v[64:67], v[112:115], v[128:131]
  ds_read_b64_tr_b16 v[72:73], v13 offset:16384
  v_mfma_f32_16x16x32_bf16 v[132:135], v[56:59], a[244:247], v[132:135]
  ds_read_b64_tr_b16 v[74:75], v13 offset:18432
  v_mfma_f32_16x16x32_bf16 v[132:135], v[60:63], v[100:103], v[132:135]
  ds_read_b64_tr_b16 v[76:77], v12 offset:16384
  v_mfma_f32_16x16x32_bf16 v[132:135], v[64:67], v[116:119], v[132:135]
  ds_read_b64_tr_b16 v[78:79], v12 offset:18432
  v_mfma_f32_16x16x32_bf16 v[136:139], v[56:59], a[248:251], v[136:139]
  s_add_u32 m0, s33, 65536
  v_mfma_f32_16x16x32_bf16 v[136:139], v[60:63], v[104:107], v[136:139]
  s_mov_b32 s34, 0
  v_mfma_f32_16x16x32_bf16 v[136:139], v[64:67], v[120:123], v[136:139]
  buffer_load_dwordx4 v87, s[12:15], s34 offen lds
  v_mfma_f32_16x16x32_bf16 v[140:143], v[56:59], a[252:255], v[140:143]
  v_mfma_f32_16x16x32_bf16 v[140:143], v[60:63], v[108:111], v[140:143]
  v_mfma_f32_16x16x32_bf16 v[140:143], v[64:67], v[124:127], v[140:143]
  s_waitcnt lgkmcnt(0)
  v_mfma_f32_16x16x32_bf16 v[144:147], v[68:71], a[240:243], v[144:147]
  ds_read_b64_tr_b16 v[56:57], v9 offset:20480
  v_mfma_f32_16x16x32_bf16 v[144:147], v[72:75], v[96:99], v[144:147]
  ds_read_b64_tr_b16 v[58:59], v9 offset:22528
  v_mfma_f32_16x16x32_bf16 v[144:147], v[76:79], v[112:115], v[144:147]
  ds_read_b64_tr_b16 v[60:61], v8 offset:57344
  v_mfma_f32_16x16x32_bf16 v[148:151], v[68:71], a[244:247], v[148:151]
  ds_read_b64_tr_b16 v[62:63], v8 offset:59392
  v_mfma_f32_16x16x32_bf16 v[148:151], v[72:75], v[100:103], v[148:151]
  ds_read_b64_tr_b16 v[64:65], v9 offset:8192
  v_mfma_f32_16x16x32_bf16 v[148:151], v[76:79], v[116:119], v[148:151]
  ds_read_b64_tr_b16 v[66:67], v9 offset:10240
  v_mfma_f32_16x16x32_bf16 v[152:155], v[68:71], a[248:251], v[152:155]
  v_mfma_f32_16x16x32_bf16 v[152:155], v[72:75], v[104:107], v[152:155]
  v_mfma_f32_16x16x32_bf16 v[152:155], v[76:79], v[120:123], v[152:155]
  v_mfma_f32_16x16x32_bf16 v[156:159], v[68:71], a[252:255], v[156:159]
  v_mfma_f32_16x16x32_bf16 v[156:159], v[72:75], v[108:111], v[156:159]
  v_mfma_f32_16x16x32_bf16 v[156:159], v[76:79], v[124:127], v[156:159]
  s_waitcnt lgkmcnt(0)
  v_mfma_f32_16x16x32_bf16 v[160:163], v[56:59], a[48:51], 0
  s_waitcnt vmcnt(14)
  s_barrier
  s_mov_b32 s63, 294912
  buffer_store_dword v7, v29, s[96:99], s63 offen sc1
  v_mfma_f32_16x16x32_bf16 v[160:163], v[60:63], a[64:67], v[160:163]
  ds_read_b64_tr_b16 v[68:69], v12 offset:20480
  v_cvt_pk_bf16_f32 v40, v128, v129
  v_mfma_f32_16x16x32_bf16 v[160:163], v[64:67], a[80:83], v[160:163]
  ds_read_b64_tr_b16 v[70:71], v12 offset:22528
  v_cvt_pk_bf16_f32 v41, v130, v131
  v_mfma_f32_16x16x32_bf16 v[164:167], v[56:59], a[52:55], 0
  ds_read_b64_tr_b16 v[72:73], v11 offset:57344
  v_cvt_pk_bf16_f32 v42, v144, v145
  v_mfma_f32_16x16x32_bf16 v[164:167], v[60:63], a[68:71], v[164:167]
  ds_read_b64_tr_b16 v[74:75], v11 offset:59392
  v_cvt_pk_bf16_f32 v43, v146, v147
  v_mfma_f32_16x16x32_bf16 v[164:167], v[64:67], a[84:87], v[164:167]
  ds_read_b64_tr_b16 v[76:77], v12 offset:8192
  s_mov_b32 s35, 4096
  v_mfma_f32_16x16x32_bf16 v[168:171], v[56:59], a[56:59], 0
  ds_read_b64_tr_b16 v[78:79], v12 offset:10240
  buffer_store_dwordx4 v[40:43], v222, s[20:23], s35 offen sc1
  v_mfma_f32_16x16x32_bf16 v[168:171], v[60:63], a[72:75], v[168:171]
  v_cvt_pk_bf16_f32 v44, v132, v133
  v_cvt_pk_bf16_f32 v45, v134, v135
  v_mfma_f32_16x16x32_bf16 v[168:171], v[64:67], a[88:91], v[168:171]
  v_cvt_pk_bf16_f32 v46, v148, v149
  v_cvt_pk_bf16_f32 v47, v150, v151
  v_mfma_f32_16x16x32_bf16 v[172:175], v[56:59], a[60:63], 0
  v_cvt_pk_bf16_f32 v48, v136, v137
  v_cvt_pk_bf16_f32 v49, v138, v139
  v_mfma_f32_16x16x32_bf16 v[172:175], v[60:63], a[76:79], v[172:175]
  v_cvt_pk_bf16_f32 v50, v152, v153
  v_cvt_pk_bf16_f32 v51, v154, v155
  v_mfma_f32_16x16x32_bf16 v[172:175], v[64:67], a[92:95], v[172:175]
  v_cvt_pk_bf16_f32 v52, v140, v141
  s_waitcnt lgkmcnt(0)
  v_mfma_f32_16x16x32_bf16 v[176:179], v[68:71], a[48:51], 0
  ds_read_b64_tr_b16 v[56:57], v8 offset:8192
  v_cvt_pk_bf16_f32 v53, v142, v143
  v_mfma_f32_16x16x32_bf16 v[176:179], v[72:75], a[64:67], v[176:179]
  ds_read_b64_tr_b16 v[58:59], v8 offset:10240
  v_cvt_pk_bf16_f32 v54, v156, v157
  v_mfma_f32_16x16x32_bf16 v[176:179], v[76:79], a[80:83], v[176:179]
  ds_read_b64_tr_b16 v[60:61], v8 offset:12288
  v_cvt_pk_bf16_f32 v55, v158, v159
  v_mfma_f32_16x16x32_bf16 v[180:183], v[68:71], a[52:55], 0
  ds_read_b64_tr_b16 v[62:63], v8 offset:14336
  v_mfma_f32_16x16x32_bf16 v[180:183], v[72:75], a[68:71], v[180:183]
  ds_read_b64_tr_b16 v[64:65], v8 offset:28672
  v_mfma_f32_16x16x32_bf16 v[180:183], v[76:79], a[84:87], v[180:183]
  ds_read_b64_tr_b16 v[66:67], v8 offset:30720
  v_mfma_f32_16x16x32_bf16 v[184:187], v[68:71], a[56:59], 0
  v_mfma_f32_16x16x32_bf16 v[184:187], v[72:75], a[72:75], v[184:187]
  v_mfma_f32_16x16x32_bf16 v[184:187], v[76:79], a[88:91], v[184:187]
  v_mfma_f32_16x16x32_bf16 v[188:191], v[68:71], a[60:63], 0
  v_mfma_f32_16x16x32_bf16 v[188:191], v[72:75], a[76:79], v[188:191]
  v_mfma_f32_16x16x32_bf16 v[188:191], v[76:79], a[92:95], v[188:191]
  s_waitcnt lgkmcnt(0)
  v_mfma_f32_16x16x32_bf16 v[160:163], v[56:59], a[0:3], v[160:163]
  ds_read_b64_tr_b16 v[68:69], v11 offset:8192
  v_mfma_f32_16x16x32_bf16 v[160:163], v[60:63], a[16:19], v[160:163]
  ds_read_b64_tr_b16 v[70:71], v11 offset:10240
  v_mfma_f32_16x16x32_bf16 v[160:163], v[64:67], a[32:35], v[160:163]
  ds_read_b64_tr_b16 v[72:73], v11 offset:12288
  s_mov_b32 s35, 22528
  v_mfma_f32_16x16x32_bf16 v[164:167], v[56:59], a[4:7], v[164:167]
  ds_read_b64_tr_b16 v[74:75], v11 offset:14336
  buffer_store_dwordx4 v[44:47], v222, s[20:23], s35 offen sc1
  v_mfma_f32_16x16x32_bf16 v[164:167], v[60:63], a[20:23], v[164:167]
  ds_read_b64_tr_b16 v[76:77], v11 offset:28672
  v_mfma_f32_16x16x32_bf16 v[164:167], v[64:67], a[36:39], v[164:167]
  ds_read_b64_tr_b16 v[78:79], v11 offset:30720
  v_mfma_f32_16x16x32_bf16 v[168:171], v[56:59], a[8:11], v[168:171]
  v_mfma_f32_16x16x32_bf16 v[168:171], v[60:63], a[24:27], v[168:171]
  v_mfma_f32_16x16x32_bf16 v[168:171], v[64:67], a[40:43], v[168:171]
  v_mfma_f32_16x16x32_bf16 v[172:175], v[56:59], a[12:15], v[172:175]
  v_mfma_f32_16x16x32_bf16 v[172:175], v[60:63], a[28:31], v[172:175]
  v_mfma_f32_16x16x32_bf16 v[172:175], v[64:67], a[44:47], v[172:175]
  s_waitcnt lgkmcnt(0)
  v_mfma_f32_16x16x32_bf16 v[176:179], v[68:71], a[0:3], v[176:179]
  s_barrier
  v_mfma_f32_16x16x32_bf16 v[176:179], v[72:75], a[16:19], v[176:179]
  ds_read_b64_tr_b16 v[56:57], v8 offset:32768
  s_waitcnt vmcnt(4)
  v_cmp_ne_u32 vcc, v7, v31
  s_cbranch_vccnz L_sp_28
L_bk_29:
  v_mfma_f32_16x16x32_bf16 v[176:179], v[76:79], a[32:35], v[176:179]
  ds_read_b64_tr_b16 v[58:59], v8 offset:34816
  s_mov_b32 s65, 0
  v_mfma_f32_16x16x32_bf16 v[180:183], v[68:71], a[4:7], v[180:183]
  ds_read_b64_tr_b16 v[60:61], v8 offset:36864
  buffer_load_dwordx4 v[224:227], v220, s[72:75], s65 offen sc1
  v_mfma_f32_16x16x32_bf16 v[180:183], v[72:75], a[20:23], v[180:183]
  ds_read_b64_tr_b16 v[62:63], v8 offset:38912
  s_mov_b32 s35, 40960
  v_mfma_f32_16x16x32_bf16 v[180:183], v[76:79], a[36:39], v[180:183]
  ds_read_b64_tr_b16 v[64:65], v8 offset:45056
  buffer_store_dwordx4 v[48:51], v222, s[20:23], s35 offen sc1
  v_mfma_f32_16x16x32_bf16 v[184:187], v[68:71], a[8:11], v[184:187]
  ds_read_b64_tr_b16 v[66:67], v8 offset:47104
  v_mfma_f32_16x16x32_bf16 v[184:187], v[72:75], a[24:27], v[184:187]
  v_mfma_f32_16x16x32_bf16 v[184:187], v[76:79], a[40:43], v[184:187]
  v_mfma_f32_16x16x32_bf16 v[188:191], v[68:71], a[12:15], v[188:191]
  v_mfma_f32_16x16x32_bf16 v[188:191], v[72:75], a[28:31], v[188:191]
  v_mfma_f32_16x16x32_bf16 v[188:191], v[76:79], a[44:47], v[188:191]
  s_waitcnt lgkmcnt(0)
  v_mfma_f32_16x16x32_bf16 v[160:163], v[56:59], a[112:115], v[160:163]
  ds_read_b64_tr_b16 v[68:69], v11 offset:32768
  v_mfma_f32_16x16x32_bf16 v[160:163], v[60:63], a[128:131], v[160:163]
  ds_read_b64_tr_b16 v[70:71], v11 offset:34816
  v_mfma_f32_16x16x32_bf16 v[160:163], v[64:67], a[144:147], v[160:163]
  ds_read_b64_tr_b16 v[72:73], v11 offset:36864
  v_mfma_f32_16x16x32_bf16 v[164:167], v[56:59], a[116:119], v[164:167]
  ds_read_b64_tr_b16 v[74:75], v11 offset:38912
  s_mov_b32 s65, 9437184
  v_mfma_f32_16x16x32_bf16 v[164:167], v[60:63], a[132:135], v[164:167]
  ds_read_b64_tr_b16 v[76:77], v11 offset:45056
  buffer_load_dwordx4 v[228:231], v220, s[72:75], s65 offen sc1
  v_mfma_f32_16x16x32_bf16 v[164:167], v[64:67], a[148:151], v[164:167]
  ds_read_b64_tr_b16 v[78:79], v11 offset:47104
  s_mov_b32 s35, 59392
  v_mfma_f32_16x16x32_bf16 v[168:171], v[56:59], a[120:123], v[168:171]
  buffer_store_dwordx4 v[52:55], v222, s[20:23], s35 offen sc1
  v_mfma_f32_16x16x32_bf16 v[168:171], v[60:63], a[136:139], v[168:171]
  v_mfma_f32_16x16x32_bf16 v[168:171], v[64:67], a[152:155], v[168:171]
  v_mfma_f32_16x16x32_bf16 v[172:175], v[56:59], a[124:127], v[172:175]
  v_mfma_f32_16x16x32_bf16 v[172:175], v[60:63], a[140:143], v[172:175]
  v_mfma_f32_16x16x32_bf16 v[172:175], v[64:67], a[156:159], v[172:175]
  s_waitcnt lgkmcnt(0)
  v_mfma_f32_16x16x32_bf16 v[176:179], v[68:71], a[112:115], v[176:179]
  ds_read_b64_tr_b16 v[56:57], v8 offset:49152
  v_mfma_f32_16x16x32_bf16 v[176:179], v[72:75], a[128:131], v[176:179]
  ds_read_b64_tr_b16 v[58:59], v8 offset:51200
  v_mfma_f32_16x16x32_bf16 v[176:179], v[76:79], a[144:147], v[176:179]
  ds_read_b64_tr_b16 v[60:61], v8 offset:53248
  v_mfma_f32_16x16x32_bf16 v[180:183], v[68:71], a[116:119], v[180:183]
  ds_read_b64_tr_b16 v[62:63], v8 offset:55296
  v_mfma_f32_16x16x32_bf16 v[180:183], v[72:75], a[132:135], v[180:183]
  ds_read_b64_tr_b16 v[64:65], v8 offset:16384
  s_mov_b32 s65, 10240
  v_mfma_f32_16x16x32_bf16 v[180:183], v[76:79], a[148:151], v[180:183]
  ds_read_b64_tr_b16 v[66:67], v8 offset:18432
  buffer_load_dwordx4 v[232:235], v220, s[72:75], s65 offen sc1
  v_mfma_f32_16x16x32_bf16 v[184:187], v[68:71], a[120:123], v[184:187]
  v_mfma_f32_16x16x32_bf16 v[184:187], v[72:75], a[136:139], v[184:187]
  v_mfma_f32_16x16x32_bf16 v[184:187], v[76:79], a[152:155], v[184:187]
  v_mfma_f32_16x16x32_bf16 v[188:191], v[68:71], a[124:127], v[188:191]
  v_mfma_f32_16x16x32_bf16 v[188:191], v[72:75], a[140:143], v[188:191]
  v_mfma_f32_16x16x32_bf16 v[188:191], v[76:79], a[156:159], v[188:191]
  s_waitcnt lgkmcnt(0)
  v_mfma_f32_16x16x32_bf16 v[160:163], v[56:59], a[96:99], v[160:163]
  s_barrier
  v_mfma_f32_16x16x32_bf16 v[160:163], v[60:63], a[160:163], v[160:163]
  ds_read_b64_tr_b16 v[68:69], v11 offset:49152
  v_mfma_f32_16x16x32_bf16 v[160:163], v[64:67], a[176:179], v[160:163]
  ds_read_b64_tr_b16 v[70:71], v11 offset:51200
  v_mfma_f32_16x16x32_bf16 v[164:167], v[56:59], a[100:103], v[164:167]
  ds_read_b64_tr_b16 v[72:73], v11 offset:53248
  v_mfma_f32_16x16x32_bf16 v[164:167], v[60:63], a[164:167], v[164:167]
  ds_read_b64_tr_b16 v[74:75], v11 offset:55296
  v_mfma_f32_16x16x32_bf16 v[164:167], v[64:67], a[180:183], v[164:167]
  ds_read_b64_tr_b16 v[76:77], v11 offset:16384
  s_mov_b32 s65, 9447424
  v_mfma_f32_16x16x32_bf16 v[168:171], v[56:59], a[104:107], v[168:171]
  ds_read_b64_tr_b16 v[78:79], v11 offset:18432
  buffer_load_dwordx4 v[236:239], v220, s[72:75], s65 offen sc1
  v_mfma_f32_16x16x32_bf16 v[168:171], v[60:63], a[168:171], v[168:171]
  v_mfma_f32_16x16x32_bf16 v[168:171], v[64:67], a[184:187], v[168:171]
  v_mfma_f32_16x16x32_bf16 v[172:175], v[56:59], a[108:111], v[172:175]
  v_mfma_f32_16x16x32_bf16 v[172:175], v[60:63], a[172:175], v[172:175]
  v_mfma_f32_16x16x32_bf16 v[172:175], v[64:67], a[188:191], v[172:175]
  s_waitcnt lgkmcnt(0)
  v_mfma_f32_16x16x32_bf16 v[176:179], v[68:71], a[96:99], v[176:179]
  ds_read_b64_tr_b16 v[56:57], v8 offset:20480
  v_mfma_f32_16x16x32_bf16 v[176:179], v[72:75], a[160:163], v[176:179]
  ds_read_b64_tr_b16 v[58:59], v8 offset:22528
  s_mov_b32 s63, 294912
  buffer_load_dword v31, v30, s[96:99], s63 offen sc1
  v_mfma_f32_16x16x32_bf16 v[176:179], v[76:79], a[176:179], v[176:179]
  ds_read_b64_tr_b16 v[60:61], v8 offset:24576
  v_mfma_f32_16x16x32_bf16 v[180:183], v[68:71], a[100:103], v[180:183]
  ds_read_b64_tr_b16 v[62:63], v8 offset:26624
  v_mfma_f32_16x16x32_bf16 v[180:183], v[72:75], a[164:167], v[180:183]
  ds_read_b64_tr_b16 v[64:65], v8 offset:40960
  v_mfma_f32_16x16x32_bf16 v[180:183], v[76:79], a[180:183], v[180:183]
  ds_read_b64_tr_b16 v[66:67], v8 offset:43008
  v_mfma_f32_16x16x32_bf16 v[184:187], v[68:71], a[104:107], v[184:187]
  v_mfma_f32_16x16x32_bf16 v[184:187], v[72:75], a[168:171], v[184:187]
  v_mfma_f32_16x16x32_bf16 v[184:187], v[76:79], a[184:187], v[184:187]
  v_mfma_f32_16x16x32_bf16 v[188:191], v[68:71], a[108:111], v[188:191]
  v_mfma_f32_16x16x32_bf16 v[188:191], v[72:75], a[172:175], v[188:191]
  v_mfma_f32_16x16x32_bf16 v[188:191], v[76:79], a[188:191], v[188:191]
  s_waitcnt lgkmcnt(0)
  v_mfma_f32_16x16x32_bf16 v[160:163], v[56:59], a[192:195], v[160:163]
  ds_read_b64_tr_b16 v[68:69], v11 offset:20480
  v_mfma_f32_16x16x32_bf16 v[160:163], v[60:63], a[208:211], v[160:163]
  ds_read_b64_tr_b16 v[70:71], v11 offset:22528
  v_mfma_f32_16x16x32_bf16 v[160:163], v[64:67], a[224:227], v[160:163]
  ds_read_b64_tr_b16 v[72:73], v11 offset:24576
  v_mfma_f32_16x16x32_bf16 v[164:167], v[56:59], a[196:199], v[164:167]
  ds_read_b64_tr_b16 v[74:75], v11 offset:26624
  v_mfma_f32_16x16x32_bf16 v[164:167], v[60:63], a[212:215], v[164:167]
  ds_read_b64_tr_b16 v[76:77], v11 offset:40960
  v_mfma_f32_16x16x32_bf16 v[164:167], v[64:67], a[228:231], v[164:167]
  ds_read_b64_tr_b16 v[78:79], v11 offset:43008
  v_mfma_f32_16x16x32_bf16 v[168:171], v[56:59], a[200:203], v[168:171]
  v_mfma_f32_16x16x32_bf16 v[168:171], v[60:63], a[216:219], v[168:171]
  v_mfma_f32_16x16x32_bf16 v[168:171], v[64:67], a[232:235], v[168:171]
  v_mfma_f32_16x16x32_bf16 v[172:175], v[56:59], a[204:207], v[172:175]
  v_mfma_f32_16x16x32_bf16 v[172:175], v[60:63], a[220:223], v[172:175]
  v_mfma_f32_16x16x32_bf16 v[172:175], v[64:67], a[236:239], v[172:175]
  s_waitcnt lgkmcnt(0)
  v_mfma_f32_16x16x32_bf16 v[176:179], v[68:71], a[192:195], v[176:179]
  s_barrier
  v_mfma_f32_16x16x32_bf16 v[176:179], v[72:75], a[208:211], v[176:179]
  ds_read_b64_tr_b16 v[56:57], v9 offset:61440
  v_mfma_f32_16x16x32_bf16 v[176:179], v[76:79], a[224:227], v[176:179]
  ds_read_b64_tr_b16 v[58:59], v9 offset:63488
  v_mfma_f32_16x16x32_bf16 v[180:183], v[68:71], a[196:199], v[180:183]
  ds_read_b64_tr_b16 v[60:61], v10 offset:20480
  v_mfma_f32_16x16x32_bf16 v[180:183], v[72:75], a[212:215], v[180:183]
  ds_read_b64_tr_b16 v[62:63], v10 offset:22528
  v_mfma_f32_16x16x32_bf16 v[180:183], v[76:79], a[228:231], v[180:183]
  ds_read_b64_tr_b16 v[64:65], v9 offset:49152
  v_mfma_f32_16x16x32_bf16 v[184:187], v[68:71], a[200:203], v[184:187]
  ds_read_b64_tr_b16 v[66:67], v9 offset:51200
  v_mfma_f32_16x16x32_bf16 v[184:187], v[72:75], a[216:219], v[184:187]
  v_mfma_f32_16x16x32_bf16 v[184:187], v[76:79], a[232:235], v[184:187]
  v_mfma_f32_16x16x32_bf16 v[188:191], v[68:71], a[204:207], v[188:191]
  v_mfma_f32_16x16x32_bf16 v[188:191], v[72:75], a[220:223], v[188:191]
  v_mfma_f32_16x16x32_bf16 v[188:191], v[76:79], a[236:239], v[188:191]
  s_waitcnt lgkmcnt(0)
  v_mfma_f32_16x16x32_bf16 v[160:163], v[56:59], a[240:243], v[160:163]
  ds_read_b64_tr_b16 v[68:69], v12 offset:61440
  v_mfma_f32_16x16x32_bf16 v[160:163], v[60:63], v[96:99], v[160:163]
  ds_read_b64_tr_b16 v[70:71], v12 offset:63488
  v_mfma_f32_16x16x32_bf16 v[160:163], v[64:67], v[112:115], v[160:163]
  ds_read_b64_tr_b16 v[72:73], v13 offset:20480
  v_mfma_f32_16x16x32_bf16 v[164:167], v[56:59], a[244:247], v[164:167]
  ds_read_b64_tr_b16 v[74:75], v13 offset:22528
  v_mfma_f32_16x16x32_bf16 v[164:167], v[60:63], v[100:103], v[164:167]
  ds_read_b64_tr_b16 v[76:77], v12 offset:49152
  v_mfma_f32_16x16x32_bf16 v[164:167], v[64:67], v[116:119], v[164:167]
  ds_read_b64_tr_b16 v[78:79], v12 offset:51200
  v_mfma_f32_16x16x32_bf16 v[168:171], v[56:59], a[248:251], v[168:171]
  v_mfma_f32_16x16x32_bf16 v[168:171], v[60:63], v[104:107], v[168:171]
  v_mfma_f32_16x16x32_bf16 v[168:171], v[64:67], v[120:123], v[168:171]
  v_mfma_f32_16x16x32_bf16 v[172:175], v[56:59], a[252:255], v[172:175]
  v_mfma_f32_16x16x32_bf16 v[172:175], v[60:63], v[108:111], v[172:175]
  v_mfma_f32_16x16x32_bf16 v[172:175], v[64:67], v[124:127], v[172:175]
  s_waitcnt lgkmcnt(0)
  v_mfma_f32_16x16x32_bf16 v[176:179], v[68:71], a[240:243], v[176:179]
  ds_read_b64_tr_b16 v[56:57], v25 offset:24576
  v_mfma_f32_16x16x32_bf16 v[176:179], v[72:75], v[96:99], v[176:179]
  ds_read_b64_tr_b16 v[58:59], v25 offset:25600
  v_mfma_f32_16x16x32_bf16 v[176:179], v[76:79], v[112:115], v[176:179]
  ds_read_b64_tr_b16 v[60:61], v15 offset:53248
  v_mfma_f32_16x16x32_bf16 v[180:183], v[68:71], a[244:247], v[180:183]
  ds_read_b64_tr_b16 v[62:63], v15 offset:54272
  v_mfma_f32_16x16x32_bf16 v[180:183], v[72:75], v[100:103], v[180:183]
  ds_read_b64_tr_b16 v[64:65], v25
  v_mfma_f32_16x16x32_bf16 v[180:183], v[76:79], v[116:119], v[180:183]
  ds_read_b64_tr_b16 v[66:67], v25 offset:1024
  v_mfma_f32_16x16x32_bf16 v[184:187], v[68:71], a[248:251], v[184:187]
  v_mfma_f32_16x16x32_bf16 v[184:187], v[72:75], v[104:107], v[184:187]
  v_mfma_f32_16x16x32_bf16 v[184:187], v[76:79], v[120:123], v[184:187]
  v_mfma_f32_16x16x32_bf16 v[188:191], v[68:71], a[252:255], v[188:191]
  v_mfma_f32_16x16x32_bf16 v[188:191], v[72:75], v[108:111], v[188:191]
  v_mfma_f32_16x16x32_bf16 v[188:191], v[76:79], v[124:127], v[188:191]
  s_waitcnt lgkmcnt(0)
  v_mfma_f32_16x16x32_bf16 v[128:131], v[56:59], a[48:51], 0
  s_barrier
  v_mfma_f32_16x16x32_bf16 v[128:131], v[60:63], a[64:67], v[128:131]
  ds_read_b64_tr_b16 v[68:69], v25 offset:26624
  s_waitcnt vmcnt(6)
  v_mfma_f32_16x16x32_bf16 v[192:195], v[212:215], v[224:227], 0
  s_waitcnt vmcnt(0)
  v_cmp_ne_u32 vcc, v7, v31
  s_cbranch_vccnz L_sp_30
L_bk_31:
  v_mfma_f32_16x16x32_bf16 v[128:131], v[64:67], a[80:83], v[128:131]
  ds_read_b64_tr_b16 v[70:71], v25 offset:27648
  v_mfma_f32_16x16x32_bf16 v[192:195], v[212:215], v[228:231], v[192:195]
  v_mfma_f32_16x16x32_bf16 v[132:135], v[56:59], a[52:55], 0
  ds_read_b64_tr_b16 v[72:73], v15 offset:55296
  v_mfma_f32_16x16x32_bf16 v[192:195], v[216:219], v[232:235], v[192:195]
  v_mfma_f32_16x16x32_bf16 v[132:135], v[60:63], a[68:71], v[132:135]
  ds_read_b64_tr_b16 v[74:75], v15 offset:56320
  v_mfma_f32_16x16x32_bf16 v[192:195], v[216:219], v[236:239], v[192:195]
  v_mfma_f32_16x16x32_bf16 v[132:135], v[64:67], a[84:87], v[132:135]
  ds_read_b64_tr_b16 v[76:77], v25 offset:2048
  s_mov_b32 s65, 2048
  v_mfma_f32_16x16x32_bf16 v[136:139], v[56:59], a[56:59], 0
  ds_read_b64_tr_b16 v[78:79], v25 offset:3072
  buffer_load_dwordx4 v[240:243], v220, s[72:75], s65 offen sc1
  v_mfma_f32_16x16x32_bf16 v[136:139], v[60:63], a[72:75], v[136:139]
  v_cvt_pk_bf16_f32 v40, v160, v161
  v_cvt_pk_bf16_f32 v41, v162, v163
  v_mfma_f32_16x16x32_bf16 v[136:139], v[64:67], a[88:91], v[136:139]
  v_cvt_pk_bf16_f32 v42, v176, v177
  v_cvt_pk_bf16_f32 v43, v178, v179
  v_mfma_f32_16x16x32_bf16 v[140:143], v[56:59], a[60:63], 0
  s_mov_b32 s35, 6144
  buffer_store_dwordx4 v[40:43], v222, s[20:23], s35 offen sc1
  v_mfma_f32_16x16x32_bf16 v[140:143], v[60:63], a[76:79], v[140:143]
  v_cvt_pk_bf16_f32 v44, v164, v165
  v_cvt_pk_bf16_f32 v45, v166, v167
  v_mfma_f32_16x16x32_bf16 v[140:143], v[64:67], a[92:95], v[140:143]
  v_cvt_pk_bf16_f32 v46, v180, v181
  s_waitcnt lgkmcnt(0)
  v_mfma_f32_16x16x32_bf16 v[128:131], v[68:71], a[0:3], v[128:131]
  ds_read_b64_tr_b16 v[56:57], v15 offset:24576
  v_cvt_pk_bf16_f32 v47, v182, v183
  v_mfma_f32_16x16x32_bf16 v[128:131], v[72:75], a[16:19], v[128:131]
  ds_read_b64_tr_b16 v[58:59], v15 offset:25600
  s_mov_b32 s35, 24576
  v_mfma_f32_16x16x32_bf16 v[128:131], v[76:79], a[32:35], v[128:131]
  ds_read_b64_tr_b16 v[60:61], v15 offset:28672
  buffer_store_dwordx4 v[44:47], v222, s[20:23], s35 offen sc1
  v_mfma_f32_16x16x32_bf16 v[132:135], v[68:71], a[4:7], v[132:135]
  ds_read_b64_tr_b16 v[62:63], v15 offset:29696
  v_cvt_pk_bf16_f32 v48, v168, v169
  v_mfma_f32_16x16x32_bf16 v[132:135], v[72:75], a[20:23], v[132:135]
  ds_read_b64_tr_b16 v[64:65], v14 offset:61440
  v_cvt_pk_bf16_f32 v49, v170, v171
  v_mfma_f32_16x16x32_bf16 v[132:135], v[76:79], a[36:39], v[132:135]
  ds_read_b64_tr_b16 v[66:67], v14 offset:62464
  s_mov_b32 s65, 9439232
  v_mfma_f32_16x16x32_bf16 v[136:139], v[68:71], a[8:11], v[136:139]
  buffer_load_dwordx4 v[244:247], v220, s[72:75], s65 offen sc1
  v_cvt_pk_bf16_f32 v50, v184, v185
  v_mfma_f32_16x16x32_bf16 v[136:139], v[72:75], a[24:27], v[136:139]
  v_cvt_pk_bf16_f32 v51, v186, v187
  s_mov_b32 s35, 43008
  v_mfma_f32_16x16x32_bf16 v[136:139], v[76:79], a[40:43], v[136:139]
  buffer_store_dwordx4 v[48:51], v222, s[20:23], s35 offen sc1
  v_cvt_pk_bf16_f32 v52, v172, v173
  v_mfma_f32_16x16x32_bf16 v[140:143], v[68:71], a[12:15], v[140:143]
  v_cvt_pk_bf16_f32 v53, v174, v175
  v_cvt_pk_bf16_f32 v54, v188, v189
  v_mfma_f32_16x16x32_bf16 v[140:143], v[72:75], a[28:31], v[140:143]
  v_cvt_pk_bf16_f32 v55, v190, v191
  s_mov_b32 s35, 61440
  v_mfma_f32_16x16x32_bf16 v[140:143], v[76:79], a[44:47], v[140:143]
  buffer_store_dwordx4 v[52:55], v222, s[20:23], s35 offen sc1
  s_waitcnt lgkmcnt(0)
  v_mfma_f32_16x16x32_bf16 v[128:131], v[56:59], a[112:115], v[128:131]
  ds_read_b64_tr_b16 v[68:69], v15 offset:26624
  v_mfma_f32_16x16x32_bf16 v[128:131], v[60:63], a[128:131], v[128:131]
  ds_read_b64_tr_b16 v[70:71], v15 offset:27648
  v_mfma_f32_16x16x32_bf16 v[128:131], v[64:67], a[144:147], v[128:131]
  ds_read_b64_tr_b16 v[72:73], v15 offset:30720
  s_mov_b32 s65, 12288
  v_mfma_f32_16x16x32_bf16 v[132:135], v[56:59], a[116:119], v[132:135]
  ds_read_b64_tr_b16 v[74:75], v15 offset:31744
  buffer_load_dwordx4 v[248:251], v220, s[72:75], s65 offen sc1
  v_mfma_f32_16x16x32_bf16 v[132:135], v[60:63], a[132:135], v[132:135]
  ds_read_b64_tr_b16 v[76:77], v14 offset:63488
  v_mfma_f32_16x16x32_bf16 v[132:135], v[64:67], a[148:151], v[132:135]
  ds_read_b64_tr_b16 v[78:79], v14 offset:64512
  v_mfma_f32_16x16x32_bf16 v[136:139], v[56:59], a[120:123], v[136:139]
  v_mfma_f32_16x16x32_bf16 v[136:139], v[60:63], a[136:139], v[136:139]
  v_mfma_f32_16x16x32_bf16 v[136:139], v[64:67], a[152:155], v[136:139]
  v_mfma_f32_16x16x32_bf16 v[140:143], v[56:59], a[124:127], v[140:143]
  s_mov_b32 s65, 9449472
  buffer_load_dwordx4 v[252:255], v220, s[72:75], s65 offen sc1
  v_mfma_f32_16x16x32_bf16 v[140:143], v[60:63], a[140:143], v[140:143]
  v_mfma_f32_16x16x32_bf16 v[140:143], v[64:67], a[156:159], v[140:143]
  s_waitcnt lgkmcnt(0)
  v_mfma_f32_16x16x32_bf16 v[128:131], v[68:71], a[96:99], v[128:131]
  s_barrier
  v_mfma_f32_16x16x32_bf16 v[128:131], v[72:75], a[192:195], v[128:131]
  ds_read_b64_tr_b16 v[56:57], v25 offset:4096
  s_add_u32 m0, s101, 0
  v_mfma_f32_16x16x32_bf16 v[128:131], v[76:79], a[208:211], v[128:131]
  ds_read_b64_tr_b16 v[58:59], v25 offset:5120
  s_mov_b32 s64, 0
  v_mfma_f32_16x16x32_bf16 v[132:135], v[68:71], a[100:103], v[132:135]
  ds_read_b64_tr_b16 v[60:61], v15 offset:32768
  buffer_load_dwordx4 v94, s[44:47], s64 offen lds
  v_mfma_f32_16x16x32_bf16 v[132:135], v[72:75], a[196:199], v[132:135]
  ds_read_b64_tr_b16 v[62:63], v15 offset:33792
  s_add_u32 m0, s101, 0
  v_mfma_f32_16x16x32_bf16 v[132:135], v[76:79], a[212:215], v[132:135]
  ds_read_b64_tr_b16 v[64:65], v15
  s_mov_b32 s64, 0
  v_mfma_f32_16x16x32_bf16 v[136:139], v[68:71], a[104:107], v[136:139]
  ds_read_b64_tr_b16 v[66:67], v15 offset:1024
  buffer_load_dwordx4 v94, s[44:47], s64 offen offset:1024 lds
  v_mfma_f32_16x16x32_bf16 v[136:139], v[72:75], a[200:203], v[136:139]
  s_add_u32 m0, s101, 0
  v_mfma_f32_16x16x32_bf16 v[136:139], v[76:79], a[216:219], v[136:139]
  s_mov_b32 s64, 0
  v_mfma_f32_16x16x32_bf16 v[140:143], v[68:71], a[108:111], v[140:143]
  buffer_load_dwordx4 v94, s[44:47], s64 offen offset:2048 lds
  v_mfma_f32_16x16x32_bf16 v[140:143], v[72:75], a[204:207], v[140:143]
  v_mfma_f32_16x16x32_bf16 v[140:143], v[76:79], a[220:223], v[140:143]
  s_waitcnt lgkmcnt(0)
  v_mfma_f32_16x16x32_bf16 v[128:131], v[56:59], a[224:227], v[128:131]
  ds_read_b64_tr_b16 v[68:69], v25 offset:6144
  s_add_u32 m0, s101, 0
  v_mfma_f32_16x16x32_bf16 v[128:131], v[60:63], a[240:243], v[128:131]
  ds_read_b64_tr_b16 v[70:71], v25 offset:7168
  s_mov_b32 s64, 0
  v_mfma_f32_16x16x32_bf16 v[128:131], v[64:67], a[160:163], v[128:131]
  ds_read_b64_tr_b16 v[72:73], v15 offset:34816
  buffer_load_dwordx4 v94, s[44:47], s64 offen offset:3072 lds
  v_mfma_f32_16x16x32_bf16 v[132:135], v[56:59], a[228:231], v[132:135]
  ds_read_b64_tr_b16 v[74:75], v15 offset:35840
  s_add_u32 m0, s101, 16384
  v_mfma_f32_16x16x32_bf16 v[132:135], v[60:63], a[244:247], v[132:135]
  ds_read_b64_tr_b16 v[76:77], v15 offset:2048
  s_mov_b32 s64, 16384
  v_mfma_f32_16x16x32_bf16 v[132:135], v[64:67], a[164:167], v[132:135]
  ds_read_b64_tr_b16 v[78:79], v15 offset:3072
  buffer_load_dwordx4 v94, s[44:47], s64 offen lds
  v_mfma_f32_16x16x32_bf16 v[136:139], v[56:59], a[232:235], v[136:139]
  s_add_u32 m0, s101, 16384
  v_mfma_f32_16x16x32_bf16 v[136:139], v[60:63], a[248:251], v[136:139]
  s_mov_b32 s64, 16384
  v_mfma_f32_16x16x32_bf16 v[136:139], v[64:67], a[168:171], v[136:139]
  buffer_load_dwordx4 v94, s[44:47], s64 offen offset:1024 lds
  v_mfma_f32_16x16x32_bf16 v[140:143], v[56:59], a[236:239], v[140:143]
  v_mfma_f32_16x16x32_bf16 v[140:143], v[60:63], a[252:255], v[140:143]
  v_mfma_f32_16x16x32_bf16 v[140:143], v[64:67], a[172:175], v[140:143]
  s_waitcnt lgkmcnt(0)
  v_mfma_f32_16x16x32_bf16 v[128:131], v[68:71], v[96:99], v[128:131]
  v_mfma_f32_16x16x32_bf16 v[128:131], v[72:75], v[112:115], v[128:131]
  v_mfma_f32_16x16x32_bf16 v[128:131], v[76:79], a[176:179], v[128:131]
  v_mfma_f32_16x16x32_bf16 v[132:135], v[68:71], v[100:103], v[132:135]
  v_mfma_f32_16x16x32_bf16 v[132:135], v[72:75], v[116:119], v[132:135]
  v_mfma_f32_16x16x32_bf16 v[132:135], v[76:79], a[180:183], v[132:135]
  v_mfma_f32_16x16x32_bf16 v[136:139], v[68:71], v[104:107], v[136:139]
  s_add_u32 m0, s101, 16384
  v_mfma_f32_16x16x32_bf16 v[136:139], v[72:75], v[120:123], v[136:139]
  s_mov_b32 s64, 16384
  v_mfma_f32_16x16x32_bf16 v[136:139], v[76:79], a[184:187], v[136:139]
  buffer_load_dwordx4 v94, s[44:47], s64 offen offset:2048 lds
  v_mfma_f32_16x16x32_bf16 v[140:143], v[68:71], v[108:111], v[140:143]
  s_add_u32 m0, s101, 16384
  v_mfma_f32_16x16x32_bf16 v[140:143], v[72:75], v[124:127], v[140:143]
  s_mov_b32 s64, 16384
  v_mfma_f32_16x16x32_bf16 v[140:143], v[76:79], a[188:191], v[140:143]
  buffer_load_dwordx4 v94, s[44:47], s64 offen offset:3072 lds
  v_cvt_pk_bf16_f32 v40, v128, v129
  v_cvt_pk_bf16_f32 v41, v130, v131
  s_mov_b32 s35, 0
  buffer_store_dwordx2 v[40:41], v3, s[20:23], s35 offen sc1
  v_cvt_pk_bf16_f32 v44, v132, v133
  v_cvt_pk_bf16_f32 v45, v134, v135
  s_mov_b32 s35, 18432
  buffer_store_dwordx2 v[44:45], v3, s[20:23], s35 offen sc1
  v_cvt_pk_bf16_f32 v48, v136, v137
  v_cvt_pk_bf16_f32 v49, v138, v139
  s_mov_b32 s35, 36864
  buffer_store_dwordx2 v[48:49], v3, s[20:23], s35 offen sc1
  v_cvt_pk_bf16_f32 v52, v140, v141
  v_cvt_pk_bf16_f32 v53, v142, v143
  s_mov_b32 s35, 55296
  buffer_store_dwordx2 v[52:53], v3, s[20:23], s35 offen sc1
  s_add_u32 s48, s90, 7118848
  s_addc_u32 s49, s91, 0
  s_and_b32 s49, s49, 0xffff
  s_mov_b32 s50, 131072
  s_mov_b32 s51, 0x20000
  s_add_u32 s52, s90, 7077888
  s_addc_u32 s53, s91, 0
  s_and_b32 s53, s53, 0xffff
  s_mov_b32 s54, 32768
  s_mov_b32 s55, 0x20000
  s_add_u32 s56, s90, 7110656
  s_addc_u32 s57, s91, 0
  s_and_b32 s57, s57, 0xffff
  s_mov_b32 s58, 8192
  s_mov_b32 s59, 0x20000
  s_lshl_b32 s36, s93, 4
  s_add_u32 s36, s36, s94
  s_lshr_b32 s37, s36, 1
  s_mul_i32 s37, s37, 18432
  s_and_b32 s38, s36, 1
  s_lshl_b32 s38, s38, 7
  s_add_u32 s39, s37, s38
  s_lshl_b32 s38, s92, 9
  s_add_u32 s39, s39, s38
  v_and_b32 v4, 7, v0
  v_bfe_u32 v6, v0, 3, 1
  v_lshlrev_b32 v4, 4, v4
  v_lshl_add_u32 v4, v6, 8, v4
  v_add_u32 v4, s39, v4
  v_subrev_u32 v18, s37, v4
  v_and_b32 v18, 1023, v18
  v_lshrrev_b32 v18, 1, v18
  s_lshr_b32 s38, s92, 1
  s_lshl_b32 s38, s38, 10
  s_add_u32 s38, s38, s37
  v_add_u32 v18, s38, v18
  v_bfe_u32 v2, v0, 4, 2
  v_lshl_add_u32 v8, v2, 2, v4
  v_lshl_add_u32 v9, v2, 11, v4
  v_lshrrev_b32 v5, 1, v2
  v_lshl_add_u32 v18, v5, 9, v18
  v_and_b32 v4, 1, v2
  v_lshl_add_u32 v18, v4, 2, v18
  s_cmp_lt_u32 s92, 2
  s_cselect_b64 vcc, -1, 0
  v_cndmask_b32 v19, v18, v8, vcc
  v_cndmask_b32 v18, v8, v18, vcc
  s_mov_b32 s65, 0
  buffer_load_dword v56, v8, s[16:19], s65 offen sc1
  buffer_load_dword v57, v8, s[16:19], s65 offen offset:2048 sc1
  s_mov_b32 s65, 4096
  buffer_load_dword v58, v18, s[16:19], s65 offen sc1
  buffer_load_dword v59, v8, s[16:19], s65 offen offset:2048 sc1
  s_mov_b32 s65, 8192
  buffer_load_dword v60, v8, s[16:19], s65 offen sc1
  buffer_load_dword v61, v8, s[16:19], s65 offen offset:2048 sc1
  s_mov_b32 s65, 12288
  buffer_load_dword v62, v19, s[16:19], s65 offen sc1
  buffer_load_dword v63, v8, s[16:19], s65 offen offset:2048 sc1
  s_mov_b32 s65, 16384
  buffer_load_dword v64, v8, s[16:19], s65 offen sc1
  s_lshl_b32 s37, s36, 3
  v_and_b32 v15, 7, v0
  v_add_u32 v10, s37, v15
  v_lshlrev_b32 v12, 2, v10
  v_bfe_u32 v13, v0, 3, 3
  v_lshl_add_u32 v13, v13, 14, v12
  s_mov_b32 s65, 8192
  buffer_load_dword v68, v13, s[48:51], 0 offen sc1
  buffer_load_dword v69, v13, s[48:51], s65 offen sc1
  s_lshl_b32 s37, s36, 7
  v_lshl_add_u32 v17, v15, 2, s37
  buffer_load_dword v67, v17, s[52:55], 0 offen offset:32 sc1
  buffer_load_dword v66, v12, s[56:59], 0 offen sc1
  v_lshl_add_u32 v17, v0, 2, s37
  v_mov_b32 v16, 0x7ffffff0
  v_cmp_gt_u32 vcc, 32, v0
  s_nop 1
  v_cndmask_b32 v17, v16, v17, vcc
  v_lshlrev_b32 v15, 4, v15
  v_add_u32 v15, 163328, v15
  s_lshl_b32 s37, s92, 2
  v_add_u32 v14, s37, v15
  v_mul_u32_u24 v10, 1152, v10
  v_lshl_add_u32 v10, v6, 3, v10
  s_lshr_b32 s37, s92, 1
  s_lshl_b32 s37, s37, 6
  s_and_b32 s38, s92, 1
  s_lshl_b32 s38, s38, 4
  s_add_u32 s37, s37, s38
  v_add_u32 v10, s37, v10
  v_lshl_add_u32 v11, v5, 5, v10
  v_lshl_add_u32 v11, v4, 2, v11
  v_lshl_add_u32 v10, v2, 7, v10
  v_bfe_u32 v4, v0, 1, 4
  v_lshlrev_b32 v4, 7, v4
  v_and_b32 v20, 4, v30
  v_add_u32 v4, v4, v20
  s_lshl_b32 s36, s93, 11
  s_lshl_b32 s37, s94, 3
  s_add_u32 s36, s36, s37
  s_add_u32 s36, s36, 427920
  s_cmp_lt_u32 s94, 14
  s_cselect_b32 s36, 0x7ffffff0, s36
  s_cmp_eq_u32 s93, 15
  s_cselect_b32 s36, 0x7ffffff0, s36
  v_add_u32 v4, s36, v4
  v_lshrrev_b32 v20, 5, v0
  v_cmp_eq_u32 vcc, 1, v20
  s_nop 1
  v_cndmask_b32 v20, v29, v4, vcc
  s_waitcnt vmcnt(13)
  s_barrier
  s_mov_b32 s63, 393216
  buffer_store_dword v7, v29, s[96:99], s63 offen sc1
  s_mov_b32 s63, 393216
  buffer_load_dword v31, v30, s[96:99], s63 offen sc1
  s_waitcnt vmcnt(0)
  v_cmp_ne_u32 vcc, v7, v31
  s_cbranch_vccnz L_sp_32
L_bk_33:
  s_mov_b32 s65, 4096
  buffer_load_dwordx4 v[144:147], v220, s[72:75], s65 offen sc1
  s_mov_b32 s65, 9441280
  buffer_load_dwordx4 v[148:151], v220, s[72:75], s65 offen sc1
  s_mov_b32 s65, 14336
  buffer_load_dwordx4 v[152:155], v220, s[72:75], s65 offen sc1
  s_mov_b32 s65, 9451520
  buffer_load_dwordx4 v[156:159], v220, s[72:75], s65 offen sc1
  s_mov_b32 s65, 6144
  buffer_load_dwordx4 v[160:163], v220, s[72:75], s65 offen sc1
  s_mov_b32 s65, 9443328
  buffer_load_dwordx4 v[164:167], v220, s[72:75], s65 offen sc1
  s_mov_b32 s65, 16384
  buffer_load_dwordx4 v[168:171], v220, s[72:75], s65 offen sc1
  s_mov_b32 s65, 9453568
  buffer_load_dwordx4 v[172:175], v220, s[72:75], s65 offen sc1
  s_mov_b32 s65, 8192
  buffer_load_dwordx2 v[176:177], v221, s[72:75], s65 offen sc1
  buffer_load_dwordx2 v[178:179], v221, s[72:75], s65 offen offset:512 sc1
  s_mov_b32 s65, 9445376
  buffer_load_dwordx2 v[180:181], v221, s[72:75], s65 offen sc1
  buffer_load_dwordx2 v[182:183], v221, s[72:75], s65 offen offset:512 sc1
  v_mfma_f32_16x16x32_bf16 v[196:199], v[212:215], v[240:243], 0
  v_mfma_f32_16x16x32_bf16 v[196:199], v[212:215], v[244:247], v[196:199]
  v_mfma_f32_16x16x32_bf16 v[196:199], v[216:219], v[248:251], v[196:199]
  v_mfma_f32_16x16x32_bf16 v[196:199], v[216:219], v[252:255], v[196:199]
  v_add_f32 v67, v67, v66
  v_add_f32 v68, v68, v69
  s_nop 1
  v_add_f32_dpp v68, v68, v68 row_ror:8 row_mask:0xf bank_mask:0xf
  v_mov_b32 v69, v68
  s_nop 1
  v_permlane16_swap_b32 v68, v69
  v_add_f32 v68, v68, v69
  v_mov_b32 v69, v68
  s_nop 1
  v_permlane32_swap_b32 v68, v69
  v_add_f32 v68, v68, v69
  v_mov_b32 v69, 0x3727c5ac
  v_fmac_f32 v69, 0x3ae38e39, v68
  v_rcp_f32 v66, v69
  s_waitcnt vmcnt(11)
  v_mfma_f32_16x16x32_bf16 v[200:203], v[212:215], v[144:147], 0
  s_waitcnt vmcnt(10)
  v_mfma_f32_16x16x32_bf16 v[200:203], v[212:215], v[148:151], v[200:203]
  s_waitcnt vmcnt(9)
  v_mfma_f32_16x16x32_bf16 v[200:203], v[216:219], v[152:155], v[200:203]
  s_waitcnt vmcnt(8)
  v_mfma_f32_16x16x32_bf16 v[200:203], v[216:219], v[156:159], v[200:203]
  s_waitcnt vmcnt(7)
  v_mfma_f32_16x16x32_bf16 v[204:207], v[212:215], v[160:163], 0
  s_waitcnt vmcnt(6)
  v_mfma_f32_16x16x32_bf16 v[204:207], v[212:215], v[164:167], v[204:207]
  s_waitcnt vmcnt(5)
  v_mfma_f32_16x16x32_bf16 v[204:207], v[216:219], v[168:171], v[204:207]
  s_waitcnt vmcnt(4)
  v_mfma_f32_16x16x32_bf16 v[204:207], v[216:219], v[172:175], v[204:207]
  s_waitcnt vmcnt(2)
  v_mfma_f32_16x16x32_bf16 v[208:211], v[212:215], v[176:179], 0
  s_waitcnt vmcnt(0)
  v_mfma_f32_16x16x32_bf16 v[208:211], v[212:215], v[180:183], v[208:211]
  s_cmp_lg_u32 s95, 0
  s_cbranch_scc1 L_last
  s_add_u32 s48, s90, 45522944
  s_addc_u32 s49, s91, 0
  s_and_b32 s49, s49, 0xffff
  s_mov_b32 s50, 2359296
  s_mov_b32 s51, 0x20000
  s_add_u32 s52, s90, 52600832
  s_addc_u32 s53, s91, 0
  s_and_b32 s53, s53, 0xffff
  s_mov_b32 s54, 32768
  s_mov_b32 s55, 0x20000
  v_lshlrev_b32 v68, 16, v56
  v_and_b32 v69, 0xffff0000, v56
  v_fma_f32 v192, v192, v66, v68
  v_fma_f32 v193, v193, v66, v69
  s_add_u32 m0, s101, 32768
  s_mov_b32 s64, 32768
  buffer_load_dwordx4 v94, s[44:47], s64 offen lds
  v_lshlrev_b32 v68, 16, v57
  v_and_b32 v69, 0xffff0000, v57
  v_fma_f32 v196, v196, v66, v68
  v_fma_f32 v197, v197, v66, v69
  v_lshlrev_b32 v68, 16, v58
  v_and_b32 v69, 0xffff0000, v58
  v_fma_f32 v200, v200, v66, v68
  s_add_u32 m0, s101, 32768
  s_mov_b32 s64, 32768
  buffer_load_dwordx4 v94, s[44:47], s64 offen offset:1024 lds
  v_fma_f32 v201, v201, v66, v69
  v_lshlrev_b32 v68, 16, v59
  v_and_b32 v69, 0xffff0000, v59
  v_fma_f32 v204, v204, v66, v68
  v_fma_f32 v205, v205, v66, v69
  v_lshlrev_b32 v68, 16, v60
  v_and_b32 v69, 0xffff0000, v60
  s_add_u32 m0, s101, 32768
  s_mov_b32 s64, 32768
  buffer_load_dwordx4 v94, s[44:47], s64 offen offset:2048 lds
  v_fma_f32 v208, v208, v66, v68
  v_fma_f32 v209, v209, v66, v69
  v_lshlrev_b32 v68, 16, v61
  v_and_b32 v69, 0xffff0000, v61
  v_fma_f32 v194, v194, v66, v68
  v_fma_f32 v195, v195, v66, v69
  v_lshlrev_b32 v68, 16, v62
  s_add_u32 m0, s101, 32768
  s_mov_b32 s64, 32768
  buffer_load_dwordx4 v94, s[44:47], s64 offen offset:3072 lds
  v_and_b32 v69, 0xffff0000, v62
  v_fma_f32 v198, v198, v66, v68
  v_fma_f32 v199, v199, v66, v69
  v_lshlrev_b32 v68, 16, v63
  v_and_b32 v69, 0xffff0000, v63
  v_fma_f32 v202, v202, v66, v68
  v_fma_f32 v203, v203, v66, v69
  s_add_u32 m0, s101, 49152
  s_mov_b32 s64, 49152
  buffer_load_dwordx4 v94, s[44:47], s64 offen lds
  v_lshlrev_b32 v68, 16, v64
  v_and_b32 v69, 0xffff0000, v64
  v_fma_f32 v206, v206, v66, v68
  v_fma_f32 v207, v207, v66, v69
  v_add_f32 v32, v192, v193
  v_add_f32 v33, v196, v197
  v_add_f32 v32, v32, v200
  s_add_u32 m0, s101, 49152
  s_mov_b32 s64, 49152
  buffer_load_dwordx4 v94, s[44:47], s64 offen offset:1024 lds
  v_add_f32 v33, v33, v201
  v_add_f32 v32, v32, v204
  v_add_f32 v33, v33, v205
  v_add_f32 v32, v32, v208
  v_add_f32 v33, v33, v209
  v_add_f32 v32, v32, v194
  v_add_f32 v33, v33, v195
  s_add_u32 m0, s101, 49152
  s_mov_b32 s64, 49152
  buffer_load_dwordx4 v94, s[44:47], s64 offen offset:2048 lds
  v_add_f32 v32, v32, v198
  v_add_f32 v33, v33, v199
  v_add_f32 v32, v32, v202
  v_add_f32 v33, v33, v203
  v_add_f32 v32, v32, v206
  v_add_f32 v33, v33, v207
  v_add_f32 v32, v32, v33
  s_add_u32 m0, s101, 49152
  s_mov_b32 s64, 49152
  buffer_load_dwordx4 v94, s[44:47], s64 offen offset:3072 lds
  v_mul_f32 v34, v192, v192
  v_mul_f32 v35, v193, v193
  v_fmac_f32 v34, v196, v196
  v_fmac_f32 v35, v197, v197
  v_fmac_f32 v34, v200, v200
  v_fmac_f32 v35, v201, v201
  v_fmac_f32 v34, v204, v204
  s_add_u32 m0, s101, 65536
  s_mov_b32 s64, 65536
  buffer_load_dwordx4 v94, s[44:47], s64 offen lds
  v_fmac_f32 v35, v205, v205
  v_fmac_f32 v34, v208, v208
  v_fmac_f32 v35, v209, v209
  v_fmac_f32 v34, v194, v194
  v_fmac_f32 v35, v195, v195
  v_fmac_f32 v34, v198, v198
  v_fmac_f32 v35, v199, v199
  s_add_u32 m0, s101, 65536
  s_mov_b32 s64, 65536
  buffer_load_dwordx4 v94, s[44:47], s64 offen offset:1024 lds
  v_fmac_f32 v34, v202, v202
  v_fmac_f32 v35, v203, v203
  v_fmac_f32 v34, v206, v206
  v_fmac_f32 v35, v207, v207
  v_add_f32 v34, v34, v35
  v_add_f32_dpp v32, v32, v32 row_ror:8 row_mask:0xf bank_mask:0xf
  s_nop 0
  v_add_f32_dpp v34, v34, v34 row_ror:8 row_mask:0xf bank_mask:0xf
  s_add_u32 m0, s101, 65536
  s_mov_b32 s64, 65536
  buffer_load_dwordx4 v94, s[44:47], s64 offen offset:2048 lds
  v_mov_b32 v33, v32
  v_mov_b32 v35, v34
  s_nop 0
  v_permlane16_swap_b32 v32, v33
  v_permlane16_swap_b32 v34, v35
  v_add_f32 v32, v32, v33
  v_add_f32 v34, v34, v35
  v_mov_b32 v33, v32
  s_add_u32 m0, s101, 65536
  s_mov_b32 s64, 65536
  buffer_load_dwordx4 v94, s[44:47], s64 offen offset:3072 lds
  v_mov_b32 v35, v34
  v_permlane32_swap_b32 v32, v33
  s_nop 0
  v_permlane32_swap_b32 v34, v35
  v_add_f32 v32, v32, v33
  v_add_f32 v34, v34, v35
  ds_write_b32 v14, v32
  ds_write_b32 v14, v34 offset:128
  s_waitcnt lgkmcnt(0)
  s_barrier
  ds_read_b128 v[36:39], v15
  ds_read_b128 v[52:55], v15 offset:128
  s_waitcnt lgkmcnt(1)
  v_add_f32 v36, v36, v37
  v_add_f32 v38, v38, v39
  v_add_f32 v32, v36, v38
  v_mul_f32 v32, 0x3ae38e39, v32
  v_sub_f32 v192, v192, v32
  v_sub_f32 v193, v193, v32
  v_sub_f32 v196, v196, v32
  v_sub_f32 v197, v197, v32
  v_sub_f32 v200, v200, v32
  v_sub_f32 v201, v201, v32
  v_sub_f32 v204, v204, v32
  v_sub_f32 v205, v205, v32
  v_sub_f32 v208, v208, v32
  v_sub_f32 v209, v209, v32
  v_sub_f32 v194, v194, v32
  v_sub_f32 v195, v195, v32
  v_sub_f32 v198, v198, v32
  v_sub_f32 v199, v199, v32
  v_sub_f32 v202, v202, v32
  v_sub_f32 v203, v203, v32
  v_sub_f32 v206, v206, v32
  v_sub_f32 v207, v207, v32
  v_cvt_pk_bf16_f32 v40, v192, v193
  v_cvt_pk_bf16_f32 v41, v196, v197
  v_cvt_pk_bf16_f32 v42, v200, v201
  v_cvt_pk_bf16_f32 v43, v204, v205
  v_cvt_pk_bf16_f32 v44, v208, v209
  v_cvt_pk_bf16_f32 v45, v194, v195
  v_cvt_pk_bf16_f32 v46, v198, v199
  v_cvt_pk_bf16_f32 v47, v202, v203
  v_cvt_pk_bf16_f32 v48, v206, v207
  v_permlane32_swap_b32 v40, v42
  v_permlane32_swap_b32 v41, v43
  v_permlane32_swap_b32 v44, v46
  v_permlane32_swap_b32 v45, v47
  v_permlane16_swap_b32 v40, v41
  v_permlane16_swap_b32 v42, v43
  v_permlane16_swap_b32 v44, v45
  v_permlane16_swap_b32 v46, v47
  s_mov_b32 s34, 8192
  s_mov_b32 s35, 16384
  buffer_store_dwordx4 v[40:43], v9, s[48:51], 0 offen sc1
  buffer_store_dwordx4 v[44:47], v9, s[48:51], s34 offen sc1
  buffer_store_dword v48, v8, s[48:51], s35 offen sc1
  s_waitcnt lgkmcnt(0)
  v_add_f32 v52, v52, v53
  v_add_f32 v54, v54, v55
  v_add_f32 v34, v52, v54
  v_mul_f32 v34, 0x3ae38e39, v34
  v_fma_f32 v34, -v32, v32, v34
  v_max_f32 v34, 0, v34
  v_add_f32 v33, 0x3727c5ac, v34
  v_rsq_f32 v33, v33
  v_add_f32 v32, v32, v67
  v_and_b32 v35, 8, v0
  v_cmp_eq_u32 vcc, 0, v35
  s_nop 1
  v_cndmask_b32 v32, v32, v33, vcc
  buffer_store_dword v32, v17, s[52:55], 0 offen sc1
  s_waitcnt vmcnt(0)
  s_barrier
  s_mov_b32 s36, 45522944
  buffer_store_dword v7, v20, s[96:99], s36 offen sc1
  s_add_u32 m0, s101, 81920
  s_mov_b32 s64, 81920
  buffer_load_dwordx4 v94, s[44:47], s64 offen lds
  s_add_u32 m0, s101, 81920
  s_mov_b32 s64, 81920
  buffer_load_dwordx4 v94, s[44:47], s64 offen offset:1024 lds
  s_add_u32 m0, s101, 81920
  s_mov_b32 s64, 81920
  buffer_load_dwordx4 v94, s[44:47], s64 offen offset:2048 lds
  s_add_u32 m0, s101, 81920
  s_mov_b32 s64, 81920
  buffer_load_dwordx4 v94, s[44:47], s64 offen offset:3072 lds
  s_add_u32 m0, s101, 98304
  s_mov_b32 s64, 98304
  buffer_load_dwordx4 v94, s[44:47], s64 offen lds
  s_add_u32 m0, s101, 98304
  s_mov_b32 s64, 98304
  buffer_load_dwordx4 v94, s[44:47], s64 offen offset:1024 lds
  s_add_u32 m0, s101, 98304
  s_mov_b32 s64, 98304
  buffer_load_dwordx4 v94, s[44:47], s64 offen offset:2048 lds
  s_add_u32 m0, s101, 98304
  s_mov_b32 s64, 98304
  buffer_load_dwordx4 v94, s[44:47], s64 offen offset:3072 lds
  s_add_u32 m0, s101, 114688
  s_mov_b32 s64, 114688
  buffer_load_dwordx4 v94, s[44:47], s64 offen lds
  s_add_u32 m0, s101, 114688
  s_mov_b32 s64, 114688
  buffer_load_dwordx4 v94, s[44:47], s64 offen offset:1024 lds
  s_add_u32 m0, s101, 114688
  s_mov_b32 s64, 114688
  buffer_load_dwordx4 v94, s[44:47], s64 offen offset:2048 lds
  s_add_u32 m0, s101, 114688
  s_mov_b32 s64, 114688
  buffer_load_dwordx4 v94, s[44:47], s64 offen offset:3072 lds
  s_mov_b32 s95, 1
  s_add_u32 s90, s90, 45522944
  s_addc_u32 s91, s91, 0
  s_add_u32 s96, s90, 7249920
  s_addc_u32 s97, s91, 0
  s_and_b32 s97, s97, 0xffff
  s_mov_b32 s98, 46047232
  s_mov_b32 s99, 0x20000
  s_branch L_layer
L_last:
  s_mov_b32 s48, s88
  s_and_b32 s49, s89, 0xffff
  s_mov_b32 s50, 2359296
  s_mov_b32 s51, 0x20000
  v_lshlrev_b32 v68, 16, v56
  v_and_b32 v69, 0xffff0000, v56
  v_fma_f32 v192, v192, v66, v68
  v_fma_f32 v193, v193, v66, v69
  v_lshlrev_b32 v68, 16, v57
  v_and_b32 v69, 0xffff0000, v57
  v_fma_f32 v196, v196, v66, v68
  v_fma_f32 v197, v197, v66, v69
  v_lshlrev_b32 v68, 16, v58
  v_and_b32 v69, 0xffff0000, v58
  v_fma_f32 v200, v200, v66, v68
  v_fma_f32 v201, v201, v66, v69
  v_lshlrev_b32 v68, 16, v59
  v_and_b32 v69, 0xffff0000, v59
  v_fma_f32 v204, v204, v66, v68
  v_fma_f32 v205, v205, v66, v69
  v_lshlrev_b32 v68, 16, v60
  v_and_b32 v69, 0xffff0000, v60
  v_fma_f32 v208, v208, v66, v68
  v_fma_f32 v209, v209, v66, v69
  v_lshlrev_b32 v68, 16, v61
  v_and_b32 v69, 0xffff0000, v61
  v_fma_f32 v194, v194, v66, v68
  v_fma_f32 v195, v195, v66, v69
  v_lshlrev_b32 v68, 16, v62
  v_and_b32 v69, 0xffff0000, v62
  v_fma_f32 v198, v198, v66, v68
  v_fma_f32 v199, v199, v66, v69
  v_lshlrev_b32 v68, 16, v63
  v_and_b32 v69, 0xffff0000, v63
  v_fma_f32 v202, v202, v66, v68
  v_fma_f32 v203, v203, v66, v69
  v_lshlrev_b32 v68, 16, v64
  v_and_b32 v69, 0xffff0000, v64
  v_fma_f32 v206, v206, v66, v68
  v_fma_f32 v207, v207, v66, v69
  v_add_f32 v192, v192, v67
  v_add_f32 v193, v193, v67
  v_add_f32 v196, v196, v67
  v_add_f32 v197, v197, v67
  v_add_f32 v200, v200, v67
  v_add_f32 v201, v201, v67
  v_add_f32 v204, v204, v67
  v_add_f32 v205, v205, v67
  v_add_f32 v208, v208, v67
  v_add_f32 v209, v209, v67
  v_add_f32 v194, v194, v67
  v_add_f32 v195, v195, v67
  v_add_f32 v198, v198, v67
  v_add_f32 v199, v199, v67
  v_add_f32 v202, v202, v67
  v_add_f32 v203, v203, v67
  v_add_f32 v206, v206, v67
  v_add_f32 v207, v207, v67
  v_cvt_pk_bf16_f32 v40, v192, v193
  v_cvt_pk_bf16_f32 v41, v196, v197
  v_cvt_pk_bf16_f32 v42, v200, v201
  v_cvt_pk_bf16_f32 v43, v204, v205
  v_cvt_pk_bf16_f32 v44, v208, v209
  v_cvt_pk_bf16_f32 v45, v194, v195
  v_cvt_pk_bf16_f32 v46, v198, v199
  v_cvt_pk_bf16_f32 v47, v202, v203
  v_cvt_pk_bf16_f32 v48, v206, v207
  v_permlane32_swap_b32 v40, v42
  v_permlane32_swap_b32 v41, v43
  v_permlane32_swap_b32 v44, v46
  v_permlane32_swap_b32 v45, v47
  v_permlane16_swap_b32 v40, v41
  v_permlane16_swap_b32 v42, v43
  v_permlane16_swap_b32 v44, v45
  v_permlane16_swap_b32 v46, v47
  buffer_store_dwordx2 v[40:41], v10, s[48:51], 0 offen
  buffer_store_dwordx2 v[42:43], v10, s[48:51], 0 offen offset:32
  buffer_store_dwordx2 v[44:45], v10, s[48:51], 0 offen offset:512
  buffer_store_dwordx2 v[46:47], v10, s[48:51], 0 offen offset:544
  buffer_store_dword v48, v11, s[48:51], 0 offen offset:1024
L_main_end:
  s_endpgm
L_sp_2:
  s_mov_b32 s100, 0
L_sp_2_l:
  buffer_load_dword v7, v112, s[72:75], 0 offen sc1
  s_add_u32 s100, s100, 1
  s_cmp_gt_u32 s100, 65536
  s_cbranch_scc1 L_bk_3
  s_waitcnt vmcnt(0)
  v_cmp_eq_u32 vcc, 0, v7
  s_cbranch_vccnz L_sp_2_l
  s_branch L_bk_3
L_sp_4:
  s_mov_b32 s100, 0
  s_mov_b32 s36, 98304
L_sp_4_l:
  buffer_load_dword v31, v1, s[96:99], s36 offen sc1
  s_add_u32 s100, s100, 1
  s_cmp_gt_u32 s100, 65536
  s_cbranch_scc1 L_bk_5
  s_waitcnt vmcnt(0)
  v_cmp_ne_u32 vcc, v7, v31
  s_cbranch_vccnz L_sp_4_l
  s_branch L_bk_5
L_sp_6:
  s_mov_b32 s100, 0
  s_mov_b32 s37, 229376
L_sp_6_l:
  buffer_load_dword v31, v27, s[96:99], s37 offen sc1
  s_add_u32 s100, s100, 1
  s_cmp_gt_u32 s100, 65536
  s_cbranch_scc1 L_bk_7
  s_waitcnt vmcnt(0)
  v_cmp_ne_u32 vcc, v7, v31
  s_cbranch_vccnz L_sp_6_l
  s_branch L_bk_7
L_sp_8:
  s_mov_b32 s100, 0
  s_mov_b32 s37, 229376
L_sp_8_l:
  buffer_load_dword v26, v28, s[96:99], s37 offen sc1
  s_add_u32 s100, s100, 1
  s_cmp_gt_u32 s100, 65536
  s_cbranch_scc1 L_bk_9
  s_waitcnt vmcnt(0)
  v_cmp_ne_u32 vcc, v7, v26
  s_cbranch_vccnz L_sp_8_l
  s_branch L_bk_9
L_sp_10:
  s_mov_b32 s100, 0
  s_mov_b32 s36, 0
L_sp_10_l:
  buffer_load_dword v31, v25, s[96:99], s36 offen sc1
  s_add_u32 s100, s100, 1
  s_cmp_gt_u32 s100, 65536
  s_cbranch_scc1 L_bk_11
  s_waitcnt vmcnt(0)
  v_cmp_ne_u32 vcc, v7, v31
  s_cbranch_vccnz L_sp_10_l
  s_branch L_bk_11
L_sp_18:
  s_mov_b32 s100, 0
  s_mov_b32 s36, 32768
L_sp_18_l:
  buffer_load_dword v31, v30, s[96:99], s36 offen sc1
  s_add_u32 s100, s100, 1
  s_cmp_gt_u32 s100, 65536
  s_cbranch_scc1 L_bk_19
  s_waitcnt vmcnt(0)
  v_cmp_ne_u32 vcc, v7, v31
  s_cbranch_vccnz L_sp_18_l
  s_branch L_bk_19
L_sp_20:
  s_mov_b32 s100, 0
  s_mov_b32 s36, 65536
L_sp_20_l:
  buffer_load_dword v31, v30, s[96:99], s36 offen sc1
  s_add_u32 s100, s100, 1
  s_cmp_gt_u32 s100, 65536
  s_cbranch_scc1 L_bk_21
  s_waitcnt vmcnt(0)
  v_cmp_ne_u32 vcc, v7, v31
  s_cbranch_vccnz L_sp_20_l
  s_branch L_bk_21
L_sp_22:
  s_mov_b32 s100, 0
  s_mov_b32 s63, 131072
L_sp_22_l:
  buffer_load_dword v31, v91, s[96:99], s63 offen sc1
  s_add_u32 s100, s100, 1
  s_cmp_gt_u32 s100, 65536
  s_cbranch_scc1 L_bk_23
  s_waitcnt vmcnt(0)
  v_cmp_ne_u32 vcc, v7, v31
  s_cbranch_vccnz L_sp_22_l
  s_branch L_bk_23
L_sp_24:
  s_mov_b32 s100, 0
  s_mov_b32 s63, 163840
L_sp_24_l:
  buffer_load_dword v31, v91, s[96:99], s63 offen sc1
  s_add_u32 s100, s100, 1
  s_cmp_gt_u32 s100, 65536
  s_cbranch_scc1 L_bk_25
  s_waitcnt vmcnt(0)
  v_cmp_ne_u32 vcc, v7, v31
  s_cbranch_vccnz L_sp_24_l
  s_branch L_bk_25
L_sp_26:
  s_mov_b32 s100, 0
  s_mov_b32 s63, 196608
L_sp_26_l:
  buffer_load_dword v31, v91, s[96:99], s63 offen sc1
  s_add_u32 s100, s100, 1
  s_cmp_gt_u32 s100, 65536
  s_cbranch_scc1 L_bk_27
  s_waitcnt vmcnt(0)
  v_cmp_ne_u32 vcc, v7, v31
  s_cbranch_vccnz L_sp_26_l
  s_branch L_bk_27
L_sp_28:
  s_mov_b32 s100, 0
  s_mov_b32 s63, 262144
L_sp_28_l:
  buffer_load_dword v31, v30, s[96:99], s63 offen sc1
  s_add_u32 s100, s100, 1
  s_cmp_gt_u32 s100, 65536
  s_cbranch_scc1 L_bk_29
  s_waitcnt vmcnt(0)
  v_cmp_ne_u32 vcc, v7, v31
  s_cbranch_vccnz L_sp_28_l
  s_branch L_bk_29
L_sp_30:
  s_mov_b32 s100, 0
  s_mov_b32 s63, 294912
L_sp_30_l:
  buffer_load_dword v31, v30, s[96:99], s63 offen sc1
  s_add_u32 s100, s100, 1
  s_cmp_gt_u32 s100, 65536
  s_cbranch_scc1 L_bk_31
  s_waitcnt vmcnt(0)
  v_cmp_ne_u32 vcc, v7, v31
  s_cbranch_vccnz L_sp_30_l
  s_branch L_bk_31
L_sp_32:
  s_mov_b32 s100, 0
  s_mov_b32 s63, 393216
L_sp_32_l:
  buffer_load_dword v31, v30, s[96:99], s63 offen sc1
  s_add_u32 s100, s100, 1
  s_cmp_gt_u32 s100, 65536
  s_cbranch_scc1 L_bk_33
  s_waitcnt vmcnt(0)
  v_cmp_ne_u32 vcc, v7, v31
  s_cbranch_vccnz L_sp_32_l
  s_branch L_bk_33
L_code_end:
.section .rodata,"a"
.p2align 6
.amdhsa_kernel interleave_layers__sliding_local_dilated__glu_gated_bilinear__prompt_kernel
  .amdhsa_next_free_vgpr 512
  .amdhsa_next_free_sgpr 102
  .amdhsa_accum_offset 256
  .amdhsa_group_segment_fixed_size 0
  .amdhsa_kernarg_size 80
  .amdhsa_user_sgpr_count 2
  .amdhsa_user_sgpr_kernarg_segment_ptr 1
  .amdhsa_system_sgpr_workgroup_id_x 1
  .amdhsa_float_denorm_mode_32 3
.end_amdhsa_kernel
```
